```python
import torch

def _softmax(x, axis=-1):
    return torch.softmax(x, dim=axis)
def _gelu(x):
    return torch.nn.functional.gelu(x, approximate="tanh")
def _silu(x):
    return torch.nn.functional.silu(x)
def _sigmoid(x):
    return torch.sigmoid(x)
def _layernorm(x, axis=-1, eps=1e-5):
    m = x.mean(dim=axis, keepdim=True)
    v = x.var(dim=axis, keepdim=True, unbiased=False)
    return (x - m) / torch.sqrt(v + eps)
def _scatter_add(tgt, idx, src, axis=0):
    return tgt.clone().index_add_(axis, idx, src)
def _segment_sum(src, seg, n):
    out = torch.zeros((n,) + src.shape[1:], dtype=src.dtype)
    return out.index_add_(0, seg, src)
def _pad(x, pw):
    flat = tuple(v for pair in reversed(pw) for v in pair)
    return torch.nn.functional.pad(x, flat)

kernel_name = 'interleave_layers__sliding_local_dilated__ssm_conv_s4d__prompt'

def setup_inputs():

    _w = (lambda a: (lambda t: t.to(torch.bfloat16) if t.is_floating_point() else t)(torch.as_tensor(a)))
    def _A_setup():
        B, S, D = 1, 2048, 640
        return {
            "x": _w((lambda *s: torch.randn(*s, dtype=torch.bfloat16) * 0.05)(B, S, D)),
            "wqkv": _w((lambda *s: torch.randn(*s, dtype=torch.bfloat16) * 0.05)(D, 3 * D)),
            "wo": _w((lambda *s: torch.randn(*s, dtype=torch.bfloat16) * 0.05)(D, D)),
        }
    _A_in = _A_setup()

    def _B_setup():
        Bsz, L, D, N = 1, 2048, 640, 192
        return {
            "u": _w((lambda *s: torch.randn(*s, dtype=torch.bfloat16) * 0.05)(Bsz, L, D)),
            "log_A_real": _w((lambda *s: torch.randn(*s, dtype=torch.bfloat16) * 3.2)(D, N) * 0.5),
            "A_imag": _w((lambda *s: torch.randn(*s, dtype=torch.bfloat16) * 0.1)(D, N) * 3.14),
            "C_real": _w((lambda *s: torch.randn(*s, dtype=torch.bfloat16) * 0.4)(D, N) / N ** 0.5),
            "C_imag": _w((lambda *s: torch.randn(*s, dtype=torch.bfloat16) * 0.4)(D, N) / N ** 0.5),
            "log_dt": _w((lambda *s: torch.randn(*s, dtype=torch.bfloat16) * 0.1)(D) * 0.5 - 4.0),
            "D_skip": _w((lambda *s: torch.randn(*s, dtype=torch.bfloat16) * 0.1)(D)),
        }
    _B_in = _B_setup()

    return {
        "A_x": _A_in["x"],
        "A_wqkv": _A_in["wqkv"],
        "A_wo": _A_in["wo"],
        "B_u": _B_in["u"],
        "B_log_A_real": _B_in["log_A_real"],
        "B_A_imag": _B_in["A_imag"],
        "B_C_real": _B_in["C_real"],
        "B_C_imag": _B_in["C_imag"],
        "B_log_dt": _B_in["log_dt"],
        "B_D_skip": _B_in["D_skip"],
    }

def reference(A_x, A_wqkv, A_wo, B_u, B_log_A_real, B_A_imag, B_C_real, B_C_imag, B_log_dt, B_D_skip):
    def _A_ref(x, wqkv, wo):
        B, S, D = x.shape
        H = 32; Dh = D // H
        W, dil = 8, 2
        qkv = (lambda x, *d: x.permute(*d))((x @ wqkv).reshape(B, S, 3, H, Dh), 2, 0, 3, 1, 4)
        q, k, v = qkv[0], qkv[1], qkv[2]
        scale = Dh ** -0.5
        pos = torch.arange(S)
        off = torch.arange(W) * dil
        idx = pos[:, None] - off[None, :]
        mask = idx >= 0
        idx_c = torch.where(mask, idx, 0).reshape(-1)
        kg = k[:, :, idx_c, :].reshape(B, H, S, W, Dh)
        vg = v[:, :, idx_c, :].reshape(B, H, S, W, Dh)
        logits = torch.einsum("bhsd,bhswd->bhsw", q, kg) * scale
        logits = torch.where(mask[None, None, :, :], logits, -1e9)
        attn = _softmax(logits, axis=-1)
        o = torch.einsum("bhsw,bhswd->bhsd", attn, vg)
        return (lambda x, *d: x.permute(*d))(o, 0, 2, 1, 3).reshape(B, S, D) @ wo

    def _B_ref(u, log_A_real, A_imag, C_real, C_imag, log_dt, D_skip):
        L = u.shape[1]
        dt = torch.exp(log_dt)
        A = -torch.exp(log_A_real) + 1j * A_imag
        C = (C_real + 1j * C_imag) * dt[:, None]
        pos = (lambda x, dt: x.to(dt))(torch.arange(L), log_dt.dtype)
        P = torch.exp((A * dt[:, None])[:, :, None] * pos[None, None, :])
        K = 2.0 * torch.einsum("dn,dnl->dl", C, P).real
        L2 = 2 * L
        u_t = (lambda x, *d: x.permute(*d))(u, 0, 2, 1)
        Kf = (lambda x, *a, **k: torch.fft.rfft(x.float(), *a, **k))(K, L2)
        Uf = (lambda x, *a, **k: torch.fft.rfft(x.float(), *a, **k))(u_t, L2)
        y = (lambda x, *a, **k: torch.fft.irfft(x, *a, **k).to(torch.bfloat16))(Uf * Kf[None, :, :], L2)[:, :, :L]
        y = (lambda x, *d: x.permute(*d))(y, 0, 2, 1)
        return y + u * D_skip[None, None, :]

    x = A_x
    x = x + _A_ref(_layernorm(x, axis=-1), A_wqkv, A_wo)
    x = x + _B_ref(_layernorm(x, axis=-1), B_log_A_real, B_A_imag, B_C_real, B_C_imag, B_log_dt, B_D_skip)
    x = x + _A_ref(_layernorm(x, axis=-1), A_wqkv, A_wo)
    x = x + _B_ref(_layernorm(x, axis=-1), B_log_A_real, B_A_imag, B_C_real, B_C_imag, B_log_dt, B_D_skip)
    return x
```

```asm
; @launch grid=(256,1,1) block=(256,1,1) lds=163840
.amdgcn_target "amdgcn-amd-amdhsa--gfx950"
.text
.globl interleave_layers__sliding_local_dilated__ssm_conv_s4d__prompt_kernel
.p2align 8
.type interleave_layers__sliding_local_dilated__ssm_conv_s4d__prompt_kernel,@function
interleave_layers__sliding_local_dilated__ssm_conv_s4d__prompt_kernel:
    s_getpc_b64 s[42:43]
L_start:
    s_cmp_ge_u32 s2, 256
    s_cbranch_scc1 L_end
    s_load_dwordx16 s[44:59], s[0:1], 0
    s_load_dwordx8 s[60:67], s[0:1], 64
    s_load_dwordx2 s[68:69], s[0:1], 96
    v_and_b32 v1, 63, v0
    v_lshrrev_b32 v2, 6, v0
    s_nop 0
    v_readfirstlane_b32 s24, v2
    s_bfe_u32 s82, s2, 0x40003
    s_lshl_b32 s82, s82, 13
    v_lshrrev_b32 v159, 2, v0
    v_lshl_add_u32 v159, v159, 7, s82
    v_min_u32 v159, L_last-L_start, v159
    global_load_dword v159, v159, s[42:43]
    s_and_b32 s25, s2, 7
    s_lshr_b32 s26, s2, 3
    s_and_b32 s27, s26, 3
    s_lshr_b32 s28, s26, 4
    s_lshl_b32 s28, s28, 2
    s_add_u32 s3, s27, s28
    s_lshl_b32 s27, s3, 2
    s_lshr_b32 s70, 0x75206431, s27
    s_and_b32 s70, s70, 7
    s_and_b32 s27, s25, 1
    s_lshl_b32 s27, s27, 3
    s_add_u32 s70, s70, s27
    s_bfe_u32 s71, s26, 0x10002
    s_bfe_u32 s28, s26, 0x10003
    s_and_b32 s72, s25, 6
    s_add_u32 s72, s72, s28
    s_and_b32 s73, s26, 7
    s_lshr_b32 s28, s26, 3
    s_lshl_b32 s74, s25, 2
    s_add_u32 s74, s74, s28
    s_mul_i32 s75, s25, 20
    s_add_u32 s75, s75, s26
    s_min_u32 s27, s2, 239
    s_mul_i32 s25, s27, 10923
    s_lshr_b32 s25, s25, 16
    s_mul_i32 s26, s25, 6
    s_sub_u32 s26, s27, s26
    s_mul_i32 s27, s25, 61440
    s_mul_i32 s28, s26, 640
    s_add_u32 s27, s27, s28
    s_lshl_b32 s28, s24, 10
    v_add_u32 v85, 0, v0
    v_mul_u32_u24 v84, 1639, v85
    v_lshrrev_b32 v84, 16, v84
    v_mul_u32_u24 v84, 3200, v84
    v_lshl_add_u32 v85, v85, 4, v84
    v_add_u32 v86, 256, v0
    v_mul_u32_u24 v84, 1639, v86
    v_lshrrev_b32_e64 v84, 16, v84
    v_mul_u32_u24 v84, 3200, v84
    v_lshl_add_u32 v86, v86, 4, v84
    v_add_u32 v87, 512, v0
    v_min_u32 v87, 639, v87
    v_mul_u32_u24 v84, 1639, v87
    v_lshrrev_b32_e64 v84, 16, v84
    v_mul_u32_u24 v84, 3200, v84
    v_lshl_add_u32 v87, v87, 4, v84
    s_mov_b32 s76, 0
    s_mov_b32 s77, 0x80000000
    s_mov_b32 s80, -1
    s_mov_b32 s81, 0
    s_nop 0
    s_mov_b32 s78, 0xfe0000fe
    s_mov_b32 s79, 0xfe0000fe
    s_mov_b32 s6, 2621440
    s_mov_b32 s7, 0x20000
    s_mov_b32 s10, 2457600
    s_mov_b32 s11, 0x20000
    s_mov_b32 s14, 819200
    s_mov_b32 s15, 0x20000
    s_mov_b32 s18, 22061056
    s_mov_b32 s19, 0x20000
    s_mov_b32 s22, 2621440
    s_mov_b32 s23, 0x20000
    s_waitcnt lgkmcnt(0)
    s_mov_b32 s4, s44
    s_and_b32 s5, s45, 0xffff
    s_mov_b32 s8, s46
    s_and_b32 s9, s47, 0xffff
    s_mov_b32 s12, s48
    s_and_b32 s13, s49, 0xffff
    s_mov_b32 s16, s68
    s_and_b32 s17, s69, 0xffff
    s_mov_b32 s20, s64
    s_and_b32 s21, s65, 0xffff
    s_cmp_lg_u32 s2, 255
    s_cbranch_scc1 fz_1
    v_mov_b32 v120, 0
    v_mov_b32 v121, 0
    v_mov_b32 v122, 0
    v_mov_b32 v123, 0
    v_lshlrev_b32 v124, 4, v0
    s_mov_b32 s88, 3538944
    buffer_store_dwordx4 v[120:123], v124, s[16:19], s88 offen sc1
    s_mov_b32 s88, 3543040
    buffer_store_dwordx4 v[120:123], v124, s[16:19], s88 offen sc1
    s_mov_b32 s88, 3547136
    buffer_store_dwordx4 v[120:123], v124, s[16:19], s88 offen sc1
    s_mov_b32 s88, 3555328
    buffer_store_dwordx4 v[120:123], v124, s[16:19], s88 offen sc1
    s_mov_b32 s88, 3559424
    buffer_store_dwordx4 v[120:123], v124, s[16:19], s88 offen sc1
    s_mov_b32 s88, 3563520
    buffer_store_dwordx4 v[120:123], v124, s[16:19], s88 offen sc1
fz_1:
    s_min_u32 s96, s75, 159
    s_lshl_b32 s96, s96, 2
    s_add_u32 s96, s96, s24
    s_mul_i32 s97, s96, 384
    s_lshl_b32 s96, s96, 1
    v_lshl_add_u32 v2, v1, 2, s97
    v_mov_b32 v241, s96
    global_load_dword v232, v2, s[52:53]
    global_load_dword v233, v2, s[54:55]
    global_load_dword v234, v2, s[56:57]
    global_load_dword v235, v2, s[58:59]
    global_load_ushort v240, v241, s[60:61]
    s_add_u32 m0, s28, 134272
    s_nop 0
    buffer_load_dwordx4 v85, s[8:11], s27 offen lds
    s_add_u32 m0, s28, 138368
    s_nop 0
    buffer_load_dwordx4 v86, s[8:11], s27 offen lds
    s_add_u32 m0, s28, 142464
    s_nop 0
    buffer_load_dwordx4 v87, s[8:11], s27 offen lds
    s_lshr_b32 s29, s26, 1
    s_and_b32 s30, s26, 1
    s_lshl_b32 s30, s30, 3
    s_lshl_b32 s31, s25, 10
    s_add_u32 s31, s31, 0
    s_cmp_ge_u32 s2, 240
    s_cselect_b32 s31, 1073741824, s31
    v_bfe_u32 v93, v0, 2, 2
    v_bfe_u32 v92, v0, 1, 1
    v_lshl_add_u32 v92, v92, 3, v93
    v_mul_u32_u24 v92, 640, v92
    v_and_b32 v93, 1, v0
    v_mul_u32_u24 v93, 40, v93
    v_add_u32 v91, v92, v93
    v_add_u32 v91, 134272, v91
    v_lshrrev_b32 v88, 4, v0
    v_add_u32 v88, 0, v88
    v_cmp_gt_u32 vcc, 40, v88
    v_min_u32 v88, 39, v88
    v_mul_u32_u24 v89, 13108, v88
    v_lshrrev_b32 v89, 16, v89
    v_mul_u32_u24 v90, 5, v89
    v_sub_u32_e64 v90, v88, v90
    v_mul_u32_u24 v92, 80, v89
    v_lshl_add_u32 v92, v90, 3, v92
    v_add_u32 v111, v92, v91
    v_add_u32 v89, s30, v89
    v_cmp_eq_u32 s[82:83], 4, v90
    v_mov_b32 v92, s29
    s_nop 0
    v_cndmask_b32 v93, v90, v92, s[82:83]
    v_cndmask_b32 v92, v92, 3, s[82:83]
    v_lshl_add_u32 v89, v89, 2, v93
    v_mul_u32_u24 v89, 40960, v89
    v_lshl_add_u32 v89, v92, 8, v89
    v_and_b32 v92, 15, v0
    v_lshl_add_u32 v89, v92, 4, v89
    v_mov_b32 v92, 1073741824
    v_cndmask_b32 v89, v92, v89, vcc
    v_add_u32 v108, s31, v89
    v_lshrrev_b32 v88, 4, v0
    v_add_u32 v88, 16, v88
    v_cmp_gt_u32 vcc, 40, v88
    v_min_u32 v88, 39, v88
    v_mul_u32_u24 v89, 13108, v88
    v_lshrrev_b32 v89, 16, v89
    v_mul_u32_u24 v90, 5, v89
    v_sub_u32_e64 v90, v88, v90
    v_mul_u32_u24 v92, 80, v89
    v_lshl_add_u32 v92, v90, 3, v92
    v_add_u32 v112, v92, v91
    v_add_u32 v89, s30, v89
    v_cmp_eq_u32 s[82:83], 4, v90
    v_mov_b32 v92, s29
    s_nop 0
    v_cndmask_b32 v93, v90, v92, s[82:83]
    v_cndmask_b32 v92, v92, 3, s[82:83]
    v_lshl_add_u32 v89, v89, 2, v93
    v_mul_u32_u24 v89, 40960, v89
    v_lshl_add_u32 v89, v92, 8, v89
    v_and_b32 v92, 15, v0
    v_lshl_add_u32 v89, v92, 4, v89
    v_mov_b32 v92, 1073741824
    v_cndmask_b32 v89, v92, v89, vcc
    v_add_u32 v109, s31, v89
    v_lshrrev_b32 v88, 4, v0
    v_add_u32 v88, 32, v88
    v_cmp_gt_u32 vcc, 40, v88
    v_min_u32 v88, 39, v88
    v_mul_u32_u24 v89, 13108, v88
    v_lshrrev_b32 v89, 16, v89
    v_mul_u32_u24 v90, 5, v89
    v_sub_u32_e64 v90, v88, v90
    v_mul_u32_u24 v92, 80, v89
    v_lshl_add_u32 v92, v90, 3, v92
    v_add_u32 v113, v92, v91
    v_add_u32 v89, s30, v89
    v_cmp_eq_u32 s[82:83], 4, v90
    v_mov_b32 v92, s29
    s_nop 0
    v_cndmask_b32 v93, v90, v92, s[82:83]
    v_cndmask_b32 v92, v92, 3, s[82:83]
    v_lshl_add_u32 v89, v89, 2, v93
    v_mul_u32_u24 v89, 40960, v89
    v_lshl_add_u32 v89, v92, 8, v89
    v_and_b32 v92, 15, v0
    v_lshl_add_u32 v89, v92, 4, v89
    v_mov_b32 v92, 1073741824
    v_cndmask_b32 v89, v92, v89, vcc
    v_add_u32 v110, s31, v89
    s_mul_i32 s25, s3, 18
    s_lshl_b32 s26, s72, 7
    s_add_u32 s25, s25, s26
    s_add_u32 s25, s25, s71
    s_add_u32 s25, s25, -16
    s_max_i32 s25, s25, 0
    s_mul_i32 s25, s25, 1280
    v_lshrrev_b32_e64 v204, 1, v0
    v_min_u32 v204, 89, v204
    v_mul_u32_u24 v205, 6554, v204
    v_lshrrev_b32_e64 v205, 16, v205
    v_mul_u32_u24 v205, 1280, v205
    v_lshl_add_u32 v204, v204, 7, v205
    buffer_load_dword v204, v204, s[4:7], s25 offen
    s_and_b32 s25, s2, 7
    s_lshl_b32 s86, s25, 7
    s_add_u32 s86, s86, 3538944
    s_lshl_b32 s87, s25, 10
    s_add_u32 s87, s87, 3538944
    s_add_u32 s89, s87, 16384
    v_cmp_gt_u32 s[50:51], 8, v0
    v_cmp_eq_u32 vcc, 0, v0
    v_lshlrev_b32 v4, 7, v1
    v_mov_b32 v6, 1073741824
    v_cndmask_b32 v4, v6, v4, s[50:51]
    v_cndmask_b32 v6, v6, 0, vcc
    v_mov_b32 v5, 0
    v_mov_b32 v140, 0
    v_mov_b32_e64 v141, 0
    v_mov_b32 v142, 0x3f803f80
    v_mov_b32 v143, 0x3f803f80
    v_lshlrev_b32_e64 v144, 3, v0
    v_add_u32 v144, 155648, v144
    ds_write_b64 v144, v[140:141]
    ds_write_b64 v144, v[142:143] offset:2048
    v_and_b32 v50, 31, v1
    v_lshrrev_b32 v51, 5, v1
    v_mul_u32_u24 v52, 40, v50
    v_mul_u32_u24 v53, 3200, v51
    v_add_u32 v53, v52, v53
    s_lshl_b32 s25, s24, 3
    s_add_u32 s25, s25, 320
    v_add_u32 v38, s25, v53
    s_mul_i32 s25, s24, 6400
    s_add_u32 s25, s25, 352
    v_add_u32 v39, s25, v53
    s_lshl_b32 s31, s71, 12
    v_lshl_add_u32 v47, v50, 3, s31
    v_bfe_u32 v52, v1, 2, 1
    v_and_b32 v53, 3, v1
    v_lshlrev_b32 v54, 13, v52
    v_lshl_add_u32 v54, v53, 3, v54
    v_add_u32_e64 v48, s31, v54
    v_bfe_u32 v54, v1, 4, 1
    v_lshl_add_u32 v52, v54, 1, v52
    v_mul_u32_u24 v52, 40, v52
    v_add_u32 v52, v52, v53
    v_mul_u32_u24_e64 v52, 40, v52
    v_bfe_u32 v53, v1, 3, 1
    v_cmp_eq_u32 s[82:83], v53, v54
    v_lshl_add_u32 v53, v53, 1, v51
    v_cmp_eq_u32 vcc, 3, v53
    v_mov_b32 v54, s24
    s_nop 0
    v_cndmask_b32 v53, v53, v54, vcc
    v_cndmask_b32 v54, v54, 4, vcc
    v_mul_u32_u24 v53, 6400, v53
    v_lshl_add_u32 v52, v54, 3, v52
    v_add_u32_e64 v52, v52, v53
    v_add_u32 v40, 160, v52
    v_mov_b32 v52, 19584
    v_cndmask_b32 v49, 0, v52, s[78:79]
    v_and_b32 v50, 15, v1
    v_lshrrev_b32 v51, 4, v1
    s_and_b32 s25, s24, 1
    s_and_b32 s26, s24, 2
    s_mul_i32 s27, s25, 3200
    s_mul_i32 s28, s26, 320
    s_add_u32 s27, s27, s28
    s_add_u32 s27, s27, 0
    v_and_b32 v52, 1, v1
    v_mul_u32_u24 v52, 1600, v52
    v_lshrrev_b32 v53, 1, v50
    v_mul_u32_u24_e64 v54, 40, v53
    v_add3_u32 v52, v52, v54, s27
    v_lshl_add_u32 v41, v51, 3, v52
    v_add_u32_e64 v42, 32, v52
    v_bfe_u32 v52, v1, 2, 1
    v_mul_u32_u24 v52, 1600, v52
    v_lshrrev_b32 v54, 3, v1
    v_mul_u32_u24 v54, 40, v54
    v_add3_u32 v52, v52, v54, s27
    v_add_u32 v52, 12800, v52
    v_and_b32 v54, 3, v1
    v_lshl_add_u32 v43, v54, 3, v52
    v_add_u32 v52, 32, v52
    v_cmp_eq_u32 vcc, 0, v54
    v_mov_b32 v54, 157696
    s_nop 0
    v_cndmask_b32 v44, v54, v52, vcc
    v_and_b32 v52, 1, v51
    v_add_u32 v52, s26, v52
    v_lshrrev_b32 v54, 2, v50
    v_lshl_add_u32 v52, v52, 2, v54
    v_and_b32 v53, 1, v53
    v_lshl_add_u32 v52, v53, 4, v52
    v_and_b32 v53, 1, v50
    v_lshl_add_u32 v52, v53, 10, v52
    s_lshl_b32 s30, s70, 1
    s_add_u32 s30, s30, s25
    s_lshl_b32 s29, s30, 3
    s_add_u32 s29, s29, s71
    s_lshl_b32 s29, s29, 13
    v_lshrrev_b32 v53, 1, v51
    v_lshlrev_b32 v53, 15, v53
    v_lshl_add_u32 v53, v52, 4, v53
    v_add_u32_e64 v45, s29, v53
    s_lshl_b32 s29, s30, 2
    s_add_u32 s29, s29, s71
    s_lshl_b32 s29, s29, 12
    s_add_u32 s29, s29, 2097152
    v_lshl_add_u32 v46, v52, 3, s29
    s_or_b32 s29, s26, s72
    s_cmp_eq_u32 s29, 0
    s_cselect_b64 s[90:91], -1, 0
    v_lshlrev_b32 v52, 2, v51
    v_sub_u32 v52, v50, v52
    v_mov_b32 v55, 0xf149f2ca
    v_subrev_u32 v53, 0, v52
    v_cmp_lt_u32 vcc, 7, v53
    s_nop 1
    v_cndmask_b32 v28, 0, v55, vcc
    v_cmp_lt_i32 vcc, -9, v53
    s_nop 1
    v_cndmask_b32 v32, 0, v55, vcc
    v_cmp_le_i32 vcc, 0, v53
    v_mov_b32 v54, 0xffff
    s_nop 0
    v_cndmask_b32 v54, 0, v54, vcc
    v_mov_b32 v36, v54
    v_subrev_u32 v53, 1, v52
    v_cmp_lt_u32 vcc, 7, v53
    s_nop 1
    v_cndmask_b32 v29, 0, v55, vcc
    v_cmp_lt_i32 vcc, -9, v53
    s_nop 1
    v_cndmask_b32 v33, 0, v55, vcc
    v_cmp_le_i32 vcc, 0, v53
    v_mov_b32 v54, 0xffff0000
    s_nop 0
    v_cndmask_b32 v54, 0, v54, vcc
    v_or_b32 v36, v36, v54
    v_subrev_u32 v53, 2, v52
    v_cmp_lt_u32 vcc, 7, v53
    s_nop 1
    v_cndmask_b32 v30, 0, v55, vcc
    v_cmp_lt_i32 vcc, -9, v53
    s_nop 1
    v_cndmask_b32 v34, 0, v55, vcc
    v_cmp_le_i32 vcc, 0, v53
    v_mov_b32 v54, 0xffff
    s_nop 0
    v_cndmask_b32 v54, 0, v54, vcc
    v_mov_b32 v37, v54
    v_subrev_u32 v53, 3, v52
    v_cmp_lt_u32 vcc, 7, v53
    s_nop 1
    v_cndmask_b32 v31, 0, v55, vcc
    v_cmp_lt_i32 vcc, -9, v53
    s_nop 1
    v_cndmask_b32 v35, 0, v55, vcc
    v_cmp_le_i32 vcc, 0, v53
    v_mov_b32 v54, 0xffff0000
    s_nop 0
    v_cndmask_b32 v54, 0, v54, vcc
    v_or_b32 v37, v37, v54
    v_and_b32 v62, 15, v1
    v_lshrrev_b32 v63, 4, v1
    s_and_b32 s25, s74, 3
    s_lshr_b32 s26, s74, 2
    s_lshl_b32 s27, s24, 6
    s_add_u32 s27, s27, s25
    s_lshl_b32 s27, s27, 13
    s_lshl_b32 s28, s26, 9
    s_add_u32 s27, s27, s28
    v_lshl_add_u32 v64, v63, 17, s27
    v_lshl_add_u32 v56, v62, 4, v64
    s_lshl_b32 s27, s24, 5
    s_add_u32 s27, s27, s25
    s_lshl_b32 s27, s27, 12
    s_lshl_b32 s28, s26, 8
    s_add_u32 s27, s27, s28
    s_add_u32 s27, s27, 2097152
    v_lshl_add_u32 v64, v63, 15, s27
    v_lshl_add_u32 v57, v62, 3, v64
    v_lshlrev_b32 v58, 4, v1
    s_lshl_b32 s29, s25, 12
    s_add_u32 s29, s29, s28
    v_lshl_add_u32 v64, v62, 4, s29
    v_lshl_add_u32 v61, v63, 2, v64
    s_mul_i32 s30, s73, 20
    s_lshl_b32 s31, s24, 2
    s_add_u32 s30, s30, s31
    s_lshl_b32 s31, s30, 14
    v_lshl_add_u32 v64, v63, 14, v64
    v_add_u32 v59, s31, v64
    s_lshl_b32 s31, s26, 7
    s_add_u32 s31, s31, s25
    s_mul_i32 s31, s31, 1280
    s_lshl_b32 s30, s30, 3
    s_add_u32 s31, s31, s30
    v_mul_u32_u24 v64, 10240, v62
    v_lshl_add_u32 v64, v63, 3, v64
    v_add_u32_e64 v60, s31, v64
    s_lshl_b32 s25, s24, 12
    v_lshl_add_u32 v62, v1, 4, s25
    s_mul_i32 s25, s24, 1216
    s_add_u32 s25, s25, 192
    v_lshl_add_u32 v63, v1, 2, s25
    s_mul_i32 s25, s24, 4864
    s_add_u32 s25, s25, 80
    v_and_b32_e64 v70, 3, v1
    v_mul_u32_u24 v70, 1216, v70
    v_bfe_u32 v71, v1, 2, 3
    v_lshl_add_u32 v70, v71, 4, v70
    v_lshrrev_b32 v71, 5, v1
    v_lshl_add_u32 v70, v71, 4, v70
    v_add_u32 v64, s25, v70
    s_mul_i32 s25, s24, 4160
    s_add_u32 s25, s25, 134368
    v_lshlrev_b32 v71, 6, v71
    v_sub_u32 v71, s25, v71
    v_bfe_u32 v70, v1, 4, 1
    v_lshl_add_u32 v71, v70, 5, v71
    v_and_b32_e64 v70, 3, v1
    v_lshl_add_u32 v71, v70, 3, v71
    v_bfe_u32 v70, v1, 2, 2
    v_lshlrev_b32 v70, 3, v70
    v_sub_u32 v65, v71, v70
    s_mul_i32 s25, s24, 4224
    s_add_u32 s25, s25, 19456
    v_and_b32 v70, 3, v1
    v_mul_u32_u24 v70, 1056, v70
    v_and_b32 v71, 60, v1
    v_add3_u32 v66, v70, v71, s25
    s_mul_i32 s25, s24, 1056
    s_add_u32 s25, s25, 19456
    v_lshl_add_u32 v67, v1, 3, s25
    s_mul_i32 s25, s24, 1280
    s_lshl_b32 s26, s75, 3
    s_add_u32 s25, s25, s26
    v_mul_u32_u24 v70, 10240, v1
    v_add_u32 v68, s25, v70
    s_and_b32 s25, s24, 1
    s_lshl_b32 s25, s25, 6
    s_and_b32 s26, s24, 2
    s_add_u32 s25, s25, s26
    s_mul_i32 s25, s25, 1280
    v_lshrrev_b32 v140, 4, v1
    v_and_b32 v141, 15, v1
    v_xor_b32 v141, v140, v141
    v_lshlrev_b32_e64 v141, 4, v141
    v_mul_u32_u24 v142, 5120, v140
    v_add3_u32 v73, v141, v142, s25
    s_and_b32 s25, s24, 1
    s_lshl_b32 s25, s25, 3
    s_add_u32 s25, s25, s26
    s_mul_i32 s25, s25, 1280
    v_add3_u32 v77, v141, v142, s25
    v_lshrrev_b32 v141, 5, v1
    v_and_b32 v140, 3, v1
    v_xor_b32 v142, v140, v141
    v_lshlrev_b32_e64 v142, 4, v142
    v_lshl_add_u32 v142, v140, 8, v142
    v_bfe_u32 v140, v1, 2, 3
    v_mul_u32_u24 v140, 1088, v140
    v_add_u32 v78, v140, v142
    v_and_b32 v140, 1, v1
    v_xor_b32 v142, v140, v141
    v_lshlrev_b32 v142, 4, v142
    v_lshl_add_u32 v142, v140, 8, v142
    v_bfe_u32 v140, v1, 1, 2
    v_mul_u32_u24 v140, 544, v140
    v_add_u32_e64 v142, v140, v142
    v_add_u32 v74, 19392, v73
    v_add_u32 v75, 38784, v73
    v_add_u32 v76, 58176, v73
    v_add_u32 v142, 53760, v142
    v_and_b32 v140, 31, v1
    v_cmp_eq_u32 vcc, 0, v140
    v_cmp_eq_u32 s[82:83], 24, v140
    s_nop 0
    s_or_b64 vcc, vcc, s[82:83]
    v_mov_b32 v140, 155648
    v_mov_b32 v141, 157696
    v_cndmask_b32_e64 v140, v140, v141, vcc
    v_cndmask_b32 v79, v140, v142, s[78:79]
    v_bfe_u32 v201, v1, 3, 2
    v_and_b32 v202, s24, v201
    v_cmp_eq_u32 vcc, 3, v202
    v_lshrrev_b32 v202, 5, v1
    v_lshl_add_u32 v201, v201, 1, v202
    v_and_b32 v202, 7, v1
    v_lshl_add_u32 v201, v201, 3, v202
    v_lshlrev_b32 v200, 4, v201
    v_mov_b32 v201, 1073741824
    v_cndmask_b32 v200, v200, v201, vcc
    s_lshl_b32 s101, s70, 2
    s_add_u32 s101, s101, s24
    s_mul_i32 s101, s101, 40960
    s_add_u32 s101, s101, 0
    s_lshl_b32 s25, s72, 5
    s_add_u32 s25, s25, 0
    s_sub_u32 s26, s25, 4
    s_max_i32 s26, s26, 0
    s_mul_i32 s27, s71, 1280
    s_mul_i32 s99, s25, 5120
    s_mul_i32 s100, s26, 5120
    s_mul_i32 s92, s24, 4352
    s_mul_i32 s93, s24, 544
    s_add_u32 s99, s99, s27
    s_add_u32 s100, s100, s27
    s_mov_b32 s38, 0x10000
    s_mov_b32 s39, 0x1000
    s_cmp_ge_u32 s2, 160
    s_cbranch_scc1 nc_2
    s_mul_i32 s37, s24, 8704
    s_add_u32 s25, s37, 0
    s_add_u32 s37, s37, 0
    s_mov_b32 m0, s37
    v_and_b32 v199, 31, v1
    v_mul_u32_u24 v199, 272, v199
    v_lshrrev_b32 v215, 5, v1
    v_lshl_add_u32 v199, v215, 4, v199
    v_add_u32 v252, s25, v199
    s_waitcnt vmcnt(4)
    v_lshlrev_b32 v253, 16, v240
    v_mul_f32 v253, 0x3fb8aa3b, v253
    v_exp_f32 v253, v253
    s_nop 0
    v_cvt_pk_bf16_f32 v253, v253, v253
    v_lshlrev_b32 v253, 16, v253
    v_lshlrev_b32 v199, 16, v232
    v_mul_f32 v199, 0x3fb8aa3b, v199
    v_exp_f32 v199, v199
    v_lshlrev_b32 v255, 16, v233
    v_mul_f32 v255, v255, v253
    v_mul_f32 v255, 0x3e22f983, v255
    v_cvt_pk_bf16_f32 v199, v199, v199
    v_lshlrev_b32 v199, 16, v199
    v_mul_f32_e64 v254, v199, v253
    v_mul_f32 v254, 0xbfb8aa3b, v254
    v_mul_f32 v182, 0x41000000, v254
    v_mul_f32 v185, 0x41000000, v255
    v_mul_f32 v184, 0x43800000, v254
    v_mul_f32 v189, 0x43800000, v255
    v_fract_f32 v185, v185
    v_fract_f32 v188, v255
    v_fract_f32 v189, v189
    v_exp_f32 v182, v182
    v_exp_f32 v183, v254
    v_exp_f32 v184, v184
    v_cos_f32 v186, v185
    v_sin_f32 v187, v185
    v_cos_f32 v180, v188
    v_sin_f32 v181, v188
    v_cos_f32 v190, v189
    v_sin_f32 v191, v189
    v_lshlrev_b32 v192, 16, v234
    v_lshlrev_b32 v193, 16, v235
    v_add_f32 v199, v253, v253
    v_mul_f32 v192, v192, v199
    v_mul_f32 v193, v193, v199
    v_mul_f32 v186, v186, v182
    v_mul_f32 v187, v187, v182
    v_mul_f32 v180, v180, v183
    v_mul_f32 v181, v181, v183
    v_mul_f32 v190, v190, v184
    v_mul_f32_e64 v191, v191, v184
    v_mov_b32 v242, 0x3f80
    v_cvt_pk_bf16_f32 v243, v186, v187
    v_pk_mul_f32 v[194:195], v[186:187], v[186:187] op_sel:[0,0] op_sel_hi:[0,1]
    v_pk_fma_f32 v[172:173], v[186:187], v[186:187], v[194:195] op_sel:[1,1,0] op_sel_hi:[1,0,1] neg_lo:[0,1,0]
    v_cvt_pk_bf16_f32 v244, v172, v173
    v_pk_mul_f32 v[194:195], v[172:173], v[186:187] op_sel:[0,0] op_sel_hi:[0,1]
    v_pk_fma_f32 v[174:175], v[172:173], v[186:187], v[194:195] op_sel:[1,1,0] op_sel_hi:[1,0,1] neg_lo:[0,1,0]
    v_cvt_pk_bf16_f32 v245, v174, v175
    v_pk_mul_f32 v[194:195], v[174:175], v[186:187] op_sel:[0,0] op_sel_hi:[0,1]
    v_pk_fma_f32 v[172:173], v[174:175], v[186:187], v[194:195] op_sel:[1,1,0] op_sel_hi:[1,0,1] neg_lo:[0,1,0]
    v_cvt_pk_bf16_f32 v246, v172, v173
    v_pk_mul_f32 v[194:195], v[172:173], v[186:187] op_sel:[0,0] op_sel_hi:[0,1]
    v_pk_fma_f32 v[174:175], v[172:173], v[186:187], v[194:195] op_sel:[1,1,0] op_sel_hi:[1,0,1] neg_lo:[0,1,0]
    v_cvt_pk_bf16_f32 v247, v174, v175
    v_pk_mul_f32 v[194:195], v[174:175], v[186:187] op_sel:[0,0] op_sel_hi:[0,1]
    v_pk_fma_f32 v[172:173], v[174:175], v[186:187], v[194:195] op_sel:[1,1,0] op_sel_hi:[1,0,1] neg_lo:[0,1,0]
    v_cvt_pk_bf16_f32 v248, v172, v173
    v_pk_mul_f32 v[194:195], v[172:173], v[186:187] op_sel:[0,0] op_sel_hi:[0,1]
    v_pk_fma_f32 v[174:175], v[172:173], v[186:187], v[194:195] op_sel:[1,1,0] op_sel_hi:[1,0,1] neg_lo:[0,1,0]
    v_cvt_pk_bf16_f32 v249, v174, v175
    v_pk_mul_f32 v[194:195], v[174:175], v[186:187] op_sel:[0,0] op_sel_hi:[0,1]
    v_pk_fma_f32 v[172:173], v[174:175], v[186:187], v[194:195] op_sel:[1,1,0] op_sel_hi:[1,0,1] neg_lo:[0,1,0]
    v_cvt_pk_bf16_f32 v250, v172, v173
    v_pk_mul_f32 v[194:195], v[172:173], v[186:187] op_sel:[0,0] op_sel_hi:[0,1]
    v_pk_fma_f32 v[174:175], v[172:173], v[186:187], v[194:195] op_sel:[1,1,0] op_sel_hi:[1,0,1] neg_lo:[0,1,0]
    v_cvt_pk_bf16_f32 v251, v174, v175
    ds_write_addtid_b32 v242 offset:0
    ds_write_addtid_b32 v243 offset:272
    ds_write_addtid_b32 v244 offset:544
    ds_write_addtid_b32 v245 offset:816
    ds_write_addtid_b32 v246 offset:1088
    ds_write_addtid_b32 v247 offset:1360
    ds_write_addtid_b32 v248 offset:1632
    ds_write_addtid_b32 v249 offset:1904
    ds_write_addtid_b32 v250 offset:2176
    ds_write_addtid_b32 v251 offset:2448
    v_pk_mul_f32 v[194:195], v[174:175], v[186:187] op_sel:[0,0] op_sel_hi:[0,1]
    v_pk_fma_f32 v[172:173], v[174:175], v[186:187], v[194:195] op_sel:[1,1,0] op_sel_hi:[1,0,1] neg_lo:[0,1,0]
    v_cvt_pk_bf16_f32 v242, v172, v173
    v_pk_mul_f32 v[194:195], v[172:173], v[186:187] op_sel:[0,0] op_sel_hi:[0,1]
    v_pk_fma_f32 v[174:175], v[172:173], v[186:187], v[194:195] op_sel:[1,1,0] op_sel_hi:[1,0,1] neg_lo:[0,1,0]
    v_cvt_pk_bf16_f32 v243, v174, v175
    v_pk_mul_f32 v[194:195], v[174:175], v[186:187] op_sel:[0,0] op_sel_hi:[0,1]
    v_pk_fma_f32 v[172:173], v[174:175], v[186:187], v[194:195] op_sel:[1,1,0] op_sel_hi:[1,0,1] neg_lo:[0,1,0]
    v_cvt_pk_bf16_f32 v244, v172, v173
    v_pk_mul_f32 v[194:195], v[172:173], v[186:187] op_sel:[0,0] op_sel_hi:[0,1]
    v_pk_fma_f32 v[174:175], v[172:173], v[186:187], v[194:195] op_sel:[1,1,0] op_sel_hi:[1,0,1] neg_lo:[0,1,0]
    v_cvt_pk_bf16_f32 v245, v174, v175
    v_pk_mul_f32 v[194:195], v[174:175], v[186:187] op_sel:[0,0] op_sel_hi:[0,1]
    v_pk_fma_f32 v[172:173], v[174:175], v[186:187], v[194:195] op_sel:[1,1,0] op_sel_hi:[1,0,1] neg_lo:[0,1,0]
    v_cvt_pk_bf16_f32 v246, v172, v173
    v_pk_mul_f32 v[194:195], v[172:173], v[186:187] op_sel:[0,0] op_sel_hi:[0,1]
    v_pk_fma_f32 v[174:175], v[172:173], v[186:187], v[194:195] op_sel:[1,1,0] op_sel_hi:[1,0,1] neg_lo:[0,1,0]
    v_cvt_pk_bf16_f32 v247, v174, v175
    v_pk_mul_f32 v[194:195], v[174:175], v[186:187] op_sel:[0,0] op_sel_hi:[0,1]
    v_pk_fma_f32 v[172:173], v[174:175], v[186:187], v[194:195] op_sel:[1,1,0] op_sel_hi:[1,0,1] neg_lo:[0,1,0]
    v_cvt_pk_bf16_f32 v248, v172, v173
    v_pk_mul_f32 v[194:195], v[172:173], v[186:187] op_sel:[0,0] op_sel_hi:[0,1]
    v_pk_fma_f32 v[174:175], v[172:173], v[186:187], v[194:195] op_sel:[1,1,0] op_sel_hi:[1,0,1] neg_lo:[0,1,0]
    v_cvt_pk_bf16_f32 v249, v174, v175
    v_pk_mul_f32 v[194:195], v[174:175], v[186:187] op_sel:[0,0] op_sel_hi:[0,1]
    v_pk_fma_f32 v[172:173], v[174:175], v[186:187], v[194:195] op_sel:[1,1,0] op_sel_hi:[1,0,1] neg_lo:[0,1,0]
    v_cvt_pk_bf16_f32 v250, v172, v173
    v_pk_mul_f32 v[194:195], v[172:173], v[186:187] op_sel:[0,0] op_sel_hi:[0,1]
    v_pk_fma_f32 v[174:175], v[172:173], v[186:187], v[194:195] op_sel:[1,1,0] op_sel_hi:[1,0,1] neg_lo:[0,1,0]
    v_cvt_pk_bf16_f32 v251, v174, v175
    ds_write_addtid_b32 v242 offset:2720
    ds_write_addtid_b32 v243 offset:2992
    ds_write_addtid_b32 v244 offset:3264
    ds_write_addtid_b32 v245 offset:3536
    ds_write_addtid_b32 v246 offset:3808
    ds_write_addtid_b32 v247 offset:4080
    ds_write_addtid_b32 v248 offset:4352
    ds_write_addtid_b32 v249 offset:4624
    ds_write_addtid_b32 v250 offset:4896
    ds_write_addtid_b32 v251 offset:5168
    v_pk_mul_f32 v[194:195], v[174:175], v[186:187] op_sel:[0,0] op_sel_hi:[0,1]
    v_pk_fma_f32 v[172:173], v[174:175], v[186:187], v[194:195] op_sel:[1,1,0] op_sel_hi:[1,0,1] neg_lo:[0,1,0]
    v_cvt_pk_bf16_f32 v242, v172, v173
    v_pk_mul_f32 v[194:195], v[172:173], v[186:187] op_sel:[0,0] op_sel_hi:[0,1]
    v_pk_fma_f32 v[174:175], v[172:173], v[186:187], v[194:195] op_sel:[1,1,0] op_sel_hi:[1,0,1] neg_lo:[0,1,0]
    v_cvt_pk_bf16_f32 v243, v174, v175
    v_pk_mul_f32 v[194:195], v[174:175], v[186:187] op_sel:[0,0] op_sel_hi:[0,1]
    v_pk_fma_f32 v[172:173], v[174:175], v[186:187], v[194:195] op_sel:[1,1,0] op_sel_hi:[1,0,1] neg_lo:[0,1,0]
    v_cvt_pk_bf16_f32 v244, v172, v173
    v_pk_mul_f32 v[194:195], v[172:173], v[186:187] op_sel:[0,0] op_sel_hi:[0,1]
    v_pk_fma_f32 v[174:175], v[172:173], v[186:187], v[194:195] op_sel:[1,1,0] op_sel_hi:[1,0,1] neg_lo:[0,1,0]
    v_cvt_pk_bf16_f32 v245, v174, v175
    v_pk_mul_f32 v[194:195], v[174:175], v[186:187] op_sel:[0,0] op_sel_hi:[0,1]
    v_pk_fma_f32 v[172:173], v[174:175], v[186:187], v[194:195] op_sel:[1,1,0] op_sel_hi:[1,0,1] neg_lo:[0,1,0]
    v_cvt_pk_bf16_f32 v246, v172, v173
    v_pk_mul_f32 v[194:195], v[172:173], v[186:187] op_sel:[0,0] op_sel_hi:[0,1]
    v_pk_fma_f32 v[174:175], v[172:173], v[186:187], v[194:195] op_sel:[1,1,0] op_sel_hi:[1,0,1] neg_lo:[0,1,0]
    v_cvt_pk_bf16_f32 v247, v174, v175
    v_pk_mul_f32 v[194:195], v[174:175], v[186:187] op_sel:[0,0] op_sel_hi:[0,1]
    v_pk_fma_f32 v[172:173], v[174:175], v[186:187], v[194:195] op_sel:[1,1,0] op_sel_hi:[1,0,1] neg_lo:[0,1,0]
    v_cvt_pk_bf16_f32 v248, v172, v173
    v_pk_mul_f32 v[194:195], v[172:173], v[186:187] op_sel:[0,0] op_sel_hi:[0,1]
    v_pk_fma_f32 v[174:175], v[172:173], v[186:187], v[194:195] op_sel:[1,1,0] op_sel_hi:[1,0,1] neg_lo:[0,1,0]
    v_cvt_pk_bf16_f32 v249, v174, v175
    v_pk_mul_f32 v[194:195], v[174:175], v[186:187] op_sel:[0,0] op_sel_hi:[0,1]
    v_pk_fma_f32 v[172:173], v[174:175], v[186:187], v[194:195] op_sel:[1,1,0] op_sel_hi:[1,0,1] neg_lo:[0,1,0]
    v_cvt_pk_bf16_f32 v250, v172, v173
    v_pk_mul_f32 v[194:195], v[172:173], v[186:187] op_sel:[0,0] op_sel_hi:[0,1]
    v_pk_fma_f32 v[174:175], v[172:173], v[186:187], v[194:195] op_sel:[1,1,0] op_sel_hi:[1,0,1] neg_lo:[0,1,0]
    v_cvt_pk_bf16_f32 v251, v174, v175
    ds_write_addtid_b32 v242 offset:5440
    ds_write_addtid_b32 v243 offset:5712
    ds_write_addtid_b32 v244 offset:5984
    ds_write_addtid_b32 v245 offset:6256
    ds_write_addtid_b32 v246 offset:6528
    ds_write_addtid_b32 v247 offset:6800
    ds_write_addtid_b32 v248 offset:7072
    ds_write_addtid_b32 v249 offset:7344
    ds_write_addtid_b32 v250 offset:7616
    ds_write_addtid_b32 v251 offset:7888
    v_pk_mul_f32 v[194:195], v[174:175], v[186:187] op_sel:[0,0] op_sel_hi:[0,1]
    v_pk_fma_f32 v[172:173], v[174:175], v[186:187], v[194:195] op_sel:[1,1,0] op_sel_hi:[1,0,1] neg_lo:[0,1,0]
    v_cvt_pk_bf16_f32 v242, v172, v173
    v_pk_mul_f32 v[194:195], v[172:173], v[186:187] op_sel:[0,0] op_sel_hi:[0,1]
    v_pk_fma_f32 v[174:175], v[172:173], v[186:187], v[194:195] op_sel:[1,1,0] op_sel_hi:[1,0,1] neg_lo:[0,1,0]
    v_cvt_pk_bf16_f32 v243, v174, v175
    ds_write_addtid_b32 v242 offset:8160
    ds_write_addtid_b32 v243 offset:8432
    ds_read_b128 a[160:163], v252 offset:0
    ds_read_b128 a[164:167], v252 offset:32
    ds_read_b128 a[168:171], v252 offset:64
    ds_read_b128 a[172:175], v252 offset:96
    ds_read_b128 a[176:179], v252 offset:128
    s_waitcnt vmcnt(1)
    s_barrier
    ds_read_b64_tr_b16 v[96:97], v111
    ds_read_b64_tr_b16 v[98:99], v111 offset:2560
    ds_read_b64_tr_b16 v[100:101], v112
    ds_read_b64_tr_b16 v[102:103], v112 offset:2560
    ds_read_b64_tr_b16 v[104:105], v113
    ds_read_b64_tr_b16 v[106:107], v113 offset:2560
    s_waitcnt lgkmcnt(4)
    buffer_store_dwordx4 v[96:99], v108, s[16:19], 0 offen sc1
    s_waitcnt lgkmcnt(2)
    buffer_store_dwordx4 v[100:103], v109, s[16:19], 0 offen sc1
    s_waitcnt lgkmcnt(0)
    s_nop 0
    buffer_store_dwordx4 v[104:107], v110, s[16:19], 0 offen sc1
    global_load_dword v7, v5, s[66:67] sc1
    ds_read_b128 a[180:183], v252 offset:160
    ds_read_b128 a[184:187], v252 offset:192
    ds_read_b128 a[188:191], v252 offset:224
    v_pk_mul_f32 v[194:195], v[180:181], v[180:181] op_sel:[0,0] op_sel_hi:[0,1]
    v_pk_fma_f32 v[182:183], v[180:181], v[180:181], v[194:195] op_sel:[1,1,0] op_sel_hi:[1,0,1] neg_lo:[0,1,0]
    v_pk_mul_f32 v[194:195], v[182:183], v[182:183] op_sel:[0,0] op_sel_hi:[0,1]
    v_pk_fma_f32 v[184:185], v[182:183], v[182:183], v[194:195] op_sel:[1,1,0] op_sel_hi:[1,0,1] neg_lo:[0,1,0]
    v_cvt_pk_bf16_f32 v242, v192, -v193
    v_pk_mul_f32 v[194:195], v[192:193], v[180:181] op_sel:[0,0] op_sel_hi:[0,1]
    v_pk_fma_f32 v[174:175], v[192:193], v[180:181], v[194:195] op_sel:[1,1,0] op_sel_hi:[1,0,1] neg_lo:[0,1,0]
    v_cvt_pk_bf16_f32 v243, v174, -v175
    v_pk_mul_f32 v[194:195], v[174:175], v[180:181] op_sel:[0,0] op_sel_hi:[0,1]
    v_pk_fma_f32 v[172:173], v[174:175], v[180:181], v[194:195] op_sel:[1,1,0] op_sel_hi:[1,0,1] neg_lo:[0,1,0]
    v_cvt_pk_bf16_f32 v244, v172, -v173
    v_pk_mul_f32 v[194:195], v[172:173], v[180:181] op_sel:[0,0] op_sel_hi:[0,1]
    v_pk_fma_f32 v[174:175], v[172:173], v[180:181], v[194:195] op_sel:[1,1,0] op_sel_hi:[1,0,1] neg_lo:[0,1,0]
    v_cvt_pk_bf16_f32 v245, v174, -v175
    v_pk_mul_f32 v[194:195], v[174:175], v[180:181] op_sel:[0,0] op_sel_hi:[0,1]
    v_pk_fma_f32 v[172:173], v[174:175], v[180:181], v[194:195] op_sel:[1,1,0] op_sel_hi:[1,0,1] neg_lo:[0,1,0]
    v_cvt_pk_bf16_f32 v246, v172, -v173
    v_pk_mul_f32 v[194:195], v[172:173], v[180:181] op_sel:[0,0] op_sel_hi:[0,1]
    v_pk_fma_f32 v[174:175], v[172:173], v[180:181], v[194:195] op_sel:[1,1,0] op_sel_hi:[1,0,1] neg_lo:[0,1,0]
    v_cvt_pk_bf16_f32 v247, v174, -v175
    v_pk_mul_f32 v[194:195], v[174:175], v[180:181] op_sel:[0,0] op_sel_hi:[0,1]
    v_pk_fma_f32 v[172:173], v[174:175], v[180:181], v[194:195] op_sel:[1,1,0] op_sel_hi:[1,0,1] neg_lo:[0,1,0]
    v_cvt_pk_bf16_f32 v248, v172, -v173
    v_pk_mul_f32 v[194:195], v[172:173], v[180:181] op_sel:[0,0] op_sel_hi:[0,1]
    v_pk_fma_f32 v[174:175], v[172:173], v[180:181], v[194:195] op_sel:[1,1,0] op_sel_hi:[1,0,1] neg_lo:[0,1,0]
    v_cvt_pk_bf16_f32 v249, v174, -v175
    v_pk_mul_f32 v[194:195], v[192:193], v[190:191] op_sel:[0,0] op_sel_hi:[0,1]
    v_pk_fma_f32 v[176:177], v[192:193], v[190:191], v[194:195] op_sel:[1,1,0] op_sel_hi:[1,0,1] neg_lo:[0,1,0]
    v_cvt_pk_bf16_f32 v250, v176, -v177
    v_pk_mul_f32 v[194:195], v[176:177], v[182:183] op_sel:[0,0] op_sel_hi:[0,1]
    v_pk_fma_f32 v[174:175], v[176:177], v[182:183], v[194:195] op_sel:[1,1,0] op_sel_hi:[1,0,1] neg_lo:[0,1,0]
    v_cvt_pk_bf16_f32 v251, v174, -v175
    ds_write_addtid_b32 v242 offset:0
    ds_write_addtid_b32 v243 offset:272
    ds_write_addtid_b32 v244 offset:544
    ds_write_addtid_b32 v245 offset:816
    ds_write_addtid_b32 v246 offset:1088
    ds_write_addtid_b32 v247 offset:1360
    ds_write_addtid_b32 v248 offset:1632
    ds_write_addtid_b32 v249 offset:1904
    ds_write_addtid_b32 v250 offset:2176
    ds_write_addtid_b32 v251 offset:2448
    v_pk_mul_f32 v[194:195], v[174:175], v[182:183] op_sel:[0,0] op_sel_hi:[0,1]
    v_pk_fma_f32 v[172:173], v[174:175], v[182:183], v[194:195] op_sel:[1,1,0] op_sel_hi:[1,0,1] neg_lo:[0,1,0]
    v_cvt_pk_bf16_f32 v242, v172, -v173
    s_min_u32 s96, s75, 159
    s_lshl_b32 s96, s96, 2
    s_add_u32 s96, s96, s24
    s_mul_i32 s97, s96, 384
    s_lshl_b32 s96, s96, 1
    v_lshl_add_u32 v2, v1, 1, s97
    v_mov_b32 v241, s96
    global_load_ushort v236, v2, s[52:53] offset:256
    global_load_ushort v237, v2, s[54:55] offset:256
    global_load_ushort v238, v2, s[56:57] offset:256
    global_load_ushort v239, v2, s[58:59] offset:256
    global_load_ushort v241, v241, s[62:63]
    v_pk_mul_f32 v[194:195], v[172:173], v[182:183] op_sel:[0,0] op_sel_hi:[0,1]
    v_pk_fma_f32 v[174:175], v[172:173], v[182:183], v[194:195] op_sel:[1,1,0] op_sel_hi:[1,0,1] neg_lo:[0,1,0]
    v_cvt_pk_bf16_f32 v243, v174, -v175
    v_pk_mul_f32 v[194:195], v[174:175], v[182:183] op_sel:[0,0] op_sel_hi:[0,1]
    v_pk_fma_f32 v[172:173], v[174:175], v[182:183], v[194:195] op_sel:[1,1,0] op_sel_hi:[1,0,1] neg_lo:[0,1,0]
    v_cvt_pk_bf16_f32 v244, v172, -v173
    v_pk_mul_f32 v[194:195], v[176:177], v[190:191] op_sel:[0,0] op_sel_hi:[0,1]
    v_pk_fma_f32 v[178:179], v[176:177], v[190:191], v[194:195] op_sel:[1,1,0] op_sel_hi:[1,0,1] neg_lo:[0,1,0]
    v_cvt_pk_bf16_f32 v245, v178, -v179
    v_pk_mul_f32 v[194:195], v[178:179], v[184:185] op_sel:[0,0] op_sel_hi:[0,1]
    v_pk_fma_f32 v[174:175], v[178:179], v[184:185], v[194:195] op_sel:[1,1,0] op_sel_hi:[1,0,1] neg_lo:[0,1,0]
    v_cvt_pk_bf16_f32 v246, v174, -v175
    v_pk_mul_f32 v[194:195], v[174:175], v[184:185] op_sel:[0,0] op_sel_hi:[0,1]
    v_pk_fma_f32 v[172:173], v[174:175], v[184:185], v[194:195] op_sel:[1,1,0] op_sel_hi:[1,0,1] neg_lo:[0,1,0]
    v_cvt_pk_bf16_f32 v247, v172, -v173
    v_pk_mul_f32 v[194:195], v[178:179], v[190:191] op_sel:[0,0] op_sel_hi:[0,1]
    v_pk_fma_f32 v[176:177], v[178:179], v[190:191], v[194:195] op_sel:[1,1,0] op_sel_hi:[1,0,1] neg_lo:[0,1,0]
    v_cvt_pk_bf16_f32 v248, v176, -v177
    v_pk_mul_f32 v[194:195], v[176:177], v[184:185] op_sel:[0,0] op_sel_hi:[0,1]
    v_pk_fma_f32 v[174:175], v[176:177], v[184:185], v[194:195] op_sel:[1,1,0] op_sel_hi:[1,0,1] neg_lo:[0,1,0]
    v_cvt_pk_bf16_f32 v249, v174, -v175
    v_pk_mul_f32 v[194:195], v[174:175], v[184:185] op_sel:[0,0] op_sel_hi:[0,1]
    v_pk_fma_f32 v[172:173], v[174:175], v[184:185], v[194:195] op_sel:[1,1,0] op_sel_hi:[1,0,1] neg_lo:[0,1,0]
    v_cvt_pk_bf16_f32 v250, v172, -v173
    v_pk_mul_f32 v[194:195], v[176:177], v[190:191] op_sel:[0,0] op_sel_hi:[0,1]
    v_pk_fma_f32 v[178:179], v[176:177], v[190:191], v[194:195] op_sel:[1,1,0] op_sel_hi:[1,0,1] neg_lo:[0,1,0]
    v_cvt_pk_bf16_f32 v251, v178, -v179
    ds_write_addtid_b32 v242 offset:2720
    ds_write_addtid_b32 v242 offset:3264
    ds_write_addtid_b32 v243 offset:3536
    ds_write_addtid_b32 v244 offset:3808
    ds_write_addtid_b32 v245 offset:4352
    ds_write_addtid_b32 v246 offset:4624
    ds_write_addtid_b32 v247 offset:4896
    ds_write_addtid_b32 v248 offset:5440
    ds_write_addtid_b32 v249 offset:5712
    ds_write_addtid_b32 v250 offset:5984
    ds_write_addtid_b32 v251 offset:6528
    v_pk_mul_f32 v[194:195], v[178:179], v[186:187] op_sel:[0,0] op_sel_hi:[0,1]
    v_pk_fma_f32 v[174:175], v[178:179], v[186:187], v[194:195] op_sel:[1,1,0] op_sel_hi:[1,0,1] neg_lo:[0,1,0]
    v_cvt_pk_bf16_f32 v242, v174, -v175
    v_pk_mul_f32 v[194:195], v[178:179], v[190:191] op_sel:[0,0] op_sel_hi:[0,1]
    v_pk_fma_f32 v[176:177], v[178:179], v[190:191], v[194:195] op_sel:[1,1,0] op_sel_hi:[1,0,1] neg_lo:[0,1,0]
    v_cvt_pk_bf16_f32 v243, v176, -v177
    v_pk_mul_f32 v[194:195], v[176:177], v[186:187] op_sel:[0,0] op_sel_hi:[0,1]
    v_pk_fma_f32 v[174:175], v[176:177], v[186:187], v[194:195] op_sel:[1,1,0] op_sel_hi:[1,0,1] neg_lo:[0,1,0]
    v_cvt_pk_bf16_f32 v244, v174, -v175
    v_pk_mul_f32 v[194:195], v[176:177], v[190:191] op_sel:[0,0] op_sel_hi:[0,1]
    v_lshrrev_b32 v132, 5, v0
    v_and_b32 v133, 31, v0
    v_mul_u32_u24 v132, 1280, v132
    v_lshl_add_u32 v134, v133, 4, v132
    v_mov_b32 v135, 1073741824
    v_cmp_gt_u32 vcc, 16, v133
    s_mul_i32 s96, s2, 10240
    buffer_load_dwordx4 v[120:123], v134, s[4:7], s96 offen
    v_cndmask_b32_e64 v135, v135, v134, vcc
    buffer_load_dwordx4 v[124:127], v134, s[4:7], s96 offen offset:512
    buffer_load_dwordx4 v[128:131], v135, s[4:7], s96 offen offset:1024
    v_pk_fma_f32 v[178:179], v[176:177], v[190:191], v[194:195] op_sel:[1,1,0] op_sel_hi:[1,0,1] neg_lo:[0,1,0]
    v_cvt_pk_bf16_f32 v245, v178, -v179
    v_pk_mul_f32 v[194:195], v[178:179], v[186:187] op_sel:[0,0] op_sel_hi:[0,1]
    v_pk_fma_f32 v[174:175], v[178:179], v[186:187], v[194:195] op_sel:[1,1,0] op_sel_hi:[1,0,1] neg_lo:[0,1,0]
    v_cvt_pk_bf16_f32 v246, v174, -v175
    v_pk_mul_f32 v[194:195], v[178:179], v[190:191] op_sel:[0,0] op_sel_hi:[0,1]
    v_pk_fma_f32 v[176:177], v[178:179], v[190:191], v[194:195] op_sel:[1,1,0] op_sel_hi:[1,0,1] neg_lo:[0,1,0]
    v_cvt_pk_bf16_f32 v247, v176, -v177
    v_pk_mul_f32 v[194:195], v[176:177], v[186:187] op_sel:[0,0] op_sel_hi:[0,1]
    v_pk_fma_f32 v[174:175], v[176:177], v[186:187], v[194:195] op_sel:[1,1,0] op_sel_hi:[1,0,1] neg_lo:[0,1,0]
    v_cvt_pk_bf16_f32 v248, v174, -v175
    ds_write_addtid_b32 v242 offset:6800
    ds_write_addtid_b32 v243 offset:7072
    ds_write_addtid_b32 v244 offset:7344
    ds_write_addtid_b32 v245 offset:7616
    ds_write_addtid_b32 v246 offset:7888
    ds_write_addtid_b32 v247 offset:8160
    ds_write_addtid_b32 v248 offset:8432
    ds_read_b128 a[192:195], v252 offset:0
    ds_read_b128 a[196:199], v252 offset:32
    ds_read_b128 a[200:203], v252 offset:64
    ds_read_b128 a[204:207], v252 offset:96
    ds_read_b128 a[208:211], v252 offset:128
    ds_read_b128 a[212:215], v252 offset:160
    ds_read_b128 a[216:219], v252 offset:192
    ds_read_b128 a[220:223], v252 offset:224
    s_add_u32 m0, s92, 36352
    s_nop 0
    buffer_load_dwordx4 v73, s[4:7], s99 offen offset:0  lds
    v_and_b32 v199, 0xffff0000, v232
    v_mul_f32 v199, 0x3fb8aa3b, v199
    v_exp_f32 v199, v199
    v_and_b32 v255, 0xffff0000, v233
    v_mul_f32 v255, v255, v253
    v_mul_f32 v255, 0x3e22f983, v255
    v_cvt_pk_bf16_f32 v199, v199, v199
    v_lshlrev_b32 v199, 16, v199
    v_mul_f32 v254, v199, v253
    v_mul_f32 v254, 0xbfb8aa3b, v254
    s_waitcnt lgkmcnt(7)
    v_mfma_f32_32x32x16_bf16 v[216:231], a[192:195], a[160:163], 0
    s_add_u32 m0, s92, 36352
    s_nop 0
    buffer_load_dwordx4 v74, s[4:7], s99 offen offset:1088  lds
    v_mul_f32 v182, 0x41000000, v254
    v_mul_f32 v185, 0x41000000, v255
    v_mul_f32 v184, 0x43800000, v254
    v_mul_f32 v189, 0x43800000, v255
    s_waitcnt lgkmcnt(6)
    v_mfma_f32_32x32x16_bf16 v[216:231], a[196:199], a[164:167], v[216:231]
    s_add_u32 m0, s92, 36352
    s_nop 0
    buffer_load_dwordx4 v75, s[4:7], s99 offen offset:2176  lds
    v_mov_b32 v140, 1073741824
    v_lshlrev_b32 v141, 2, v0
    v_cmp_gt_u32 vcc, 64, v0
    s_nop 1
    v_cndmask_b32 v141, v140, v141, vcc
    v_mov_b32_e64 v140, 0
    s_lshl_b32 s97, s2, 8
    s_add_u32 s97, s97, 3473408
    buffer_store_dword v140, v141, s[16:19], s97 offen sc1
    v_fract_f32 v185, v185
    v_fract_f32 v188, v255
    v_fract_f32 v189, v189
    v_exp_f32_e64 v182, v182
    s_waitcnt lgkmcnt(5)
    v_mfma_f32_32x32x16_bf16 v[216:231], a[200:203], a[168:171], v[216:231]
    s_add_u32 m0, s92, 36352
    s_nop 0
    buffer_load_dwordx4 v76, s[4:7], s99 offen offset:3264  lds
    v_exp_f32 v183, v254
    v_exp_f32 v184, v184
    v_cos_f32 v186, v185
    v_sin_f32 v187, v185
    s_waitcnt lgkmcnt(4)
    v_mfma_f32_32x32x16_bf16 v[216:231], a[204:207], a[172:175], v[216:231]
    s_add_u32 m0, s93, 53760
    s_add_u32 s99, s99, 256
    s_mov_b64 exec, s[80:81]
    buffer_load_dwordx4 v77, s[4:7], s100 offen  lds
    s_mov_b64 exec, -1
    s_add_u32 s100, s100, 256
    v_cos_f32 v180, v188
    v_sin_f32 v181, v188
    v_cos_f32 v190, v189
    v_sin_f32_e64 v191, v189
    s_waitcnt lgkmcnt(3)
    v_mfma_f32_32x32x16_bf16 v[216:231], a[208:211], a[176:179], v[216:231]
    s_add_u32 m0, s92, 55936
    s_nop 0
    buffer_load_dwordx4 v73, s[4:7], s99 offen offset:0  lds
    v_and_b32 v192, 0xffff0000, v234
    v_and_b32 v193, 0xffff0000, v235
    v_add_f32 v199, v253, v253
    v_mul_f32 v192, v192, v199
    s_waitcnt lgkmcnt(2)
    v_mfma_f32_32x32x16_bf16 v[216:231], a[212:215], a[180:183], v[216:231]
    s_add_u32 m0, s92, 55936
    s_nop 0
    buffer_load_dwordx4 v74, s[4:7], s99 offen offset:1088  lds
    v_mul_f32 v193, v193, v199
    v_mul_f32 v186, v186, v182
    v_mul_f32 v187, v187, v182
    v_mul_f32 v180, v180, v183
    s_waitcnt lgkmcnt(1)
    v_mfma_f32_32x32x16_bf16 v[216:231], a[216:219], a[184:187], v[216:231]
    s_add_u32 m0, s92, 55936
    s_nop 0
    buffer_load_dwordx4 v75, s[4:7], s99 offen offset:2176  lds
    v_mul_f32 v181, v181, v183
    v_mul_f32 v190, v190, v184
    v_mul_f32_e64 v191, v191, v184
    s_waitcnt lgkmcnt(0)
    v_mfma_f32_32x32x16_bf16 v[216:231], a[220:223], a[188:191], v[216:231]
    s_add_u32 m0, s92, 55936
    s_nop 0
    buffer_load_dwordx4 v76, s[4:7], s99 offen offset:3264  lds
    s_mov_b32 m0, s37
    v_mov_b32 v242, 0x3f80
    v_cvt_pk_bf16_f32 v243, v186, v187
    v_mov_b32 v142, 1073741824
    v_lshlrev_b32 v143, 2, v0
    v_cmp_gt_u32 vcc, 16, v0
    s_nop 1
    v_cndmask_b32 v143, v142, v143, vcc
    v_mov_b32_e64 v142, -1
    s_lshl_b32 s97, s2, 6
    s_add_u32 s97, s97, 3457024
    buffer_store_dword v142, v143, s[16:19], s97 offen sc1
    v_pk_mul_f32 v[194:195], v[186:187], v[186:187] op_sel:[0,0] op_sel_hi:[0,1]
    v_pk_fma_f32 v[172:173], v[186:187], v[186:187], v[194:195] op_sel:[1,1,0] op_sel_hi:[1,0,1] neg_lo:[0,1,0]
    v_cvt_pk_bf16_f32 v244, v172, v173
    v_pk_mul_f32 v[194:195], v[172:173], v[186:187] op_sel:[0,0] op_sel_hi:[0,1]
    v_pk_fma_f32 v[174:175], v[172:173], v[186:187], v[194:195] op_sel:[1,1,0] op_sel_hi:[1,0,1] neg_lo:[0,1,0]
    v_cvt_pk_bf16_f32 v245, v174, v175
    v_pk_mul_f32 v[194:195], v[174:175], v[186:187] op_sel:[0,0] op_sel_hi:[0,1]
    v_pk_fma_f32 v[172:173], v[174:175], v[186:187], v[194:195] op_sel:[1,1,0] op_sel_hi:[1,0,1] neg_lo:[0,1,0]
    v_cvt_pk_bf16_f32 v246, v172, v173
    v_pk_mul_f32 v[194:195], v[172:173], v[186:187] op_sel:[0,0] op_sel_hi:[0,1]
    v_pk_fma_f32 v[174:175], v[172:173], v[186:187], v[194:195] op_sel:[1,1,0] op_sel_hi:[1,0,1] neg_lo:[0,1,0]
    v_cvt_pk_bf16_f32 v247, v174, v175
    v_pk_mul_f32 v[194:195], v[174:175], v[186:187] op_sel:[0,0] op_sel_hi:[0,1]
    v_pk_fma_f32 v[172:173], v[174:175], v[186:187], v[194:195] op_sel:[1,1,0] op_sel_hi:[1,0,1] neg_lo:[0,1,0]
    v_cvt_pk_bf16_f32 v248, v172, v173
    v_pk_mul_f32 v[194:195], v[172:173], v[186:187] op_sel:[0,0] op_sel_hi:[0,1]
    v_pk_fma_f32 v[174:175], v[172:173], v[186:187], v[194:195] op_sel:[1,1,0] op_sel_hi:[1,0,1] neg_lo:[0,1,0]
    v_cvt_pk_bf16_f32 v249, v174, v175
    v_pk_mul_f32 v[194:195], v[174:175], v[186:187] op_sel:[0,0] op_sel_hi:[0,1]
    v_pk_fma_f32 v[172:173], v[174:175], v[186:187], v[194:195] op_sel:[1,1,0] op_sel_hi:[1,0,1] neg_lo:[0,1,0]
    v_cvt_pk_bf16_f32 v250, v172, v173
    v_pk_mul_f32 v[194:195], v[172:173], v[186:187] op_sel:[0,0] op_sel_hi:[0,1]
    v_pk_fma_f32 v[174:175], v[172:173], v[186:187], v[194:195] op_sel:[1,1,0] op_sel_hi:[1,0,1] neg_lo:[0,1,0]
    v_cvt_pk_bf16_f32 v251, v174, v175
    ds_write_addtid_b32 v242 offset:0
    ds_write_addtid_b32 v243 offset:272
    ds_write_addtid_b32 v244 offset:544
    ds_write_addtid_b32 v245 offset:816
    ds_write_addtid_b32 v246 offset:1088
    ds_write_addtid_b32 v247 offset:1360
    ds_write_addtid_b32 v248 offset:1632
    ds_write_addtid_b32 v249 offset:1904
    ds_write_addtid_b32 v250 offset:2176
    ds_write_addtid_b32 v251 offset:2448
    v_pk_mul_f32 v[194:195], v[174:175], v[186:187] op_sel:[0,0] op_sel_hi:[0,1]
    v_pk_fma_f32 v[172:173], v[174:175], v[186:187], v[194:195] op_sel:[1,1,0] op_sel_hi:[1,0,1] neg_lo:[0,1,0]
    v_cvt_pk_bf16_f32 v242, v172, v173
    v_pk_mul_f32 v[194:195], v[172:173], v[186:187] op_sel:[0,0] op_sel_hi:[0,1]
    v_pk_fma_f32 v[174:175], v[172:173], v[186:187], v[194:195] op_sel:[1,1,0] op_sel_hi:[1,0,1] neg_lo:[0,1,0]
    v_cvt_pk_bf16_f32 v243, v174, v175
    v_pk_mul_f32 v[194:195], v[174:175], v[186:187] op_sel:[0,0] op_sel_hi:[0,1]
    v_pk_fma_f32 v[172:173], v[174:175], v[186:187], v[194:195] op_sel:[1,1,0] op_sel_hi:[1,0,1] neg_lo:[0,1,0]
    v_cvt_pk_bf16_f32 v244, v172, v173
    v_pk_mul_f32 v[194:195], v[172:173], v[186:187] op_sel:[0,0] op_sel_hi:[0,1]
    v_pk_fma_f32 v[174:175], v[172:173], v[186:187], v[194:195] op_sel:[1,1,0] op_sel_hi:[1,0,1] neg_lo:[0,1,0]
    v_cvt_pk_bf16_f32 v245, v174, v175
    v_pk_mul_f32 v[194:195], v[174:175], v[186:187] op_sel:[0,0] op_sel_hi:[0,1]
    v_pk_fma_f32 v[172:173], v[174:175], v[186:187], v[194:195] op_sel:[1,1,0] op_sel_hi:[1,0,1] neg_lo:[0,1,0]
    s_waitcnt vmcnt(20)
    s_waitcnt vmcnt(19)
    v_cmp_gt_u32 vcc, 1, v7
    s_nop 0
    s_and_b64 vcc, vcc, s[50:51]
    s_and_b64 vcc, vcc, 1
    s_cbranch_scc1 ps_4
pc_6:
    s_barrier
    v_lshlrev_b32 v2, 3, v4
    v_mov_b32 v5, 1
    v_cndmask_b32 v2, v4, v2, s[50:51]
    buffer_atomic_add v5, v2, s[16:19], s86 offen offset:0 sc1
    v_cvt_pk_bf16_f32 v246, v172, v173
    v_pk_mul_f32 v[194:195], v[172:173], v[186:187] op_sel:[0,0] op_sel_hi:[0,1]
    v_pk_fma_f32 v[174:175], v[172:173], v[186:187], v[194:195] op_sel:[1,1,0] op_sel_hi:[1,0,1] neg_lo:[0,1,0]
    v_cvt_pk_bf16_f32 v247, v174, v175
    v_pk_mul_f32 v[194:195], v[174:175], v[186:187] op_sel:[0,0] op_sel_hi:[0,1]
    v_pk_fma_f32 v[172:173], v[174:175], v[186:187], v[194:195] op_sel:[1,1,0] op_sel_hi:[1,0,1] neg_lo:[0,1,0]
    v_cvt_pk_bf16_f32 v248, v172, v173
    v_pk_mul_f32 v[194:195], v[172:173], v[186:187] op_sel:[0,0] op_sel_hi:[0,1]
    v_pk_fma_f32 v[174:175], v[172:173], v[186:187], v[194:195] op_sel:[1,1,0] op_sel_hi:[1,0,1] neg_lo:[0,1,0]
    v_cvt_pk_bf16_f32 v249, v174, v175
    v_pk_mul_f32 v[194:195], v[174:175], v[186:187] op_sel:[0,0] op_sel_hi:[0,1]
    v_pk_fma_f32 v[172:173], v[174:175], v[186:187], v[194:195] op_sel:[1,1,0] op_sel_hi:[1,0,1] neg_lo:[0,1,0]
    v_cvt_pk_bf16_f32 v250, v172, v173
    v_pk_mul_f32 v[194:195], v[172:173], v[186:187] op_sel:[0,0] op_sel_hi:[0,1]
    v_pk_fma_f32 v[174:175], v[172:173], v[186:187], v[194:195] op_sel:[1,1,0] op_sel_hi:[1,0,1] neg_lo:[0,1,0]
    v_cvt_pk_bf16_f32 v251, v174, v175
    ds_write_addtid_b32 v242 offset:2720
    ds_write_addtid_b32 v243 offset:2992
    ds_write_addtid_b32 v244 offset:3264
    ds_write_addtid_b32 v245 offset:3536
    ds_write_addtid_b32 v246 offset:3808
    ds_write_addtid_b32 v247 offset:4080
    ds_write_addtid_b32 v248 offset:4352
    ds_write_addtid_b32 v249 offset:4624
    ds_write_addtid_b32 v250 offset:4896
    ds_write_addtid_b32 v251 offset:5168
    v_pk_mul_f32 v[194:195], v[174:175], v[186:187] op_sel:[0,0] op_sel_hi:[0,1]
    v_pk_fma_f32 v[172:173], v[174:175], v[186:187], v[194:195] op_sel:[1,1,0] op_sel_hi:[1,0,1] neg_lo:[0,1,0]
    v_cvt_pk_bf16_f32 v242, v172, v173
    v_pk_mul_f32 v[194:195], v[172:173], v[186:187] op_sel:[0,0] op_sel_hi:[0,1]
    v_mov_b32 v144, -1
    v_mov_b32 v145, -1
    v_mov_b32 v146, -1
    v_mov_b32 v147, -1
    v_lshlrev_b32 v148, 4, v0
    s_sub_u32 s88, s2, 0
    s_mul_i32 s88, s88, 20480
    s_min_u32 s88, s88, 5222400
    s_add_u32 s88, s88, 4194304
    buffer_store_dwordx4 v[144:147], v148, s[16:19], s88 offen sc1
    v_pk_fma_f32 v[174:175], v[172:173], v[186:187], v[194:195] op_sel:[1,1,0] op_sel_hi:[1,0,1] neg_lo:[0,1,0]
    v_cvt_pk_bf16_f32 v243, v174, v175
    v_pk_mul_f32 v[194:195], v[174:175], v[186:187] op_sel:[0,0] op_sel_hi:[0,1]
    v_pk_fma_f32 v[172:173], v[174:175], v[186:187], v[194:195] op_sel:[1,1,0] op_sel_hi:[1,0,1] neg_lo:[0,1,0]
    v_cvt_pk_bf16_f32 v244, v172, v173
    v_pk_mul_f32 v[194:195], v[172:173], v[186:187] op_sel:[0,0] op_sel_hi:[0,1]
    v_pk_fma_f32 v[174:175], v[172:173], v[186:187], v[194:195] op_sel:[1,1,0] op_sel_hi:[1,0,1] neg_lo:[0,1,0]
    v_cvt_pk_bf16_f32 v245, v174, v175
    v_pk_mul_f32 v[194:195], v[174:175], v[186:187] op_sel:[0,0] op_sel_hi:[0,1]
    v_pk_fma_f32 v[172:173], v[174:175], v[186:187], v[194:195] op_sel:[1,1,0] op_sel_hi:[1,0,1] neg_lo:[0,1,0]
    v_cvt_pk_bf16_f32 v246, v172, v173
    v_pk_mul_f32 v[194:195], v[172:173], v[186:187] op_sel:[0,0] op_sel_hi:[0,1]
    v_pk_fma_f32 v[174:175], v[172:173], v[186:187], v[194:195] op_sel:[1,1,0] op_sel_hi:[1,0,1] neg_lo:[0,1,0]
    v_cvt_pk_bf16_f32 v247, v174, v175
    v_pk_mul_f32 v[194:195], v[174:175], v[186:187] op_sel:[0,0] op_sel_hi:[0,1]
    v_pk_fma_f32 v[172:173], v[174:175], v[186:187], v[194:195] op_sel:[1,1,0] op_sel_hi:[1,0,1] neg_lo:[0,1,0]
    v_cvt_pk_bf16_f32 v248, v172, v173
    v_pk_mul_f32 v[194:195], v[172:173], v[186:187] op_sel:[0,0] op_sel_hi:[0,1]
    v_pk_fma_f32 v[174:175], v[172:173], v[186:187], v[194:195] op_sel:[1,1,0] op_sel_hi:[1,0,1] neg_lo:[0,1,0]
    v_cvt_pk_bf16_f32 v249, v174, v175
    v_pk_mul_f32 v[194:195], v[174:175], v[186:187] op_sel:[0,0] op_sel_hi:[0,1]
    v_pk_fma_f32 v[172:173], v[174:175], v[186:187], v[194:195] op_sel:[1,1,0] op_sel_hi:[1,0,1] neg_lo:[0,1,0]
    v_cvt_pk_bf16_f32 v250, v172, v173
    v_pk_mul_f32 v[194:195], v[172:173], v[186:187] op_sel:[0,0] op_sel_hi:[0,1]
    v_pk_fma_f32 v[174:175], v[172:173], v[186:187], v[194:195] op_sel:[1,1,0] op_sel_hi:[1,0,1] neg_lo:[0,1,0]
    v_cvt_pk_bf16_f32 v251, v174, v175
    ds_write_addtid_b32 v242 offset:5440
    ds_write_addtid_b32 v243 offset:5712
    ds_write_addtid_b32 v244 offset:5984
    ds_write_addtid_b32 v245 offset:6256
    s_add_u32 s88, s88, 4096
    buffer_store_dwordx4 v[144:147], v148, s[16:19], s88 offen sc1
    ds_write_addtid_b32 v246 offset:6528
    ds_write_addtid_b32 v247 offset:6800
    ds_write_addtid_b32 v248 offset:7072
    ds_write_addtid_b32 v249 offset:7344
    ds_write_addtid_b32 v250 offset:7616
    ds_write_addtid_b32 v251 offset:7888
    v_pk_mul_f32 v[194:195], v[174:175], v[186:187] op_sel:[0,0] op_sel_hi:[0,1]
    v_pk_fma_f32 v[172:173], v[174:175], v[186:187], v[194:195] op_sel:[1,1,0] op_sel_hi:[1,0,1] neg_lo:[0,1,0]
    v_cvt_pk_bf16_f32 v242, v172, v173
    v_pk_mul_f32 v[194:195], v[172:173], v[186:187] op_sel:[0,0] op_sel_hi:[0,1]
    v_pk_fma_f32 v[174:175], v[172:173], v[186:187], v[194:195] op_sel:[1,1,0] op_sel_hi:[1,0,1] neg_lo:[0,1,0]
    v_cvt_pk_bf16_f32 v243, v174, v175
    ds_write_addtid_b32 v242 offset:8160
    ds_write_addtid_b32 v243 offset:8432
    ds_read_b128 a[160:163], v252 offset:0
    ds_read_b128 a[164:167], v252 offset:32
    ds_read_b128 a[168:171], v252 offset:64
    ds_read_b128 a[172:175], v252 offset:96
    ds_read_b128 a[176:179], v252 offset:128
    ds_read_b128 a[180:183], v252 offset:160
    ds_read_b128 a[184:187], v252 offset:192
    ds_read_b128 a[188:191], v252 offset:224
    v_pk_mul_f32 v[194:195], v[180:181], v[180:181] op_sel:[0,0] op_sel_hi:[0,1]
    v_pk_fma_f32 v[182:183], v[180:181], v[180:181], v[194:195] op_sel:[1,1,0] op_sel_hi:[1,0,1] neg_lo:[0,1,0]
    v_pk_mul_f32 v[194:195], v[182:183], v[182:183] op_sel:[0,0] op_sel_hi:[0,1]
    v_pk_fma_f32 v[184:185], v[182:183], v[182:183], v[194:195] op_sel:[1,1,0] op_sel_hi:[1,0,1] neg_lo:[0,1,0]
    v_cvt_pk_bf16_f32 v242, v192, -v193
    v_pk_mul_f32 v[194:195], v[192:193], v[180:181] op_sel:[0,0] op_sel_hi:[0,1]
    v_pk_fma_f32 v[174:175], v[192:193], v[180:181], v[194:195] op_sel:[1,1,0] op_sel_hi:[1,0,1] neg_lo:[0,1,0]
    v_cvt_pk_bf16_f32 v243, v174, -v175
    s_add_u32 s88, s88, 4096
    buffer_store_dwordx4 v[144:147], v148, s[16:19], s88 offen sc1
    v_pk_mul_f32 v[194:195], v[174:175], v[180:181] op_sel:[0,0] op_sel_hi:[0,1]
    v_pk_fma_f32 v[172:173], v[174:175], v[180:181], v[194:195] op_sel:[1,1,0] op_sel_hi:[1,0,1] neg_lo:[0,1,0]
    v_cvt_pk_bf16_f32 v244, v172, -v173
    v_pk_mul_f32 v[194:195], v[172:173], v[180:181] op_sel:[0,0] op_sel_hi:[0,1]
    v_pk_fma_f32 v[174:175], v[172:173], v[180:181], v[194:195] op_sel:[1,1,0] op_sel_hi:[1,0,1] neg_lo:[0,1,0]
    v_cvt_pk_bf16_f32 v245, v174, -v175
    v_pk_mul_f32 v[194:195], v[174:175], v[180:181] op_sel:[0,0] op_sel_hi:[0,1]
    v_pk_fma_f32 v[172:173], v[174:175], v[180:181], v[194:195] op_sel:[1,1,0] op_sel_hi:[1,0,1] neg_lo:[0,1,0]
    v_cvt_pk_bf16_f32 v246, v172, -v173
    v_pk_mul_f32 v[194:195], v[172:173], v[180:181] op_sel:[0,0] op_sel_hi:[0,1]
    v_pk_fma_f32 v[174:175], v[172:173], v[180:181], v[194:195] op_sel:[1,1,0] op_sel_hi:[1,0,1] neg_lo:[0,1,0]
    v_cvt_pk_bf16_f32 v247, v174, -v175
    v_pk_mul_f32 v[194:195], v[174:175], v[180:181] op_sel:[0,0] op_sel_hi:[0,1]
    v_pk_fma_f32 v[172:173], v[174:175], v[180:181], v[194:195] op_sel:[1,1,0] op_sel_hi:[1,0,1] neg_lo:[0,1,0]
    v_cvt_pk_bf16_f32 v248, v172, -v173
    v_pk_mul_f32 v[194:195], v[172:173], v[180:181] op_sel:[0,0] op_sel_hi:[0,1]
    v_pk_fma_f32 v[174:175], v[172:173], v[180:181], v[194:195] op_sel:[1,1,0] op_sel_hi:[1,0,1] neg_lo:[0,1,0]
    v_cvt_pk_bf16_f32 v249, v174, -v175
    v_pk_mul_f32 v[194:195], v[192:193], v[190:191] op_sel:[0,0] op_sel_hi:[0,1]
    v_pk_fma_f32 v[176:177], v[192:193], v[190:191], v[194:195] op_sel:[1,1,0] op_sel_hi:[1,0,1] neg_lo:[0,1,0]
    v_cvt_pk_bf16_f32 v250, v176, -v177
    v_pk_mul_f32 v[194:195], v[176:177], v[182:183] op_sel:[0,0] op_sel_hi:[0,1]
    v_pk_fma_f32 v[174:175], v[176:177], v[182:183], v[194:195] op_sel:[1,1,0] op_sel_hi:[1,0,1] neg_lo:[0,1,0]
    v_cvt_pk_bf16_f32 v251, v174, -v175
    ds_write_addtid_b32 v242 offset:0
    ds_write_addtid_b32 v243 offset:272
    ds_write_addtid_b32 v244 offset:544
    ds_write_addtid_b32 v245 offset:816
    ds_write_addtid_b32 v246 offset:1088
    ds_write_addtid_b32 v247 offset:1360
    s_add_u32 s88, s88, 4096
    buffer_store_dwordx4 v[144:147], v148, s[16:19], s88 offen sc1
    ds_write_addtid_b32 v248 offset:1632
    ds_write_addtid_b32 v249 offset:1904
    ds_write_addtid_b32 v250 offset:2176
    ds_write_addtid_b32 v251 offset:2448
    v_pk_mul_f32 v[194:195], v[174:175], v[182:183] op_sel:[0,0] op_sel_hi:[0,1]
    v_pk_fma_f32 v[172:173], v[174:175], v[182:183], v[194:195] op_sel:[1,1,0] op_sel_hi:[1,0,1] neg_lo:[0,1,0]
    v_cvt_pk_bf16_f32 v242, v172, -v173
    v_pk_mul_f32 v[194:195], v[172:173], v[182:183] op_sel:[0,0] op_sel_hi:[0,1]
    v_pk_fma_f32 v[174:175], v[172:173], v[182:183], v[194:195] op_sel:[1,1,0] op_sel_hi:[1,0,1] neg_lo:[0,1,0]
    v_cvt_pk_bf16_f32 v243, v174, -v175
    v_pk_mul_f32 v[194:195], v[174:175], v[182:183] op_sel:[0,0] op_sel_hi:[0,1]
    v_pk_fma_f32 v[172:173], v[174:175], v[182:183], v[194:195] op_sel:[1,1,0] op_sel_hi:[1,0,1] neg_lo:[0,1,0]
    v_cvt_pk_bf16_f32 v244, v172, -v173
    v_pk_mul_f32 v[194:195], v[176:177], v[190:191] op_sel:[0,0] op_sel_hi:[0,1]
    v_pk_fma_f32 v[178:179], v[176:177], v[190:191], v[194:195] op_sel:[1,1,0] op_sel_hi:[1,0,1] neg_lo:[0,1,0]
    v_cvt_pk_bf16_f32 v245, v178, -v179
    v_pk_mul_f32 v[194:195], v[178:179], v[184:185] op_sel:[0,0] op_sel_hi:[0,1]
    v_pk_fma_f32 v[174:175], v[178:179], v[184:185], v[194:195] op_sel:[1,1,0] op_sel_hi:[1,0,1] neg_lo:[0,1,0]
    v_cvt_pk_bf16_f32 v246, v174, -v175
    v_pk_mul_f32 v[194:195], v[174:175], v[184:185] op_sel:[0,0] op_sel_hi:[0,1]
    v_pk_fma_f32 v[172:173], v[174:175], v[184:185], v[194:195] op_sel:[1,1,0] op_sel_hi:[1,0,1] neg_lo:[0,1,0]
    v_cvt_pk_bf16_f32 v247, v172, -v173
    v_pk_mul_f32 v[194:195], v[178:179], v[190:191] op_sel:[0,0] op_sel_hi:[0,1]
    v_pk_fma_f32 v[176:177], v[178:179], v[190:191], v[194:195] op_sel:[1,1,0] op_sel_hi:[1,0,1] neg_lo:[0,1,0]
    v_cvt_pk_bf16_f32 v248, v176, -v177
    v_pk_mul_f32 v[194:195], v[176:177], v[184:185] op_sel:[0,0] op_sel_hi:[0,1]
    v_pk_fma_f32 v[174:175], v[176:177], v[184:185], v[194:195] op_sel:[1,1,0] op_sel_hi:[1,0,1] neg_lo:[0,1,0]
    v_cvt_pk_bf16_f32 v249, v174, -v175
    v_pk_mul_f32 v[194:195], v[174:175], v[184:185] op_sel:[0,0] op_sel_hi:[0,1]
    v_pk_fma_f32 v[172:173], v[174:175], v[184:185], v[194:195] op_sel:[1,1,0] op_sel_hi:[1,0,1] neg_lo:[0,1,0]
    s_add_u32 s88, s88, 4096
    buffer_store_dwordx4 v[144:147], v148, s[16:19], s88 offen sc1
    v_cvt_pk_bf16_f32 v250, v172, -v173
    v_pk_mul_f32 v[194:195], v[176:177], v[190:191] op_sel:[0,0] op_sel_hi:[0,1]
    v_pk_fma_f32 v[178:179], v[176:177], v[190:191], v[194:195] op_sel:[1,1,0] op_sel_hi:[1,0,1] neg_lo:[0,1,0]
    v_cvt_pk_bf16_f32 v251, v178, -v179
    ds_write_addtid_b32 v242 offset:2720
    ds_write_addtid_b32 v242 offset:3264
    ds_write_addtid_b32 v243 offset:3536
    ds_write_addtid_b32 v244 offset:3808
    ds_write_addtid_b32 v245 offset:4352
    ds_write_addtid_b32 v246 offset:4624
    ds_write_addtid_b32 v247 offset:4896
    ds_write_addtid_b32 v248 offset:5440
    ds_write_addtid_b32 v249 offset:5712
    ds_write_addtid_b32 v250 offset:5984
    ds_write_addtid_b32 v251 offset:6528
    v_pk_mul_f32 v[194:195], v[178:179], v[186:187] op_sel:[0,0] op_sel_hi:[0,1]
    v_pk_fma_f32 v[174:175], v[178:179], v[186:187], v[194:195] op_sel:[1,1,0] op_sel_hi:[1,0,1] neg_lo:[0,1,0]
    v_cvt_pk_bf16_f32 v242, v174, -v175
    v_pk_mul_f32 v[194:195], v[178:179], v[190:191] op_sel:[0,0] op_sel_hi:[0,1]
    v_pk_fma_f32 v[176:177], v[178:179], v[190:191], v[194:195] op_sel:[1,1,0] op_sel_hi:[1,0,1] neg_lo:[0,1,0]
    v_cvt_pk_bf16_f32 v243, v176, -v177
    v_pk_mul_f32 v[194:195], v[176:177], v[186:187] op_sel:[0,0] op_sel_hi:[0,1]
    v_pk_fma_f32 v[174:175], v[176:177], v[186:187], v[194:195] op_sel:[1,1,0] op_sel_hi:[1,0,1] neg_lo:[0,1,0]
    v_cvt_pk_bf16_f32 v244, v174, -v175
    v_pk_mul_f32 v[194:195], v[176:177], v[190:191] op_sel:[0,0] op_sel_hi:[0,1]
    v_pk_fma_f32 v[178:179], v[176:177], v[190:191], v[194:195] op_sel:[1,1,0] op_sel_hi:[1,0,1] neg_lo:[0,1,0]
    v_cvt_pk_bf16_f32 v245, v178, -v179
    v_pk_mul_f32 v[194:195], v[178:179], v[186:187] op_sel:[0,0] op_sel_hi:[0,1]
    v_pk_fma_f32 v[174:175], v[178:179], v[186:187], v[194:195] op_sel:[1,1,0] op_sel_hi:[1,0,1] neg_lo:[0,1,0]
    v_cvt_pk_bf16_f32 v246, v174, -v175
    v_mov_b32 v134, 0x3f803f80
    v_mov_b32 v132, 0
    v_mov_b32 v133, 0
    s_waitcnt vmcnt(19)
    v_dot2c_f32_bf16 v132, v120, v134
    v_dot2c_f32_bf16 v133, v120, v120
    v_dot2c_f32_bf16 v132, v121, v134
    v_dot2c_f32_bf16 v133, v121, v121
    v_dot2c_f32_bf16 v132, v122, v134
    v_dot2c_f32_bf16 v133, v122, v122
    v_dot2c_f32_bf16 v132, v123, v134
    v_dot2c_f32_bf16 v133, v123, v123
    s_waitcnt vmcnt(18)
    v_dot2c_f32_bf16 v132, v124, v134
    v_dot2c_f32_bf16 v133, v124, v124
    v_dot2c_f32_bf16 v132, v125, v134
    v_dot2c_f32_bf16 v133, v125, v125
    v_dot2c_f32_bf16 v132, v126, v134
    v_dot2c_f32_bf16 v133, v126, v126
    v_dot2c_f32_bf16 v132, v127, v134
    v_dot2c_f32_bf16 v133, v127, v127
    s_waitcnt vmcnt(17)
    v_dot2c_f32_bf16 v132, v128, v134
    v_dot2c_f32_bf16 v133, v128, v128
    v_dot2c_f32_bf16 v132, v129, v134
    v_dot2c_f32_bf16 v133, v129, v129
    v_dot2c_f32_bf16 v132, v130, v134
    v_dot2c_f32_bf16 v133, v130, v130
    v_dot2c_f32_bf16 v132, v131, v134
    v_dot2c_f32_bf16 v133, v131, v131
    v_lshrrev_b32 v135, 5, v0
    v_and_b32 v121, 3, v135
    v_lshrrev_b32 v135, 2, v135
    v_add_f32_dpp v132, v132, v132 row_shr:1 row_mask:0xf bank_mask:0xf bound_ctrl:0
    v_add_f32_dpp v133, v133, v133 row_shr:1 row_mask:0xf bank_mask:0xf bound_ctrl:0
    v_lshlrev_b32_e64 v135, 3, v135
    v_add_f32_dpp v132, v132, v132 row_shr:2 row_mask:0xf bank_mask:0xf bound_ctrl:0
    v_add_f32_dpp v133, v133, v133 row_shr:2 row_mask:0xf bank_mask:0xf bound_ctrl:0
    v_lshl_add_u32 v135, v121, 12, v135
    v_add_f32_dpp v132, v132, v132 row_shr:4 row_mask:0xf bank_mask:0xf bound_ctrl:0
    v_add_f32_dpp v133, v133, v133 row_shr:4 row_mask:0xf bank_mask:0xf bound_ctrl:0
    v_and_b32_e64 v121, 31, v0
    v_add_f32_dpp v132, v132, v132 row_shr:8 row_mask:0xf bank_mask:0xf bound_ctrl:0
    v_add_f32_dpp v133, v133, v133 row_shr:8 row_mask:0xf bank_mask:0xf bound_ctrl:0
    v_cmp_eq_u32_e64 vcc, 31, v121
    v_add_f32_dpp v132, v132, v132 row_bcast:15 row_mask:0xa bank_mask:0xf
    v_add_f32_dpp v133, v133, v133 row_bcast:15 row_mask:0xa bank_mask:0xf
    v_mov_b32 v121, 1073741824
    v_cndmask_b32_e64 v120, v121, v135, vcc
    s_lshl_b32 s96, s2, 4
    s_add_u32 s96, s96, 3440640
    v_mul_f32 v135, 0x3acccccd, v132
    v_mul_f32 v133, 0x3acccccd, v133
    v_fma_f32 v133, -v135, v135, v133
    v_max_f32 v133, 0, v133
    v_add_f32 v133, 0x3727c5ac, v133
    v_rsq_f32_e64 v132, v133
    s_nop 0
    v_mul_f32 v133, -v135, v132
    buffer_store_dwordx2 v[132:133], v120, s[16:19], s96 offen sc1
    v_pk_mul_f32 v[194:195], v[178:179], v[190:191] op_sel:[0,0] op_sel_hi:[0,1]
    v_pk_fma_f32 v[176:177], v[178:179], v[190:191], v[194:195] op_sel:[1,1,0] op_sel_hi:[1,0,1] neg_lo:[0,1,0]
    v_cvt_pk_bf16_f32 v247, v176, -v177
    v_pk_mul_f32 v[194:195], v[176:177], v[186:187] op_sel:[0,0] op_sel_hi:[0,1]
    v_pk_fma_f32 v[174:175], v[176:177], v[186:187], v[194:195] op_sel:[1,1,0] op_sel_hi:[1,0,1] neg_lo:[0,1,0]
    v_cvt_pk_bf16_f32 v248, v174, -v175
    ds_write_addtid_b32 v242 offset:6800
    ds_write_addtid_b32 v243 offset:7072
    ds_write_addtid_b32 v244 offset:7344
    ds_write_addtid_b32 v245 offset:7616
    ds_write_addtid_b32 v246 offset:7888
    ds_write_addtid_b32 v247 offset:8160
    ds_write_addtid_b32 v248 offset:8432
    ds_read_b128 a[192:195], v252 offset:0
    ds_read_b128 a[196:199], v252 offset:32
    ds_read_b128 a[200:203], v252 offset:64
    ds_read_b128 a[204:207], v252 offset:96
    ds_read_b128 a[208:211], v252 offset:128
    ds_read_b128 a[212:215], v252 offset:160
    ds_read_b128 a[216:219], v252 offset:192
    ds_read_b128 a[220:223], v252 offset:224
    s_add_u32 m0, s93, 73344
    s_add_u32 s99, s99, 256
    s_mov_b64 exec, s[80:81]
    buffer_load_dwordx4 v77, s[4:7], s100 offen  lds
    s_mov_b64 exec, -1
    s_add_u32 s100, s100, 256
    v_lshlrev_b32 v199, 16, v236
    v_mul_f32 v199, 0x3fb8aa3b, v199
    v_exp_f32 v199, v199
    v_lshlrev_b32 v255, 16, v237
    v_mul_f32 v255, v255, v253
    v_mul_f32 v255, 0x3e22f983, v255
    v_cvt_pk_bf16_f32 v199, v199, v199
    v_lshlrev_b32 v199, 16, v199
    v_mul_f32 v254, v199, v253
    v_mul_f32 v254, 0xbfb8aa3b, v254
    s_waitcnt lgkmcnt(7)
    v_mfma_f32_32x32x16_bf16 v[216:231], a[192:195], a[160:163], v[216:231]
    s_add_u32 m0, s92, 75520
    s_nop 0
    buffer_load_dwordx4 v73, s[4:7], s99 offen offset:0  lds
    v_mul_f32 v182, 0x41000000, v254
    v_mul_f32 v185, 0x41000000, v255
    v_mul_f32 v184, 0x43800000, v254
    v_mul_f32 v189, 0x43800000, v255
    s_waitcnt lgkmcnt(6)
    v_mfma_f32_32x32x16_bf16 v[216:231], a[196:199], a[164:167], v[216:231]
    s_add_u32 m0, s92, 75520
    s_nop 0
    buffer_load_dwordx4 v74, s[4:7], s99 offen offset:1088  lds
    v_fract_f32 v185, v185
    v_fract_f32 v188, v255
    v_fract_f32 v189, v189
    v_exp_f32 v182, v182
    s_waitcnt lgkmcnt(5)
    v_mfma_f32_32x32x16_bf16 v[216:231], a[200:203], a[168:171], v[216:231]
    s_add_u32 m0, s92, 75520
    s_nop 0
    buffer_load_dwordx4 v75, s[4:7], s99 offen offset:2176  lds
    v_exp_f32 v183, v254
    v_exp_f32 v184, v184
    v_cos_f32 v186, v185
    v_sin_f32 v187, v185
    s_waitcnt lgkmcnt(4)
    v_mfma_f32_32x32x16_bf16 v[216:231], a[204:207], a[172:175], v[216:231]
    s_add_u32 m0, s92, 75520
    buffer_load_dword v7, v4, s[16:19], s87 offen offset:0 sc1
    buffer_load_dwordx4 v76, s[4:7], s99 offen offset:3264  lds
    v_cos_f32 v180, v188
    v_sin_f32 v181, v188
    v_cos_f32 v190, v189
    v_sin_f32_e64 v191, v189
    s_waitcnt lgkmcnt(3)
    v_mfma_f32_32x32x16_bf16 v[216:231], a[208:211], a[176:179], v[216:231]
    s_add_u32 m0, s93, 92928
    s_add_u32 s99, s99, 256
    s_mov_b64 exec, s[80:81]
    buffer_load_dwordx4 v77, s[4:7], s100 offen  lds
    s_mov_b64 exec, -1
    s_add_u32 s100, s100, 256
    v_lshlrev_b32 v192, 16, v238
    v_lshlrev_b32 v193, 16, v239
    v_add_f32 v199, v253, v253
    v_mul_f32_e64 v192, v192, v199
    s_waitcnt lgkmcnt(2)
    v_mfma_f32_32x32x16_bf16 v[216:231], a[212:215], a[180:183], v[216:231]
    s_add_u32 m0, s92, 95104
    s_nop 0
    buffer_load_dwordx4 v73, s[4:7], s99 offen offset:0  lds
    v_mul_f32 v193, v193, v199
    v_mul_f32 v186, v186, v182
    v_mul_f32 v187, v187, v182
    v_mul_f32 v180, v180, v183
    s_waitcnt lgkmcnt(1)
    v_mfma_f32_32x32x16_bf16 v[216:231], a[216:219], a[184:187], v[216:231]
    s_add_u32 m0, s92, 95104
    s_nop 0
    buffer_load_dwordx4 v74, s[4:7], s99 offen offset:1088  lds
    v_mul_f32 v181, v181, v183
    v_mul_f32 v190, v190, v184
    v_mul_f32 v191, v191, v184
    s_waitcnt lgkmcnt(0)
    v_mfma_f32_32x32x16_bf16 v[216:231], a[220:223], a[188:191], v[216:231]
    s_mov_b32 m0, s37
    v_mov_b32 v242, 0x3f80
    v_cvt_pk_bf16_f32 v243, v186, v187
    v_pk_mul_f32 v[194:195], v[186:187], v[186:187] op_sel:[0,0] op_sel_hi:[0,1]
    v_pk_fma_f32 v[172:173], v[186:187], v[186:187], v[194:195] op_sel:[1,1,0] op_sel_hi:[1,0,1] neg_lo:[0,1,0]
    v_cvt_pk_bf16_f32 v244, v172, v173
    v_pk_mul_f32 v[194:195], v[172:173], v[186:187] op_sel:[0,0] op_sel_hi:[0,1]
    v_pk_fma_f32 v[174:175], v[172:173], v[186:187], v[194:195] op_sel:[1,1,0] op_sel_hi:[1,0,1] neg_lo:[0,1,0]
    v_cvt_pk_bf16_f32 v245, v174, v175
    v_pk_mul_f32 v[194:195], v[174:175], v[186:187] op_sel:[0,0] op_sel_hi:[0,1]
    v_pk_fma_f32 v[172:173], v[174:175], v[186:187], v[194:195] op_sel:[1,1,0] op_sel_hi:[1,0,1] neg_lo:[0,1,0]
    v_cvt_pk_bf16_f32 v246, v172, v173
    v_pk_mul_f32 v[194:195], v[172:173], v[186:187] op_sel:[0,0] op_sel_hi:[0,1]
    v_pk_fma_f32 v[174:175], v[172:173], v[186:187], v[194:195] op_sel:[1,1,0] op_sel_hi:[1,0,1] neg_lo:[0,1,0]
    v_cvt_pk_bf16_f32 v247, v174, v175
    v_pk_mul_f32 v[194:195], v[174:175], v[186:187] op_sel:[0,0] op_sel_hi:[0,1]
    v_pk_fma_f32 v[172:173], v[174:175], v[186:187], v[194:195] op_sel:[1,1,0] op_sel_hi:[1,0,1] neg_lo:[0,1,0]
    v_cvt_pk_bf16_f32 v248, v172, v173
    v_pk_mul_f32 v[194:195], v[172:173], v[186:187] op_sel:[0,0] op_sel_hi:[0,1]
    v_pk_fma_f32 v[174:175], v[172:173], v[186:187], v[194:195] op_sel:[1,1,0] op_sel_hi:[1,0,1] neg_lo:[0,1,0]
    v_cvt_pk_bf16_f32 v249, v174, v175
    v_pk_mul_f32 v[194:195], v[174:175], v[186:187] op_sel:[0,0] op_sel_hi:[0,1]
    v_pk_fma_f32 v[172:173], v[174:175], v[186:187], v[194:195] op_sel:[1,1,0] op_sel_hi:[1,0,1] neg_lo:[0,1,0]
    v_cvt_pk_bf16_f32 v250, v172, v173
    v_pk_mul_f32 v[194:195], v[172:173], v[186:187] op_sel:[0,0] op_sel_hi:[0,1]
    v_pk_fma_f32 v[174:175], v[172:173], v[186:187], v[194:195] op_sel:[1,1,0] op_sel_hi:[1,0,1] neg_lo:[0,1,0]
    v_cvt_pk_bf16_f32 v251, v174, v175
    ds_write_addtid_b32 v242 offset:0
    ds_write_addtid_b32 v243 offset:272
    ds_write_addtid_b32 v244 offset:544
    ds_write_addtid_b32 v245 offset:816
    ds_write_addtid_b32 v246 offset:1088
    ds_write_addtid_b32 v247 offset:1360
    ds_write_addtid_b32 v248 offset:1632
    ds_write_addtid_b32 v249 offset:1904
    ds_write_addtid_b32 v250 offset:2176
    ds_write_addtid_b32 v251 offset:2448
    v_pk_mul_f32 v[194:195], v[174:175], v[186:187] op_sel:[0,0] op_sel_hi:[0,1]
    v_pk_fma_f32 v[172:173], v[174:175], v[186:187], v[194:195] op_sel:[1,1,0] op_sel_hi:[1,0,1] neg_lo:[0,1,0]
    v_cvt_pk_bf16_f32 v242, v172, v173
    v_pk_mul_f32 v[194:195], v[172:173], v[186:187] op_sel:[0,0] op_sel_hi:[0,1]
    v_pk_fma_f32 v[174:175], v[172:173], v[186:187], v[194:195] op_sel:[1,1,0] op_sel_hi:[1,0,1] neg_lo:[0,1,0]
    v_cvt_pk_bf16_f32 v243, v174, v175
    v_pk_mul_f32 v[194:195], v[174:175], v[186:187] op_sel:[0,0] op_sel_hi:[0,1]
    v_pk_fma_f32 v[172:173], v[174:175], v[186:187], v[194:195] op_sel:[1,1,0] op_sel_hi:[1,0,1] neg_lo:[0,1,0]
    v_cvt_pk_bf16_f32 v244, v172, v173
    v_pk_mul_f32 v[194:195], v[172:173], v[186:187] op_sel:[0,0] op_sel_hi:[0,1]
    v_pk_fma_f32 v[174:175], v[172:173], v[186:187], v[194:195] op_sel:[1,1,0] op_sel_hi:[1,0,1] neg_lo:[0,1,0]
    v_cvt_pk_bf16_f32 v245, v174, v175
    v_pk_mul_f32 v[194:195], v[174:175], v[186:187] op_sel:[0,0] op_sel_hi:[0,1]
    s_waitcnt vmcnt(4)
    v_cmp_gt_u32 vcc, 32, v7
    s_nop 0
    s_and_b64 vcc, vcc, s[50:51]
    s_cbranch_scc1 ps_7
pc_9:
    s_barrier
    v_pk_fma_f32 v[172:173], v[174:175], v[186:187], v[194:195] op_sel:[1,1,0] op_sel_hi:[1,0,1] neg_lo:[0,1,0]
    v_cvt_pk_bf16_f32 v246, v172, v173
    v_pk_mul_f32 v[194:195], v[172:173], v[186:187] op_sel:[0,0] op_sel_hi:[0,1]
    v_pk_fma_f32 v[174:175], v[172:173], v[186:187], v[194:195] op_sel:[1,1,0] op_sel_hi:[1,0,1] neg_lo:[0,1,0]
    v_cvt_pk_bf16_f32 v247, v174, v175
    v_pk_mul_f32 v[194:195], v[174:175], v[186:187] op_sel:[0,0] op_sel_hi:[0,1]
    v_pk_fma_f32 v[172:173], v[174:175], v[186:187], v[194:195] op_sel:[1,1,0] op_sel_hi:[1,0,1] neg_lo:[0,1,0]
    v_cvt_pk_bf16_f32 v248, v172, v173
    v_pk_mul_f32 v[194:195], v[172:173], v[186:187] op_sel:[0,0] op_sel_hi:[0,1]
    v_pk_fma_f32 v[174:175], v[172:173], v[186:187], v[194:195] op_sel:[1,1,0] op_sel_hi:[1,0,1] neg_lo:[0,1,0]
    v_cvt_pk_bf16_f32 v249, v174, v175
    v_pk_mul_f32 v[194:195], v[174:175], v[186:187] op_sel:[0,0] op_sel_hi:[0,1]
    v_pk_fma_f32 v[172:173], v[174:175], v[186:187], v[194:195] op_sel:[1,1,0] op_sel_hi:[1,0,1] neg_lo:[0,1,0]
    v_cvt_pk_bf16_f32 v250, v172, v173
    v_pk_mul_f32 v[194:195], v[172:173], v[186:187] op_sel:[0,0] op_sel_hi:[0,1]
    buffer_load_dwordx4 a[0:3], v200, s[16:19], s101 offen offset:0 sc1
    v_pk_fma_f32 v[174:175], v[172:173], v[186:187], v[194:195] op_sel:[1,1,0] op_sel_hi:[1,0,1] neg_lo:[0,1,0]
    v_cvt_pk_bf16_f32 v251, v174, v175
    ds_write_addtid_b32 v242 offset:2720
    ds_write_addtid_b32 v243 offset:2992
    ds_write_addtid_b32 v244 offset:3264
    ds_write_addtid_b32 v245 offset:3536
    ds_write_addtid_b32 v246 offset:3808
    ds_write_addtid_b32 v247 offset:4080
    ds_write_addtid_b32 v248 offset:4352
    ds_write_addtid_b32 v249 offset:4624
    ds_write_addtid_b32 v250 offset:4896
    ds_write_addtid_b32 v251 offset:5168
    v_pk_mul_f32 v[194:195], v[174:175], v[186:187] op_sel:[0,0] op_sel_hi:[0,1]
    v_pk_fma_f32 v[172:173], v[174:175], v[186:187], v[194:195] op_sel:[1,1,0] op_sel_hi:[1,0,1] neg_lo:[0,1,0]
    v_cvt_pk_bf16_f32 v242, v172, v173
    buffer_load_dwordx4 a[4:7], v200, s[16:19], s101 offen offset:1024 sc1
    v_pk_mul_f32 v[194:195], v[172:173], v[186:187] op_sel:[0,0] op_sel_hi:[0,1]
    v_pk_fma_f32 v[174:175], v[172:173], v[186:187], v[194:195] op_sel:[1,1,0] op_sel_hi:[1,0,1] neg_lo:[0,1,0]
    v_cvt_pk_bf16_f32 v243, v174, v175
    v_pk_mul_f32 v[194:195], v[174:175], v[186:187] op_sel:[0,0] op_sel_hi:[0,1]
    v_pk_fma_f32 v[172:173], v[174:175], v[186:187], v[194:195] op_sel:[1,1,0] op_sel_hi:[1,0,1] neg_lo:[0,1,0]
    v_cvt_pk_bf16_f32 v244, v172, v173
    v_pk_mul_f32 v[194:195], v[172:173], v[186:187] op_sel:[0,0] op_sel_hi:[0,1]
    v_pk_fma_f32 v[174:175], v[172:173], v[186:187], v[194:195] op_sel:[1,1,0] op_sel_hi:[1,0,1] neg_lo:[0,1,0]
    v_cvt_pk_bf16_f32 v245, v174, v175
    v_pk_mul_f32 v[194:195], v[174:175], v[186:187] op_sel:[0,0] op_sel_hi:[0,1]
    v_pk_fma_f32 v[172:173], v[174:175], v[186:187], v[194:195] op_sel:[1,1,0] op_sel_hi:[1,0,1] neg_lo:[0,1,0]
    v_cvt_pk_bf16_f32 v246, v172, v173
    v_pk_mul_f32 v[194:195], v[172:173], v[186:187] op_sel:[0,0] op_sel_hi:[0,1]
    v_pk_fma_f32 v[174:175], v[172:173], v[186:187], v[194:195] op_sel:[1,1,0] op_sel_hi:[1,0,1] neg_lo:[0,1,0]
    v_cvt_pk_bf16_f32 v247, v174, v175
    buffer_load_dwordx4 a[8:11], v200, s[16:19], s101 offen offset:2048 sc1
    v_pk_mul_f32 v[194:195], v[174:175], v[186:187] op_sel:[0,0] op_sel_hi:[0,1]
    v_pk_fma_f32 v[172:173], v[174:175], v[186:187], v[194:195] op_sel:[1,1,0] op_sel_hi:[1,0,1] neg_lo:[0,1,0]
    v_cvt_pk_bf16_f32 v248, v172, v173
    v_pk_mul_f32 v[194:195], v[172:173], v[186:187] op_sel:[0,0] op_sel_hi:[0,1]
    v_pk_fma_f32 v[174:175], v[172:173], v[186:187], v[194:195] op_sel:[1,1,0] op_sel_hi:[1,0,1] neg_lo:[0,1,0]
    v_cvt_pk_bf16_f32 v249, v174, v175
    v_pk_mul_f32 v[194:195], v[174:175], v[186:187] op_sel:[0,0] op_sel_hi:[0,1]
    v_pk_fma_f32 v[172:173], v[174:175], v[186:187], v[194:195] op_sel:[1,1,0] op_sel_hi:[1,0,1] neg_lo:[0,1,0]
    v_cvt_pk_bf16_f32 v250, v172, v173
    v_pk_mul_f32 v[194:195], v[172:173], v[186:187] op_sel:[0,0] op_sel_hi:[0,1]
    v_pk_fma_f32 v[174:175], v[172:173], v[186:187], v[194:195] op_sel:[1,1,0] op_sel_hi:[1,0,1] neg_lo:[0,1,0]
    v_cvt_pk_bf16_f32 v251, v174, v175
    ds_write_addtid_b32 v242 offset:5440
    ds_write_addtid_b32 v243 offset:5712
    ds_write_addtid_b32 v244 offset:5984
    buffer_load_dwordx4 a[12:15], v200, s[16:19], s101 offen offset:3072 sc1
    ds_write_addtid_b32 v245 offset:6256
    ds_write_addtid_b32 v246 offset:6528
    ds_write_addtid_b32 v247 offset:6800
    ds_write_addtid_b32 v248 offset:7072
    ds_write_addtid_b32 v249 offset:7344
    ds_write_addtid_b32 v250 offset:7616
    ds_write_addtid_b32 v251 offset:7888
    v_pk_mul_f32 v[194:195], v[174:175], v[186:187] op_sel:[0,0] op_sel_hi:[0,1]
    v_pk_fma_f32 v[172:173], v[174:175], v[186:187], v[194:195] op_sel:[1,1,0] op_sel_hi:[1,0,1] neg_lo:[0,1,0]
    v_cvt_pk_bf16_f32 v242, v172, v173
    v_pk_mul_f32 v[194:195], v[172:173], v[186:187] op_sel:[0,0] op_sel_hi:[0,1]
    v_pk_fma_f32 v[174:175], v[172:173], v[186:187], v[194:195] op_sel:[1,1,0] op_sel_hi:[1,0,1] neg_lo:[0,1,0]
    v_cvt_pk_bf16_f32 v243, v174, v175
    ds_write_addtid_b32 v242 offset:8160
    ds_write_addtid_b32 v243 offset:8432
    s_add_u32 s101, s101, 4096
    buffer_load_dwordx4 a[16:19], v200, s[16:19], s101 offen offset:0 sc1
    ds_read_b128 a[160:163], v252 offset:0
    ds_read_b128 a[164:167], v252 offset:32
    ds_read_b128 a[168:171], v252 offset:64
    ds_read_b128 a[172:175], v252 offset:96
    ds_read_b128 a[176:179], v252 offset:128
    ds_read_b128 a[180:183], v252 offset:160
    ds_read_b128 a[184:187], v252 offset:192
    ds_read_b128 a[188:191], v252 offset:224
    v_pk_mul_f32 v[194:195], v[180:181], v[180:181] op_sel:[0,0] op_sel_hi:[0,1]
    v_pk_fma_f32 v[182:183], v[180:181], v[180:181], v[194:195] op_sel:[1,1,0] op_sel_hi:[1,0,1] neg_lo:[0,1,0]
    v_pk_mul_f32 v[194:195], v[182:183], v[182:183] op_sel:[0,0] op_sel_hi:[0,1]
    v_pk_fma_f32 v[184:185], v[182:183], v[182:183], v[194:195] op_sel:[1,1,0] op_sel_hi:[1,0,1] neg_lo:[0,1,0]
    v_cvt_pk_bf16_f32 v242, v192, -v193
    v_pk_mul_f32 v[194:195], v[192:193], v[180:181] op_sel:[0,0] op_sel_hi:[0,1]
    v_pk_fma_f32 v[174:175], v[192:193], v[180:181], v[194:195] op_sel:[1,1,0] op_sel_hi:[1,0,1] neg_lo:[0,1,0]
    buffer_load_dwordx4 a[20:23], v200, s[16:19], s101 offen offset:1024 sc1
    v_cvt_pk_bf16_f32 v243, v174, -v175
    v_pk_mul_f32 v[194:195], v[174:175], v[180:181] op_sel:[0,0] op_sel_hi:[0,1]
    v_pk_fma_f32 v[172:173], v[174:175], v[180:181], v[194:195] op_sel:[1,1,0] op_sel_hi:[1,0,1] neg_lo:[0,1,0]
    v_cvt_pk_bf16_f32 v244, v172, -v173
    v_pk_mul_f32 v[194:195], v[172:173], v[180:181] op_sel:[0,0] op_sel_hi:[0,1]
    v_pk_fma_f32 v[174:175], v[172:173], v[180:181], v[194:195] op_sel:[1,1,0] op_sel_hi:[1,0,1] neg_lo:[0,1,0]
    v_cvt_pk_bf16_f32 v245, v174, -v175
    v_pk_mul_f32 v[194:195], v[174:175], v[180:181] op_sel:[0,0] op_sel_hi:[0,1]
    v_pk_fma_f32 v[172:173], v[174:175], v[180:181], v[194:195] op_sel:[1,1,0] op_sel_hi:[1,0,1] neg_lo:[0,1,0]
    v_cvt_pk_bf16_f32 v246, v172, -v173
    v_pk_mul_f32 v[194:195], v[172:173], v[180:181] op_sel:[0,0] op_sel_hi:[0,1]
    v_pk_fma_f32 v[174:175], v[172:173], v[180:181], v[194:195] op_sel:[1,1,0] op_sel_hi:[1,0,1] neg_lo:[0,1,0]
    v_cvt_pk_bf16_f32 v247, v174, -v175
    v_pk_mul_f32 v[194:195], v[174:175], v[180:181] op_sel:[0,0] op_sel_hi:[0,1]
    v_pk_fma_f32 v[172:173], v[174:175], v[180:181], v[194:195] op_sel:[1,1,0] op_sel_hi:[1,0,1] neg_lo:[0,1,0]
    buffer_load_dwordx4 a[24:27], v200, s[16:19], s101 offen offset:2048 sc1
    v_cvt_pk_bf16_f32 v248, v172, -v173
    v_pk_mul_f32 v[194:195], v[172:173], v[180:181] op_sel:[0,0] op_sel_hi:[0,1]
    v_pk_fma_f32 v[174:175], v[172:173], v[180:181], v[194:195] op_sel:[1,1,0] op_sel_hi:[1,0,1] neg_lo:[0,1,0]
    v_cvt_pk_bf16_f32 v249, v174, -v175
    v_pk_mul_f32 v[194:195], v[192:193], v[190:191] op_sel:[0,0] op_sel_hi:[0,1]
    v_pk_fma_f32 v[176:177], v[192:193], v[190:191], v[194:195] op_sel:[1,1,0] op_sel_hi:[1,0,1] neg_lo:[0,1,0]
    v_cvt_pk_bf16_f32 v250, v176, -v177
    v_pk_mul_f32 v[194:195], v[176:177], v[182:183] op_sel:[0,0] op_sel_hi:[0,1]
    v_pk_fma_f32 v[174:175], v[176:177], v[182:183], v[194:195] op_sel:[1,1,0] op_sel_hi:[1,0,1] neg_lo:[0,1,0]
    v_cvt_pk_bf16_f32 v251, v174, -v175
    ds_write_addtid_b32 v242 offset:0
    ds_write_addtid_b32 v243 offset:272
    ds_write_addtid_b32 v244 offset:544
    ds_write_addtid_b32 v245 offset:816
    ds_write_addtid_b32 v246 offset:1088
    buffer_load_dwordx4 a[28:31], v200, s[16:19], s101 offen offset:3072 sc1
    ds_write_addtid_b32 v247 offset:1360
    ds_write_addtid_b32 v248 offset:1632
    ds_write_addtid_b32 v249 offset:1904
    ds_write_addtid_b32 v250 offset:2176
    ds_write_addtid_b32 v251 offset:2448
    v_pk_mul_f32 v[194:195], v[174:175], v[182:183] op_sel:[0,0] op_sel_hi:[0,1]
    v_pk_fma_f32 v[172:173], v[174:175], v[182:183], v[194:195] op_sel:[1,1,0] op_sel_hi:[1,0,1] neg_lo:[0,1,0]
    v_cvt_pk_bf16_f32 v242, v172, -v173
    v_pk_mul_f32 v[194:195], v[172:173], v[182:183] op_sel:[0,0] op_sel_hi:[0,1]
    v_pk_fma_f32 v[174:175], v[172:173], v[182:183], v[194:195] op_sel:[1,1,0] op_sel_hi:[1,0,1] neg_lo:[0,1,0]
    v_cvt_pk_bf16_f32 v243, v174, -v175
    v_pk_mul_f32 v[194:195], v[174:175], v[182:183] op_sel:[0,0] op_sel_hi:[0,1]
    v_pk_fma_f32 v[172:173], v[174:175], v[182:183], v[194:195] op_sel:[1,1,0] op_sel_hi:[1,0,1] neg_lo:[0,1,0]
    v_cvt_pk_bf16_f32 v244, v172, -v173
    v_pk_mul_f32 v[194:195], v[176:177], v[190:191] op_sel:[0,0] op_sel_hi:[0,1]
    s_add_u32 s101, s101, 4096
    buffer_load_dwordx4 a[32:35], v200, s[16:19], s101 offen offset:0 sc1
    v_pk_fma_f32 v[178:179], v[176:177], v[190:191], v[194:195] op_sel:[1,1,0] op_sel_hi:[1,0,1] neg_lo:[0,1,0]
    v_cvt_pk_bf16_f32 v245, v178, -v179
    v_pk_mul_f32 v[194:195], v[178:179], v[184:185] op_sel:[0,0] op_sel_hi:[0,1]
    v_pk_fma_f32 v[174:175], v[178:179], v[184:185], v[194:195] op_sel:[1,1,0] op_sel_hi:[1,0,1] neg_lo:[0,1,0]
    v_cvt_pk_bf16_f32 v246, v174, -v175
    v_pk_mul_f32 v[194:195], v[174:175], v[184:185] op_sel:[0,0] op_sel_hi:[0,1]
    v_pk_fma_f32 v[172:173], v[174:175], v[184:185], v[194:195] op_sel:[1,1,0] op_sel_hi:[1,0,1] neg_lo:[0,1,0]
    v_cvt_pk_bf16_f32 v247, v172, -v173
    v_pk_mul_f32 v[194:195], v[178:179], v[190:191] op_sel:[0,0] op_sel_hi:[0,1]
    v_pk_fma_f32 v[176:177], v[178:179], v[190:191], v[194:195] op_sel:[1,1,0] op_sel_hi:[1,0,1] neg_lo:[0,1,0]
    v_cvt_pk_bf16_f32 v248, v176, -v177
    v_pk_mul_f32 v[194:195], v[176:177], v[184:185] op_sel:[0,0] op_sel_hi:[0,1]
    v_pk_fma_f32 v[174:175], v[176:177], v[184:185], v[194:195] op_sel:[1,1,0] op_sel_hi:[1,0,1] neg_lo:[0,1,0]
    v_cvt_pk_bf16_f32 v249, v174, -v175
    v_pk_mul_f32 v[194:195], v[174:175], v[184:185] op_sel:[0,0] op_sel_hi:[0,1]
    buffer_load_dwordx4 a[36:39], v200, s[16:19], s101 offen offset:1024 sc1
    v_pk_fma_f32 v[172:173], v[174:175], v[184:185], v[194:195] op_sel:[1,1,0] op_sel_hi:[1,0,1] neg_lo:[0,1,0]
    v_cvt_pk_bf16_f32 v250, v172, -v173
    v_pk_mul_f32 v[194:195], v[176:177], v[190:191] op_sel:[0,0] op_sel_hi:[0,1]
    v_pk_fma_f32 v[178:179], v[176:177], v[190:191], v[194:195] op_sel:[1,1,0] op_sel_hi:[1,0,1] neg_lo:[0,1,0]
    v_cvt_pk_bf16_f32 v251, v178, -v179
    ds_write_addtid_b32 v242 offset:2720
    ds_write_addtid_b32 v242 offset:3264
    ds_write_addtid_b32 v243 offset:3536
    ds_write_addtid_b32 v244 offset:3808
    ds_write_addtid_b32 v245 offset:4352
    ds_write_addtid_b32 v246 offset:4624
    ds_write_addtid_b32 v247 offset:4896
    ds_write_addtid_b32 v248 offset:5440
    ds_write_addtid_b32 v249 offset:5712
    ds_write_addtid_b32 v250 offset:5984
    buffer_load_dwordx4 a[40:43], v200, s[16:19], s101 offen offset:2048 sc1
    ds_write_addtid_b32 v251 offset:6528
    v_pk_mul_f32 v[194:195], v[178:179], v[186:187] op_sel:[0,0] op_sel_hi:[0,1]
    v_pk_fma_f32 v[174:175], v[178:179], v[186:187], v[194:195] op_sel:[1,1,0] op_sel_hi:[1,0,1] neg_lo:[0,1,0]
    v_cvt_pk_bf16_f32 v242, v174, -v175
    v_pk_mul_f32 v[194:195], v[178:179], v[190:191] op_sel:[0,0] op_sel_hi:[0,1]
    v_pk_fma_f32 v[176:177], v[178:179], v[190:191], v[194:195] op_sel:[1,1,0] op_sel_hi:[1,0,1] neg_lo:[0,1,0]
    v_cvt_pk_bf16_f32 v243, v176, -v177
    v_pk_mul_f32 v[194:195], v[176:177], v[186:187] op_sel:[0,0] op_sel_hi:[0,1]
    v_pk_fma_f32 v[174:175], v[176:177], v[186:187], v[194:195] op_sel:[1,1,0] op_sel_hi:[1,0,1] neg_lo:[0,1,0]
    v_cvt_pk_bf16_f32 v244, v174, -v175
    v_pk_mul_f32 v[194:195], v[176:177], v[190:191] op_sel:[0,0] op_sel_hi:[0,1]
    v_pk_fma_f32 v[178:179], v[176:177], v[190:191], v[194:195] op_sel:[1,1,0] op_sel_hi:[1,0,1] neg_lo:[0,1,0]
    v_cvt_pk_bf16_f32 v245, v178, -v179
    v_pk_mul_f32 v[194:195], v[178:179], v[186:187] op_sel:[0,0] op_sel_hi:[0,1]
    v_pk_fma_f32 v[174:175], v[178:179], v[186:187], v[194:195] op_sel:[1,1,0] op_sel_hi:[1,0,1] neg_lo:[0,1,0]
    buffer_load_dwordx4 a[44:47], v200, s[16:19], s101 offen offset:3072 sc1
    v_cvt_pk_bf16_f32 v246, v174, -v175
    v_pk_mul_f32 v[194:195], v[178:179], v[190:191] op_sel:[0,0] op_sel_hi:[0,1]
    v_pk_fma_f32 v[176:177], v[178:179], v[190:191], v[194:195] op_sel:[1,1,0] op_sel_hi:[1,0,1] neg_lo:[0,1,0]
    v_cvt_pk_bf16_f32 v247, v176, -v177
    v_pk_mul_f32 v[194:195], v[176:177], v[186:187] op_sel:[0,0] op_sel_hi:[0,1]
    v_pk_fma_f32 v[174:175], v[176:177], v[186:187], v[194:195] op_sel:[1,1,0] op_sel_hi:[1,0,1] neg_lo:[0,1,0]
    v_cvt_pk_bf16_f32 v248, v174, -v175
    ds_write_addtid_b32 v242 offset:6800
    ds_write_addtid_b32 v243 offset:7072
    ds_write_addtid_b32 v244 offset:7344
    ds_write_addtid_b32 v245 offset:7616
    ds_write_addtid_b32 v246 offset:7888
    ds_write_addtid_b32 v247 offset:8160
    ds_write_addtid_b32 v248 offset:8432
    ds_read_b128 a[192:195], v252 offset:0
    s_add_u32 s101, s101, 4096
    buffer_load_dwordx4 a[48:51], v200, s[16:19], s101 offen offset:0 sc1
    ds_read_b128 a[196:199], v252 offset:32
    ds_read_b128 a[200:203], v252 offset:64
    ds_read_b128 a[204:207], v252 offset:96
    ds_read_b128 a[208:211], v252 offset:128
    ds_read_b128 a[212:215], v252 offset:160
    ds_read_b128 a[216:219], v252 offset:192
    ds_read_b128 a[220:223], v252 offset:224
    s_add_u32 m0, s92, 95104
    s_nop 0
    buffer_load_dwordx4 v75, s[4:7], s99 offen offset:2176  lds
    s_waitcnt lgkmcnt(7)
    v_mfma_f32_32x32x16_bf16 v[216:231], a[192:195], a[160:163], v[216:231]
    s_add_u32 m0, s92, 95104
    s_nop 0
    buffer_load_dwordx4 v76, s[4:7], s99 offen offset:3264  lds
    s_waitcnt lgkmcnt(6)
    v_mfma_f32_32x32x16_bf16 v[216:231], a[196:199], a[164:167], v[216:231]
    s_add_u32 m0, s93, 112512
    s_add_u32 s99, s99, 256
    buffer_load_dwordx4 a[52:55], v200, s[16:19], s101 offen offset:1024 sc1
    s_mov_b64 exec, s[80:81]
    buffer_load_dwordx4 v77, s[4:7], s100 offen  lds
    s_mov_b64 exec, -1
    s_add_u32 s100, s100, 256
    s_waitcnt lgkmcnt(5)
    v_mfma_f32_32x32x16_bf16 v[216:231], a[200:203], a[168:171], v[216:231]
    s_add_u32 m0, s92, 114688
    s_nop 0
    buffer_load_dwordx4 v73, s[4:7], s99 offen offset:0  lds
    s_waitcnt lgkmcnt(4)
    v_mfma_f32_32x32x16_bf16 v[216:231], a[204:207], a[172:175], v[216:231]
    s_add_u32 m0, s92, 114688
    s_nop 0
    buffer_load_dwordx4 v74, s[4:7], s99 offen offset:1088  lds
    s_waitcnt lgkmcnt(3)
    v_mfma_f32_32x32x16_bf16 v[216:231], a[208:211], a[176:179], v[216:231]
    s_add_u32 m0, s92, 114688
    s_nop 0
    buffer_load_dwordx4 v75, s[4:7], s99 offen offset:2176  lds
    s_waitcnt lgkmcnt(2)
    v_mfma_f32_32x32x16_bf16 v[216:231], a[212:215], a[180:183], v[216:231]
    s_add_u32 m0, s92, 114688
    s_nop 0
    buffer_load_dwordx4 v76, s[4:7], s99 offen offset:3264  lds
    s_waitcnt lgkmcnt(1)
    v_mfma_f32_32x32x16_bf16 v[216:231], a[216:219], a[184:187], v[216:231]
    s_add_u32 m0, s93, 132096
    s_add_u32 s99, s99, 256
    s_mov_b64 exec, s[80:81]
    buffer_load_dwordx4 v77, s[4:7], s100 offen  lds
    s_mov_b64 exec, -1
    s_add_u32 s100, s100, 256
    s_waitcnt lgkmcnt(0)
    v_mfma_f32_32x32x16_bf16 v[216:231], a[220:223], a[188:191], v[216:231]
    s_mov_b32 m0, s37
    s_branch ec_3
nc_2:
    s_cmp_lg_u32 s2, 255
    s_cbranch_scc1 fr_10
    v_mov_b32 v2, 1
    s_waitcnt vmcnt(9)
    s_barrier
    s_mov_b64 exec, 1
    global_store_dword v5, v2, s[66:67] sc1
    s_mov_b64 exec, -1
fr_10:
    s_sub_u32 s33, s2, 160
    s_min_u32 s33, s33, 159
    s_mul_i32 s29, s33, 3277
    s_lshr_b32 s29, s29, 16
    s_mul_i32 s30, s29, 20
    s_sub_u32 s30, s33, s30
    s_mul_i32 s31, s30, 13108
    s_lshr_b32 s31, s31, 16
    s_mul_i32 s32, s31, 5
    s_sub_u32 s32, s30, s32
    s_lshl_b32 s28, s24, 10
    s_lshr_b32 s34, s32, 1
    s_mul_i32 s34, s34, 20
    s_and_b32 s35, s32, 1
    s_lshl_b32 s35, s35, 3
    s_add_u32 s34, s34, s35
    s_cmp_eq_u32 s32, 4
    s_cselect_b32 s34, 16, s34
    s_cselect_b32 s35, 20, 4
    s_mul_i32 s36, s31, 160
    s_add_u32 s34, s34, s36
    s_mul_i32 s34, s34, 1280
    s_mul_i32 s36, s29, 160
    s_add_u32 s34, s34, s36
    v_add_u32 v162, 0, v0
    v_mul_u32_u24 v160, 6554, v162
    v_lshrrev_b32 v160, 16, v160
    v_mul_u32_u24 v161, 10, v160
    v_sub_u32 v161, v162, v161
    v_lshrrev_b32 v163, 3, v160
    v_mul_u32_u24 v163, 40, v163
    v_bfe_u32 v164, v160, 2, 1
    v_mul_u32_u24 v164, s35, v164
    v_and_b32_e64 v160, 3, v160
    v_add3_u32 v160, v160, v163, v164
    v_mul_u32_u24 v160, 1280, v160
    v_lshl_add_u32 v162, v161, 4, v160
    s_add_u32 m0, s28, 0
    s_nop 0
    buffer_load_dwordx4 v162, s[12:15], s34 offen lds
    v_add_u32 v162, 256, v0
    v_min_u32 v162, 319, v162
    v_mul_u32_u24 v160, 6554, v162
    v_lshrrev_b32 v160, 16, v160
    v_mul_u32_u24 v161, 10, v160
    v_sub_u32 v161, v162, v161
    v_lshrrev_b32 v163, 3, v160
    v_mul_u32_u24 v163, 40, v163
    v_bfe_u32 v164, v160, 2, 1
    v_mul_u32_u24 v164, s35, v164
    v_and_b32_e64 v160, 3, v160
    v_add3_u32 v160, v160, v163, v164
    v_mul_u32_u24 v160, 1280, v160
    v_lshl_add_u32 v162, v161, 4, v160
    s_add_u32 m0, s28, 4096
    s_nop 0
    buffer_load_dwordx4 v162, s[12:15], s34 offen lds
    v_bfe_u32 v163, v0, 4, 2
    v_bfe_u32 v164, v0, 2, 2
    v_lshl_add_u32 v163, v163, 3, v164
    v_mul_u32_u24 v163, 160, v163
    v_and_b32 v164, 3, v0
    v_lshl_add_u32 v165, v164, 3, v163
    v_add_u32 v165, 0, v165
    s_lshl_b32 s36, s24, 5
    v_add_u32_e64 v166, s36, v165
    s_mul_i32 s33, s33, 5120
    s_add_u32 s33, s33, 2621440
    v_lshl_add_u32 v167, v1, 4, s33
    v_add_u32 v164, 4096, v167
    v_mov_b32 v163, 1073741824
    v_cmp_gt_u32 vcc, 64, v0
    s_sub_u32 s36, s24, s31
    s_and_b32 s36, s36, 3
    s_lshl_b32 s36, s36, 10
    v_cndmask_b32 v168, v163, v164, vcc
    v_add_u32 v167, s36, v167
    s_sub_u32 s33, s2, 64
    s_min_u32 s33, s33, 159
    s_mul_i32 s29, s33, 3277
    s_lshr_b32 s29, s29, 16
    s_mul_i32 s30, s29, 20
    s_sub_u32 s30, s33, s30
    s_mul_i32 s31, s30, 13108
    s_lshr_b32 s31, s31, 16
    s_mul_i32 s32, s31, 5
    s_sub_u32 s32, s30, s32
    s_lshl_b32 s28, s24, 10
    s_lshr_b32 s34, s32, 1
    s_mul_i32 s34, s34, 20
    s_and_b32 s35, s32, 1
    s_lshl_b32 s35, s35, 3
    s_add_u32 s34, s34, s35
    s_cmp_eq_u32 s32, 4
    s_cselect_b32 s34, 16, s34
    s_cselect_b32 s35, 20, 4
    s_mul_i32 s36, s31, 160
    s_add_u32 s34, s34, s36
    s_mul_i32 s34, s34, 1280
    s_mul_i32 s36, s29, 160
    s_add_u32 s34, s34, s36
    v_add_u32 v182, 0, v0
    v_mul_u32_u24 v180, 6554, v182
    v_lshrrev_b32 v180, 16, v180
    v_mul_u32_u24 v181, 10, v180
    v_sub_u32 v181, v182, v181
    v_lshrrev_b32 v183, 3, v180
    v_mul_u32_u24 v183, 40, v183
    v_bfe_u32 v184, v180, 2, 1
    v_mul_u32_u24 v184, s35, v184
    v_and_b32_e64 v180, 3, v180
    v_add3_u32 v180, v180, v183, v184
    v_mul_u32_u24 v180, 1280, v180
    v_lshl_add_u32 v182, v181, 4, v180
    s_add_u32 m0, s28, 8192
    s_nop 0
    buffer_load_dwordx4 v182, s[12:15], s34 offen lds
    v_add_u32 v182, 256, v0
    v_min_u32 v182, 319, v182
    v_mul_u32_u24 v180, 6554, v182
    v_lshrrev_b32 v180, 16, v180
    v_mul_u32_u24 v181, 10, v180
    v_sub_u32 v181, v182, v181
    v_lshrrev_b32 v183, 3, v180
    v_mul_u32_u24 v183, 40, v183
    v_bfe_u32 v184, v180, 2, 1
    v_mul_u32_u24 v184, s35, v184
    v_and_b32 v180, 3, v180
    v_add3_u32 v180, v180, v183, v184
    v_mul_u32_u24 v180, 1280, v180
    v_lshl_add_u32 v182, v181, 4, v180
    s_add_u32 m0, s28, 12288
    s_nop 0
    buffer_load_dwordx4 v182, s[12:15], s34 offen lds
    v_bfe_u32 v183, v0, 4, 2
    v_bfe_u32 v184, v0, 2, 2
    v_lshl_add_u32 v183, v183, 3, v184
    v_mul_u32_u24 v183, 160, v183
    v_and_b32 v184, 3, v0
    v_lshl_add_u32 v185, v184, 3, v183
    v_add_u32 v185, 8192, v185
    s_lshl_b32 s36, s24, 5
    v_add_u32 v186, s36, v185
    s_mul_i32 s33, s33, 5120
    s_add_u32 s33, s33, 2621440
    v_lshl_add_u32 v187, v1, 4, s33
    v_add_u32 v184, 4096, v187
    v_mov_b32 v183, 1073741824
    v_cmp_gt_u32 vcc, 64, v0
    s_sub_u32 s36, s24, s31
    s_and_b32 s36, s36, 3
    s_lshl_b32 s36, s36, 10
    v_cndmask_b32 v188, v183, v184, vcc
    v_add_u32 v187, s36, v187
    v_mov_b32 v216, 0
    v_mov_b32 v217, 0
    v_mov_b32 v218, 0
    v_mov_b32 v219, 0
    v_mov_b32 v220, 0
    v_mov_b32 v221, 0
    v_mov_b32 v222, 0
    v_mov_b32 v223, 0
    v_mov_b32 v224, 0
    v_mov_b32 v225, 0
    v_mov_b32 v226, 0
    v_mov_b32 v227, 0
    v_mov_b32 v228, 0
    v_mov_b32 v229, 0
    v_mov_b32 v230, 0
    v_mov_b32_e64 v231, 0
    s_waitcnt vmcnt(5)
    s_barrier
    ds_read_b64_tr_b16 v[96:97], v111
    ds_read_b64_tr_b16 v[98:99], v111 offset:2560
    ds_read_b64_tr_b16 v[100:101], v112
    ds_read_b64_tr_b16 v[102:103], v112 offset:2560
    ds_read_b64_tr_b16 v[104:105], v113
    ds_read_b64_tr_b16 v[106:107], v113 offset:2560
    s_waitcnt lgkmcnt(4)
    buffer_store_dwordx4 v[96:99], v108, s[16:19], 0 offen sc1
    s_waitcnt lgkmcnt(2)
    buffer_store_dwordx4 v[100:103], v109, s[16:19], 0 offen sc1
    s_waitcnt lgkmcnt(0)
    buffer_store_dwordx4 v[104:107], v110, s[16:19], 0 offen sc1
    global_load_dword v7, v5, s[66:67] sc1
    v_lshrrev_b32 v132, 5, v0
    v_and_b32_e64 v133, 31, v0
    v_mul_u32_u24 v132, 1280, v132
    v_lshl_add_u32 v134, v133, 4, v132
    v_mov_b32 v135, 1073741824
    v_cmp_gt_u32 vcc, 16, v133
    s_mul_i32 s96, s2, 10240
    buffer_load_dwordx4 v[120:123], v134, s[4:7], s96 offen
    v_cndmask_b32_e64 v135, v135, v134, vcc
    buffer_load_dwordx4 v[124:127], v134, s[4:7], s96 offen offset:512
    buffer_load_dwordx4 v[128:131], v135, s[4:7], s96 offen offset:1024
    s_waitcnt vmcnt(4)
    s_waitcnt vmcnt(3)
    v_cmp_gt_u32 vcc, 1, v7
    s_nop 0
    s_and_b64 vcc, vcc, s[50:51]
    s_and_b64 vcc, vcc, 1
    s_cbranch_scc1 ps_11
pc_13:
    s_barrier
    v_lshlrev_b32 v2, 3, v4
    v_mov_b32 v5, 1
    v_cndmask_b32 v2, v4, v2, s[50:51]
    buffer_atomic_add v5, v2, s[16:19], s86 offen offset:0 sc1
    ds_read_b64_tr_b16 v[172:173], v166
    ds_read_b64_tr_b16 v[174:175], v166 offset:640
    ds_read_b64_tr_b16 v[176:177], v165 offset:128
    ds_read_b64_tr_b16 v[178:179], v165 offset:768
    s_waitcnt lgkmcnt(2)
    buffer_store_dwordx4 v[172:175], v167, s[16:19], 0 offen sc1
    s_waitcnt lgkmcnt(0)
    buffer_store_dwordx4 v[176:179], v168, s[16:19], 0 offen sc1
    ds_read_b64_tr_b16 v[192:193], v186
    ds_read_b64_tr_b16 v[194:195], v186 offset:640
    ds_read_b64_tr_b16 v[196:197], v185 offset:128
    ds_read_b64_tr_b16 v[198:199], v185 offset:768
    s_waitcnt lgkmcnt(2)
    buffer_store_dwordx4 v[192:195], v187, s[16:19], 0 offen sc1
    s_waitcnt lgkmcnt(0)
    buffer_store_dwordx4 v[196:199], v188, s[16:19], 0 offen sc1
    s_add_u32 m0, s92, 36352
    s_nop 0
    s_nop 0
    buffer_load_dwordx4 v73, s[4:7], s99 offen offset:0  lds
    buffer_load_dwordx4 v74, s[4:7], s99 offen offset:1088  lds
    buffer_load_dwordx4 v75, s[4:7], s99 offen offset:2176  lds
    buffer_load_dwordx4 v76, s[4:7], s99 offen offset:3264  lds
    s_add_u32 m0, s93, 53760
    s_add_u32 s99, s99, 256
    s_mov_b64 exec, s[80:81]
    buffer_load_dwordx4 v77, s[4:7], s100 offen  lds
    s_mov_b64 exec, -1
    s_add_u32 s100, s100, 256
    s_add_u32 m0, s92, 55936
    s_nop 0
    s_nop 0
    buffer_load_dwordx4 v73, s[4:7], s99 offen offset:0  lds
    buffer_load_dwordx4 v74, s[4:7], s99 offen offset:1088  lds
    buffer_load_dwordx4 v75, s[4:7], s99 offen offset:2176  lds
    buffer_load_dwordx4 v76, s[4:7], s99 offen offset:3264  lds
    s_add_u32 m0, s93, 73344
    s_add_u32 s99, s99, 256
    s_mov_b64 exec, s[80:81]
    buffer_load_dwordx4 v77, s[4:7], s100 offen  lds
    s_mov_b64 exec, -1
    s_add_u32 s100, s100, 256
    s_add_u32 m0, s92, 75520
    s_nop 0
    s_nop 0
    buffer_load_dwordx4 v73, s[4:7], s99 offen offset:0  lds
    buffer_load_dwordx4 v74, s[4:7], s99 offen offset:1088  lds
    buffer_load_dwordx4 v75, s[4:7], s99 offen offset:2176  lds
    buffer_load_dwordx4 v76, s[4:7], s99 offen offset:3264  lds
    s_add_u32 m0, s93, 92928
    s_add_u32 s99, s99, 256
    s_mov_b64 exec, s[80:81]
    buffer_load_dwordx4 v77, s[4:7], s100 offen  lds
    s_mov_b64 exec, -1
    s_add_u32 s100, s100, 256
    s_add_u32 m0, s92, 95104
    s_nop 0
    s_nop 0
    buffer_load_dwordx4 v73, s[4:7], s99 offen offset:0  lds
    buffer_load_dwordx4 v74, s[4:7], s99 offen offset:1088  lds
    buffer_load_dwordx4 v75, s[4:7], s99 offen offset:2176  lds
    buffer_load_dwordx4 v76, s[4:7], s99 offen offset:3264  lds
    s_add_u32 m0, s93, 112512
    s_add_u32 s99, s99, 256
    s_mov_b64 exec, s[80:81]
    buffer_load_dwordx4 v77, s[4:7], s100 offen  lds
    s_mov_b64 exec, -1
    s_add_u32 s100, s100, 256
    s_add_u32 m0, s92, 114688
    s_nop 0
    s_nop 0
    buffer_load_dwordx4 v73, s[4:7], s99 offen offset:0  lds
    buffer_load_dwordx4 v74, s[4:7], s99 offen offset:1088  lds
    buffer_load_dwordx4 v75, s[4:7], s99 offen offset:2176  lds
    buffer_load_dwordx4 v76, s[4:7], s99 offen offset:3264  lds
    s_add_u32 m0, s93, 132096
    s_add_u32 s99, s99, 256
    s_mov_b64 exec, s[80:81]
    buffer_load_dwordx4 v77, s[4:7], s100 offen  lds
    s_mov_b64 exec, -1
    s_add_u32 s100, s100, 256
    v_mov_b32 v140, 1073741824
    v_lshlrev_b32 v141, 2, v0
    v_cmp_gt_u32 vcc, 64, v0
    s_nop 1
    v_cndmask_b32 v141, v140, v141, vcc
    v_mov_b32_e64 v140, 0
    s_lshl_b32 s97, s2, 8
    s_add_u32 s97, s97, 3473408
    buffer_store_dword v140, v141, s[16:19], s97 offen sc1
    v_mov_b32 v142, 1073741824
    v_lshlrev_b32 v143, 2, v0
    v_cmp_gt_u32 vcc, 16, v0
    s_nop 1
    v_cndmask_b32 v143, v142, v143, vcc
    v_mov_b32_e64 v142, -1
    s_lshl_b32 s97, s2, 6
    s_add_u32 s97, s97, 3457024
    buffer_store_dword v142, v143, s[16:19], s97 offen sc1
    v_mov_b32 v144, -1
    v_mov_b32 v145, -1
    v_mov_b32 v146, -1
    v_mov_b32 v147, -1
    v_lshlrev_b32 v148, 4, v0
    s_sub_u32 s88, s2, 0
    s_mul_i32 s88, s88, 20480
    s_min_u32 s88, s88, 5222400
    s_add_u32 s88, s88, 4194304
    buffer_store_dwordx4 v[144:147], v148, s[16:19], s88 offen sc1
    s_add_u32 s88, s88, 4096
    buffer_store_dwordx4 v[144:147], v148, s[16:19], s88 offen sc1
    s_add_u32 s88, s88, 4096
    buffer_store_dwordx4 v[144:147], v148, s[16:19], s88 offen sc1
    s_add_u32 s88, s88, 4096
    buffer_store_dwordx4 v[144:147], v148, s[16:19], s88 offen sc1
    s_add_u32 s88, s88, 4096
    buffer_store_dwordx4 v[144:147], v148, s[16:19], s88 offen sc1
    v_mov_b32 v134, 0x3f803f80
    v_mov_b32 v132, 0
    v_mov_b32 v133, 0
    s_waitcnt vmcnt(39)
    v_dot2c_f32_bf16 v132, v120, v134
    v_dot2c_f32_bf16 v133, v120, v120
    v_dot2c_f32_bf16 v132, v121, v134
    v_dot2c_f32_bf16 v133, v121, v121
    v_dot2c_f32_bf16 v132, v122, v134
    v_dot2c_f32_bf16 v133, v122, v122
    v_dot2c_f32_bf16 v132, v123, v134
    v_dot2c_f32_bf16 v133, v123, v123
    s_waitcnt vmcnt(38)
    v_dot2c_f32_bf16 v132, v124, v134
    v_dot2c_f32_bf16 v133, v124, v124
    v_dot2c_f32_bf16 v132, v125, v134
    v_dot2c_f32_bf16 v133, v125, v125
    v_dot2c_f32_bf16 v132, v126, v134
    v_dot2c_f32_bf16 v133, v126, v126
    v_dot2c_f32_bf16 v132, v127, v134
    v_dot2c_f32_bf16 v133, v127, v127
    s_waitcnt vmcnt(37)
    v_dot2c_f32_bf16 v132, v128, v134
    v_dot2c_f32_bf16 v133, v128, v128
    v_dot2c_f32_bf16 v132, v129, v134
    v_dot2c_f32_bf16 v133, v129, v129
    v_dot2c_f32_bf16 v132, v130, v134
    v_dot2c_f32_bf16 v133, v130, v130
    v_dot2c_f32_bf16 v132, v131, v134
    v_dot2c_f32_bf16 v133, v131, v131
    v_lshrrev_b32 v135, 5, v0
    v_and_b32 v121, 3, v135
    v_lshrrev_b32 v135, 2, v135
    v_add_f32_dpp v132, v132, v132 row_shr:1 row_mask:0xf bank_mask:0xf bound_ctrl:0
    v_add_f32_dpp v133, v133, v133 row_shr:1 row_mask:0xf bank_mask:0xf bound_ctrl:0
    v_lshlrev_b32_e64 v135, 3, v135
    v_add_f32_dpp v132, v132, v132 row_shr:2 row_mask:0xf bank_mask:0xf bound_ctrl:0
    v_add_f32_dpp v133, v133, v133 row_shr:2 row_mask:0xf bank_mask:0xf bound_ctrl:0
    v_lshl_add_u32 v135, v121, 12, v135
    v_add_f32_dpp v132, v132, v132 row_shr:4 row_mask:0xf bank_mask:0xf bound_ctrl:0
    v_add_f32_dpp v133, v133, v133 row_shr:4 row_mask:0xf bank_mask:0xf bound_ctrl:0
    v_and_b32_e64 v121, 31, v0
    v_add_f32_dpp v132, v132, v132 row_shr:8 row_mask:0xf bank_mask:0xf bound_ctrl:0
    v_add_f32_dpp v133, v133, v133 row_shr:8 row_mask:0xf bank_mask:0xf bound_ctrl:0
    v_cmp_eq_u32_e64 vcc, 31, v121
    v_add_f32_dpp v132, v132, v132 row_bcast:15 row_mask:0xa bank_mask:0xf
    v_add_f32_dpp v133, v133, v133 row_bcast:15 row_mask:0xa bank_mask:0xf
    v_mov_b32 v121, 1073741824
    v_cndmask_b32_e64 v120, v121, v135, vcc
    s_lshl_b32 s96, s2, 4
    s_add_u32 s96, s96, 3440640
    v_mul_f32 v135, 0x3acccccd, v132
    v_mul_f32 v133, 0x3acccccd, v133
    v_fma_f32 v133, -v135, v135, v133
    v_max_f32 v133, 0, v133
    v_add_f32 v133, 0x3727c5ac, v133
    v_rsq_f32_e64 v132, v133
    s_nop 0
    v_mul_f32 v133, -v135, v132
    buffer_store_dwordx2 v[132:133], v120, s[16:19], s96 offen sc1
    s_waitcnt vmcnt(0)
    buffer_load_dword v7, v4, s[16:19], s87 offen offset:0 sc1
    s_waitcnt vmcnt(0)
    v_cmp_gt_u32_e64 vcc, 32, v7
    s_nop 0
    s_and_b64 vcc, vcc, s[50:51]
    s_cbranch_scc1 ps_14
pc_16:
    s_barrier
    buffer_load_dwordx4 a[0:3], v200, s[16:19], s101 offen offset:0 sc1
    buffer_load_dwordx4 a[4:7], v200, s[16:19], s101 offen offset:1024 sc1
    buffer_load_dwordx4 a[8:11], v200, s[16:19], s101 offen offset:2048 sc1
    buffer_load_dwordx4 a[12:15], v200, s[16:19], s101 offen offset:3072 sc1
    s_add_u32 s101, s101, 4096
    buffer_load_dwordx4 a[16:19], v200, s[16:19], s101 offen offset:0 sc1
    buffer_load_dwordx4 a[20:23], v200, s[16:19], s101 offen offset:1024 sc1
    buffer_load_dwordx4 a[24:27], v200, s[16:19], s101 offen offset:2048 sc1
    buffer_load_dwordx4 a[28:31], v200, s[16:19], s101 offen offset:3072 sc1
    s_add_u32 s101, s101, 4096
    buffer_load_dwordx4 a[32:35], v200, s[16:19], s101 offen offset:0 sc1
    buffer_load_dwordx4 a[36:39], v200, s[16:19], s101 offen offset:1024 sc1
    buffer_load_dwordx4 a[40:43], v200, s[16:19], s101 offen offset:2048 sc1
    buffer_load_dwordx4 a[44:47], v200, s[16:19], s101 offen offset:3072 sc1
    s_add_u32 s101, s101, 4096
    buffer_load_dwordx4 a[48:51], v200, s[16:19], s101 offen offset:0 sc1
    buffer_load_dwordx4 a[52:55], v200, s[16:19], s101 offen offset:1024 sc1
ec_3:
    s_mul_i32 s25, s3, 18
    s_lshl_b32 s26, s72, 7
    s_add_u32 s25, s25, s26
    s_add_u32 s25, s25, s71
    s_add_u32 s25, s25, 1008
    s_max_i32 s25, s25, 0
    s_mul_i32 s25, s25, 1280
    v_lshrrev_b32 v206, 1, v0
    v_min_u32 v206, 89, v206
    v_mul_u32_u24 v207, 6554, v206
    v_lshrrev_b32_e64 v207, 16, v207
    v_mul_u32_u24 v207, 1280, v207
    v_lshl_add_u32 v206, v206, 7, v207
    buffer_load_dword v206, v206, s[4:7], s25 offen
    v_add_u32 v196, 36352, v78
    v_mov_b32 v198, v79
    v_xor_b32 v197, 32, v196
    s_barrier
    v_lshlrev_b32 v2, 3, v4
    v_mov_b32_e64 v5, 1
    v_cndmask_b32 v2, v4, v2, s[50:51]
    buffer_atomic_add v5, v2, s[16:19], s86 offen offset:4 sc1
    ds_read_b128 v[160:163], v198 offset:0
    ds_read_b128 v[164:167], v196 offset:0
    ds_read_b128 v[168:171], v196 offset:8704
    ds_read_b128 v[172:175], v198 offset:32
    ds_read_b128 v[176:179], v197 offset:0
    ds_read_b128 v[180:183], v197 offset:8704
    s_waitcnt lgkmcnt(3)
    s_waitcnt vmcnt(15)
    v_mfma_f32_16x16x32_bf16 v[112:115], a[0:3], v[160:163], 0
    ds_read_b128 v[184:187], v198 offset:64
    v_mfma_f32_32x32x16_bf16 v[80:95], a[0:3], v[164:167], 0
    ds_read_b128 v[188:191], v196 offset:64
    v_mov_b32 v208, 0
    v_mov_b32 v209, 0
    v_lshrrev_b32_e64 v210, 5, v0
    v_mul_u32_u24 v210, 1600, v210
    v_mfma_f32_32x32x16_bf16 v[96:111], a[0:3], v[168:171], 0
    ds_read_b128 v[192:195], v196 offset:8768
    buffer_load_dwordx4 a[56:59], v200, s[16:19], s101 offen offset:2048 sc1
    v_and_b32 v211, 31, v0
    v_min_u32 v211, 19, v211
    s_waitcnt lgkmcnt(3)
    s_waitcnt vmcnt(15)
    v_mfma_f32_16x16x32_bf16 v[112:115], a[4:7], v[172:175], v[112:115]
    ds_read_b128 v[160:163], v198 offset:96
    v_mfma_f32_32x32x16_bf16 v[80:95], a[4:7], v[176:179], v[80:95]
    ds_read_b128 v[164:167], v197 offset:64
    v_lshl_add_u32 v210, v211, 3, v210
    v_add_u32 v210, 6400, v210
    ds_write_b64 v210, v[208:209]
    s_mul_i32 s33, s24, 4160
    v_mfma_f32_32x32x16_bf16 v[96:111], a[4:7], v[180:183], v[96:111]
    ds_read_b128 v[168:171], v197 offset:8768
    buffer_load_dwordx4 a[60:63], v200, s[16:19], s101 offen offset:3072 sc1
    s_add_u32 s33, s33, 134272
    v_and_b32_e64 v250, 31, v1
    s_waitcnt lgkmcnt(4)
    s_waitcnt vmcnt(15)
    v_mfma_f32_16x16x32_bf16 v[112:115], a[8:11], v[184:187], v[112:115]
    ds_read_b128 v[172:175], v198 offset:128
    v_mfma_f32_32x32x16_bf16 v[80:95], a[8:11], v[188:191], v[80:95]
    ds_read_b128 v[176:179], v196 offset:128
    v_lshl_add_u32 v250, v250, 4, s33
    v_lshrrev_b32_e64 v253, 5, v1
    v_lshl_add_u32 v251, v253, 3, v250
    v_lshl_add_u32 v252, v253, 9, v250
    v_mfma_f32_32x32x16_bf16 v[96:111], a[8:11], v[192:195], v[96:111]
    ds_read_b128 v[180:183], v196 offset:8832
    s_add_u32 s101, s101, 4096
    buffer_load_dwordx4 a[64:67], v200, s[16:19], s101 offen offset:0 sc1
    v_lshl_add_u32 v250, v253, 10, v250
    s_waitcnt lgkmcnt(3)
    s_waitcnt vmcnt(15)
    v_mfma_f32_16x16x32_bf16 v[112:115], a[12:15], v[160:163], v[112:115]
    ds_read_b128 v[184:187], v198 offset:160
    v_mfma_f32_32x32x16_bf16 v[80:95], a[12:15], v[164:167], v[80:95]
    ds_read_b128 v[188:191], v197 offset:128
    v_cmp_eq_u32 vcc, 0, v1
    v_lshlrev_b32 v254, 16, v241
    v_min_u32 v253, 15, v1
    v_cndmask_b32 v254, 0, v254, vcc
    v_mfma_f32_32x32x16_bf16 v[96:111], a[12:15], v[168:171], v[96:111]
    ds_read_b128 v[192:195], v197 offset:8832
    buffer_load_dwordx4 a[68:71], v200, s[16:19], s101 offen offset:1024 sc1
    v_lshl_add_u32 v253, v253, 2, s33
    v_add_f32_e64 v216, v216, v254
    s_waitcnt lgkmcnt(3)
    s_waitcnt vmcnt(15)
    v_mfma_f32_16x16x32_bf16 v[112:115], a[16:19], v[172:175], v[112:115]
    ds_read_b128 v[160:163], v198 offset:192
    v_mfma_f32_32x32x16_bf16 v[80:95], a[16:19], v[176:179], v[80:95]
    ds_read_b128 v[164:167], v196 offset:192
    v_and_b32 v254, 1, v1
    v_cmp_eq_u32 vcc, 1, v254
    v_mov_b32_e64 v254, 0
    v_cvt_pk_bf16_f32 v242, v216, v217
    v_mfma_f32_32x32x16_bf16 v[96:111], a[16:19], v[180:183], v[96:111]
    ds_read_b128 v[168:171], v196 offset:8896
    buffer_load_dwordx4 a[72:75], v200, s[16:19], s101 offen offset:2048 sc1
    v_cvt_pk_bf16_f32 v243, v218, v219
    v_cvt_pk_bf16_f32 v244, v220, v220
    s_waitcnt lgkmcnt(3)
    s_waitcnt vmcnt(15)
    v_mfma_f32_16x16x32_bf16 v[112:115], a[20:23], v[184:187], v[112:115]
    ds_read_b128 v[172:175], v198 offset:224
    v_mfma_f32_32x32x16_bf16 v[80:95], a[20:23], v[188:191], v[80:95]
    ds_read_b128 v[176:179], v197 offset:192
    v_cvt_pk_bf16_f32 v245, v221, v222
    v_cvt_pk_bf16_f32 v246, v224, v224
    v_cvt_pk_bf16_f32 v247, v224, v225
    v_cvt_pk_bf16_f32 v248, v225, v225
    v_mfma_f32_32x32x16_bf16 v[96:111], a[20:23], v[192:195], v[96:111]
    ds_read_b128 v[180:183], v197 offset:8896
    buffer_load_dwordx4 a[76:79], v200, s[16:19], s101 offen offset:3072 sc1
    v_cvt_pk_bf16_f32 v249, v226, v226
    ds_write_b32 v253, v254
    s_barrier
    s_waitcnt lgkmcnt(4)
    s_waitcnt vmcnt(15)
    v_mfma_f32_16x16x32_bf16 v[112:115], a[24:27], v[160:163], v[112:115]
    v_add_u32 v198, v49, v198
    v_mfma_f32_32x32x16_bf16 v[80:95], a[24:27], v[164:167], v[80:95]
    v_add_u32 v196, 19584, v196
    v_add_u32 v197, 19584, v197
    ds_read_b128 v[184:187], v198 offset:0
    ds_write_b64 v251, v[242:243] offset:64
    ds_write_b64 v251, v[244:245] offset:576
    v_mfma_f32_32x32x16_bf16 v[96:111], a[24:27], v[168:171], v[96:111]
    ds_read_b128 v[188:191], v196 offset:0
    ds_read_b128 v[192:195], v196 offset:8704
    s_add_u32 s101, s101, 4096
    buffer_load_dwordx4 a[80:83], v200, s[16:19], s101 offen offset:0 sc1
    s_waitcnt lgkmcnt(6)
    s_waitcnt vmcnt(15)
    v_mfma_f32_16x16x32_bf16 v[112:115], a[28:31], v[172:175], v[112:115]
    ds_read_b128 v[160:163], v198 offset:32
    v_mfma_f32_32x32x16_bf16 v[80:95], a[28:31], v[176:179], v[80:95]
    ds_read_b128 v[164:167], v197 offset:0
    ds_write_b128 v252, v[246:249] offset:1088
    v_cndmask_b32 v255, v228, v229, vcc
    v_cvt_pk_bf16_f32 v216, v228, v228
    v_mov_b32 v217, v216
    v_mfma_f32_32x32x16_bf16 v[96:111], a[28:31], v[180:183], v[96:111]
    ds_read_b128 v[168:171], v197 offset:8704
    buffer_load_dwordx4 a[84:87], v200, s[16:19], s101 offen offset:1024 sc1
    v_cvt_pk_bf16_f32 v218, v255, v229
    v_cvt_pk_bf16_f32 v219, v229, v229
    s_waitcnt lgkmcnt(4)
    s_waitcnt vmcnt(15)
    v_mfma_f32_16x16x32_bf16 v[112:115], a[32:35], v[184:187], v[112:115]
    ds_read_b128 v[172:175], v198 offset:64
    v_mfma_f32_32x32x16_bf16 v[80:95], a[32:35], v[188:191], v[80:95]
    ds_read_b128 v[176:179], v196 offset:64
    ds_write_b128 v250, v[216:219] offset:2112
    v_cndmask_b32 v255, v230, v231, vcc
    v_cvt_pk_bf16_f32 v220, v230, v230
    v_mov_b32 v221, v220
    v_mfma_f32_32x32x16_bf16 v[96:111], a[32:35], v[192:195], v[96:111]
    ds_read_b128 v[180:183], v196 offset:8768
    buffer_load_dwordx4 a[88:91], v200, s[16:19], s101 offen offset:2048 sc1
    v_cvt_pk_bf16_f32 v222, v255, v231
    v_cvt_pk_bf16_f32 v223, v231, v231
    s_waitcnt lgkmcnt(4)
    s_waitcnt vmcnt(15)
    v_mfma_f32_16x16x32_bf16 v[112:115], a[36:39], v[160:163], v[112:115]
    ds_read_b128 v[184:187], v198 offset:96
    v_mfma_f32_32x32x16_bf16 v[80:95], a[36:39], v[164:167], v[80:95]
    ds_read_b128 v[188:191], v197 offset:64
    ds_write_b128 v250, v[220:223] offset:2624
    v_mfma_f32_32x32x16_bf16 v[96:111], a[36:39], v[168:171], v[96:111]
    ds_read_b128 v[192:195], v197 offset:8768
    buffer_load_dwordx4 a[92:95], v200, s[16:19], s101 offen offset:3072 sc1
    s_waitcnt lgkmcnt(4)
    s_waitcnt vmcnt(15)
    v_mfma_f32_16x16x32_bf16 v[112:115], a[40:43], v[172:175], v[112:115]
    ds_read_b128 v[160:163], v198 offset:128
    v_mfma_f32_32x32x16_bf16 v[80:95], a[40:43], v[176:179], v[80:95]
    ds_read_b128 v[164:167], v196 offset:128
    v_mfma_f32_32x32x16_bf16 v[96:111], a[40:43], v[180:183], v[96:111]
    ds_read_b128 v[168:171], v196 offset:8832
    s_add_u32 s101, s101, 4096
    buffer_load_dwordx4 a[96:99], v200, s[16:19], s101 offen offset:0 sc1
    s_waitcnt lgkmcnt(3)
    s_waitcnt vmcnt(15)
    v_mfma_f32_16x16x32_bf16 v[112:115], a[44:47], v[184:187], v[112:115]
    ds_read_b128 v[172:175], v198 offset:160
    v_mfma_f32_32x32x16_bf16 v[80:95], a[44:47], v[188:191], v[80:95]
    ds_read_b128 v[176:179], v197 offset:128
    v_mfma_f32_32x32x16_bf16 v[96:111], a[44:47], v[192:195], v[96:111]
    ds_read_b128 v[180:183], v197 offset:8832
    buffer_load_dwordx4 a[100:103], v200, s[16:19], s101 offen offset:1024 sc1
    s_waitcnt lgkmcnt(3)
    s_waitcnt vmcnt(15)
    v_mfma_f32_16x16x32_bf16 v[112:115], a[48:51], v[160:163], v[112:115]
    ds_read_b128 v[184:187], v198 offset:192
    v_mfma_f32_32x32x16_bf16 v[80:95], a[48:51], v[164:167], v[80:95]
    ds_read_b128 v[188:191], v196 offset:192
    v_mfma_f32_32x32x16_bf16 v[96:111], a[48:51], v[168:171], v[96:111]
    ds_read_b128 v[192:195], v196 offset:8896
    buffer_load_dwordx4 a[104:107], v200, s[16:19], s101 offen offset:2048 sc1
    s_waitcnt lgkmcnt(3)
    s_waitcnt vmcnt(15)
    v_mfma_f32_16x16x32_bf16 v[112:115], a[52:55], v[172:175], v[112:115]
    ds_read_b128 v[160:163], v198 offset:224
    v_mfma_f32_32x32x16_bf16 v[80:95], a[52:55], v[176:179], v[80:95]
    ds_read_b128 v[164:167], v197 offset:192
    v_mfma_f32_32x32x16_bf16 v[96:111], a[52:55], v[180:183], v[96:111]
    ds_read_b128 v[168:171], v197 offset:8896
    buffer_load_dwordx4 a[108:111], v200, s[16:19], s101 offen offset:3072 sc1
    s_barrier
    s_waitcnt lgkmcnt(3)
    s_waitcnt vmcnt(13)
    v_mfma_f32_16x16x32_bf16 v[112:115], a[56:59], v[184:187], v[112:115]
    v_add_u32 v198, v49, v198
    v_mfma_f32_32x32x16_bf16 v[80:95], a[56:59], v[188:191], v[80:95]
    v_add_u32 v196, 19584, v196
    v_add_u32 v197, 19584, v197
    ds_read_b128 v[172:175], v198 offset:0
    v_mfma_f32_32x32x16_bf16 v[96:111], a[56:59], v[192:195], v[96:111]
    ds_read_b128 v[176:179], v196 offset:0
    ds_read_b128 v[180:183], v196 offset:8704
    s_add_u32 s101, s101, 4096
    buffer_load_dwordx4 a[112:115], v200, s[16:19], s101 offen offset:0 sc1
    s_waitcnt lgkmcnt(3)
    s_waitcnt vmcnt(13)
    v_mfma_f32_16x16x32_bf16 v[112:115], a[60:63], v[160:163], v[112:115]
    ds_read_b128 v[184:187], v198 offset:32
    v_mfma_f32_32x32x16_bf16 v[80:95], a[60:63], v[164:167], v[80:95]
    ds_read_b128 v[188:191], v197 offset:0
    v_mfma_f32_32x32x16_bf16 v[96:111], a[60:63], v[168:171], v[96:111]
    ds_read_b128 v[192:195], v197 offset:8704
    buffer_load_dwordx4 a[116:119], v200, s[16:19], s101 offen offset:1024 sc1
    s_waitcnt lgkmcnt(3)
    s_waitcnt vmcnt(13)
    v_mfma_f32_16x16x32_bf16 v[112:115], a[64:67], v[172:175], v[112:115]
    ds_read_b128 v[160:163], v198 offset:64
    v_mfma_f32_32x32x16_bf16 v[80:95], a[64:67], v[176:179], v[80:95]
    ds_read_b128 v[164:167], v196 offset:64
    v_mfma_f32_32x32x16_bf16 v[96:111], a[64:67], v[180:183], v[96:111]
    ds_read_b128 v[168:171], v196 offset:8768
    buffer_load_dwordx4 a[120:123], v200, s[16:19], s101 offen offset:2048 sc1
    s_waitcnt lgkmcnt(3)
    s_waitcnt vmcnt(13)
    v_mfma_f32_16x16x32_bf16 v[112:115], a[68:71], v[184:187], v[112:115]
    ds_read_b128 v[172:175], v198 offset:96
    v_mfma_f32_32x32x16_bf16 v[80:95], a[68:71], v[188:191], v[80:95]
    ds_read_b128 v[176:179], v197 offset:64
    v_mfma_f32_32x32x16_bf16 v[96:111], a[68:71], v[192:195], v[96:111]
    ds_read_b128 v[180:183], v197 offset:8768
    buffer_load_dwordx4 a[124:127], v200, s[16:19], s101 offen offset:3072 sc1
    s_waitcnt lgkmcnt(3)
    s_waitcnt vmcnt(13)
    v_mfma_f32_16x16x32_bf16 v[112:115], a[72:75], v[160:163], v[112:115]
    ds_read_b128 v[184:187], v198 offset:128
    v_mfma_f32_32x32x16_bf16 v[80:95], a[72:75], v[164:167], v[80:95]
    ds_read_b128 v[188:191], v196 offset:128
    v_mfma_f32_32x32x16_bf16 v[96:111], a[72:75], v[168:171], v[96:111]
    ds_read_b128 v[192:195], v196 offset:8832
    s_add_u32 s101, s101, 4096
    buffer_load_dwordx4 a[128:131], v200, s[16:19], s101 offen offset:0 sc1
    s_waitcnt lgkmcnt(3)
    s_waitcnt vmcnt(13)
    v_mfma_f32_16x16x32_bf16 v[112:115], a[76:79], v[172:175], v[112:115]
    ds_read_b128 v[160:163], v198 offset:160
    v_mfma_f32_32x32x16_bf16 v[80:95], a[76:79], v[176:179], v[80:95]
    ds_read_b128 v[164:167], v197 offset:128
    v_mfma_f32_32x32x16_bf16 v[96:111], a[76:79], v[180:183], v[96:111]
    ds_read_b128 v[168:171], v197 offset:8832
    buffer_load_dwordx4 a[132:135], v200, s[16:19], s101 offen offset:1024 sc1
    s_waitcnt lgkmcnt(3)
    s_waitcnt vmcnt(13)
    v_mfma_f32_16x16x32_bf16 v[112:115], a[80:83], v[184:187], v[112:115]
    ds_read_b128 v[172:175], v198 offset:192
    v_mfma_f32_32x32x16_bf16 v[80:95], a[80:83], v[188:191], v[80:95]
    ds_read_b128 v[176:179], v196 offset:192
    v_mfma_f32_32x32x16_bf16 v[96:111], a[80:83], v[192:195], v[96:111]
    ds_read_b128 v[180:183], v196 offset:8896
    buffer_load_dwordx4 a[136:139], v200, s[16:19], s101 offen offset:2048 sc1
    s_waitcnt lgkmcnt(3)
    s_waitcnt vmcnt(13)
    v_mfma_f32_16x16x32_bf16 v[112:115], a[84:87], v[160:163], v[112:115]
    ds_read_b128 v[184:187], v198 offset:224
    v_mfma_f32_32x32x16_bf16 v[80:95], a[84:87], v[164:167], v[80:95]
    ds_read_b128 v[188:191], v197 offset:192
    v_mfma_f32_32x32x16_bf16 v[96:111], a[84:87], v[168:171], v[96:111]
    ds_read_b128 v[192:195], v197 offset:8896
    buffer_load_dwordx4 a[140:143], v200, s[16:19], s101 offen offset:3072 sc1
    s_barrier
    s_waitcnt lgkmcnt(3)
    s_waitcnt vmcnt(13)
    v_mfma_f32_16x16x32_bf16 v[112:115], a[88:91], v[172:175], v[112:115]
    v_add_u32 v198, v49, v198
    v_mfma_f32_32x32x16_bf16 v[80:95], a[88:91], v[176:179], v[80:95]
    v_add_u32 v196, 19584, v196
    v_add_u32 v197, 19584, v197
    ds_read_b128 v[160:163], v198 offset:0
    v_mfma_f32_32x32x16_bf16 v[96:111], a[88:91], v[180:183], v[96:111]
    ds_read_b128 v[164:167], v196 offset:0
    ds_read_b128 v[168:171], v196 offset:8704
    s_add_u32 s101, s101, 4096
    buffer_load_dword v7, v4, s[16:19], s87 offen offset:4 sc1
    s_waitcnt lgkmcnt(3)
    s_waitcnt vmcnt(13)
    v_mfma_f32_16x16x32_bf16 v[112:115], a[92:95], v[184:187], v[112:115]
    ds_read_b128 v[172:175], v198 offset:32
    v_mfma_f32_32x32x16_bf16 v[80:95], a[92:95], v[188:191], v[80:95]
    ds_read_b128 v[176:179], v197 offset:0
    v_mfma_f32_32x32x16_bf16 v[96:111], a[92:95], v[192:195], v[96:111]
    ds_read_b128 v[180:183], v197 offset:8704
    buffer_load_dwordx4 a[144:147], v200, s[16:19], s101 offen offset:0 sc1
    s_waitcnt lgkmcnt(3)
    s_waitcnt vmcnt(13)
    v_mfma_f32_16x16x32_bf16 v[112:115], a[96:99], v[160:163], v[112:115]
    ds_read_b128 v[184:187], v198 offset:64
    v_mfma_f32_32x32x16_bf16 v[80:95], a[96:99], v[164:167], v[80:95]
    ds_read_b128 v[188:191], v196 offset:64
    v_mfma_f32_32x32x16_bf16 v[96:111], a[96:99], v[168:171], v[96:111]
    ds_read_b128 v[192:195], v196 offset:8768
    buffer_load_dwordx4 a[148:151], v200, s[16:19], s101 offen offset:1024 sc1
    s_waitcnt lgkmcnt(3)
    s_waitcnt vmcnt(13)
    v_mfma_f32_16x16x32_bf16 v[112:115], a[100:103], v[172:175], v[112:115]
    ds_read_b128 v[160:163], v198 offset:96
    v_mfma_f32_32x32x16_bf16 v[80:95], a[100:103], v[176:179], v[80:95]
    ds_read_b128 v[164:167], v197 offset:64
    v_mfma_f32_32x32x16_bf16 v[96:111], a[100:103], v[180:183], v[96:111]
    ds_read_b128 v[168:171], v197 offset:8768
    buffer_load_dwordx4 a[152:155], v200, s[16:19], s101 offen offset:2048 sc1
    s_waitcnt lgkmcnt(3)
    s_waitcnt vmcnt(13)
    v_mfma_f32_16x16x32_bf16 v[112:115], a[104:107], v[184:187], v[112:115]
    ds_read_b128 v[172:175], v198 offset:128
    v_mfma_f32_32x32x16_bf16 v[80:95], a[104:107], v[188:191], v[80:95]
    ds_read_b128 v[176:179], v196 offset:128
    v_mfma_f32_32x32x16_bf16 v[96:111], a[104:107], v[192:195], v[96:111]
    ds_read_b128 v[180:183], v196 offset:8832
    buffer_load_dwordx4 a[156:159], v200, s[16:19], s101 offen offset:3072 sc1
    s_waitcnt lgkmcnt(3)
    s_waitcnt vmcnt(13)
    v_mfma_f32_16x16x32_bf16 v[112:115], a[108:111], v[160:163], v[112:115]
    ds_read_b128 v[184:187], v198 offset:160
    v_mfma_f32_32x32x16_bf16 v[80:95], a[108:111], v[164:167], v[80:95]
    ds_read_b128 v[188:191], v197 offset:128
    v_mfma_f32_32x32x16_bf16 v[96:111], a[108:111], v[168:171], v[96:111]
    ds_read_b128 v[192:195], v197 offset:8832
    s_add_u32 s101, s101, 4096
    s_lshl_b32 s25, s72, 5
    s_add_u32 s25, s25, 256
    s_sub_u32 s26, s25, 4
    s_max_i32 s26, s26, 0
    s_mul_i32 s27, s71, 1280
    s_mul_i32 s99, s25, 5120
    s_mul_i32 s100, s26, 5120
    s_mul_i32 s92, s24, 4352
    s_mul_i32 s93, s24, 544
    s_add_u32 s99, s99, s27
    s_add_u32 s100, s100, s27
    s_waitcnt lgkmcnt(3)
    s_waitcnt vmcnt(12)
    v_mfma_f32_16x16x32_bf16 v[112:115], a[112:115], v[172:175], v[112:115]
    ds_read_b128 v[160:163], v198 offset:192
    v_mfma_f32_32x32x16_bf16 v[80:95], a[112:115], v[176:179], v[80:95]
    ds_read_b128 v[164:167], v196 offset:192
    v_mfma_f32_32x32x16_bf16 v[96:111], a[112:115], v[180:183], v[96:111]
    ds_read_b128 v[168:171], v196 offset:8896
    s_waitcnt lgkmcnt(3)
    s_waitcnt vmcnt(11)
    v_mfma_f32_16x16x32_bf16 v[112:115], a[116:119], v[184:187], v[112:115]
    ds_read_b128 v[172:175], v198 offset:224
    v_mfma_f32_32x32x16_bf16 v[80:95], a[116:119], v[188:191], v[80:95]
    ds_read_b128 v[176:179], v197 offset:192
    v_mfma_f32_32x32x16_bf16 v[96:111], a[116:119], v[192:195], v[96:111]
    ds_read_b128 v[180:183], v197 offset:8896
    s_waitcnt vmcnt(4)
    v_cmp_gt_u32 vcc, 32, v7
    s_nop 0
    s_and_b64 vcc, vcc, s[50:51]
    s_cbranch_scc1 ps_17
pc_19:
    s_barrier
    s_waitcnt lgkmcnt(3)
    v_mfma_f32_16x16x32_bf16 v[112:115], a[120:123], v[160:163], v[112:115]
    v_add_u32_e64 v198, v49, v198
    v_mfma_f32_32x32x16_bf16 v[80:95], a[120:123], v[164:167], v[80:95]
    v_add_u32 v196, 19584, v196
    v_add_u32 v197, 19584, v197
    s_lshl_b32 s31, s24, 7
    s_add_u32 s31, s31, 159744
    v_bfe_u32 v132, v1, 3, 1
    v_mfma_f32_32x32x16_bf16 v[96:111], a[120:123], v[168:171], v[96:111]
    ds_read_b128 v[184:187], v198 offset:0
    ds_read_b128 v[188:191], v196 offset:0
    s_lshl_b32 s98, s72, 5
    s_add_u32 s98, s98, 0
    s_sub_u32 s95, s98, 4
    s_max_i32 s95, s95, 0
    s_lshl_b32 s94, s98, 3
    s_lshl_b32 s95, s95, 3
    s_add_u32 s94, s94, 3440640
    s_add_u32 s95, s95, 3440640
    s_add_u32 s96, s94, 8192
    buffer_load_dwordx2 v[152:153], v47, s[16:19], s94 offen sc1
    v_lshrrev_b32 v133, 4, v1
    v_lshl_add_u32 v132, v132, 2, v133
    s_waitcnt lgkmcnt(2)
    v_mfma_f32_16x16x32_bf16 v[112:115], a[124:127], v[172:175], v[112:115]
    ds_read_b128 v[192:195], v198 offset:32
    v_mfma_f32_32x32x16_bf16 v[80:95], a[124:127], v[176:179], v[80:95]
    ds_read_b128 v[160:163], v197 offset:0
    v_lshl_add_u32 v132, v132, 4, s31
    v_lshrrev_b32 v133, 5, v1
    v_lshl_add_u32 v133, v133, 4, s31
    v_mfma_f32_32x32x16_bf16 v[96:111], a[124:127], v[180:183], v[96:111]
    buffer_load_dwordx2 v[154:155], v47, s[16:19], s96 offen sc1
    s_waitcnt lgkmcnt(2)
    v_mfma_f32_16x16x32_bf16 v[112:115], a[128:131], v[184:187], v[112:115]
    ds_read_b128 v[164:167], v198 offset:64
    v_mfma_f32_32x32x16_bf16 v[80:95], a[128:131], v[188:191], v[80:95]
    ds_read_b128 v[168:171], v196 offset:64
    s_waitcnt lgkmcnt(2)
    v_mfma_f32_16x16x32_bf16 v[112:115], a[132:135], v[192:195], v[112:115]
    ds_read_b128 v[172:175], v198 offset:96
    v_mfma_f32_32x32x16_bf16 v[80:95], a[132:135], v[160:163], v[80:95]
    ds_read_b128 v[176:179], v197 offset:64
    buffer_load_dwordx2 v[156:157], v48, s[16:19], s95 offen sc1
    s_waitcnt lgkmcnt(2)
    v_mfma_f32_16x16x32_bf16 v[112:115], a[136:139], v[164:167], v[112:115]
    ds_read_b128 v[180:183], v198 offset:128
    v_mfma_f32_32x32x16_bf16 v[80:95], a[136:139], v[168:171], v[80:95]
    ds_read_b128 v[184:187], v196 offset:128
    s_waitcnt lgkmcnt(2)
    v_mfma_f32_16x16x32_bf16 v[112:115], a[140:143], v[172:175], v[112:115]
    ds_read_b128 v[188:191], v198 offset:160
    v_mfma_f32_32x32x16_bf16 v[80:95], a[140:143], v[176:179], v[80:95]
    ds_read_b128 v[192:195], v197 offset:128
    s_add_u32 m0, s92, 36352
    s_nop 0
    buffer_load_dwordx4 v73, s[4:7], s99 offen offset:0  lds
    s_waitcnt lgkmcnt(2)
    s_waitcnt vmcnt(7)
    v_mfma_f32_16x16x32_bf16 v[112:115], a[144:147], v[180:183], v[112:115]
    ds_read_b128 v[160:163], v198 offset:192
    v_mfma_f32_32x32x16_bf16 v[80:95], a[144:147], v[184:187], v[80:95]
    ds_read_b128 v[164:167], v196 offset:192
    s_waitcnt lgkmcnt(2)
    s_waitcnt vmcnt(6)
    v_mfma_f32_16x16x32_bf16 v[112:115], a[148:151], v[188:191], v[112:115]
    ds_read_b128 v[168:171], v198 offset:224
    v_mfma_f32_32x32x16_bf16 v[80:95], a[148:151], v[192:195], v[80:95]
    ds_read_b128 v[172:175], v197 offset:192
    buffer_load_dwordx4 v74, s[4:7], s99 offen offset:1088  lds
    s_waitcnt lgkmcnt(2)
    s_waitcnt vmcnt(6)
    v_mfma_f32_16x16x32_bf16 v[112:115], a[152:155], v[160:163], v[112:115]
    ds_read_b128 v[176:179], v196 offset:8704
    v_mfma_f32_32x32x16_bf16 v[80:95], a[152:155], v[164:167], v[80:95]
    ds_read_b128 v[180:183], v197 offset:8704
    s_waitcnt lgkmcnt(2)
    s_waitcnt vmcnt(5)
    v_mfma_f32_16x16x32_bf16 v[112:115], a[156:159], v[168:171], v[112:115]
    ds_read_b128 v[184:187], v196 offset:8768
    v_mfma_f32_32x32x16_bf16 v[80:95], a[156:159], v[172:175], v[80:95]
    ds_read_b128 v[188:191], v197 offset:8768
    buffer_load_dwordx4 v75, s[4:7], s99 offen offset:2176  lds
    s_waitcnt lgkmcnt(2)
    v_mfma_f32_32x32x16_bf16 v[96:111], a[128:131], v[176:179], v[96:111]
    ds_read_b128 v[192:195], v196 offset:8832
    v_mfma_f32_32x32x16_bf16 v[96:111], a[132:135], v[180:183], v[96:111]
    ds_read_b128 v[160:163], v197 offset:8832
    buffer_load_dwordx4 v76, s[4:7], s99 offen offset:3264  lds
    s_mov_b32 exec_lo, 0x01010101
    s_mov_b32 exec_hi, 0x01010101
    ds_write_b128 v132, v[112:115]
    s_mov_b64 exec, -1
    s_waitcnt lgkmcnt(3)
    v_mfma_f32_32x32x16_bf16 v[96:111], a[136:139], v[184:187], v[96:111]
    ds_read_b128 v[164:167], v196 offset:8896
    ds_read_b128 v[24:27], v132
    ds_read_b128 v[8:11], v133 offset:0
    ds_read_b128 v[12:15], v133 offset:32
    ds_read_b128 v[16:19], v133 offset:64
    v_mfma_f32_32x32x16_bf16 v[96:111], a[140:143], v[188:191], v[96:111]
    ds_read_b128 v[168:171], v197 offset:8896
    s_add_u32 m0, s93, 53760
    s_add_u32 s99, s99, 256
    s_mov_b64 exec, s[80:81]
    buffer_load_dwordx4 v77, s[4:7], s100 offen  lds
    s_mov_b64 exec, -1
    s_add_u32 s100, s100, 256
    ds_read_b128 v[20:23], v133 offset:96
    s_waitcnt vmcnt(5) lgkmcnt(5)
    v_mul_f32 v148, v24, v157
    v_mfma_f32_32x32x16_bf16 v[96:111], a[144:147], v[192:195], v[96:111]
    v_mul_f32 v149, v25, v157
    v_mul_f32 v150, v26, v157
    v_mul_f32 v151, v27, v157
    s_waitcnt lgkmcnt(4)
    v_mul_f32 v116, v8, v153
    v_mul_f32 v117, v9, v153
    v_mfma_f32_32x32x16_bf16 v[96:111], a[148:151], v[160:163], v[96:111]
    v_mul_f32 v118, v10, v153
    v_mul_f32 v119, v11, v153
    s_waitcnt lgkmcnt(3)
    v_mul_f32 v120, v12, v153
    v_mul_f32 v121, v13, v153
    s_waitcnt lgkmcnt(1)
    v_mfma_f32_32x32x16_bf16 v[96:111], a[152:155], v[164:167], v[96:111]
    v_mul_f32 v122, v14, v153
    v_mul_f32 v123, v15, v153
    v_mul_f32 v124, v16, v153
    v_mul_f32 v125, v17, v153
    v_mul_f32_e64 v126, v18, v153
    v_mfma_f32_32x32x16_bf16 v[96:111], a[156:159], v[168:171], v[96:111]
    s_add_u32 m0, s92, 55936
    s_nop 0
    buffer_load_dwordx4 v73, s[4:7], s99 offen offset:0  lds
    v_mul_f32 v127, v19, v153
    s_waitcnt lgkmcnt(0)
    v_mul_f32 v128, v20, v153
    v_mul_f32 v129, v21, v153
    v_mul_f32 v130, v22, v153
    v_mul_f32_e64 v131, v23, v153
    v_fma_f32 v112, v112, v156, v148
    v_fma_f32 v113, v113, v156, v149
    v_fma_f32 v114, v114, v156, v150
    v_fma_f32 v115, v115, v156, v151
    v_cvt_pk_bf16_f32 v112, v112, v113
    v_cvt_pk_bf16_f32 v113, v114, v115
    v_fma_f32 v80, v80, v152, v116
    v_fma_f32 v81, v81, v152, v117
    v_fma_f32 v82, v82, v152, v118
    v_fma_f32 v83, v83, v152, v119
    v_cvt_pk_bf16_f32 v80, v80, v81
    v_cvt_pk_bf16_f32 v81, v82, v83
    ds_write_b64 v40, v[112:113] offset:0
    ds_write_b64 v38, v[80:81] offset:0
    v_fma_f32 v84, v84, v152, v120
    v_fma_f32 v85, v85, v152, v121
    v_fma_f32 v86, v86, v152, v122
    v_fma_f32 v87, v87, v152, v123
    v_cvt_pk_bf16_f32 v84, v84, v85
    v_cvt_pk_bf16_f32 v85, v86, v87
    v_fma_f32 v88, v88, v152, v124
    v_fma_f32 v89, v89, v152, v125
    v_fma_f32 v90, v90, v152, v126
    v_fma_f32 v91, v91, v152, v127
    v_cvt_pk_bf16_f32 v88, v88, v89
    v_cvt_pk_bf16_f32 v89, v90, v91
    ds_write_b64 v38, v[84:85] offset:6400
    ds_write_b64 v38, v[88:89] offset:12800
    v_fma_f32 v92, v92, v152, v128
    v_fma_f32 v93, v93, v152, v129
    v_fma_f32 v94, v94, v152, v130
    v_fma_f32 v95, v95, v152, v131
    v_cvt_pk_bf16_f32 v92, v92, v93
    v_cvt_pk_bf16_f32 v93, v94, v95
    ds_write_b64 v39, v[92:93] offset:0
    v_mul_f32 v132, v8, v155
    v_mul_f32 v133, v9, v155
    v_mul_f32 v134, v10, v155
    v_mul_f32 v135, v11, v155
    v_mul_f32 v136, v12, v155
    v_mul_f32 v137, v13, v155
    v_mul_f32 v138, v14, v155
    v_mul_f32 v139, v15, v155
    v_mul_f32 v140, v16, v155
    v_mul_f32 v141, v17, v155
    v_mul_f32 v142, v18, v155
    v_mul_f32 v143, v19, v155
    v_mul_f32 v144, v20, v155
    v_mul_f32 v145, v21, v155
    v_mul_f32 v146, v22, v155
    v_mul_f32 v147, v23, v155
    v_pk_fma_f32 v[96:97], v[96:97], v[154:155], v[132:133] op_sel_hi:[1,0,1]
    v_pk_fma_f32 v[98:99], v[98:99], v[154:155], v[134:135] op_sel_hi:[1,0,1]
    v_cvt_pk_bf16_f32 v96, v96, v97
    v_cvt_pk_bf16_f32 v97, v98, v99
    v_pk_fma_f32 v[100:101], v[100:101], v[154:155], v[136:137] op_sel_hi:[1,0,1]
    v_pk_fma_f32 v[102:103], v[102:103], v[154:155], v[138:139] op_sel_hi:[1,0,1]
    v_cvt_pk_bf16_f32 v100, v100, v101
    v_cvt_pk_bf16_f32 v101, v102, v103
    ds_write_b64 v38, v[96:97] offset:1600
    ds_write_b64 v38, v[100:101] offset:8000
    v_pk_fma_f32 v[104:105], v[104:105], v[154:155], v[140:141] op_sel_hi:[1,0,1]
    v_pk_fma_f32 v[106:107], v[106:107], v[154:155], v[142:143] op_sel_hi:[1,0,1]
    v_cvt_pk_bf16_f32 v104, v104, v105
    v_cvt_pk_bf16_f32 v105, v106, v107
    v_pk_fma_f32 v[108:109], v[108:109], v[154:155], v[144:145] op_sel_hi:[1,0,1]
    v_pk_fma_f32 v[110:111], v[110:111], v[154:155], v[146:147] op_sel_hi:[1,0,1]
    v_cvt_pk_bf16_f32 v108, v108, v109
    v_cvt_pk_bf16_f32 v109, v110, v111
    ds_write_b64 v38, v[104:105] offset:14400
    ds_write_b64 v39, v[108:109] offset:1600
    s_waitcnt lgkmcnt(0)
    s_barrier
    v_mov_b32 v94, 0
    v_mov_b32 v95, 0
    v_mov_b32 v98, 0
    v_mov_b32 v99, 0
    s_mov_b64 exec, 0xffff
    ds_read_b64 v[94:95], v42 offset:320
    ds_read_b64 v[98:99], v42 offset:640
    s_mov_b64 exec, -1
    s_nop 0
    ds_read_b64 v[92:93], v41 offset:320
    ds_read_b64 v[96:97], v41 offset:640
    ds_read_b64 v[84:85], v41 offset:6720
    ds_read_b64 v[86:87], v42 offset:6720
    ds_read_b64 v[80:81], v41 offset:6400
    ds_read_b64 v[82:83], v42 offset:6400
    ds_read_b64 v[88:89], v41 offset:7040
    ds_read_b64 v[90:91], v42 offset:7040
    ds_read_b64_tr_b16 v[106:107], v44 offset:0
    ds_read_b64_tr_b16 v[100:101], v43 offset:0
    ds_read_b64_tr_b16 v[108:109], v44 offset:320
    ds_read_b64_tr_b16 v[102:103], v43 offset:320
    buffer_load_dwordx4 v74, s[4:7], s99 offen offset:1088  lds
    ds_read_b64_tr_b16 v[110:111], v44 offset:640
    ds_read_b64_tr_b16 v[104:105], v43 offset:640
    v_mov_b32 v156, 0xf149f2ca
    v_cndmask_b32 v152, v32, v156, s[90:91]
    v_cndmask_b32 v153, v33, v156, s[90:91]
    v_cndmask_b32 v154, v34, v156, s[90:91]
    v_cndmask_b32 v155, v35, v156, s[90:91]
    s_mov_b32 s82, 0x3ea52b5c
    buffer_load_dwordx4 v75, s[4:7], s99 offen offset:2176  lds
    s_lshl_b32 s25, s98, 4
    s_add_u32 s25, s25, 4194304
    s_lshl_b32 s26, s98, 3
    s_add_u32 s26, s26, 4194304
    s_waitcnt lgkmcnt(10)
    v_mfma_f32_16x16x32_bf16 v[116:119], v[84:87], v[92:95], v[28:31]
    v_mfma_f32_16x16x32_bf16 v[120:123], v[84:87], v[96:99], v[32:35]
    s_waitcnt lgkmcnt(8)
    v_mfma_f32_16x16x32_bf16 v[112:115], v[80:83], v[92:95], v[152:155]
    s_waitcnt lgkmcnt(6)
    v_mfma_f32_16x16x32_bf16 v[124:127], v[88:91], v[96:99], v[28:31]
    buffer_load_dwordx4 v76, s[4:7], s99 offen offset:3264  lds
    s_nop 4
    v_max_f32 v112, v112, v116
    v_max_f32 v113, v113, v117
    v_max_f32 v114, v114, v118
    v_max_f32 v115, v115, v119
    v_max3_f32 v156, v112, v113, v114
    v_max_f32 v156, v156, v115
    v_max_f32 v120, v120, v124
    v_max_f32_e64 v121, v121, v125
    s_add_u32 m0, s93, 73344
    s_add_u32 s99, s99, 256
    s_mov_b64 exec, s[80:81]
    buffer_load_dwordx4 v77, s[4:7], s100 offen  lds
    s_mov_b64 exec, -1
    s_add_u32 s100, s100, 256
    v_max_f32 v122, v122, v126
    v_max_f32 v123, v123, v127
    v_max3_f32 v157, v120, v121, v122
    v_max_f32 v157, v157, v123
    s_nop 1
    v_permlane16_swap_b32 v156, v157
    v_max_f32 v156, v156, v157
    v_mov_b32 v157, v156
    s_nop 1
    v_permlane32_swap_b32 v156, v157
    s_add_u32 m0, s92, 75520
    s_nop 0
    buffer_load_dwordx4 v73, s[4:7], s99 offen offset:0  lds
    v_max_f32 v156, v156, v157
    v_mul_f32 v156, s82, v156
    v_mov_b32 v157, v156
    s_nop 1
    v_permlane16_swap_b32_e64 v156, v157
    v_fma_f32 v112, v112, s82, -v156
    v_fma_f32 v113, v113, s82, -v156
    v_fma_f32 v114, v114, s82, -v156
    v_fma_f32 v115, v115, s82, -v156
    buffer_load_dwordx4 v74, s[4:7], s99 offen offset:1088  lds
    v_exp_f32 v112, v112
    v_exp_f32 v113, v113
    v_exp_f32 v114, v114
    v_exp_f32 v115, v115
    v_cvt_pk_bf16_f32 v116, v112, v113
    v_cvt_pk_bf16_f32 v117, v114, v115
    v_bfi_b32 v128, v36, 0, v116
    v_and_b32_e64 v130, v36, v116
    buffer_load_dwordx4 v75, s[4:7], s99 offen offset:2176  lds
    v_bfi_b32 v129, v37, 0, v117
    v_and_b32 v131, v37, v117
    s_waitcnt lgkmcnt(3)
    s_nop 0
    v_mfma_f32_16x16x32_bf16 v[144:147], v[106:109], v[128:131], 0
    s_waitcnt lgkmcnt(2)
    v_mfma_f32_16x16x32_bf16 v[136:139], v[100:103], v[128:131], 0
    v_fma_f32 v120, v120, s82, -v157
    v_fma_f32 v121, v121, s82, -v157
    v_fma_f32 v122, v122, s82, -v157
    v_fma_f32 v123, v123, s82, -v157
    buffer_load_dwordx4 v76, s[4:7], s99 offen offset:3264  lds
    v_exp_f32 v120, v120
    v_exp_f32 v121, v121
    v_exp_f32 v122, v122
    v_exp_f32 v123, v123
    v_cvt_pk_bf16_f32 v124, v120, v121
    v_cvt_pk_bf16_f32 v125, v122, v123
    v_bfi_b32 v132, v36, 0, v124
    v_and_b32_e64 v134, v36, v124
    s_add_u32 m0, s93, 92928
    s_add_u32 s99, s99, 256
    s_mov_b64 exec, s[80:81]
    buffer_load_dwordx4 v77, s[4:7], s100 offen  lds
    s_mov_b64 exec, -1
    s_add_u32 s100, s100, 256
    v_bfi_b32 v133, v37, 0, v125
    v_and_b32 v135, v37, v125
    s_waitcnt lgkmcnt(1)
    s_nop 0
    v_mfma_f32_16x16x32_bf16 v[148:151], v[108:111], v[132:135], 0
    s_waitcnt lgkmcnt(0)
    v_mfma_f32_16x16x32_bf16 v[140:143], v[102:105], v[132:135], 0
    v_mov_b32 v158, v144
    s_nop 1
    v_permlane16_swap_b32 v144, v158
    v_rcp_f32 v158, v158
    s_nop 0
    v_pk_mul_f32 v[136:137], v[136:137], v[158:159] op_sel_hi:[1,0]
    s_lshl_b32 s97, s73, 2
    s_add_u32 s97, s97, s24
    s_nop 0
    s_mul_i32 s97, s97, 25600
    s_add_u32 s97, s97, 2621440
    buffer_load_dwordx4 a[160:163], v58, s[16:19], s97 offen offset:0 sc1
    v_pk_mul_f32 v[138:139], v[138:139], v[158:159] op_sel_hi:[1,0]
    v_pk_mul_f32 v[144:145], v[144:145], v[158:159] op_sel_hi:[1,0]
    v_pk_mul_f32 v[146:147], v[146:147], v[158:159] op_sel_hi:[1,0]
    v_cvt_pk_bf16_f32 v112, v136, v137
    v_cvt_pk_bf16_f32 v116, v144, v145
    v_cvt_pk_bf16_f32 v113, v138, v139
    v_cvt_pk_bf16_f32 v117, v146, v147
    v_mov_b32 v160, v148
    buffer_load_dwordx4 a[164:167], v58, s[16:19], s97 offen offset:1024 sc1
    s_nop 0
    v_permlane16_swap_b32 v148, v160
    v_rcp_f32_e64 v160, v160
    s_nop 0
    v_pk_mul_f32 v[140:141], v[140:141], v[160:161] op_sel_hi:[1,0]
    v_pk_mul_f32 v[142:143], v[142:143], v[160:161] op_sel_hi:[1,0]
    v_pk_mul_f32 v[148:149], v[148:149], v[160:161] op_sel_hi:[1,0]
    v_pk_mul_f32 v[150:151], v[150:151], v[160:161] op_sel_hi:[1,0]
    v_cvt_pk_bf16_f32 v114, v140, v141
    v_cvt_pk_bf16_f32 v118, v148, v149
    buffer_load_dwordx4 a[168:171], v58, s[16:19], s97 offen offset:2048 sc1
    v_cvt_pk_bf16_f32 v115, v142, v143
    v_cvt_pk_bf16_f32 v119, v150, v151
    v_permlane16_swap_b32 v112, v114
    v_permlane16_swap_b32 v113, v115
    v_permlane16_swap_b32 v116, v118
    v_permlane16_swap_b32 v117, v119
    buffer_store_dwordx4 v[112:115], v45, s[16:19], s25 offen sc1
    s_mov_b64 exec, s[80:81]
    buffer_store_dwordx2 v[116:117], v46, s[16:19], s26 offen sc1
    s_mov_b64 exec, -1
    buffer_load_dwordx4 a[172:175], v58, s[16:19], s97 offen offset:3072 sc1
    s_add_u32 s97, s97, 4096
    buffer_load_dwordx4 a[176:179], v58, s[16:19], s97 offen offset:0 sc1
    v_add_u32 v196, 36352, v78
    v_mov_b32 v198, v79
    v_xor_b32 v197, 32, v196
    s_waitcnt vmcnt(17)
    s_barrier
    ds_read_b128 v[160:163], v198 offset:0
    ds_read_b128 v[164:167], v196 offset:0
    ds_read_b128 v[168:171], v196 offset:8704
    ds_read_b128 v[172:175], v198 offset:32
    ds_read_b128 v[176:179], v197 offset:0
    ds_read_b128 v[180:183], v197 offset:8704
    s_waitcnt lgkmcnt(3)
    v_mfma_f32_16x16x32_bf16 v[112:115], a[0:3], v[160:163], 0
    ds_read_b128 v[184:187], v198 offset:64
    v_mfma_f32_32x32x16_bf16 v[80:95], a[0:3], v[164:167], 0
    ds_read_b128 v[188:191], v196 offset:64
    v_mfma_f32_32x32x16_bf16 v[96:111], a[0:3], v[168:171], 0
    ds_read_b128 v[192:195], v196 offset:8768
    s_add_u32 m0, s92, 95104
    s_nop 0
    buffer_load_dwordx4 v73, s[4:7], s99 offen offset:0  lds
    s_waitcnt lgkmcnt(3)
    v_mfma_f32_16x16x32_bf16 v[112:115], a[4:7], v[172:175], v[112:115]
    ds_read_b128 v[160:163], v198 offset:96
    v_mfma_f32_32x32x16_bf16 v[80:95], a[4:7], v[176:179], v[80:95]
    ds_read_b128 v[164:167], v197 offset:64
    v_mfma_f32_32x32x16_bf16 v[96:111], a[4:7], v[180:183], v[96:111]
    ds_read_b128 v[168:171], v197 offset:8768
    buffer_load_dwordx4 v74, s[4:7], s99 offen offset:1088  lds
    s_waitcnt lgkmcnt(3)
    v_mfma_f32_16x16x32_bf16 v[112:115], a[8:11], v[184:187], v[112:115]
    ds_read_b128 v[172:175], v198 offset:128
    v_mfma_f32_32x32x16_bf16 v[80:95], a[8:11], v[188:191], v[80:95]
    ds_read_b128 v[176:179], v196 offset:128
    v_mfma_f32_32x32x16_bf16 v[96:111], a[8:11], v[192:195], v[96:111]
    ds_read_b128 v[180:183], v196 offset:8832
    buffer_load_dwordx4 v75, s[4:7], s99 offen offset:2176  lds
    s_waitcnt lgkmcnt(3)
    v_mfma_f32_16x16x32_bf16 v[112:115], a[12:15], v[160:163], v[112:115]
    ds_read_b128 v[184:187], v198 offset:160
    v_mfma_f32_32x32x16_bf16 v[80:95], a[12:15], v[164:167], v[80:95]
    ds_read_b128 v[188:191], v197 offset:128
    v_mfma_f32_32x32x16_bf16 v[96:111], a[12:15], v[168:171], v[96:111]
    ds_read_b128 v[192:195], v197 offset:8832
    buffer_load_dwordx4 v76, s[4:7], s99 offen offset:3264  lds
    s_waitcnt lgkmcnt(3)
    v_mfma_f32_16x16x32_bf16 v[112:115], a[16:19], v[172:175], v[112:115]
    ds_read_b128 v[160:163], v198 offset:192
    v_mfma_f32_32x32x16_bf16 v[80:95], a[16:19], v[176:179], v[80:95]
    ds_read_b128 v[164:167], v196 offset:192
    v_mfma_f32_32x32x16_bf16 v[96:111], a[16:19], v[180:183], v[96:111]
    ds_read_b128 v[168:171], v196 offset:8896
    s_add_u32 m0, s93, 112512
    s_add_u32 s99, s99, 256
    s_mov_b64 exec, s[80:81]
    buffer_load_dwordx4 v77, s[4:7], s100 offen  lds
    s_mov_b64 exec, -1
    s_add_u32 s100, s100, 256
    s_waitcnt lgkmcnt(3)
    v_mfma_f32_16x16x32_bf16 v[112:115], a[20:23], v[184:187], v[112:115]
    ds_read_b128 v[172:175], v198 offset:224
    v_mfma_f32_32x32x16_bf16 v[80:95], a[20:23], v[188:191], v[80:95]
    ds_read_b128 v[176:179], v197 offset:192
    v_mfma_f32_32x32x16_bf16 v[96:111], a[20:23], v[192:195], v[96:111]
    ds_read_b128 v[180:183], v197 offset:8896
    s_add_u32 m0, s92, 114688
    s_nop 0
    buffer_load_dwordx4 v73, s[4:7], s99 offen offset:0  lds
    s_waitcnt vmcnt(18)
    s_barrier
    s_waitcnt lgkmcnt(3)
    v_mfma_f32_16x16x32_bf16 v[112:115], a[24:27], v[160:163], v[112:115]
    v_add_u32 v198, v49, v198
    v_mfma_f32_32x32x16_bf16 v[80:95], a[24:27], v[164:167], v[80:95]
    v_add_u32 v196, 19584, v196
    v_add_u32 v197, 19584, v197
    ds_read_b128 v[184:187], v198 offset:0
    v_mfma_f32_32x32x16_bf16 v[96:111], a[24:27], v[168:171], v[96:111]
    ds_read_b128 v[188:191], v196 offset:0
    ds_read_b128 v[192:195], v196 offset:8704
    buffer_load_dwordx4 v74, s[4:7], s99 offen offset:1088  lds
    s_waitcnt lgkmcnt(3)
    v_mfma_f32_16x16x32_bf16 v[112:115], a[28:31], v[172:175], v[112:115]
    ds_read_b128 v[160:163], v198 offset:32
    v_mfma_f32_32x32x16_bf16 v[80:95], a[28:31], v[176:179], v[80:95]
    ds_read_b128 v[164:167], v197 offset:0
    v_mfma_f32_32x32x16_bf16 v[96:111], a[28:31], v[180:183], v[96:111]
    ds_read_b128 v[168:171], v197 offset:8704
    buffer_load_dwordx4 v75, s[4:7], s99 offen offset:2176  lds
    s_waitcnt lgkmcnt(3)
    v_mfma_f32_16x16x32_bf16 v[112:115], a[32:35], v[184:187], v[112:115]
    ds_read_b128 v[172:175], v198 offset:64
    v_mfma_f32_32x32x16_bf16 v[80:95], a[32:35], v[188:191], v[80:95]
    ds_read_b128 v[176:179], v196 offset:64
    v_mfma_f32_32x32x16_bf16 v[96:111], a[32:35], v[192:195], v[96:111]
    ds_read_b128 v[180:183], v196 offset:8768
    buffer_load_dwordx4 v76, s[4:7], s99 offen offset:3264  lds
    s_waitcnt lgkmcnt(3)
    v_mfma_f32_16x16x32_bf16 v[112:115], a[36:39], v[160:163], v[112:115]
    ds_read_b128 v[184:187], v198 offset:96
    v_mfma_f32_32x32x16_bf16 v[80:95], a[36:39], v[164:167], v[80:95]
    ds_read_b128 v[188:191], v197 offset:64
    v_mfma_f32_32x32x16_bf16 v[96:111], a[36:39], v[168:171], v[96:111]
    ds_read_b128 v[192:195], v197 offset:8768
    s_add_u32 m0, s93, 132096
    s_add_u32 s99, s99, 256
    s_mov_b64 exec, s[80:81]
    buffer_load_dwordx4 v77, s[4:7], s100 offen  lds
    s_mov_b64 exec, -1
    s_add_u32 s100, s100, 256
    s_waitcnt lgkmcnt(3)
    v_mfma_f32_16x16x32_bf16 v[112:115], a[40:43], v[172:175], v[112:115]
    ds_read_b128 v[160:163], v198 offset:128
    v_mfma_f32_32x32x16_bf16 v[80:95], a[40:43], v[176:179], v[80:95]
    ds_read_b128 v[164:167], v196 offset:128
    s_lshl_b32 s25, s24, 6
    s_and_b32 s35, s74, 3
    s_lshl_b32 s35, s35, 13
    s_add_u32 s35, s35, s25
    v_mfma_f32_32x32x16_bf16 v[96:111], a[40:43], v[180:183], v[96:111]
    ds_read_b128 v[168:171], v196 offset:8832
    s_lshl_b32 s98, s72, 5
    s_add_u32 s98, s98, 256
    s_sub_u32 s95, s98, 4
    s_max_i32 s95, s95, 0
    s_lshl_b32 s94, s98, 3
    s_lshl_b32 s95, s95, 3
    s_add_u32 s94, s94, 3440640
    s_add_u32 s95, s95, 3440640
    s_add_u32 s96, s94, 8192
    buffer_load_dwordx2 v[152:153], v47, s[16:19], s94 offen sc1
    s_waitcnt lgkmcnt(3)
    v_mfma_f32_16x16x32_bf16 v[112:115], a[44:47], v[184:187], v[112:115]
    ds_read_b128 v[172:175], v198 offset:160
    v_mfma_f32_32x32x16_bf16 v[80:95], a[44:47], v[188:191], v[80:95]
    ds_read_b128 v[176:179], v197 offset:128
    s_lshr_b32 s25, s74, 4
    s_lshl_b32 s25, s25, 11
    s_add_u32 s35, s35, s25
    s_and_b32 s25, s74, 12
    v_mfma_f32_32x32x16_bf16 v[96:111], a[44:47], v[192:195], v[96:111]
    ds_read_b128 v[180:183], v197 offset:8832
    buffer_load_dwordx2 v[154:155], v47, s[16:19], s96 offen sc1
    s_lshl_b32 s25, s25, 6
    s_add_u32 s35, s35, s25
    s_waitcnt lgkmcnt(3)
    v_mfma_f32_16x16x32_bf16 v[112:115], a[48:51], v[160:163], v[112:115]
    ds_read_b128 v[184:187], v198 offset:192
    v_mfma_f32_32x32x16_bf16 v[80:95], a[48:51], v[164:167], v[80:95]
    ds_read_b128 v[188:191], v196 offset:192
    s_mul_i32 s36, s73, 20
    s_add_u32 s36, s36, s24
    s_add_u32 s36, s36, 16
    s_lshl_b32 s36, s36, 14
    v_mfma_f32_32x32x16_bf16 v[96:111], a[48:51], v[168:171], v[96:111]
    ds_read_b128 v[192:195], v196 offset:8896
    buffer_load_dwordx2 v[156:157], v48, s[16:19], s95 offen sc1
    v_add_u32 v199, 36352, v58
    s_lshl_b32 s32, s24, 11
    s_waitcnt lgkmcnt(3)
    v_mfma_f32_16x16x32_bf16 v[112:115], a[52:55], v[172:175], v[112:115]
    ds_read_b128 v[160:163], v198 offset:224
    v_mfma_f32_32x32x16_bf16 v[80:95], a[52:55], v[176:179], v[80:95]
    ds_read_b128 v[164:167], v197 offset:192
    v_add_u32 v203, s32, v199
    s_add_u32 s32, s24, 1
    s_and_b32 s32, s32, 3
    s_mul_i32 s32, s32, 6144
    v_mfma_f32_32x32x16_bf16 v[96:111], a[52:55], v[180:183], v[96:111]
    ds_read_b128 v[168:171], v197 offset:8896
    buffer_load_dwordx4 a[180:183], v58, s[16:19], s97 offen offset:1024 sc1
    v_add_u32 v200, s32, v199
    s_add_u32 s32, s24, 2
    s_waitcnt vmcnt(21)
    s_barrier
    s_waitcnt lgkmcnt(3)
    v_mfma_f32_16x16x32_bf16 v[112:115], a[56:59], v[184:187], v[112:115]
    v_add_u32 v198, v49, v198
    v_mfma_f32_32x32x16_bf16 v[80:95], a[56:59], v[188:191], v[80:95]
    v_add_u32 v196, 19584, v196
    v_add_u32 v197, 19584, v197
    ds_read_b128 v[172:175], v198 offset:0
    s_and_b32 s32, s32, 3
    s_mul_i32 s32, s32, 6144
    v_mfma_f32_32x32x16_bf16 v[96:111], a[56:59], v[192:195], v[96:111]
    ds_read_b128 v[176:179], v196 offset:0
    ds_read_b128 v[180:183], v196 offset:8704
    buffer_load_dwordx4 a[184:187], v58, s[16:19], s97 offen offset:2048 sc1
    v_add_u32_e64 v201, s32, v199
    s_waitcnt lgkmcnt(3)
    v_mfma_f32_16x16x32_bf16 v[112:115], a[60:63], v[160:163], v[112:115]
    ds_read_b128 v[184:187], v198 offset:32
    v_mfma_f32_32x32x16_bf16 v[80:95], a[60:63], v[164:167], v[80:95]
    ds_read_b128 v[188:191], v197 offset:0
    s_add_u32 s32, s24, 3
    s_and_b32 s32, s32, 3
    s_mul_i32 s32, s32, 6144
    v_add_u32_e64 v202, s32, v199
    v_mfma_f32_32x32x16_bf16 v[96:111], a[60:63], v[168:171], v[96:111]
    ds_read_b128 v[192:195], v197 offset:8704
    buffer_load_dwordx4 a[188:191], v58, s[16:19], s97 offen offset:3072 sc1
    s_mul_i32 s32, s24, 6144
    v_add_u32 v204, s32, v199
    s_waitcnt lgkmcnt(3)
    v_mfma_f32_16x16x32_bf16 v[112:115], a[64:67], v[172:175], v[112:115]
    ds_read_b128 v[160:163], v198 offset:64
    v_mfma_f32_32x32x16_bf16 v[80:95], a[64:67], v[176:179], v[80:95]
    ds_read_b128 v[164:167], v196 offset:64
    s_lshl_b32 s32, s24, 8
    s_add_u32 s32, s32, 36352
    v_and_b32 v214, 15, v1
    v_lshl_add_u32 v206, v214, 4, s32
    v_mfma_f32_32x32x16_bf16 v[96:111], a[64:67], v[180:183], v[96:111]
    ds_read_b128 v[168:171], v196 offset:8768
    s_add_u32 s97, s97, 4096
    buffer_load_dwordx4 a[192:195], v58, s[16:19], s97 offen offset:0 sc1
    v_lshrrev_b32 v215, 5, v1
    s_waitcnt lgkmcnt(3)
    v_mfma_f32_16x16x32_bf16 v[112:115], a[68:71], v[184:187], v[112:115]
    ds_read_b128 v[172:175], v198 offset:96
    v_mfma_f32_32x32x16_bf16 v[80:95], a[68:71], v[188:191], v[80:95]
    ds_read_b128 v[176:179], v197 offset:64
    v_lshl_add_u32 v205, v215, 10, v206
    v_bfe_u32 v215, v1, 4, 1
    v_lshl_add_u32 v205, v215, 3, v205
    v_lshlrev_b32_e64 v214, 2, v214
    v_mfma_f32_32x32x16_bf16 v[96:111], a[68:71], v[192:195], v[96:111]
    ds_read_b128 v[180:183], v197 offset:8768
    buffer_load_dwordx4 a[196:199], v58, s[16:19], s97 offen offset:1024 sc1
    v_lshl_add_u32 v214, v215, 10, v214
    s_lshl_b32 s32, s24, 6
    s_waitcnt lgkmcnt(3)
    v_mfma_f32_16x16x32_bf16 v[112:115], a[72:75], v[160:163], v[112:115]
    ds_read_b128 v[184:187], v198 offset:128
    v_mfma_f32_32x32x16_bf16 v[80:95], a[72:75], v[164:167], v[80:95]
    ds_read_b128 v[188:191], v196 offset:128
    v_lshl_add_u32 v207, v215, 3, s32
    v_and_b32 v215, 12, v1
    v_lshl_add_u32 v207, v215, 2, v207
    v_and_b32 v215, 2, v1
    v_mfma_f32_32x32x16_bf16 v[96:111], a[72:75], v[168:171], v[96:111]
    ds_read_b128 v[192:195], v196 offset:8832
    buffer_load_dwordx4 a[200:203], v58, s[16:19], s97 offen offset:2048 sc1
    v_lshl_add_u32 v207, v215, 1, v207
    v_add_u32 v207, 69120, v207
    s_waitcnt lgkmcnt(3)
    v_mfma_f32_16x16x32_bf16 v[112:115], a[76:79], v[172:175], v[112:115]
    ds_read_b128 v[160:163], v198 offset:160
    v_mfma_f32_32x32x16_bf16 v[80:95], a[76:79], v[176:179], v[80:95]
    ds_read_b128 v[164:167], v197 offset:128
    v_lshrrev_b32 v215, 4, v1
    v_lshl_add_u32 v206, v215, 2, v206
    v_mov_b32 v215, 0x3f803f80
    v_mfma_f32_32x32x16_bf16 v[96:111], a[76:79], v[180:183], v[96:111]
    ds_read_b128 v[168:171], v197 offset:8832
    buffer_load_dwordx4 a[204:207], v58, s[16:19], s97 offen offset:3072 sc1
    s_waitcnt lgkmcnt(3)
    v_mfma_f32_16x16x32_bf16 v[112:115], a[80:83], v[184:187], v[112:115]
    ds_read_b128 v[172:175], v198 offset:192
    v_mfma_f32_32x32x16_bf16 v[80:95], a[80:83], v[188:191], v[80:95]
    ds_read_b128 v[176:179], v196 offset:192
    v_mfma_f32_32x32x16_bf16 v[96:111], a[80:83], v[192:195], v[96:111]
    ds_read_b128 v[180:183], v196 offset:8896
    s_add_u32 s97, s97, 4096
    buffer_load_dwordx4 a[208:211], v58, s[16:19], s97 offen offset:0 sc1
    s_waitcnt lgkmcnt(3)
    v_mfma_f32_16x16x32_bf16 v[112:115], a[84:87], v[160:163], v[112:115]
    ds_read_b128 v[184:187], v198 offset:224
    v_mfma_f32_32x32x16_bf16 v[80:95], a[84:87], v[164:167], v[80:95]
    ds_read_b128 v[188:191], v197 offset:192
    v_mfma_f32_32x32x16_bf16 v[96:111], a[84:87], v[168:171], v[96:111]
    ds_read_b128 v[192:195], v197 offset:8896
    buffer_load_dwordx4 a[212:215], v58, s[16:19], s97 offen offset:1024 sc1
    s_waitcnt vmcnt(17)
    s_barrier
    s_waitcnt lgkmcnt(3)
    v_mfma_f32_16x16x32_bf16 v[112:115], a[88:91], v[172:175], v[112:115]
    v_add_u32 v198, v49, v198
    v_mfma_f32_32x32x16_bf16 v[80:95], a[88:91], v[176:179], v[80:95]
    v_add_u32 v196, 19584, v196
    v_add_u32 v197, 19584, v197
    ds_read_b128 v[160:163], v198 offset:0
    v_mfma_f32_32x32x16_bf16 v[96:111], a[88:91], v[180:183], v[96:111]
    ds_read_b128 v[164:167], v196 offset:0
    ds_read_b128 v[168:171], v196 offset:8704
    buffer_load_dwordx4 a[216:219], v58, s[16:19], s97 offen offset:2048 sc1
    s_waitcnt lgkmcnt(3)
    v_mfma_f32_16x16x32_bf16 v[112:115], a[92:95], v[184:187], v[112:115]
    ds_read_b128 v[172:175], v198 offset:32
    v_mfma_f32_32x32x16_bf16 v[80:95], a[92:95], v[188:191], v[80:95]
    ds_read_b128 v[176:179], v197 offset:0
    v_mfma_f32_32x32x16_bf16 v[96:111], a[92:95], v[192:195], v[96:111]
    ds_read_b128 v[180:183], v197 offset:8704
    buffer_load_dwordx4 a[220:223], v58, s[16:19], s97 offen offset:3072 sc1
    s_waitcnt lgkmcnt(3)
    v_mfma_f32_16x16x32_bf16 v[112:115], a[96:99], v[160:163], v[112:115]
    ds_read_b128 v[184:187], v198 offset:64
    v_mfma_f32_32x32x16_bf16 v[80:95], a[96:99], v[164:167], v[80:95]
    ds_read_b128 v[188:191], v196 offset:64
    v_mfma_f32_32x32x16_bf16 v[96:111], a[96:99], v[168:171], v[96:111]
    ds_read_b128 v[192:195], v196 offset:8768
    s_add_u32 s97, s97, 4096
    buffer_load_dwordx4 a[224:227], v58, s[16:19], s97 offen offset:0 sc1
    s_waitcnt lgkmcnt(3)
    v_mfma_f32_16x16x32_bf16 v[112:115], a[100:103], v[172:175], v[112:115]
    ds_read_b128 v[160:163], v198 offset:96
    v_mfma_f32_32x32x16_bf16 v[80:95], a[100:103], v[176:179], v[80:95]
    ds_read_b128 v[164:167], v197 offset:64
    v_mfma_f32_32x32x16_bf16 v[96:111], a[100:103], v[180:183], v[96:111]
    ds_read_b128 v[168:171], v197 offset:8768
    buffer_load_dwordx4 a[228:231], v58, s[16:19], s97 offen offset:1024 sc1
    s_waitcnt lgkmcnt(3)
    v_mfma_f32_16x16x32_bf16 v[112:115], a[104:107], v[184:187], v[112:115]
    ds_read_b128 v[172:175], v198 offset:128
    v_mfma_f32_32x32x16_bf16 v[80:95], a[104:107], v[188:191], v[80:95]
    ds_read_b128 v[176:179], v196 offset:128
    v_mfma_f32_32x32x16_bf16 v[96:111], a[104:107], v[192:195], v[96:111]
    ds_read_b128 v[180:183], v196 offset:8832
    buffer_load_dwordx4 a[232:235], v58, s[16:19], s97 offen offset:2048 sc1
    s_waitcnt lgkmcnt(3)
    v_mfma_f32_16x16x32_bf16 v[112:115], a[108:111], v[160:163], v[112:115]
    ds_read_b128 v[184:187], v198 offset:160
    v_mfma_f32_32x32x16_bf16 v[80:95], a[108:111], v[164:167], v[80:95]
    ds_read_b128 v[188:191], v197 offset:128
    v_mfma_f32_32x32x16_bf16 v[96:111], a[108:111], v[168:171], v[96:111]
    ds_read_b128 v[192:195], v197 offset:8832
    buffer_load_dwordx4 a[236:239], v58, s[16:19], s97 offen offset:3072 sc1
    s_waitcnt lgkmcnt(3)
    v_mfma_f32_16x16x32_bf16 v[112:115], a[112:115], v[172:175], v[112:115]
    ds_read_b128 v[160:163], v198 offset:192
    v_mfma_f32_32x32x16_bf16 v[80:95], a[112:115], v[176:179], v[80:95]
    ds_read_b128 v[164:167], v196 offset:192
    v_mfma_f32_32x32x16_bf16 v[96:111], a[112:115], v[180:183], v[96:111]
    ds_read_b128 v[168:171], v196 offset:8896
    s_add_u32 s97, s97, 4096
    buffer_load_dwordx4 a[240:243], v58, s[16:19], s97 offen offset:0 sc1
    s_waitcnt lgkmcnt(3)
    v_mfma_f32_16x16x32_bf16 v[112:115], a[116:119], v[184:187], v[112:115]
    ds_read_b128 v[172:175], v198 offset:224
    v_mfma_f32_32x32x16_bf16 v[80:95], a[116:119], v[188:191], v[80:95]
    ds_read_b128 v[176:179], v197 offset:192
    v_mfma_f32_32x32x16_bf16 v[96:111], a[116:119], v[192:195], v[96:111]
    ds_read_b128 v[180:183], v197 offset:8896
    buffer_load_dwordx4 a[244:247], v58, s[16:19], s97 offen offset:1024 sc1
    s_waitcnt vmcnt(20)
    s_barrier
    s_waitcnt lgkmcnt(3)
    v_mfma_f32_16x16x32_bf16 v[112:115], a[120:123], v[160:163], v[112:115]
    v_add_u32_e64 v198, v49, v198
    v_mfma_f32_32x32x16_bf16 v[80:95], a[120:123], v[164:167], v[80:95]
    v_add_u32 v196, 19584, v196
    v_add_u32 v197, 19584, v197
    s_waitcnt vmcnt(17)
    v_mul_f32 v148, v24, v157
    v_mul_f32 v149, v25, v157
    v_mul_f32 v150, v26, v157
    v_mfma_f32_32x32x16_bf16 v[96:111], a[120:123], v[168:171], v[96:111]
    ds_read_b128 v[184:187], v198 offset:0
    ds_read_b128 v[188:191], v196 offset:0
    buffer_load_dwordx4 a[248:251], v58, s[16:19], s97 offen offset:2048 sc1
    v_mul_f32 v151, v27, v157
    v_mul_f32_e64 v116, v8, v153
    s_waitcnt lgkmcnt(2)
    v_mfma_f32_16x16x32_bf16 v[112:115], a[124:127], v[172:175], v[112:115]
    ds_read_b128 v[192:195], v198 offset:32
    v_mfma_f32_32x32x16_bf16 v[80:95], a[124:127], v[176:179], v[80:95]
    ds_read_b128 v[160:163], v197 offset:0
    v_mul_f32 v117, v9, v153
    v_mul_f32 v118, v10, v153
    v_mul_f32 v119, v11, v153
    v_mul_f32 v120, v12, v153
    v_mfma_f32_32x32x16_bf16 v[96:111], a[124:127], v[180:183], v[96:111]
    buffer_load_dwordx4 a[252:255], v58, s[16:19], s97 offen offset:3072 sc1
    v_mul_f32 v121, v13, v153
    v_mul_f32 v122, v14, v153
    v_mul_f32 v123, v15, v153
    s_waitcnt lgkmcnt(2)
    v_mfma_f32_16x16x32_bf16 v[112:115], a[128:131], v[184:187], v[112:115]
    ds_read_b128 v[164:167], v198 offset:64
    v_mfma_f32_32x32x16_bf16 v[80:95], a[128:131], v[188:191], v[80:95]
    ds_read_b128 v[168:171], v196 offset:64
    v_mul_f32 v124, v16, v153
    v_mul_f32 v125, v17, v153
    v_mul_f32 v126, v18, v153
    s_waitcnt lgkmcnt(2)
    v_mfma_f32_16x16x32_bf16 v[112:115], a[132:135], v[192:195], v[112:115]
    ds_read_b128 v[172:175], v198 offset:96
    v_mfma_f32_32x32x16_bf16 v[80:95], a[132:135], v[160:163], v[80:95]
    ds_read_b128 v[176:179], v197 offset:64
    s_add_u32 s97, s97, 4096
    buffer_load_dwordx4 v[52:55], v58, s[16:19], s97 offen offset:0 sc1
    v_mul_f32 v127, v19, v153
    v_mul_f32_e64 v128, v20, v153
    s_waitcnt lgkmcnt(2)
    v_mfma_f32_16x16x32_bf16 v[112:115], a[136:139], v[164:167], v[112:115]
    ds_read_b128 v[180:183], v198 offset:128
    v_mfma_f32_32x32x16_bf16 v[80:95], a[136:139], v[168:171], v[80:95]
    ds_read_b128 v[184:187], v196 offset:128
    v_mul_f32 v129, v21, v153
    v_mul_f32 v130, v22, v153
    v_mul_f32 v131, v23, v153
    s_waitcnt lgkmcnt(2)
    v_mfma_f32_16x16x32_bf16 v[112:115], a[140:143], v[172:175], v[112:115]
    ds_read_b128 v[188:191], v198 offset:160
    v_mfma_f32_32x32x16_bf16 v[80:95], a[140:143], v[176:179], v[80:95]
    ds_read_b128 v[192:195], v197 offset:128
    s_mov_b32 s96, 4194304
    buffer_load_dwordx4 v[216:219], v56, s[16:19], s96 offen offset:0 sc1
    v_mul_f32 v132, v8, v155
    v_mul_f32_e64 v133, v9, v155
    s_waitcnt lgkmcnt(2)
    v_mfma_f32_16x16x32_bf16 v[112:115], a[144:147], v[180:183], v[112:115]
    ds_read_b128 v[160:163], v198 offset:192
    v_mfma_f32_32x32x16_bf16 v[80:95], a[144:147], v[184:187], v[80:95]
    ds_read_b128 v[164:167], v196 offset:192
    v_mul_f32 v134, v10, v155
    v_mul_f32 v135, v11, v155
    v_mul_f32 v136, v12, v155
    s_waitcnt lgkmcnt(2)
    v_mfma_f32_16x16x32_bf16 v[112:115], a[148:151], v[188:191], v[112:115]
    ds_read_b128 v[168:171], v198 offset:224
    v_mfma_f32_32x32x16_bf16 v[80:95], a[148:151], v[192:195], v[80:95]
    ds_read_b128 v[172:175], v197 offset:192
    buffer_load_dwordx4 v[220:223], v56, s[16:19], s96 offen offset:256 sc1
    v_mul_f32 v137, v13, v155
    v_mul_f32_e64 v138, v14, v155
    s_waitcnt lgkmcnt(2)
    v_mfma_f32_16x16x32_bf16 v[112:115], a[152:155], v[160:163], v[112:115]
    ds_read_b128 v[176:179], v196 offset:8704
    v_mfma_f32_32x32x16_bf16 v[80:95], a[152:155], v[164:167], v[80:95]
    ds_read_b128 v[180:183], v197 offset:8704
    v_mul_f32 v139, v15, v155
    v_mul_f32 v140, v16, v155
    v_mul_f32 v141, v17, v155
    s_waitcnt lgkmcnt(2)
    v_mfma_f32_16x16x32_bf16 v[112:115], a[156:159], v[168:171], v[112:115]
    ds_read_b128 v[184:187], v196 offset:8768
    v_mfma_f32_32x32x16_bf16 v[80:95], a[156:159], v[172:175], v[80:95]
    ds_read_b128 v[188:191], v197 offset:8768
    s_mov_b32 s96, 4227072
    buffer_load_dwordx4 v[224:227], v56, s[16:19], s96 offen offset:0 sc1
    v_mul_f32 v142, v18, v155
    v_mul_f32 v143, v19, v155
    v_mul_f32 v144, v20, v155
    v_mul_f32 v145, v21, v155
    v_mul_f32 v146, v22, v155
    v_mul_f32_e64 v147, v23, v155
    s_waitcnt lgkmcnt(2)
    v_mfma_f32_32x32x16_bf16 v[96:111], a[128:131], v[176:179], v[96:111]
    ds_read_b128 v[192:195], v196 offset:8832
    v_mfma_f32_32x32x16_bf16 v[96:111], a[132:135], v[180:183], v[96:111]
    ds_read_b128 v[160:163], v197 offset:8832
    buffer_load_dwordx4 v[228:231], v56, s[16:19], s96 offen offset:256 sc1
    v_fma_f32 v112, v112, v156, v148
    v_fma_f32 v113, v113, v156, v149
    s_waitcnt lgkmcnt(2)
    v_mfma_f32_32x32x16_bf16 v[96:111], a[136:139], v[184:187], v[96:111]
    ds_read_b128 v[164:167], v196 offset:8896
    v_fma_f32 v114, v114, v156, v150
    v_fma_f32 v115, v115, v156, v151
    v_cvt_pk_bf16_f32 v112, v112, v113
    v_cvt_pk_bf16_f32 v113, v114, v115
    v_mfma_f32_32x32x16_bf16 v[96:111], a[140:143], v[188:191], v[96:111]
    ds_read_b128 v[168:171], v197 offset:8896
    s_mov_b32 s96, 4259840
    buffer_load_dwordx4 v[232:235], v56, s[16:19], s96 offen offset:0 sc1
    v_fma_f32 v80, v80, v152, v116
    v_fma_f32 v81, v81, v152, v117
    s_waitcnt lgkmcnt(2)
    v_mfma_f32_32x32x16_bf16 v[96:111], a[144:147], v[192:195], v[96:111]
    v_fma_f32 v82, v82, v152, v118
    v_fma_f32 v83, v83, v152, v119
    v_cvt_pk_bf16_f32 v80, v80, v81
    v_cvt_pk_bf16_f32 v81, v82, v83
    ds_write_b64 v40, v[112:113] offset:0
    v_mfma_f32_32x32x16_bf16 v[96:111], a[148:151], v[160:163], v[96:111]
    ds_write_b64 v38, v[80:81] offset:0
    v_fma_f32 v84, v84, v152, v120
    v_fma_f32 v85, v85, v152, v121
    v_fma_f32 v86, v86, v152, v122
    s_waitcnt lgkmcnt(2)
    v_mfma_f32_32x32x16_bf16 v[96:111], a[152:155], v[164:167], v[96:111]
    v_fma_f32 v87, v87, v152, v123
    v_cvt_pk_bf16_f32 v84, v84, v85
    v_cvt_pk_bf16_f32 v85, v86, v87
    v_fma_f32 v88, v88, v152, v124
    v_fma_f32 v89, v89, v152, v125
    v_mfma_f32_32x32x16_bf16 v[96:111], a[156:159], v[168:171], v[96:111]
    buffer_load_dwordx4 v[236:239], v56, s[16:19], s96 offen offset:256 sc1
    v_fma_f32 v90, v90, v152, v126
    v_fma_f32 v91, v91, v152, v127
    v_cvt_pk_bf16_f32 v88, v88, v89
    v_cvt_pk_bf16_f32 v89, v90, v91
    ds_write_b64 v38, v[84:85] offset:6400
    ds_write_b64 v38, v[88:89] offset:12800
    v_fma_f32 v92, v92, v152, v128
    v_fma_f32 v93, v93, v152, v129
    v_fma_f32 v94, v94, v152, v130
    v_fma_f32 v95, v95, v152, v131
    v_cvt_pk_bf16_f32 v92, v92, v93
    v_cvt_pk_bf16_f32 v93, v94, v95
    ds_write_b64 v39, v[92:93] offset:0
    v_pk_fma_f32 v[96:97], v[96:97], v[154:155], v[132:133] op_sel_hi:[1,0,1]
    v_pk_fma_f32 v[98:99], v[98:99], v[154:155], v[134:135] op_sel_hi:[1,0,1]
    v_cvt_pk_bf16_f32 v96, v96, v97
    v_cvt_pk_bf16_f32 v97, v98, v99
    v_pk_fma_f32 v[100:101], v[100:101], v[154:155], v[136:137] op_sel_hi:[1,0,1]
    v_pk_fma_f32 v[102:103], v[102:103], v[154:155], v[138:139] op_sel_hi:[1,0,1]
    v_cvt_pk_bf16_f32 v100, v100, v101
    v_cvt_pk_bf16_f32 v101, v102, v103
    ds_write_b64 v38, v[96:97] offset:1600
    ds_write_b64 v38, v[100:101] offset:8000
    v_pk_fma_f32 v[104:105], v[104:105], v[154:155], v[140:141] op_sel_hi:[1,0,1]
    v_pk_fma_f32 v[106:107], v[106:107], v[154:155], v[142:143] op_sel_hi:[1,0,1]
    v_cvt_pk_bf16_f32 v104, v104, v105
    v_cvt_pk_bf16_f32 v105, v106, v107
    v_pk_fma_f32 v[108:109], v[108:109], v[154:155], v[144:145] op_sel_hi:[1,0,1]
    v_pk_fma_f32 v[110:111], v[110:111], v[154:155], v[146:147] op_sel_hi:[1,0,1]
    v_cvt_pk_bf16_f32 v108, v108, v109
    v_cvt_pk_bf16_f32 v109, v110, v111
    ds_write_b64 v38, v[104:105] offset:14400
    ds_write_b64 v39, v[108:109] offset:1600
    s_waitcnt lgkmcnt(0)
    s_barrier
    v_mov_b32 v94, 0
    v_mov_b32 v95, 0
    v_mov_b32 v98, 0
    v_mov_b32_e64 v99, 0
    s_mov_b64 exec, 0xffff
    ds_read_b64 v[94:95], v42 offset:320
    ds_read_b64 v[98:99], v42 offset:640
    s_mov_b64 exec, -1
    s_nop 0
    ds_read_b64 v[92:93], v41 offset:320
    ds_read_b64 v[96:97], v41 offset:640
    ds_read_b64 v[84:85], v41 offset:6720
    ds_read_b64 v[86:87], v42 offset:6720
    ds_read_b64 v[80:81], v41 offset:6400
    ds_read_b64 v[82:83], v42 offset:6400
    ds_read_b64 v[88:89], v41 offset:7040
    ds_read_b64 v[90:91], v42 offset:7040
    ds_read_b64_tr_b16 v[106:107], v44 offset:0
    ds_read_b64_tr_b16 v[100:101], v43 offset:0
    ds_read_b64_tr_b16 v[108:109], v44 offset:320
    ds_read_b64_tr_b16 v[102:103], v43 offset:320
    s_mov_b32 s96, 4292608
    buffer_load_dwordx4 v[240:243], v56, s[16:19], s96 offen offset:0 sc1
    ds_read_b64_tr_b16 v[110:111], v44 offset:640
    ds_read_b64_tr_b16 v[104:105], v43 offset:640
    s_mov_b32 s82, 0x3ea52b5c
    s_lshl_b32 s25, s98, 4
    s_add_u32 s25, s25, 4194304
    s_lshl_b32 s26, s98, 3
    s_add_u32 s26, s26, 4194304
    s_waitcnt lgkmcnt(10)
    v_mfma_f32_16x16x32_bf16 v[116:119], v[84:87], v[92:95], v[28:31]
    buffer_load_dwordx4 v[244:247], v56, s[16:19], s96 offen offset:256 sc1
    v_mfma_f32_16x16x32_bf16 v[120:123], v[84:87], v[96:99], v[32:35]
    s_waitcnt lgkmcnt(8)
    v_mfma_f32_16x16x32_bf16 v[112:115], v[80:83], v[92:95], v[32:35]
    s_waitcnt lgkmcnt(6)
    v_mfma_f32_16x16x32_bf16 v[124:127], v[88:91], v[96:99], v[28:31]
    s_nop 5
    v_max_f32 v112, v112, v116
    v_max_f32 v113, v113, v117
    v_max_f32 v114, v114, v118
    v_max_f32 v115, v115, v119
    v_max3_f32 v156, v112, v113, v114
    s_mov_b32 s96, 4194304
    buffer_load_dwordx2 v[248:249], v57, s[16:19], s96 offen offset:0 sc1
    v_max_f32 v156, v156, v115
    v_max_f32 v120, v120, v124
    v_max_f32 v121, v121, v125
    v_max_f32 v122, v122, v126
    v_max_f32 v123, v123, v127
    v_max3_f32 v157, v120, v121, v122
    v_max_f32 v157, v157, v123
    s_nop 1
    v_permlane16_swap_b32 v156, v157
    buffer_load_dwordx2 v[252:253], v57, s[16:19], s96 offen offset:128 sc1
    v_max_f32 v156, v156, v157
    v_mov_b32 v157, v156
    s_nop 1
    v_permlane32_swap_b32 v156, v157
    v_max_f32 v156, v156, v157
    v_mul_f32 v156, s82, v156
    v_mov_b32 v157, v156
    s_nop 1
    v_permlane16_swap_b32_e64 v156, v157
    v_fma_f32 v112, v112, s82, -v156
    s_mov_b32 s96, 4210688
    buffer_load_dwordx2 v[250:251], v57, s[16:19], s96 offen offset:0 sc1
    v_fma_f32 v113, v113, s82, -v156
    v_fma_f32 v114, v114, s82, -v156
    v_fma_f32 v115, v115, s82, -v156
    v_exp_f32 v112, v112
    v_exp_f32 v113, v113
    v_exp_f32 v114, v114
    v_exp_f32 v115, v115
    v_cvt_pk_bf16_f32 v116, v112, v113
    buffer_load_dwordx2 v[254:255], v57, s[16:19], s96 offen offset:128 sc1
    v_cvt_pk_bf16_f32 v117, v114, v115
    v_bfi_b32 v128, v36, 0, v116
    v_and_b32 v130, v36, v116
    v_bfi_b32 v129, v37, 0, v117
    v_and_b32 v131, v37, v117
    s_waitcnt lgkmcnt(3)
    s_nop 0
    v_mfma_f32_16x16x32_bf16 v[144:147], v[106:109], v[128:131], 0
    s_waitcnt lgkmcnt(2)
    v_mfma_f32_16x16x32_bf16 v[136:139], v[100:103], v[128:131], 0
    v_fma_f32 v120, v120, s82, -v157
    s_mov_b32 s96, 0
    s_mov_b32 s97, 5120
    buffer_load_dwordx2 v[208:209], v60, s[4:7], s96 offen
    v_fma_f32 v121, v121, s82, -v157
    v_fma_f32 v122, v122, s82, -v157
    v_fma_f32 v123, v123, s82, -v157
    v_exp_f32 v120, v120
    v_exp_f32 v121, v121
    v_exp_f32 v122, v122
    v_exp_f32 v123, v123
    v_cvt_pk_bf16_f32 v124, v120, v121
    buffer_load_dwordx2 v[210:211], v60, s[4:7], s97 offen
    v_cvt_pk_bf16_f32 v125, v122, v123
    v_bfi_b32 v132, v36, 0, v124
    v_and_b32 v134, v36, v124
    v_bfi_b32 v133, v37, 0, v125
    v_and_b32 v135, v37, v125
    s_waitcnt lgkmcnt(1)
    s_nop 0
    v_mfma_f32_16x16x32_bf16 v[148:151], v[108:111], v[132:135], 0
    s_waitcnt lgkmcnt(0)
    v_mfma_f32_16x16x32_bf16 v[140:143], v[102:105], v[132:135], 0
    v_mov_b32 v158, v144
    v_lshrrev_b32_e64 v212, 5, v1
    v_mul_u32_u24 v212, 5104, v212
    v_bfe_u32 v213, v1, 4, 1
    v_lshlrev_b32 v213, 2, v213
    v_sub_u32 v212, v212, v213
    v_add_u32 v212, v212, v60
    s_mul_i32 s97, s24, 24
    s_sub_u32 s97, 128, s97
    buffer_load_dword v212, v212, s[4:7], s97 offen
    v_permlane16_swap_b32 v144, v158
    v_rcp_f32_e64 v158, v158
    s_nop 0
    v_pk_mul_f32 v[136:137], v[136:137], v[158:159] op_sel_hi:[1,0]
    v_pk_mul_f32 v[138:139], v[138:139], v[158:159] op_sel_hi:[1,0]
    v_pk_mul_f32 v[144:145], v[144:145], v[158:159] op_sel_hi:[1,0]
    v_pk_mul_f32 v[146:147], v[146:147], v[158:159] op_sel_hi:[1,0]
    v_cvt_pk_bf16_f32 v112, v136, v137
    v_cvt_pk_bf16_f32 v116, v144, v145
    v_cvt_pk_bf16_f32 v113, v138, v139
    v_cvt_pk_bf16_f32 v117, v146, v147
    v_mov_b32 v160, v148
    s_nop 1
    v_permlane16_swap_b32 v148, v160
    v_rcp_f32_e64 v160, v160
    s_nop 0
    v_pk_mul_f32 v[140:141], v[140:141], v[160:161] op_sel_hi:[1,0]
    v_pk_mul_f32 v[142:143], v[142:143], v[160:161] op_sel_hi:[1,0]
    v_pk_mul_f32 v[148:149], v[148:149], v[160:161] op_sel_hi:[1,0]
    v_pk_mul_f32 v[150:151], v[150:151], v[160:161] op_sel_hi:[1,0]
    v_cvt_pk_bf16_f32 v114, v140, v141
    v_cvt_pk_bf16_f32 v118, v148, v149
    v_cvt_pk_bf16_f32 v115, v142, v143
    v_cvt_pk_bf16_f32 v119, v150, v151
    v_permlane16_swap_b32 v112, v114
    v_permlane16_swap_b32 v113, v115
    v_permlane16_swap_b32 v116, v118
    v_permlane16_swap_b32 v117, v119
    buffer_store_dwordx4 v[112:115], v45, s[16:19], s25 offen sc1
    s_mov_b64 exec, s[80:81]
    buffer_store_dwordx2 v[116:117], v46, s[16:19], s26 offen sc1
    s_mov_b64 exec, -1
oe_20:
    s_waitcnt vmcnt(16)
    v_mfma_f32_16x16x32_bf16 v[112:115], a[176:179], v[216:219], 0
    v_mov_b32 v136, 0
    v_mov_b32 v137, 0
    s_waitcnt vmcnt(15)
    v_mfma_f32_16x16x32_bf16 v[116:119], a[176:179], v[220:223], 0
    v_mov_b32 v138, 0
    v_mov_b32 v139, 0
    s_waitcnt vmcnt(14)
    v_mfma_f32_16x16x32_bf16 v[112:115], a[196:199], v[224:227], v[112:115]
    v_mov_b32 v140, 0
    v_mov_b32 v141, 0
    s_waitcnt vmcnt(13)
    v_mfma_f32_16x16x32_bf16 v[116:119], a[196:199], v[228:231], v[116:119]
    s_mov_b32 s25, 6815744
    s_add_u32 s26, s36, 6815744
    s_waitcnt vmcnt(12)
    v_mfma_f32_16x16x32_bf16 v[112:115], a[216:219], v[232:235], v[112:115]
    s_add_u32 s27, s35, 3473408
    s_mov_b32 s28, 0x99999999
    s_waitcnt vmcnt(11)
    v_mfma_f32_16x16x32_bf16 v[116:119], a[216:219], v[236:239], v[116:119]
    s_mov_b32 s29, 0x99999999
    s_waitcnt vmcnt(10)
    v_mfma_f32_16x16x32_bf16 v[112:115], a[236:239], v[240:243], v[112:115]
    s_waitcnt vmcnt(9)
    v_mfma_f32_16x16x32_bf16 v[116:119], a[236:239], v[244:247], v[116:119]
    s_waitcnt vmcnt(6)
    v_mfma_f32_16x16x32_bf16 v[112:115], v[52:55], v[248:251], v[112:115]
    s_waitcnt vmcnt(5)
    v_mfma_f32_16x16x32_bf16 v[116:119], v[52:55], v[252:255], v[116:119]
    v_mfma_f32_16x16x32_bf16 v[88:91], a[164:167], v[216:219], 0
    v_mfma_f32_16x16x32_bf16 v[92:95], a[164:167], v[220:223], 0
    v_mfma_f32_16x16x32_bf16 v[88:91], a[184:187], v[224:227], v[88:91]
    v_mfma_f32_16x16x32_bf16 v[92:95], a[184:187], v[228:231], v[92:95]
    v_mfma_f32_16x16x32_bf16 v[88:91], a[204:207], v[232:235], v[88:91]
    v_mfma_f32_16x16x32_bf16 v[92:95], a[204:207], v[236:239], v[92:95]
    s_nop 1
    v_cmp_u_f32 vcc, v112, v116
    s_nop 0
    s_cbranch_vccnz rd_21
rc_22:
    v_mfma_f32_16x16x32_bf16 v[88:91], a[224:227], v[240:243], v[88:91]
    ds_write_b128 v203, v[112:115] offset:24576
    v_mfma_f32_16x16x32_bf16 v[92:95], a[224:227], v[244:247], v[92:95]
    v_mfma_f32_16x16x32_bf16 v[88:91], a[244:247], v[248:251], v[88:91]
    ds_write_b128 v203, v[116:119] offset:25600
    v_mfma_f32_16x16x32_bf16 v[92:95], a[244:247], v[252:255], v[92:95]
    v_mfma_f32_16x16x32_bf16 v[96:99], a[168:171], v[216:219], 0
    s_waitcnt vmcnt(4)
    v_lshlrev_b32 v120, 16, v208
    v_and_b32 v121, 0xffff0000, v208
    v_mfma_f32_16x16x32_bf16 v[100:103], a[168:171], v[220:223], 0
    v_lshlrev_b32_e64 v122, 16, v209
    v_and_b32 v123, 0xffff0000, v209
    v_mfma_f32_16x16x32_bf16 v[96:99], a[188:191], v[224:227], v[96:99]
    s_waitcnt vmcnt(3)
    v_lshlrev_b32 v124, 16, v210
    v_and_b32 v125, 0xffff0000, v210
    v_mfma_f32_16x16x32_bf16 v[100:103], a[188:191], v[228:231], v[100:103]
    v_lshlrev_b32_e64 v126, 16, v211
    v_and_b32 v127, 0xffff0000, v211
    v_mfma_f32_16x16x32_bf16 v[96:99], a[208:211], v[232:235], v[96:99]
    s_waitcnt vmcnt(2)
    v_lshlrev_b32 v128, 16, v212
    v_and_b32 v129, 0xffff0000, v212
    v_mfma_f32_16x16x32_bf16 v[100:103], a[208:211], v[236:239], v[100:103]
    v_mfma_f32_16x16x32_bf16 v[96:99], a[228:231], v[240:243], v[96:99]
    ds_write_b128 v200, v[88:91] offset:0
    v_mfma_f32_16x16x32_bf16 v[100:103], a[228:231], v[244:247], v[100:103]
    v_mfma_f32_16x16x32_bf16 v[96:99], a[248:251], v[248:251], v[96:99]
    ds_write_b128 v200, v[92:95] offset:1024
    v_mfma_f32_16x16x32_bf16 v[100:103], a[248:251], v[252:255], v[100:103]
    v_mfma_f32_16x16x32_bf16 v[104:107], a[172:175], v[216:219], 0
    v_mfma_f32_16x16x32_bf16 v[108:111], a[172:175], v[220:223], 0
    v_mfma_f32_16x16x32_bf16 v[104:107], a[192:195], v[224:227], v[104:107]
    v_mfma_f32_16x16x32_bf16 v[108:111], a[192:195], v[228:231], v[108:111]
    v_mfma_f32_16x16x32_bf16 v[104:107], a[212:215], v[232:235], v[104:107]
    v_mfma_f32_16x16x32_bf16 v[108:111], a[212:215], v[236:239], v[108:111]
    v_mfma_f32_16x16x32_bf16 v[104:107], a[232:235], v[240:243], v[104:107]
    ds_write_b128 v201, v[96:99] offset:2048
    v_mfma_f32_16x16x32_bf16 v[108:111], a[232:235], v[244:247], v[108:111]
    v_mfma_f32_16x16x32_bf16 v[104:107], a[252:255], v[248:251], v[104:107]
    ds_write_b128 v201, v[100:103] offset:3072
    v_mfma_f32_16x16x32_bf16 v[108:111], a[252:255], v[252:255], v[108:111]
    v_mfma_f32_16x16x32_bf16 v[80:83], a[160:163], v[216:219], v[120:123]
    v_mfma_f32_16x16x32_bf16 v[84:87], a[160:163], v[220:223], v[124:127]
    v_mfma_f32_16x16x32_bf16 v[80:83], a[180:183], v[224:227], v[80:83]
    v_mfma_f32_16x16x32_bf16 v[84:87], a[180:183], v[228:231], v[84:87]
    v_mfma_f32_16x16x32_bf16 v[80:83], a[200:203], v[232:235], v[80:83]
    s_nop 0
    ds_write_b128 v202, v[104:107] offset:4096
    v_mfma_f32_16x16x32_bf16 v[84:87], a[200:203], v[236:239], v[84:87]
    ds_write_b128 v202, v[108:111] offset:5120
    v_mfma_f32_16x16x32_bf16 v[80:83], a[220:223], v[240:243], v[80:83]
    v_mfma_f32_16x16x32_bf16 v[84:87], a[220:223], v[244:247], v[84:87]
    v_mfma_f32_16x16x32_bf16 v[80:83], a[240:243], v[248:251], v[80:83]
    v_mfma_f32_16x16x32_bf16 v[84:87], a[240:243], v[252:255], v[84:87]
    s_waitcnt lgkmcnt(0)
    s_barrier
    s_nop 0
    ds_read_b128 v[88:91], v204 offset:0
    ds_read_b128 v[92:95], v204 offset:1024
    ds_read_b128 v[96:99], v204 offset:2048
    ds_read_b128 v[100:103], v204 offset:3072
    ds_read_b128 v[104:107], v204 offset:4096
    ds_read_b128 v[108:111], v204 offset:5120
    ds_read_b64 v[112:113], v205 offset:24576
    ds_read_b64 v[114:115], v205 offset:26624
    ds_read_b64 v[116:117], v205 offset:28672
    ds_read_b64 v[118:119], v205 offset:30720
    s_mov_b32 s96, 4198400
    buffer_load_dwordx4 v[216:219], v56, s[16:19], s96 offen offset:0 sc1
    buffer_load_dwordx4 v[220:223], v56, s[16:19], s96 offen offset:256 sc1
    s_mov_b32 s96, 4231168
    buffer_load_dwordx4 v[224:227], v56, s[16:19], s96 offen offset:0 sc1
    buffer_load_dwordx4 v[228:231], v56, s[16:19], s96 offen offset:256 sc1
    s_mov_b32 s96, 4263936
    buffer_load_dwordx4 v[232:235], v56, s[16:19], s96 offen offset:0 sc1
    buffer_load_dwordx4 v[236:239], v56, s[16:19], s96 offen offset:256 sc1
    s_waitcnt lgkmcnt(9)
    v_pk_add_f32 v[80:81], v[80:81], v[88:89]
    v_pk_add_f32 v[82:83], v[82:83], v[90:91]
    s_waitcnt lgkmcnt(8)
    v_pk_add_f32 v[84:85], v[84:85], v[92:93]
    v_pk_add_f32 v[86:87], v[86:87], v[94:95]
    s_waitcnt lgkmcnt(7)
    v_pk_add_f32 v[80:81], v[80:81], v[96:97]
    v_pk_add_f32 v[82:83], v[82:83], v[98:99]
    s_waitcnt lgkmcnt(6)
    v_pk_add_f32 v[84:85], v[84:85], v[100:101]
    v_pk_add_f32 v[86:87], v[86:87], v[102:103]
    s_waitcnt lgkmcnt(5)
    v_pk_add_f32 v[80:81], v[80:81], v[104:105]
    v_pk_add_f32 v[82:83], v[82:83], v[106:107]
    s_waitcnt lgkmcnt(4)
    v_pk_add_f32 v[84:85], v[84:85], v[108:109]
    v_pk_add_f32 v[86:87], v[86:87], v[110:111]
    v_cvt_pk_bf16_f32 v132, v80, v81
    v_cvt_pk_bf16_f32 v133, v82, v83
    v_cvt_pk_bf16_f32 v134, v84, v85
    v_cvt_pk_bf16_f32 v135, v86, v87
    s_waitcnt lgkmcnt(3)
    v_pk_add_f32 v[128:129], v[128:129], v[112:113]
    s_waitcnt lgkmcnt(2)
    v_pk_add_f32 v[128:129], v[128:129], v[114:115]
    s_waitcnt lgkmcnt(1)
    v_pk_add_f32 v[128:129], v[128:129], v[116:117]
    s_waitcnt lgkmcnt(0)
    v_pk_add_f32 v[128:129], v[128:129], v[118:119]
    v_cvt_pk_bf16_f32 v130, v128, v129
    buffer_store_dwordx4 v[132:135], v59, s[16:19], s25 offen sc1
    buffer_store_dword v130, v61, s[16:19], s26 offen sc1
    v_dot2c_f32_bf16 v136, v132, v215
    v_dot2c_f32_bf16 v137, v132, v132
    v_dot2c_f32_bf16 v136, v133, v215
    v_dot2c_f32_bf16 v137, v133, v133
    v_dot2c_f32_bf16 v138, v134, v215
    v_dot2c_f32_bf16 v139, v134, v134
    v_dot2c_f32_bf16 v138, v135, v215
    v_dot2c_f32_bf16 v139, v135, v135
    v_dot2c_f32_bf16 v140, v130, v215
    v_dot2c_f32_bf16 v141, v130, v130
    v_permlane32_swap_b32 v136, v138
    v_permlane32_swap_b32 v137, v139
    v_pk_add_f32 v[136:137], v[136:137], v[138:139]
    v_pk_add_f32 v[136:137], v[136:137], v[140:141]
    s_nop 1
    v_permlane16_swap_b32 v136, v137
    v_add_f32_e64 v136, v136, v137
    ds_write_b32 v206, v136 offset:32768
    s_mov_b32 s96, 4296704
    buffer_load_dwordx4 v[240:243], v56, s[16:19], s96 offen offset:0 sc1
    buffer_load_dwordx4 v[244:247], v56, s[16:19], s96 offen offset:256 sc1
    s_mov_b32 s96, 4196352
    buffer_load_dwordx2 v[248:249], v57, s[16:19], s96 offen offset:0 sc1
    buffer_load_dwordx2 v[252:253], v57, s[16:19], s96 offen offset:128 sc1
    s_mov_b32 s96, 4212736
    buffer_load_dwordx2 v[250:251], v57, s[16:19], s96 offen offset:0 sc1
    buffer_load_dwordx2 v[254:255], v57, s[16:19], s96 offen offset:128 sc1
    s_mov_b32 s96, 1310720
    s_mov_b32 s97, 1315840
    buffer_load_dwordx2 v[208:209], v60, s[4:7], s96 offen
    buffer_load_dwordx2 v[210:211], v60, s[4:7], s97 offen
    v_lshrrev_b32_e64 v212, 5, v1
    v_mul_u32_u24 v212, 5104, v212
    v_bfe_u32 v213, v1, 4, 1
    v_lshlrev_b32 v213, 2, v213
    v_sub_u32 v212, v212, v213
    v_add_u32 v212, v212, v60
    s_mul_i32 s97, s24, 24
    s_sub_u32 s97, 1310848, s97
    buffer_load_dword v212, v212, s[4:7], s97 offen
    s_waitcnt lgkmcnt(0)
    s_barrier
    ds_read2st64_b32 v[136:137], v207 offset0:0 offset1:1
    ds_read2st64_b32 v[138:139], v207 offset0:2 offset1:3
    ds_read_b64_tr_b16 v[144:145], v65 offset:32
    ds_read_b64_tr_b16 v[146:147], v65 offset:0
    ds_read_b64_tr_b16 v[148:149], v65 offset:160
    ds_read_b64_tr_b16 v[150:151], v65 offset:128
    ds_read_b64_tr_b16 v[152:153], v65 offset:288
    ds_read_b64_tr_b16 v[154:155], v65 offset:256
    ds_read_b64_tr_b16 v[156:157], v65 offset:416
    ds_read_b64_tr_b16 v[158:159], v65 offset:384
    ds_read_b64_tr_b16 v[160:161], v65 offset:544
    ds_read_b64_tr_b16 v[162:163], v65 offset:512
    ds_read_b64_tr_b16 v[164:165], v65 offset:672
    ds_read_b64_tr_b16 v[166:167], v65 offset:640
    ds_read_b64_tr_b16 v[168:169], v65 offset:800
    ds_read_b64_tr_b16 v[170:171], v65 offset:768
    ds_read_b64_tr_b16 v[172:173], v65 offset:928
    ds_read_b64_tr_b16 v[174:175], v65 offset:896
    s_waitcnt lgkmcnt(15)
    v_pk_add_f32 v[136:137], v[136:137], v[138:139]
    v_add_f32 v136, v136, v137
    v_cndmask_b32 v136, v136, 1.0, s[28:29]
    s_mov_b64 exec, s[80:81]
    buffer_atomic_add_f32 v136, v214, s[16:19], s27 offen
    s_mov_b64 exec, -1
    v_lshrrev_b32 v176, 4, v0
    v_mul_u32_u24 v176, 1216, v176
    v_and_b32 v177, 15, v0
    v_lshl_add_u32 v176, v177, 3, v176
    v_add_u32 v176, 64, v176
    v_mov_b32 v178, 0
    v_mov_b32 v179, 0
    ds_write_b64 v176, v[178:179]
    v_mov_b32 v70, 0
    v_mov_b32 v71, 0
    v_mov_b32 v72, 0
    s_lshl_b32 s25, s24, 17
    v_lshrrev_b32 v176, 5, v1
    v_lshl_add_u32 v176, v176, 14, s25
    v_bfe_u32 v177, v1, 4, 1
    v_lshl_add_u32 v176, v177, 13, v176
    v_and_b32_e64 v177, 15, v1
    v_lshl_add_u32 v73, v177, 4, v176
    v_bfe_u32 v176, v1, 2, 3
    v_lshl_add_u32 v176, v176, 14, s25
    v_bfe_u32 v177, v1, 1, 1
    v_lshl_add_u32 v176, v177, 13, v176
    v_and_b32 v177, 1, v1
    v_lshl_add_u32 v77, v177, 4, v176
    v_lshrrev_b32 v177, 5, v1
    v_and_b32 v176, 31, v1
    v_lshlrev_b32 v176, 3, v176
    v_lshl_add_u32 v78, v177, 10, v176
    v_and_b32 v176, 7, v1
    v_lshlrev_b32 v176, 3, v176
    v_lshl_add_u32 v178, v177, 7, v176
    v_add_u32 v74, 31744, v73
    v_add_u32 v75, 63488, v73
    v_add_u32 v76, 95232, v73
    v_add_u32 v178, 53760, v178
    v_and_b32 v176, 31, v1
    v_cmp_eq_u32 vcc, 0, v176
    v_cmp_eq_u32 s[82:83], 24, v176
    s_nop 0
    s_or_b64 vcc, vcc, s[82:83]
    v_mov_b32 v176, 155648
    v_mov_b32 v177, 157696
    v_cndmask_b32 v176, v176, v177, vcc
    v_cndmask_b32 v79, v176, v178, s[78:79]
oe_23:
    s_waitcnt vmcnt(17)
    v_mfma_f32_16x16x32_bf16 v[112:115], a[176:179], v[216:219], 0
    v_mov_b32 v136, 0
    v_mov_b32 v137, 0
    s_waitcnt vmcnt(16)
    v_mfma_f32_16x16x32_bf16 v[116:119], a[176:179], v[220:223], 0
    v_mov_b32 v138, 0
    v_mov_b32 v139, 0
    s_waitcnt vmcnt(15)
    v_mfma_f32_16x16x32_bf16 v[112:115], a[196:199], v[224:227], v[112:115]
    v_mov_b32 v140, 0
    v_mov_b32_e64 v141, 0
    s_waitcnt vmcnt(14)
    v_mfma_f32_16x16x32_bf16 v[116:119], a[196:199], v[228:231], v[116:119]
    s_mov_b32 s25, 6817792
    s_add_u32 s26, s36, 6817792
    s_waitcnt vmcnt(13)
    v_mfma_f32_16x16x32_bf16 v[112:115], a[216:219], v[232:235], v[112:115]
    s_add_u32 s27, s35, 3477504
    s_mov_b32 s28, 0x99999999
    s_waitcnt vmcnt(12)
    v_mfma_f32_16x16x32_bf16 v[116:119], a[216:219], v[236:239], v[116:119]
    s_mov_b32 s29, 0x99999999
    s_waitcnt vmcnt(9)
    v_mfma_f32_16x16x32_bf16 v[112:115], a[236:239], v[240:243], v[112:115]
    s_waitcnt vmcnt(8)
    v_mfma_f32_16x16x32_bf16 v[116:119], a[236:239], v[244:247], v[116:119]
    s_waitcnt vmcnt(5)
    v_mfma_f32_16x16x32_bf16 v[112:115], v[52:55], v[248:251], v[112:115]
    s_waitcnt vmcnt(4)
    v_mfma_f32_16x16x32_bf16 v[116:119], v[52:55], v[252:255], v[116:119]
    v_mfma_f32_16x16x32_bf16 v[88:91], a[164:167], v[216:219], 0
    v_mfma_f32_16x16x32_bf16 v[92:95], a[164:167], v[220:223], 0
    v_mfma_f32_16x16x32_bf16 v[88:91], a[184:187], v[224:227], v[88:91]
    v_mfma_f32_16x16x32_bf16 v[92:95], a[184:187], v[228:231], v[92:95]
    v_mfma_f32_16x16x32_bf16 v[88:91], a[204:207], v[232:235], v[88:91]
    v_mfma_f32_16x16x32_bf16 v[92:95], a[204:207], v[236:239], v[92:95]
    s_nop 1
    v_cmp_u_f32 vcc, v112, v116
    s_nop 0
    s_cbranch_vccnz rd_24
rc_25:
    v_mfma_f32_16x16x32_bf16 v[88:91], a[224:227], v[240:243], v[88:91]
    ds_write_b128 v203, v[112:115] offset:24576
    v_mfma_f32_16x16x32_bf16 v[92:95], a[224:227], v[244:247], v[92:95]
    v_mfma_f32_16x16x32_bf16 v[88:91], a[244:247], v[248:251], v[88:91]
    ds_write_b128 v203, v[116:119] offset:25600
    v_mfma_f32_16x16x32_bf16 v[92:95], a[244:247], v[252:255], v[92:95]
    v_mfma_f32_16x16x32_bf16 v[96:99], a[168:171], v[216:219], 0
    s_waitcnt vmcnt(3)
    v_lshlrev_b32 v120, 16, v208
    v_and_b32 v121, 0xffff0000, v208
    v_mfma_f32_16x16x32_bf16 v[100:103], a[168:171], v[220:223], 0
    v_lshlrev_b32_e64 v122, 16, v209
    v_and_b32 v123, 0xffff0000, v209
    v_mfma_f32_16x16x32_bf16 v[96:99], a[188:191], v[224:227], v[96:99]
    s_waitcnt vmcnt(2)
    v_lshlrev_b32 v124, 16, v210
    v_and_b32 v125, 0xffff0000, v210
    v_mfma_f32_16x16x32_bf16 v[100:103], a[188:191], v[228:231], v[100:103]
    v_lshlrev_b32_e64 v126, 16, v211
    v_and_b32 v127, 0xffff0000, v211
    v_mfma_f32_16x16x32_bf16 v[96:99], a[208:211], v[232:235], v[96:99]
    s_waitcnt vmcnt(1)
    v_lshlrev_b32 v128, 16, v212
    v_and_b32 v129, 0xffff0000, v212
    v_mfma_f32_16x16x32_bf16 v[100:103], a[208:211], v[236:239], v[100:103]
    v_mfma_f32_16x16x32_bf16 v[96:99], a[228:231], v[240:243], v[96:99]
    ds_write_b128 v200, v[88:91] offset:0
    v_mfma_f32_16x16x32_bf16 v[100:103], a[228:231], v[244:247], v[100:103]
    v_mfma_f32_16x16x32_bf16 v[96:99], a[248:251], v[248:251], v[96:99]
    ds_write_b128 v200, v[92:95] offset:1024
    v_mfma_f32_16x16x32_bf16 v[100:103], a[248:251], v[252:255], v[100:103]
    v_mfma_f32_16x16x32_bf16 v[104:107], a[172:175], v[216:219], 0
    v_mfma_f32_16x16x32_bf16 v[108:111], a[172:175], v[220:223], 0
    v_mfma_f32_16x16x32_bf16 v[104:107], a[192:195], v[224:227], v[104:107]
    v_mfma_f32_16x16x32_bf16 v[108:111], a[192:195], v[228:231], v[108:111]
    v_mfma_f32_16x16x32_bf16 v[104:107], a[212:215], v[232:235], v[104:107]
    v_mfma_f32_16x16x32_bf16 v[108:111], a[212:215], v[236:239], v[108:111]
    v_mfma_f32_16x16x32_bf16 v[104:107], a[232:235], v[240:243], v[104:107]
    ds_write_b128 v201, v[96:99] offset:2048
    v_mfma_f32_16x16x32_bf16 v[108:111], a[232:235], v[244:247], v[108:111]
    v_mfma_f32_16x16x32_bf16 v[104:107], a[252:255], v[248:251], v[104:107]
    ds_write_b128 v201, v[100:103] offset:3072
    v_mfma_f32_16x16x32_bf16 v[108:111], a[252:255], v[252:255], v[108:111]
    v_mfma_f32_16x16x32_bf16 v[80:83], a[160:163], v[216:219], v[120:123]
    v_mfma_f32_16x16x32_bf16 v[84:87], a[160:163], v[220:223], v[124:127]
    v_mfma_f32_16x16x32_bf16 v[80:83], a[180:183], v[224:227], v[80:83]
    v_mfma_f32_16x16x32_bf16 v[84:87], a[180:183], v[228:231], v[84:87]
    v_mfma_f32_16x16x32_bf16 v[80:83], a[200:203], v[232:235], v[80:83]
    s_nop 0
    ds_write_b128 v202, v[104:107] offset:4096
    v_mfma_f32_16x16x32_bf16 v[84:87], a[200:203], v[236:239], v[84:87]
    ds_write_b128 v202, v[108:111] offset:5120
    v_mfma_f32_16x16x32_bf16 v[80:83], a[220:223], v[240:243], v[80:83]
    v_mfma_f32_16x16x32_bf16 v[84:87], a[220:223], v[244:247], v[84:87]
    v_mfma_f32_16x16x32_bf16 v[80:83], a[240:243], v[248:251], v[80:83]
    v_mfma_f32_16x16x32_bf16 v[84:87], a[240:243], v[252:255], v[84:87]
    s_waitcnt lgkmcnt(0)
    s_barrier
    s_nop 0
    ds_read_b128 v[88:91], v204 offset:0
    ds_read_b128 v[92:95], v204 offset:1024
    ds_read_b128 v[96:99], v204 offset:2048
    ds_read_b128 v[100:103], v204 offset:3072
    ds_read_b128 v[104:107], v204 offset:4096
    ds_read_b128 v[108:111], v204 offset:5120
    ds_read_b64 v[112:113], v205 offset:24576
    ds_read_b64 v[114:115], v205 offset:26624
    ds_read_b64 v[116:117], v205 offset:28672
    ds_read_b64 v[118:119], v205 offset:30720
    s_lshl_b32 s96, s75, 14
    s_add_u32 s96, s96, 6815744
    s_lshl_b32 s97, s24, 12
    s_add_u32 s97, s97, 3473408
    buffer_load_dwordx4 v[176:179], v62, s[16:19], s96 offen offset:0 sc1
    buffer_load_dwordx4 v[180:183], v62, s[16:19], s96 offen offset:1024 sc1
    buffer_load_dwordx4 v[184:187], v62, s[16:19], s97 offen offset:0 sc1
    buffer_load_dwordx4 v[188:191], v62, s[16:19], s97 offen offset:1024 sc1
    buffer_load_dwordx4 v[192:195], v62, s[16:19], s97 offen offset:2048 sc1
    buffer_load_dwordx4 v[196:199], v62, s[16:19], s97 offen offset:3072 sc1
    s_waitcnt lgkmcnt(9)
    v_pk_add_f32 v[80:81], v[80:81], v[88:89]
    v_pk_add_f32 v[82:83], v[82:83], v[90:91]
    s_waitcnt lgkmcnt(8)
    v_pk_add_f32 v[84:85], v[84:85], v[92:93]
    v_pk_add_f32 v[86:87], v[86:87], v[94:95]
    s_waitcnt lgkmcnt(7)
    v_pk_add_f32 v[80:81], v[80:81], v[96:97]
    v_pk_add_f32 v[82:83], v[82:83], v[98:99]
    s_waitcnt lgkmcnt(6)
    v_pk_add_f32 v[84:85], v[84:85], v[100:101]
    v_pk_add_f32 v[86:87], v[86:87], v[102:103]
    s_waitcnt lgkmcnt(5)
    v_pk_add_f32 v[80:81], v[80:81], v[104:105]
    v_pk_add_f32 v[82:83], v[82:83], v[106:107]
    s_waitcnt lgkmcnt(4)
    v_pk_add_f32 v[84:85], v[84:85], v[108:109]
    v_pk_add_f32 v[86:87], v[86:87], v[110:111]
    v_cvt_pk_bf16_f32 v132, v80, v81
    v_cvt_pk_bf16_f32 v133, v82, v83
    v_cvt_pk_bf16_f32 v134, v84, v85
    v_cvt_pk_bf16_f32 v135, v86, v87
    s_waitcnt lgkmcnt(3)
    v_pk_add_f32 v[128:129], v[128:129], v[112:113]
    s_waitcnt lgkmcnt(2)
    v_pk_add_f32 v[128:129], v[128:129], v[114:115]
    s_waitcnt lgkmcnt(1)
    v_pk_add_f32 v[128:129], v[128:129], v[116:117]
    s_waitcnt lgkmcnt(0)
    v_pk_add_f32 v[128:129], v[128:129], v[118:119]
    v_cvt_pk_bf16_f32 v130, v128, v129
    buffer_store_dwordx4 v[132:135], v59, s[16:19], s25 offen sc1
    buffer_store_dword v130, v61, s[16:19], s26 offen sc1
    v_dot2c_f32_bf16 v136, v132, v215
    v_dot2c_f32_bf16 v137, v132, v132
    v_dot2c_f32_bf16 v136, v133, v215
    v_dot2c_f32_bf16 v137, v133, v133
    v_dot2c_f32_bf16 v138, v134, v215
    v_dot2c_f32_bf16 v139, v134, v134
    v_dot2c_f32_bf16 v138, v135, v215
    v_dot2c_f32_bf16 v139, v135, v135
    v_dot2c_f32_bf16 v140, v130, v215
    v_dot2c_f32_bf16 v141, v130, v130
    v_permlane32_swap_b32 v136, v138
    v_permlane32_swap_b32 v137, v139
    v_pk_add_f32 v[136:137], v[136:137], v[138:139]
    v_pk_add_f32 v[136:137], v[136:137], v[140:141]
    s_nop 1
    v_permlane16_swap_b32 v136, v137
    v_add_f32 v136, v136, v137
    ds_write_b32 v206, v136 offset:32768
    s_waitcnt lgkmcnt(0)
    s_barrier
    ds_read2st64_b32 v[136:137], v207 offset0:0 offset1:1
    ds_read2st64_b32 v[138:139], v207 offset0:2 offset1:3
    s_waitcnt lgkmcnt(0)
    v_pk_add_f32 v[136:137], v[136:137], v[138:139]
    v_add_f32 v136, v136, v137
    v_cndmask_b32 v136, v136, 1.0, s[28:29]
    s_mov_b64 exec, s[80:81]
    buffer_atomic_add_f32 v136, v214, s[16:19], s27 offen
    s_mov_b64 exec, -1
    s_cmp_ge_u32 s2, 160
    s_cbranch_scc1 nc_26
    s_waitcnt vmcnt(3)
ce_28:
    v_max3_u32 v208, v176, v177, v178
    v_max3_u32 v208, v208, v179, v180
    v_max3_u32 v208, v208, v181, v182
    v_max_u32 v208, v208, v183
    v_cmp_eq_u32 s[82:83], -1, v208
    v_min3_f32 v209, v184, v187, v188
    v_min3_f32 v209, v209, v191, v192
    v_min3_f32 v209, v209, v195, v196
    v_min_f32 v209, v209, v199
    v_cmp_neq_f32 vcc, 0x41000000, v209
    s_nop 0
    s_or_b64 vcc, vcc, s[82:83]
    s_cbranch_vccnz rd_29
rc_30:
    v_mul_f32 v208, 0x3acccccd, v185
    v_mul_f32 v209, 0x3acccccd, v189
    v_mul_f32 v186, 0x3acccccd, v186
    v_mul_f32 v190, 0x3acccccd, v190
    v_fma_f32 v186, -v208, v208, v186
    v_fma_f32 v190, -v209, v209, v190
    v_max_f32 v186, 0, v186
    v_max_f32 v190, 0, v190
    v_add_f32 v186, 0x3727c5ac, v186
    v_add_f32 v190, 0x3727c5ac, v190
    v_rsq_f32 v185, v186
    v_rsq_f32 v189, v190
    v_mul_f32 v186, -v208, v185
    v_mul_f32 v190, -v209, v189
    v_lshlrev_b32 v80, 16, v176
    v_and_b32 v82, 0xffff0000, v176
    v_lshlrev_b32 v84, 16, v177
    v_and_b32 v86, 0xffff0000, v177
    v_lshlrev_b32 v81, 16, v178
    v_and_b32 v83, 0xffff0000, v178
    v_lshlrev_b32 v85, 16, v179
    v_and_b32 v87, 0xffff0000, v179
    v_fma_f32 v208, v80, v185, v186
    v_fma_f32 v209, v81, v189, v190
    v_cvt_pk_bf16_f32 v176, v208, v209
    v_fma_f32 v208, v82, v185, v186
    v_fma_f32 v209, v83, v189, v190
    v_cvt_pk_bf16_f32 v177, v208, v209
    v_fma_f32 v208, v84, v185, v186
    v_fma_f32 v209, v85, v189, v190
    v_cvt_pk_bf16_f32 v178, v208, v209
    v_fma_f32 v208, v86, v185, v186
    v_fma_f32 v209, v87, v189, v190
    v_cvt_pk_bf16_f32 v179, v208, v209
    ds_write_b32 v63, v176 offset:0
    ds_write_b32 v63, v177 offset:4864
    ds_write_b32 v63, v178 offset:9728
    ds_write_b32 v63, v179 offset:14592
    v_mul_f32 v208, 0x3acccccd, v193
    v_mul_f32 v209, 0x3acccccd, v197
    v_mul_f32 v194, 0x3acccccd, v194
    v_mul_f32 v198, 0x3acccccd, v198
    v_fma_f32 v194, -v208, v208, v194
    v_fma_f32 v198, -v209, v209, v198
    v_max_f32 v194, 0, v194
    v_max_f32 v198, 0, v198
    v_add_f32 v194, 0x3727c5ac, v194
    v_add_f32 v198, 0x3727c5ac, v198
    v_rsq_f32 v193, v194
    v_rsq_f32 v197, v198
    v_mul_f32 v194, -v208, v193
    v_mul_f32 v198, -v209, v197
    v_lshlrev_b32 v88, 16, v180
    v_and_b32 v90, 0xffff0000, v180
    v_lshlrev_b32 v92, 16, v181
    v_and_b32 v94, 0xffff0000, v181
    v_lshlrev_b32 v89, 16, v182
    v_and_b32 v91, 0xffff0000, v182
    v_lshlrev_b32 v93, 16, v183
    v_and_b32 v95, 0xffff0000, v183
    v_fma_f32 v208, v88, v193, v194
    v_fma_f32 v209, v89, v197, v198
    v_cvt_pk_bf16_f32 v180, v208, v209
    v_fma_f32 v208, v90, v193, v194
    v_fma_f32 v209, v91, v197, v198
    v_cvt_pk_bf16_f32 v181, v208, v209
    v_fma_f32 v208, v92, v193, v194
    v_fma_f32 v209, v93, v197, v198
    v_cvt_pk_bf16_f32 v182, v208, v209
    v_fma_f32 v208, v94, v193, v194
    v_fma_f32 v209, v95, v197, v198
    v_cvt_pk_bf16_f32 v183, v208, v209
    ds_write_b32 v63, v180 offset:256
    ds_write_b32 v63, v181 offset:5120
    ds_write_b32 v63, v182 offset:9984
    ds_write_b32 v63, v183 offset:14848
    s_waitcnt lgkmcnt(0)
    s_barrier
    ds_read_b128 v[212:215], v64 offset:96
    ds_read_b128 v[216:219], v64 offset:64
    ds_read_b128 v[220:223], v64 offset:32
    ds_read_b128 v[224:227], v64 offset:0
    s_waitcnt lgkmcnt(3)
    v_mfma_f32_32x32x16_bf16 v[96:111], v[212:215], v[144:147], 0
    ds_read_b128 v[228:231], v64 offset:224
    ds_read_b64_tr_b16 v[176:177], v65 offset:1056
    ds_read_b64_tr_b16 v[178:179], v65 offset:1024
    ds_read_b64_tr_b16 v[180:181], v65 offset:1184
    ds_read_b64_tr_b16 v[182:183], v65 offset:1152
    s_waitcnt lgkmcnt(7)
    v_mfma_f32_32x32x16_bf16 v[96:111], v[216:219], v[148:151], v[96:111]
    ds_read_b128 v[232:235], v64 offset:192
    ds_read_b64_tr_b16 v[184:185], v65 offset:1312
    ds_read_b64_tr_b16 v[186:187], v65 offset:1280
    ds_read_b64_tr_b16 v[188:189], v65 offset:1440
    ds_read_b64_tr_b16 v[190:191], v65 offset:1408
    s_waitcnt lgkmcnt(11)
    v_mfma_f32_32x32x16_bf16 v[96:111], v[220:223], v[152:155], v[96:111]
    ds_read_b128 v[236:239], v64 offset:160
    ds_read_b64_tr_b16 v[192:193], v65 offset:1568
    ds_read_b64_tr_b16 v[194:195], v65 offset:1536
    ds_read_b64_tr_b16 v[196:197], v65 offset:1696
    ds_read_b64_tr_b16 v[198:199], v65 offset:1664
    s_waitcnt lgkmcnt(15)
    v_mfma_f32_32x32x16_bf16 v[96:111], v[224:227], v[156:159], v[96:111]
    ds_read_b128 v[240:243], v64 offset:128
    ds_read_b64_tr_b16 v[200:201], v65 offset:1824
    ds_read_b64_tr_b16 v[202:203], v65 offset:1792
    ds_read_b64_tr_b16 v[204:205], v65 offset:1952
    ds_read_b64_tr_b16 v[206:207], v65 offset:1920
    s_waitcnt lgkmcnt(15)
    v_mfma_f32_32x32x16_bf16 v[112:127], v[228:231], v[144:147], 0
    v_mov_b32 v248, -1
    v_mov_b32 v249, -1
    v_mov_b32 v250, -1
    v_mov_b32 v251, -1
    s_lshl_b32 s88, s75, 14
    s_add_u32 s88, s88, 9437184
    buffer_store_dwordx4 v[248:251], v62, s[16:19], s88 offen offset:0 sc1
    s_waitcnt lgkmcnt(14)
    v_mfma_f32_32x32x16_bf16 v[112:127], v[232:235], v[148:151], v[112:127]
    v_cndmask_b32 v208, v99, v72, s[76:77]
    v_cndmask_b32 v209, v103, v99, s[76:77]
    v_cndmask_b32 v210, v107, v103, s[76:77]
    v_cndmask_b32 v211, v111, v107, s[76:77]
    v_mov_b32_e64 v72, v111
    s_waitcnt lgkmcnt(9)
    v_mfma_f32_32x32x16_bf16 v[112:127], v[236:239], v[152:155], v[112:127]
    v_add_f32_dpp v98, v208, v98 wave_ror:1 row_mask:0xf bank_mask:0xf
    v_add_f32_dpp v102, v209, v102 wave_ror:1 row_mask:0xf bank_mask:0xf
    v_add_f32_dpp v106, v210, v106 wave_ror:1 row_mask:0xf bank_mask:0xf
    v_add_f32_dpp v110, v211, v110 wave_ror:1 row_mask:0xf bank_mask:0xf
    v_cndmask_b32 v208, v98, v71, s[76:77]
    s_waitcnt lgkmcnt(4)
    v_mfma_f32_32x32x16_bf16 v[112:127], v[240:243], v[156:159], v[112:127]
    v_cndmask_b32 v209, v102, v98, s[76:77]
    v_cndmask_b32 v210, v106, v102, s[76:77]
    v_cndmask_b32 v211, v110, v106, s[76:77]
    v_mov_b32 v71, v110
    v_add_f32_dpp v97, v208, v97 wave_ror:1 row_mask:0xf bank_mask:0xf
    v_add_f32_dpp v101, v209, v101 wave_ror:1 row_mask:0xf bank_mask:0xf
    v_mfma_f32_32x32x16_bf16 v[112:127], v[212:215], v[160:163], v[112:127]
    ds_read_b128 v[244:247], v64 offset:352
    v_add_f32_dpp v105, v210, v105 wave_ror:1 row_mask:0xf bank_mask:0xf
    v_add_f32_dpp v109, v211, v109 wave_ror:1 row_mask:0xf bank_mask:0xf
    v_cndmask_b32 v208, v97, v70, s[76:77]
    v_cndmask_b32 v209, v101, v97, s[76:77]
    v_cndmask_b32 v210, v105, v101, s[76:77]
    v_mfma_f32_32x32x16_bf16 v[112:127], v[216:219], v[164:167], v[112:127]
    ds_read_b128 v[216:219], v64 offset:320
    v_cndmask_b32 v211, v109, v105, s[76:77]
    v_mov_b32_e64 v70, v109
    v_add_f32_dpp v96, v208, v96 wave_ror:1 row_mask:0xf bank_mask:0xf
    v_add_f32_dpp v100, v209, v100 wave_ror:1 row_mask:0xf bank_mask:0xf
    v_add_f32_dpp v104, v210, v104 wave_ror:1 row_mask:0xf bank_mask:0xf
    v_mfma_f32_32x32x16_bf16 v[112:127], v[220:223], v[168:171], v[112:127]
    ds_read_b128 v[220:223], v64 offset:288
    buffer_store_dwordx4 v[248:251], v62, s[16:19], s88 offen offset:1024 sc1
    v_add_f32_dpp v108, v211, v108 wave_ror:1 row_mask:0xf bank_mask:0xf
    v_mfma_f32_32x32x16_bf16 v[112:127], v[224:227], v[172:175], v[112:127]
    ds_read_b128 v[224:227], v64 offset:256
    ds_write_b32 v66, v96 offset:0
    ds_write_b32 v66, v100 offset:64
    s_waitcnt lgkmcnt(5)
    v_mfma_f32_32x32x16_bf16 v[128:143], v[244:247], v[144:147], 0
    ds_write_b32 v66, v104 offset:128
    ds_write_b32 v66, v108 offset:192
    s_nop 0
    s_waitcnt lgkmcnt(6)
    v_mfma_f32_32x32x16_bf16 v[128:143], v[216:219], v[148:151], v[128:143]
    s_nop 3
    v_cndmask_b32 v208, v115, v72, s[76:77]
    s_waitcnt lgkmcnt(5)
    v_mfma_f32_32x32x16_bf16 v[128:143], v[220:223], v[152:155], v[128:143]
    v_cndmask_b32 v209, v119, v115, s[76:77]
    v_cndmask_b32 v210, v123, v119, s[76:77]
    v_cndmask_b32 v211, v127, v123, s[76:77]
    v_mov_b32 v72, v127
    v_add_f32_dpp v114, v208, v114 wave_ror:1 row_mask:0xf bank_mask:0xf
    s_waitcnt lgkmcnt(4)
    v_mfma_f32_32x32x16_bf16 v[128:143], v[224:227], v[156:159], v[128:143]
    v_add_f32_dpp v118, v209, v118 wave_ror:1 row_mask:0xf bank_mask:0xf
    v_add_f32_dpp v122, v210, v122 wave_ror:1 row_mask:0xf bank_mask:0xf
    v_add_f32_dpp v126, v211, v126 wave_ror:1 row_mask:0xf bank_mask:0xf
    v_cndmask_b32 v208, v114, v71, s[76:77]
    v_cndmask_b32 v209, v118, v114, s[76:77]
    v_cndmask_b32 v210, v122, v118, s[76:77]
    v_mfma_f32_32x32x16_bf16 v[128:143], v[228:231], v[160:163], v[128:143]
    buffer_store_dwordx4 v[248:251], v62, s[16:19], s88 offen offset:2048 sc1
    v_cndmask_b32 v211, v126, v122, s[76:77]
    v_mov_b32 v71, v126
    v_add_f32_dpp v113, v208, v113 wave_ror:1 row_mask:0xf bank_mask:0xf
    v_add_f32_dpp v117, v209, v117 wave_ror:1 row_mask:0xf bank_mask:0xf
    v_add_f32_dpp v121, v210, v121 wave_ror:1 row_mask:0xf bank_mask:0xf
    v_mfma_f32_32x32x16_bf16 v[128:143], v[232:235], v[164:167], v[128:143]
    ds_read_b128 v[232:235], v64 offset:64
    v_add_f32_dpp v125, v211, v125 wave_ror:1 row_mask:0xf bank_mask:0xf
    v_cndmask_b32 v208, v113, v70, s[76:77]
    v_cndmask_b32 v209, v117, v113, s[76:77]
    v_cndmask_b32 v210, v121, v117, s[76:77]
    v_cndmask_b32 v211, v125, v121, s[76:77]
    v_mfma_f32_32x32x16_bf16 v[128:143], v[236:239], v[168:171], v[128:143]
    ds_read_b128 v[236:239], v64 offset:32
    v_mov_b32_e64 v70, v125
    v_add_f32_dpp v112, v208, v112 wave_ror:1 row_mask:0xf bank_mask:0xf
    v_add_f32_dpp v116, v209, v116 wave_ror:1 row_mask:0xf bank_mask:0xf
    v_add_f32_dpp v120, v210, v120 wave_ror:1 row_mask:0xf bank_mask:0xf
    v_add_f32_dpp v124, v211, v124 wave_ror:1 row_mask:0xf bank_mask:0xf
    v_mfma_f32_32x32x16_bf16 v[128:143], v[240:243], v[172:175], v[128:143]
    ds_read_b128 v[240:243], v64 offset:0
    ds_write_b32 v66, v112 offset:256
    ds_write_b32 v66, v116 offset:320
    v_mfma_f32_32x32x16_bf16 v[128:143], v[212:215], v[176:179], v[128:143]
    ds_read_b128 v[212:215], v64 offset:480
    ds_write_b32 v66, v120 offset:384
    ds_write_b32 v66, v124 offset:448
    s_waitcnt lgkmcnt(7)
    v_mfma_f32_32x32x16_bf16 v[128:143], v[232:235], v[180:183], v[128:143]
    ds_read_b128 v[232:235], v64 offset:448
    s_waitcnt lgkmcnt(7)
    v_mfma_f32_32x32x16_bf16 v[128:143], v[236:239], v[184:187], v[128:143]
    ds_read_b128 v[236:239], v64 offset:416
    buffer_store_dwordx4 v[248:251], v62, s[16:19], s88 offen offset:3072 sc1
    s_waitcnt lgkmcnt(7)
    v_mfma_f32_32x32x16_bf16 v[128:143], v[240:243], v[188:191], v[128:143]
    ds_read_b128 v[240:243], v64 offset:384
    s_nop 3
    s_waitcnt lgkmcnt(5)
    v_mfma_f32_32x32x16_bf16 v[112:127], v[212:215], v[144:147], 0
    s_nop 4
    s_waitcnt lgkmcnt(2)
    v_mfma_f32_32x32x16_bf16 v[112:127], v[232:235], v[148:151], v[112:127]
    v_cndmask_b32 v208, v131, v72, s[76:77]
    v_cndmask_b32 v209, v135, v131, s[76:77]
    v_cndmask_b32 v210, v139, v135, s[76:77]
    v_cndmask_b32 v211, v143, v139, s[76:77]
    v_mov_b32_e64 v72, v143
    s_waitcnt lgkmcnt(1)
    v_mfma_f32_32x32x16_bf16 v[112:127], v[236:239], v[152:155], v[112:127]
    v_add_f32_dpp v130, v208, v130 wave_ror:1 row_mask:0xf bank_mask:0xf
    v_add_f32_dpp v134, v209, v134 wave_ror:1 row_mask:0xf bank_mask:0xf
    v_add_f32_dpp v138, v210, v138 wave_ror:1 row_mask:0xf bank_mask:0xf
    v_add_f32_dpp v142, v211, v142 wave_ror:1 row_mask:0xf bank_mask:0xf
    v_cndmask_b32 v208, v130, v71, s[76:77]
    s_waitcnt lgkmcnt(0)
    v_mfma_f32_32x32x16_bf16 v[112:127], v[240:243], v[156:159], v[112:127]
    v_cndmask_b32 v209, v134, v130, s[76:77]
    v_cndmask_b32 v210, v138, v134, s[76:77]
    v_cndmask_b32 v211, v142, v138, s[76:77]
    v_mov_b32 v71, v142
    v_add_f32_dpp v129, v208, v129 wave_ror:1 row_mask:0xf bank_mask:0xf
    v_add_f32_dpp v133, v209, v133 wave_ror:1 row_mask:0xf bank_mask:0xf
    v_mfma_f32_32x32x16_bf16 v[112:127], v[244:247], v[160:163], v[112:127]
    v_add_f32_dpp v137, v210, v137 wave_ror:1 row_mask:0xf bank_mask:0xf
    v_add_f32_dpp v141, v211, v141 wave_ror:1 row_mask:0xf bank_mask:0xf
    v_cndmask_b32 v208, v129, v70, s[76:77]
    v_cndmask_b32 v209, v133, v129, s[76:77]
    v_cndmask_b32 v210, v137, v133, s[76:77]
    v_cndmask_b32 v211, v141, v137, s[76:77]
    v_mfma_f32_32x32x16_bf16 v[112:127], v[216:219], v[164:167], v[112:127]
    ds_read_b128 v[240:243], v64 offset:192
    v_mov_b32_e64 v70, v141
    v_add_f32_dpp v128, v208, v128 wave_ror:1 row_mask:0xf bank_mask:0xf
    v_add_f32_dpp v132, v209, v132 wave_ror:1 row_mask:0xf bank_mask:0xf
    v_add_f32_dpp v136, v210, v136 wave_ror:1 row_mask:0xf bank_mask:0xf
    v_add_f32_dpp v140, v211, v140 wave_ror:1 row_mask:0xf bank_mask:0xf
    v_mfma_f32_32x32x16_bf16 v[112:127], v[220:223], v[168:171], v[112:127]
    ds_read_b128 v[220:223], v64 offset:160
    ds_write_b32 v66, v128 offset:512
    ds_write_b32 v66, v132 offset:576
    v_mfma_f32_32x32x16_bf16 v[112:127], v[224:227], v[172:175], v[112:127]
    ds_read_b128 v[224:227], v64 offset:128
    ds_write_b32 v66, v136 offset:640
    ds_write_b32 v66, v140 offset:704
    v_mfma_f32_32x32x16_bf16 v[112:127], v[228:231], v[176:179], v[112:127]
    ds_read_b128 v[236:239], v64 offset:96
    s_waitcnt lgkmcnt(7)
    v_mfma_f32_32x32x16_bf16 v[112:127], v[240:243], v[180:183], v[112:127]
    ds_read_b128 v[240:243], v64 offset:64
    s_waitcnt lgkmcnt(7)
    v_mfma_f32_32x32x16_bf16 v[112:127], v[220:223], v[184:187], v[112:127]
    ds_read_b128 v[220:223], v64 offset:32
    s_waitcnt lgkmcnt(5)
    v_mfma_f32_32x32x16_bf16 v[112:127], v[224:227], v[188:191], v[112:127]
    ds_read_b128 v[224:227], v64 offset:0
    s_waitcnt lgkmcnt(3)
    v_mfma_f32_32x32x16_bf16 v[112:127], v[236:239], v[192:195], v[112:127]
    ds_read_b64_tr_b16 v[216:217], v65 offset:544
    ds_read_b64_tr_b16 v[218:219], v65 offset:512
    s_waitcnt lgkmcnt(4)
    v_mfma_f32_32x32x16_bf16 v[112:127], v[240:243], v[196:199], v[112:127]
    ds_read_b64_tr_b16 v[240:241], v65 offset:1056
    ds_read_b64_tr_b16 v[242:243], v65 offset:1024
    s_waitcnt lgkmcnt(5)
    v_mfma_f32_32x32x16_bf16 v[112:127], v[220:223], v[200:203], v[112:127]
    s_waitcnt lgkmcnt(4)
    v_mfma_f32_32x32x16_bf16 v[112:127], v[224:227], v[204:207], v[112:127]
    ds_read_b64_tr_b16 v[224:225], v65 offset:1568
    ds_read_b64_tr_b16 v[226:227], v65 offset:1536
    s_lshl_b32 s96, s75, 14
    s_add_u32 s96, s96, 6815744
    s_lshl_b32 s97, s24, 12
    s_add_u32 s97, s97, 3477504
    buffer_load_dwordx4 v[248:251], v62, s[16:19], s96 offen offset:2048 sc1
    s_waitcnt lgkmcnt(4)
    v_mfma_f32_32x32x16_bf16 v[144:159], v[212:215], v[216:219], 0
    s_nop 3
    v_cndmask_b32 v208, v115, v72, s[76:77]
    s_waitcnt lgkmcnt(2)
    v_mfma_f32_32x32x16_bf16 v[144:159], v[244:247], v[240:243], v[144:159]
    buffer_load_dwordx4 v[252:255], v62, s[16:19], s96 offen offset:3072 sc1
    v_cndmask_b32 v209, v119, v115, s[76:77]
    v_cndmask_b32 v210, v123, v119, s[76:77]
    v_cndmask_b32 v211, v127, v123, s[76:77]
    v_mov_b32_e64 v72, v127
    v_add_f32_dpp v114, v208, v114 wave_ror:1 row_mask:0xf bank_mask:0xf
    v_mfma_f32_32x32x16_bf16 v[160:175], v[212:215], v[240:243], 0
    ds_read_b64_tr_b16 v[216:217], v65 offset:2080
    ds_read_b64_tr_b16 v[218:219], v65 offset:2048
    v_add_f32_dpp v118, v209, v118 wave_ror:1 row_mask:0xf bank_mask:0xf
    v_add_f32_dpp v122, v210, v122 wave_ror:1 row_mask:0xf bank_mask:0xf
    v_add_f32_dpp v126, v211, v126 wave_ror:1 row_mask:0xf bank_mask:0xf
    s_waitcnt lgkmcnt(2)
    v_mfma_f32_32x32x16_bf16 v[144:159], v[228:231], v[224:227], v[144:159]
    buffer_load_dwordx4 v[96:99], v62, s[16:19], s97 offen offset:0 sc1
    v_cndmask_b32 v208, v114, v71, s[76:77]
    v_cndmask_b32 v209, v118, v114, s[76:77]
    v_cndmask_b32 v210, v122, v118, s[76:77]
    v_cndmask_b32 v211, v126, v122, s[76:77]
    v_mov_b32 v71, v126
    v_mfma_f32_32x32x16_bf16 v[160:175], v[244:247], v[224:227], v[160:175]
    v_add_f32_dpp v113, v208, v113 wave_ror:1 row_mask:0xf bank_mask:0xf
    v_add_f32_dpp v117, v209, v117 wave_ror:1 row_mask:0xf bank_mask:0xf
    v_add_f32_dpp v121, v210, v121 wave_ror:1 row_mask:0xf bank_mask:0xf
    v_add_f32_dpp v125, v211, v125 wave_ror:1 row_mask:0xf bank_mask:0xf
    v_cndmask_b32 v208, v113, v70, s[76:77]
    v_cndmask_b32 v209, v117, v113, s[76:77]
    v_mfma_f32_32x32x16_bf16 v[176:191], v[212:215], v[224:227], 0
    buffer_load_dwordx4 v[100:103], v62, s[16:19], s97 offen offset:1024 sc1
    v_cndmask_b32 v210, v121, v117, s[76:77]
    v_cndmask_b32 v211, v125, v121, s[76:77]
    v_mov_b32 v70, v125
    v_add_f32_dpp v112, v208, v112 wave_ror:1 row_mask:0xf bank_mask:0xf
    s_waitcnt lgkmcnt(0)
    v_mfma_f32_32x32x16_bf16 v[144:159], v[236:239], v[216:219], v[144:159]
    ds_read_b64_tr_b16 v[240:241], v65 offset:2592
    ds_read_b64_tr_b16 v[242:243], v65 offset:2560
    v_add_f32_dpp v116, v209, v116 wave_ror:1 row_mask:0xf bank_mask:0xf
    v_add_f32_dpp v120, v210, v120 wave_ror:1 row_mask:0xf bank_mask:0xf
    v_add_f32_dpp v124, v211, v124 wave_ror:1 row_mask:0xf bank_mask:0xf
    v_mfma_f32_32x32x16_bf16 v[160:175], v[228:231], v[216:219], v[160:175]
    buffer_load_dwordx4 v[104:107], v62, s[16:19], s97 offen offset:2048 sc1
    ds_write_b32 v66, v112 offset:768
    ds_write_b32 v66, v116 offset:832
    v_mfma_f32_32x32x16_bf16 v[176:191], v[244:247], v[216:219], v[176:191]
    ds_write_b32 v66, v120 offset:896
    ds_write_b32 v66, v124 offset:960
    v_mfma_f32_32x32x16_bf16 v[192:207], v[212:215], v[216:219], 0
    ds_read_b64_tr_b16 v[212:213], v65 offset:3104
    ds_read_b64_tr_b16 v[214:215], v65 offset:3072
    buffer_load_dwordx4 v[108:111], v62, s[16:19], s97 offen offset:3072 sc1
    s_waitcnt lgkmcnt(6)
    v_mfma_f32_32x32x16_bf16 v[160:175], v[236:239], v[240:243], v[160:175]
    v_mfma_f32_32x32x16_bf16 v[176:191], v[228:231], v[240:243], v[176:191]
    ds_read_b64_tr_b16 v[224:225], v65 offset:3616
    ds_read_b64_tr_b16 v[226:227], v65 offset:3584
    s_waitcnt vmcnt(6) lgkmcnt(4)
    s_barrier
    v_mfma_f32_32x32x16_bf16 v[192:207], v[244:247], v[240:243], v[192:207]
    ds_read_b64_tr_b16 v[244:245], v65 offset:672
    ds_read_b64_tr_b16 v[246:247], v65 offset:640
    ds_read_b64 v[112:113], v67 offset:0
    ds_read_b64 v[114:115], v67 offset:4224
    ds_read_b64 v[116:117], v67 offset:8448
    s_waitcnt lgkmcnt(7)
    v_mfma_f32_32x32x16_bf16 v[176:191], v[236:239], v[212:215], v[176:191]
    ds_read_b128 v[216:219], v64 offset:320
    ds_read_b64_tr_b16 v[240:241], v65 offset:1184
    ds_read_b64_tr_b16 v[242:243], v65 offset:1152
    ds_read_b64 v[118:119], v67 offset:12672
    ds_read_b64 v[120:121], v67 offset:512
    ds_read_b64 v[122:123], v67 offset:4736
    v_mfma_f32_32x32x16_bf16 v[192:207], v[228:231], v[212:215], v[192:207]
    ds_read_b64 v[124:125], v67 offset:8960
    ds_read_b64 v[126:127], v67 offset:13184
    s_lshl_b32 s25, s75, 14
    s_add_u32 s25, s25, 9437184
    s_waitcnt lgkmcnt(13)
    v_mfma_f32_32x32x16_bf16 v[192:207], v[236:239], v[224:227], v[192:207]
    ds_read_b128 v[228:231], v64 offset:192
    ds_read_b64_tr_b16 v[236:237], v65 offset:1696
    ds_read_b64_tr_b16 v[238:239], v65 offset:1664
    s_waitcnt lgkmcnt(14)
    v_mfma_f32_32x32x16_bf16 v[144:159], v[232:235], v[244:247], v[144:159]
    s_waitcnt lgkmcnt(8)
    v_mfma_f32_32x32x16_bf16 v[144:159], v[216:219], v[240:243], v[144:159]
    v_mfma_f32_32x32x16_bf16 v[160:175], v[232:235], v[240:243], v[160:175]
    ds_read_b128 v[212:215], v64 offset:64
    ds_read_b64_tr_b16 v[224:225], v65 offset:2208
    ds_read_b64_tr_b16 v[226:227], v65 offset:2176
    s_waitcnt lgkmcnt(6)
    v_add_f32 v112, v112, v80
    s_waitcnt lgkmcnt(3)
    v_mfma_f32_32x32x16_bf16 v[144:159], v[228:231], v[236:239], v[144:159]
    v_add_f32 v113, v113, v81
    v_add_f32 v114, v114, v82
    v_add_f32 v115, v115, v83
    v_add_f32 v116, v116, v84
    v_add_f32 v117, v117, v85
    v_add_f32 v118, v118, v86
    v_mfma_f32_32x32x16_bf16 v[160:175], v[216:219], v[236:239], v[160:175]
    v_add_f32 v119, v119, v87
    v_cvt_pk_bf16_f32 v128, v112, v114
    v_cvt_pk_bf16_f32 v129, v116, v118
    v_cvt_pk_bf16_f32 v130, v113, v115
    v_cvt_pk_bf16_f32 v131, v117, v119
    v_mfma_f32_32x32x16_bf16 v[176:191], v[232:235], v[236:239], v[176:191]
    buffer_store_dwordx4 v[128:131], v62, s[16:19], s25 offen offset:0 sc1
    v_add_f32 v120, v120, v88
    v_add_f32 v121, v121, v89
    v_add_f32 v122, v122, v90
    v_add_f32_e64 v123, v123, v91
    s_waitcnt lgkmcnt(0)
    v_mfma_f32_32x32x16_bf16 v[144:159], v[212:215], v[224:227], v[144:159]
    ds_read_b64_tr_b16 v[244:245], v65 offset:2720
    ds_read_b64_tr_b16 v[246:247], v65 offset:2688
    v_add_f32 v124, v124, v92
    v_add_f32 v125, v125, v93
    v_add_f32 v126, v126, v94
    v_add_f32 v127, v127, v95
    v_mfma_f32_32x32x16_bf16 v[160:175], v[228:231], v[224:227], v[160:175]
    v_cvt_pk_bf16_f32 v132, v120, v122
    v_cvt_pk_bf16_f32 v133, v124, v126
    v_cvt_pk_bf16_f32 v134, v121, v123
    v_cvt_pk_bf16_f32 v135, v125, v127
    v_mfma_f32_32x32x16_bf16 v[176:191], v[216:219], v[224:227], v[176:191]
    buffer_store_dwordx4 v[132:135], v62, s[16:19], s25 offen offset:1024 sc1
    v_mov_b32_e64 v5, 1
    s_add_u32 s82, s86, 24576
    buffer_atomic_add v5, v6, s[16:19], s82 offen offset:0 sc0 sc1
    v_mfma_f32_32x32x16_bf16 v[192:207], v[232:235], v[224:227], v[192:207]
    ds_read_b64_tr_b16 v[232:233], v65 offset:3232
    ds_read_b64_tr_b16 v[234:235], v65 offset:3200
    ds_read_b64_tr_b16 v[112:113], v65 offset:32
    ds_read_b64_tr_b16 v[114:115], v65 offset:0
    ds_read_b64_tr_b16 v[116:117], v65 offset:160
    s_waitcnt lgkmcnt(5)
    v_mfma_f32_32x32x16_bf16 v[160:175], v[212:215], v[244:247], v[160:175]
    ds_read_b64_tr_b16 v[118:119], v65 offset:128
    ds_read_b64_tr_b16 v[120:121], v65 offset:288
    ds_read_b64_tr_b16 v[122:123], v65 offset:256
    ds_read_b64_tr_b16 v[124:125], v65 offset:416
    ds_read_b64_tr_b16 v[126:127], v65 offset:384
    ds_read_b64_tr_b16 v[128:129], v65 offset:544
    v_mfma_f32_32x32x16_bf16 v[176:191], v[228:231], v[244:247], v[176:191]
    ds_read_b64_tr_b16 v[240:241], v65 offset:3744
    ds_read_b64_tr_b16 v[242:243], v65 offset:3712
    ds_read_b64_tr_b16 v[130:131], v65 offset:512
    ds_read_b64_tr_b16 v[132:133], v65 offset:672
    ds_read_b64_tr_b16 v[134:135], v65 offset:640
    ds_read_b64_tr_b16 v[136:137], v65 offset:800
    v_mfma_f32_32x32x16_bf16 v[192:207], v[216:219], v[244:247], v[192:207]
    ds_read_b128 v[216:219], v64 offset:416
    ds_read_b64_tr_b16 v[236:237], v65 offset:800
    ds_read_b64_tr_b16 v[238:239], v65 offset:768
    ds_read_b64_tr_b16 v[138:139], v65 offset:768
    ds_read_b64_tr_b16 v[140:141], v65 offset:928
    s_waitcnt lgkmcnt(15)
    v_mfma_f32_32x32x16_bf16 v[176:191], v[212:215], v[232:235], v[176:191]
    ds_read_b128 v[224:227], v64 offset:288
    ds_read_b64_tr_b16 v[244:245], v65 offset:1312
    ds_read_b64_tr_b16 v[246:247], v65 offset:1280
    ds_read_b64_tr_b16 v[142:143], v65 offset:896
    v_mfma_f32_32x32x16_bf16 v[192:207], v[228:231], v[232:235], v[192:207]
    s_waitcnt vmcnt(3)
ce_31:
    v_max3_u32 v208, v248, v249, v250
    v_max3_u32 v208, v208, v251, v252
    v_max3_u32 v208, v208, v253, v254
    v_max_u32 v208, v208, v255
    v_cmp_eq_u32 s[82:83], -1, v208
    v_min3_f32 v209, v96, v99, v100
    v_min3_f32 v209, v209, v103, v104
    v_min3_f32 v209, v209, v107, v108
    v_min_f32 v209, v209, v111
    v_cmp_neq_f32 vcc, 0x41000000, v209
    s_nop 0
    s_or_b64 vcc, vcc, s[82:83]
    s_cbranch_vccnz rd_32
rc_33:
    s_waitcnt lgkmcnt(13)
    v_mfma_f32_32x32x16_bf16 v[192:207], v[212:215], v[240:243], v[192:207]
    ds_read_b128 v[228:231], v64 offset:160
    ds_read_b64_tr_b16 v[212:213], v65 offset:1824
    ds_read_b64_tr_b16 v[214:215], v65 offset:1792
    v_mul_f32 v208, 0x3acccccd, v97
    v_mul_f32 v209, 0x3acccccd, v101
    s_waitcnt lgkmcnt(9)
    v_mfma_f32_32x32x16_bf16 v[144:159], v[216:219], v[236:239], v[144:159]
    v_mul_f32 v98, 0x3acccccd, v98
    v_mul_f32 v102, 0x3acccccd, v102
    v_fma_f32 v98, -v208, v208, v98
    v_fma_f32 v102, -v209, v209, v102
    v_max_f32 v98, 0, v98
    s_waitcnt lgkmcnt(4)
    v_mfma_f32_32x32x16_bf16 v[144:159], v[224:227], v[244:247], v[144:159]
    v_max_f32_e64 v102, 0, v102
    v_add_f32 v98, 0x3727c5ac, v98
    v_add_f32 v102, 0x3727c5ac, v102
    v_rsq_f32_e64 v97, v98
    v_mfma_f32_32x32x16_bf16 v[160:175], v[216:219], v[244:247], v[160:175]
    ds_read_b64_tr_b16 v[232:233], v65 offset:2336
    ds_read_b64_tr_b16 v[234:235], v65 offset:2304
    v_rsq_f32 v101, v102
    v_mul_f32 v98, -v208, v97
    s_waitcnt lgkmcnt(2)
    v_mfma_f32_32x32x16_bf16 v[144:159], v[228:231], v[212:215], v[144:159]
    v_mul_f32 v102, -v209, v101
    v_lshlrev_b32 v80, 16, v248
    v_and_b32 v82, 0xffff0000, v248
    v_lshlrev_b32 v84, 16, v249
    v_and_b32 v86, 0xffff0000, v249
    v_lshlrev_b32_e64 v81, 16, v250
    v_mfma_f32_32x32x16_bf16 v[160:175], v[224:227], v[212:215], v[160:175]
    v_and_b32 v83, 0xffff0000, v250
    v_lshlrev_b32_e64 v85, 16, v251
    v_and_b32 v87, 0xffff0000, v251
    v_fma_f32 v208, v80, v97, v98
    v_fma_f32 v209, v81, v101, v102
    v_cvt_pk_bf16_f32 v248, v208, v209
    v_mfma_f32_32x32x16_bf16 v[176:191], v[216:219], v[212:215], v[176:191]
    v_fma_f32 v208, v82, v97, v98
    v_fma_f32 v209, v83, v101, v102
    v_cvt_pk_bf16_f32 v249, v208, v209
    v_fma_f32 v208, v84, v97, v98
    v_fma_f32 v209, v85, v101, v102
    s_waitcnt lgkmcnt(0)
    v_mfma_f32_32x32x16_bf16 v[144:159], v[220:223], v[232:235], v[144:159]
    ds_read_b64_tr_b16 v[240:241], v65 offset:2848
    ds_read_b64_tr_b16 v[242:243], v65 offset:2816
    v_cvt_pk_bf16_f32 v250, v208, v209
    v_fma_f32 v208, v86, v97, v98
    v_fma_f32 v209, v87, v101, v102
    v_cvt_pk_bf16_f32 v251, v208, v209
    v_mfma_f32_32x32x16_bf16 v[160:175], v[228:231], v[232:235], v[160:175]
    ds_write_b32 v63, v248 offset:512
    ds_write_b32 v63, v249 offset:5376
    ds_write_b32 v63, v250 offset:10240
    v_mfma_f32_32x32x16_bf16 v[176:191], v[224:227], v[232:235], v[176:191]
    ds_write_b32 v63, v251 offset:15104
    v_mul_f32 v208, 0x3acccccd, v105
    v_mul_f32 v209, 0x3acccccd, v109
    v_mul_f32 v106, 0x3acccccd, v106
    v_mul_f32 v110, 0x3acccccd, v110
    v_mfma_f32_32x32x16_bf16 v[192:207], v[216:219], v[232:235], v[192:207]
    ds_read_b64_tr_b16 v[216:217], v65 offset:3360
    ds_read_b64_tr_b16 v[218:219], v65 offset:3328
    v_fma_f32 v106, -v208, v208, v106
    v_fma_f32 v110, -v209, v209, v110
    v_max_f32 v106, 0, v106
    s_waitcnt lgkmcnt(6)
    v_mfma_f32_32x32x16_bf16 v[160:175], v[220:223], v[240:243], v[160:175]
    v_max_f32 v110, 0, v110
    v_add_f32 v106, 0x3727c5ac, v106
    v_add_f32 v110, 0x3727c5ac, v110
    v_rsq_f32_e64 v105, v106
    v_mfma_f32_32x32x16_bf16 v[176:191], v[228:231], v[240:243], v[176:191]
    ds_read_b64_tr_b16 v[236:237], v65 offset:3872
    ds_read_b64_tr_b16 v[238:239], v65 offset:3840
    v_rsq_f32_e64 v109, v110
    v_mul_f32 v106, -v208, v105
    v_mul_f32 v110, -v209, v109
    v_mfma_f32_32x32x16_bf16 v[192:207], v[224:227], v[240:243], v[192:207]
    ds_read_b128 v[224:227], v64 offset:384
    ds_read_b64_tr_b16 v[244:245], v65 offset:928
    ds_read_b64_tr_b16 v[246:247], v65 offset:896
    v_lshlrev_b32 v88, 16, v252
    v_and_b32 v90, 0xffff0000, v252
    s_waitcnt lgkmcnt(5)
    v_mfma_f32_32x32x16_bf16 v[176:191], v[220:223], v[216:219], v[176:191]
    ds_read_b128 v[212:215], v64 offset:256
    ds_read_b64_tr_b16 v[232:233], v65 offset:1440
    ds_read_b64_tr_b16 v[234:235], v65 offset:1408
    v_lshlrev_b32 v92, 16, v253
    v_and_b32 v94, 0xffff0000, v253
    v_lshlrev_b32 v89, 16, v254
    v_mfma_f32_32x32x16_bf16 v[192:207], v[228:231], v[216:219], v[192:207]
    v_and_b32 v91, 0xffff0000, v254
    v_lshlrev_b32_e64 v93, 16, v255
    v_and_b32 v95, 0xffff0000, v255
    v_fma_f32 v208, v88, v105, v106
    v_fma_f32 v209, v89, v109, v110
    s_waitcnt lgkmcnt(6)
    v_mfma_f32_32x32x16_bf16 v[192:207], v[220:223], v[236:239], v[192:207]
    ds_read_b128 v[220:223], v64 offset:128
    ds_read_b64_tr_b16 v[228:229], v65 offset:1952
    ds_read_b64_tr_b16 v[230:231], v65 offset:1920
    v_cvt_pk_bf16_f32 v252, v208, v209
    v_fma_f32 v208, v90, v105, v106
    s_waitcnt lgkmcnt(6)
    v_mfma_f32_32x32x16_bf16 v[144:159], v[224:227], v[244:247], v[144:159]
    v_fma_f32 v209, v91, v109, v110
    v_cvt_pk_bf16_f32 v253, v208, v209
    v_fma_f32 v208, v92, v105, v106
    v_fma_f32 v209, v93, v109, v110
    v_cvt_pk_bf16_f32 v254, v208, v209
    s_waitcnt lgkmcnt(3)
    v_mfma_f32_32x32x16_bf16 v[144:159], v[212:215], v[232:235], v[144:159]
    v_fma_f32 v208, v94, v105, v106
    v_fma_f32 v209, v95, v109, v110
    v_cvt_pk_bf16_f32 v255, v208, v209
    v_mfma_f32_32x32x16_bf16 v[160:175], v[224:227], v[232:235], v[160:175]
    ds_read_b128 v[240:243], v64 offset:0
    ds_read_b64_tr_b16 v[216:217], v65 offset:2464
    ds_read_b64_tr_b16 v[218:219], v65 offset:2432
    ds_write_b32 v63, v252 offset:768
    s_waitcnt lgkmcnt(4)
    v_mfma_f32_32x32x16_bf16 v[144:159], v[220:223], v[228:231], v[144:159]
    ds_write_b32 v63, v253 offset:5632
    ds_write_b32 v63, v254 offset:10496
    ds_write_b32 v63, v255 offset:15360
    v_mfma_f32_32x32x16_bf16 v[160:175], v[212:215], v[228:231], v[160:175]
    s_waitcnt vmcnt(0)
    v_cmp_eq_u32 vcc, 19, v5
    s_nop 0
    s_cbranch_vccnz gl_34
gc_35:
    s_lshl_b32 s25, s72, 5
    s_add_u32 s25, s25, 0
    s_sub_u32 s26, s25, 4
    s_max_i32 s26, s26, 0
    v_mfma_f32_32x32x16_bf16 v[176:191], v[224:227], v[228:231], v[176:191]
    s_lshl_b32 s27, s71, 12
    s_add_u32 s27, s27, 9437184
    s_lshl_b32 s99, s25, 3
    s_lshl_b32 s100, s26, 3
    s_lshl_b32 s92, s24, 12
    s_waitcnt lgkmcnt(4)
    v_mfma_f32_32x32x16_bf16 v[144:159], v[240:243], v[216:219], v[144:159]
    ds_read_b64_tr_b16 v[236:237], v65 offset:2976
    ds_read_b64_tr_b16 v[238:239], v65 offset:2944
    s_lshl_b32 s93, s24, 9
    s_add_u32 s99, s99, s27
    s_add_u32 s100, s100, s27
    v_mfma_f32_32x32x16_bf16 v[160:175], v[220:223], v[216:219], v[160:175]
    v_mfma_f32_32x32x16_bf16 v[176:191], v[212:215], v[216:219], v[176:191]
    v_mfma_f32_32x32x16_bf16 v[192:207], v[224:227], v[216:219], v[192:207]
    ds_read_b64_tr_b16 v[224:225], v65 offset:3488
    ds_read_b64_tr_b16 v[226:227], v65 offset:3456
    s_waitcnt lgkmcnt(2)
    v_mfma_f32_32x32x16_bf16 v[160:175], v[240:243], v[236:239], v[160:175]
    v_mfma_f32_32x32x16_bf16 v[176:191], v[220:223], v[236:239], v[176:191]
    ds_read_b64_tr_b16 v[244:245], v65 offset:4000
    ds_read_b64_tr_b16 v[246:247], v65 offset:3968
    v_mfma_f32_32x32x16_bf16 v[192:207], v[212:215], v[236:239], v[192:207]
    s_waitcnt lgkmcnt(2)
    v_mfma_f32_32x32x16_bf16 v[176:191], v[240:243], v[224:227], v[176:191]
    v_mfma_f32_32x32x16_bf16 v[192:207], v[220:223], v[224:227], v[192:207]
    s_waitcnt lgkmcnt(0)
    v_mfma_f32_32x32x16_bf16 v[192:207], v[240:243], v[244:247], v[192:207]
    s_waitcnt lgkmcnt(0)
    s_barrier
    ds_read_b128 v[212:215], v64 offset:608
    ds_read_b128 v[216:219], v64 offset:576
    ds_read_b128 v[220:223], v64 offset:544
    ds_read_b128 v[224:227], v64 offset:512
    s_waitcnt lgkmcnt(3)
    v_mfma_f32_32x32x16_bf16 v[144:159], v[212:215], v[112:115], v[144:159]
    ds_read_b128 v[228:231], v64 offset:736
    s_waitcnt lgkmcnt(3)
    v_mfma_f32_32x32x16_bf16 v[144:159], v[216:219], v[116:119], v[144:159]
    ds_read_b128 v[232:235], v64 offset:704
    s_waitcnt lgkmcnt(3)
    v_mfma_f32_32x32x16_bf16 v[144:159], v[220:223], v[120:123], v[144:159]
    ds_read_b128 v[236:239], v64 offset:672
    s_waitcnt lgkmcnt(3)
    v_mfma_f32_32x32x16_bf16 v[144:159], v[224:227], v[124:127], v[144:159]
    ds_read_b128 v[240:243], v64 offset:640
    s_nop 3
    s_waitcnt lgkmcnt(3)
    v_mfma_f32_32x32x16_bf16 v[160:175], v[228:231], v[112:115], v[160:175]
    s_nop 4
    s_waitcnt lgkmcnt(2)
    v_mfma_f32_32x32x16_bf16 v[160:175], v[232:235], v[116:119], v[160:175]
    v_cndmask_b32 v208, v147, v72, s[76:77]
    v_cndmask_b32 v209, v151, v147, s[76:77]
    v_cndmask_b32 v210, v155, v151, s[76:77]
    v_cndmask_b32 v211, v159, v155, s[76:77]
    v_mov_b32_e64 v72, v159
    s_waitcnt lgkmcnt(1)
    v_mfma_f32_32x32x16_bf16 v[160:175], v[236:239], v[120:123], v[160:175]
    v_add_f32_dpp v146, v208, v146 wave_ror:1 row_mask:0xf bank_mask:0xf
    v_add_f32_dpp v150, v209, v150 wave_ror:1 row_mask:0xf bank_mask:0xf
    v_add_f32_dpp v154, v210, v154 wave_ror:1 row_mask:0xf bank_mask:0xf
    v_add_f32_dpp v158, v211, v158 wave_ror:1 row_mask:0xf bank_mask:0xf
    v_cndmask_b32 v208, v146, v71, s[76:77]
    s_waitcnt lgkmcnt(0)
    v_mfma_f32_32x32x16_bf16 v[160:175], v[240:243], v[124:127], v[160:175]
    v_cndmask_b32 v209, v150, v146, s[76:77]
    v_cndmask_b32 v210, v154, v150, s[76:77]
    v_cndmask_b32 v211, v158, v154, s[76:77]
    v_mov_b32 v71, v158
    v_add_f32_dpp v145, v208, v145 wave_ror:1 row_mask:0xf bank_mask:0xf
    v_add_f32_dpp v149, v209, v149 wave_ror:1 row_mask:0xf bank_mask:0xf
    v_mfma_f32_32x32x16_bf16 v[160:175], v[212:215], v[128:131], v[160:175]
    ds_read_b128 v[244:247], v64 offset:864
    v_add_f32_dpp v153, v210, v153 wave_ror:1 row_mask:0xf bank_mask:0xf
    v_add_f32_dpp v157, v211, v157 wave_ror:1 row_mask:0xf bank_mask:0xf
    v_cndmask_b32 v208, v145, v70, s[76:77]
    v_cndmask_b32 v209, v149, v145, s[76:77]
    v_cndmask_b32 v210, v153, v149, s[76:77]
    v_mfma_f32_32x32x16_bf16 v[160:175], v[216:219], v[132:135], v[160:175]
    ds_read_b128 v[248:251], v64 offset:832
    v_cndmask_b32 v211, v157, v153, s[76:77]
    v_mov_b32_e64 v70, v157
    v_add_f32_dpp v144, v208, v144 wave_ror:1 row_mask:0xf bank_mask:0xf
    v_add_f32_dpp v148, v209, v148 wave_ror:1 row_mask:0xf bank_mask:0xf
    v_add_f32_dpp v152, v210, v152 wave_ror:1 row_mask:0xf bank_mask:0xf
    v_mfma_f32_32x32x16_bf16 v[160:175], v[220:223], v[136:139], v[160:175]
    ds_read_b128 v[252:255], v64 offset:800
    v_add_f32_dpp v156, v211, v156 wave_ror:1 row_mask:0xf bank_mask:0xf
    ds_write_b32 v66, v144 offset:0
    v_mfma_f32_32x32x16_bf16 v[160:175], v[224:227], v[140:143], v[160:175]
    ds_read_b128 v[224:227], v64 offset:768
    ds_write_b32 v66, v148 offset:64
    ds_write_b32 v66, v152 offset:128
    s_waitcnt lgkmcnt(6)
    v_mfma_f32_32x32x16_bf16 v[176:191], v[244:247], v[112:115], v[176:191]
    ds_write_b32 v66, v156 offset:192
    s_nop 2
    s_waitcnt lgkmcnt(6)
    v_mfma_f32_32x32x16_bf16 v[176:191], v[248:251], v[116:119], v[176:191]
    s_nop 2
    v_cndmask_b32 v208, v163, v72, s[76:77]
    v_cndmask_b32 v209, v167, v163, s[76:77]
    s_waitcnt lgkmcnt(5)
    v_mfma_f32_32x32x16_bf16 v[176:191], v[252:255], v[120:123], v[176:191]
    v_cndmask_b32 v210, v171, v167, s[76:77]
    v_cndmask_b32 v211, v175, v171, s[76:77]
    v_mov_b32 v72, v175
    v_add_f32_dpp v162, v208, v162 wave_ror:1 row_mask:0xf bank_mask:0xf
    v_add_f32_dpp v166, v209, v166 wave_ror:1 row_mask:0xf bank_mask:0xf
    s_waitcnt lgkmcnt(3)
    v_mfma_f32_32x32x16_bf16 v[176:191], v[224:227], v[124:127], v[176:191]
    v_add_f32_dpp v170, v210, v170 wave_ror:1 row_mask:0xf bank_mask:0xf
    v_add_f32_dpp v174, v211, v174 wave_ror:1 row_mask:0xf bank_mask:0xf
    v_cndmask_b32 v208, v162, v71, s[76:77]
    v_cndmask_b32 v209, v166, v162, s[76:77]
    v_cndmask_b32 v210, v170, v166, s[76:77]
    v_cndmask_b32 v211, v174, v170, s[76:77]
    v_mfma_f32_32x32x16_bf16 v[176:191], v[228:231], v[128:131], v[176:191]
    ds_read_b64_tr_b16 v[228:229], v65 offset:1056
    ds_read_b64_tr_b16 v[230:231], v65 offset:1024
    v_mov_b32 v71, v174
    v_add_f32_dpp v161, v208, v161 wave_ror:1 row_mask:0xf bank_mask:0xf
    v_add_f32_dpp v165, v209, v165 wave_ror:1 row_mask:0xf bank_mask:0xf
    v_add_f32_dpp v169, v210, v169 wave_ror:1 row_mask:0xf bank_mask:0xf
    v_mfma_f32_32x32x16_bf16 v[176:191], v[232:235], v[132:135], v[176:191]
    ds_read_b64_tr_b16 v[232:233], v65 offset:1184
    ds_read_b64_tr_b16 v[234:235], v65 offset:1152
    v_add_f32_dpp v173, v211, v173 wave_ror:1 row_mask:0xf bank_mask:0xf
    v_cndmask_b32 v208, v161, v70, s[76:77]
    v_cndmask_b32 v209, v165, v161, s[76:77]
    v_cndmask_b32 v210, v169, v165, s[76:77]
    v_mfma_f32_32x32x16_bf16 v[176:191], v[236:239], v[136:139], v[176:191]
    ds_read_b64_tr_b16 v[236:237], v65 offset:1312
    ds_read_b64_tr_b16 v[238:239], v65 offset:1280
    v_cndmask_b32 v211, v173, v169, s[76:77]
    v_mov_b32_e64 v70, v173
    v_add_f32_dpp v160, v208, v160 wave_ror:1 row_mask:0xf bank_mask:0xf
    v_add_f32_dpp v164, v209, v164 wave_ror:1 row_mask:0xf bank_mask:0xf
    v_mfma_f32_32x32x16_bf16 v[176:191], v[240:243], v[140:143], v[176:191]
    ds_read_b128 v[240:243], v64 offset:512
    ds_read_b64_tr_b16 v[224:225], v65 offset:1440
    ds_read_b64_tr_b16 v[226:227], v65 offset:1408
    v_add_f32_dpp v168, v210, v168 wave_ror:1 row_mask:0xf bank_mask:0xf
    v_add_f32_dpp v172, v211, v172 wave_ror:1 row_mask:0xf bank_mask:0xf
    s_waitcnt lgkmcnt(7)
    v_mfma_f32_32x32x16_bf16 v[176:191], v[212:215], v[228:231], v[176:191]
    ds_read_b128 v[212:215], v64 offset:992
    ds_write_b32 v66, v160 offset:256
    ds_write_b32 v66, v164 offset:320
    s_waitcnt lgkmcnt(8)
    v_mfma_f32_32x32x16_bf16 v[176:191], v[216:219], v[232:235], v[176:191]
    ds_read_b128 v[216:219], v64 offset:960
    ds_write_b32 v66, v168 offset:384
    ds_write_b32 v66, v172 offset:448
    s_waitcnt lgkmcnt(9)
    v_mfma_f32_32x32x16_bf16 v[176:191], v[220:223], v[236:239], v[176:191]
    ds_read_b128 v[220:223], v64 offset:928
    s_waitcnt lgkmcnt(7)
    v_mfma_f32_32x32x16_bf16 v[176:191], v[240:243], v[224:227], v[176:191]
    ds_read_b128 v[240:243], v64 offset:896
    s_waitcnt lgkmcnt(2)
    s_barrier
    v_mfma_f32_32x32x16_bf16 v[192:207], v[212:215], v[112:115], v[192:207]
    ds_read_b64 v[144:145], v67 offset:0
    ds_read_b64 v[146:147], v67 offset:4224
    ds_read_b64 v[148:149], v67 offset:8448
    ds_read_b64 v[150:151], v67 offset:12672
    s_lshl_b32 s25, s75, 14
    v_mfma_f32_32x32x16_bf16 v[192:207], v[216:219], v[116:119], v[192:207]
    buffer_load_dword v7, v4, s[16:19], s89 offen offset:0 sc1
    s_add_u32 s25, s25, 9437184
    s_nop 0
    v_cndmask_b32 v208, v179, v72, s[76:77]
    v_cndmask_b32 v209, v183, v179, s[76:77]
    s_waitcnt lgkmcnt(5)
    v_mfma_f32_32x32x16_bf16 v[192:207], v[220:223], v[120:123], v[192:207]
    v_cndmask_b32 v210, v187, v183, s[76:77]
    v_cndmask_b32 v211, v191, v187, s[76:77]
    v_mov_b32 v72, v191
    v_add_f32_dpp v178, v208, v178 wave_ror:1 row_mask:0xf bank_mask:0xf
    v_add_f32_dpp v182, v209, v182 wave_ror:1 row_mask:0xf bank_mask:0xf
    s_waitcnt lgkmcnt(4)
    v_mfma_f32_32x32x16_bf16 v[192:207], v[240:243], v[124:127], v[192:207]
    ds_read_b128 v[212:215], v64 offset:768
    v_add_f32_dpp v186, v210, v186 wave_ror:1 row_mask:0xf bank_mask:0xf
    v_add_f32_dpp v190, v211, v190 wave_ror:1 row_mask:0xf bank_mask:0xf
    v_cndmask_b32 v208, v178, v71, s[76:77]
    v_cndmask_b32 v209, v182, v178, s[76:77]
    v_cndmask_b32 v210, v186, v182, s[76:77]
    v_mfma_f32_32x32x16_bf16 v[192:207], v[244:247], v[128:131], v[192:207]
    ds_read_b128 v[244:247], v64 offset:736
    v_cndmask_b32 v211, v190, v186, s[76:77]
    v_mov_b32 v71, v190
    v_add_f32_dpp v177, v208, v177 wave_ror:1 row_mask:0xf bank_mask:0xf
    v_add_f32_dpp v181, v209, v181 wave_ror:1 row_mask:0xf bank_mask:0xf
    v_add_f32_dpp v185, v210, v185 wave_ror:1 row_mask:0xf bank_mask:0xf
    v_mfma_f32_32x32x16_bf16 v[192:207], v[248:251], v[132:135], v[192:207]
    ds_read_b128 v[248:251], v64 offset:704
    v_add_f32_dpp v189, v211, v189 wave_ror:1 row_mask:0xf bank_mask:0xf
    v_cndmask_b32 v208, v177, v70, s[76:77]
    v_cndmask_b32 v209, v181, v177, s[76:77]
    v_cndmask_b32 v210, v185, v181, s[76:77]
    v_cndmask_b32 v211, v189, v185, s[76:77]
    v_mfma_f32_32x32x16_bf16 v[192:207], v[252:255], v[136:139], v[192:207]
    ds_read_b128 v[252:255], v64 offset:672
    v_mov_b32_e64 v70, v189
    v_add_f32_dpp v176, v208, v176 wave_ror:1 row_mask:0xf bank_mask:0xf
    v_add_f32_dpp v180, v209, v180 wave_ror:1 row_mask:0xf bank_mask:0xf
    v_add_f32_dpp v184, v210, v184 wave_ror:1 row_mask:0xf bank_mask:0xf
    s_waitcnt lgkmcnt(3)
    v_mfma_f32_32x32x16_bf16 v[192:207], v[212:215], v[140:143], v[192:207]
    ds_read_b128 v[216:219], v64 offset:640
    v_add_f32_dpp v188, v211, v188 wave_ror:1 row_mask:0xf bank_mask:0xf
    s_waitcnt lgkmcnt(3)
    v_mfma_f32_32x32x16_bf16 v[192:207], v[244:247], v[228:231], v[192:207]
    ds_read_b128 v[228:231], v64 offset:608
    ds_read_b64_tr_b16 v[220:221], v65 offset:1568
    ds_read_b64_tr_b16 v[222:223], v65 offset:1536
    ds_write_b32 v66, v176 offset:512
    s_waitcnt lgkmcnt(6)
    v_mfma_f32_32x32x16_bf16 v[192:207], v[248:251], v[232:235], v[192:207]
    ds_read_b128 v[232:235], v64 offset:576
    ds_read_b64_tr_b16 v[240:241], v65 offset:1696
    ds_read_b64_tr_b16 v[242:243], v65 offset:1664
    ds_write_b32 v66, v180 offset:576
    s_waitcnt lgkmcnt(9)
    v_mfma_f32_32x32x16_bf16 v[192:207], v[252:255], v[236:239], v[192:207]
    ds_read_b128 v[236:239], v64 offset:544
    ds_read_b64_tr_b16 v[212:213], v65 offset:1824
    ds_read_b64_tr_b16 v[214:215], v65 offset:1792
    ds_write_b32 v66, v184 offset:640
    s_waitcnt lgkmcnt(12)
    v_mfma_f32_32x32x16_bf16 v[192:207], v[216:219], v[224:227], v[192:207]
    ds_read_b128 v[224:227], v64 offset:512
    ds_read_b64_tr_b16 v[244:245], v65 offset:1952
    ds_read_b64_tr_b16 v[246:247], v65 offset:1920
    ds_write_b32 v66, v188 offset:704
    s_waitcnt lgkmcnt(13)
    v_mfma_f32_32x32x16_bf16 v[192:207], v[228:231], v[220:223], v[192:207]
    v_add_f32 v144, v144, v80
    v_add_f32 v145, v145, v81
    v_add_f32 v146, v146, v82
    v_add_f32 v147, v147, v83
    s_waitcnt lgkmcnt(9)
    v_mfma_f32_32x32x16_bf16 v[192:207], v[232:235], v[240:243], v[192:207]
    v_add_f32 v148, v148, v84
    v_add_f32 v149, v149, v85
    v_add_f32 v150, v150, v86
    v_add_f32 v151, v151, v87
    v_cvt_pk_bf16_f32 v160, v144, v146
    s_waitcnt lgkmcnt(5)
    v_mfma_f32_32x32x16_bf16 v[192:207], v[236:239], v[212:215], v[192:207]
    v_cvt_pk_bf16_f32 v161, v148, v150
    v_cvt_pk_bf16_f32 v162, v145, v147
    v_cvt_pk_bf16_f32 v163, v149, v151
    s_waitcnt lgkmcnt(1)
    v_mfma_f32_32x32x16_bf16 v[192:207], v[224:227], v[244:247], v[192:207]
    buffer_store_dwordx4 v[160:163], v62, s[16:19], s25 offen offset:2048 sc1
    s_nop 10
    v_cndmask_b32 v208, v195, v72, s[76:77]
    v_cndmask_b32 v209, v199, v195, s[76:77]
    v_cndmask_b32 v210, v203, v199, s[76:77]
    v_cndmask_b32 v211, v207, v203, s[76:77]
    v_mov_b32_e64 v72, v207
    v_add_f32_dpp v194, v208, v194 wave_ror:1 row_mask:0xf bank_mask:0xf
    v_add_f32_dpp v198, v209, v198 wave_ror:1 row_mask:0xf bank_mask:0xf
    v_add_f32_dpp v202, v210, v202 wave_ror:1 row_mask:0xf bank_mask:0xf
    v_add_f32_dpp v206, v211, v206 wave_ror:1 row_mask:0xf bank_mask:0xf
    v_cndmask_b32 v208, v194, v71, s[76:77]
    v_cndmask_b32 v209, v198, v194, s[76:77]
    v_cndmask_b32 v210, v202, v198, s[76:77]
    v_cndmask_b32 v211, v206, v202, s[76:77]
    v_mov_b32_e64 v71, v206
    v_add_f32_dpp v193, v208, v193 wave_ror:1 row_mask:0xf bank_mask:0xf
    v_add_f32_dpp v197, v209, v197 wave_ror:1 row_mask:0xf bank_mask:0xf
    v_add_f32_dpp v201, v210, v201 wave_ror:1 row_mask:0xf bank_mask:0xf
    v_add_f32_dpp v205, v211, v205 wave_ror:1 row_mask:0xf bank_mask:0xf
    v_cndmask_b32 v208, v193, v70, s[76:77]
    v_cndmask_b32 v209, v197, v193, s[76:77]
    v_cndmask_b32 v210, v201, v197, s[76:77]
    v_cndmask_b32 v211, v205, v201, s[76:77]
    v_mov_b32_e64 v70, v205
    v_add_f32_dpp v192, v208, v192 wave_ror:1 row_mask:0xf bank_mask:0xf
    v_add_f32_dpp v196, v209, v196 wave_ror:1 row_mask:0xf bank_mask:0xf
    v_add_f32_dpp v200, v210, v200 wave_ror:1 row_mask:0xf bank_mask:0xf
    v_add_f32_dpp v204, v211, v204 wave_ror:1 row_mask:0xf bank_mask:0xf
    ds_write_b32 v66, v192 offset:768
    ds_write_b32 v66, v196 offset:832
    ds_write_b32 v66, v200 offset:896
    ds_write_b32 v66, v204 offset:960
    s_waitcnt lgkmcnt(0)
    s_waitcnt vmcnt(1)
    v_cmp_gt_u32_e64 vcc, 1, v7
    s_nop 0
    s_and_b64 vcc, vcc, s[50:51]
    s_cbranch_scc1 ps_36
pc_38:
    s_barrier
    ds_read_b64 v[152:153], v67 offset:512
    ds_read_b64 v[154:155], v67 offset:4736
    ds_read_b64 v[156:157], v67 offset:8960
    ds_read_b64 v[158:159], v67 offset:13184
    s_add_u32 m0, s92, 36352
    s_nop 0
    s_nop 0
    buffer_load_dwordx4 v73, s[16:19], s99 offen offset:0 sc1 lds
    buffer_load_dwordx4 v74, s[16:19], s99 offen offset:1024 sc1 lds
    buffer_load_dwordx4 v75, s[16:19], s99 offen offset:2048 sc1 lds
    buffer_load_dwordx4 v76, s[16:19], s99 offen offset:3072 sc1 lds
    s_add_u32 m0, s93, 53760
    s_add_u32 s99, s99, 524288
    s_mov_b64 exec, s[80:81]
    buffer_load_dwordx4 v77, s[16:19], s100 offen sc1 lds
    s_mov_b64 exec, -1
    s_add_u32 s100, s100, 524288
    s_lshl_b32 s25, s75, 14
    s_add_u32 s25, s25, 9437184
    s_waitcnt lgkmcnt(0)
    v_add_f32 v152, v152, v88
    v_add_f32 v153, v153, v89
    v_add_f32 v154, v154, v90
    v_add_f32 v155, v155, v91
    v_add_f32 v156, v156, v92
    v_add_f32 v157, v157, v93
    v_add_f32 v158, v158, v94
    v_add_f32 v159, v159, v95
    v_cvt_pk_bf16_f32 v164, v152, v154
    v_cvt_pk_bf16_f32 v165, v156, v158
    v_cvt_pk_bf16_f32 v166, v153, v155
    v_cvt_pk_bf16_f32 v167, v157, v159
    buffer_store_dwordx4 v[164:167], v62, s[16:19], s25 offen offset:3072 sc1
    v_mov_b32_e64 v5, 1
    s_add_u32 s82, s86, 24576
    buffer_atomic_add v5, v6, s[16:19], s82 offen offset:4 sc0 sc1
    s_add_u32 m0, s92, 55936
    s_nop 0
    s_nop 0
    buffer_load_dwordx4 v73, s[16:19], s99 offen offset:0 sc1 lds
    buffer_load_dwordx4 v74, s[16:19], s99 offen offset:1024 sc1 lds
    buffer_load_dwordx4 v75, s[16:19], s99 offen offset:2048 sc1 lds
    buffer_load_dwordx4 v76, s[16:19], s99 offen offset:3072 sc1 lds
    s_add_u32 m0, s93, 73344
    s_add_u32 s99, s99, 524288
    s_mov_b64 exec, s[80:81]
    buffer_load_dwordx4 v77, s[16:19], s100 offen sc1 lds
    s_mov_b64 exec, -1
    s_add_u32 s100, s100, 524288
    s_branch ec_27
nc_26:
    v_mov_b32 v100, -1
    v_mov_b32 v101, -1
    v_mov_b32 v102, -1
    v_mov_b32 v103, -1
    v_lshlrev_b32 v104, 4, v0
    s_sub_u32 s88, s2, 160
    s_mul_i32 s88, s88, 57344
    s_min_u32 s88, s88, 5185536
    s_add_u32 s88, s88, 12058624
    buffer_store_dwordx4 v[100:103], v104, s[16:19], s88 offen sc1
    s_add_u32 s88, s88, 4096
    buffer_store_dwordx4 v[100:103], v104, s[16:19], s88 offen sc1
    s_add_u32 s88, s88, 4096
    buffer_store_dwordx4 v[100:103], v104, s[16:19], s88 offen sc1
    s_add_u32 s88, s88, 4096
    buffer_store_dwordx4 v[100:103], v104, s[16:19], s88 offen sc1
    s_add_u32 s88, s88, 4096
    buffer_store_dwordx4 v[100:103], v104, s[16:19], s88 offen sc1
    s_add_u32 s88, s88, 4096
    buffer_store_dwordx4 v[100:103], v104, s[16:19], s88 offen sc1
    s_add_u32 s88, s88, 4096
    buffer_store_dwordx4 v[100:103], v104, s[16:19], s88 offen sc1
    s_add_u32 s88, s88, 4096
    buffer_store_dwordx4 v[100:103], v104, s[16:19], s88 offen sc1
    s_add_u32 s88, s88, 4096
    buffer_store_dwordx4 v[100:103], v104, s[16:19], s88 offen sc1
    s_add_u32 s88, s88, 4096
    buffer_store_dwordx4 v[100:103], v104, s[16:19], s88 offen sc1
    s_add_u32 s88, s88, 4096
    buffer_store_dwordx4 v[100:103], v104, s[16:19], s88 offen sc1
    s_add_u32 s88, s88, 4096
    buffer_store_dwordx4 v[100:103], v104, s[16:19], s88 offen sc1
    s_add_u32 s88, s88, 4096
    buffer_store_dwordx4 v[100:103], v104, s[16:19], s88 offen sc1
    s_add_u32 s88, s88, 4096
    buffer_store_dwordx4 v[100:103], v104, s[16:19], s88 offen sc1
    s_waitcnt vmcnt(0)
    s_barrier
    v_mov_b32_e64 v5, 1
    s_add_u32 s82, s86, 8192
    buffer_atomic_add v5, v6, s[16:19], s82 offen offset:12 sc0 sc1
    s_waitcnt vmcnt(0)
    v_cmp_eq_u32 vcc, 11, v5
    s_nop 0
    s_cbranch_vccnz gl_39
gc_40:
    buffer_load_dword v7, v4, s[16:19], s89 offen offset:0 sc1
    s_waitcnt vmcnt(0)
    v_cmp_gt_u32 vcc, 1, v7
    s_nop 0
    s_and_b64 vcc, vcc, s[50:51]
    s_cbranch_scc1 ps_41
pc_43:
    s_barrier
    s_sub_u32 s3, s2, 160
    s_and_b32 s3, s3, 63
    s_add_u32 s3, s3, 0
    s_and_b32 s25, s3, 3
    s_lshl_b32 s25, s25, 12
    s_lshr_b32 s26, s3, 2
    s_lshl_b32 s26, s26, 7
    s_add_u32 s3, s25, s26
    v_lshrrev_b32 v236, 3, v0
    v_and_b32 v237, 7, v0
    v_lshlrev_b32 v237, 4, v237
    v_lshl_add_u32 v236, v236, 14, v237
    s_sub_u32 s25, s2, 160
    s_cmp_lt_u32 s25, 64
    s_cselect_b32 s25, 0, 1073741824
    v_add_u32_e64 v236, s25, v236
    s_add_u32 s26, s3, 9437184
    buffer_load_dwordx4 v[216:219], v236, s[16:19], s26 offen sc1
    s_add_u32 s26, s26, 524288
    buffer_load_dwordx4 v[220:223], v236, s[16:19], s26 offen sc1
    s_add_u32 s26, s26, 524288
    buffer_load_dwordx4 v[224:227], v236, s[16:19], s26 offen sc1
    s_add_u32 s26, s26, 524288
    buffer_load_dwordx4 v[228:231], v236, s[16:19], s26 offen sc1
    s_add_u32 s26, s26, 524288
    buffer_load_dwordx4 v[232:235], v236, s[16:19], s26 offen sc1
    s_lshl_b32 s25, s72, 5
    s_add_u32 s25, s25, 0
    s_sub_u32 s26, s25, 4
    s_max_i32 s26, s26, 0
    s_lshl_b32 s27, s71, 12
    s_add_u32 s27, s27, 9437184
    s_lshl_b32 s99, s25, 3
    s_lshl_b32 s100, s26, 3
    s_lshl_b32 s92, s24, 12
    s_lshl_b32 s93, s24, 9
    s_add_u32 s99, s99, s27
    s_add_u32 s100, s100, s27
    s_add_u32 m0, s92, 36352
    s_nop 0
    buffer_load_dwordx4 v73, s[16:19], s99 offen offset:0 sc1 lds
    buffer_load_dwordx4 v74, s[16:19], s99 offen offset:1024 sc1 lds
    buffer_load_dwordx4 v75, s[16:19], s99 offen offset:2048 sc1 lds
    buffer_load_dwordx4 v76, s[16:19], s99 offen offset:3072 sc1 lds
    s_add_u32 m0, s93, 53760
    s_add_u32 s99, s99, 524288
    s_mov_b64 exec, s[80:81]
    buffer_load_dwordx4 v77, s[16:19], s100 offen sc1 lds
    s_mov_b64 exec, -1
    s_add_u32 s100, s100, 524288
    s_add_u32 m0, s92, 55936
    s_nop 0
    s_nop 0
    buffer_load_dwordx4 v73, s[16:19], s99 offen offset:0 sc1 lds
    buffer_load_dwordx4 v74, s[16:19], s99 offen offset:1024 sc1 lds
    buffer_load_dwordx4 v75, s[16:19], s99 offen offset:2048 sc1 lds
    buffer_load_dwordx4 v76, s[16:19], s99 offen offset:3072 sc1 lds
    s_add_u32 m0, s93, 73344
    s_add_u32 s99, s99, 524288
    s_mov_b64 exec, s[80:81]
    buffer_load_dwordx4 v77, s[16:19], s100 offen sc1 lds
    s_mov_b64 exec, -1
    s_add_u32 s100, s100, 524288
    s_sub_u32 s85, s2, 160
    s_cmp_ge_u32 s85, 64
    s_cbranch_scc1 s2_44
    v_mov_b32 v238, 0x3f803f80
    s_lshl_b32 s25, s24, 7
    s_add_u32 s25, s25, 134272
    v_lshrrev_b32 v239, 4, v1
    v_lshl_add_u32 v237, v239, 2, v237
    v_add_u32 v237, s25, v237
se_45:
    v_mov_b32 v240, 0
    v_mov_b32 v241, 0
    v_mov_b32 v242, 0
    v_mov_b32 v243, 0
    s_waitcnt vmcnt(14)
    v_dot2c_f32_bf16 v240, v216, v238
    v_dot2c_f32_bf16 v241, v216, v216
    v_dot2c_f32_bf16 v240, v217, v238
    v_dot2c_f32_bf16 v241, v217, v217
    v_dot2c_f32_bf16 v242, v218, v238
    v_dot2c_f32_bf16 v243, v218, v218
    v_dot2c_f32_bf16 v242, v219, v238
    v_dot2c_f32_bf16 v243, v219, v219
    s_waitcnt vmcnt(13)
    v_dot2c_f32_bf16 v240, v220, v238
    v_dot2c_f32_bf16 v241, v220, v220
    v_dot2c_f32_bf16 v240, v221, v238
    v_dot2c_f32_bf16 v241, v221, v221
    v_dot2c_f32_bf16 v242, v222, v238
    v_dot2c_f32_bf16 v243, v222, v222
    v_dot2c_f32_bf16 v242, v223, v238
    v_dot2c_f32_bf16 v243, v223, v223
    s_waitcnt vmcnt(12)
    v_dot2c_f32_bf16 v240, v224, v238
    v_dot2c_f32_bf16 v241, v224, v224
    v_dot2c_f32_bf16 v240, v225, v238
    v_dot2c_f32_bf16 v241, v225, v225
    v_dot2c_f32_bf16 v242, v226, v238
    v_dot2c_f32_bf16 v243, v226, v226
    v_dot2c_f32_bf16 v242, v227, v238
    v_dot2c_f32_bf16 v243, v227, v227
    s_waitcnt vmcnt(11)
    v_dot2c_f32_bf16 v240, v228, v238
    v_dot2c_f32_bf16 v241, v228, v228
    v_dot2c_f32_bf16 v240, v229, v238
    v_dot2c_f32_bf16 v241, v229, v229
    v_dot2c_f32_bf16 v242, v230, v238
    v_dot2c_f32_bf16 v243, v230, v230
    v_dot2c_f32_bf16 v242, v231, v238
    v_dot2c_f32_bf16 v243, v231, v231
    s_waitcnt vmcnt(10)
    v_dot2c_f32_bf16 v240, v232, v238
    v_dot2c_f32_bf16 v241, v232, v232
    v_dot2c_f32_bf16 v240, v233, v238
    v_dot2c_f32_bf16 v241, v233, v233
    v_dot2c_f32_bf16 v242, v234, v238
    v_dot2c_f32_bf16 v243, v234, v234
    v_dot2c_f32_bf16 v242, v235, v238
    v_dot2c_f32_bf16 v243, v235, v235
    s_nop 2
    v_cmp_u_f32 vcc, v241, v243
    s_nop 0
    s_cbranch_vccnz rd_46
rc_47:
    v_permlane32_swap_b32 v240, v242
    v_permlane32_swap_b32 v241, v243
    v_pk_add_f32 v[240:241], v[240:241], v[242:243]
    s_nop 1
    v_permlane16_swap_b32 v240, v241
    v_add_f32 v240, v240, v241
    s_nop 1
    v_add_f32_dpp v240, v240, v240 row_ror:8 row_mask:0xf bank_mask:0xf
    ds_write_b32 v237, v240
    v_and_b32 v236, 15, v0
    v_lshlrev_b32 v236, 3, v236
    v_add_u32 v237, 134272, v236
    v_mov_b32 v239, 1073741824
    v_cmp_gt_u32 vcc, 16, v0
    s_nop 1
    v_cndmask_b32 v236, v239, v236, vcc
    s_add_u32 s25, s3, 3457024
    s_waitcnt lgkmcnt(0)
    s_barrier
    ds_read_b64 v[216:217], v237 offset:0
    ds_read_b64 v[218:219], v237 offset:128
    ds_read_b64 v[220:221], v237 offset:256
    ds_read_b64 v[222:223], v237 offset:384
    s_waitcnt lgkmcnt(2)
    v_pk_add_f32 v[216:217], v[216:217], v[218:219]
    s_waitcnt lgkmcnt(0)
    v_pk_add_f32 v[220:221], v[220:221], v[222:223]
    v_pk_add_f32 v[216:217], v[216:217], v[220:221]
    v_mul_f32 v239, 0x3acccccd, v216
    v_mul_f32 v217, 0x3acccccd, v217
    v_fma_f32 v217, -v239, v239, v217
    v_max_f32 v217, 0, v217
    v_add_f32 v217, 0x3727c5ac, v217
    v_rsq_f32_e64 v216, v217
    s_nop 0
    v_mul_f32 v217, -v239, v216
    buffer_store_dwordx2 v[216:217], v236, s[16:19], s25 offen sc1
s2_44:
ec_27:
ge_48:
    v_add_u32 v196, 36352, v78
    v_mov_b32_e64 v198, v79
    s_waitcnt vmcnt(5)
    s_barrier
    ds_read_b64 v[160:161], v198 offset:0
    ds_read_b64 v[162:163], v198 offset:64
    ds_read_b64 v[164:165], v196 offset:0
    ds_read_b64 v[166:167], v196 offset:512
    ds_read_b64 v[168:169], v196 offset:256
    ds_read_b64 v[170:171], v196 offset:768
    ds_read_b64 v[172:173], v198 offset:256
    ds_read_b64 v[174:175], v198 offset:320
    ds_read_b64 v[176:177], v196 offset:2048
    ds_read_b64 v[178:179], v196 offset:2560
    ds_read_b64 v[180:181], v196 offset:2304
    ds_read_b64 v[182:183], v196 offset:2816
    s_waitcnt lgkmcnt(6)
    v_mfma_f32_16x16x32_bf16 v[112:115], a[0:3], v[160:163], 0
    ds_read_b64 v[184:185], v198 offset:512
    v_mfma_f32_32x32x16_bf16 v[80:95], a[0:3], v[164:167], 0
    ds_read_b64 v[186:187], v198 offset:576
    ds_read_b64 v[188:189], v196 offset:4096
    ds_read_b64 v[190:191], v196 offset:4608
    v_mov_b32 v208, 0
    v_mov_b32_e64 v209, 0
    v_mfma_f32_32x32x16_bf16 v[96:111], a[0:3], v[168:171], 0
    ds_read_b64 v[192:193], v196 offset:4352
    ds_read_b64 v[194:195], v196 offset:4864
    s_add_u32 m0, s92, 75520
    s_nop 0
    buffer_load_dwordx4 v73, s[16:19], s99 offen offset:0 sc1 lds
    s_waitcnt lgkmcnt(6)
    v_mfma_f32_16x16x32_bf16 v[112:115], a[4:7], v[172:175], v[112:115]
    ds_read_b64 v[160:161], v198 offset:768
    v_mfma_f32_32x32x16_bf16 v[80:95], a[4:7], v[176:179], v[80:95]
    ds_read_b64 v[162:163], v198 offset:832
    ds_read_b64 v[164:165], v196 offset:6144
    ds_read_b64 v[166:167], v196 offset:6656
    v_lshrrev_b32_e64 v210, 5, v0
    v_mul_u32_u24 v210, 1600, v210
    v_mfma_f32_32x32x16_bf16 v[96:111], a[4:7], v[180:183], v[96:111]
    ds_read_b64 v[168:169], v196 offset:6400
    ds_read_b64 v[170:171], v196 offset:6912
    buffer_load_dwordx4 v74, s[16:19], s99 offen offset:1024 sc1 lds
    v_and_b32 v211, 31, v0
    s_waitcnt lgkmcnt(6)
    v_mfma_f32_16x16x32_bf16 v[112:115], a[8:11], v[184:187], v[112:115]
    ds_read_b64 v[172:173], v198 offset:1024
    v_mfma_f32_32x32x16_bf16 v[80:95], a[8:11], v[188:191], v[80:95]
    ds_read_b64 v[174:175], v198 offset:1088
    ds_read_b64 v[176:177], v196 offset:8192
    ds_read_b64 v[178:179], v196 offset:8704
    v_min_u32_e64 v211, 19, v211
    v_lshl_add_u32 v210, v211, 3, v210
    v_mfma_f32_32x32x16_bf16 v[96:111], a[8:11], v[192:195], v[96:111]
    ds_read_b64 v[180:181], v196 offset:8448
    ds_read_b64 v[182:183], v196 offset:8960
    buffer_load_dwordx4 v75, s[16:19], s99 offen offset:2048 sc1 lds
    v_add_u32 v210, 6400, v210
    s_waitcnt lgkmcnt(6)
    v_mfma_f32_16x16x32_bf16 v[112:115], a[12:15], v[160:163], v[112:115]
    ds_read_b64 v[184:185], v198 offset:1280
    v_mfma_f32_32x32x16_bf16 v[80:95], a[12:15], v[164:167], v[80:95]
    ds_read_b64 v[186:187], v198 offset:1344
    ds_read_b64 v[188:189], v196 offset:10240
    ds_read_b64 v[190:191], v196 offset:10752
    ds_write_b64 v210, v[208:209]
    v_mfma_f32_32x32x16_bf16 v[96:111], a[12:15], v[168:171], v[96:111]
    ds_read_b64 v[192:193], v196 offset:10496
    ds_read_b64 v[194:195], v196 offset:11008
    buffer_load_dwordx4 v76, s[16:19], s99 offen offset:3072 sc1 lds
    s_waitcnt lgkmcnt(7)
    v_mfma_f32_16x16x32_bf16 v[112:115], a[16:19], v[172:175], v[112:115]
    ds_read_b64 v[160:161], v198 offset:1536
    v_mfma_f32_32x32x16_bf16 v[80:95], a[16:19], v[176:179], v[80:95]
    ds_read_b64 v[162:163], v198 offset:1600
    ds_read_b64 v[164:165], v196 offset:12288
    ds_read_b64 v[166:167], v196 offset:12800
    v_mfma_f32_32x32x16_bf16 v[96:111], a[16:19], v[180:183], v[96:111]
    ds_read_b64 v[168:169], v196 offset:12544
    ds_read_b64 v[170:171], v196 offset:13056
    s_add_u32 m0, s93, 92928
    s_add_u32 s99, s99, 524288
    s_mov_b64 exec, s[80:81]
    buffer_load_dwordx4 v77, s[16:19], s100 offen sc1 lds
    s_mov_b64 exec, -1
    s_add_u32 s100, s100, 524288
    s_waitcnt lgkmcnt(6)
    v_mfma_f32_16x16x32_bf16 v[112:115], a[20:23], v[184:187], v[112:115]
    ds_read_b64 v[172:173], v198 offset:1792
    v_mfma_f32_32x32x16_bf16 v[80:95], a[20:23], v[188:191], v[80:95]
    ds_read_b64 v[174:175], v198 offset:1856
    ds_read_b64 v[176:177], v196 offset:14336
    ds_read_b64 v[178:179], v196 offset:14848
    v_mfma_f32_32x32x16_bf16 v[96:111], a[20:23], v[192:195], v[96:111]
    ds_read_b64 v[180:181], v196 offset:14592
    ds_read_b64 v[182:183], v196 offset:15104
    buffer_load_dword v7, v4, s[16:19], s87 offen offset:12 sc1
    v_cmp_eq_u32 vcc, 19, v5
    s_nop 0
    s_cbranch_vccnz gl_49
gc_50:
    s_waitcnt vmcnt(6)
    s_barrier
    s_waitcnt lgkmcnt(6)
    v_mfma_f32_16x16x32_bf16 v[112:115], a[24:27], v[160:163], v[112:115]
    v_add_u32 v198, v49, v198
    v_mfma_f32_32x32x16_bf16 v[80:95], a[24:27], v[164:167], v[80:95]
    v_add_u32 v196, 19584, v196
    ds_read_b64 v[184:185], v198 offset:0
    ds_read_b64 v[186:187], v198 offset:64
    ds_read_b64 v[188:189], v196 offset:0
    v_mfma_f32_32x32x16_bf16 v[96:111], a[24:27], v[168:171], v[96:111]
    ds_read_b64 v[190:191], v196 offset:512
    ds_read_b64 v[192:193], v196 offset:256
    ds_read_b64 v[194:195], v196 offset:768
    s_add_u32 m0, s92, 95104
    s_nop 0
    buffer_load_dwordx4 v73, s[16:19], s99 offen offset:0 sc1 lds
    s_waitcnt lgkmcnt(6)
    v_mfma_f32_16x16x32_bf16 v[112:115], a[28:31], v[172:175], v[112:115]
    ds_read_b64 v[160:161], v198 offset:256
    v_mfma_f32_32x32x16_bf16 v[80:95], a[28:31], v[176:179], v[80:95]
    ds_read_b64 v[162:163], v198 offset:320
    ds_read_b64 v[164:165], v196 offset:2048
    ds_read_b64 v[166:167], v196 offset:2560
    v_mfma_f32_32x32x16_bf16 v[96:111], a[28:31], v[180:183], v[96:111]
    ds_read_b64 v[168:169], v196 offset:2304
    ds_read_b64 v[170:171], v196 offset:2816
    buffer_load_dwordx4 v74, s[16:19], s99 offen offset:1024 sc1 lds
    s_waitcnt lgkmcnt(6)
    v_mfma_f32_16x16x32_bf16 v[112:115], a[32:35], v[184:187], v[112:115]
    ds_read_b64 v[172:173], v198 offset:512
    v_mfma_f32_32x32x16_bf16 v[80:95], a[32:35], v[188:191], v[80:95]
    ds_read_b64 v[174:175], v198 offset:576
    ds_read_b64 v[176:177], v196 offset:4096
    ds_read_b64 v[178:179], v196 offset:4608
    v_mfma_f32_32x32x16_bf16 v[96:111], a[32:35], v[192:195], v[96:111]
    ds_read_b64 v[180:181], v196 offset:4352
    ds_read_b64 v[182:183], v196 offset:4864
    buffer_load_dwordx4 v75, s[16:19], s99 offen offset:2048 sc1 lds
    s_waitcnt lgkmcnt(6)
    v_mfma_f32_16x16x32_bf16 v[112:115], a[36:39], v[160:163], v[112:115]
    ds_read_b64 v[184:185], v198 offset:768
    v_mfma_f32_32x32x16_bf16 v[80:95], a[36:39], v[164:167], v[80:95]
    ds_read_b64 v[186:187], v198 offset:832
    ds_read_b64 v[188:189], v196 offset:6144
    ds_read_b64 v[190:191], v196 offset:6656
    v_mfma_f32_32x32x16_bf16 v[96:111], a[36:39], v[168:171], v[96:111]
    ds_read_b64 v[192:193], v196 offset:6400
    ds_read_b64 v[194:195], v196 offset:6912
    buffer_load_dwordx4 v76, s[16:19], s99 offen offset:3072 sc1 lds
    s_waitcnt lgkmcnt(6)
    v_mfma_f32_16x16x32_bf16 v[112:115], a[40:43], v[172:175], v[112:115]
    ds_read_b64 v[160:161], v198 offset:1024
    v_mfma_f32_32x32x16_bf16 v[80:95], a[40:43], v[176:179], v[80:95]
    ds_read_b64 v[162:163], v198 offset:1088
    ds_read_b64 v[164:165], v196 offset:8192
    ds_read_b64 v[166:167], v196 offset:8704
    v_mfma_f32_32x32x16_bf16 v[96:111], a[40:43], v[180:183], v[96:111]
    ds_read_b64 v[168:169], v196 offset:8448
    ds_read_b64 v[170:171], v196 offset:8960
    s_add_u32 m0, s93, 112512
    s_add_u32 s99, s99, 524288
    s_mov_b64 exec, s[80:81]
    buffer_load_dwordx4 v77, s[16:19], s100 offen sc1 lds
    s_mov_b64 exec, -1
    s_add_u32 s100, s100, 524288
    s_waitcnt lgkmcnt(6)
    v_mfma_f32_16x16x32_bf16 v[112:115], a[44:47], v[184:187], v[112:115]
    ds_read_b64 v[172:173], v198 offset:1280
    v_mfma_f32_32x32x16_bf16 v[80:95], a[44:47], v[188:191], v[80:95]
    ds_read_b64 v[174:175], v198 offset:1344
    ds_read_b64 v[176:177], v196 offset:10240
    ds_read_b64 v[178:179], v196 offset:10752
    v_mfma_f32_32x32x16_bf16 v[96:111], a[44:47], v[192:195], v[96:111]
    ds_read_b64 v[180:181], v196 offset:10496
    ds_read_b64 v[182:183], v196 offset:11008
    s_add_u32 m0, s92, 114688
    s_nop 0
    buffer_load_dwordx4 v73, s[16:19], s99 offen offset:0 sc1 lds
    s_waitcnt lgkmcnt(6)
    v_mfma_f32_16x16x32_bf16 v[112:115], a[48:51], v[160:163], v[112:115]
    ds_read_b64 v[184:185], v198 offset:1536
    v_mfma_f32_32x32x16_bf16 v[80:95], a[48:51], v[164:167], v[80:95]
    ds_read_b64 v[186:187], v198 offset:1600
    ds_read_b64 v[188:189], v196 offset:12288
    ds_read_b64 v[190:191], v196 offset:12800
    v_mfma_f32_32x32x16_bf16 v[96:111], a[48:51], v[168:171], v[96:111]
    ds_read_b64 v[192:193], v196 offset:12544
    ds_read_b64 v[194:195], v196 offset:13056
    buffer_load_dwordx4 v74, s[16:19], s99 offen offset:1024 sc1 lds
    s_waitcnt lgkmcnt(6)
    v_mfma_f32_16x16x32_bf16 v[112:115], a[52:55], v[172:175], v[112:115]
    ds_read_b64 v[160:161], v198 offset:1792
    v_mfma_f32_32x32x16_bf16 v[80:95], a[52:55], v[176:179], v[80:95]
    ds_read_b64 v[162:163], v198 offset:1856
    ds_read_b64 v[164:165], v196 offset:14336
    ds_read_b64 v[166:167], v196 offset:14848
    v_mfma_f32_32x32x16_bf16 v[96:111], a[52:55], v[180:183], v[96:111]
    ds_read_b64 v[168:169], v196 offset:14592
    ds_read_b64 v[170:171], v196 offset:15104
    buffer_load_dwordx4 v75, s[16:19], s99 offen offset:2048 sc1 lds
    s_waitcnt vmcnt(8)
    v_cmp_gt_u32 vcc, 1, v7
    s_nop 0
    s_and_b64 vcc, vcc, s[50:51]
    s_cbranch_scc1 ps_51
pc_53:
    s_barrier
    s_waitcnt lgkmcnt(6)
    v_mfma_f32_16x16x32_bf16 v[112:115], a[56:59], v[184:187], v[112:115]
    v_add_u32_e64 v198, v49, v198
    v_mfma_f32_32x32x16_bf16 v[80:95], a[56:59], v[188:191], v[80:95]
    v_add_u32 v196, 19584, v196
    ds_read_b64 v[172:173], v198 offset:0
    ds_read_b64 v[174:175], v198 offset:64
    ds_read_b64 v[176:177], v196 offset:0
    v_mfma_f32_32x32x16_bf16 v[96:111], a[56:59], v[192:195], v[96:111]
    ds_read_b64 v[178:179], v196 offset:512
    ds_read_b64 v[180:181], v196 offset:256
    ds_read_b64 v[182:183], v196 offset:768
    buffer_load_dwordx4 v76, s[16:19], s99 offen offset:3072 sc1 lds
    s_waitcnt lgkmcnt(6)
    v_mfma_f32_16x16x32_bf16 v[112:115], a[60:63], v[160:163], v[112:115]
    ds_read_b64 v[184:185], v198 offset:256
    v_mfma_f32_32x32x16_bf16 v[80:95], a[60:63], v[164:167], v[80:95]
    ds_read_b64 v[186:187], v198 offset:320
    ds_read_b64 v[188:189], v196 offset:2048
    ds_read_b64 v[190:191], v196 offset:2560
    v_mfma_f32_32x32x16_bf16 v[96:111], a[60:63], v[168:171], v[96:111]
    ds_read_b64 v[192:193], v196 offset:2304
    ds_read_b64 v[194:195], v196 offset:2816
    s_add_u32 m0, s93, 132096
    s_add_u32 s99, s99, 524288
    s_mov_b64 exec, s[80:81]
    buffer_load_dwordx4 v77, s[16:19], s100 offen sc1 lds
    s_mov_b64 exec, -1
    s_add_u32 s100, s100, 524288
    s_waitcnt lgkmcnt(6)
    v_mfma_f32_16x16x32_bf16 v[112:115], a[64:67], v[172:175], v[112:115]
    ds_read_b64 v[160:161], v198 offset:512
    v_mfma_f32_32x32x16_bf16 v[80:95], a[64:67], v[176:179], v[80:95]
    ds_read_b64 v[162:163], v198 offset:576
    ds_read_b64 v[164:165], v196 offset:4096
    ds_read_b64 v[166:167], v196 offset:4608
    v_mfma_f32_32x32x16_bf16 v[96:111], a[64:67], v[180:183], v[96:111]
    ds_read_b64 v[168:169], v196 offset:4352
    ds_read_b64 v[170:171], v196 offset:4864
    s_lshl_b32 s25, s72, 5
    s_add_u32 s25, s25, 256
    s_sub_u32 s26, s25, 4
    s_max_i32 s26, s26, 0
    s_lshl_b32 s27, s71, 12
    s_add_u32 s27, s27, 9437184
    s_lshl_b32 s99, s25, 3
    s_lshl_b32 s100, s26, 3
    s_lshl_b32 s92, s24, 12
    s_lshl_b32 s93, s24, 9
    s_add_u32 s99, s99, s27
    s_add_u32 s100, s100, s27
    s_waitcnt lgkmcnt(6)
    v_mfma_f32_16x16x32_bf16 v[112:115], a[68:71], v[184:187], v[112:115]
    ds_read_b64 v[172:173], v198 offset:768
    v_mfma_f32_32x32x16_bf16 v[80:95], a[68:71], v[188:191], v[80:95]
    ds_read_b64 v[174:175], v198 offset:832
    ds_read_b64 v[176:177], v196 offset:6144
    ds_read_b64 v[178:179], v196 offset:6656
    v_mfma_f32_32x32x16_bf16 v[96:111], a[68:71], v[192:195], v[96:111]
    ds_read_b64 v[180:181], v196 offset:6400
    ds_read_b64 v[182:183], v196 offset:6912
    s_waitcnt lgkmcnt(6)
    v_mfma_f32_16x16x32_bf16 v[112:115], a[72:75], v[160:163], v[112:115]
    ds_read_b64 v[184:185], v198 offset:1024
    v_mfma_f32_32x32x16_bf16 v[80:95], a[72:75], v[164:167], v[80:95]
    ds_read_b64 v[186:187], v198 offset:1088
    ds_read_b64 v[188:189], v196 offset:8192
    ds_read_b64 v[190:191], v196 offset:8704
    v_mfma_f32_32x32x16_bf16 v[96:111], a[72:75], v[168:171], v[96:111]
    ds_read_b64 v[192:193], v196 offset:8448
    ds_read_b64 v[194:195], v196 offset:8960
    s_waitcnt lgkmcnt(6)
    v_mfma_f32_16x16x32_bf16 v[112:115], a[76:79], v[172:175], v[112:115]
    ds_read_b64 v[160:161], v198 offset:1280
    v_mfma_f32_32x32x16_bf16 v[80:95], a[76:79], v[176:179], v[80:95]
    ds_read_b64 v[162:163], v198 offset:1344
    ds_read_b64 v[164:165], v196 offset:10240
    ds_read_b64 v[166:167], v196 offset:10752
    v_mfma_f32_32x32x16_bf16 v[96:111], a[76:79], v[180:183], v[96:111]
    ds_read_b64 v[168:169], v196 offset:10496
    ds_read_b64 v[170:171], v196 offset:11008
    s_waitcnt lgkmcnt(6)
    v_mfma_f32_16x16x32_bf16 v[112:115], a[80:83], v[184:187], v[112:115]
    ds_read_b64 v[172:173], v198 offset:1536
    v_mfma_f32_32x32x16_bf16 v[80:95], a[80:83], v[188:191], v[80:95]
    ds_read_b64 v[174:175], v198 offset:1600
    ds_read_b64 v[176:177], v196 offset:12288
    ds_read_b64 v[178:179], v196 offset:12800
    v_mfma_f32_32x32x16_bf16 v[96:111], a[80:83], v[192:195], v[96:111]
    ds_read_b64 v[180:181], v196 offset:12544
    ds_read_b64 v[182:183], v196 offset:13056
    s_lshl_b32 s98, s72, 5
    s_add_u32 s98, s98, 0
    s_sub_u32 s95, s98, 4
    s_max_i32 s95, s95, 0
    s_lshl_b32 s94, s98, 3
    s_lshl_b32 s95, s95, 3
    s_add_u32 s94, s94, 3457024
    s_add_u32 s95, s95, 3457024
    s_add_u32 s96, s94, 8192
    buffer_load_dwordx2 v[152:153], v47, s[16:19], s94 offen sc1
    s_waitcnt lgkmcnt(6)
    v_mfma_f32_16x16x32_bf16 v[112:115], a[84:87], v[160:163], v[112:115]
    ds_read_b64 v[184:185], v198 offset:1792
    v_mfma_f32_32x32x16_bf16 v[80:95], a[84:87], v[164:167], v[80:95]
    ds_read_b64 v[186:187], v198 offset:1856
    ds_read_b64 v[188:189], v196 offset:14336
    ds_read_b64 v[190:191], v196 offset:14848
    v_mfma_f32_32x32x16_bf16 v[96:111], a[84:87], v[168:171], v[96:111]
    ds_read_b64 v[192:193], v196 offset:14592
    ds_read_b64 v[194:195], v196 offset:15104
    buffer_load_dwordx2 v[154:155], v47, s[16:19], s96 offen sc1
    s_waitcnt vmcnt(7)
    s_barrier
    s_waitcnt lgkmcnt(6)
    v_mfma_f32_16x16x32_bf16 v[112:115], a[88:91], v[172:175], v[112:115]
    v_add_u32_e64 v198, v49, v198
    v_mfma_f32_32x32x16_bf16 v[80:95], a[88:91], v[176:179], v[80:95]
    v_add_u32 v196, 19584, v196
    ds_read_b64 v[160:161], v198 offset:0
    ds_read_b64 v[162:163], v198 offset:64
    ds_read_b64 v[164:165], v196 offset:0
    v_mfma_f32_32x32x16_bf16 v[96:111], a[88:91], v[180:183], v[96:111]
    ds_read_b64 v[166:167], v196 offset:512
    ds_read_b64 v[168:169], v196 offset:256
    ds_read_b64 v[170:171], v196 offset:768
    buffer_load_dwordx2 v[156:157], v48, s[16:19], s95 offen sc1
    s_waitcnt lgkmcnt(6)
    v_mfma_f32_16x16x32_bf16 v[112:115], a[92:95], v[184:187], v[112:115]
    ds_read_b64 v[172:173], v198 offset:256
    v_mfma_f32_32x32x16_bf16 v[80:95], a[92:95], v[188:191], v[80:95]
    ds_read_b64 v[174:175], v198 offset:320
    ds_read_b64 v[176:177], v196 offset:2048
    ds_read_b64 v[178:179], v196 offset:2560
    v_mfma_f32_32x32x16_bf16 v[96:111], a[92:95], v[192:195], v[96:111]
    ds_read_b64 v[180:181], v196 offset:2304
    ds_read_b64 v[182:183], v196 offset:2816
    buffer_load_dword v7, v4, s[16:19], s89 offen offset:4 sc1
    s_waitcnt lgkmcnt(6)
    v_mfma_f32_16x16x32_bf16 v[112:115], a[96:99], v[160:163], v[112:115]
    ds_read_b64 v[184:185], v198 offset:512
    v_mfma_f32_32x32x16_bf16 v[80:95], a[96:99], v[164:167], v[80:95]
    ds_read_b64 v[186:187], v198 offset:576
    ds_read_b64 v[188:189], v196 offset:4096
    ds_read_b64 v[190:191], v196 offset:4608
    v_mfma_f32_32x32x16_bf16 v[96:111], a[96:99], v[168:171], v[96:111]
    ds_read_b64 v[192:193], v196 offset:4352
    ds_read_b64 v[194:195], v196 offset:4864
    s_waitcnt lgkmcnt(6)
    v_mfma_f32_16x16x32_bf16 v[112:115], a[100:103], v[172:175], v[112:115]
    ds_read_b64 v[160:161], v198 offset:768
    v_mfma_f32_32x32x16_bf16 v[80:95], a[100:103], v[176:179], v[80:95]
    ds_read_b64 v[162:163], v198 offset:832
    ds_read_b64 v[164:165], v196 offset:6144
    ds_read_b64 v[166:167], v196 offset:6656
    v_mfma_f32_32x32x16_bf16 v[96:111], a[100:103], v[180:183], v[96:111]
    ds_read_b64 v[168:169], v196 offset:6400
    ds_read_b64 v[170:171], v196 offset:6912
    s_waitcnt lgkmcnt(6)
    v_mfma_f32_16x16x32_bf16 v[112:115], a[104:107], v[184:187], v[112:115]
    ds_read_b64 v[172:173], v198 offset:1024
    v_mfma_f32_32x32x16_bf16 v[80:95], a[104:107], v[188:191], v[80:95]
    ds_read_b64 v[174:175], v198 offset:1088
    ds_read_b64 v[176:177], v196 offset:8192
    ds_read_b64 v[178:179], v196 offset:8704
    v_mfma_f32_32x32x16_bf16 v[96:111], a[104:107], v[192:195], v[96:111]
    ds_read_b64 v[180:181], v196 offset:8448
    ds_read_b64 v[182:183], v196 offset:8960
    s_waitcnt lgkmcnt(6)
    v_mfma_f32_16x16x32_bf16 v[112:115], a[108:111], v[160:163], v[112:115]
    ds_read_b64 v[184:185], v198 offset:1280
    v_mfma_f32_32x32x16_bf16 v[80:95], a[108:111], v[164:167], v[80:95]
    ds_read_b64 v[186:187], v198 offset:1344
    ds_read_b64 v[188:189], v196 offset:10240
    ds_read_b64 v[190:191], v196 offset:10752
    v_mfma_f32_32x32x16_bf16 v[96:111], a[108:111], v[168:171], v[96:111]
    ds_read_b64 v[192:193], v196 offset:10496
    ds_read_b64 v[194:195], v196 offset:11008
    s_waitcnt lgkmcnt(6)
    v_mfma_f32_16x16x32_bf16 v[112:115], a[112:115], v[172:175], v[112:115]
    ds_read_b64 v[160:161], v198 offset:1536
    v_mfma_f32_32x32x16_bf16 v[80:95], a[112:115], v[176:179], v[80:95]
    ds_read_b64 v[162:163], v198 offset:1600
    ds_read_b64 v[164:165], v196 offset:12288
    ds_read_b64 v[166:167], v196 offset:12800
    v_mfma_f32_32x32x16_bf16 v[96:111], a[112:115], v[180:183], v[96:111]
    ds_read_b64 v[168:169], v196 offset:12544
    ds_read_b64 v[170:171], v196 offset:13056
    s_waitcnt lgkmcnt(6)
    v_mfma_f32_16x16x32_bf16 v[112:115], a[116:119], v[184:187], v[112:115]
    ds_read_b64 v[172:173], v198 offset:1792
    v_mfma_f32_32x32x16_bf16 v[80:95], a[116:119], v[188:191], v[80:95]
    ds_read_b64 v[174:175], v198 offset:1856
    ds_read_b64 v[176:177], v196 offset:14336
    ds_read_b64 v[178:179], v196 offset:14848
    v_mfma_f32_32x32x16_bf16 v[96:111], a[116:119], v[192:195], v[96:111]
    ds_read_b64 v[180:181], v196 offset:14592
    ds_read_b64 v[182:183], v196 offset:15104
sl_54:
    s_waitcnt vmcnt(2)
    v_max3_u32 v2, v152, v153, v154
    s_waitcnt vmcnt(1)
    v_max3_u32 v2, v2, v155, v156
    v_max_u32 v2, v2, v157
    v_cmp_eq_u32 vcc, -1, v2
    s_nop 0
    s_cbranch_vccnz rd_55
rc_56:
    s_waitcnt vmcnt(0)
    v_cmp_gt_u32 vcc, 1, v7
    s_nop 0
    s_and_b64 vcc, vcc, s[50:51]
    s_cbranch_scc1 ps_57
pc_59:
    s_barrier
    s_waitcnt lgkmcnt(6)
    v_mfma_f32_16x16x32_bf16 v[112:115], a[120:123], v[160:163], v[112:115]
    v_add_u32_e64 v198, v49, v198
    v_mfma_f32_32x32x16_bf16 v[80:95], a[120:123], v[164:167], v[80:95]
    v_add_u32 v196, 19584, v196
    ds_read_b64 v[184:185], v198 offset:0
    ds_read_b64 v[186:187], v198 offset:64
    v_mul_f32 v148, v24, v157
    v_mul_f32 v149, v25, v157
    v_mfma_f32_32x32x16_bf16 v[96:111], a[120:123], v[168:171], v[96:111]
    ds_read_b64 v[188:189], v196 offset:0
    ds_read_b64 v[190:191], v196 offset:512
    s_sub_u32 s3, s2, 160
    s_and_b32 s3, s3, 63
    s_add_u32 s3, s3, 64
    s_and_b32 s25, s3, 3
    s_lshl_b32 s25, s25, 12
    s_lshr_b32 s26, s3, 2
    s_lshl_b32 s26, s26, 7
    s_add_u32 s3, s25, s26
    v_lshrrev_b32 v236, 3, v0
    v_and_b32 v237, 7, v0
    v_lshlrev_b32 v237, 4, v237
    v_lshl_add_u32 v236, v236, 14, v237
    s_sub_u32 s25, s2, 160
    s_cmp_lt_u32 s25, 64
    s_cselect_b32 s25, 0, 1073741824
    v_add_u32_e64 v236, s25, v236
    s_add_u32 s26, s3, 9437184
    buffer_load_dwordx4 v[216:219], v236, s[16:19], s26 offen sc1
    v_mul_f32 v150, v26, v157
    v_mul_f32_e64 v151, v27, v157
    s_waitcnt lgkmcnt(4)
    v_mfma_f32_16x16x32_bf16 v[112:115], a[124:127], v[172:175], v[112:115]
    ds_read_b64 v[192:193], v198 offset:256
    v_mfma_f32_32x32x16_bf16 v[80:95], a[124:127], v[176:179], v[80:95]
    ds_read_b64 v[194:195], v198 offset:320
    ds_read_b64 v[160:161], v196 offset:2048
    v_mul_f32 v116, v8, v153
    v_mul_f32 v117, v9, v153
    v_mul_f32_e64 v118, v10, v153
    v_mfma_f32_32x32x16_bf16 v[96:111], a[124:127], v[180:183], v[96:111]
    ds_read_b64 v[162:163], v196 offset:2560
    s_add_u32 s26, s26, 524288
    buffer_load_dwordx4 v[220:223], v236, s[16:19], s26 offen sc1
    v_mul_f32 v119, v11, v153
    v_mul_f32_e64 v120, v12, v153
    s_waitcnt lgkmcnt(4)
    v_mfma_f32_16x16x32_bf16 v[112:115], a[128:131], v[184:187], v[112:115]
    ds_read_b64 v[164:165], v198 offset:512
    v_mfma_f32_32x32x16_bf16 v[80:95], a[128:131], v[188:191], v[80:95]
    ds_read_b64 v[166:167], v198 offset:576
    ds_read_b64 v[168:169], v196 offset:4096
    ds_read_b64 v[170:171], v196 offset:4608
    v_mul_f32 v121, v13, v153
    v_mul_f32_e64 v122, v14, v153
    s_waitcnt lgkmcnt(4)
    v_mfma_f32_16x16x32_bf16 v[112:115], a[132:135], v[192:195], v[112:115]
    ds_read_b64 v[172:173], v198 offset:768
    v_mfma_f32_32x32x16_bf16 v[80:95], a[132:135], v[160:163], v[80:95]
    ds_read_b64 v[174:175], v198 offset:832
    ds_read_b64 v[176:177], v196 offset:6144
    ds_read_b64 v[178:179], v196 offset:6656
    s_add_u32 s26, s26, 524288
    buffer_load_dwordx4 v[224:227], v236, s[16:19], s26 offen sc1
    v_mul_f32 v123, v15, v153
    v_mul_f32_e64 v124, v16, v153
    s_waitcnt lgkmcnt(4)
    v_mfma_f32_16x16x32_bf16 v[112:115], a[136:139], v[164:167], v[112:115]
    ds_read_b64 v[180:181], v198 offset:1024
    v_mfma_f32_32x32x16_bf16 v[80:95], a[136:139], v[168:171], v[80:95]
    ds_read_b64 v[182:183], v198 offset:1088
    ds_read_b64 v[184:185], v196 offset:8192
    ds_read_b64 v[186:187], v196 offset:8704
    v_mul_f32 v125, v17, v153
    v_mul_f32_e64 v126, v18, v153
    s_waitcnt lgkmcnt(4)
    v_mfma_f32_16x16x32_bf16 v[112:115], a[140:143], v[172:175], v[112:115]
    ds_read_b64 v[188:189], v198 offset:1280
    v_mfma_f32_32x32x16_bf16 v[80:95], a[140:143], v[176:179], v[80:95]
    ds_read_b64 v[190:191], v198 offset:1344
    ds_read_b64 v[192:193], v196 offset:10240
    ds_read_b64 v[194:195], v196 offset:10752
    s_add_u32 s26, s26, 524288
    buffer_load_dwordx4 v[228:231], v236, s[16:19], s26 offen sc1
    v_mul_f32 v127, v19, v153
    v_mul_f32_e64 v128, v20, v153
    s_waitcnt lgkmcnt(4)
    v_mfma_f32_16x16x32_bf16 v[112:115], a[144:147], v[180:183], v[112:115]
    ds_read_b64 v[160:161], v198 offset:1536
    v_mfma_f32_32x32x16_bf16 v[80:95], a[144:147], v[184:187], v[80:95]
    ds_read_b64 v[162:163], v198 offset:1600
    ds_read_b64 v[164:165], v196 offset:12288
    ds_read_b64 v[166:167], v196 offset:12800
    v_mul_f32 v129, v21, v153
    v_mul_f32_e64 v130, v22, v153
    s_waitcnt lgkmcnt(4)
    v_mfma_f32_16x16x32_bf16 v[112:115], a[148:151], v[188:191], v[112:115]
    ds_read_b64 v[168:169], v198 offset:1792
    v_mfma_f32_32x32x16_bf16 v[80:95], a[148:151], v[192:195], v[80:95]
    ds_read_b64 v[170:171], v198 offset:1856
    ds_read_b64 v[172:173], v196 offset:14336
    ds_read_b64 v[174:175], v196 offset:14848
    s_add_u32 s26, s26, 524288
    buffer_load_dwordx4 v[232:235], v236, s[16:19], s26 offen sc1
    v_mul_f32 v131, v23, v153
    v_mul_f32_e64 v132, v8, v155
    s_waitcnt lgkmcnt(4)
    v_mfma_f32_16x16x32_bf16 v[112:115], a[152:155], v[160:163], v[112:115]
    ds_read_b64 v[176:177], v196 offset:256
    v_mfma_f32_32x32x16_bf16 v[80:95], a[152:155], v[164:167], v[80:95]
    ds_read_b64 v[178:179], v196 offset:768
    ds_read_b64 v[180:181], v196 offset:2304
    ds_read_b64 v[182:183], v196 offset:2816
    v_mul_f32 v133, v9, v155
    v_mul_f32_e64 v134, v10, v155
    s_waitcnt lgkmcnt(4)
    v_mfma_f32_16x16x32_bf16 v[112:115], a[156:159], v[168:171], v[112:115]
    ds_read_b64 v[184:185], v196 offset:4352
    v_mfma_f32_32x32x16_bf16 v[80:95], a[156:159], v[172:175], v[80:95]
    ds_read_b64 v[186:187], v196 offset:4864
    ds_read_b64 v[188:189], v196 offset:6400
    ds_read_b64 v[190:191], v196 offset:6912
    s_add_u32 m0, s92, 36352
    s_nop 0
    buffer_load_dwordx4 v73, s[16:19], s99 offen offset:0 sc1 lds
    v_mul_f32 v135, v11, v155
    v_mul_f32 v136, v12, v155
    v_mul_f32 v137, v13, v155
    v_mul_f32 v138, v14, v155
    v_mul_f32 v139, v15, v155
    v_mul_f32 v140, v16, v155
    v_mul_f32 v141, v17, v155
    v_mul_f32 v142, v18, v155
    v_mul_f32 v143, v19, v155
    v_mul_f32 v144, v20, v155
    v_mul_f32 v145, v21, v155
    v_mul_f32 v146, v22, v155
    v_mul_f32_e64 v147, v23, v155
    s_waitcnt lgkmcnt(4)
    v_mfma_f32_32x32x16_bf16 v[96:111], a[128:131], v[176:179], v[96:111]
    ds_read_b64 v[192:193], v196 offset:8448
    ds_read_b64 v[194:195], v196 offset:8960
    v_mfma_f32_32x32x16_bf16 v[96:111], a[132:135], v[180:183], v[96:111]
    ds_read_b64 v[160:161], v196 offset:10496
    ds_read_b64 v[162:163], v196 offset:11008
    buffer_load_dwordx4 v74, s[16:19], s99 offen offset:1024 sc1 lds
    v_fma_f32 v112, v112, v156, v148
    v_fma_f32 v113, v113, v156, v149
    s_waitcnt lgkmcnt(4)
    v_mfma_f32_32x32x16_bf16 v[96:111], a[136:139], v[184:187], v[96:111]
    ds_read_b64 v[164:165], v196 offset:12544
    ds_read_b64 v[166:167], v196 offset:13056
    v_fma_f32 v114, v114, v156, v150
    v_fma_f32 v115, v115, v156, v151
    v_cvt_pk_bf16_f32 v112, v112, v113
    v_mfma_f32_32x32x16_bf16 v[96:111], a[140:143], v[188:191], v[96:111]
    ds_read_b64 v[168:169], v196 offset:14592
    ds_read_b64 v[170:171], v196 offset:15104
    buffer_load_dwordx4 v75, s[16:19], s99 offen offset:2048 sc1 lds
    v_cvt_pk_bf16_f32 v113, v114, v115
    v_fma_f32 v80, v80, v152, v116
    s_waitcnt lgkmcnt(4)
    v_mfma_f32_32x32x16_bf16 v[96:111], a[144:147], v[192:195], v[96:111]
    v_fma_f32 v81, v81, v152, v117
    v_fma_f32 v82, v82, v152, v118
    v_fma_f32 v83, v83, v152, v119
    v_cvt_pk_bf16_f32 v80, v80, v81
    v_cvt_pk_bf16_f32 v81, v82, v83
    v_mfma_f32_32x32x16_bf16 v[96:111], a[148:151], v[160:163], v[96:111]
    ds_write_b64 v40, v[112:113] offset:0
    ds_write_b64 v38, v[80:81] offset:0
    v_fma_f32 v84, v84, v152, v120
    v_fma_f32 v85, v85, v152, v121
    s_waitcnt lgkmcnt(2)
    v_mfma_f32_32x32x16_bf16 v[96:111], a[152:155], v[164:167], v[96:111]
    v_fma_f32 v86, v86, v152, v122
    v_fma_f32 v87, v87, v152, v123
    v_cvt_pk_bf16_f32 v84, v84, v85
    v_cvt_pk_bf16_f32 v85, v86, v87
    v_fma_f32 v88, v88, v152, v124
    v_mfma_f32_32x32x16_bf16 v[96:111], a[156:159], v[168:171], v[96:111]
    buffer_load_dwordx4 v76, s[16:19], s99 offen offset:3072 sc1 lds
    v_fma_f32 v89, v89, v152, v125
    v_fma_f32 v90, v90, v152, v126
    v_fma_f32 v91, v91, v152, v127
    v_cvt_pk_bf16_f32 v88, v88, v89
    v_cvt_pk_bf16_f32 v89, v90, v91
    ds_write_b64 v38, v[84:85] offset:6400
    ds_write_b64 v38, v[88:89] offset:12800
    v_fma_f32 v92, v92, v152, v128
    v_fma_f32 v93, v93, v152, v129
    v_fma_f32 v94, v94, v152, v130
    v_fma_f32 v95, v95, v152, v131
    v_cvt_pk_bf16_f32 v92, v92, v93
    v_cvt_pk_bf16_f32 v93, v94, v95
    ds_write_b64 v39, v[92:93] offset:0
    v_pk_fma_f32 v[96:97], v[96:97], v[154:155], v[132:133] op_sel_hi:[1,0,1]
    v_pk_fma_f32 v[98:99], v[98:99], v[154:155], v[134:135] op_sel_hi:[1,0,1]
    v_cvt_pk_bf16_f32 v96, v96, v97
    v_cvt_pk_bf16_f32 v97, v98, v99
    v_pk_fma_f32 v[100:101], v[100:101], v[154:155], v[136:137] op_sel_hi:[1,0,1]
    v_pk_fma_f32 v[102:103], v[102:103], v[154:155], v[138:139] op_sel_hi:[1,0,1]
    v_cvt_pk_bf16_f32 v100, v100, v101
    v_cvt_pk_bf16_f32 v101, v102, v103
    ds_write_b64 v38, v[96:97] offset:1600
    ds_write_b64 v38, v[100:101] offset:8000
    v_pk_fma_f32 v[104:105], v[104:105], v[154:155], v[140:141] op_sel_hi:[1,0,1]
    v_pk_fma_f32 v[106:107], v[106:107], v[154:155], v[142:143] op_sel_hi:[1,0,1]
    v_cvt_pk_bf16_f32 v104, v104, v105
    v_cvt_pk_bf16_f32 v105, v106, v107
    v_pk_fma_f32 v[108:109], v[108:109], v[154:155], v[144:145] op_sel_hi:[1,0,1]
    v_pk_fma_f32 v[110:111], v[110:111], v[154:155], v[146:147] op_sel_hi:[1,0,1]
    v_cvt_pk_bf16_f32 v108, v108, v109
    v_cvt_pk_bf16_f32 v109, v110, v111
    ds_write_b64 v38, v[104:105] offset:14400
    ds_write_b64 v39, v[108:109] offset:1600
    v_cmp_u_f32 vcc, v82, v114
    v_cmp_u_f32 s[82:83], v98, v98
    s_lshl_b32 s25, s24, 2
    s_add_u32 s25, s25, 160256
    s_or_b64 vcc, vcc, s[82:83]
    s_cselect_b32 s26, 1, 0
    v_mov_b32 v196, s25
    v_mov_b32 v197, s26
    ds_write_b32 v196, v197
    s_waitcnt lgkmcnt(0)
    s_barrier
    s_sub_u32 s85, s2, 160
    s_cmp_ge_u32 s85, 64
    s_cbranch_scc1 s2_60
    v_mov_b32 v238, 0x3f803f80
    s_lshl_b32 s25, s24, 7
    s_add_u32 s25, s25, 134272
    v_lshrrev_b32 v239, 4, v1
    v_lshl_add_u32 v237, v239, 2, v237
    v_add_u32 v237, s25, v237
se_61:
    v_mov_b32 v240, 0
    v_mov_b32 v241, 0
    v_mov_b32 v242, 0
    v_mov_b32 v243, 0
    s_waitcnt vmcnt(8)
    v_dot2c_f32_bf16 v240, v216, v238
    v_dot2c_f32_bf16 v241, v216, v216
    v_dot2c_f32_bf16 v240, v217, v238
    v_dot2c_f32_bf16 v241, v217, v217
    v_dot2c_f32_bf16 v242, v218, v238
    v_dot2c_f32_bf16 v243, v218, v218
    v_dot2c_f32_bf16 v242, v219, v238
    v_dot2c_f32_bf16 v243, v219, v219
    s_waitcnt vmcnt(7)
    v_dot2c_f32_bf16 v240, v220, v238
    v_dot2c_f32_bf16 v241, v220, v220
    v_dot2c_f32_bf16 v240, v221, v238
    v_dot2c_f32_bf16 v241, v221, v221
    v_dot2c_f32_bf16 v242, v222, v238
    v_dot2c_f32_bf16 v243, v222, v222
    v_dot2c_f32_bf16 v242, v223, v238
    v_dot2c_f32_bf16 v243, v223, v223
    s_waitcnt vmcnt(6)
    v_dot2c_f32_bf16 v240, v224, v238
    v_dot2c_f32_bf16 v241, v224, v224
    v_dot2c_f32_bf16 v240, v225, v238
    v_dot2c_f32_bf16 v241, v225, v225
    v_dot2c_f32_bf16 v242, v226, v238
    v_dot2c_f32_bf16 v243, v226, v226
    v_dot2c_f32_bf16 v242, v227, v238
    v_dot2c_f32_bf16 v243, v227, v227
    s_waitcnt vmcnt(5)
    v_dot2c_f32_bf16 v240, v228, v238
    v_dot2c_f32_bf16 v241, v228, v228
    v_dot2c_f32_bf16 v240, v229, v238
    v_dot2c_f32_bf16 v241, v229, v229
    v_dot2c_f32_bf16 v242, v230, v238
    v_dot2c_f32_bf16 v243, v230, v230
    v_dot2c_f32_bf16 v242, v231, v238
    v_dot2c_f32_bf16 v243, v231, v231
    s_waitcnt vmcnt(4)
    v_dot2c_f32_bf16 v240, v232, v238
    v_dot2c_f32_bf16 v241, v232, v232
    v_dot2c_f32_bf16 v240, v233, v238
    v_dot2c_f32_bf16 v241, v233, v233
    v_dot2c_f32_bf16 v242, v234, v238
    v_dot2c_f32_bf16 v243, v234, v234
    v_dot2c_f32_bf16 v242, v235, v238
    v_dot2c_f32_bf16 v243, v235, v235
    s_nop 2
    v_cmp_u_f32 vcc, v241, v243
    s_nop 0
    s_cbranch_vccnz rd_62
rc_63:
    v_permlane32_swap_b32 v240, v242
    v_permlane32_swap_b32 v241, v243
    v_pk_add_f32 v[240:241], v[240:241], v[242:243]
    s_nop 1
    v_permlane16_swap_b32 v240, v241
    v_add_f32_e64 v240, v240, v241
    s_nop 1
    v_add_f32_dpp v240, v240, v240 row_ror:8 row_mask:0xf bank_mask:0xf
    ds_write_b32 v237, v240
    v_and_b32 v236, 15, v0
    v_lshlrev_b32 v236, 3, v236
    v_add_u32 v237, 134272, v236
    v_mov_b32 v239, 1073741824
    v_cmp_gt_u32 vcc, 16, v0
    s_nop 1
    v_cndmask_b32 v236, v239, v236, vcc
    s_add_u32 s25, s3, 3457024
    s_waitcnt lgkmcnt(0)
    s_barrier
    ds_read_b64 v[216:217], v237 offset:0
    ds_read_b64 v[218:219], v237 offset:128
    ds_read_b64 v[220:221], v237 offset:256
    ds_read_b64 v[222:223], v237 offset:384
    s_waitcnt lgkmcnt(2)
    v_pk_add_f32 v[216:217], v[216:217], v[218:219]
    s_waitcnt lgkmcnt(0)
    v_pk_add_f32 v[220:221], v[220:221], v[222:223]
    v_pk_add_f32 v[216:217], v[216:217], v[220:221]
    v_mul_f32 v239, 0x3acccccd, v216
    v_mul_f32 v217, 0x3acccccd, v217
    v_fma_f32 v217, -v239, v239, v217
    v_max_f32 v217, 0, v217
    v_add_f32 v217, 0x3727c5ac, v217
    v_rsq_f32_e64 v216, v217
    s_nop 0
    v_mul_f32 v217, -v239, v216
    buffer_store_dwordx2 v[216:217], v236, s[16:19], s25 offen sc1
s2_60:
    v_mov_b32 v158, 160256
    ds_read_b128 v[128:131], v158
    v_mov_b32 v94, 0
    v_mov_b32 v95, 0
    v_mov_b32 v98, 0
    v_mov_b32 v99, 0
    s_mov_b64 exec, 0xffff
    ds_read_b64 v[94:95], v42 offset:320
    ds_read_b64 v[98:99], v42 offset:640
    s_mov_b64 exec, -1
    s_nop 0
    ds_read_b64 v[92:93], v41 offset:320
    ds_read_b64 v[96:97], v41 offset:640
    ds_read_b64 v[84:85], v41 offset:6720
    ds_read_b64 v[86:87], v42 offset:6720
    ds_read_b64 v[80:81], v41 offset:6400
    ds_read_b64 v[82:83], v42 offset:6400
    ds_read_b64 v[88:89], v41 offset:7040
    ds_read_b64 v[90:91], v42 offset:7040
    ds_read_b64_tr_b16 v[106:107], v44 offset:0
    ds_read_b64_tr_b16 v[100:101], v43 offset:0
    s_add_u32 m0, s93, 53760
    s_add_u32 s99, s99, 524288
    s_mov_b64 exec, s[80:81]
    buffer_load_dwordx4 v77, s[16:19], s100 offen sc1 lds
    s_mov_b64 exec, -1
    s_add_u32 s100, s100, 524288
    ds_read_b64_tr_b16 v[108:109], v44 offset:320
    ds_read_b64_tr_b16 v[102:103], v43 offset:320
    ds_read_b64_tr_b16 v[110:111], v44 offset:640
    ds_read_b64_tr_b16 v[104:105], v43 offset:640
    v_mov_b32 v156, 0xf149f2ca
    v_cndmask_b32 v152, v32, v156, s[90:91]
    v_cndmask_b32 v153, v33, v156, s[90:91]
    v_cndmask_b32 v154, v34, v156, s[90:91]
    s_add_u32 m0, s92, 55936
    s_nop 0
    buffer_load_dwordx4 v73, s[16:19], s99 offen offset:0 sc1 lds
    v_cndmask_b32 v155, v35, v156, s[90:91]
    s_mov_b32 s82, 0x3ea52b5c
    s_lshl_b32 s25, s98, 4
    s_add_u32 s25, s25, 12058624
    s_lshl_b32 s26, s98, 3
    s_add_u32 s26, s26, 12058624
    s_waitcnt lgkmcnt(15)
    v_or3_b32 v128, v128, v129, v130
    v_or_b32 v128, v128, v131
    buffer_load_dwordx4 v74, s[16:19], s99 offen offset:1024 sc1 lds
    v_cmp_ne_u32_e64 vcc, 0, v128
    s_nop 0
    s_cbranch_vccnz rd_64
rc_65:
    s_waitcnt lgkmcnt(10)
    v_mfma_f32_16x16x32_bf16 v[116:119], v[84:87], v[92:95], v[28:31]
    v_mfma_f32_16x16x32_bf16 v[120:123], v[84:87], v[96:99], v[32:35]
    s_waitcnt lgkmcnt(8)
    v_mfma_f32_16x16x32_bf16 v[112:115], v[80:83], v[92:95], v[152:155]
    s_waitcnt lgkmcnt(6)
    v_mfma_f32_16x16x32_bf16 v[124:127], v[88:91], v[96:99], v[28:31]
    s_nop 5
    v_max_f32 v112, v112, v116
    v_max_f32 v113, v113, v117
    v_max_f32 v114, v114, v118
    buffer_load_dwordx4 v75, s[16:19], s99 offen offset:2048 sc1 lds
    v_max_f32 v115, v115, v119
    v_max3_f32 v156, v112, v113, v114
    v_max_f32 v156, v156, v115
    v_max_f32 v120, v120, v124
    v_max_f32 v121, v121, v125
    v_max_f32 v122, v122, v126
    v_max_f32 v123, v123, v127
    v_max3_f32 v157, v120, v121, v122
    buffer_load_dwordx4 v76, s[16:19], s99 offen offset:3072 sc1 lds
    v_max_f32 v157, v157, v123
    s_nop 1
    v_permlane16_swap_b32 v156, v157
    v_max_f32 v156, v156, v157
    v_mov_b32 v157, v156
    s_nop 1
    v_permlane32_swap_b32 v156, v157
    v_max_f32 v156, v156, v157
    v_mul_f32 v156, s82, v156
    v_mov_b32 v157, v156
    s_add_u32 m0, s93, 73344
    s_add_u32 s99, s99, 524288
    s_mov_b64 exec, s[80:81]
    buffer_load_dwordx4 v77, s[16:19], s100 offen sc1 lds
    s_mov_b64 exec, -1
    s_add_u32 s100, s100, 524288
    v_permlane16_swap_b32_e64 v156, v157
    v_fma_f32 v112, v112, s82, -v156
    v_fma_f32 v113, v113, s82, -v156
    v_fma_f32 v114, v114, s82, -v156
    v_fma_f32 v115, v115, s82, -v156
    v_exp_f32 v112, v112
    v_exp_f32 v113, v113
    v_exp_f32 v114, v114
    s_add_u32 m0, s92, 75520
    s_nop 0
    buffer_load_dwordx4 v73, s[16:19], s99 offen offset:0 sc1 lds
    v_exp_f32_e64 v115, v115
    v_cvt_pk_bf16_f32 v116, v112, v113
    v_cvt_pk_bf16_f32 v117, v114, v115
    v_bfi_b32 v128, v36, 0, v116
    v_and_b32 v130, v36, v116
    v_bfi_b32 v129, v37, 0, v117
    v_and_b32 v131, v37, v117
    s_waitcnt lgkmcnt(3)
    s_nop 0
    v_mfma_f32_16x16x32_bf16 v[144:147], v[106:109], v[128:131], 0
    buffer_load_dwordx4 v74, s[16:19], s99 offen offset:1024 sc1 lds
    s_waitcnt lgkmcnt(2)
    v_mfma_f32_16x16x32_bf16 v[136:139], v[100:103], v[128:131], 0
    v_fma_f32 v120, v120, s82, -v157
    v_fma_f32 v121, v121, s82, -v157
    v_fma_f32 v122, v122, s82, -v157
    v_fma_f32 v123, v123, s82, -v157
    v_exp_f32 v120, v120
    v_exp_f32 v121, v121
    v_exp_f32 v122, v122
    buffer_load_dwordx4 v75, s[16:19], s99 offen offset:2048 sc1 lds
    v_exp_f32_e64 v123, v123
    v_cvt_pk_bf16_f32 v124, v120, v121
    v_cvt_pk_bf16_f32 v125, v122, v123
    v_bfi_b32 v132, v36, 0, v124
    v_and_b32 v134, v36, v124
    v_bfi_b32 v133, v37, 0, v125
    v_and_b32 v135, v37, v125
    s_waitcnt lgkmcnt(1)
    s_nop 0
    v_mfma_f32_16x16x32_bf16 v[148:151], v[108:111], v[132:135], 0
    buffer_load_dwordx4 v76, s[16:19], s99 offen offset:3072 sc1 lds
    s_waitcnt lgkmcnt(0)
    v_mfma_f32_16x16x32_bf16 v[140:143], v[102:105], v[132:135], 0
    v_mov_b32 v158, v144
    s_nop 1
    v_permlane16_swap_b32 v144, v158
    v_rcp_f32 v158, v158
    s_nop 0
    v_pk_mul_f32 v[136:137], v[136:137], v[158:159] op_sel_hi:[1,0]
    v_pk_mul_f32 v[138:139], v[138:139], v[158:159] op_sel_hi:[1,0]
    v_pk_mul_f32 v[144:145], v[144:145], v[158:159] op_sel_hi:[1,0]
    v_pk_mul_f32 v[146:147], v[146:147], v[158:159] op_sel_hi:[1,0]
    s_add_u32 m0, s93, 92928
    s_add_u32 s99, s99, 524288
    s_mov_b64 exec, s[80:81]
    buffer_load_dwordx4 v77, s[16:19], s100 offen sc1 lds
    s_mov_b64 exec, -1
    s_add_u32 s100, s100, 524288
    v_cvt_pk_bf16_f32 v112, v136, v137
    v_cvt_pk_bf16_f32 v116, v144, v145
    v_cvt_pk_bf16_f32 v113, v138, v139
    v_cvt_pk_bf16_f32 v117, v146, v147
    v_mov_b32 v160, v148
    s_nop 1
    v_permlane16_swap_b32 v148, v160
    v_rcp_f32_e64 v160, v160
    s_nop 0
    v_pk_mul_f32 v[140:141], v[140:141], v[160:161] op_sel_hi:[1,0]
    v_pk_mul_f32 v[142:143], v[142:143], v[160:161] op_sel_hi:[1,0]
    v_pk_mul_f32 v[148:149], v[148:149], v[160:161] op_sel_hi:[1,0]
    v_pk_mul_f32 v[150:151], v[150:151], v[160:161] op_sel_hi:[1,0]
    v_cvt_pk_bf16_f32 v114, v140, v141
    v_cvt_pk_bf16_f32 v118, v148, v149
    v_cvt_pk_bf16_f32 v115, v142, v143
    v_cvt_pk_bf16_f32 v119, v150, v151
    v_permlane16_swap_b32 v112, v114
    v_permlane16_swap_b32 v113, v115
    v_permlane16_swap_b32 v116, v118
    v_permlane16_swap_b32 v117, v119
    buffer_store_dwordx4 v[112:115], v45, s[16:19], s25 offen sc1
    s_mov_b64 exec, s[80:81]
    buffer_store_dwordx2 v[116:117], v46, s[16:19], s26 offen sc1
    s_mov_b64 exec, -1
ge_66:
    v_add_u32 v196, 36352, v78
    v_mov_b32_e64 v198, v79
    s_waitcnt vmcnt(12)
    s_barrier
    ds_read_b64 v[160:161], v198 offset:0
    ds_read_b64 v[162:163], v198 offset:64
    ds_read_b64 v[164:165], v196 offset:0
    ds_read_b64 v[166:167], v196 offset:512
    ds_read_b64 v[168:169], v196 offset:256
    ds_read_b64 v[170:171], v196 offset:768
    ds_read_b64 v[172:173], v198 offset:256
    ds_read_b64 v[174:175], v198 offset:320
    ds_read_b64 v[176:177], v196 offset:2048
    ds_read_b64 v[178:179], v196 offset:2560
    ds_read_b64 v[180:181], v196 offset:2304
    ds_read_b64 v[182:183], v196 offset:2816
    s_waitcnt lgkmcnt(6)
    v_mfma_f32_16x16x32_bf16 v[112:115], a[0:3], v[160:163], 0
    ds_read_b64 v[184:185], v198 offset:512
    v_mfma_f32_32x32x16_bf16 v[80:95], a[0:3], v[164:167], 0
    ds_read_b64 v[186:187], v198 offset:576
    ds_read_b64 v[188:189], v196 offset:4096
    ds_read_b64 v[190:191], v196 offset:4608
    v_mfma_f32_32x32x16_bf16 v[96:111], a[0:3], v[168:171], 0
    ds_read_b64 v[192:193], v196 offset:4352
    ds_read_b64 v[194:195], v196 offset:4864
    s_add_u32 m0, s92, 95104
    s_nop 0
    buffer_load_dwordx4 v73, s[16:19], s99 offen offset:0 sc1 lds
    s_waitcnt lgkmcnt(6)
    v_mfma_f32_16x16x32_bf16 v[112:115], a[4:7], v[172:175], v[112:115]
    ds_read_b64 v[160:161], v198 offset:768
    v_mfma_f32_32x32x16_bf16 v[80:95], a[4:7], v[176:179], v[80:95]
    ds_read_b64 v[162:163], v198 offset:832
    ds_read_b64 v[164:165], v196 offset:6144
    ds_read_b64 v[166:167], v196 offset:6656
    v_mfma_f32_32x32x16_bf16 v[96:111], a[4:7], v[180:183], v[96:111]
    ds_read_b64 v[168:169], v196 offset:6400
    ds_read_b64 v[170:171], v196 offset:6912
    buffer_load_dwordx4 v74, s[16:19], s99 offen offset:1024 sc1 lds
    s_waitcnt lgkmcnt(6)
    v_mfma_f32_16x16x32_bf16 v[112:115], a[8:11], v[184:187], v[112:115]
    ds_read_b64 v[172:173], v198 offset:1024
    v_mfma_f32_32x32x16_bf16 v[80:95], a[8:11], v[188:191], v[80:95]
    ds_read_b64 v[174:175], v198 offset:1088
    ds_read_b64 v[176:177], v196 offset:8192
    ds_read_b64 v[178:179], v196 offset:8704
    v_mfma_f32_32x32x16_bf16 v[96:111], a[8:11], v[192:195], v[96:111]
    ds_read_b64 v[180:181], v196 offset:8448
    ds_read_b64 v[182:183], v196 offset:8960
    buffer_load_dwordx4 v75, s[16:19], s99 offen offset:2048 sc1 lds
    s_waitcnt lgkmcnt(6)
    v_mfma_f32_16x16x32_bf16 v[112:115], a[12:15], v[160:163], v[112:115]
    ds_read_b64 v[184:185], v198 offset:1280
    v_mfma_f32_32x32x16_bf16 v[80:95], a[12:15], v[164:167], v[80:95]
    ds_read_b64 v[186:187], v198 offset:1344
    ds_read_b64 v[188:189], v196 offset:10240
    ds_read_b64 v[190:191], v196 offset:10752
    v_mfma_f32_32x32x16_bf16 v[96:111], a[12:15], v[168:171], v[96:111]
    ds_read_b64 v[192:193], v196 offset:10496
    ds_read_b64 v[194:195], v196 offset:11008
    buffer_load_dwordx4 v76, s[16:19], s99 offen offset:3072 sc1 lds
    s_waitcnt lgkmcnt(6)
    v_mfma_f32_16x16x32_bf16 v[112:115], a[16:19], v[172:175], v[112:115]
    ds_read_b64 v[160:161], v198 offset:1536
    v_mfma_f32_32x32x16_bf16 v[80:95], a[16:19], v[176:179], v[80:95]
    ds_read_b64 v[162:163], v198 offset:1600
    ds_read_b64 v[164:165], v196 offset:12288
    ds_read_b64 v[166:167], v196 offset:12800
    v_mfma_f32_32x32x16_bf16 v[96:111], a[16:19], v[180:183], v[96:111]
    ds_read_b64 v[168:169], v196 offset:12544
    ds_read_b64 v[170:171], v196 offset:13056
    s_add_u32 m0, s93, 112512
    s_add_u32 s99, s99, 524288
    s_mov_b64 exec, s[80:81]
    buffer_load_dwordx4 v77, s[16:19], s100 offen sc1 lds
    s_mov_b64 exec, -1
    s_add_u32 s100, s100, 524288
    s_waitcnt lgkmcnt(6)
    v_mfma_f32_16x16x32_bf16 v[112:115], a[20:23], v[184:187], v[112:115]
    ds_read_b64 v[172:173], v198 offset:1792
    v_mfma_f32_32x32x16_bf16 v[80:95], a[20:23], v[188:191], v[80:95]
    ds_read_b64 v[174:175], v198 offset:1856
    ds_read_b64 v[176:177], v196 offset:14336
    ds_read_b64 v[178:179], v196 offset:14848
    v_mfma_f32_32x32x16_bf16 v[96:111], a[20:23], v[192:195], v[96:111]
    ds_read_b64 v[180:181], v196 offset:14592
    ds_read_b64 v[182:183], v196 offset:15104
    s_add_u32 m0, s92, 114688
    s_nop 0
    buffer_load_dwordx4 v73, s[16:19], s99 offen offset:0 sc1 lds
    s_waitcnt vmcnt(13)
    s_barrier
    s_waitcnt lgkmcnt(6)
    v_mfma_f32_16x16x32_bf16 v[112:115], a[24:27], v[160:163], v[112:115]
    v_add_u32 v198, v49, v198
    v_mfma_f32_32x32x16_bf16 v[80:95], a[24:27], v[164:167], v[80:95]
    v_add_u32 v196, 19584, v196
    ds_read_b64 v[184:185], v198 offset:0
    ds_read_b64 v[186:187], v198 offset:64
    ds_read_b64 v[188:189], v196 offset:0
    v_mfma_f32_32x32x16_bf16 v[96:111], a[24:27], v[168:171], v[96:111]
    ds_read_b64 v[190:191], v196 offset:512
    ds_read_b64 v[192:193], v196 offset:256
    ds_read_b64 v[194:195], v196 offset:768
    buffer_load_dwordx4 v74, s[16:19], s99 offen offset:1024 sc1 lds
    s_waitcnt lgkmcnt(6)
    v_mfma_f32_16x16x32_bf16 v[112:115], a[28:31], v[172:175], v[112:115]
    ds_read_b64 v[160:161], v198 offset:256
    v_mfma_f32_32x32x16_bf16 v[80:95], a[28:31], v[176:179], v[80:95]
    ds_read_b64 v[162:163], v198 offset:320
    ds_read_b64 v[164:165], v196 offset:2048
    ds_read_b64 v[166:167], v196 offset:2560
    v_mfma_f32_32x32x16_bf16 v[96:111], a[28:31], v[180:183], v[96:111]
    ds_read_b64 v[168:169], v196 offset:2304
    ds_read_b64 v[170:171], v196 offset:2816
    buffer_load_dwordx4 v75, s[16:19], s99 offen offset:2048 sc1 lds
    s_waitcnt lgkmcnt(6)
    v_mfma_f32_16x16x32_bf16 v[112:115], a[32:35], v[184:187], v[112:115]
    ds_read_b64 v[172:173], v198 offset:512
    v_mfma_f32_32x32x16_bf16 v[80:95], a[32:35], v[188:191], v[80:95]
    ds_read_b64 v[174:175], v198 offset:576
    ds_read_b64 v[176:177], v196 offset:4096
    ds_read_b64 v[178:179], v196 offset:4608
    v_mfma_f32_32x32x16_bf16 v[96:111], a[32:35], v[192:195], v[96:111]
    ds_read_b64 v[180:181], v196 offset:4352
    ds_read_b64 v[182:183], v196 offset:4864
    buffer_load_dwordx4 v76, s[16:19], s99 offen offset:3072 sc1 lds
    s_waitcnt lgkmcnt(6)
    v_mfma_f32_16x16x32_bf16 v[112:115], a[36:39], v[160:163], v[112:115]
    ds_read_b64 v[184:185], v198 offset:768
    v_mfma_f32_32x32x16_bf16 v[80:95], a[36:39], v[164:167], v[80:95]
    ds_read_b64 v[186:187], v198 offset:832
    ds_read_b64 v[188:189], v196 offset:6144
    ds_read_b64 v[190:191], v196 offset:6656
    v_mfma_f32_32x32x16_bf16 v[96:111], a[36:39], v[168:171], v[96:111]
    ds_read_b64 v[192:193], v196 offset:6400
    ds_read_b64 v[194:195], v196 offset:6912
    s_add_u32 m0, s93, 132096
    s_add_u32 s99, s99, 524288
    s_mov_b64 exec, s[80:81]
    buffer_load_dwordx4 v77, s[16:19], s100 offen sc1 lds
    s_mov_b64 exec, -1
    s_add_u32 s100, s100, 524288
    s_waitcnt lgkmcnt(6)
    v_mfma_f32_16x16x32_bf16 v[112:115], a[40:43], v[172:175], v[112:115]
    ds_read_b64 v[160:161], v198 offset:1024
    v_mfma_f32_32x32x16_bf16 v[80:95], a[40:43], v[176:179], v[80:95]
    ds_read_b64 v[162:163], v198 offset:1088
    ds_read_b64 v[164:165], v196 offset:8192
    ds_read_b64 v[166:167], v196 offset:8704
    v_add_u32 v199, 36352, v58
    s_lshl_b32 s32, s24, 11
    v_mfma_f32_32x32x16_bf16 v[96:111], a[40:43], v[180:183], v[96:111]
    ds_read_b64 v[168:169], v196 offset:8448
    ds_read_b64 v[170:171], v196 offset:8960
    v_add_u32 v203, s32, v199
    s_add_u32 s32, s24, 1
    s_waitcnt lgkmcnt(6)
    v_mfma_f32_16x16x32_bf16 v[112:115], a[44:47], v[184:187], v[112:115]
    ds_read_b64 v[172:173], v198 offset:1280
    v_mfma_f32_32x32x16_bf16 v[80:95], a[44:47], v[188:191], v[80:95]
    ds_read_b64 v[174:175], v198 offset:1344
    ds_read_b64 v[176:177], v196 offset:10240
    ds_read_b64 v[178:179], v196 offset:10752
    s_and_b32 s32, s32, 3
    s_mul_i32 s32, s32, 6144
    v_mfma_f32_32x32x16_bf16 v[96:111], a[44:47], v[192:195], v[96:111]
    ds_read_b64 v[180:181], v196 offset:10496
    ds_read_b64 v[182:183], v196 offset:11008
    v_add_u32 v200, s32, v199
    s_add_u32 s32, s24, 2
    s_waitcnt lgkmcnt(6)
    v_mfma_f32_16x16x32_bf16 v[112:115], a[48:51], v[160:163], v[112:115]
    ds_read_b64 v[184:185], v198 offset:1536
    v_mfma_f32_32x32x16_bf16 v[80:95], a[48:51], v[164:167], v[80:95]
    ds_read_b64 v[186:187], v198 offset:1600
    ds_read_b64 v[188:189], v196 offset:12288
    ds_read_b64 v[190:191], v196 offset:12800
    s_and_b32 s32, s32, 3
    s_mul_i32 s32, s32, 6144
    v_mfma_f32_32x32x16_bf16 v[96:111], a[48:51], v[168:171], v[96:111]
    ds_read_b64 v[192:193], v196 offset:12544
    ds_read_b64 v[194:195], v196 offset:13056
    v_add_u32 v201, s32, v199
    s_add_u32 s32, s24, 3
    s_waitcnt lgkmcnt(6)
    v_mfma_f32_16x16x32_bf16 v[112:115], a[52:55], v[172:175], v[112:115]
    ds_read_b64 v[160:161], v198 offset:1792
    v_mfma_f32_32x32x16_bf16 v[80:95], a[52:55], v[176:179], v[80:95]
    ds_read_b64 v[162:163], v198 offset:1856
    ds_read_b64 v[164:165], v196 offset:14336
    ds_read_b64 v[166:167], v196 offset:14848
    s_and_b32 s32, s32, 3
    s_mul_i32 s32, s32, 6144
    v_mfma_f32_32x32x16_bf16 v[96:111], a[52:55], v[180:183], v[96:111]
    ds_read_b64 v[168:169], v196 offset:14592
    ds_read_b64 v[170:171], v196 offset:15104
    v_add_u32 v202, s32, v199
    s_mul_i32 s32, s24, 6144
    s_waitcnt vmcnt(12)
    s_barrier
    s_waitcnt lgkmcnt(6)
    v_mfma_f32_16x16x32_bf16 v[112:115], a[56:59], v[184:187], v[112:115]
    v_add_u32 v198, v49, v198
    v_mfma_f32_32x32x16_bf16 v[80:95], a[56:59], v[188:191], v[80:95]
    v_add_u32 v196, 19584, v196
    ds_read_b64 v[172:173], v198 offset:0
    ds_read_b64 v[174:175], v198 offset:64
    ds_read_b64 v[176:177], v196 offset:0
    v_add_u32_e64 v204, s32, v199
    v_mfma_f32_32x32x16_bf16 v[96:111], a[56:59], v[192:195], v[96:111]
    ds_read_b64 v[178:179], v196 offset:512
    ds_read_b64 v[180:181], v196 offset:256
    ds_read_b64 v[182:183], v196 offset:768
    s_lshl_b32 s32, s24, 8
    s_waitcnt lgkmcnt(6)
    v_mfma_f32_16x16x32_bf16 v[112:115], a[60:63], v[160:163], v[112:115]
    ds_read_b64 v[184:185], v198 offset:256
    v_mfma_f32_32x32x16_bf16 v[80:95], a[60:63], v[164:167], v[80:95]
    ds_read_b64 v[186:187], v198 offset:320
    ds_read_b64 v[188:189], v196 offset:2048
    ds_read_b64 v[190:191], v196 offset:2560
    s_add_u32 s32, s32, 36352
    v_and_b32_e64 v214, 15, v1
    v_mfma_f32_32x32x16_bf16 v[96:111], a[60:63], v[168:171], v[96:111]
    ds_read_b64 v[192:193], v196 offset:2304
    ds_read_b64 v[194:195], v196 offset:2816
    v_lshl_add_u32 v206, v214, 4, s32
    v_lshrrev_b32 v215, 5, v1
    s_waitcnt lgkmcnt(6)
    v_mfma_f32_16x16x32_bf16 v[112:115], a[64:67], v[172:175], v[112:115]
    ds_read_b64 v[160:161], v198 offset:512
    v_mfma_f32_32x32x16_bf16 v[80:95], a[64:67], v[176:179], v[80:95]
    ds_read_b64 v[162:163], v198 offset:576
    ds_read_b64 v[164:165], v196 offset:4096
    ds_read_b64 v[166:167], v196 offset:4608
    v_lshl_add_u32 v205, v215, 10, v206
    v_bfe_u32 v215, v1, 4, 1
    v_mfma_f32_32x32x16_bf16 v[96:111], a[64:67], v[180:183], v[96:111]
    ds_read_b64 v[168:169], v196 offset:4352
    ds_read_b64 v[170:171], v196 offset:4864
    v_lshl_add_u32 v205, v215, 3, v205
    v_lshlrev_b32 v214, 2, v214
    s_waitcnt lgkmcnt(6)
    v_mfma_f32_16x16x32_bf16 v[112:115], a[68:71], v[184:187], v[112:115]
    ds_read_b64 v[172:173], v198 offset:768
    v_mfma_f32_32x32x16_bf16 v[80:95], a[68:71], v[188:191], v[80:95]
    ds_read_b64 v[174:175], v198 offset:832
    ds_read_b64 v[176:177], v196 offset:6144
    ds_read_b64 v[178:179], v196 offset:6656
    v_lshl_add_u32 v214, v215, 10, v214
    s_lshl_b32 s32, s24, 6
    v_mfma_f32_32x32x16_bf16 v[96:111], a[68:71], v[192:195], v[96:111]
    ds_read_b64 v[180:181], v196 offset:6400
    ds_read_b64 v[182:183], v196 offset:6912
    v_lshl_add_u32 v207, v215, 3, s32
    v_and_b32_e64 v215, 12, v1
    s_waitcnt lgkmcnt(6)
    v_mfma_f32_16x16x32_bf16 v[112:115], a[72:75], v[160:163], v[112:115]
    ds_read_b64 v[184:185], v198 offset:1024
    v_mfma_f32_32x32x16_bf16 v[80:95], a[72:75], v[164:167], v[80:95]
    ds_read_b64 v[186:187], v198 offset:1088
    ds_read_b64 v[188:189], v196 offset:8192
    ds_read_b64 v[190:191], v196 offset:8704
    v_lshl_add_u32 v207, v215, 2, v207
    v_and_b32_e64 v215, 2, v1
    v_mfma_f32_32x32x16_bf16 v[96:111], a[72:75], v[168:171], v[96:111]
    ds_read_b64 v[192:193], v196 offset:8448
    ds_read_b64 v[194:195], v196 offset:8960
    s_lshl_b32 s98, s72, 5
    s_add_u32 s98, s98, 256
    s_sub_u32 s95, s98, 4
    s_max_i32 s95, s95, 0
    s_lshl_b32 s94, s98, 3
    s_lshl_b32 s95, s95, 3
    s_add_u32 s94, s94, 3457024
    s_add_u32 s95, s95, 3457024
    s_add_u32 s96, s94, 8192
    buffer_load_dwordx2 v[152:153], v47, s[16:19], s94 offen sc1
    s_waitcnt lgkmcnt(6)
    v_mfma_f32_16x16x32_bf16 v[112:115], a[76:79], v[172:175], v[112:115]
    ds_read_b64 v[160:161], v198 offset:1280
    v_mfma_f32_32x32x16_bf16 v[80:95], a[76:79], v[176:179], v[80:95]
    ds_read_b64 v[162:163], v198 offset:1344
    ds_read_b64 v[164:165], v196 offset:10240
    ds_read_b64 v[166:167], v196 offset:10752
    v_lshl_add_u32 v207, v215, 1, v207
    v_add_u32 v207, 69120, v207
    v_mfma_f32_32x32x16_bf16 v[96:111], a[76:79], v[180:183], v[96:111]
    ds_read_b64 v[168:169], v196 offset:10496
    ds_read_b64 v[170:171], v196 offset:11008
    buffer_load_dwordx2 v[154:155], v47, s[16:19], s96 offen sc1
    v_lshrrev_b32 v215, 4, v1
    s_waitcnt lgkmcnt(6)
    v_mfma_f32_16x16x32_bf16 v[112:115], a[80:83], v[184:187], v[112:115]
    ds_read_b64 v[172:173], v198 offset:1536
    v_mfma_f32_32x32x16_bf16 v[80:95], a[80:83], v[188:191], v[80:95]
    ds_read_b64 v[174:175], v198 offset:1600
    ds_read_b64 v[176:177], v196 offset:12288
    ds_read_b64 v[178:179], v196 offset:12800
    v_lshl_add_u32 v206, v215, 2, v206
    v_mov_b32 v215, 0x3f803f80
    v_mfma_f32_32x32x16_bf16 v[96:111], a[80:83], v[192:195], v[96:111]
    ds_read_b64 v[180:181], v196 offset:12544
    ds_read_b64 v[182:183], v196 offset:13056
    buffer_load_dwordx2 v[156:157], v48, s[16:19], s95 offen sc1
    s_waitcnt lgkmcnt(6)
    v_mfma_f32_16x16x32_bf16 v[112:115], a[84:87], v[160:163], v[112:115]
    ds_read_b64 v[184:185], v198 offset:1792
    v_mfma_f32_32x32x16_bf16 v[80:95], a[84:87], v[164:167], v[80:95]
    ds_read_b64 v[186:187], v198 offset:1856
    ds_read_b64 v[188:189], v196 offset:14336
    ds_read_b64 v[190:191], v196 offset:14848
    v_mfma_f32_32x32x16_bf16 v[96:111], a[84:87], v[168:171], v[96:111]
    ds_read_b64 v[192:193], v196 offset:14592
    ds_read_b64 v[194:195], v196 offset:15104
    s_waitcnt vmcnt(8)
    s_barrier
    s_waitcnt lgkmcnt(6)
    v_mfma_f32_16x16x32_bf16 v[112:115], a[88:91], v[172:175], v[112:115]
    v_add_u32_e64 v198, v49, v198
    v_mfma_f32_32x32x16_bf16 v[80:95], a[88:91], v[176:179], v[80:95]
    v_add_u32 v196, 19584, v196
    ds_read_b64 v[160:161], v198 offset:0
    ds_read_b64 v[162:163], v198 offset:64
    ds_read_b64 v[164:165], v196 offset:0
    v_mfma_f32_32x32x16_bf16 v[96:111], a[88:91], v[180:183], v[96:111]
    ds_read_b64 v[166:167], v196 offset:512
    ds_read_b64 v[168:169], v196 offset:256
    ds_read_b64 v[170:171], v196 offset:768
    s_waitcnt lgkmcnt(6)
    v_mfma_f32_16x16x32_bf16 v[112:115], a[92:95], v[184:187], v[112:115]
    ds_read_b64 v[172:173], v198 offset:256
    v_mfma_f32_32x32x16_bf16 v[80:95], a[92:95], v[188:191], v[80:95]
    ds_read_b64 v[174:175], v198 offset:320
    ds_read_b64 v[176:177], v196 offset:2048
    ds_read_b64 v[178:179], v196 offset:2560
    v_mfma_f32_32x32x16_bf16 v[96:111], a[92:95], v[192:195], v[96:111]
    ds_read_b64 v[180:181], v196 offset:2304
    ds_read_b64 v[182:183], v196 offset:2816
    s_waitcnt lgkmcnt(6)
    v_mfma_f32_16x16x32_bf16 v[112:115], a[96:99], v[160:163], v[112:115]
    ds_read_b64 v[184:185], v198 offset:512
    v_mfma_f32_32x32x16_bf16 v[80:95], a[96:99], v[164:167], v[80:95]
    ds_read_b64 v[186:187], v198 offset:576
    ds_read_b64 v[188:189], v196 offset:4096
    ds_read_b64 v[190:191], v196 offset:4608
    v_mfma_f32_32x32x16_bf16 v[96:111], a[96:99], v[168:171], v[96:111]
    ds_read_b64 v[192:193], v196 offset:4352
    ds_read_b64 v[194:195], v196 offset:4864
    s_waitcnt lgkmcnt(6)
    v_mfma_f32_16x16x32_bf16 v[112:115], a[100:103], v[172:175], v[112:115]
    ds_read_b64 v[160:161], v198 offset:768
    v_mfma_f32_32x32x16_bf16 v[80:95], a[100:103], v[176:179], v[80:95]
    ds_read_b64 v[162:163], v198 offset:832
    ds_read_b64 v[164:165], v196 offset:6144
    ds_read_b64 v[166:167], v196 offset:6656
    v_mfma_f32_32x32x16_bf16 v[96:111], a[100:103], v[180:183], v[96:111]
    ds_read_b64 v[168:169], v196 offset:6400
    ds_read_b64 v[170:171], v196 offset:6912
    s_waitcnt lgkmcnt(6)
    v_mfma_f32_16x16x32_bf16 v[112:115], a[104:107], v[184:187], v[112:115]
    ds_read_b64 v[172:173], v198 offset:1024
    v_mfma_f32_32x32x16_bf16 v[80:95], a[104:107], v[188:191], v[80:95]
    ds_read_b64 v[174:175], v198 offset:1088
    ds_read_b64 v[176:177], v196 offset:8192
    ds_read_b64 v[178:179], v196 offset:8704
    v_mfma_f32_32x32x16_bf16 v[96:111], a[104:107], v[192:195], v[96:111]
    ds_read_b64 v[180:181], v196 offset:8448
    ds_read_b64 v[182:183], v196 offset:8960
    s_mov_b32 s96, 12058624
    buffer_load_dwordx4 v[216:219], v56, s[16:19], s96 offen offset:0 sc1
    s_waitcnt lgkmcnt(6)
    v_mfma_f32_16x16x32_bf16 v[112:115], a[108:111], v[160:163], v[112:115]
    ds_read_b64 v[184:185], v198 offset:1280
    v_mfma_f32_32x32x16_bf16 v[80:95], a[108:111], v[164:167], v[80:95]
    ds_read_b64 v[186:187], v198 offset:1344
    ds_read_b64 v[188:189], v196 offset:10240
    ds_read_b64 v[190:191], v196 offset:10752
    v_mfma_f32_32x32x16_bf16 v[96:111], a[108:111], v[168:171], v[96:111]
    ds_read_b64 v[192:193], v196 offset:10496
    ds_read_b64 v[194:195], v196 offset:11008
    buffer_load_dwordx4 v[220:223], v56, s[16:19], s96 offen offset:256 sc1
    s_waitcnt lgkmcnt(6)
    v_mfma_f32_16x16x32_bf16 v[112:115], a[112:115], v[172:175], v[112:115]
    ds_read_b64 v[160:161], v198 offset:1536
    v_mfma_f32_32x32x16_bf16 v[80:95], a[112:115], v[176:179], v[80:95]
    ds_read_b64 v[162:163], v198 offset:1600
    ds_read_b64 v[164:165], v196 offset:12288
    ds_read_b64 v[166:167], v196 offset:12800
    v_mfma_f32_32x32x16_bf16 v[96:111], a[112:115], v[180:183], v[96:111]
    ds_read_b64 v[168:169], v196 offset:12544
    ds_read_b64 v[170:171], v196 offset:13056
    s_mov_b32 s96, 12091392
    buffer_load_dwordx4 v[224:227], v56, s[16:19], s96 offen offset:0 sc1
    s_waitcnt lgkmcnt(6)
    v_mfma_f32_16x16x32_bf16 v[112:115], a[116:119], v[184:187], v[112:115]
    ds_read_b64 v[172:173], v198 offset:1792
    v_mfma_f32_32x32x16_bf16 v[80:95], a[116:119], v[188:191], v[80:95]
    ds_read_b64 v[174:175], v198 offset:1856
    ds_read_b64 v[176:177], v196 offset:14336
    ds_read_b64 v[178:179], v196 offset:14848
    v_mfma_f32_32x32x16_bf16 v[96:111], a[116:119], v[192:195], v[96:111]
    ds_read_b64 v[180:181], v196 offset:14592
    ds_read_b64 v[182:183], v196 offset:15104
    buffer_load_dwordx4 v[228:231], v56, s[16:19], s96 offen offset:256 sc1
sl_67:
    s_waitcnt vmcnt(5)
    v_max3_u32 v2, v152, v153, v154
    s_waitcnt vmcnt(4)
    v_max3_u32 v2, v2, v155, v156
    v_max_u32 v2, v2, v157
    v_cmp_eq_u32 vcc, -1, v2
    s_nop 0
    s_cbranch_vccnz rd_68
rc_69:
    s_barrier
    s_waitcnt lgkmcnt(6)
    v_mfma_f32_16x16x32_bf16 v[112:115], a[120:123], v[160:163], v[112:115]
    v_add_u32 v198, v49, v198
    v_mfma_f32_32x32x16_bf16 v[80:95], a[120:123], v[164:167], v[80:95]
    v_add_u32 v196, 19584, v196
    ds_read_b64 v[184:185], v198 offset:0
    ds_read_b64 v[186:187], v198 offset:64
    v_mul_f32 v148, v24, v157
    v_mul_f32 v149, v25, v157
    v_mfma_f32_32x32x16_bf16 v[96:111], a[120:123], v[168:171], v[96:111]
    ds_read_b64 v[188:189], v196 offset:0
    ds_read_b64 v[190:191], v196 offset:512
    s_mov_b32 s96, 12124160
    buffer_load_dwordx4 v[232:235], v56, s[16:19], s96 offen offset:0 sc1
    v_mul_f32 v150, v26, v157
    v_mul_f32_e64 v151, v27, v157
    s_waitcnt lgkmcnt(4)
    v_mfma_f32_16x16x32_bf16 v[112:115], a[124:127], v[172:175], v[112:115]
    ds_read_b64 v[192:193], v198 offset:256
    v_mfma_f32_32x32x16_bf16 v[80:95], a[124:127], v[176:179], v[80:95]
    ds_read_b64 v[194:195], v198 offset:320
    ds_read_b64 v[160:161], v196 offset:2048
    v_mul_f32 v116, v8, v153
    v_mul_f32 v117, v9, v153
    v_mul_f32_e64 v118, v10, v153
    v_mfma_f32_32x32x16_bf16 v[96:111], a[124:127], v[180:183], v[96:111]
    ds_read_b64 v[162:163], v196 offset:2560
    buffer_load_dwordx4 v[236:239], v56, s[16:19], s96 offen offset:256 sc1
    v_mul_f32 v119, v11, v153
    v_mul_f32_e64 v120, v12, v153
    s_waitcnt lgkmcnt(4)
    v_mfma_f32_16x16x32_bf16 v[112:115], a[128:131], v[184:187], v[112:115]
    ds_read_b64 v[164:165], v198 offset:512
    v_mfma_f32_32x32x16_bf16 v[80:95], a[128:131], v[188:191], v[80:95]
    ds_read_b64 v[166:167], v198 offset:576
    ds_read_b64 v[168:169], v196 offset:4096
    ds_read_b64 v[170:171], v196 offset:4608
    v_mul_f32 v121, v13, v153
    v_mul_f32_e64 v122, v14, v153
    s_waitcnt lgkmcnt(4)
    v_mfma_f32_16x16x32_bf16 v[112:115], a[132:135], v[192:195], v[112:115]
    ds_read_b64 v[172:173], v198 offset:768
    v_mfma_f32_32x32x16_bf16 v[80:95], a[132:135], v[160:163], v[80:95]
    ds_read_b64 v[174:175], v198 offset:832
    ds_read_b64 v[176:177], v196 offset:6144
    ds_read_b64 v[178:179], v196 offset:6656
    s_mov_b32 s96, 12156928
    buffer_load_dwordx4 v[240:243], v56, s[16:19], s96 offen offset:0 sc1
    v_mul_f32 v123, v15, v153
    v_mul_f32_e64 v124, v16, v153
    s_waitcnt lgkmcnt(4)
    v_mfma_f32_16x16x32_bf16 v[112:115], a[136:139], v[164:167], v[112:115]
    ds_read_b64 v[180:181], v198 offset:1024
    v_mfma_f32_32x32x16_bf16 v[80:95], a[136:139], v[168:171], v[80:95]
    ds_read_b64 v[182:183], v198 offset:1088
    ds_read_b64 v[184:185], v196 offset:8192
    ds_read_b64 v[186:187], v196 offset:8704
    v_mul_f32 v125, v17, v153
    v_mul_f32_e64 v126, v18, v153
    s_waitcnt lgkmcnt(4)
    v_mfma_f32_16x16x32_bf16 v[112:115], a[140:143], v[172:175], v[112:115]
    ds_read_b64 v[188:189], v198 offset:1280
    v_mfma_f32_32x32x16_bf16 v[80:95], a[140:143], v[176:179], v[80:95]
    ds_read_b64 v[190:191], v198 offset:1344
    ds_read_b64 v[192:193], v196 offset:10240
    ds_read_b64 v[194:195], v196 offset:10752
    buffer_load_dwordx4 v[244:247], v56, s[16:19], s96 offen offset:256 sc1
    v_mul_f32 v127, v19, v153
    v_mul_f32_e64 v128, v20, v153
    s_waitcnt lgkmcnt(4)
    v_mfma_f32_16x16x32_bf16 v[112:115], a[144:147], v[180:183], v[112:115]
    ds_read_b64 v[160:161], v198 offset:1536
    v_mfma_f32_32x32x16_bf16 v[80:95], a[144:147], v[184:187], v[80:95]
    ds_read_b64 v[162:163], v198 offset:1600
    ds_read_b64 v[164:165], v196 offset:12288
    ds_read_b64 v[166:167], v196 offset:12800
    v_mul_f32 v129, v21, v153
    v_mul_f32_e64 v130, v22, v153
    s_waitcnt lgkmcnt(4)
    v_mfma_f32_16x16x32_bf16 v[112:115], a[148:151], v[188:191], v[112:115]
    ds_read_b64 v[168:169], v198 offset:1792
    v_mfma_f32_32x32x16_bf16 v[80:95], a[148:151], v[192:195], v[80:95]
    ds_read_b64 v[170:171], v198 offset:1856
    ds_read_b64 v[172:173], v196 offset:14336
    ds_read_b64 v[174:175], v196 offset:14848
    s_mov_b32 s96, 12058624
    buffer_load_dwordx2 v[248:249], v57, s[16:19], s96 offen offset:0 sc1
    v_mul_f32 v131, v23, v153
    v_mul_f32_e64 v132, v8, v155
    s_waitcnt lgkmcnt(4)
    v_mfma_f32_16x16x32_bf16 v[112:115], a[152:155], v[160:163], v[112:115]
    ds_read_b64 v[176:177], v196 offset:256
    v_mfma_f32_32x32x16_bf16 v[80:95], a[152:155], v[164:167], v[80:95]
    ds_read_b64 v[178:179], v196 offset:768
    ds_read_b64 v[180:181], v196 offset:2304
    ds_read_b64 v[182:183], v196 offset:2816
    v_mul_f32 v133, v9, v155
    v_mul_f32_e64 v134, v10, v155
    s_waitcnt lgkmcnt(4)
    v_mfma_f32_16x16x32_bf16 v[112:115], a[156:159], v[168:171], v[112:115]
    ds_read_b64 v[184:185], v196 offset:4352
    v_mfma_f32_32x32x16_bf16 v[80:95], a[156:159], v[172:175], v[80:95]
    ds_read_b64 v[186:187], v196 offset:4864
    ds_read_b64 v[188:189], v196 offset:6400
    ds_read_b64 v[190:191], v196 offset:6912
    buffer_load_dwordx2 v[252:253], v57, s[16:19], s96 offen offset:128 sc1
    v_mul_f32 v135, v11, v155
    v_mul_f32 v136, v12, v155
    v_mul_f32 v137, v13, v155
    v_mul_f32 v138, v14, v155
    v_mul_f32 v139, v15, v155
    v_mul_f32 v140, v16, v155
    v_mul_f32 v141, v17, v155
    v_mul_f32 v142, v18, v155
    v_mul_f32 v143, v19, v155
    v_mul_f32 v144, v20, v155
    v_mul_f32 v145, v21, v155
    v_mul_f32 v146, v22, v155
    v_mul_f32 v147, v23, v155
    s_waitcnt lgkmcnt(4)
    v_mfma_f32_32x32x16_bf16 v[96:111], a[128:131], v[176:179], v[96:111]
    ds_read_b64 v[192:193], v196 offset:8448
    ds_read_b64 v[194:195], v196 offset:8960
    v_mfma_f32_32x32x16_bf16 v[96:111], a[132:135], v[180:183], v[96:111]
    ds_read_b64 v[160:161], v196 offset:10496
    ds_read_b64 v[162:163], v196 offset:11008
    s_mov_b32 s96, 12075008
    buffer_load_dwordx2 v[250:251], v57, s[16:19], s96 offen offset:0 sc1
    v_fma_f32 v112, v112, v156, v148
    v_fma_f32 v113, v113, v156, v149
    s_waitcnt lgkmcnt(4)
    v_mfma_f32_32x32x16_bf16 v[96:111], a[136:139], v[184:187], v[96:111]
    ds_read_b64 v[164:165], v196 offset:12544
    ds_read_b64 v[166:167], v196 offset:13056
    v_fma_f32 v114, v114, v156, v150
    v_fma_f32 v115, v115, v156, v151
    v_cvt_pk_bf16_f32 v112, v112, v113
    v_mfma_f32_32x32x16_bf16 v[96:111], a[140:143], v[188:191], v[96:111]
    ds_read_b64 v[168:169], v196 offset:14592
    ds_read_b64 v[170:171], v196 offset:15104
    buffer_load_dwordx2 v[254:255], v57, s[16:19], s96 offen offset:128 sc1
    v_cvt_pk_bf16_f32 v113, v114, v115
    v_fma_f32 v80, v80, v152, v116
    s_waitcnt lgkmcnt(4)
    v_mfma_f32_32x32x16_bf16 v[96:111], a[144:147], v[192:195], v[96:111]
    v_fma_f32 v81, v81, v152, v117
    v_fma_f32 v82, v82, v152, v118
    v_fma_f32 v83, v83, v152, v119
    v_cvt_pk_bf16_f32 v80, v80, v81
    v_cvt_pk_bf16_f32 v81, v82, v83
    v_mfma_f32_32x32x16_bf16 v[96:111], a[148:151], v[160:163], v[96:111]
    ds_write_b64 v40, v[112:113] offset:0
    ds_write_b64 v38, v[80:81] offset:0
    v_fma_f32 v84, v84, v152, v120
    v_fma_f32 v85, v85, v152, v121
    s_waitcnt lgkmcnt(2)
    v_mfma_f32_32x32x16_bf16 v[96:111], a[152:155], v[164:167], v[96:111]
    v_fma_f32 v86, v86, v152, v122
    v_fma_f32 v87, v87, v152, v123
    v_cvt_pk_bf16_f32 v84, v84, v85
    v_cvt_pk_bf16_f32 v85, v86, v87
    v_fma_f32 v88, v88, v152, v124
    v_mfma_f32_32x32x16_bf16 v[96:111], a[156:159], v[168:171], v[96:111]
    s_mov_b32 s96, 9437184
    buffer_load_dwordx4 v[208:211], v59, s[16:19], s96 offen sc1
    v_fma_f32 v89, v89, v152, v125
    v_fma_f32 v90, v90, v152, v126
    v_fma_f32 v91, v91, v152, v127
    v_cvt_pk_bf16_f32 v88, v88, v89
    v_cvt_pk_bf16_f32 v89, v90, v91
    ds_write_b64 v38, v[84:85] offset:6400
    ds_write_b64 v38, v[88:89] offset:12800
    v_fma_f32 v92, v92, v152, v128
    v_fma_f32 v93, v93, v152, v129
    v_fma_f32 v94, v94, v152, v130
    v_fma_f32 v95, v95, v152, v131
    v_cvt_pk_bf16_f32 v92, v92, v93
    v_cvt_pk_bf16_f32 v93, v94, v95
    ds_write_b64 v39, v[92:93] offset:0
    v_pk_fma_f32 v[96:97], v[96:97], v[154:155], v[132:133] op_sel_hi:[1,0,1]
    v_pk_fma_f32 v[98:99], v[98:99], v[154:155], v[134:135] op_sel_hi:[1,0,1]
    v_cvt_pk_bf16_f32 v96, v96, v97
    v_cvt_pk_bf16_f32 v97, v98, v99
    v_pk_fma_f32 v[100:101], v[100:101], v[154:155], v[136:137] op_sel_hi:[1,0,1]
    v_pk_fma_f32 v[102:103], v[102:103], v[154:155], v[138:139] op_sel_hi:[1,0,1]
    v_cvt_pk_bf16_f32 v100, v100, v101
    v_cvt_pk_bf16_f32 v101, v102, v103
    ds_write_b64 v38, v[96:97] offset:1600
    ds_write_b64 v38, v[100:101] offset:8000
    v_pk_fma_f32 v[104:105], v[104:105], v[154:155], v[140:141] op_sel_hi:[1,0,1]
    v_pk_fma_f32 v[106:107], v[106:107], v[154:155], v[142:143] op_sel_hi:[1,0,1]
    v_cvt_pk_bf16_f32 v104, v104, v105
    v_cvt_pk_bf16_f32 v105, v106, v107
    v_pk_fma_f32 v[108:109], v[108:109], v[154:155], v[144:145] op_sel_hi:[1,0,1]
    v_pk_fma_f32 v[110:111], v[110:111], v[154:155], v[146:147] op_sel_hi:[1,0,1]
    v_cvt_pk_bf16_f32 v108, v108, v109
    v_cvt_pk_bf16_f32 v109, v110, v111
    ds_write_b64 v38, v[104:105] offset:14400
    ds_write_b64 v39, v[108:109] offset:1600
    v_cmp_u_f32 vcc, v82, v114
    v_cmp_u_f32 s[82:83], v98, v98
    s_lshl_b32 s25, s24, 2
    s_add_u32 s25, s25, 160256
    s_or_b64 vcc, vcc, s[82:83]
    s_cselect_b32 s26, 1, 0
    v_mov_b32 v196, s25
    v_mov_b32 v197, s26
    ds_write_b32 v196, v197
    s_waitcnt lgkmcnt(0)
    s_barrier
    v_mov_b32 v158, 160256
    ds_read_b128 v[128:131], v158
    v_mov_b32 v94, 0
    v_mov_b32 v95, 0
    v_mov_b32 v98, 0
    v_mov_b32_e64 v99, 0
    s_mov_b64 exec, 0xffff
    ds_read_b64 v[94:95], v42 offset:320
    ds_read_b64 v[98:99], v42 offset:640
    s_mov_b64 exec, -1
    s_nop 0
    ds_read_b64 v[92:93], v41 offset:320
    ds_read_b64 v[96:97], v41 offset:640
    ds_read_b64 v[84:85], v41 offset:6720
    ds_read_b64 v[86:87], v42 offset:6720
    ds_read_b64 v[80:81], v41 offset:6400
    ds_read_b64 v[82:83], v42 offset:6400
    ds_read_b64 v[88:89], v41 offset:7040
    ds_read_b64 v[90:91], v42 offset:7040
    ds_read_b64_tr_b16 v[106:107], v44 offset:0
    ds_read_b64_tr_b16 v[100:101], v43 offset:0
    s_add_u32 s97, s36, 9437184
    buffer_load_dword v212, v61, s[16:19], s97 offen sc1
    ds_read_b64_tr_b16 v[108:109], v44 offset:320
    ds_read_b64_tr_b16 v[102:103], v43 offset:320
    ds_read_b64_tr_b16 v[110:111], v44 offset:640
    ds_read_b64_tr_b16 v[104:105], v43 offset:640
    s_mov_b32 s82, 0x3ea52b5c
    s_lshl_b32 s25, s98, 4
    s_add_u32 s25, s25, 12058624
    s_lshl_b32 s26, s98, 3
    s_add_u32 s26, s26, 12058624
    s_waitcnt lgkmcnt(15)
    v_or3_b32 v128, v128, v129, v130
    v_or_b32 v128, v128, v131
    v_cmp_ne_u32 vcc, 0, v128
    s_nop 0
    s_cbranch_vccnz rd_70
rc_71:
    s_waitcnt lgkmcnt(10)
    v_mfma_f32_16x16x32_bf16 v[116:119], v[84:87], v[92:95], v[28:31]
    v_mfma_f32_16x16x32_bf16 v[120:123], v[84:87], v[96:99], v[32:35]
    s_waitcnt lgkmcnt(8)
    v_mfma_f32_16x16x32_bf16 v[112:115], v[80:83], v[92:95], v[32:35]
    s_waitcnt lgkmcnt(6)
    v_mfma_f32_16x16x32_bf16 v[124:127], v[88:91], v[96:99], v[28:31]
    s_nop 5
    v_max_f32 v112, v112, v116
    v_max_f32 v113, v113, v117
    v_max_f32 v114, v114, v118
    v_max_f32 v115, v115, v119
    v_max3_f32 v156, v112, v113, v114
    v_max_f32 v156, v156, v115
    v_max_f32 v120, v120, v124
    v_max_f32 v121, v121, v125
    v_max_f32 v122, v122, v126
    v_max_f32 v123, v123, v127
    v_max3_f32 v157, v120, v121, v122
    v_max_f32 v157, v157, v123
    s_nop 1
    v_permlane16_swap_b32 v156, v157
    v_max_f32 v156, v156, v157
    v_mov_b32 v157, v156
    s_nop 1
    v_permlane32_swap_b32 v156, v157
    v_max_f32 v156, v156, v157
    v_mul_f32 v156, s82, v156
    v_mov_b32 v157, v156
    s_nop 1
    v_permlane16_swap_b32 v156, v157
    v_fma_f32 v112, v112, s82, -v156
    v_fma_f32 v113, v113, s82, -v156
    v_fma_f32 v114, v114, s82, -v156
    v_fma_f32 v115, v115, s82, -v156
    v_exp_f32 v112, v112
    v_exp_f32 v113, v113
    v_exp_f32 v114, v114
    v_exp_f32 v115, v115
    v_cvt_pk_bf16_f32 v116, v112, v113
    v_cvt_pk_bf16_f32 v117, v114, v115
    v_bfi_b32 v128, v36, 0, v116
    v_and_b32 v130, v36, v116
    v_bfi_b32 v129, v37, 0, v117
    v_and_b32 v131, v37, v117
    s_waitcnt lgkmcnt(3)
    s_nop 0
    v_mfma_f32_16x16x32_bf16 v[144:147], v[106:109], v[128:131], 0
    s_waitcnt lgkmcnt(2)
    v_mfma_f32_16x16x32_bf16 v[136:139], v[100:103], v[128:131], 0
    v_fma_f32 v120, v120, s82, -v157
    v_fma_f32 v121, v121, s82, -v157
    v_fma_f32 v122, v122, s82, -v157
    v_fma_f32 v123, v123, s82, -v157
    v_exp_f32 v120, v120
    v_exp_f32 v121, v121
    v_exp_f32 v122, v122
    v_exp_f32_e64 v123, v123
    v_cvt_pk_bf16_f32 v124, v120, v121
    v_cvt_pk_bf16_f32 v125, v122, v123
    v_bfi_b32 v132, v36, 0, v124
    v_and_b32 v134, v36, v124
    v_bfi_b32 v133, v37, 0, v125
    v_and_b32 v135, v37, v125
    s_waitcnt lgkmcnt(1)
    s_nop 0
    v_mfma_f32_16x16x32_bf16 v[148:151], v[108:111], v[132:135], 0
    s_waitcnt lgkmcnt(0)
    v_mfma_f32_16x16x32_bf16 v[140:143], v[102:105], v[132:135], 0
    v_mov_b32 v158, v144
    s_nop 1
    v_permlane16_swap_b32 v144, v158
    v_rcp_f32 v158, v158
    s_nop 0
    v_pk_mul_f32 v[136:137], v[136:137], v[158:159] op_sel_hi:[1,0]
    v_pk_mul_f32 v[138:139], v[138:139], v[158:159] op_sel_hi:[1,0]
    v_pk_mul_f32 v[144:145], v[144:145], v[158:159] op_sel_hi:[1,0]
    v_pk_mul_f32 v[146:147], v[146:147], v[158:159] op_sel_hi:[1,0]
    v_cvt_pk_bf16_f32 v112, v136, v137
    v_cvt_pk_bf16_f32 v116, v144, v145
    v_cvt_pk_bf16_f32 v113, v138, v139
    v_cvt_pk_bf16_f32 v117, v146, v147
    v_mov_b32 v160, v148
    s_nop 1
    v_permlane16_swap_b32 v148, v160
    v_rcp_f32_e64 v160, v160
    s_nop 0
    v_pk_mul_f32 v[140:141], v[140:141], v[160:161] op_sel_hi:[1,0]
    v_pk_mul_f32 v[142:143], v[142:143], v[160:161] op_sel_hi:[1,0]
    v_pk_mul_f32 v[148:149], v[148:149], v[160:161] op_sel_hi:[1,0]
    v_pk_mul_f32 v[150:151], v[150:151], v[160:161] op_sel_hi:[1,0]
    v_cvt_pk_bf16_f32 v114, v140, v141
    v_cvt_pk_bf16_f32 v118, v148, v149
    v_cvt_pk_bf16_f32 v115, v142, v143
    v_cvt_pk_bf16_f32 v119, v150, v151
    v_permlane16_swap_b32 v112, v114
    v_permlane16_swap_b32 v113, v115
    v_permlane16_swap_b32 v116, v118
    v_permlane16_swap_b32 v117, v119
    buffer_store_dwordx4 v[112:115], v45, s[16:19], s25 offen sc1
    s_mov_b64 exec, s[80:81]
    buffer_store_dwordx2 v[116:117], v46, s[16:19], s26 offen sc1
    s_mov_b64 exec, -1
oe_72:
    s_waitcnt vmcnt(15)
    v_mfma_f32_16x16x32_bf16 v[112:115], a[176:179], v[216:219], 0
    v_mov_b32 v136, 0
    v_mov_b32 v137, 0
    s_waitcnt vmcnt(14)
    v_mfma_f32_16x16x32_bf16 v[116:119], a[176:179], v[220:223], 0
    v_mov_b32 v138, 0
    v_mov_b32 v139, 0
    s_waitcnt vmcnt(13)
    v_mfma_f32_16x16x32_bf16 v[112:115], a[196:199], v[224:227], v[112:115]
    v_mov_b32 v140, 0
    v_mov_b32 v141, 0
    s_waitcnt vmcnt(12)
    v_mfma_f32_16x16x32_bf16 v[116:119], a[196:199], v[228:231], v[116:119]
    s_mov_b32 s25, 14680064
    s_add_u32 s26, s36, 14680064
    s_waitcnt vmcnt(11)
    v_mfma_f32_16x16x32_bf16 v[112:115], a[216:219], v[232:235], v[112:115]
    s_add_u32 s27, s35, 3506176
    s_mov_b32 s28, 0x99999999
    s_waitcnt vmcnt(10)
    v_mfma_f32_16x16x32_bf16 v[116:119], a[216:219], v[236:239], v[116:119]
    s_mov_b32 s29, 0x99999999
    s_waitcnt vmcnt(9)
    v_mfma_f32_16x16x32_bf16 v[112:115], a[236:239], v[240:243], v[112:115]
    s_waitcnt vmcnt(8)
    v_mfma_f32_16x16x32_bf16 v[116:119], a[236:239], v[244:247], v[116:119]
    s_waitcnt vmcnt(5)
    v_mfma_f32_16x16x32_bf16 v[112:115], v[52:55], v[248:251], v[112:115]
    s_waitcnt vmcnt(4)
    v_mfma_f32_16x16x32_bf16 v[116:119], v[52:55], v[252:255], v[116:119]
    v_mfma_f32_16x16x32_bf16 v[88:91], a[164:167], v[216:219], 0
    v_mfma_f32_16x16x32_bf16 v[92:95], a[164:167], v[220:223], 0
    v_mfma_f32_16x16x32_bf16 v[88:91], a[184:187], v[224:227], v[88:91]
    s_waitcnt vmcnt(3)
    v_max3_u32 v132, v208, v209, v210
    s_waitcnt vmcnt(2)
    v_max3_u32 v132, v132, v211, v212
    v_mfma_f32_16x16x32_bf16 v[92:95], a[184:187], v[228:231], v[92:95]
    v_cmp_eq_u32 s[82:83], -1, v132
    v_mfma_f32_16x16x32_bf16 v[88:91], a[204:207], v[232:235], v[88:91]
    v_mfma_f32_16x16x32_bf16 v[92:95], a[204:207], v[236:239], v[92:95]
    v_cmp_u_f32 vcc, v112, v116
    s_nop 0
    s_or_b64 vcc, vcc, s[82:83]
    s_cbranch_vccnz rd_73
rc_74:
    v_mfma_f32_16x16x32_bf16 v[88:91], a[224:227], v[240:243], v[88:91]
    ds_write_b128 v203, v[112:115] offset:24576
    v_mfma_f32_16x16x32_bf16 v[92:95], a[224:227], v[244:247], v[92:95]
    v_mfma_f32_16x16x32_bf16 v[88:91], a[244:247], v[248:251], v[88:91]
    ds_write_b128 v203, v[116:119] offset:25600
    v_mfma_f32_16x16x32_bf16 v[92:95], a[244:247], v[252:255], v[92:95]
    v_mfma_f32_16x16x32_bf16 v[96:99], a[168:171], v[216:219], 0
    v_lshlrev_b32_e64 v120, 16, v208
    v_and_b32 v121, 0xffff0000, v208
    v_mfma_f32_16x16x32_bf16 v[100:103], a[168:171], v[220:223], 0
    v_lshlrev_b32_e64 v122, 16, v209
    v_and_b32 v123, 0xffff0000, v209
    v_mfma_f32_16x16x32_bf16 v[96:99], a[188:191], v[224:227], v[96:99]
    v_lshlrev_b32_e64 v124, 16, v210
    v_and_b32 v125, 0xffff0000, v210
    v_mfma_f32_16x16x32_bf16 v[100:103], a[188:191], v[228:231], v[100:103]
    v_lshlrev_b32_e64 v126, 16, v211
    v_and_b32 v127, 0xffff0000, v211
    v_mfma_f32_16x16x32_bf16 v[96:99], a[208:211], v[232:235], v[96:99]
    v_lshlrev_b32_e64 v128, 16, v212
    v_and_b32 v129, 0xffff0000, v212
    v_mfma_f32_16x16x32_bf16 v[100:103], a[208:211], v[236:239], v[100:103]
    v_mfma_f32_16x16x32_bf16 v[96:99], a[228:231], v[240:243], v[96:99]
    ds_write_b128 v200, v[88:91] offset:0
    v_mfma_f32_16x16x32_bf16 v[100:103], a[228:231], v[244:247], v[100:103]
    v_mfma_f32_16x16x32_bf16 v[96:99], a[248:251], v[248:251], v[96:99]
    ds_write_b128 v200, v[92:95] offset:1024
    v_mfma_f32_16x16x32_bf16 v[100:103], a[248:251], v[252:255], v[100:103]
    v_mfma_f32_16x16x32_bf16 v[104:107], a[172:175], v[216:219], 0
    v_mfma_f32_16x16x32_bf16 v[108:111], a[172:175], v[220:223], 0
    v_mfma_f32_16x16x32_bf16 v[104:107], a[192:195], v[224:227], v[104:107]
    v_mfma_f32_16x16x32_bf16 v[108:111], a[192:195], v[228:231], v[108:111]
    v_mfma_f32_16x16x32_bf16 v[104:107], a[212:215], v[232:235], v[104:107]
    v_mfma_f32_16x16x32_bf16 v[108:111], a[212:215], v[236:239], v[108:111]
    v_mfma_f32_16x16x32_bf16 v[104:107], a[232:235], v[240:243], v[104:107]
    ds_write_b128 v201, v[96:99] offset:2048
    v_mfma_f32_16x16x32_bf16 v[108:111], a[232:235], v[244:247], v[108:111]
    v_mfma_f32_16x16x32_bf16 v[104:107], a[252:255], v[248:251], v[104:107]
    ds_write_b128 v201, v[100:103] offset:3072
    v_mfma_f32_16x16x32_bf16 v[108:111], a[252:255], v[252:255], v[108:111]
    v_mfma_f32_16x16x32_bf16 v[80:83], a[160:163], v[216:219], v[120:123]
    v_mfma_f32_16x16x32_bf16 v[84:87], a[160:163], v[220:223], v[124:127]
    v_mfma_f32_16x16x32_bf16 v[80:83], a[180:183], v[224:227], v[80:83]
    v_mfma_f32_16x16x32_bf16 v[84:87], a[180:183], v[228:231], v[84:87]
    v_mfma_f32_16x16x32_bf16 v[80:83], a[200:203], v[232:235], v[80:83]
    s_nop 0
    ds_write_b128 v202, v[104:107] offset:4096
    v_mfma_f32_16x16x32_bf16 v[84:87], a[200:203], v[236:239], v[84:87]
    ds_write_b128 v202, v[108:111] offset:5120
    v_mfma_f32_16x16x32_bf16 v[80:83], a[220:223], v[240:243], v[80:83]
    v_mfma_f32_16x16x32_bf16 v[84:87], a[220:223], v[244:247], v[84:87]
    v_mfma_f32_16x16x32_bf16 v[80:83], a[240:243], v[248:251], v[80:83]
    v_mfma_f32_16x16x32_bf16 v[84:87], a[240:243], v[252:255], v[84:87]
    s_waitcnt lgkmcnt(0)
    s_barrier
    s_nop 0
    ds_read_b128 v[88:91], v204 offset:0
    ds_read_b128 v[92:95], v204 offset:1024
    ds_read_b128 v[96:99], v204 offset:2048
    ds_read_b128 v[100:103], v204 offset:3072
    ds_read_b128 v[104:107], v204 offset:4096
    ds_read_b128 v[108:111], v204 offset:5120
    ds_read_b64 v[112:113], v205 offset:24576
    ds_read_b64 v[114:115], v205 offset:26624
    ds_read_b64 v[116:117], v205 offset:28672
    ds_read_b64 v[118:119], v205 offset:30720
    s_mov_b32 s96, 12062720
    buffer_load_dwordx4 v[216:219], v56, s[16:19], s96 offen offset:0 sc1
    buffer_load_dwordx4 v[220:223], v56, s[16:19], s96 offen offset:256 sc1
    s_mov_b32 s96, 12095488
    buffer_load_dwordx4 v[224:227], v56, s[16:19], s96 offen offset:0 sc1
    buffer_load_dwordx4 v[228:231], v56, s[16:19], s96 offen offset:256 sc1
    s_mov_b32 s96, 12128256
    buffer_load_dwordx4 v[232:235], v56, s[16:19], s96 offen offset:0 sc1
    buffer_load_dwordx4 v[236:239], v56, s[16:19], s96 offen offset:256 sc1
    s_waitcnt lgkmcnt(9)
    v_pk_add_f32 v[80:81], v[80:81], v[88:89]
    v_pk_add_f32 v[82:83], v[82:83], v[90:91]
    s_waitcnt lgkmcnt(8)
    v_pk_add_f32 v[84:85], v[84:85], v[92:93]
    v_pk_add_f32 v[86:87], v[86:87], v[94:95]
    s_waitcnt lgkmcnt(7)
    v_pk_add_f32 v[80:81], v[80:81], v[96:97]
    v_pk_add_f32 v[82:83], v[82:83], v[98:99]
    s_waitcnt lgkmcnt(6)
    v_pk_add_f32 v[84:85], v[84:85], v[100:101]
    v_pk_add_f32 v[86:87], v[86:87], v[102:103]
    s_waitcnt lgkmcnt(5)
    v_pk_add_f32 v[80:81], v[80:81], v[104:105]
    v_pk_add_f32 v[82:83], v[82:83], v[106:107]
    s_waitcnt lgkmcnt(4)
    v_pk_add_f32 v[84:85], v[84:85], v[108:109]
    v_pk_add_f32 v[86:87], v[86:87], v[110:111]
    v_cvt_pk_bf16_f32 v132, v80, v81
    v_cvt_pk_bf16_f32 v133, v82, v83
    v_cvt_pk_bf16_f32 v134, v84, v85
    v_cvt_pk_bf16_f32 v135, v86, v87
    s_waitcnt lgkmcnt(3)
    v_pk_add_f32 v[128:129], v[128:129], v[112:113]
    s_waitcnt lgkmcnt(2)
    v_pk_add_f32 v[128:129], v[128:129], v[114:115]
    s_waitcnt lgkmcnt(1)
    v_pk_add_f32 v[128:129], v[128:129], v[116:117]
    s_waitcnt lgkmcnt(0)
    v_pk_add_f32 v[128:129], v[128:129], v[118:119]
    v_cvt_pk_bf16_f32 v130, v128, v129
    buffer_store_dwordx4 v[132:135], v59, s[16:19], s25 offen sc1
    buffer_store_dword v130, v61, s[16:19], s26 offen sc1
    v_dot2c_f32_bf16 v136, v132, v215
    v_dot2c_f32_bf16 v137, v132, v132
    v_dot2c_f32_bf16 v136, v133, v215
    v_dot2c_f32_bf16 v137, v133, v133
    v_dot2c_f32_bf16 v138, v134, v215
    v_dot2c_f32_bf16 v139, v134, v134
    v_dot2c_f32_bf16 v138, v135, v215
    v_dot2c_f32_bf16 v139, v135, v135
    v_dot2c_f32_bf16 v140, v130, v215
    v_dot2c_f32_bf16 v141, v130, v130
    v_permlane32_swap_b32 v136, v138
    v_permlane32_swap_b32 v137, v139
    v_pk_add_f32 v[136:137], v[136:137], v[138:139]
    v_pk_add_f32 v[136:137], v[136:137], v[140:141]
    s_nop 1
    v_permlane16_swap_b32 v136, v137
    v_add_f32_e64 v136, v136, v137
    ds_write_b32 v206, v136 offset:32768
    s_mov_b32 s96, 12161024
    buffer_load_dwordx4 v[240:243], v56, s[16:19], s96 offen offset:0 sc1
    buffer_load_dwordx4 v[244:247], v56, s[16:19], s96 offen offset:256 sc1
    s_mov_b32 s96, 12060672
    buffer_load_dwordx2 v[248:249], v57, s[16:19], s96 offen offset:0 sc1
    buffer_load_dwordx2 v[252:253], v57, s[16:19], s96 offen offset:128 sc1
    s_mov_b32 s96, 12077056
    buffer_load_dwordx2 v[250:251], v57, s[16:19], s96 offen offset:0 sc1
    buffer_load_dwordx2 v[254:255], v57, s[16:19], s96 offen offset:128 sc1
    s_mov_b32 s96, 9439232
    buffer_load_dwordx4 v[208:211], v59, s[16:19], s96 offen sc1
    s_add_u32 s97, s36, 9439232
    buffer_load_dword v212, v61, s[16:19], s97 offen sc1
    s_waitcnt lgkmcnt(0)
    s_barrier
    ds_read2st64_b32 v[136:137], v207 offset0:0 offset1:1
    ds_read2st64_b32 v[138:139], v207 offset0:2 offset1:3
    ds_read_b64_tr_b16 v[144:145], v65 offset:32
    ds_read_b64_tr_b16 v[146:147], v65 offset:0
    ds_read_b64_tr_b16 v[148:149], v65 offset:160
    ds_read_b64_tr_b16 v[150:151], v65 offset:128
    ds_read_b64_tr_b16 v[152:153], v65 offset:288
    ds_read_b64_tr_b16 v[154:155], v65 offset:256
    ds_read_b64_tr_b16 v[156:157], v65 offset:416
    ds_read_b64_tr_b16 v[158:159], v65 offset:384
    ds_read_b64_tr_b16 v[160:161], v65 offset:544
    ds_read_b64_tr_b16 v[162:163], v65 offset:512
    ds_read_b64_tr_b16 v[164:165], v65 offset:672
    ds_read_b64_tr_b16 v[166:167], v65 offset:640
    ds_read_b64_tr_b16 v[168:169], v65 offset:800
    ds_read_b64_tr_b16 v[170:171], v65 offset:768
    ds_read_b64_tr_b16 v[172:173], v65 offset:928
    ds_read_b64_tr_b16 v[174:175], v65 offset:896
    s_waitcnt lgkmcnt(15)
    v_pk_add_f32 v[136:137], v[136:137], v[138:139]
    v_add_f32 v136, v136, v137
    v_cndmask_b32 v136, v136, 1.0, s[28:29]
    s_mov_b64 exec, s[80:81]
    buffer_atomic_add_f32 v136, v214, s[16:19], s27 offen
    s_mov_b64 exec, -1
    v_lshrrev_b32 v176, 4, v0
    v_mul_u32_u24 v176, 1216, v176
    v_and_b32 v177, 15, v0
    v_lshl_add_u32 v176, v177, 3, v176
    v_add_u32 v176, 64, v176
    v_mov_b32 v178, 0
    v_mov_b32 v179, 0
    ds_write_b64 v176, v[178:179]
    v_mov_b32 v70, 0
    v_mov_b32 v71, 0
    v_mov_b32 v72, 0
oe_75:
    s_waitcnt vmcnt(16)
    v_mfma_f32_16x16x32_bf16 v[112:115], a[176:179], v[216:219], 0
    v_mov_b32 v136, 0
    v_mov_b32 v137, 0
    s_waitcnt vmcnt(15)
    v_mfma_f32_16x16x32_bf16 v[116:119], a[176:179], v[220:223], 0
    v_mov_b32 v138, 0
    v_mov_b32 v139, 0
    s_waitcnt vmcnt(14)
    v_mfma_f32_16x16x32_bf16 v[112:115], a[196:199], v[224:227], v[112:115]
    v_mov_b32 v140, 0
    v_mov_b32 v141, 0
    s_waitcnt vmcnt(13)
    v_mfma_f32_16x16x32_bf16 v[116:119], a[196:199], v[228:231], v[116:119]
    s_mov_b32 s25, 14682112
    s_add_u32 s26, s36, 14682112
    s_waitcnt vmcnt(12)
    v_mfma_f32_16x16x32_bf16 v[112:115], a[216:219], v[232:235], v[112:115]
    s_add_u32 s27, s35, 3510272
    s_mov_b32 s28, 0x99999999
    s_waitcnt vmcnt(11)
    v_mfma_f32_16x16x32_bf16 v[116:119], a[216:219], v[236:239], v[116:119]
    s_mov_b32 s29, 0x99999999
    s_waitcnt vmcnt(8)
    v_mfma_f32_16x16x32_bf16 v[112:115], a[236:239], v[240:243], v[112:115]
    s_waitcnt vmcnt(7)
    v_mfma_f32_16x16x32_bf16 v[116:119], a[236:239], v[244:247], v[116:119]
    s_waitcnt vmcnt(4)
    v_mfma_f32_16x16x32_bf16 v[112:115], v[52:55], v[248:251], v[112:115]
    s_waitcnt vmcnt(3)
    v_mfma_f32_16x16x32_bf16 v[116:119], v[52:55], v[252:255], v[116:119]
    v_mfma_f32_16x16x32_bf16 v[88:91], a[164:167], v[216:219], 0
    v_mfma_f32_16x16x32_bf16 v[92:95], a[164:167], v[220:223], 0
    v_mfma_f32_16x16x32_bf16 v[88:91], a[184:187], v[224:227], v[88:91]
    s_waitcnt vmcnt(2)
    v_max3_u32 v132, v208, v209, v210
    s_waitcnt vmcnt(1)
    v_max3_u32 v132, v132, v211, v212
    v_mfma_f32_16x16x32_bf16 v[92:95], a[184:187], v[228:231], v[92:95]
    v_cmp_eq_u32 s[82:83], -1, v132
    v_mfma_f32_16x16x32_bf16 v[88:91], a[204:207], v[232:235], v[88:91]
    v_mfma_f32_16x16x32_bf16 v[92:95], a[204:207], v[236:239], v[92:95]
    v_cmp_u_f32 vcc, v112, v116
    s_nop 0
    s_or_b64 vcc, vcc, s[82:83]
    s_cbranch_vccnz rd_76
rc_77:
    v_mfma_f32_16x16x32_bf16 v[88:91], a[224:227], v[240:243], v[88:91]
    ds_write_b128 v203, v[112:115] offset:24576
    v_mfma_f32_16x16x32_bf16 v[92:95], a[224:227], v[244:247], v[92:95]
    v_mfma_f32_16x16x32_bf16 v[88:91], a[244:247], v[248:251], v[88:91]
    ds_write_b128 v203, v[116:119] offset:25600
    v_mfma_f32_16x16x32_bf16 v[92:95], a[244:247], v[252:255], v[92:95]
    v_mfma_f32_16x16x32_bf16 v[96:99], a[168:171], v[216:219], 0
    v_lshlrev_b32_e64 v120, 16, v208
    v_and_b32 v121, 0xffff0000, v208
    v_mfma_f32_16x16x32_bf16 v[100:103], a[168:171], v[220:223], 0
    v_lshlrev_b32_e64 v122, 16, v209
    v_and_b32 v123, 0xffff0000, v209
    v_mfma_f32_16x16x32_bf16 v[96:99], a[188:191], v[224:227], v[96:99]
    v_lshlrev_b32_e64 v124, 16, v210
    v_and_b32 v125, 0xffff0000, v210
    v_mfma_f32_16x16x32_bf16 v[100:103], a[188:191], v[228:231], v[100:103]
    v_lshlrev_b32_e64 v126, 16, v211
    v_and_b32 v127, 0xffff0000, v211
    v_mfma_f32_16x16x32_bf16 v[96:99], a[208:211], v[232:235], v[96:99]
    v_lshlrev_b32_e64 v128, 16, v212
    v_and_b32 v129, 0xffff0000, v212
    v_mfma_f32_16x16x32_bf16 v[100:103], a[208:211], v[236:239], v[100:103]
    v_mfma_f32_16x16x32_bf16 v[96:99], a[228:231], v[240:243], v[96:99]
    ds_write_b128 v200, v[88:91] offset:0
    v_mfma_f32_16x16x32_bf16 v[100:103], a[228:231], v[244:247], v[100:103]
    v_mfma_f32_16x16x32_bf16 v[96:99], a[248:251], v[248:251], v[96:99]
    ds_write_b128 v200, v[92:95] offset:1024
    v_mfma_f32_16x16x32_bf16 v[100:103], a[248:251], v[252:255], v[100:103]
    v_mfma_f32_16x16x32_bf16 v[104:107], a[172:175], v[216:219], 0
    v_mfma_f32_16x16x32_bf16 v[108:111], a[172:175], v[220:223], 0
    v_mfma_f32_16x16x32_bf16 v[104:107], a[192:195], v[224:227], v[104:107]
    v_mfma_f32_16x16x32_bf16 v[108:111], a[192:195], v[228:231], v[108:111]
    v_mfma_f32_16x16x32_bf16 v[104:107], a[212:215], v[232:235], v[104:107]
    v_mfma_f32_16x16x32_bf16 v[108:111], a[212:215], v[236:239], v[108:111]
    v_mfma_f32_16x16x32_bf16 v[104:107], a[232:235], v[240:243], v[104:107]
    ds_write_b128 v201, v[96:99] offset:2048
    v_mfma_f32_16x16x32_bf16 v[108:111], a[232:235], v[244:247], v[108:111]
    v_mfma_f32_16x16x32_bf16 v[104:107], a[252:255], v[248:251], v[104:107]
    ds_write_b128 v201, v[100:103] offset:3072
    v_mfma_f32_16x16x32_bf16 v[108:111], a[252:255], v[252:255], v[108:111]
    v_mfma_f32_16x16x32_bf16 v[80:83], a[160:163], v[216:219], v[120:123]
    v_mfma_f32_16x16x32_bf16 v[84:87], a[160:163], v[220:223], v[124:127]
    v_mfma_f32_16x16x32_bf16 v[80:83], a[180:183], v[224:227], v[80:83]
    v_mfma_f32_16x16x32_bf16 v[84:87], a[180:183], v[228:231], v[84:87]
    v_mfma_f32_16x16x32_bf16 v[80:83], a[200:203], v[232:235], v[80:83]
    s_nop 0
    ds_write_b128 v202, v[104:107] offset:4096
    v_mfma_f32_16x16x32_bf16 v[84:87], a[200:203], v[236:239], v[84:87]
    ds_write_b128 v202, v[108:111] offset:5120
    v_mfma_f32_16x16x32_bf16 v[80:83], a[220:223], v[240:243], v[80:83]
    v_mfma_f32_16x16x32_bf16 v[84:87], a[220:223], v[244:247], v[84:87]
    v_mfma_f32_16x16x32_bf16 v[80:83], a[240:243], v[248:251], v[80:83]
    v_mfma_f32_16x16x32_bf16 v[84:87], a[240:243], v[252:255], v[84:87]
    s_waitcnt lgkmcnt(0)
    s_barrier
    s_nop 0
    ds_read_b128 v[88:91], v204 offset:0
    ds_read_b128 v[92:95], v204 offset:1024
    ds_read_b128 v[96:99], v204 offset:2048
    ds_read_b128 v[100:103], v204 offset:3072
    ds_read_b128 v[104:107], v204 offset:4096
    ds_read_b128 v[108:111], v204 offset:5120
    ds_read_b64 v[112:113], v205 offset:24576
    ds_read_b64 v[114:115], v205 offset:26624
    ds_read_b64 v[116:117], v205 offset:28672
    ds_read_b64 v[118:119], v205 offset:30720
    s_lshl_b32 s96, s75, 14
    s_add_u32 s96, s96, 14680064
    s_lshl_b32 s97, s24, 12
    s_add_u32 s97, s97, 3506176
    buffer_load_dwordx4 v[176:179], v62, s[16:19], s96 offen offset:0 sc1
    buffer_load_dwordx4 v[180:183], v62, s[16:19], s96 offen offset:1024 sc1
    buffer_load_dwordx4 v[184:187], v62, s[16:19], s97 offen offset:0 sc1
    buffer_load_dwordx4 v[188:191], v62, s[16:19], s97 offen offset:1024 sc1
    buffer_load_dwordx4 v[192:195], v62, s[16:19], s97 offen offset:2048 sc1
    buffer_load_dwordx4 v[196:199], v62, s[16:19], s97 offen offset:3072 sc1
    s_waitcnt lgkmcnt(9)
    v_pk_add_f32 v[80:81], v[80:81], v[88:89]
    v_pk_add_f32 v[82:83], v[82:83], v[90:91]
    s_waitcnt lgkmcnt(8)
    v_pk_add_f32 v[84:85], v[84:85], v[92:93]
    v_pk_add_f32 v[86:87], v[86:87], v[94:95]
    s_waitcnt lgkmcnt(7)
    v_pk_add_f32 v[80:81], v[80:81], v[96:97]
    v_pk_add_f32 v[82:83], v[82:83], v[98:99]
    s_waitcnt lgkmcnt(6)
    v_pk_add_f32 v[84:85], v[84:85], v[100:101]
    v_pk_add_f32 v[86:87], v[86:87], v[102:103]
    s_waitcnt lgkmcnt(5)
    v_pk_add_f32 v[80:81], v[80:81], v[104:105]
    v_pk_add_f32 v[82:83], v[82:83], v[106:107]
    s_waitcnt lgkmcnt(4)
    v_pk_add_f32 v[84:85], v[84:85], v[108:109]
    v_pk_add_f32 v[86:87], v[86:87], v[110:111]
    v_cvt_pk_bf16_f32 v132, v80, v81
    v_cvt_pk_bf16_f32 v133, v82, v83
    v_cvt_pk_bf16_f32 v134, v84, v85
    v_cvt_pk_bf16_f32 v135, v86, v87
    s_waitcnt lgkmcnt(3)
    v_pk_add_f32 v[128:129], v[128:129], v[112:113]
    s_waitcnt lgkmcnt(2)
    v_pk_add_f32 v[128:129], v[128:129], v[114:115]
    s_waitcnt lgkmcnt(1)
    v_pk_add_f32 v[128:129], v[128:129], v[116:117]
    s_waitcnt lgkmcnt(0)
    v_pk_add_f32 v[128:129], v[128:129], v[118:119]
    v_cvt_pk_bf16_f32 v130, v128, v129
    buffer_store_dwordx4 v[132:135], v59, s[16:19], s25 offen sc1
    buffer_store_dword v130, v61, s[16:19], s26 offen sc1
    v_dot2c_f32_bf16 v136, v132, v215
    v_dot2c_f32_bf16 v137, v132, v132
    v_dot2c_f32_bf16 v136, v133, v215
    v_dot2c_f32_bf16 v137, v133, v133
    v_dot2c_f32_bf16 v138, v134, v215
    v_dot2c_f32_bf16 v139, v134, v134
    v_dot2c_f32_bf16 v138, v135, v215
    v_dot2c_f32_bf16 v139, v135, v135
    v_dot2c_f32_bf16 v140, v130, v215
    v_dot2c_f32_bf16 v141, v130, v130
    v_permlane32_swap_b32 v136, v138
    v_permlane32_swap_b32 v137, v139
    v_pk_add_f32 v[136:137], v[136:137], v[138:139]
    v_pk_add_f32 v[136:137], v[136:137], v[140:141]
    s_nop 1
    v_permlane16_swap_b32 v136, v137
    v_add_f32 v136, v136, v137
    ds_write_b32 v206, v136 offset:32768
    s_waitcnt lgkmcnt(0)
    s_barrier
    ds_read2st64_b32 v[136:137], v207 offset0:0 offset1:1
    ds_read2st64_b32 v[138:139], v207 offset0:2 offset1:3
    s_waitcnt lgkmcnt(0)
    v_pk_add_f32 v[136:137], v[136:137], v[138:139]
    v_add_f32 v136, v136, v137
    v_cndmask_b32 v136, v136, 1.0, s[28:29]
    s_mov_b64 exec, s[80:81]
    buffer_atomic_add_f32 v136, v214, s[16:19], s27 offen
    s_mov_b64 exec, -1
    s_cmp_ge_u32 s2, 160
    s_cbranch_scc1 nc_78
    s_waitcnt vmcnt(3)
ce_80:
    v_max3_u32 v208, v176, v177, v178
    v_max3_u32 v208, v208, v179, v180
    v_max3_u32 v208, v208, v181, v182
    v_max_u32 v208, v208, v183
    v_cmp_eq_u32 s[82:83], -1, v208
    v_min3_f32 v209, v184, v187, v188
    v_min3_f32 v209, v209, v191, v192
    v_min3_f32 v209, v209, v195, v196
    v_min_f32 v209, v209, v199
    v_cmp_neq_f32 vcc, 0x41000000, v209
    s_nop 0
    s_or_b64 vcc, vcc, s[82:83]
    s_cbranch_vccnz rd_81
rc_82:
    v_mul_f32 v208, 0x3acccccd, v185
    v_mul_f32 v209, 0x3acccccd, v189
    v_mul_f32 v186, 0x3acccccd, v186
    v_mul_f32 v190, 0x3acccccd, v190
    v_fma_f32 v186, -v208, v208, v186
    v_fma_f32 v190, -v209, v209, v190
    v_max_f32 v186, 0, v186
    v_max_f32 v190, 0, v190
    v_add_f32 v186, 0x3727c5ac, v186
    v_add_f32 v190, 0x3727c5ac, v190
    v_rsq_f32 v185, v186
    v_rsq_f32 v189, v190
    v_mul_f32 v186, -v208, v185
    v_mul_f32 v190, -v209, v189
    v_lshlrev_b32 v80, 16, v176
    v_and_b32 v82, 0xffff0000, v176
    v_lshlrev_b32 v84, 16, v177
    v_and_b32 v86, 0xffff0000, v177
    v_lshlrev_b32 v81, 16, v178
    v_and_b32 v83, 0xffff0000, v178
    v_lshlrev_b32 v85, 16, v179
    v_and_b32 v87, 0xffff0000, v179
    v_fma_f32 v208, v80, v185, v186
    v_fma_f32 v209, v81, v189, v190
    v_cvt_pk_bf16_f32 v176, v208, v209
    v_fma_f32 v208, v82, v185, v186
    v_fma_f32 v209, v83, v189, v190
    v_cvt_pk_bf16_f32 v177, v208, v209
    v_fma_f32 v208, v84, v185, v186
    v_fma_f32 v209, v85, v189, v190
    v_cvt_pk_bf16_f32 v178, v208, v209
    v_fma_f32 v208, v86, v185, v186
    v_fma_f32 v209, v87, v189, v190
    v_cvt_pk_bf16_f32 v179, v208, v209
    ds_write_b32 v63, v176 offset:0
    ds_write_b32 v63, v177 offset:4864
    ds_write_b32 v63, v178 offset:9728
    ds_write_b32 v63, v179 offset:14592
    v_mul_f32 v208, 0x3acccccd, v193
    v_mul_f32 v209, 0x3acccccd, v197
    v_mul_f32 v194, 0x3acccccd, v194
    v_mul_f32 v198, 0x3acccccd, v198
    v_fma_f32 v194, -v208, v208, v194
    v_fma_f32 v198, -v209, v209, v198
    v_max_f32 v194, 0, v194
    v_max_f32 v198, 0, v198
    v_add_f32 v194, 0x3727c5ac, v194
    v_add_f32 v198, 0x3727c5ac, v198
    v_rsq_f32 v193, v194
    v_rsq_f32 v197, v198
    v_mul_f32 v194, -v208, v193
    v_mul_f32 v198, -v209, v197
    v_lshlrev_b32 v88, 16, v180
    v_and_b32 v90, 0xffff0000, v180
    v_lshlrev_b32 v92, 16, v181
    v_and_b32 v94, 0xffff0000, v181
    v_lshlrev_b32 v89, 16, v182
    v_and_b32 v91, 0xffff0000, v182
    v_lshlrev_b32 v93, 16, v183
    v_and_b32 v95, 0xffff0000, v183
    v_fma_f32 v208, v88, v193, v194
    v_fma_f32 v209, v89, v197, v198
    v_cvt_pk_bf16_f32 v180, v208, v209
    v_fma_f32 v208, v90, v193, v194
    v_fma_f32 v209, v91, v197, v198
    v_cvt_pk_bf16_f32 v181, v208, v209
    v_fma_f32 v208, v92, v193, v194
    v_fma_f32 v209, v93, v197, v198
    v_cvt_pk_bf16_f32 v182, v208, v209
    v_fma_f32 v208, v94, v193, v194
    v_fma_f32 v209, v95, v197, v198
    v_cvt_pk_bf16_f32 v183, v208, v209
    ds_write_b32 v63, v180 offset:256
    ds_write_b32 v63, v181 offset:5120
    ds_write_b32 v63, v182 offset:9984
    ds_write_b32 v63, v183 offset:14848
    s_waitcnt lgkmcnt(0)
    s_barrier
    ds_read_b128 v[212:215], v64 offset:96
    ds_read_b128 v[216:219], v64 offset:64
    ds_read_b128 v[220:223], v64 offset:32
    ds_read_b128 v[224:227], v64 offset:0
    s_waitcnt lgkmcnt(3)
    v_mfma_f32_32x32x16_bf16 v[96:111], v[212:215], v[144:147], 0
    ds_read_b128 v[228:231], v64 offset:224
    ds_read_b64_tr_b16 v[176:177], v65 offset:1056
    ds_read_b64_tr_b16 v[178:179], v65 offset:1024
    ds_read_b64_tr_b16 v[180:181], v65 offset:1184
    ds_read_b64_tr_b16 v[182:183], v65 offset:1152
    s_waitcnt lgkmcnt(7)
    v_mfma_f32_32x32x16_bf16 v[96:111], v[216:219], v[148:151], v[96:111]
    ds_read_b128 v[232:235], v64 offset:192
    ds_read_b64_tr_b16 v[184:185], v65 offset:1312
    ds_read_b64_tr_b16 v[186:187], v65 offset:1280
    ds_read_b64_tr_b16 v[188:189], v65 offset:1440
    ds_read_b64_tr_b16 v[190:191], v65 offset:1408
    s_waitcnt lgkmcnt(11)
    v_mfma_f32_32x32x16_bf16 v[96:111], v[220:223], v[152:155], v[96:111]
    ds_read_b128 v[236:239], v64 offset:160
    ds_read_b64_tr_b16 v[192:193], v65 offset:1568
    ds_read_b64_tr_b16 v[194:195], v65 offset:1536
    ds_read_b64_tr_b16 v[196:197], v65 offset:1696
    ds_read_b64_tr_b16 v[198:199], v65 offset:1664
    s_waitcnt lgkmcnt(15)
    v_mfma_f32_32x32x16_bf16 v[96:111], v[224:227], v[156:159], v[96:111]
    ds_read_b128 v[240:243], v64 offset:128
    ds_read_b64_tr_b16 v[200:201], v65 offset:1824
    ds_read_b64_tr_b16 v[202:203], v65 offset:1792
    ds_read_b64_tr_b16 v[204:205], v65 offset:1952
    ds_read_b64_tr_b16 v[206:207], v65 offset:1920
    s_waitcnt lgkmcnt(15)
    v_mfma_f32_32x32x16_bf16 v[112:127], v[228:231], v[144:147], 0
    s_nop 4
    s_waitcnt lgkmcnt(14)
    v_mfma_f32_32x32x16_bf16 v[112:127], v[232:235], v[148:151], v[112:127]
    v_cndmask_b32 v208, v99, v72, s[76:77]
    v_cndmask_b32 v209, v103, v99, s[76:77]
    v_cndmask_b32 v210, v107, v103, s[76:77]
    v_cndmask_b32 v211, v111, v107, s[76:77]
    v_mov_b32_e64 v72, v111
    s_waitcnt lgkmcnt(9)
    v_mfma_f32_32x32x16_bf16 v[112:127], v[236:239], v[152:155], v[112:127]
    v_add_f32_dpp v98, v208, v98 wave_ror:1 row_mask:0xf bank_mask:0xf
    v_add_f32_dpp v102, v209, v102 wave_ror:1 row_mask:0xf bank_mask:0xf
    v_add_f32_dpp v106, v210, v106 wave_ror:1 row_mask:0xf bank_mask:0xf
    v_add_f32_dpp v110, v211, v110 wave_ror:1 row_mask:0xf bank_mask:0xf
    v_cndmask_b32 v208, v98, v71, s[76:77]
    s_waitcnt lgkmcnt(4)
    v_mfma_f32_32x32x16_bf16 v[112:127], v[240:243], v[156:159], v[112:127]
    v_cndmask_b32 v209, v102, v98, s[76:77]
    v_cndmask_b32 v210, v106, v102, s[76:77]
    v_cndmask_b32 v211, v110, v106, s[76:77]
    v_mov_b32 v71, v110
    v_add_f32_dpp v97, v208, v97 wave_ror:1 row_mask:0xf bank_mask:0xf
    v_add_f32_dpp v101, v209, v101 wave_ror:1 row_mask:0xf bank_mask:0xf
    v_mfma_f32_32x32x16_bf16 v[112:127], v[212:215], v[160:163], v[112:127]
    ds_read_b128 v[244:247], v64 offset:352
    v_add_f32_dpp v105, v210, v105 wave_ror:1 row_mask:0xf bank_mask:0xf
    v_add_f32_dpp v109, v211, v109 wave_ror:1 row_mask:0xf bank_mask:0xf
    v_cndmask_b32 v208, v97, v70, s[76:77]
    v_cndmask_b32 v209, v101, v97, s[76:77]
    v_cndmask_b32 v210, v105, v101, s[76:77]
    v_mfma_f32_32x32x16_bf16 v[112:127], v[216:219], v[164:167], v[112:127]
    ds_read_b128 v[216:219], v64 offset:320
    v_cndmask_b32 v211, v109, v105, s[76:77]
    v_mov_b32_e64 v70, v109
    v_add_f32_dpp v96, v208, v96 wave_ror:1 row_mask:0xf bank_mask:0xf
    v_add_f32_dpp v100, v209, v100 wave_ror:1 row_mask:0xf bank_mask:0xf
    v_add_f32_dpp v104, v210, v104 wave_ror:1 row_mask:0xf bank_mask:0xf
    v_mfma_f32_32x32x16_bf16 v[112:127], v[220:223], v[168:171], v[112:127]
    ds_read_b128 v[220:223], v64 offset:288
    v_add_f32_dpp v108, v211, v108 wave_ror:1 row_mask:0xf bank_mask:0xf
    ds_write_b32 v66, v96 offset:0
    v_mfma_f32_32x32x16_bf16 v[112:127], v[224:227], v[172:175], v[112:127]
    ds_read_b128 v[224:227], v64 offset:256
    ds_write_b32 v66, v100 offset:64
    ds_write_b32 v66, v104 offset:128
    s_waitcnt lgkmcnt(6)
    v_mfma_f32_32x32x16_bf16 v[128:143], v[244:247], v[144:147], 0
    ds_write_b32 v66, v108 offset:192
    s_nop 2
    s_waitcnt lgkmcnt(6)
    v_mfma_f32_32x32x16_bf16 v[128:143], v[216:219], v[148:151], v[128:143]
    s_nop 2
    v_cndmask_b32 v208, v115, v72, s[76:77]
    v_cndmask_b32 v209, v119, v115, s[76:77]
    s_waitcnt lgkmcnt(5)
    v_mfma_f32_32x32x16_bf16 v[128:143], v[220:223], v[152:155], v[128:143]
    v_cndmask_b32 v210, v123, v119, s[76:77]
    v_cndmask_b32 v211, v127, v123, s[76:77]
    v_mov_b32 v72, v127
    v_add_f32_dpp v114, v208, v114 wave_ror:1 row_mask:0xf bank_mask:0xf
    v_add_f32_dpp v118, v209, v118 wave_ror:1 row_mask:0xf bank_mask:0xf
    s_waitcnt lgkmcnt(3)
    v_mfma_f32_32x32x16_bf16 v[128:143], v[224:227], v[156:159], v[128:143]
    v_add_f32_dpp v122, v210, v122 wave_ror:1 row_mask:0xf bank_mask:0xf
    v_add_f32_dpp v126, v211, v126 wave_ror:1 row_mask:0xf bank_mask:0xf
    v_cndmask_b32 v208, v114, v71, s[76:77]
    v_cndmask_b32 v209, v118, v114, s[76:77]
    v_cndmask_b32 v210, v122, v118, s[76:77]
    v_cndmask_b32 v211, v126, v122, s[76:77]
    v_mfma_f32_32x32x16_bf16 v[128:143], v[228:231], v[160:163], v[128:143]
    v_mov_b32 v71, v126
    v_add_f32_dpp v113, v208, v113 wave_ror:1 row_mask:0xf bank_mask:0xf
    v_add_f32_dpp v117, v209, v117 wave_ror:1 row_mask:0xf bank_mask:0xf
    v_add_f32_dpp v121, v210, v121 wave_ror:1 row_mask:0xf bank_mask:0xf
    v_add_f32_dpp v125, v211, v125 wave_ror:1 row_mask:0xf bank_mask:0xf
    v_cndmask_b32 v208, v113, v70, s[76:77]
    v_mfma_f32_32x32x16_bf16 v[128:143], v[232:235], v[164:167], v[128:143]
    ds_read_b128 v[232:235], v64 offset:64
    v_cndmask_b32 v209, v117, v113, s[76:77]
    v_cndmask_b32 v210, v121, v117, s[76:77]
    v_cndmask_b32 v211, v125, v121, s[76:77]
    v_mov_b32_e64 v70, v125
    v_add_f32_dpp v112, v208, v112 wave_ror:1 row_mask:0xf bank_mask:0xf
    v_mfma_f32_32x32x16_bf16 v[128:143], v[236:239], v[168:171], v[128:143]
    ds_read_b128 v[236:239], v64 offset:32
    v_add_f32_dpp v116, v209, v116 wave_ror:1 row_mask:0xf bank_mask:0xf
    v_add_f32_dpp v120, v210, v120 wave_ror:1 row_mask:0xf bank_mask:0xf
    v_add_f32_dpp v124, v211, v124 wave_ror:1 row_mask:0xf bank_mask:0xf
    v_mfma_f32_32x32x16_bf16 v[128:143], v[240:243], v[172:175], v[128:143]
    ds_read_b128 v[240:243], v64 offset:0
    ds_write_b32 v66, v112 offset:256
    ds_write_b32 v66, v116 offset:320
    v_mfma_f32_32x32x16_bf16 v[128:143], v[212:215], v[176:179], v[128:143]
    ds_read_b128 v[212:215], v64 offset:480
    ds_write_b32 v66, v120 offset:384
    ds_write_b32 v66, v124 offset:448
    s_waitcnt lgkmcnt(7)
    v_mfma_f32_32x32x16_bf16 v[128:143], v[232:235], v[180:183], v[128:143]
    ds_read_b128 v[232:235], v64 offset:448
    s_waitcnt lgkmcnt(7)
    v_mfma_f32_32x32x16_bf16 v[128:143], v[236:239], v[184:187], v[128:143]
    ds_read_b128 v[236:239], v64 offset:416
    s_waitcnt lgkmcnt(7)
    v_mfma_f32_32x32x16_bf16 v[128:143], v[240:243], v[188:191], v[128:143]
    ds_read_b128 v[240:243], v64 offset:384
    s_nop 3
    s_waitcnt lgkmcnt(5)
    v_mfma_f32_32x32x16_bf16 v[112:127], v[212:215], v[144:147], 0
    s_nop 4
    s_waitcnt lgkmcnt(2)
    v_mfma_f32_32x32x16_bf16 v[112:127], v[232:235], v[148:151], v[112:127]
    v_cndmask_b32 v208, v131, v72, s[76:77]
    v_cndmask_b32 v209, v135, v131, s[76:77]
    v_cndmask_b32 v210, v139, v135, s[76:77]
    v_cndmask_b32 v211, v143, v139, s[76:77]
    v_mov_b32_e64 v72, v143
    s_waitcnt lgkmcnt(1)
    v_mfma_f32_32x32x16_bf16 v[112:127], v[236:239], v[152:155], v[112:127]
    v_add_f32_dpp v130, v208, v130 wave_ror:1 row_mask:0xf bank_mask:0xf
    v_add_f32_dpp v134, v209, v134 wave_ror:1 row_mask:0xf bank_mask:0xf
    v_add_f32_dpp v138, v210, v138 wave_ror:1 row_mask:0xf bank_mask:0xf
    v_add_f32_dpp v142, v211, v142 wave_ror:1 row_mask:0xf bank_mask:0xf
    v_cndmask_b32 v208, v130, v71, s[76:77]
    s_waitcnt lgkmcnt(0)
    v_mfma_f32_32x32x16_bf16 v[112:127], v[240:243], v[156:159], v[112:127]
    v_cndmask_b32 v209, v134, v130, s[76:77]
    v_cndmask_b32 v210, v138, v134, s[76:77]
    v_cndmask_b32 v211, v142, v138, s[76:77]
    v_mov_b32 v71, v142
    v_add_f32_dpp v129, v208, v129 wave_ror:1 row_mask:0xf bank_mask:0xf
    v_add_f32_dpp v133, v209, v133 wave_ror:1 row_mask:0xf bank_mask:0xf
    v_mfma_f32_32x32x16_bf16 v[112:127], v[244:247], v[160:163], v[112:127]
    v_add_f32_dpp v137, v210, v137 wave_ror:1 row_mask:0xf bank_mask:0xf
    v_add_f32_dpp v141, v211, v141 wave_ror:1 row_mask:0xf bank_mask:0xf
    v_cndmask_b32 v208, v129, v70, s[76:77]
    v_cndmask_b32 v209, v133, v129, s[76:77]
    v_cndmask_b32 v210, v137, v133, s[76:77]
    v_cndmask_b32 v211, v141, v137, s[76:77]
    v_mfma_f32_32x32x16_bf16 v[112:127], v[216:219], v[164:167], v[112:127]
    ds_read_b128 v[240:243], v64 offset:192
    v_mov_b32_e64 v70, v141
    v_add_f32_dpp v128, v208, v128 wave_ror:1 row_mask:0xf bank_mask:0xf
    v_add_f32_dpp v132, v209, v132 wave_ror:1 row_mask:0xf bank_mask:0xf
    v_add_f32_dpp v136, v210, v136 wave_ror:1 row_mask:0xf bank_mask:0xf
    v_add_f32_dpp v140, v211, v140 wave_ror:1 row_mask:0xf bank_mask:0xf
    v_mfma_f32_32x32x16_bf16 v[112:127], v[220:223], v[168:171], v[112:127]
    ds_read_b128 v[220:223], v64 offset:160
    ds_write_b32 v66, v128 offset:512
    ds_write_b32 v66, v132 offset:576
    v_mfma_f32_32x32x16_bf16 v[112:127], v[224:227], v[172:175], v[112:127]
    ds_read_b128 v[224:227], v64 offset:128
    ds_write_b32 v66, v136 offset:640
    ds_write_b32 v66, v140 offset:704
    v_mfma_f32_32x32x16_bf16 v[112:127], v[228:231], v[176:179], v[112:127]
    ds_read_b128 v[236:239], v64 offset:96
    s_waitcnt lgkmcnt(7)
    v_mfma_f32_32x32x16_bf16 v[112:127], v[240:243], v[180:183], v[112:127]
    ds_read_b128 v[240:243], v64 offset:64
    s_waitcnt lgkmcnt(7)
    v_mfma_f32_32x32x16_bf16 v[112:127], v[220:223], v[184:187], v[112:127]
    ds_read_b128 v[220:223], v64 offset:32
    s_waitcnt lgkmcnt(5)
    v_mfma_f32_32x32x16_bf16 v[112:127], v[224:227], v[188:191], v[112:127]
    ds_read_b128 v[224:227], v64 offset:0
    s_waitcnt lgkmcnt(3)
    v_mfma_f32_32x32x16_bf16 v[112:127], v[236:239], v[192:195], v[112:127]
    ds_read_b64_tr_b16 v[216:217], v65 offset:544
    ds_read_b64_tr_b16 v[218:219], v65 offset:512
    s_waitcnt lgkmcnt(4)
    v_mfma_f32_32x32x16_bf16 v[112:127], v[240:243], v[196:199], v[112:127]
    ds_read_b64_tr_b16 v[240:241], v65 offset:1056
    ds_read_b64_tr_b16 v[242:243], v65 offset:1024
    s_waitcnt lgkmcnt(5)
    v_mfma_f32_32x32x16_bf16 v[112:127], v[220:223], v[200:203], v[112:127]
    s_waitcnt lgkmcnt(4)
    v_mfma_f32_32x32x16_bf16 v[112:127], v[224:227], v[204:207], v[112:127]
    ds_read_b64_tr_b16 v[224:225], v65 offset:1568
    ds_read_b64_tr_b16 v[226:227], v65 offset:1536
    s_lshl_b32 s96, s75, 14
    s_add_u32 s96, s96, 14680064
    s_lshl_b32 s97, s24, 12
    s_add_u32 s97, s97, 3510272
    buffer_load_dwordx4 v[248:251], v62, s[16:19], s96 offen offset:2048 sc1
    s_waitcnt lgkmcnt(4)
    v_mfma_f32_32x32x16_bf16 v[144:159], v[212:215], v[216:219], 0
    s_nop 3
    v_cndmask_b32 v208, v115, v72, s[76:77]
    s_waitcnt lgkmcnt(2)
    v_mfma_f32_32x32x16_bf16 v[144:159], v[244:247], v[240:243], v[144:159]
    buffer_load_dwordx4 v[252:255], v62, s[16:19], s96 offen offset:3072 sc1
    v_cndmask_b32 v209, v119, v115, s[76:77]
    v_cndmask_b32 v210, v123, v119, s[76:77]
    v_cndmask_b32 v211, v127, v123, s[76:77]
    v_mov_b32_e64 v72, v127
    v_add_f32_dpp v114, v208, v114 wave_ror:1 row_mask:0xf bank_mask:0xf
    v_mfma_f32_32x32x16_bf16 v[160:175], v[212:215], v[240:243], 0
    ds_read_b64_tr_b16 v[216:217], v65 offset:2080
    ds_read_b64_tr_b16 v[218:219], v65 offset:2048
    v_add_f32_dpp v118, v209, v118 wave_ror:1 row_mask:0xf bank_mask:0xf
    v_add_f32_dpp v122, v210, v122 wave_ror:1 row_mask:0xf bank_mask:0xf
    v_add_f32_dpp v126, v211, v126 wave_ror:1 row_mask:0xf bank_mask:0xf
    s_waitcnt lgkmcnt(2)
    v_mfma_f32_32x32x16_bf16 v[144:159], v[228:231], v[224:227], v[144:159]
    buffer_load_dwordx4 v[96:99], v62, s[16:19], s97 offen offset:0 sc1
    v_cndmask_b32 v208, v114, v71, s[76:77]
    v_cndmask_b32 v209, v118, v114, s[76:77]
    v_cndmask_b32 v210, v122, v118, s[76:77]
    v_cndmask_b32 v211, v126, v122, s[76:77]
    v_mov_b32 v71, v126
    v_mfma_f32_32x32x16_bf16 v[160:175], v[244:247], v[224:227], v[160:175]
    v_add_f32_dpp v113, v208, v113 wave_ror:1 row_mask:0xf bank_mask:0xf
    v_add_f32_dpp v117, v209, v117 wave_ror:1 row_mask:0xf bank_mask:0xf
    v_add_f32_dpp v121, v210, v121 wave_ror:1 row_mask:0xf bank_mask:0xf
    v_add_f32_dpp v125, v211, v125 wave_ror:1 row_mask:0xf bank_mask:0xf
    v_cndmask_b32 v208, v113, v70, s[76:77]
    v_cndmask_b32 v209, v117, v113, s[76:77]
    v_mfma_f32_32x32x16_bf16 v[176:191], v[212:215], v[224:227], 0
    buffer_load_dwordx4 v[100:103], v62, s[16:19], s97 offen offset:1024 sc1
    v_cndmask_b32 v210, v121, v117, s[76:77]
    v_cndmask_b32 v211, v125, v121, s[76:77]
    v_mov_b32 v70, v125
    v_add_f32_dpp v112, v208, v112 wave_ror:1 row_mask:0xf bank_mask:0xf
    s_waitcnt lgkmcnt(0)
    v_mfma_f32_32x32x16_bf16 v[144:159], v[236:239], v[216:219], v[144:159]
    ds_read_b64_tr_b16 v[240:241], v65 offset:2592
    ds_read_b64_tr_b16 v[242:243], v65 offset:2560
    v_add_f32_dpp v116, v209, v116 wave_ror:1 row_mask:0xf bank_mask:0xf
    v_add_f32_dpp v120, v210, v120 wave_ror:1 row_mask:0xf bank_mask:0xf
    v_add_f32_dpp v124, v211, v124 wave_ror:1 row_mask:0xf bank_mask:0xf
    v_mfma_f32_32x32x16_bf16 v[160:175], v[228:231], v[216:219], v[160:175]
    buffer_load_dwordx4 v[104:107], v62, s[16:19], s97 offen offset:2048 sc1
    ds_write_b32 v66, v112 offset:768
    ds_write_b32 v66, v116 offset:832
    v_mfma_f32_32x32x16_bf16 v[176:191], v[244:247], v[216:219], v[176:191]
    ds_write_b32 v66, v120 offset:896
    ds_write_b32 v66, v124 offset:960
    v_mfma_f32_32x32x16_bf16 v[192:207], v[212:215], v[216:219], 0
    ds_read_b64_tr_b16 v[212:213], v65 offset:3104
    ds_read_b64_tr_b16 v[214:215], v65 offset:3072
    buffer_load_dwordx4 v[108:111], v62, s[16:19], s97 offen offset:3072 sc1
    s_waitcnt lgkmcnt(6)
    v_mfma_f32_32x32x16_bf16 v[160:175], v[236:239], v[240:243], v[160:175]
    v_mfma_f32_32x32x16_bf16 v[176:191], v[228:231], v[240:243], v[176:191]
    ds_read_b64_tr_b16 v[224:225], v65 offset:3616
    ds_read_b64_tr_b16 v[226:227], v65 offset:3584
    s_waitcnt lgkmcnt(4)
    s_barrier
    v_mfma_f32_32x32x16_bf16 v[192:207], v[244:247], v[240:243], v[192:207]
    ds_read_b64_tr_b16 v[244:245], v65 offset:672
    ds_read_b64_tr_b16 v[246:247], v65 offset:640
    ds_read_b64 v[112:113], v67 offset:0
    ds_read_b64 v[114:115], v67 offset:4224
    ds_read_b64 v[116:117], v67 offset:8448
    s_waitcnt lgkmcnt(7)
    v_mfma_f32_32x32x16_bf16 v[176:191], v[236:239], v[212:215], v[176:191]
    ds_read_b128 v[216:219], v64 offset:320
    ds_read_b64_tr_b16 v[240:241], v65 offset:1184
    ds_read_b64_tr_b16 v[242:243], v65 offset:1152
    ds_read_b64 v[118:119], v67 offset:12672
    ds_read_b64 v[120:121], v67 offset:512
    ds_read_b64 v[122:123], v67 offset:4736
    v_mfma_f32_32x32x16_bf16 v[192:207], v[228:231], v[212:215], v[192:207]
    ds_read_b64 v[124:125], v67 offset:8960
    ds_read_b64 v[126:127], v67 offset:13184
    s_waitcnt lgkmcnt(13)
    v_mfma_f32_32x32x16_bf16 v[192:207], v[236:239], v[224:227], v[192:207]
    ds_read_b128 v[228:231], v64 offset:192
    ds_read_b64_tr_b16 v[236:237], v65 offset:1696
    ds_read_b64_tr_b16 v[238:239], v65 offset:1664
    s_waitcnt lgkmcnt(14)
    v_mfma_f32_32x32x16_bf16 v[144:159], v[232:235], v[244:247], v[144:159]
    s_waitcnt lgkmcnt(8)
    v_mfma_f32_32x32x16_bf16 v[144:159], v[216:219], v[240:243], v[144:159]
    v_mfma_f32_32x32x16_bf16 v[160:175], v[232:235], v[240:243], v[160:175]
    ds_read_b128 v[212:215], v64 offset:64
    ds_read_b64_tr_b16 v[224:225], v65 offset:2208
    ds_read_b64_tr_b16 v[226:227], v65 offset:2176
    s_waitcnt lgkmcnt(6)
    v_add_f32 v112, v112, v80
    s_waitcnt lgkmcnt(3)
    v_mfma_f32_32x32x16_bf16 v[144:159], v[228:231], v[236:239], v[144:159]
    v_add_f32 v113, v113, v81
    v_add_f32 v114, v114, v82
    v_add_f32 v115, v115, v83
    v_add_f32 v116, v116, v84
    v_add_f32 v117, v117, v85
    v_add_f32 v118, v118, v86
    v_mfma_f32_32x32x16_bf16 v[160:175], v[216:219], v[236:239], v[160:175]
    v_add_f32_e64 v119, v119, v87
    v_cvt_pk_bf16_f32 v128, v112, v114
    v_cvt_pk_bf16_f32 v129, v116, v118
    v_cvt_pk_bf16_f32 v130, v113, v115
    v_cvt_pk_bf16_f32 v131, v117, v119
    s_mov_b32 s25, 0
    v_mfma_f32_32x32x16_bf16 v[176:191], v[232:235], v[236:239], v[176:191]
    buffer_store_dwordx2 v[128:129], v68, s[20:23], s25 offen
    s_mov_b32 s25, 5120
    buffer_store_dwordx2 v[130:131], v68, s[20:23], s25 offen
    v_add_f32 v120, v120, v88
    v_add_f32 v121, v121, v89
    s_waitcnt lgkmcnt(0)
    v_mfma_f32_32x32x16_bf16 v[144:159], v[212:215], v[224:227], v[144:159]
    ds_read_b64_tr_b16 v[244:245], v65 offset:2720
    ds_read_b64_tr_b16 v[246:247], v65 offset:2688
    v_add_f32 v122, v122, v90
    v_add_f32 v123, v123, v91
    v_add_f32 v124, v124, v92
    v_add_f32 v125, v125, v93
    v_mfma_f32_32x32x16_bf16 v[160:175], v[228:231], v[224:227], v[160:175]
    v_add_f32 v126, v126, v94
    v_add_f32 v127, v127, v95
    v_cvt_pk_bf16_f32 v132, v120, v122
    v_cvt_pk_bf16_f32 v133, v124, v126
    v_cvt_pk_bf16_f32 v134, v121, v123
    v_cvt_pk_bf16_f32 v135, v125, v127
    v_mfma_f32_32x32x16_bf16 v[176:191], v[216:219], v[224:227], v[176:191]
    s_mov_b32 s25, 655360
    buffer_store_dwordx2 v[132:133], v68, s[20:23], s25 offen
    s_mov_b32 s25, 660480
    buffer_store_dwordx2 v[134:135], v68, s[20:23], s25 offen
    ds_read_b64_tr_b16 v[112:113], v65 offset:32
    ds_read_b64_tr_b16 v[114:115], v65 offset:0
    v_mfma_f32_32x32x16_bf16 v[192:207], v[232:235], v[224:227], v[192:207]
    ds_read_b64_tr_b16 v[232:233], v65 offset:3232
    ds_read_b64_tr_b16 v[234:235], v65 offset:3200
    ds_read_b64_tr_b16 v[116:117], v65 offset:160
    ds_read_b64_tr_b16 v[118:119], v65 offset:128
    ds_read_b64_tr_b16 v[120:121], v65 offset:288
    s_waitcnt lgkmcnt(7)
    v_mfma_f32_32x32x16_bf16 v[160:175], v[212:215], v[244:247], v[160:175]
    ds_read_b64_tr_b16 v[122:123], v65 offset:256
    ds_read_b64_tr_b16 v[124:125], v65 offset:416
    ds_read_b64_tr_b16 v[126:127], v65 offset:384
    ds_read_b64_tr_b16 v[128:129], v65 offset:544
    ds_read_b64_tr_b16 v[130:131], v65 offset:512
    ds_read_b64_tr_b16 v[132:133], v65 offset:672
    v_mfma_f32_32x32x16_bf16 v[176:191], v[228:231], v[244:247], v[176:191]
    ds_read_b64_tr_b16 v[240:241], v65 offset:3744
    ds_read_b64_tr_b16 v[242:243], v65 offset:3712
    ds_read_b64_tr_b16 v[134:135], v65 offset:640
    ds_read_b64_tr_b16 v[136:137], v65 offset:800
    ds_read_b64_tr_b16 v[138:139], v65 offset:768
    ds_read_b64_tr_b16 v[140:141], v65 offset:928
    v_mfma_f32_32x32x16_bf16 v[192:207], v[216:219], v[244:247], v[192:207]
    ds_read_b128 v[216:219], v64 offset:416
    ds_read_b64_tr_b16 v[236:237], v65 offset:800
    ds_read_b64_tr_b16 v[238:239], v65 offset:768
    ds_read_b64_tr_b16 v[142:143], v65 offset:896
    s_waitcnt lgkmcnt(15)
    v_mfma_f32_32x32x16_bf16 v[176:191], v[212:215], v[232:235], v[176:191]
    ds_read_b128 v[224:227], v64 offset:288
    ds_read_b64_tr_b16 v[244:245], v65 offset:1312
    ds_read_b64_tr_b16 v[246:247], v65 offset:1280
    s_waitcnt vmcnt(4)
ce_83:
    v_max3_u32 v208, v248, v249, v250
    v_max3_u32 v208, v208, v251, v252
    v_max3_u32 v208, v208, v253, v254
    v_max_u32 v208, v208, v255
    v_cmp_eq_u32 s[82:83], -1, v208
    v_min3_f32 v209, v96, v99, v100
    v_min3_f32 v209, v209, v103, v104
    v_min3_f32 v209, v209, v107, v108
    v_min_f32 v209, v209, v111
    v_cmp_neq_f32 vcc, 0x41000000, v209
    s_nop 0
    s_or_b64 vcc, vcc, s[82:83]
    s_cbranch_vccnz rd_84
rc_85:
    v_mfma_f32_32x32x16_bf16 v[192:207], v[228:231], v[232:235], v[192:207]
    v_mul_f32 v208, 0x3acccccd, v97
    v_mul_f32 v209, 0x3acccccd, v101
    v_mul_f32 v98, 0x3acccccd, v98
    v_mul_f32 v102, 0x3acccccd, v102
    v_fma_f32 v98, -v208, v208, v98
    s_waitcnt lgkmcnt(11)
    v_mfma_f32_32x32x16_bf16 v[192:207], v[212:215], v[240:243], v[192:207]
    ds_read_b128 v[228:231], v64 offset:160
    ds_read_b64_tr_b16 v[212:213], v65 offset:1824
    ds_read_b64_tr_b16 v[214:215], v65 offset:1792
    v_fma_f32 v102, -v209, v209, v102
    v_max_f32 v98, 0, v98
    s_waitcnt lgkmcnt(7)
    v_mfma_f32_32x32x16_bf16 v[144:159], v[216:219], v[236:239], v[144:159]
    v_max_f32 v102, 0, v102
    v_add_f32 v98, 0x3727c5ac, v98
    v_add_f32 v102, 0x3727c5ac, v102
    v_rsq_f32 v97, v98
    s_waitcnt lgkmcnt(3)
    v_mfma_f32_32x32x16_bf16 v[144:159], v[224:227], v[244:247], v[144:159]
    v_rsq_f32_e64 v101, v102
    v_mul_f32 v98, -v208, v97
    v_mul_f32 v102, -v209, v101
    v_lshlrev_b32_e64 v80, 16, v248
    v_and_b32 v82, 0xffff0000, v248
    v_mfma_f32_32x32x16_bf16 v[160:175], v[216:219], v[244:247], v[160:175]
    ds_read_b64_tr_b16 v[232:233], v65 offset:2336
    ds_read_b64_tr_b16 v[234:235], v65 offset:2304
    v_lshlrev_b32 v84, 16, v249
    v_and_b32 v86, 0xffff0000, v249
    v_lshlrev_b32_e64 v81, 16, v250
    s_waitcnt lgkmcnt(2)
    v_mfma_f32_32x32x16_bf16 v[144:159], v[228:231], v[212:215], v[144:159]
    v_and_b32 v83, 0xffff0000, v250
    v_lshlrev_b32_e64 v85, 16, v251
    v_and_b32 v87, 0xffff0000, v251
    v_fma_f32 v208, v80, v97, v98
    v_fma_f32 v209, v81, v101, v102
    v_cvt_pk_bf16_f32 v248, v208, v209
    v_mfma_f32_32x32x16_bf16 v[160:175], v[224:227], v[212:215], v[160:175]
    v_fma_f32 v208, v82, v97, v98
    v_fma_f32 v209, v83, v101, v102
    v_cvt_pk_bf16_f32 v249, v208, v209
    v_fma_f32 v208, v84, v97, v98
    v_fma_f32 v209, v85, v101, v102
    v_cvt_pk_bf16_f32 v250, v208, v209
    v_mfma_f32_32x32x16_bf16 v[176:191], v[216:219], v[212:215], v[176:191]
    v_fma_f32 v208, v86, v97, v98
    v_fma_f32 v209, v87, v101, v102
    v_cvt_pk_bf16_f32 v251, v208, v209
    s_waitcnt lgkmcnt(0)
    v_mfma_f32_32x32x16_bf16 v[144:159], v[220:223], v[232:235], v[144:159]
    ds_read_b64_tr_b16 v[240:241], v65 offset:2848
    ds_read_b64_tr_b16 v[242:243], v65 offset:2816
    ds_write_b32 v63, v248 offset:512
    ds_write_b32 v63, v249 offset:5376
    v_mfma_f32_32x32x16_bf16 v[160:175], v[228:231], v[232:235], v[160:175]
    ds_write_b32 v63, v250 offset:10240
    ds_write_b32 v63, v251 offset:15104
    v_mul_f32 v208, 0x3acccccd, v105
    v_mul_f32 v209, 0x3acccccd, v109
    v_mfma_f32_32x32x16_bf16 v[176:191], v[224:227], v[232:235], v[176:191]
    v_mul_f32 v106, 0x3acccccd, v106
    v_mul_f32 v110, 0x3acccccd, v110
    v_fma_f32 v106, -v208, v208, v106
    v_fma_f32 v110, -v209, v209, v110
    v_max_f32 v106, 0, v106
    v_max_f32_e64 v110, 0, v110
    v_mfma_f32_32x32x16_bf16 v[192:207], v[216:219], v[232:235], v[192:207]
    ds_read_b64_tr_b16 v[216:217], v65 offset:3360
    ds_read_b64_tr_b16 v[218:219], v65 offset:3328
    v_add_f32 v106, 0x3727c5ac, v106
    v_add_f32 v110, 0x3727c5ac, v110
    s_waitcnt lgkmcnt(6)
    v_mfma_f32_32x32x16_bf16 v[160:175], v[220:223], v[240:243], v[160:175]
    v_rsq_f32 v105, v106
    v_rsq_f32_e64 v109, v110
    v_mul_f32 v106, -v208, v105
    v_mul_f32 v110, -v209, v109
    v_mfma_f32_32x32x16_bf16 v[176:191], v[228:231], v[240:243], v[176:191]
    ds_read_b64_tr_b16 v[236:237], v65 offset:3872
    ds_read_b64_tr_b16 v[238:239], v65 offset:3840
    v_lshlrev_b32 v88, 16, v252
    v_and_b32 v90, 0xffff0000, v252
    v_lshlrev_b32 v92, 16, v253
    v_and_b32 v94, 0xffff0000, v253
    v_mfma_f32_32x32x16_bf16 v[192:207], v[224:227], v[240:243], v[192:207]
    ds_read_b128 v[224:227], v64 offset:384
    ds_read_b64_tr_b16 v[244:245], v65 offset:928
    ds_read_b64_tr_b16 v[246:247], v65 offset:896
    v_lshlrev_b32 v89, 16, v254
    v_and_b32 v91, 0xffff0000, v254
    s_waitcnt lgkmcnt(5)
    v_mfma_f32_32x32x16_bf16 v[176:191], v[220:223], v[216:219], v[176:191]
    ds_read_b128 v[212:215], v64 offset:256
    ds_read_b64_tr_b16 v[232:233], v65 offset:1440
    ds_read_b64_tr_b16 v[234:235], v65 offset:1408
    v_lshlrev_b32_e64 v93, 16, v255
    v_and_b32 v95, 0xffff0000, v255
    v_fma_f32 v208, v88, v105, v106
    v_mfma_f32_32x32x16_bf16 v[192:207], v[228:231], v[216:219], v[192:207]
    v_fma_f32 v209, v89, v109, v110
    v_cvt_pk_bf16_f32 v252, v208, v209
    v_fma_f32 v208, v90, v105, v106
    v_fma_f32 v209, v91, v109, v110
    v_cvt_pk_bf16_f32 v253, v208, v209
    s_waitcnt lgkmcnt(6)
    v_mfma_f32_32x32x16_bf16 v[192:207], v[220:223], v[236:239], v[192:207]
    ds_read_b128 v[220:223], v64 offset:128
    ds_read_b64_tr_b16 v[228:229], v65 offset:1952
    ds_read_b64_tr_b16 v[230:231], v65 offset:1920
    v_fma_f32 v208, v92, v105, v106
    v_fma_f32 v209, v93, v109, v110
    s_waitcnt lgkmcnt(6)
    v_mfma_f32_32x32x16_bf16 v[144:159], v[224:227], v[244:247], v[144:159]
    v_cvt_pk_bf16_f32 v254, v208, v209
    v_fma_f32 v208, v94, v105, v106
    v_fma_f32 v209, v95, v109, v110
    v_cvt_pk_bf16_f32 v255, v208, v209
    s_waitcnt lgkmcnt(3)
    v_mfma_f32_32x32x16_bf16 v[144:159], v[212:215], v[232:235], v[144:159]
    ds_write_b32 v63, v252 offset:768
    ds_write_b32 v63, v253 offset:5632
    ds_write_b32 v63, v254 offset:10496
    v_mfma_f32_32x32x16_bf16 v[160:175], v[224:227], v[232:235], v[160:175]
    ds_read_b128 v[240:243], v64 offset:0
    ds_read_b64_tr_b16 v[216:217], v65 offset:2464
    ds_read_b64_tr_b16 v[218:219], v65 offset:2432
    ds_write_b32 v63, v255 offset:15360
    s_waitcnt lgkmcnt(7)
    v_mfma_f32_32x32x16_bf16 v[144:159], v[220:223], v[228:231], v[144:159]
    v_mfma_f32_32x32x16_bf16 v[160:175], v[212:215], v[228:231], v[160:175]
    v_mfma_f32_32x32x16_bf16 v[176:191], v[224:227], v[228:231], v[176:191]
    s_waitcnt lgkmcnt(1)
    v_mfma_f32_32x32x16_bf16 v[144:159], v[240:243], v[216:219], v[144:159]
    ds_read_b64_tr_b16 v[236:237], v65 offset:2976
    ds_read_b64_tr_b16 v[238:239], v65 offset:2944
    v_mfma_f32_32x32x16_bf16 v[160:175], v[220:223], v[216:219], v[160:175]
    v_mfma_f32_32x32x16_bf16 v[176:191], v[212:215], v[216:219], v[176:191]
    v_mfma_f32_32x32x16_bf16 v[192:207], v[224:227], v[216:219], v[192:207]
    ds_read_b64_tr_b16 v[224:225], v65 offset:3488
    ds_read_b64_tr_b16 v[226:227], v65 offset:3456
    s_waitcnt lgkmcnt(2)
    v_mfma_f32_32x32x16_bf16 v[160:175], v[240:243], v[236:239], v[160:175]
    v_mfma_f32_32x32x16_bf16 v[176:191], v[220:223], v[236:239], v[176:191]
    ds_read_b64_tr_b16 v[244:245], v65 offset:4000
    ds_read_b64_tr_b16 v[246:247], v65 offset:3968
    v_mfma_f32_32x32x16_bf16 v[192:207], v[212:215], v[236:239], v[192:207]
    s_waitcnt lgkmcnt(2)
    v_mfma_f32_32x32x16_bf16 v[176:191], v[240:243], v[224:227], v[176:191]
    v_mfma_f32_32x32x16_bf16 v[192:207], v[220:223], v[224:227], v[192:207]
    s_waitcnt lgkmcnt(0)
    v_mfma_f32_32x32x16_bf16 v[192:207], v[240:243], v[244:247], v[192:207]
    s_waitcnt lgkmcnt(0)
    s_barrier
    ds_read_b128 v[212:215], v64 offset:608
    ds_read_b128 v[216:219], v64 offset:576
    ds_read_b128 v[220:223], v64 offset:544
    ds_read_b128 v[224:227], v64 offset:512
    s_waitcnt lgkmcnt(3)
    v_mfma_f32_32x32x16_bf16 v[144:159], v[212:215], v[112:115], v[144:159]
    ds_read_b128 v[228:231], v64 offset:736
    s_waitcnt lgkmcnt(3)
    v_mfma_f32_32x32x16_bf16 v[144:159], v[216:219], v[116:119], v[144:159]
    ds_read_b128 v[232:235], v64 offset:704
    s_waitcnt lgkmcnt(3)
    v_mfma_f32_32x32x16_bf16 v[144:159], v[220:223], v[120:123], v[144:159]
    ds_read_b128 v[236:239], v64 offset:672
    s_waitcnt lgkmcnt(3)
    v_mfma_f32_32x32x16_bf16 v[144:159], v[224:227], v[124:127], v[144:159]
    ds_read_b128 v[240:243], v64 offset:640
    s_nop 3
    s_waitcnt lgkmcnt(3)
    v_mfma_f32_32x32x16_bf16 v[160:175], v[228:231], v[112:115], v[160:175]
    s_nop 4
    s_waitcnt lgkmcnt(2)
    v_mfma_f32_32x32x16_bf16 v[160:175], v[232:235], v[116:119], v[160:175]
    v_cndmask_b32 v208, v147, v72, s[76:77]
    v_cndmask_b32 v209, v151, v147, s[76:77]
    v_cndmask_b32 v210, v155, v151, s[76:77]
    v_cndmask_b32 v211, v159, v155, s[76:77]
    v_mov_b32 v72, v159
    s_waitcnt lgkmcnt(1)
    v_mfma_f32_32x32x16_bf16 v[160:175], v[236:239], v[120:123], v[160:175]
    v_add_f32_dpp v146, v208, v146 wave_ror:1 row_mask:0xf bank_mask:0xf
    v_add_f32_dpp v150, v209, v150 wave_ror:1 row_mask:0xf bank_mask:0xf
    v_add_f32_dpp v154, v210, v154 wave_ror:1 row_mask:0xf bank_mask:0xf
    v_add_f32_dpp v158, v211, v158 wave_ror:1 row_mask:0xf bank_mask:0xf
    v_cndmask_b32 v208, v146, v71, s[76:77]
    s_waitcnt lgkmcnt(0)
    v_mfma_f32_32x32x16_bf16 v[160:175], v[240:243], v[124:127], v[160:175]
    v_cndmask_b32 v209, v150, v146, s[76:77]
    v_cndmask_b32 v210, v154, v150, s[76:77]
    v_cndmask_b32 v211, v158, v154, s[76:77]
    v_mov_b32 v71, v158
    v_add_f32_dpp v145, v208, v145 wave_ror:1 row_mask:0xf bank_mask:0xf
    v_add_f32_dpp v149, v209, v149 wave_ror:1 row_mask:0xf bank_mask:0xf
    v_mfma_f32_32x32x16_bf16 v[160:175], v[212:215], v[128:131], v[160:175]
    ds_read_b128 v[244:247], v64 offset:864
    v_add_f32_dpp v153, v210, v153 wave_ror:1 row_mask:0xf bank_mask:0xf
    v_add_f32_dpp v157, v211, v157 wave_ror:1 row_mask:0xf bank_mask:0xf
    v_cndmask_b32 v208, v145, v70, s[76:77]
    v_cndmask_b32 v209, v149, v145, s[76:77]
    v_cndmask_b32 v210, v153, v149, s[76:77]
    v_mfma_f32_32x32x16_bf16 v[160:175], v[216:219], v[132:135], v[160:175]
    ds_read_b128 v[248:251], v64 offset:832
    v_cndmask_b32 v211, v157, v153, s[76:77]
    v_mov_b32_e64 v70, v157
    v_add_f32_dpp v144, v208, v144 wave_ror:1 row_mask:0xf bank_mask:0xf
    v_add_f32_dpp v148, v209, v148 wave_ror:1 row_mask:0xf bank_mask:0xf
    v_add_f32_dpp v152, v210, v152 wave_ror:1 row_mask:0xf bank_mask:0xf
    v_mfma_f32_32x32x16_bf16 v[160:175], v[220:223], v[136:139], v[160:175]
    ds_read_b128 v[252:255], v64 offset:800
    v_add_f32_dpp v156, v211, v156 wave_ror:1 row_mask:0xf bank_mask:0xf
    ds_write_b32 v66, v144 offset:0
    v_mfma_f32_32x32x16_bf16 v[160:175], v[224:227], v[140:143], v[160:175]
    ds_read_b128 v[224:227], v64 offset:768
    ds_write_b32 v66, v148 offset:64
    ds_write_b32 v66, v152 offset:128
    s_waitcnt lgkmcnt(6)
    v_mfma_f32_32x32x16_bf16 v[176:191], v[244:247], v[112:115], v[176:191]
    ds_write_b32 v66, v156 offset:192
    s_nop 2
    s_waitcnt lgkmcnt(6)
    v_mfma_f32_32x32x16_bf16 v[176:191], v[248:251], v[116:119], v[176:191]
    s_nop 2
    v_cndmask_b32 v208, v163, v72, s[76:77]
    v_cndmask_b32 v209, v167, v163, s[76:77]
    s_waitcnt lgkmcnt(5)
    v_mfma_f32_32x32x16_bf16 v[176:191], v[252:255], v[120:123], v[176:191]
    v_cndmask_b32 v210, v171, v167, s[76:77]
    v_cndmask_b32 v211, v175, v171, s[76:77]
    v_mov_b32 v72, v175
    v_add_f32_dpp v162, v208, v162 wave_ror:1 row_mask:0xf bank_mask:0xf
    v_add_f32_dpp v166, v209, v166 wave_ror:1 row_mask:0xf bank_mask:0xf
    s_waitcnt lgkmcnt(3)
    v_mfma_f32_32x32x16_bf16 v[176:191], v[224:227], v[124:127], v[176:191]
    v_add_f32_dpp v170, v210, v170 wave_ror:1 row_mask:0xf bank_mask:0xf
    v_add_f32_dpp v174, v211, v174 wave_ror:1 row_mask:0xf bank_mask:0xf
    v_cndmask_b32 v208, v162, v71, s[76:77]
    v_cndmask_b32 v209, v166, v162, s[76:77]
    v_cndmask_b32 v210, v170, v166, s[76:77]
    v_cndmask_b32 v211, v174, v170, s[76:77]
    v_mfma_f32_32x32x16_bf16 v[176:191], v[228:231], v[128:131], v[176:191]
    ds_read_b64_tr_b16 v[228:229], v65 offset:1056
    ds_read_b64_tr_b16 v[230:231], v65 offset:1024
    v_mov_b32 v71, v174
    v_add_f32_dpp v161, v208, v161 wave_ror:1 row_mask:0xf bank_mask:0xf
    v_add_f32_dpp v165, v209, v165 wave_ror:1 row_mask:0xf bank_mask:0xf
    v_add_f32_dpp v169, v210, v169 wave_ror:1 row_mask:0xf bank_mask:0xf
    v_mfma_f32_32x32x16_bf16 v[176:191], v[232:235], v[132:135], v[176:191]
    ds_read_b64_tr_b16 v[232:233], v65 offset:1184
    ds_read_b64_tr_b16 v[234:235], v65 offset:1152
    v_add_f32_dpp v173, v211, v173 wave_ror:1 row_mask:0xf bank_mask:0xf
    v_cndmask_b32 v208, v161, v70, s[76:77]
    v_cndmask_b32 v209, v165, v161, s[76:77]
    v_cndmask_b32 v210, v169, v165, s[76:77]
    v_mfma_f32_32x32x16_bf16 v[176:191], v[236:239], v[136:139], v[176:191]
    ds_read_b64_tr_b16 v[236:237], v65 offset:1312
    ds_read_b64_tr_b16 v[238:239], v65 offset:1280
    v_cndmask_b32 v211, v173, v169, s[76:77]
    v_mov_b32_e64 v70, v173
    v_add_f32_dpp v160, v208, v160 wave_ror:1 row_mask:0xf bank_mask:0xf
    v_add_f32_dpp v164, v209, v164 wave_ror:1 row_mask:0xf bank_mask:0xf
    v_mfma_f32_32x32x16_bf16 v[176:191], v[240:243], v[140:143], v[176:191]
    ds_read_b128 v[240:243], v64 offset:512
    ds_read_b64_tr_b16 v[224:225], v65 offset:1440
    ds_read_b64_tr_b16 v[226:227], v65 offset:1408
    v_add_f32_dpp v168, v210, v168 wave_ror:1 row_mask:0xf bank_mask:0xf
    v_add_f32_dpp v172, v211, v172 wave_ror:1 row_mask:0xf bank_mask:0xf
    s_waitcnt lgkmcnt(7)
    v_mfma_f32_32x32x16_bf16 v[176:191], v[212:215], v[228:231], v[176:191]
    ds_read_b128 v[212:215], v64 offset:992
    ds_write_b32 v66, v160 offset:256
    ds_write_b32 v66, v164 offset:320
    s_waitcnt lgkmcnt(8)
    v_mfma_f32_32x32x16_bf16 v[176:191], v[216:219], v[232:235], v[176:191]
    ds_read_b128 v[216:219], v64 offset:960
    ds_write_b32 v66, v168 offset:384
    ds_write_b32 v66, v172 offset:448
    s_waitcnt lgkmcnt(9)
    v_mfma_f32_32x32x16_bf16 v[176:191], v[220:223], v[236:239], v[176:191]
    ds_read_b128 v[220:223], v64 offset:928
    s_waitcnt lgkmcnt(7)
    v_mfma_f32_32x32x16_bf16 v[176:191], v[240:243], v[224:227], v[176:191]
    ds_read_b128 v[240:243], v64 offset:896
    s_waitcnt lgkmcnt(2)
    s_barrier
    v_mfma_f32_32x32x16_bf16 v[192:207], v[212:215], v[112:115], v[192:207]
    ds_read_b64 v[144:145], v67 offset:0
    ds_read_b64 v[146:147], v67 offset:4224
    ds_read_b64 v[148:149], v67 offset:8448
    ds_read_b64 v[150:151], v67 offset:12672
    s_nop 0
    v_mfma_f32_32x32x16_bf16 v[192:207], v[216:219], v[116:119], v[192:207]
    s_nop 2
    v_cndmask_b32 v208, v179, v72, s[76:77]
    v_cndmask_b32 v209, v183, v179, s[76:77]
    s_waitcnt lgkmcnt(5)
    v_mfma_f32_32x32x16_bf16 v[192:207], v[220:223], v[120:123], v[192:207]
    v_cndmask_b32 v210, v187, v183, s[76:77]
    v_cndmask_b32 v211, v191, v187, s[76:77]
    v_mov_b32 v72, v191
    v_add_f32_dpp v178, v208, v178 wave_ror:1 row_mask:0xf bank_mask:0xf
    v_add_f32_dpp v182, v209, v182 wave_ror:1 row_mask:0xf bank_mask:0xf
    s_waitcnt lgkmcnt(4)
    v_mfma_f32_32x32x16_bf16 v[192:207], v[240:243], v[124:127], v[192:207]
    ds_read_b128 v[212:215], v64 offset:768
    v_add_f32_dpp v186, v210, v186 wave_ror:1 row_mask:0xf bank_mask:0xf
    v_add_f32_dpp v190, v211, v190 wave_ror:1 row_mask:0xf bank_mask:0xf
    v_cndmask_b32 v208, v178, v71, s[76:77]
    v_cndmask_b32 v209, v182, v178, s[76:77]
    v_cndmask_b32 v210, v186, v182, s[76:77]
    v_mfma_f32_32x32x16_bf16 v[192:207], v[244:247], v[128:131], v[192:207]
    ds_read_b128 v[244:247], v64 offset:736
    v_cndmask_b32 v211, v190, v186, s[76:77]
    v_mov_b32 v71, v190
    v_add_f32_dpp v177, v208, v177 wave_ror:1 row_mask:0xf bank_mask:0xf
    v_add_f32_dpp v181, v209, v181 wave_ror:1 row_mask:0xf bank_mask:0xf
    v_add_f32_dpp v185, v210, v185 wave_ror:1 row_mask:0xf bank_mask:0xf
    v_mfma_f32_32x32x16_bf16 v[192:207], v[248:251], v[132:135], v[192:207]
    ds_read_b128 v[248:251], v64 offset:704
    v_add_f32_dpp v189, v211, v189 wave_ror:1 row_mask:0xf bank_mask:0xf
    v_cndmask_b32 v208, v177, v70, s[76:77]
    v_cndmask_b32 v209, v181, v177, s[76:77]
    v_cndmask_b32 v210, v185, v181, s[76:77]
    v_cndmask_b32 v211, v189, v185, s[76:77]
    v_mfma_f32_32x32x16_bf16 v[192:207], v[252:255], v[136:139], v[192:207]
    ds_read_b128 v[252:255], v64 offset:672
    v_mov_b32_e64 v70, v189
    v_add_f32_dpp v176, v208, v176 wave_ror:1 row_mask:0xf bank_mask:0xf
    v_add_f32_dpp v180, v209, v180 wave_ror:1 row_mask:0xf bank_mask:0xf
    v_add_f32_dpp v184, v210, v184 wave_ror:1 row_mask:0xf bank_mask:0xf
    s_waitcnt lgkmcnt(3)
    v_mfma_f32_32x32x16_bf16 v[192:207], v[212:215], v[140:143], v[192:207]
    ds_read_b128 v[216:219], v64 offset:640
    v_add_f32_dpp v188, v211, v188 wave_ror:1 row_mask:0xf bank_mask:0xf
    s_waitcnt lgkmcnt(3)
    v_mfma_f32_32x32x16_bf16 v[192:207], v[244:247], v[228:231], v[192:207]
    ds_read_b128 v[228:231], v64 offset:608
    ds_read_b64_tr_b16 v[220:221], v65 offset:1568
    ds_read_b64_tr_b16 v[222:223], v65 offset:1536
    ds_write_b32 v66, v176 offset:512
    s_waitcnt lgkmcnt(6)
    v_mfma_f32_32x32x16_bf16 v[192:207], v[248:251], v[232:235], v[192:207]
    ds_read_b128 v[232:235], v64 offset:576
    ds_read_b64_tr_b16 v[240:241], v65 offset:1696
    ds_read_b64_tr_b16 v[242:243], v65 offset:1664
    ds_write_b32 v66, v180 offset:576
    s_waitcnt lgkmcnt(9)
    v_mfma_f32_32x32x16_bf16 v[192:207], v[252:255], v[236:239], v[192:207]
    ds_read_b128 v[236:239], v64 offset:544
    ds_read_b64_tr_b16 v[212:213], v65 offset:1824
    ds_read_b64_tr_b16 v[214:215], v65 offset:1792
    ds_write_b32 v66, v184 offset:640
    s_waitcnt lgkmcnt(12)
    v_mfma_f32_32x32x16_bf16 v[192:207], v[216:219], v[224:227], v[192:207]
    ds_read_b128 v[224:227], v64 offset:512
    ds_read_b64_tr_b16 v[244:245], v65 offset:1952
    ds_read_b64_tr_b16 v[246:247], v65 offset:1920
    ds_write_b32 v66, v188 offset:704
    s_waitcnt lgkmcnt(13)
    v_mfma_f32_32x32x16_bf16 v[192:207], v[228:231], v[220:223], v[192:207]
    v_add_f32 v144, v144, v80
    v_add_f32 v145, v145, v81
    v_add_f32 v146, v146, v82
    v_add_f32 v147, v147, v83
    s_waitcnt lgkmcnt(9)
    v_mfma_f32_32x32x16_bf16 v[192:207], v[232:235], v[240:243], v[192:207]
    v_add_f32 v148, v148, v84
    v_add_f32 v149, v149, v85
    v_add_f32 v150, v150, v86
    v_add_f32 v151, v151, v87
    v_cvt_pk_bf16_f32 v160, v144, v146
    s_waitcnt lgkmcnt(5)
    v_mfma_f32_32x32x16_bf16 v[192:207], v[236:239], v[212:215], v[192:207]
    v_cvt_pk_bf16_f32 v161, v148, v150
    v_cvt_pk_bf16_f32 v162, v145, v147
    v_cvt_pk_bf16_f32 v163, v149, v151
    s_mov_b32 s25, 1310720
    s_waitcnt lgkmcnt(1)
    v_mfma_f32_32x32x16_bf16 v[192:207], v[224:227], v[244:247], v[192:207]
    buffer_store_dwordx2 v[160:161], v68, s[20:23], s25 offen
    s_mov_b32 s25, 1315840
    buffer_store_dwordx2 v[162:163], v68, s[20:23], s25 offen
    s_nop 8
    v_cndmask_b32 v208, v195, v72, s[76:77]
    v_cndmask_b32 v209, v199, v195, s[76:77]
    v_cndmask_b32 v210, v203, v199, s[76:77]
    v_cndmask_b32 v211, v207, v203, s[76:77]
    v_mov_b32_e64 v72, v207
    v_add_f32_dpp v194, v208, v194 wave_ror:1 row_mask:0xf bank_mask:0xf
    v_add_f32_dpp v198, v209, v198 wave_ror:1 row_mask:0xf bank_mask:0xf
    v_add_f32_dpp v202, v210, v202 wave_ror:1 row_mask:0xf bank_mask:0xf
    v_add_f32_dpp v206, v211, v206 wave_ror:1 row_mask:0xf bank_mask:0xf
    v_cndmask_b32 v208, v194, v71, s[76:77]
    v_cndmask_b32 v209, v198, v194, s[76:77]
    v_cndmask_b32 v210, v202, v198, s[76:77]
    v_cndmask_b32 v211, v206, v202, s[76:77]
    v_mov_b32_e64 v71, v206
    v_add_f32_dpp v193, v208, v193 wave_ror:1 row_mask:0xf bank_mask:0xf
    v_add_f32_dpp v197, v209, v197 wave_ror:1 row_mask:0xf bank_mask:0xf
    v_add_f32_dpp v201, v210, v201 wave_ror:1 row_mask:0xf bank_mask:0xf
    v_add_f32_dpp v205, v211, v205 wave_ror:1 row_mask:0xf bank_mask:0xf
    v_cndmask_b32 v208, v193, v70, s[76:77]
    v_cndmask_b32 v209, v197, v193, s[76:77]
    v_cndmask_b32 v210, v201, v197, s[76:77]
    v_cndmask_b32 v211, v205, v201, s[76:77]
    v_mov_b32_e64 v70, v205
    v_add_f32_dpp v192, v208, v192 wave_ror:1 row_mask:0xf bank_mask:0xf
    v_add_f32_dpp v196, v209, v196 wave_ror:1 row_mask:0xf bank_mask:0xf
    v_add_f32_dpp v200, v210, v200 wave_ror:1 row_mask:0xf bank_mask:0xf
    v_add_f32_dpp v204, v211, v204 wave_ror:1 row_mask:0xf bank_mask:0xf
    ds_write_b32 v66, v192 offset:768
    ds_write_b32 v66, v196 offset:832
    ds_write_b32 v66, v200 offset:896
    ds_write_b32 v66, v204 offset:960
    s_waitcnt lgkmcnt(0)
    s_barrier
    ds_read_b64 v[152:153], v67 offset:512
    ds_read_b64 v[154:155], v67 offset:4736
    ds_read_b64 v[156:157], v67 offset:8960
    ds_read_b64 v[158:159], v67 offset:13184
    s_waitcnt lgkmcnt(0)
    v_add_f32 v152, v152, v88
    v_add_f32 v153, v153, v89
    v_add_f32 v154, v154, v90
    v_add_f32 v155, v155, v91
    v_add_f32 v156, v156, v92
    v_add_f32 v157, v157, v93
    v_add_f32 v158, v158, v94
    v_add_f32_e64 v159, v159, v95
    v_cvt_pk_bf16_f32 v164, v152, v154
    v_cvt_pk_bf16_f32 v165, v156, v158
    v_cvt_pk_bf16_f32 v166, v153, v155
    v_cvt_pk_bf16_f32 v167, v157, v159
    s_mov_b32 s25, 1966080
    buffer_store_dwordx2 v[164:165], v68, s[20:23], s25 offen
    s_mov_b32 s25, 1971200
    buffer_store_dwordx2 v[166:167], v68, s[20:23], s25 offen
    s_branch ec_79
nc_78:
ec_79:
L_end:
    s_endpgm
ps_4:
    s_mov_b32 s84, 1048576
pl_5:
    global_load_dword v7, v5, s[66:67] sc1
    s_waitcnt vmcnt(0)
    s_sub_u32 s84, s84, 1
    s_cbranch_scc1 pc_6
    v_cmp_gt_u32_e64 vcc, 1, v7
    s_nop 0
    s_and_b64 vcc, vcc, s[50:51]
    s_and_b64 vcc, vcc, 1
    s_cbranch_scc1 pl_5
    s_branch pc_6
ps_7:
    s_mov_b32 s84, 1048576
pl_8:
    buffer_load_dword v7, v4, s[16:19], s87 offen offset:0 sc1
    s_waitcnt vmcnt(0)
    s_sub_u32 s84, s84, 1
    s_cbranch_scc1 pc_9
    v_cmp_gt_u32 vcc, 32, v7
    s_nop 0
    s_and_b64 vcc, vcc, s[50:51]
    s_cbranch_scc1 pl_8
    s_branch pc_9
ps_11:
    s_mov_b32 s84, 1048576
pl_12:
    global_load_dword v7, v5, s[66:67] sc1
    s_waitcnt vmcnt(0)
    s_sub_u32 s84, s84, 1
    s_cbranch_scc1 pc_13
    v_cmp_gt_u32_e64 vcc, 1, v7
    s_nop 0
    s_and_b64 vcc, vcc, s[50:51]
    s_and_b64 vcc, vcc, 1
    s_cbranch_scc1 pl_12
    s_branch pc_13
ps_14:
    s_mov_b32 s84, 1048576
pl_15:
    buffer_load_dword v7, v4, s[16:19], s87 offen offset:0 sc1
    s_waitcnt vmcnt(0)
    s_sub_u32 s84, s84, 1
    s_cbranch_scc1 pc_16
    v_cmp_gt_u32 vcc, 32, v7
    s_nop 0
    s_and_b64 vcc, vcc, s[50:51]
    s_cbranch_scc1 pl_15
    s_branch pc_16
ps_17:
    s_mov_b32 s84, 1048576
pl_18:
    buffer_load_dword v7, v4, s[16:19], s87 offen offset:4 sc1
    s_waitcnt vmcnt(0)
    s_sub_u32 s84, s84, 1
    s_cbranch_scc1 pc_19
    v_cmp_gt_u32_e64 vcc, 32, v7
    s_nop 0
    s_and_b64 vcc, vcc, s[50:51]
    s_cbranch_scc1 pl_18
    s_branch pc_19
rd_21:
    s_cmp_eq_u32 s38, 0
    s_cbranch_scc1 rc_22
    s_sub_u32 s38, s38, 1
    s_nop 7
    s_nop 7
    s_sleep 4
    s_mov_b64 exec, vcc
    s_mov_b32 s96, 4194304
    buffer_load_dwordx4 v[216:219], v56, s[16:19], s96 offen offset:0 sc1
    buffer_load_dwordx4 v[220:223], v56, s[16:19], s96 offen offset:256 sc1
    s_mov_b32 s96, 4227072
    buffer_load_dwordx4 v[224:227], v56, s[16:19], s96 offen offset:0 sc1
    buffer_load_dwordx4 v[228:231], v56, s[16:19], s96 offen offset:256 sc1
    s_mov_b32 s96, 4259840
    buffer_load_dwordx4 v[232:235], v56, s[16:19], s96 offen offset:0 sc1
    buffer_load_dwordx4 v[236:239], v56, s[16:19], s96 offen offset:256 sc1
    s_mov_b32 s96, 4292608
    buffer_load_dwordx4 v[240:243], v56, s[16:19], s96 offen offset:0 sc1
    buffer_load_dwordx4 v[244:247], v56, s[16:19], s96 offen offset:256 sc1
    s_mov_b32 s96, 4194304
    buffer_load_dwordx2 v[248:249], v57, s[16:19], s96 offen offset:0 sc1
    buffer_load_dwordx2 v[252:253], v57, s[16:19], s96 offen offset:128 sc1
    s_mov_b32 s96, 4210688
    buffer_load_dwordx2 v[250:251], v57, s[16:19], s96 offen offset:0 sc1
    buffer_load_dwordx2 v[254:255], v57, s[16:19], s96 offen offset:128 sc1
    s_mov_b32 s96, 0
    s_mov_b32 s97, 5120
    s_waitcnt vmcnt(16)
    buffer_load_dwordx2 v[208:209], v60, s[4:7], s96 offen
    s_waitcnt vmcnt(16)
    buffer_load_dwordx2 v[210:211], v60, s[4:7], s97 offen
    s_waitcnt vmcnt(16)
    v_lshrrev_b32_e64 v212, 5, v1
    v_mul_u32_u24 v212, 5104, v212
    v_bfe_u32 v213, v1, 4, 1
    v_lshlrev_b32 v213, 2, v213
    v_sub_u32 v212, v212, v213
    v_add_u32 v212, v212, v60
    s_mul_i32 s97, s24, 24
    s_sub_u32 s97, 128, s97
    buffer_load_dword v212, v212, s[4:7], s97 offen
    s_mov_b64 exec, -1
    s_waitcnt vmcnt(0) lgkmcnt(0)
    s_branch oe_20
rd_24:
    s_cmp_eq_u32 s38, 0
    s_cbranch_scc1 rc_25
    s_sub_u32 s38, s38, 1
    s_nop 7
    s_nop 7
    s_sleep 4
    s_mov_b64 exec, vcc
    s_mov_b32 s96, 4198400
    buffer_load_dwordx4 v[216:219], v56, s[16:19], s96 offen offset:0 sc1
    buffer_load_dwordx4 v[220:223], v56, s[16:19], s96 offen offset:256 sc1
    s_mov_b32 s96, 4231168
    buffer_load_dwordx4 v[224:227], v56, s[16:19], s96 offen offset:0 sc1
    buffer_load_dwordx4 v[228:231], v56, s[16:19], s96 offen offset:256 sc1
    s_mov_b32 s96, 4263936
    buffer_load_dwordx4 v[232:235], v56, s[16:19], s96 offen offset:0 sc1
    buffer_load_dwordx4 v[236:239], v56, s[16:19], s96 offen offset:256 sc1
    s_mov_b32 s96, 4296704
    buffer_load_dwordx4 v[240:243], v56, s[16:19], s96 offen offset:0 sc1
    buffer_load_dwordx4 v[244:247], v56, s[16:19], s96 offen offset:256 sc1
    s_mov_b32 s96, 4196352
    buffer_load_dwordx2 v[248:249], v57, s[16:19], s96 offen offset:0 sc1
    buffer_load_dwordx2 v[252:253], v57, s[16:19], s96 offen offset:128 sc1
    s_mov_b32 s96, 4212736
    buffer_load_dwordx2 v[250:251], v57, s[16:19], s96 offen offset:0 sc1
    buffer_load_dwordx2 v[254:255], v57, s[16:19], s96 offen offset:128 sc1
    s_mov_b32 s96, 1310720
    s_mov_b32 s97, 1315840
    s_waitcnt vmcnt(15)
    buffer_load_dwordx2 v[208:209], v60, s[4:7], s96 offen
    s_waitcnt vmcnt(15)
    buffer_load_dwordx2 v[210:211], v60, s[4:7], s97 offen
    s_waitcnt vmcnt(15)
    v_lshrrev_b32 v212, 5, v1
    v_mul_u32_u24 v212, 5104, v212
    v_bfe_u32 v213, v1, 4, 1
    v_lshlrev_b32 v213, 2, v213
    v_sub_u32 v212, v212, v213
    v_add_u32 v212, v212, v60
    s_mul_i32 s97, s24, 24
    s_sub_u32 s97, 1310848, s97
    buffer_load_dword v212, v212, s[4:7], s97 offen
    s_mov_b64 exec, -1
    s_waitcnt vmcnt(0) lgkmcnt(0)
    s_branch oe_23
rd_29:
    s_cmp_eq_u32 s38, 0
    s_cbranch_scc1 rc_30
    s_sub_u32 s38, s38, 1
    s_nop 7
    s_nop 7
    s_sleep 4
    s_mov_b64 exec, vcc
    s_lshl_b32 s96, s75, 14
    s_add_u32 s96, s96, 6815744
    s_lshl_b32 s97, s24, 12
    s_add_u32 s97, s97, 3473408
    buffer_load_dwordx4 v[176:179], v62, s[16:19], s96 offen offset:0 sc1
    buffer_load_dwordx4 v[180:183], v62, s[16:19], s96 offen offset:1024 sc1
    buffer_load_dwordx4 v[184:187], v62, s[16:19], s97 offen offset:0 sc1
    buffer_load_dwordx4 v[188:191], v62, s[16:19], s97 offen offset:1024 sc1
    buffer_load_dwordx4 v[192:195], v62, s[16:19], s97 offen offset:2048 sc1
    buffer_load_dwordx4 v[196:199], v62, s[16:19], s97 offen offset:3072 sc1
    s_mov_b64 exec, -1
    s_waitcnt vmcnt(0) lgkmcnt(0)
    s_branch ce_28
rd_32:
    s_cmp_eq_u32 s38, 0
    s_cbranch_scc1 rc_33
    s_sub_u32 s38, s38, 1
    s_nop 7
    s_nop 7
    s_sleep 4
    s_mov_b64 exec, vcc
    s_lshl_b32 s96, s75, 14
    s_add_u32 s96, s96, 6815744
    s_lshl_b32 s97, s24, 12
    s_add_u32 s97, s97, 3477504
    buffer_load_dwordx4 v[248:251], v62, s[16:19], s96 offen offset:2048 sc1
    buffer_load_dwordx4 v[252:255], v62, s[16:19], s96 offen offset:3072 sc1
    buffer_load_dwordx4 v[96:99], v62, s[16:19], s97 offen offset:0 sc1
    buffer_load_dwordx4 v[100:103], v62, s[16:19], s97 offen offset:1024 sc1
    buffer_load_dwordx4 v[104:107], v62, s[16:19], s97 offen offset:2048 sc1
    buffer_load_dwordx4 v[108:111], v62, s[16:19], s97 offen offset:3072 sc1
    s_mov_b64 exec, -1
    s_waitcnt vmcnt(0) lgkmcnt(0)
    s_branch ce_31
gl_34:
    s_add_u32 s82, s86, 16384
    v_lshlrev_b32 v2, 10, v1
    v_mov_b32_e64 v5, 1
    s_mov_b64 exec, 255
    buffer_store_dword v5, v2, s[16:19], s82 offen offset:0 sc1
    s_mov_b64 exec, -1
    s_branch gc_35
ps_36:
    s_mov_b32 s84, 1048576
pl_37:
    buffer_load_dword v7, v4, s[16:19], s89 offen offset:0 sc1
    s_waitcnt vmcnt(0)
    s_sub_u32 s84, s84, 1
    s_cbranch_scc1 pc_38
    v_cmp_gt_u32 vcc, 1, v7
    s_nop 0
    s_and_b64 vcc, vcc, s[50:51]
    s_cbranch_scc1 pl_37
    s_branch pc_38
gl_39:
    s_add_u32 s82, s86, 0
    v_lshlrev_b32 v2, 10, v1
    v_mov_b32_e64 v5, 1
    s_mov_b64 exec, 255
    buffer_store_dword v5, v2, s[16:19], s82 offen offset:12 sc1
    s_mov_b64 exec, -1
    s_branch gc_40
ps_41:
    s_mov_b32 s84, 1048576
pl_42:
    buffer_load_dword v7, v4, s[16:19], s89 offen offset:0 sc1
    s_waitcnt vmcnt(0)
    s_sub_u32 s84, s84, 1
    s_cbranch_scc1 pc_43
    v_cmp_gt_u32_e64 vcc, 1, v7
    s_nop 0
    s_and_b64 vcc, vcc, s[50:51]
    s_cbranch_scc1 pl_42
    s_branch pc_43
rd_46:
    s_cmp_eq_u32 s38, 0
    s_cbranch_scc1 rc_47
    s_sub_u32 s38, s38, 1
    s_nop 7
    s_nop 7
    s_sleep 4
    s_mov_b64 exec, vcc
    s_add_u32 s26, s3, 9437184
    buffer_load_dwordx4 v[216:219], v236, s[16:19], s26 offen sc1
    s_add_u32 s26, s26, 524288
    buffer_load_dwordx4 v[220:223], v236, s[16:19], s26 offen sc1
    s_add_u32 s26, s26, 524288
    buffer_load_dwordx4 v[224:227], v236, s[16:19], s26 offen sc1
    s_add_u32 s26, s26, 524288
    buffer_load_dwordx4 v[228:231], v236, s[16:19], s26 offen sc1
    s_add_u32 s26, s26, 524288
    buffer_load_dwordx4 v[232:235], v236, s[16:19], s26 offen sc1
    s_mov_b64 exec, -1
    s_waitcnt vmcnt(0) lgkmcnt(0)
    s_branch se_45
gl_49:
    s_add_u32 s82, s86, 16384
    v_lshlrev_b32 v2, 10, v1
    v_mov_b32_e64 v5, 1
    s_mov_b64 exec, 255
    buffer_store_dword v5, v2, s[16:19], s82 offen offset:4 sc1
    s_mov_b64 exec, -1
    s_branch gc_50
ps_51:
    s_mov_b32 s84, 1048576
pl_52:
    buffer_load_dword v7, v4, s[16:19], s87 offen offset:12 sc1
    s_waitcnt vmcnt(0)
    s_sub_u32 s84, s84, 1
    s_cbranch_scc1 pc_53
    v_cmp_gt_u32_e64 vcc, 1, v7
    s_nop 0
    s_and_b64 vcc, vcc, s[50:51]
    s_cbranch_scc1 pl_52
    s_branch pc_53
rd_55:
    s_cmp_eq_u32 s38, 0
    s_cbranch_scc1 rc_56
    s_sub_u32 s38, s38, 1
    s_nop 7
    s_nop 7
    s_sleep 4
    s_mov_b64 exec, vcc
    s_lshl_b32 s98, s72, 5
    s_add_u32 s98, s98, 0
    s_sub_u32 s95, s98, 4
    s_max_i32 s95, s95, 0
    s_lshl_b32 s94, s98, 3
    s_lshl_b32 s95, s95, 3
    s_add_u32 s94, s94, 3457024
    s_add_u32 s95, s95, 3457024
    s_add_u32 s96, s94, 8192
    buffer_load_dwordx2 v[152:153], v47, s[16:19], s94 offen sc1
    buffer_load_dwordx2 v[154:155], v47, s[16:19], s96 offen sc1
    buffer_load_dwordx2 v[156:157], v48, s[16:19], s95 offen sc1
    s_mov_b64 exec, -1
    s_waitcnt vmcnt(0) lgkmcnt(0)
    s_branch sl_54
ps_57:
    s_mov_b32 s84, 1048576
pl_58:
    buffer_load_dword v7, v4, s[16:19], s89 offen offset:4 sc1
    s_waitcnt vmcnt(0)
    s_sub_u32 s84, s84, 1
    s_cbranch_scc1 pc_59
    v_cmp_gt_u32 vcc, 1, v7
    s_nop 0
    s_and_b64 vcc, vcc, s[50:51]
    s_cbranch_scc1 pl_58
    s_branch pc_59
rd_62:
    s_cmp_eq_u32 s38, 0
    s_cbranch_scc1 rc_63
    s_sub_u32 s38, s38, 1
    s_nop 7
    s_nop 7
    s_sleep 4
    s_mov_b64 exec, vcc
    s_add_u32 s26, s3, 9437184
    buffer_load_dwordx4 v[216:219], v236, s[16:19], s26 offen sc1
    s_add_u32 s26, s26, 524288
    buffer_load_dwordx4 v[220:223], v236, s[16:19], s26 offen sc1
    s_add_u32 s26, s26, 524288
    buffer_load_dwordx4 v[224:227], v236, s[16:19], s26 offen sc1
    s_add_u32 s26, s26, 524288
    buffer_load_dwordx4 v[228:231], v236, s[16:19], s26 offen sc1
    s_add_u32 s26, s26, 524288
    buffer_load_dwordx4 v[232:235], v236, s[16:19], s26 offen sc1
    s_mov_b64 exec, -1
    s_waitcnt vmcnt(0) lgkmcnt(0)
    s_branch se_61
rd_64:
    s_cmp_eq_u32 s39, 0
    s_cbranch_scc1 rc_65
    s_sub_u32 s39, s39, 1
    s_nop 7
    s_nop 7
    s_waitcnt vmcnt(0) lgkmcnt(0)
    s_barrier
    s_lshl_b32 s25, s72, 5
    s_add_u32 s25, s25, 0
    s_sub_u32 s26, s25, 4
    s_max_i32 s26, s26, 0
    s_lshl_b32 s27, s71, 12
    s_add_u32 s27, s27, 9437184
    s_lshl_b32 s99, s25, 3
    s_lshl_b32 s100, s26, 3
    s_lshl_b32 s92, s24, 12
    s_lshl_b32 s93, s24, 9
    s_add_u32 s99, s99, s27
    s_add_u32 s100, s100, s27
    s_add_u32 m0, s92, 36352
    s_nop 0
    buffer_load_dwordx4 v73, s[16:19], s99 offen offset:0 sc1 lds
    buffer_load_dwordx4 v74, s[16:19], s99 offen offset:1024 sc1 lds
    buffer_load_dwordx4 v75, s[16:19], s99 offen offset:2048 sc1 lds
    buffer_load_dwordx4 v76, s[16:19], s99 offen offset:3072 sc1 lds
    s_add_u32 m0, s93, 53760
    s_add_u32 s99, s99, 524288
    s_mov_b64 exec, s[80:81]
    buffer_load_dwordx4 v77, s[16:19], s100 offen sc1 lds
    s_mov_b64 exec, -1
    s_add_u32 s100, s100, 524288
    s_add_u32 m0, s92, 55936
    s_nop 0
    s_nop 0
    buffer_load_dwordx4 v73, s[16:19], s99 offen offset:0 sc1 lds
    buffer_load_dwordx4 v74, s[16:19], s99 offen offset:1024 sc1 lds
    buffer_load_dwordx4 v75, s[16:19], s99 offen offset:2048 sc1 lds
    buffer_load_dwordx4 v76, s[16:19], s99 offen offset:3072 sc1 lds
    s_add_u32 m0, s93, 73344
    s_add_u32 s99, s99, 524288
    s_mov_b64 exec, s[80:81]
    buffer_load_dwordx4 v77, s[16:19], s100 offen sc1 lds
    s_mov_b64 exec, -1
    s_add_u32 s100, s100, 524288
    s_mov_b64 exec, -1
    s_waitcnt vmcnt(0) lgkmcnt(0)
    s_branch ge_48
rd_68:
    s_cmp_eq_u32 s38, 0
    s_cbranch_scc1 rc_69
    s_sub_u32 s38, s38, 1
    s_nop 7
    s_nop 7
    s_sleep 4
    s_mov_b64 exec, vcc
    s_lshl_b32 s98, s72, 5
    s_add_u32 s98, s98, 256
    s_sub_u32 s95, s98, 4
    s_max_i32 s95, s95, 0
    s_lshl_b32 s94, s98, 3
    s_lshl_b32 s95, s95, 3
    s_nop 0
    s_add_u32 s94, s94, 3457024
    s_add_u32 s95, s95, 3457024
    s_add_u32 s96, s94, 8192
    buffer_load_dwordx2 v[152:153], v47, s[16:19], s94 offen sc1
    buffer_load_dwordx2 v[154:155], v47, s[16:19], s96 offen sc1
    buffer_load_dwordx2 v[156:157], v48, s[16:19], s95 offen sc1
    s_mov_b64 exec, -1
    s_waitcnt vmcnt(0) lgkmcnt(0)
    s_branch sl_67
rd_70:
    s_cmp_eq_u32 s39, 0
    s_cbranch_scc1 rc_71
    s_sub_u32 s39, s39, 1
    s_nop 7
    s_nop 7
    s_waitcnt vmcnt(0) lgkmcnt(0)
    s_barrier
    s_lshl_b32 s25, s72, 5
    s_add_u32 s25, s25, 256
    s_sub_u32 s26, s25, 4
    s_max_i32 s26, s26, 0
    s_lshl_b32 s27, s71, 12
    s_add_u32 s27, s27, 9437184
    s_lshl_b32 s99, s25, 3
    s_lshl_b32 s100, s26, 3
    s_lshl_b32 s92, s24, 12
    s_lshl_b32 s93, s24, 9
    s_add_u32 s99, s99, s27
    s_add_u32 s100, s100, s27
    s_add_u32 m0, s92, 36352
    s_nop 0
    s_nop 0
    buffer_load_dwordx4 v73, s[16:19], s99 offen offset:0 sc1 lds
    buffer_load_dwordx4 v74, s[16:19], s99 offen offset:1024 sc1 lds
    buffer_load_dwordx4 v75, s[16:19], s99 offen offset:2048 sc1 lds
    buffer_load_dwordx4 v76, s[16:19], s99 offen offset:3072 sc1 lds
    s_add_u32 m0, s93, 53760
    s_add_u32 s99, s99, 524288
    s_mov_b64 exec, s[80:81]
    buffer_load_dwordx4 v77, s[16:19], s100 offen sc1 lds
    s_mov_b64 exec, -1
    s_add_u32 s100, s100, 524288
    s_add_u32 m0, s92, 55936
    s_nop 0
    s_nop 0
    buffer_load_dwordx4 v73, s[16:19], s99 offen offset:0 sc1 lds
    buffer_load_dwordx4 v74, s[16:19], s99 offen offset:1024 sc1 lds
    buffer_load_dwordx4 v75, s[16:19], s99 offen offset:2048 sc1 lds
    buffer_load_dwordx4 v76, s[16:19], s99 offen offset:3072 sc1 lds
    s_add_u32 m0, s93, 73344
    s_add_u32 s99, s99, 524288
    s_mov_b64 exec, s[80:81]
    buffer_load_dwordx4 v77, s[16:19], s100 offen sc1 lds
    s_mov_b64 exec, -1
    s_add_u32 s100, s100, 524288
    s_add_u32 m0, s92, 75520
    s_nop 0
    s_nop 0
    buffer_load_dwordx4 v73, s[16:19], s99 offen offset:0 sc1 lds
    buffer_load_dwordx4 v74, s[16:19], s99 offen offset:1024 sc1 lds
    buffer_load_dwordx4 v75, s[16:19], s99 offen offset:2048 sc1 lds
    buffer_load_dwordx4 v76, s[16:19], s99 offen offset:3072 sc1 lds
    s_add_u32 m0, s93, 92928
    s_add_u32 s99, s99, 524288
    s_mov_b64 exec, s[80:81]
    buffer_load_dwordx4 v77, s[16:19], s100 offen sc1 lds
    s_mov_b64 exec, -1
    s_add_u32 s100, s100, 524288
    s_mov_b64 exec, -1
    s_waitcnt vmcnt(0) lgkmcnt(0)
    s_branch ge_66
rd_73:
    s_cmp_eq_u32 s38, 0
    s_cbranch_scc1 rc_74
    s_sub_u32 s38, s38, 1
    s_nop 7
    s_nop 7
    s_sleep 4
    s_mov_b64 exec, vcc
    s_mov_b32 s96, 12058624
    buffer_load_dwordx4 v[216:219], v56, s[16:19], s96 offen offset:0 sc1
    buffer_load_dwordx4 v[220:223], v56, s[16:19], s96 offen offset:256 sc1
    s_mov_b32 s96, 12091392
    buffer_load_dwordx4 v[224:227], v56, s[16:19], s96 offen offset:0 sc1
    buffer_load_dwordx4 v[228:231], v56, s[16:19], s96 offen offset:256 sc1
    s_mov_b32 s96, 12124160
    buffer_load_dwordx4 v[232:235], v56, s[16:19], s96 offen offset:0 sc1
    buffer_load_dwordx4 v[236:239], v56, s[16:19], s96 offen offset:256 sc1
    s_mov_b32 s96, 12156928
    buffer_load_dwordx4 v[240:243], v56, s[16:19], s96 offen offset:0 sc1
    buffer_load_dwordx4 v[244:247], v56, s[16:19], s96 offen offset:256 sc1
    s_mov_b32 s96, 12058624
    buffer_load_dwordx2 v[248:249], v57, s[16:19], s96 offen offset:0 sc1
    buffer_load_dwordx2 v[252:253], v57, s[16:19], s96 offen offset:128 sc1
    s_mov_b32 s96, 12075008
    buffer_load_dwordx2 v[250:251], v57, s[16:19], s96 offen offset:0 sc1
    buffer_load_dwordx2 v[254:255], v57, s[16:19], s96 offen offset:128 sc1
    s_mov_b32 s96, 9437184
    buffer_load_dwordx4 v[208:211], v59, s[16:19], s96 offen sc1
    s_add_u32 s97, s36, 9437184
    buffer_load_dword v212, v61, s[16:19], s97 offen sc1
    s_mov_b64 exec, -1
    s_waitcnt vmcnt(0) lgkmcnt(0)
    s_branch oe_72
rd_76:
    s_cmp_eq_u32 s38, 0
    s_cbranch_scc1 rc_77
    s_sub_u32 s38, s38, 1
    s_nop 7
    s_nop 7
    s_sleep 4
    s_mov_b64 exec, vcc
    s_mov_b32 s96, 12062720
    buffer_load_dwordx4 v[216:219], v56, s[16:19], s96 offen offset:0 sc1
    buffer_load_dwordx4 v[220:223], v56, s[16:19], s96 offen offset:256 sc1
    s_mov_b32 s96, 12095488
    buffer_load_dwordx4 v[224:227], v56, s[16:19], s96 offen offset:0 sc1
    buffer_load_dwordx4 v[228:231], v56, s[16:19], s96 offen offset:256 sc1
    s_mov_b32 s96, 12128256
    buffer_load_dwordx4 v[232:235], v56, s[16:19], s96 offen offset:0 sc1
    buffer_load_dwordx4 v[236:239], v56, s[16:19], s96 offen offset:256 sc1
    s_mov_b32 s96, 12161024
    buffer_load_dwordx4 v[240:243], v56, s[16:19], s96 offen offset:0 sc1
    buffer_load_dwordx4 v[244:247], v56, s[16:19], s96 offen offset:256 sc1
    s_mov_b32 s96, 12060672
    buffer_load_dwordx2 v[248:249], v57, s[16:19], s96 offen offset:0 sc1
    buffer_load_dwordx2 v[252:253], v57, s[16:19], s96 offen offset:128 sc1
    s_mov_b32 s96, 12077056
    buffer_load_dwordx2 v[250:251], v57, s[16:19], s96 offen offset:0 sc1
    buffer_load_dwordx2 v[254:255], v57, s[16:19], s96 offen offset:128 sc1
    s_mov_b32 s96, 9439232
    buffer_load_dwordx4 v[208:211], v59, s[16:19], s96 offen sc1
    s_add_u32 s97, s36, 9439232
    buffer_load_dword v212, v61, s[16:19], s97 offen sc1
    s_mov_b64 exec, -1
    s_waitcnt vmcnt(0) lgkmcnt(0)
    s_branch oe_75
rd_81:
    s_cmp_eq_u32 s38, 0
    s_cbranch_scc1 rc_82
    s_sub_u32 s38, s38, 1
    s_nop 7
    s_nop 7
    s_sleep 4
    s_mov_b64 exec, vcc
    s_lshl_b32 s96, s75, 14
    s_add_u32 s96, s96, 14680064
    s_lshl_b32 s97, s24, 12
    s_add_u32 s97, s97, 3506176
    buffer_load_dwordx4 v[176:179], v62, s[16:19], s96 offen offset:0 sc1
    buffer_load_dwordx4 v[180:183], v62, s[16:19], s96 offen offset:1024 sc1
    buffer_load_dwordx4 v[184:187], v62, s[16:19], s97 offen offset:0 sc1
    buffer_load_dwordx4 v[188:191], v62, s[16:19], s97 offen offset:1024 sc1
    buffer_load_dwordx4 v[192:195], v62, s[16:19], s97 offen offset:2048 sc1
    buffer_load_dwordx4 v[196:199], v62, s[16:19], s97 offen offset:3072 sc1
    s_mov_b64 exec, -1
    s_waitcnt vmcnt(0) lgkmcnt(0)
    s_branch ce_80
rd_84:
    s_cmp_eq_u32 s38, 0
    s_cbranch_scc1 rc_85
    s_sub_u32 s38, s38, 1
    s_nop 7
    s_nop 7
    s_sleep 4
    s_mov_b64 exec, vcc
    s_lshl_b32 s96, s75, 14
    s_add_u32 s96, s96, 14680064
    s_lshl_b32 s97, s24, 12
    s_add_u32 s97, s97, 3510272
    buffer_load_dwordx4 v[248:251], v62, s[16:19], s96 offen offset:2048 sc1
    buffer_load_dwordx4 v[252:255], v62, s[16:19], s96 offen offset:3072 sc1
    buffer_load_dwordx4 v[96:99], v62, s[16:19], s97 offen offset:0 sc1
    buffer_load_dwordx4 v[100:103], v62, s[16:19], s97 offen offset:1024 sc1
    buffer_load_dwordx4 v[104:107], v62, s[16:19], s97 offen offset:2048 sc1
    buffer_load_dwordx4 v[108:111], v62, s[16:19], s97 offen offset:3072 sc1
    s_mov_b64 exec, -1
    s_waitcnt vmcnt(0) lgkmcnt(0)
    s_branch ce_83
L_last:
    s_endpgm
.section .rodata,"a"
.p2align 6
.amdhsa_kernel interleave_layers__sliding_local_dilated__ssm_conv_s4d__prompt_kernel
  .amdhsa_next_free_vgpr 512
  .amdhsa_next_free_sgpr 102
  .amdhsa_accum_offset 256
  .amdhsa_group_segment_fixed_size 0
  .amdhsa_kernarg_size 104
  .amdhsa_user_sgpr_count 2
  .amdhsa_user_sgpr_kernarg_segment_ptr 1
  .amdhsa_system_sgpr_workgroup_id_x 1
.end_amdhsa_kernel
```

```asm
; @launch grid=(256,1,1) block=(256,1,1) lds=163840
.amdgcn_target "amdgcn-amd-amdhsa--gfx950"
.text
.globl interleave_layers__sliding_local_dilated__ssm_conv_s4d__prompt_kernel
.p2align 8
.type interleave_layers__sliding_local_dilated__ssm_conv_s4d__prompt_kernel,@function
interleave_layers__sliding_local_dilated__ssm_conv_s4d__prompt_kernel:
    s_getpc_b64 s[42:43]
L_start:
    s_cmp_ge_u32 s2, 256
    s_cbranch_scc1 L_end
    s_load_dwordx16 s[44:59], s[0:1], 0
    s_load_dwordx8 s[60:67], s[0:1], 64
    s_load_dwordx2 s[68:69], s[0:1], 96
    v_and_b32 v1, 63, v0
    v_lshrrev_b32 v2, 6, v0
    s_nop 0
    v_readfirstlane_b32 s24, v2
    s_bfe_u32 s82, s2, 0x40003
    s_lshl_b32 s82, s82, 13
    v_lshrrev_b32 v159, 2, v0
    v_lshl_add_u32 v159, v159, 7, s82
    v_min_u32 v159, L_last-L_start, v159
    global_load_dword v159, v159, s[42:43]
    s_and_b32 s25, s2, 7
    s_lshr_b32 s26, s2, 3
    s_and_b32 s27, s26, 3
    s_lshr_b32 s28, s26, 4
    s_lshl_b32 s28, s28, 2
    s_add_u32 s3, s27, s28
    s_lshl_b32 s27, s3, 2
    s_lshr_b32 s70, 0x75206431, s27
    s_and_b32 s70, s70, 7
    s_and_b32 s27, s25, 1
    s_lshl_b32 s27, s27, 3
    s_add_u32 s70, s70, s27
    s_bfe_u32 s71, s26, 0x10002
    s_bfe_u32 s28, s26, 0x10003
    s_and_b32 s72, s25, 6
    s_add_u32 s72, s72, s28
    s_and_b32 s73, s26, 7
    s_lshr_b32 s28, s26, 3
    s_lshl_b32 s74, s25, 2
    s_add_u32 s74, s74, s28
    s_mul_i32 s75, s25, 20
    s_add_u32 s75, s75, s26
    s_min_u32 s27, s2, 239
    s_mul_i32 s25, s27, 10923
    s_lshr_b32 s25, s25, 16
    s_mul_i32 s26, s25, 6
    s_sub_u32 s26, s27, s26
    s_mul_i32 s27, s25, 61440
    s_mul_i32 s28, s26, 640
    s_add_u32 s27, s27, s28
    s_lshl_b32 s28, s24, 10
    v_add_u32 v85, 0, v0
    v_mul_u32_u24 v84, 1639, v85
    v_lshrrev_b32 v84, 16, v84
    v_mul_u32_u24 v84, 3200, v84
    v_lshl_add_u32 v85, v85, 4, v84
    v_add_u32 v86, 256, v0
    v_mul_u32_u24 v84, 1639, v86
    v_lshrrev_b32_e64 v84, 16, v84
    v_mul_u32_u24 v84, 3200, v84
    v_lshl_add_u32 v86, v86, 4, v84
    v_add_u32 v87, 512, v0
    v_min_u32 v87, 639, v87
    v_mul_u32_u24 v84, 1639, v87
    v_lshrrev_b32_e64 v84, 16, v84
    v_mul_u32_u24 v84, 3200, v84
    v_lshl_add_u32 v87, v87, 4, v84
    s_mov_b32 s76, 0
    s_mov_b32 s77, 0x80000000
    s_mov_b32 s80, -1
    s_mov_b32 s81, 0
    s_nop 0
    s_mov_b32 s78, 0xfe0000fe
    s_mov_b32 s79, 0xfe0000fe
    s_mov_b32 s6, 2621440
    s_mov_b32 s7, 0x20000
    s_mov_b32 s10, 2457600
    s_mov_b32 s11, 0x20000
    s_mov_b32 s14, 819200
    s_mov_b32 s15, 0x20000
    s_mov_b32 s18, 22061056
    s_mov_b32 s19, 0x20000
    s_mov_b32 s22, 2621440
    s_mov_b32 s23, 0x20000
    s_waitcnt lgkmcnt(0)
    s_mov_b32 s4, s44
    s_and_b32 s5, s45, 0xffff
    s_mov_b32 s8, s46
    s_and_b32 s9, s47, 0xffff
    s_mov_b32 s12, s48
    s_and_b32 s13, s49, 0xffff
    s_mov_b32 s16, s68
    s_and_b32 s17, s69, 0xffff
    s_mov_b32 s20, s64
    s_and_b32 s21, s65, 0xffff
    s_cmp_lg_u32 s2, 255
    s_cbranch_scc1 fz_1
    v_mov_b32 v120, 0
    v_mov_b32 v121, 0
    v_mov_b32 v122, 0
    v_mov_b32 v123, 0
    v_lshlrev_b32 v124, 4, v0
    s_mov_b32 s88, 3538944
    buffer_store_dwordx4 v[120:123], v124, s[16:19], s88 offen sc1
    s_mov_b32 s88, 3543040
    buffer_store_dwordx4 v[120:123], v124, s[16:19], s88 offen sc1
    s_mov_b32 s88, 3547136
    buffer_store_dwordx4 v[120:123], v124, s[16:19], s88 offen sc1
    s_mov_b32 s88, 3555328
    buffer_store_dwordx4 v[120:123], v124, s[16:19], s88 offen sc1
    s_mov_b32 s88, 3559424
    buffer_store_dwordx4 v[120:123], v124, s[16:19], s88 offen sc1
    s_mov_b32 s88, 3563520
    buffer_store_dwordx4 v[120:123], v124, s[16:19], s88 offen sc1
fz_1:
    s_min_u32 s96, s75, 159
    s_lshl_b32 s96, s96, 2
    s_add_u32 s96, s96, s24
    s_mul_i32 s97, s96, 384
    s_lshl_b32 s96, s96, 1
    v_lshl_add_u32 v2, v1, 2, s97
    v_mov_b32 v241, s96
    global_load_dword v232, v2, s[52:53]
    global_load_dword v233, v2, s[54:55]
    global_load_dword v234, v2, s[56:57]
    global_load_dword v235, v2, s[58:59]
    global_load_ushort v240, v241, s[60:61]
    s_add_u32 m0, s28, 134272
    s_nop 0
    buffer_load_dwordx4 v85, s[8:11], s27 offen lds
    s_add_u32 m0, s28, 138368
    s_nop 0
    buffer_load_dwordx4 v86, s[8:11], s27 offen lds
    s_add_u32 m0, s28, 142464
    s_nop 0
    buffer_load_dwordx4 v87, s[8:11], s27 offen lds
    s_lshr_b32 s29, s26, 1
    s_and_b32 s30, s26, 1
    s_lshl_b32 s30, s30, 3
    s_lshl_b32 s31, s25, 10
    s_add_u32 s31, s31, 0
    s_cmp_ge_u32 s2, 240
    s_cselect_b32 s31, 1073741824, s31
    v_bfe_u32 v93, v0, 2, 2
    v_bfe_u32 v92, v0, 1, 1
    v_lshl_add_u32 v92, v92, 3, v93
    v_mul_u32_u24 v92, 640, v92
    v_and_b32 v93, 1, v0
    v_mul_u32_u24 v93, 40, v93
    v_add_u32 v91, v92, v93
    v_add_u32 v91, 134272, v91
    v_lshrrev_b32 v88, 4, v0
    v_add_u32 v88, 0, v88
    v_cmp_gt_u32 vcc, 40, v88
    v_min_u32 v88, 39, v88
    v_mul_u32_u24 v89, 13108, v88
    v_lshrrev_b32 v89, 16, v89
    v_mul_u32_u24 v90, 5, v89
    v_sub_u32_e64 v90, v88, v90
    v_mul_u32_u24 v92, 80, v89
    v_lshl_add_u32 v92, v90, 3, v92
    v_add_u32 v111, v92, v91
    v_add_u32 v89, s30, v89
    v_cmp_eq_u32 s[82:83], 4, v90
    v_mov_b32 v92, s29
    s_nop 0
    v_cndmask_b32 v93, v90, v92, s[82:83]
    v_cndmask_b32 v92, v92, 3, s[82:83]
    v_lshl_add_u32 v89, v89, 2, v93
    v_mul_u32_u24 v89, 40960, v89
    v_lshl_add_u32 v89, v92, 8, v89
    v_and_b32 v92, 15, v0
    v_lshl_add_u32 v89, v92, 4, v89
    v_mov_b32 v92, 1073741824
    v_cndmask_b32 v89, v92, v89, vcc
    v_add_u32 v108, s31, v89
    v_lshrrev_b32 v88, 4, v0
    v_add_u32 v88, 16, v88
    v_cmp_gt_u32 vcc, 40, v88
    v_min_u32 v88, 39, v88
    v_mul_u32_u24 v89, 13108, v88
    v_lshrrev_b32 v89, 16, v89
    v_mul_u32_u24 v90, 5, v89
    v_sub_u32_e64 v90, v88, v90
    v_mul_u32_u24 v92, 80, v89
    v_lshl_add_u32 v92, v90, 3, v92
    v_add_u32 v112, v92, v91
    v_add_u32 v89, s30, v89
    v_cmp_eq_u32 s[82:83], 4, v90
    v_mov_b32 v92, s29
    s_nop 0
    v_cndmask_b32 v93, v90, v92, s[82:83]
    v_cndmask_b32 v92, v92, 3, s[82:83]
    v_lshl_add_u32 v89, v89, 2, v93
    v_mul_u32_u24 v89, 40960, v89
    v_lshl_add_u32 v89, v92, 8, v89
    v_and_b32 v92, 15, v0
    v_lshl_add_u32 v89, v92, 4, v89
    v_mov_b32 v92, 1073741824
    v_cndmask_b32 v89, v92, v89, vcc
    v_add_u32 v109, s31, v89
    v_lshrrev_b32 v88, 4, v0
    v_add_u32 v88, 32, v88
    v_cmp_gt_u32 vcc, 40, v88
    v_min_u32 v88, 39, v88
    v_mul_u32_u24 v89, 13108, v88
    v_lshrrev_b32 v89, 16, v89
    v_mul_u32_u24 v90, 5, v89
    v_sub_u32_e64 v90, v88, v90
    v_mul_u32_u24 v92, 80, v89
    v_lshl_add_u32 v92, v90, 3, v92
    v_add_u32 v113, v92, v91
    v_add_u32 v89, s30, v89
    v_cmp_eq_u32 s[82:83], 4, v90
    v_mov_b32 v92, s29
    s_nop 0
    v_cndmask_b32 v93, v90, v92, s[82:83]
    v_cndmask_b32 v92, v92, 3, s[82:83]
    v_lshl_add_u32 v89, v89, 2, v93
    v_mul_u32_u24 v89, 40960, v89
    v_lshl_add_u32 v89, v92, 8, v89
    v_and_b32 v92, 15, v0
    v_lshl_add_u32 v89, v92, 4, v89
    v_mov_b32 v92, 1073741824
    v_cndmask_b32 v89, v92, v89, vcc
    v_add_u32 v110, s31, v89
    s_mul_i32 s25, s3, 18
    s_lshl_b32 s26, s72, 7
    s_add_u32 s25, s25, s26
    s_add_u32 s25, s25, s71
    s_add_u32 s25, s25, -16
    s_max_i32 s25, s25, 0
    s_mul_i32 s25, s25, 1280
    v_lshrrev_b32_e64 v204, 1, v0
    v_min_u32 v204, 89, v204
    v_mul_u32_u24 v205, 6554, v204
    v_lshrrev_b32_e64 v205, 16, v205
    v_mul_u32_u24 v205, 1280, v205
    v_lshl_add_u32 v204, v204, 7, v205
    buffer_load_dword v204, v204, s[4:7], s25 offen
    s_and_b32 s25, s2, 7
    s_lshl_b32 s86, s25, 7
    s_add_u32 s86, s86, 3538944
    s_lshl_b32 s87, s25, 10
    s_add_u32 s87, s87, 3538944
    s_add_u32 s89, s87, 16384
    v_cmp_gt_u32 s[50:51], 8, v0
    v_cmp_eq_u32 vcc, 0, v0
    v_lshlrev_b32 v4, 7, v1
    v_mov_b32 v6, 1073741824
    v_cndmask_b32 v4, v6, v4, s[50:51]
    v_cndmask_b32 v6, v6, 0, vcc
    v_mov_b32 v5, 0
    v_mov_b32 v140, 0
    v_mov_b32_e64 v141, 0
    v_mov_b32 v142, 0x3f803f80
    v_mov_b32 v143, 0x3f803f80
    v_lshlrev_b32_e64 v144, 3, v0
    v_add_u32 v144, 155648, v144
    ds_write_b64 v144, v[140:141]
    ds_write_b64 v144, v[142:143] offset:2048
    v_and_b32 v50, 31, v1
    v_lshrrev_b32 v51, 5, v1
    v_mul_u32_u24 v52, 40, v50
    v_mul_u32_u24 v53, 3200, v51
    v_add_u32 v53, v52, v53
    s_lshl_b32 s25, s24, 3
    s_add_u32 s25, s25, 320
    v_add_u32 v38, s25, v53
    s_mul_i32 s25, s24, 6400
    s_add_u32 s25, s25, 352
    v_add_u32 v39, s25, v53
    s_lshl_b32 s31, s71, 12
    v_lshl_add_u32 v47, v50, 3, s31
    v_bfe_u32 v52, v1, 2, 1
    v_and_b32 v53, 3, v1
    v_lshlrev_b32 v54, 13, v52
    v_lshl_add_u32 v54, v53, 3, v54
    v_add_u32_e64 v48, s31, v54
    v_bfe_u32 v54, v1, 4, 1
    v_lshl_add_u32 v52, v54, 1, v52
    v_mul_u32_u24 v52, 40, v52
    v_add_u32 v52, v52, v53
    v_mul_u32_u24_e64 v52, 40, v52
    v_bfe_u32 v53, v1, 3, 1
    v_cmp_eq_u32 s[82:83], v53, v54
    v_lshl_add_u32 v53, v53, 1, v51
    v_cmp_eq_u32 vcc, 3, v53
    v_mov_b32 v54, s24
    s_nop 0
    v_cndmask_b32 v53, v53, v54, vcc
    v_cndmask_b32 v54, v54, 4, vcc
    v_mul_u32_u24 v53, 6400, v53
    v_lshl_add_u32 v52, v54, 3, v52
    v_add_u32_e64 v52, v52, v53
    v_add_u32 v40, 160, v52
    v_mov_b32 v52, 19584
    v_cndmask_b32 v49, 0, v52, s[78:79]
    v_and_b32 v50, 15, v1
    v_lshrrev_b32 v51, 4, v1
    s_and_b32 s25, s24, 1
    s_and_b32 s26, s24, 2
    s_mul_i32 s27, s25, 3200
    s_mul_i32 s28, s26, 320
    s_add_u32 s27, s27, s28
    s_add_u32 s27, s27, 0
    v_and_b32 v52, 1, v1
    v_mul_u32_u24 v52, 1600, v52
    v_lshrrev_b32 v53, 1, v50
    v_mul_u32_u24_e64 v54, 40, v53
    v_add3_u32 v52, v52, v54, s27
    v_lshl_add_u32 v41, v51, 3, v52
    v_add_u32_e64 v42, 32, v52
    v_bfe_u32 v52, v1, 2, 1
    v_mul_u32_u24 v52, 1600, v52
    v_lshrrev_b32 v54, 3, v1
    v_mul_u32_u24 v54, 40, v54
    v_add3_u32 v52, v52, v54, s27
    v_add_u32 v52, 12800, v52
    v_and_b32 v54, 3, v1
    v_lshl_add_u32 v43, v54, 3, v52
    v_add_u32 v52, 32, v52
    v_cmp_eq_u32 vcc, 0, v54
    v_mov_b32 v54, 157696
    s_nop 0
    v_cndmask_b32 v44, v54, v52, vcc
    v_and_b32 v52, 1, v51
    v_add_u32 v52, s26, v52
    v_lshrrev_b32 v54, 2, v50
    v_lshl_add_u32 v52, v52, 2, v54
    v_and_b32 v53, 1, v53
    v_lshl_add_u32 v52, v53, 4, v52
    v_and_b32 v53, 1, v50
    v_lshl_add_u32 v52, v53, 10, v52
    s_lshl_b32 s30, s70, 1
    s_add_u32 s30, s30, s25
    s_lshl_b32 s29, s30, 3
    s_add_u32 s29, s29, s71
    s_lshl_b32 s29, s29, 13
    v_lshrrev_b32 v53, 1, v51
    v_lshlrev_b32 v53, 15, v53
    v_lshl_add_u32 v53, v52, 4, v53
    v_add_u32_e64 v45, s29, v53
    s_lshl_b32 s29, s30, 2
    s_add_u32 s29, s29, s71
    s_lshl_b32 s29, s29, 12
    s_add_u32 s29, s29, 2097152
    v_lshl_add_u32 v46, v52, 3, s29
    s_or_b32 s29, s26, s72
    s_cmp_eq_u32 s29, 0
    s_cselect_b64 s[90:91], -1, 0
    v_lshlrev_b32 v52, 2, v51
    v_sub_u32 v52, v50, v52
    v_mov_b32 v55, 0xf149f2ca
    v_subrev_u32 v53, 0, v52
    v_cmp_lt_u32 vcc, 7, v53
    s_nop 1
    v_cndmask_b32 v28, 0, v55, vcc
    v_cmp_lt_i32 vcc, -9, v53
    s_nop 1
    v_cndmask_b32 v32, 0, v55, vcc
    v_cmp_le_i32 vcc, 0, v53
    v_mov_b32 v54, 0xffff
    s_nop 0
    v_cndmask_b32 v54, 0, v54, vcc
    v_mov_b32 v36, v54
    v_subrev_u32 v53, 1, v52
    v_cmp_lt_u32 vcc, 7, v53
    s_nop 1
    v_cndmask_b32 v29, 0, v55, vcc
    v_cmp_lt_i32 vcc, -9, v53
    s_nop 1
    v_cndmask_b32 v33, 0, v55, vcc
    v_cmp_le_i32 vcc, 0, v53
    v_mov_b32 v54, 0xffff0000
    s_nop 0
    v_cndmask_b32 v54, 0, v54, vcc
    v_or_b32 v36, v36, v54
    v_subrev_u32 v53, 2, v52
    v_cmp_lt_u32 vcc, 7, v53
    s_nop 1
    v_cndmask_b32 v30, 0, v55, vcc
    v_cmp_lt_i32 vcc, -9, v53
    s_nop 1
    v_cndmask_b32 v34, 0, v55, vcc
    v_cmp_le_i32 vcc, 0, v53
    v_mov_b32 v54, 0xffff
    s_nop 0
    v_cndmask_b32 v54, 0, v54, vcc
    v_mov_b32 v37, v54
    v_subrev_u32 v53, 3, v52
    v_cmp_lt_u32 vcc, 7, v53
    s_nop 1
    v_cndmask_b32 v31, 0, v55, vcc
    v_cmp_lt_i32 vcc, -9, v53
    s_nop 1
    v_cndmask_b32 v35, 0, v55, vcc
    v_cmp_le_i32 vcc, 0, v53
    v_mov_b32 v54, 0xffff0000
    s_nop 0
    v_cndmask_b32 v54, 0, v54, vcc
    v_or_b32 v37, v37, v54
    v_and_b32 v62, 15, v1
    v_lshrrev_b32 v63, 4, v1
    s_and_b32 s25, s74, 3
    s_lshr_b32 s26, s74, 2
    s_lshl_b32 s27, s24, 6
    s_add_u32 s27, s27, s25
    s_lshl_b32 s27, s27, 13
    s_lshl_b32 s28, s26, 9
    s_add_u32 s27, s27, s28
    v_lshl_add_u32 v64, v63, 17, s27
    v_lshl_add_u32 v56, v62, 4, v64
    s_lshl_b32 s27, s24, 5
    s_add_u32 s27, s27, s25
    s_lshl_b32 s27, s27, 12
    s_lshl_b32 s28, s26, 8
    s_add_u32 s27, s27, s28
    s_add_u32 s27, s27, 2097152
    v_lshl_add_u32 v64, v63, 15, s27
    v_lshl_add_u32 v57, v62, 3, v64
    v_lshlrev_b32 v58, 4, v1
    s_lshl_b32 s29, s25, 12
    s_add_u32 s29, s29, s28
    v_lshl_add_u32 v64, v62, 4, s29
    v_lshl_add_u32 v61, v63, 2, v64
    s_mul_i32 s30, s73, 20
    s_lshl_b32 s31, s24, 2
    s_add_u32 s30, s30, s31
    s_lshl_b32 s31, s30, 14
    v_lshl_add_u32 v64, v63, 14, v64
    v_add_u32 v59, s31, v64
    s_lshl_b32 s31, s26, 7
    s_add_u32 s31, s31, s25
    s_mul_i32 s31, s31, 1280
    s_lshl_b32 s30, s30, 3
    s_add_u32 s31, s31, s30
    v_mul_u32_u24 v64, 10240, v62
    v_lshl_add_u32 v64, v63, 3, v64
    v_add_u32_e64 v60, s31, v64
    s_lshl_b32 s25, s24, 12
    v_lshl_add_u32 v62, v1, 4, s25
    s_mul_i32 s25, s24, 1216
    s_add_u32 s25, s25, 192
    v_lshl_add_u32 v63, v1, 2, s25
    s_mul_i32 s25, s24, 4864
    s_add_u32 s25, s25, 80
    v_and_b32_e64 v70, 3, v1
    v_mul_u32_u24 v70, 1216, v70
    v_bfe_u32 v71, v1, 2, 3
    v_lshl_add_u32 v70, v71, 4, v70
    v_lshrrev_b32 v71, 5, v1
    v_lshl_add_u32 v70, v71, 4, v70
    v_add_u32 v64, s25, v70
    s_mul_i32 s25, s24, 4160
    s_add_u32 s25, s25, 134368
    v_lshlrev_b32 v71, 6, v71
    v_sub_u32 v71, s25, v71
    v_bfe_u32 v70, v1, 4, 1
    v_lshl_add_u32 v71, v70, 5, v71
    v_and_b32_e64 v70, 3, v1
    v_lshl_add_u32 v71, v70, 3, v71
    v_bfe_u32 v70, v1, 2, 2
    v_lshlrev_b32 v70, 3, v70
    v_sub_u32 v65, v71, v70
    s_mul_i32 s25, s24, 4224
    s_add_u32 s25, s25, 19456
    v_and_b32 v70, 3, v1
    v_mul_u32_u24 v70, 1056, v70
    v_and_b32 v71, 60, v1
    v_add3_u32 v66, v70, v71, s25
    s_mul_i32 s25, s24, 1056
    s_add_u32 s25, s25, 19456
    v_lshl_add_u32 v67, v1, 3, s25
    s_mul_i32 s25, s24, 1280
    s_lshl_b32 s26, s75, 3
    s_add_u32 s25, s25, s26
    v_mul_u32_u24 v70, 10240, v1
    v_add_u32 v68, s25, v70
    s_and_b32 s25, s24, 1
    s_lshl_b32 s25, s25, 6
    s_and_b32 s26, s24, 2
    s_add_u32 s25, s25, s26
    s_mul_i32 s25, s25, 1280
    v_lshrrev_b32 v140, 4, v1
    v_and_b32 v141, 15, v1
    v_xor_b32 v141, v140, v141
    v_lshlrev_b32_e64 v141, 4, v141
    v_mul_u32_u24 v142, 5120, v140
    v_add3_u32 v73, v141, v142, s25
    s_and_b32 s25, s24, 1
    s_lshl_b32 s25, s25, 3
    s_add_u32 s25, s25, s26
    s_mul_i32 s25, s25, 1280
    v_add3_u32 v77, v141, v142, s25
    v_lshrrev_b32 v141, 5, v1
    v_and_b32 v140, 3, v1
    v_xor_b32 v142, v140, v141
    v_lshlrev_b32_e64 v142, 4, v142
    v_lshl_add_u32 v142, v140, 8, v142
    v_bfe_u32 v140, v1, 2, 3
    v_mul_u32_u24 v140, 1088, v140
    v_add_u32 v78, v140, v142
    v_and_b32 v140, 1, v1
    v_xor_b32 v142, v140, v141
    v_lshlrev_b32 v142, 4, v142
    v_lshl_add_u32 v142, v140, 8, v142
    v_bfe_u32 v140, v1, 1, 2
    v_mul_u32_u24 v140, 544, v140
    v_add_u32_e64 v142, v140, v142
    v_add_u32 v74, 19392, v73
    v_add_u32 v75, 38784, v73
    v_add_u32 v76, 58176, v73
    v_add_u32 v142, 53760, v142
    v_and_b32 v140, 31, v1
    v_cmp_eq_u32 vcc, 0, v140
    v_cmp_eq_u32 s[82:83], 24, v140
    s_nop 0
    s_or_b64 vcc, vcc, s[82:83]
    v_mov_b32 v140, 155648
    v_mov_b32 v141, 157696
    v_cndmask_b32_e64 v140, v140, v141, vcc
    v_cndmask_b32 v79, v140, v142, s[78:79]
    v_bfe_u32 v201, v1, 3, 2
    v_and_b32 v202, s24, v201
    v_cmp_eq_u32 vcc, 3, v202
    v_lshrrev_b32 v202, 5, v1
    v_lshl_add_u32 v201, v201, 1, v202
    v_and_b32 v202, 7, v1
    v_lshl_add_u32 v201, v201, 3, v202
    v_lshlrev_b32 v200, 4, v201
    v_mov_b32 v201, 1073741824
    v_cndmask_b32 v200, v200, v201, vcc
    s_lshl_b32 s101, s70, 2
    s_add_u32 s101, s101, s24
    s_mul_i32 s101, s101, 40960
    s_add_u32 s101, s101, 0
    s_lshl_b32 s25, s72, 5
    s_add_u32 s25, s25, 0
    s_sub_u32 s26, s25, 4
    s_max_i32 s26, s26, 0
    s_mul_i32 s27, s71, 1280
    s_mul_i32 s99, s25, 5120
    s_mul_i32 s100, s26, 5120
    s_mul_i32 s92, s24, 4352
    s_mul_i32 s93, s24, 544
    s_add_u32 s99, s99, s27
    s_add_u32 s100, s100, s27
    s_mov_b32 s38, 0x10000
    s_mov_b32 s39, 0x1000
    s_cmp_ge_u32 s2, 160
    s_cbranch_scc1 nc_2
    s_mul_i32 s37, s24, 8704
    s_add_u32 s25, s37, 0
    s_add_u32 s37, s37, 0
    s_mov_b32 m0, s37
    v_and_b32 v199, 31, v1
    v_mul_u32_u24 v199, 272, v199
    v_lshrrev_b32 v215, 5, v1
    v_lshl_add_u32 v199, v215, 4, v199
    v_add_u32 v252, s25, v199
    s_waitcnt vmcnt(4)
    v_lshlrev_b32 v253, 16, v240
    v_mul_f32 v253, 0x3fb8aa3b, v253
    v_exp_f32 v253, v253
    s_nop 0
    v_cvt_pk_bf16_f32 v253, v253, v253
    v_lshlrev_b32 v253, 16, v253
    v_lshlrev_b32 v199, 16, v232
    v_mul_f32 v199, 0x3fb8aa3b, v199
    v_exp_f32 v199, v199
    v_lshlrev_b32 v255, 16, v233
    v_mul_f32 v255, v255, v253
    v_mul_f32 v255, 0x3e22f983, v255
    v_cvt_pk_bf16_f32 v199, v199, v199
    v_lshlrev_b32 v199, 16, v199
    v_mul_f32_e64 v254, v199, v253
    v_mul_f32 v254, 0xbfb8aa3b, v254
    v_mul_f32 v182, 0x41000000, v254
    v_mul_f32 v185, 0x41000000, v255
    v_mul_f32 v184, 0x43800000, v254
    v_mul_f32 v189, 0x43800000, v255
    v_fract_f32 v185, v185
    v_fract_f32 v188, v255
    v_fract_f32 v189, v189
    v_exp_f32 v182, v182
    v_exp_f32 v183, v254
    v_exp_f32 v184, v184
    v_cos_f32 v186, v185
    v_sin_f32 v187, v185
    v_cos_f32 v180, v188
    v_sin_f32 v181, v188
    v_cos_f32 v190, v189
    v_sin_f32 v191, v189
    v_lshlrev_b32 v192, 16, v234
    v_lshlrev_b32 v193, 16, v235
    v_add_f32 v199, v253, v253
    v_mul_f32 v192, v192, v199
    v_mul_f32 v193, v193, v199
    v_mul_f32 v186, v186, v182
    v_mul_f32 v187, v187, v182
    v_mul_f32 v180, v180, v183
    v_mul_f32 v181, v181, v183
    v_mul_f32 v190, v190, v184
    v_mul_f32_e64 v191, v191, v184
    v_mov_b32 v242, 0x3f80
    v_cvt_pk_bf16_f32 v243, v186, v187
    v_pk_mul_f32 v[194:195], v[186:187], v[186:187] op_sel:[0,0] op_sel_hi:[0,1]
    v_pk_fma_f32 v[172:173], v[186:187], v[186:187], v[194:195] op_sel:[1,1,0] op_sel_hi:[1,0,1] neg_lo:[0,1,0]
    v_cvt_pk_bf16_f32 v244, v172, v173
    v_pk_mul_f32 v[194:195], v[172:173], v[186:187] op_sel:[0,0] op_sel_hi:[0,1]
    v_pk_fma_f32 v[174:175], v[172:173], v[186:187], v[194:195] op_sel:[1,1,0] op_sel_hi:[1,0,1] neg_lo:[0,1,0]
    v_cvt_pk_bf16_f32 v245, v174, v175
    v_pk_mul_f32 v[194:195], v[174:175], v[186:187] op_sel:[0,0] op_sel_hi:[0,1]
    v_pk_fma_f32 v[172:173], v[174:175], v[186:187], v[194:195] op_sel:[1,1,0] op_sel_hi:[1,0,1] neg_lo:[0,1,0]
    v_cvt_pk_bf16_f32 v246, v172, v173
    v_pk_mul_f32 v[194:195], v[172:173], v[186:187] op_sel:[0,0] op_sel_hi:[0,1]
    v_pk_fma_f32 v[174:175], v[172:173], v[186:187], v[194:195] op_sel:[1,1,0] op_sel_hi:[1,0,1] neg_lo:[0,1,0]
    v_cvt_pk_bf16_f32 v247, v174, v175
    v_pk_mul_f32 v[194:195], v[174:175], v[186:187] op_sel:[0,0] op_sel_hi:[0,1]
    v_pk_fma_f32 v[172:173], v[174:175], v[186:187], v[194:195] op_sel:[1,1,0] op_sel_hi:[1,0,1] neg_lo:[0,1,0]
    v_cvt_pk_bf16_f32 v248, v172, v173
    v_pk_mul_f32 v[194:195], v[172:173], v[186:187] op_sel:[0,0] op_sel_hi:[0,1]
    v_pk_fma_f32 v[174:175], v[172:173], v[186:187], v[194:195] op_sel:[1,1,0] op_sel_hi:[1,0,1] neg_lo:[0,1,0]
    v_cvt_pk_bf16_f32 v249, v174, v175
    v_pk_mul_f32 v[194:195], v[174:175], v[186:187] op_sel:[0,0] op_sel_hi:[0,1]
    v_pk_fma_f32 v[172:173], v[174:175], v[186:187], v[194:195] op_sel:[1,1,0] op_sel_hi:[1,0,1] neg_lo:[0,1,0]
    v_cvt_pk_bf16_f32 v250, v172, v173
    v_pk_mul_f32 v[194:195], v[172:173], v[186:187] op_sel:[0,0] op_sel_hi:[0,1]
    v_pk_fma_f32 v[174:175], v[172:173], v[186:187], v[194:195] op_sel:[1,1,0] op_sel_hi:[1,0,1] neg_lo:[0,1,0]
    v_cvt_pk_bf16_f32 v251, v174, v175
    ds_write_addtid_b32 v242 offset:0
    ds_write_addtid_b32 v243 offset:272
    ds_write_addtid_b32 v244 offset:544
    ds_write_addtid_b32 v245 offset:816
    ds_write_addtid_b32 v246 offset:1088
    ds_write_addtid_b32 v247 offset:1360
    ds_write_addtid_b32 v248 offset:1632
    ds_write_addtid_b32 v249 offset:1904
    ds_write_addtid_b32 v250 offset:2176
    ds_write_addtid_b32 v251 offset:2448
    v_pk_mul_f32 v[194:195], v[174:175], v[186:187] op_sel:[0,0] op_sel_hi:[0,1]
    v_pk_fma_f32 v[172:173], v[174:175], v[186:187], v[194:195] op_sel:[1,1,0] op_sel_hi:[1,0,1] neg_lo:[0,1,0]
    v_cvt_pk_bf16_f32 v242, v172, v173
    v_pk_mul_f32 v[194:195], v[172:173], v[186:187] op_sel:[0,0] op_sel_hi:[0,1]
    v_pk_fma_f32 v[174:175], v[172:173], v[186:187], v[194:195] op_sel:[1,1,0] op_sel_hi:[1,0,1] neg_lo:[0,1,0]
    v_cvt_pk_bf16_f32 v243, v174, v175
    v_pk_mul_f32 v[194:195], v[174:175], v[186:187] op_sel:[0,0] op_sel_hi:[0,1]
    v_pk_fma_f32 v[172:173], v[174:175], v[186:187], v[194:195] op_sel:[1,1,0] op_sel_hi:[1,0,1] neg_lo:[0,1,0]
    v_cvt_pk_bf16_f32 v244, v172, v173
    v_pk_mul_f32 v[194:195], v[172:173], v[186:187] op_sel:[0,0] op_sel_hi:[0,1]
    v_pk_fma_f32 v[174:175], v[172:173], v[186:187], v[194:195] op_sel:[1,1,0] op_sel_hi:[1,0,1] neg_lo:[0,1,0]
    v_cvt_pk_bf16_f32 v245, v174, v175
    v_pk_mul_f32 v[194:195], v[174:175], v[186:187] op_sel:[0,0] op_sel_hi:[0,1]
    v_pk_fma_f32 v[172:173], v[174:175], v[186:187], v[194:195] op_sel:[1,1,0] op_sel_hi:[1,0,1] neg_lo:[0,1,0]
    v_cvt_pk_bf16_f32 v246, v172, v173
    v_pk_mul_f32 v[194:195], v[172:173], v[186:187] op_sel:[0,0] op_sel_hi:[0,1]
    v_pk_fma_f32 v[174:175], v[172:173], v[186:187], v[194:195] op_sel:[1,1,0] op_sel_hi:[1,0,1] neg_lo:[0,1,0]
    v_cvt_pk_bf16_f32 v247, v174, v175
    v_pk_mul_f32 v[194:195], v[174:175], v[186:187] op_sel:[0,0] op_sel_hi:[0,1]
    v_pk_fma_f32 v[172:173], v[174:175], v[186:187], v[194:195] op_sel:[1,1,0] op_sel_hi:[1,0,1] neg_lo:[0,1,0]
    v_cvt_pk_bf16_f32 v248, v172, v173
    v_pk_mul_f32 v[194:195], v[172:173], v[186:187] op_sel:[0,0] op_sel_hi:[0,1]
    v_pk_fma_f32 v[174:175], v[172:173], v[186:187], v[194:195] op_sel:[1,1,0] op_sel_hi:[1,0,1] neg_lo:[0,1,0]
    v_cvt_pk_bf16_f32 v249, v174, v175
    v_pk_mul_f32 v[194:195], v[174:175], v[186:187] op_sel:[0,0] op_sel_hi:[0,1]
    v_pk_fma_f32 v[172:173], v[174:175], v[186:187], v[194:195] op_sel:[1,1,0] op_sel_hi:[1,0,1] neg_lo:[0,1,0]
    v_cvt_pk_bf16_f32 v250, v172, v173
    v_pk_mul_f32 v[194:195], v[172:173], v[186:187] op_sel:[0,0] op_sel_hi:[0,1]
    v_pk_fma_f32 v[174:175], v[172:173], v[186:187], v[194:195] op_sel:[1,1,0] op_sel_hi:[1,0,1] neg_lo:[0,1,0]
    v_cvt_pk_bf16_f32 v251, v174, v175
    ds_write_addtid_b32 v242 offset:2720
    ds_write_addtid_b32 v243 offset:2992
    ds_write_addtid_b32 v244 offset:3264
    s_waitcnt vmcnt(1)
    s_barrier
    ds_read_b64_tr_b16 v[96:97], v111
    ds_read_b64_tr_b16 v[98:99], v111 offset:2560
    ds_read_b64_tr_b16 v[100:101], v112
    ds_read_b64_tr_b16 v[102:103], v112 offset:2560
    ds_read_b64_tr_b16 v[104:105], v113
    ds_read_b64_tr_b16 v[106:107], v113 offset:2560
    s_waitcnt lgkmcnt(4)
    buffer_store_dwordx4 v[96:99], v108, s[16:19], 0 offen sc1
    s_waitcnt lgkmcnt(2)
    buffer_store_dwordx4 v[100:103], v109, s[16:19], 0 offen sc1
    s_waitcnt lgkmcnt(0)
    s_nop 0
    buffer_store_dwordx4 v[104:107], v110, s[16:19], 0 offen sc1
    global_load_dword v7, v5, s[66:67] sc1
    ds_write_addtid_b32 v245 offset:3536
    ds_write_addtid_b32 v246 offset:3808
    ds_write_addtid_b32 v247 offset:4080
    ds_write_addtid_b32 v248 offset:4352
    ds_write_addtid_b32 v249 offset:4624
    ds_write_addtid_b32 v250 offset:4896
    ds_write_addtid_b32 v251 offset:5168
    v_pk_mul_f32 v[194:195], v[174:175], v[186:187] op_sel:[0,0] op_sel_hi:[0,1]
    v_pk_fma_f32 v[172:173], v[174:175], v[186:187], v[194:195] op_sel:[1,1,0] op_sel_hi:[1,0,1] neg_lo:[0,1,0]
    v_cvt_pk_bf16_f32 v242, v172, v173
    v_pk_mul_f32 v[194:195], v[172:173], v[186:187] op_sel:[0,0] op_sel_hi:[0,1]
    v_pk_fma_f32 v[174:175], v[172:173], v[186:187], v[194:195] op_sel:[1,1,0] op_sel_hi:[1,0,1] neg_lo:[0,1,0]
    v_cvt_pk_bf16_f32 v243, v174, v175
    v_pk_mul_f32 v[194:195], v[174:175], v[186:187] op_sel:[0,0] op_sel_hi:[0,1]
    v_pk_fma_f32 v[172:173], v[174:175], v[186:187], v[194:195] op_sel:[1,1,0] op_sel_hi:[1,0,1] neg_lo:[0,1,0]
    v_cvt_pk_bf16_f32 v244, v172, v173
    v_pk_mul_f32 v[194:195], v[172:173], v[186:187] op_sel:[0,0] op_sel_hi:[0,1]
    v_pk_fma_f32 v[174:175], v[172:173], v[186:187], v[194:195] op_sel:[1,1,0] op_sel_hi:[1,0,1] neg_lo:[0,1,0]
    v_cvt_pk_bf16_f32 v245, v174, v175
    v_pk_mul_f32 v[194:195], v[174:175], v[186:187] op_sel:[0,0] op_sel_hi:[0,1]
    v_pk_fma_f32 v[172:173], v[174:175], v[186:187], v[194:195] op_sel:[1,1,0] op_sel_hi:[1,0,1] neg_lo:[0,1,0]
    v_cvt_pk_bf16_f32 v246, v172, v173
    v_pk_mul_f32 v[194:195], v[172:173], v[186:187] op_sel:[0,0] op_sel_hi:[0,1]
    v_pk_fma_f32 v[174:175], v[172:173], v[186:187], v[194:195] op_sel:[1,1,0] op_sel_hi:[1,0,1] neg_lo:[0,1,0]
    v_cvt_pk_bf16_f32 v247, v174, v175
    v_pk_mul_f32 v[194:195], v[174:175], v[186:187] op_sel:[0,0] op_sel_hi:[0,1]
    v_pk_fma_f32 v[172:173], v[174:175], v[186:187], v[194:195] op_sel:[1,1,0] op_sel_hi:[1,0,1] neg_lo:[0,1,0]
    v_cvt_pk_bf16_f32 v248, v172, v173
    v_pk_mul_f32 v[194:195], v[172:173], v[186:187] op_sel:[0,0] op_sel_hi:[0,1]
    v_pk_fma_f32 v[174:175], v[172:173], v[186:187], v[194:195] op_sel:[1,1,0] op_sel_hi:[1,0,1] neg_lo:[0,1,0]
    v_cvt_pk_bf16_f32 v249, v174, v175
    v_pk_mul_f32 v[194:195], v[174:175], v[186:187] op_sel:[0,0] op_sel_hi:[0,1]
    v_pk_fma_f32 v[172:173], v[174:175], v[186:187], v[194:195] op_sel:[1,1,0] op_sel_hi:[1,0,1] neg_lo:[0,1,0]
    v_cvt_pk_bf16_f32 v250, v172, v173
    v_pk_mul_f32 v[194:195], v[172:173], v[186:187] op_sel:[0,0] op_sel_hi:[0,1]
    v_pk_fma_f32 v[174:175], v[172:173], v[186:187], v[194:195] op_sel:[1,1,0] op_sel_hi:[1,0,1] neg_lo:[0,1,0]
    s_min_u32 s96, s75, 159
    s_lshl_b32 s96, s96, 2
    s_add_u32 s96, s96, s24
    s_mul_i32 s97, s96, 384
    s_lshl_b32 s96, s96, 1
    v_lshl_add_u32 v2, v1, 1, s97
    v_mov_b32 v241, s96
    global_load_ushort v236, v2, s[52:53] offset:256
    global_load_ushort v237, v2, s[54:55] offset:256
    global_load_ushort v238, v2, s[56:57] offset:256
    global_load_ushort v239, v2, s[58:59] offset:256
    global_load_ushort v241, v241, s[62:63]
    v_cvt_pk_bf16_f32 v251, v174, v175
    ds_write_addtid_b32 v242 offset:5440
    ds_write_addtid_b32 v243 offset:5712
    ds_write_addtid_b32 v244 offset:5984
    ds_write_addtid_b32 v245 offset:6256
    ds_write_addtid_b32 v246 offset:6528
    ds_write_addtid_b32 v247 offset:6800
    ds_write_addtid_b32 v248 offset:7072
    ds_write_addtid_b32 v249 offset:7344
    ds_write_addtid_b32 v250 offset:7616
    ds_write_addtid_b32 v251 offset:7888
    v_pk_mul_f32 v[194:195], v[174:175], v[186:187] op_sel:[0,0] op_sel_hi:[0,1]
    v_pk_fma_f32 v[172:173], v[174:175], v[186:187], v[194:195] op_sel:[1,1,0] op_sel_hi:[1,0,1] neg_lo:[0,1,0]
    v_cvt_pk_bf16_f32 v242, v172, v173
    v_pk_mul_f32 v[194:195], v[172:173], v[186:187] op_sel:[0,0] op_sel_hi:[0,1]
    v_pk_fma_f32 v[174:175], v[172:173], v[186:187], v[194:195] op_sel:[1,1,0] op_sel_hi:[1,0,1] neg_lo:[0,1,0]
    v_cvt_pk_bf16_f32 v243, v174, v175
    ds_write_addtid_b32 v242 offset:8160
    ds_write_addtid_b32 v243 offset:8432
    ds_read_b128 a[160:163], v252 offset:0
    ds_read_b128 a[164:167], v252 offset:32
    ds_read_b128 a[168:171], v252 offset:64
    ds_read_b128 a[172:175], v252 offset:96
    ds_read_b128 a[176:179], v252 offset:128
    ds_read_b128 a[180:183], v252 offset:160
    ds_read_b128 a[184:187], v252 offset:192
    ds_read_b128 a[188:191], v252 offset:224
    v_pk_mul_f32 v[194:195], v[180:181], v[180:181] op_sel:[0,0] op_sel_hi:[0,1]
    v_pk_fma_f32 v[182:183], v[180:181], v[180:181], v[194:195] op_sel:[1,1,0] op_sel_hi:[1,0,1] neg_lo:[0,1,0]
    v_pk_mul_f32 v[194:195], v[182:183], v[182:183] op_sel:[0,0] op_sel_hi:[0,1]
    v_pk_fma_f32 v[184:185], v[182:183], v[182:183], v[194:195] op_sel:[1,1,0] op_sel_hi:[1,0,1] neg_lo:[0,1,0]
    v_cvt_pk_bf16_f32 v242, v192, -v193
    v_pk_mul_f32 v[194:195], v[192:193], v[180:181] op_sel:[0,0] op_sel_hi:[0,1]
    v_pk_fma_f32 v[174:175], v[192:193], v[180:181], v[194:195] op_sel:[1,1,0] op_sel_hi:[1,0,1] neg_lo:[0,1,0]
    v_cvt_pk_bf16_f32 v243, v174, -v175
    v_pk_mul_f32 v[194:195], v[174:175], v[180:181] op_sel:[0,0] op_sel_hi:[0,1]
    v_lshrrev_b32 v132, 5, v0
    v_and_b32 v133, 31, v0
    v_mul_u32_u24 v132, 1280, v132
    v_lshl_add_u32 v134, v133, 4, v132
    v_mov_b32 v135, 1073741824
    v_cmp_gt_u32 vcc, 16, v133
    s_mul_i32 s96, s2, 10240
    buffer_load_dwordx4 v[120:123], v134, s[4:7], s96 offen
    v_cndmask_b32_e64 v135, v135, v134, vcc
    buffer_load_dwordx4 v[124:127], v134, s[4:7], s96 offen offset:512
    buffer_load_dwordx4 v[128:131], v135, s[4:7], s96 offen offset:1024
    v_pk_fma_f32 v[172:173], v[174:175], v[180:181], v[194:195] op_sel:[1,1,0] op_sel_hi:[1,0,1] neg_lo:[0,1,0]
    v_cvt_pk_bf16_f32 v244, v172, -v173
    v_pk_mul_f32 v[194:195], v[172:173], v[180:181] op_sel:[0,0] op_sel_hi:[0,1]
    v_pk_fma_f32 v[174:175], v[172:173], v[180:181], v[194:195] op_sel:[1,1,0] op_sel_hi:[1,0,1] neg_lo:[0,1,0]
    v_cvt_pk_bf16_f32 v245, v174, -v175
    v_pk_mul_f32 v[194:195], v[174:175], v[180:181] op_sel:[0,0] op_sel_hi:[0,1]
    v_pk_fma_f32 v[172:173], v[174:175], v[180:181], v[194:195] op_sel:[1,1,0] op_sel_hi:[1,0,1] neg_lo:[0,1,0]
    v_cvt_pk_bf16_f32 v246, v172, -v173
    v_pk_mul_f32 v[194:195], v[172:173], v[180:181] op_sel:[0,0] op_sel_hi:[0,1]
    v_pk_fma_f32 v[174:175], v[172:173], v[180:181], v[194:195] op_sel:[1,1,0] op_sel_hi:[1,0,1] neg_lo:[0,1,0]
    v_cvt_pk_bf16_f32 v247, v174, -v175
    v_pk_mul_f32 v[194:195], v[174:175], v[180:181] op_sel:[0,0] op_sel_hi:[0,1]
    v_pk_fma_f32 v[172:173], v[174:175], v[180:181], v[194:195] op_sel:[1,1,0] op_sel_hi:[1,0,1] neg_lo:[0,1,0]
    v_cvt_pk_bf16_f32 v248, v172, -v173
    v_pk_mul_f32 v[194:195], v[172:173], v[180:181] op_sel:[0,0] op_sel_hi:[0,1]
    v_pk_fma_f32 v[174:175], v[172:173], v[180:181], v[194:195] op_sel:[1,1,0] op_sel_hi:[1,0,1] neg_lo:[0,1,0]
    v_cvt_pk_bf16_f32 v249, v174, -v175
    v_pk_mul_f32 v[194:195], v[192:193], v[190:191] op_sel:[0,0] op_sel_hi:[0,1]
    v_pk_fma_f32 v[176:177], v[192:193], v[190:191], v[194:195] op_sel:[1,1,0] op_sel_hi:[1,0,1] neg_lo:[0,1,0]
    v_cvt_pk_bf16_f32 v250, v176, -v177
    v_pk_mul_f32 v[194:195], v[176:177], v[182:183] op_sel:[0,0] op_sel_hi:[0,1]
    v_pk_fma_f32 v[174:175], v[176:177], v[182:183], v[194:195] op_sel:[1,1,0] op_sel_hi:[1,0,1] neg_lo:[0,1,0]
    v_cvt_pk_bf16_f32 v251, v174, -v175
    ds_write_addtid_b32 v242 offset:0
    ds_write_addtid_b32 v243 offset:272
    ds_write_addtid_b32 v244 offset:544
    ds_write_addtid_b32 v245 offset:816
    ds_write_addtid_b32 v246 offset:1088
    ds_write_addtid_b32 v247 offset:1360
    ds_write_addtid_b32 v248 offset:1632
    ds_write_addtid_b32 v249 offset:1904
    ds_write_addtid_b32 v250 offset:2176
    ds_write_addtid_b32 v251 offset:2448
    v_pk_mul_f32 v[194:195], v[174:175], v[182:183] op_sel:[0,0] op_sel_hi:[0,1]
    v_pk_fma_f32 v[172:173], v[174:175], v[182:183], v[194:195] op_sel:[1,1,0] op_sel_hi:[1,0,1] neg_lo:[0,1,0]
    v_cvt_pk_bf16_f32 v242, v172, -v173
    v_mov_b32 v140, 1073741824
    v_lshlrev_b32 v141, 2, v0
    v_cmp_gt_u32 vcc, 64, v0
    s_nop 1
    v_cndmask_b32 v141, v140, v141, vcc
    v_mov_b32_e64 v140, 0
    s_lshl_b32 s97, s2, 8
    s_add_u32 s97, s97, 3473408
    buffer_store_dword v140, v141, s[16:19], s97 offen sc1
    v_pk_mul_f32 v[194:195], v[172:173], v[182:183] op_sel:[0,0] op_sel_hi:[0,1]
    v_pk_fma_f32 v[174:175], v[172:173], v[182:183], v[194:195] op_sel:[1,1,0] op_sel_hi:[1,0,1] neg_lo:[0,1,0]
    v_cvt_pk_bf16_f32 v243, v174, -v175
    v_pk_mul_f32 v[194:195], v[174:175], v[182:183] op_sel:[0,0] op_sel_hi:[0,1]
    v_pk_fma_f32 v[172:173], v[174:175], v[182:183], v[194:195] op_sel:[1,1,0] op_sel_hi:[1,0,1] neg_lo:[0,1,0]
    v_cvt_pk_bf16_f32 v244, v172, -v173
    v_pk_mul_f32 v[194:195], v[176:177], v[190:191] op_sel:[0,0] op_sel_hi:[0,1]
    v_pk_fma_f32 v[178:179], v[176:177], v[190:191], v[194:195] op_sel:[1,1,0] op_sel_hi:[1,0,1] neg_lo:[0,1,0]
    v_cvt_pk_bf16_f32 v245, v178, -v179
    v_pk_mul_f32 v[194:195], v[178:179], v[184:185] op_sel:[0,0] op_sel_hi:[0,1]
    v_pk_fma_f32 v[174:175], v[178:179], v[184:185], v[194:195] op_sel:[1,1,0] op_sel_hi:[1,0,1] neg_lo:[0,1,0]
    v_cvt_pk_bf16_f32 v246, v174, -v175
    v_pk_mul_f32 v[194:195], v[174:175], v[184:185] op_sel:[0,0] op_sel_hi:[0,1]
    v_pk_fma_f32 v[172:173], v[174:175], v[184:185], v[194:195] op_sel:[1,1,0] op_sel_hi:[1,0,1] neg_lo:[0,1,0]
    v_cvt_pk_bf16_f32 v247, v172, -v173
    v_pk_mul_f32 v[194:195], v[178:179], v[190:191] op_sel:[0,0] op_sel_hi:[0,1]
    v_pk_fma_f32 v[176:177], v[178:179], v[190:191], v[194:195] op_sel:[1,1,0] op_sel_hi:[1,0,1] neg_lo:[0,1,0]
    v_cvt_pk_bf16_f32 v248, v176, -v177
    v_pk_mul_f32 v[194:195], v[176:177], v[184:185] op_sel:[0,0] op_sel_hi:[0,1]
    v_pk_fma_f32 v[174:175], v[176:177], v[184:185], v[194:195] op_sel:[1,1,0] op_sel_hi:[1,0,1] neg_lo:[0,1,0]
    v_cvt_pk_bf16_f32 v249, v174, -v175
    v_pk_mul_f32 v[194:195], v[174:175], v[184:185] op_sel:[0,0] op_sel_hi:[0,1]
    v_pk_fma_f32 v[172:173], v[174:175], v[184:185], v[194:195] op_sel:[1,1,0] op_sel_hi:[1,0,1] neg_lo:[0,1,0]
    v_cvt_pk_bf16_f32 v250, v172, -v173
    v_pk_mul_f32 v[194:195], v[176:177], v[190:191] op_sel:[0,0] op_sel_hi:[0,1]
    v_pk_fma_f32 v[178:179], v[176:177], v[190:191], v[194:195] op_sel:[1,1,0] op_sel_hi:[1,0,1] neg_lo:[0,1,0]
    v_cvt_pk_bf16_f32 v251, v178, -v179
    ds_write_addtid_b32 v242 offset:2720
    ds_write_addtid_b32 v242 offset:3264
    ds_write_addtid_b32 v243 offset:3536
    ds_write_addtid_b32 v244 offset:3808
    ds_write_addtid_b32 v245 offset:4352
    ds_write_addtid_b32 v246 offset:4624
    ds_write_addtid_b32 v247 offset:4896
    ds_write_addtid_b32 v248 offset:5440
    ds_write_addtid_b32 v249 offset:5712
    v_mov_b32 v142, 1073741824
    v_lshlrev_b32 v143, 2, v0
    v_cmp_gt_u32 vcc, 16, v0
    s_nop 1
    v_cndmask_b32 v143, v142, v143, vcc
    v_mov_b32_e64 v142, -1
    s_lshl_b32 s97, s2, 6
    s_add_u32 s97, s97, 3457024
    buffer_store_dword v142, v143, s[16:19], s97 offen sc1
    ds_write_addtid_b32 v250 offset:5984
    ds_write_addtid_b32 v251 offset:6528
    v_pk_mul_f32 v[194:195], v[178:179], v[186:187] op_sel:[0,0] op_sel_hi:[0,1]
    v_pk_fma_f32 v[174:175], v[178:179], v[186:187], v[194:195] op_sel:[1,1,0] op_sel_hi:[1,0,1] neg_lo:[0,1,0]
    v_cvt_pk_bf16_f32 v242, v174, -v175
    v_pk_mul_f32 v[194:195], v[178:179], v[190:191] op_sel:[0,0] op_sel_hi:[0,1]
    v_pk_fma_f32 v[176:177], v[178:179], v[190:191], v[194:195] op_sel:[1,1,0] op_sel_hi:[1,0,1] neg_lo:[0,1,0]
    v_cvt_pk_bf16_f32 v243, v176, -v177
    v_pk_mul_f32 v[194:195], v[176:177], v[186:187] op_sel:[0,0] op_sel_hi:[0,1]
    v_pk_fma_f32 v[174:175], v[176:177], v[186:187], v[194:195] op_sel:[1,1,0] op_sel_hi:[1,0,1] neg_lo:[0,1,0]
    v_cvt_pk_bf16_f32 v244, v174, -v175
    v_pk_mul_f32 v[194:195], v[176:177], v[190:191] op_sel:[0,0] op_sel_hi:[0,1]
    v_pk_fma_f32 v[178:179], v[176:177], v[190:191], v[194:195] op_sel:[1,1,0] op_sel_hi:[1,0,1] neg_lo:[0,1,0]
    v_cvt_pk_bf16_f32 v245, v178, -v179
    v_pk_mul_f32 v[194:195], v[178:179], v[186:187] op_sel:[0,0] op_sel_hi:[0,1]
    v_pk_fma_f32 v[174:175], v[178:179], v[186:187], v[194:195] op_sel:[1,1,0] op_sel_hi:[1,0,1] neg_lo:[0,1,0]
    v_cvt_pk_bf16_f32 v246, v174, -v175
    v_pk_mul_f32 v[194:195], v[178:179], v[190:191] op_sel:[0,0] op_sel_hi:[0,1]
    v_pk_fma_f32 v[176:177], v[178:179], v[190:191], v[194:195] op_sel:[1,1,0] op_sel_hi:[1,0,1] neg_lo:[0,1,0]
    v_cvt_pk_bf16_f32 v247, v176, -v177
    v_pk_mul_f32 v[194:195], v[176:177], v[186:187] op_sel:[0,0] op_sel_hi:[0,1]
    v_pk_fma_f32 v[174:175], v[176:177], v[186:187], v[194:195] op_sel:[1,1,0] op_sel_hi:[1,0,1] neg_lo:[0,1,0]
    v_cvt_pk_bf16_f32 v248, v174, -v175
    ds_write_addtid_b32 v242 offset:6800
    ds_write_addtid_b32 v243 offset:7072
    ds_write_addtid_b32 v244 offset:7344
    ds_write_addtid_b32 v245 offset:7616
    ds_write_addtid_b32 v246 offset:7888
    ds_write_addtid_b32 v247 offset:8160
    ds_write_addtid_b32 v248 offset:8432
    ds_read_b128 a[192:195], v252 offset:0
    ds_read_b128 a[196:199], v252 offset:32
    ds_read_b128 a[200:203], v252 offset:64
    ds_read_b128 a[204:207], v252 offset:96
    ds_read_b128 a[208:211], v252 offset:128
    ds_read_b128 a[212:215], v252 offset:160
    s_waitcnt vmcnt(11)
    s_waitcnt vmcnt(10)
    v_cmp_gt_u32 vcc, 1, v7
    s_nop 0
    s_and_b64 vcc, vcc, s[50:51]
    s_and_b64 vcc, vcc, 1
    s_cbranch_scc1 ps_4
pc_6:
    s_barrier
    v_lshlrev_b32 v2, 3, v4
    v_mov_b32 v5, 1
    v_cndmask_b32 v2, v4, v2, s[50:51]
    buffer_atomic_add v5, v2, s[16:19], s86 offen offset:0 sc1
    ds_read_b128 a[216:219], v252 offset:192
    ds_read_b128 a[220:223], v252 offset:224
    v_and_b32 v199, 0xffff0000, v232
    v_mul_f32 v199, 0x3fb8aa3b, v199
    v_exp_f32 v199, v199
    v_and_b32 v255, 0xffff0000, v233
    v_mul_f32 v255, v255, v253
    v_mul_f32 v255, 0x3e22f983, v255
    v_cvt_pk_bf16_f32 v199, v199, v199
    v_lshlrev_b32 v199, 16, v199
    v_mul_f32 v254, v199, v253
    v_mul_f32 v254, 0xbfb8aa3b, v254
    s_waitcnt lgkmcnt(7)
    v_mfma_f32_32x32x16_bf16 v[216:231], a[192:195], a[160:163], 0
    v_mul_f32 v182, 0x41000000, v254
    v_mul_f32 v185, 0x41000000, v255
    v_mul_f32 v184, 0x43800000, v254
    v_mul_f32 v189, 0x43800000, v255
    s_waitcnt lgkmcnt(6)
    v_mfma_f32_32x32x16_bf16 v[216:231], a[196:199], a[164:167], v[216:231]
    v_fract_f32 v185, v185
    v_fract_f32 v188, v255
    v_fract_f32 v189, v189
    v_exp_f32 v182, v182
    s_waitcnt lgkmcnt(5)
    v_mfma_f32_32x32x16_bf16 v[216:231], a[200:203], a[168:171], v[216:231]
    v_exp_f32 v183, v254
    v_exp_f32 v184, v184
    v_cos_f32 v186, v185
    v_sin_f32 v187, v185
    s_waitcnt lgkmcnt(4)
    v_mfma_f32_32x32x16_bf16 v[216:231], a[204:207], a[172:175], v[216:231]
    v_cos_f32 v180, v188
    v_sin_f32 v181, v188
    v_cos_f32 v190, v189
    v_sin_f32 v191, v189
    s_waitcnt lgkmcnt(3)
    v_mfma_f32_32x32x16_bf16 v[216:231], a[208:211], a[176:179], v[216:231]
    v_and_b32 v192, 0xffff0000, v234
    v_and_b32 v193, 0xffff0000, v235
    v_add_f32 v199, v253, v253
    v_mul_f32 v192, v192, v199
    s_waitcnt lgkmcnt(2)
    v_mfma_f32_32x32x16_bf16 v[216:231], a[212:215], a[180:183], v[216:231]
    v_mul_f32 v193, v193, v199
    v_mul_f32 v186, v186, v182
    v_mul_f32 v187, v187, v182
    v_mul_f32 v180, v180, v183
    s_waitcnt lgkmcnt(1)
    v_mfma_f32_32x32x16_bf16 v[216:231], a[216:219], a[184:187], v[216:231]
    v_mul_f32 v181, v181, v183
    v_mul_f32 v190, v190, v184
    v_mul_f32 v191, v191, v184
    s_waitcnt lgkmcnt(0)
    v_mfma_f32_32x32x16_bf16 v[216:231], a[220:223], a[188:191], v[216:231]
    v_mov_b32 v242, 0x3f80
    v_cvt_pk_bf16_f32 v243, v186, v187
    v_pk_mul_f32 v[194:195], v[186:187], v[186:187] op_sel:[0,0] op_sel_hi:[0,1]
    v_mov_b32 v144, -1
    v_mov_b32 v145, -1
    v_mov_b32 v146, -1
    v_mov_b32 v147, -1
    v_lshlrev_b32 v148, 4, v0
    s_sub_u32 s88, s2, 0
    s_mul_i32 s88, s88, 20480
    s_min_u32 s88, s88, 5222400
    s_add_u32 s88, s88, 4194304
    buffer_store_dwordx4 v[144:147], v148, s[16:19], s88 offen sc1
    v_pk_fma_f32 v[172:173], v[186:187], v[186:187], v[194:195] op_sel:[1,1,0] op_sel_hi:[1,0,1] neg_lo:[0,1,0]
    v_cvt_pk_bf16_f32 v244, v172, v173
    v_pk_mul_f32 v[194:195], v[172:173], v[186:187] op_sel:[0,0] op_sel_hi:[0,1]
    v_pk_fma_f32 v[174:175], v[172:173], v[186:187], v[194:195] op_sel:[1,1,0] op_sel_hi:[1,0,1] neg_lo:[0,1,0]
    v_cvt_pk_bf16_f32 v245, v174, v175
    v_pk_mul_f32 v[194:195], v[174:175], v[186:187] op_sel:[0,0] op_sel_hi:[0,1]
    v_pk_fma_f32 v[172:173], v[174:175], v[186:187], v[194:195] op_sel:[1,1,0] op_sel_hi:[1,0,1] neg_lo:[0,1,0]
    v_cvt_pk_bf16_f32 v246, v172, v173
    v_pk_mul_f32 v[194:195], v[172:173], v[186:187] op_sel:[0,0] op_sel_hi:[0,1]
    v_pk_fma_f32 v[174:175], v[172:173], v[186:187], v[194:195] op_sel:[1,1,0] op_sel_hi:[1,0,1] neg_lo:[0,1,0]
    v_cvt_pk_bf16_f32 v247, v174, v175
    v_pk_mul_f32 v[194:195], v[174:175], v[186:187] op_sel:[0,0] op_sel_hi:[0,1]
    v_pk_fma_f32 v[172:173], v[174:175], v[186:187], v[194:195] op_sel:[1,1,0] op_sel_hi:[1,0,1] neg_lo:[0,1,0]
    v_cvt_pk_bf16_f32 v248, v172, v173
    v_pk_mul_f32 v[194:195], v[172:173], v[186:187] op_sel:[0,0] op_sel_hi:[0,1]
    v_pk_fma_f32 v[174:175], v[172:173], v[186:187], v[194:195] op_sel:[1,1,0] op_sel_hi:[1,0,1] neg_lo:[0,1,0]
    v_cvt_pk_bf16_f32 v249, v174, v175
    v_pk_mul_f32 v[194:195], v[174:175], v[186:187] op_sel:[0,0] op_sel_hi:[0,1]
    v_pk_fma_f32 v[172:173], v[174:175], v[186:187], v[194:195] op_sel:[1,1,0] op_sel_hi:[1,0,1] neg_lo:[0,1,0]
    v_cvt_pk_bf16_f32 v250, v172, v173
    v_pk_mul_f32 v[194:195], v[172:173], v[186:187] op_sel:[0,0] op_sel_hi:[0,1]
    v_pk_fma_f32 v[174:175], v[172:173], v[186:187], v[194:195] op_sel:[1,1,0] op_sel_hi:[1,0,1] neg_lo:[0,1,0]
    v_cvt_pk_bf16_f32 v251, v174, v175
    ds_write_addtid_b32 v242 offset:0
    ds_write_addtid_b32 v243 offset:272
    ds_write_addtid_b32 v244 offset:544
    ds_write_addtid_b32 v245 offset:816
    ds_write_addtid_b32 v246 offset:1088
    ds_write_addtid_b32 v247 offset:1360
    ds_write_addtid_b32 v248 offset:1632
    ds_write_addtid_b32 v249 offset:1904
    ds_write_addtid_b32 v250 offset:2176
    ds_write_addtid_b32 v251 offset:2448
    v_pk_mul_f32 v[194:195], v[174:175], v[186:187] op_sel:[0,0] op_sel_hi:[0,1]
    v_pk_fma_f32 v[172:173], v[174:175], v[186:187], v[194:195] op_sel:[1,1,0] op_sel_hi:[1,0,1] neg_lo:[0,1,0]
    v_cvt_pk_bf16_f32 v242, v172, v173
    v_pk_mul_f32 v[194:195], v[172:173], v[186:187] op_sel:[0,0] op_sel_hi:[0,1]
    v_pk_fma_f32 v[174:175], v[172:173], v[186:187], v[194:195] op_sel:[1,1,0] op_sel_hi:[1,0,1] neg_lo:[0,1,0]
    v_cvt_pk_bf16_f32 v243, v174, v175
    v_pk_mul_f32 v[194:195], v[174:175], v[186:187] op_sel:[0,0] op_sel_hi:[0,1]
    v_pk_fma_f32 v[172:173], v[174:175], v[186:187], v[194:195] op_sel:[1,1,0] op_sel_hi:[1,0,1] neg_lo:[0,1,0]
    v_cvt_pk_bf16_f32 v244, v172, v173
    v_pk_mul_f32 v[194:195], v[172:173], v[186:187] op_sel:[0,0] op_sel_hi:[0,1]
    v_pk_fma_f32 v[174:175], v[172:173], v[186:187], v[194:195] op_sel:[1,1,0] op_sel_hi:[1,0,1] neg_lo:[0,1,0]
    v_cvt_pk_bf16_f32 v245, v174, v175
    v_pk_mul_f32 v[194:195], v[174:175], v[186:187] op_sel:[0,0] op_sel_hi:[0,1]
    v_pk_fma_f32 v[172:173], v[174:175], v[186:187], v[194:195] op_sel:[1,1,0] op_sel_hi:[1,0,1] neg_lo:[0,1,0]
    v_cvt_pk_bf16_f32 v246, v172, v173
    v_pk_mul_f32 v[194:195], v[172:173], v[186:187] op_sel:[0,0] op_sel_hi:[0,1]
    v_pk_fma_f32 v[174:175], v[172:173], v[186:187], v[194:195] op_sel:[1,1,0] op_sel_hi:[1,0,1] neg_lo:[0,1,0]
    s_add_u32 s88, s88, 4096
    buffer_store_dwordx4 v[144:147], v148, s[16:19], s88 offen sc1
    v_cvt_pk_bf16_f32 v247, v174, v175
    v_pk_mul_f32 v[194:195], v[174:175], v[186:187] op_sel:[0,0] op_sel_hi:[0,1]
    v_pk_fma_f32 v[172:173], v[174:175], v[186:187], v[194:195] op_sel:[1,1,0] op_sel_hi:[1,0,1] neg_lo:[0,1,0]
    v_cvt_pk_bf16_f32 v248, v172, v173
    v_pk_mul_f32 v[194:195], v[172:173], v[186:187] op_sel:[0,0] op_sel_hi:[0,1]
    v_pk_fma_f32 v[174:175], v[172:173], v[186:187], v[194:195] op_sel:[1,1,0] op_sel_hi:[1,0,1] neg_lo:[0,1,0]
    v_cvt_pk_bf16_f32 v249, v174, v175
    v_pk_mul_f32 v[194:195], v[174:175], v[186:187] op_sel:[0,0] op_sel_hi:[0,1]
    v_pk_fma_f32 v[172:173], v[174:175], v[186:187], v[194:195] op_sel:[1,1,0] op_sel_hi:[1,0,1] neg_lo:[0,1,0]
    v_cvt_pk_bf16_f32 v250, v172, v173
    v_pk_mul_f32 v[194:195], v[172:173], v[186:187] op_sel:[0,0] op_sel_hi:[0,1]
    v_pk_fma_f32 v[174:175], v[172:173], v[186:187], v[194:195] op_sel:[1,1,0] op_sel_hi:[1,0,1] neg_lo:[0,1,0]
    v_cvt_pk_bf16_f32 v251, v174, v175
    ds_write_addtid_b32 v242 offset:2720
    ds_write_addtid_b32 v243 offset:2992
    ds_write_addtid_b32 v244 offset:3264
    ds_write_addtid_b32 v245 offset:3536
    ds_write_addtid_b32 v246 offset:3808
    ds_write_addtid_b32 v247 offset:4080
    ds_write_addtid_b32 v248 offset:4352
    ds_write_addtid_b32 v249 offset:4624
    ds_write_addtid_b32 v250 offset:4896
    ds_write_addtid_b32 v251 offset:5168
    v_pk_mul_f32 v[194:195], v[174:175], v[186:187] op_sel:[0,0] op_sel_hi:[0,1]
    v_pk_fma_f32 v[172:173], v[174:175], v[186:187], v[194:195] op_sel:[1,1,0] op_sel_hi:[1,0,1] neg_lo:[0,1,0]
    v_cvt_pk_bf16_f32 v242, v172, v173
    v_pk_mul_f32 v[194:195], v[172:173], v[186:187] op_sel:[0,0] op_sel_hi:[0,1]
    v_pk_fma_f32 v[174:175], v[172:173], v[186:187], v[194:195] op_sel:[1,1,0] op_sel_hi:[1,0,1] neg_lo:[0,1,0]
    v_cvt_pk_bf16_f32 v243, v174, v175
    v_pk_mul_f32 v[194:195], v[174:175], v[186:187] op_sel:[0,0] op_sel_hi:[0,1]
    v_pk_fma_f32 v[172:173], v[174:175], v[186:187], v[194:195] op_sel:[1,1,0] op_sel_hi:[1,0,1] neg_lo:[0,1,0]
    v_cvt_pk_bf16_f32 v244, v172, v173
    v_pk_mul_f32 v[194:195], v[172:173], v[186:187] op_sel:[0,0] op_sel_hi:[0,1]
    v_pk_fma_f32 v[174:175], v[172:173], v[186:187], v[194:195] op_sel:[1,1,0] op_sel_hi:[1,0,1] neg_lo:[0,1,0]
    v_cvt_pk_bf16_f32 v245, v174, v175
    v_pk_mul_f32 v[194:195], v[174:175], v[186:187] op_sel:[0,0] op_sel_hi:[0,1]
    v_pk_fma_f32 v[172:173], v[174:175], v[186:187], v[194:195] op_sel:[1,1,0] op_sel_hi:[1,0,1] neg_lo:[0,1,0]
    v_cvt_pk_bf16_f32 v246, v172, v173
    v_pk_mul_f32 v[194:195], v[172:173], v[186:187] op_sel:[0,0] op_sel_hi:[0,1]
    v_pk_fma_f32 v[174:175], v[172:173], v[186:187], v[194:195] op_sel:[1,1,0] op_sel_hi:[1,0,1] neg_lo:[0,1,0]
    v_cvt_pk_bf16_f32 v247, v174, v175
    v_pk_mul_f32 v[194:195], v[174:175], v[186:187] op_sel:[0,0] op_sel_hi:[0,1]
    v_pk_fma_f32 v[172:173], v[174:175], v[186:187], v[194:195] op_sel:[1,1,0] op_sel_hi:[1,0,1] neg_lo:[0,1,0]
    v_cvt_pk_bf16_f32 v248, v172, v173
    v_pk_mul_f32 v[194:195], v[172:173], v[186:187] op_sel:[0,0] op_sel_hi:[0,1]
    v_pk_fma_f32 v[174:175], v[172:173], v[186:187], v[194:195] op_sel:[1,1,0] op_sel_hi:[1,0,1] neg_lo:[0,1,0]
    v_cvt_pk_bf16_f32 v249, v174, v175
    v_pk_mul_f32 v[194:195], v[174:175], v[186:187] op_sel:[0,0] op_sel_hi:[0,1]
    v_pk_fma_f32 v[172:173], v[174:175], v[186:187], v[194:195] op_sel:[1,1,0] op_sel_hi:[1,0,1] neg_lo:[0,1,0]
    v_cvt_pk_bf16_f32 v250, v172, v173
    s_add_u32 s88, s88, 4096
    buffer_store_dwordx4 v[144:147], v148, s[16:19], s88 offen sc1
    v_pk_mul_f32 v[194:195], v[172:173], v[186:187] op_sel:[0,0] op_sel_hi:[0,1]
    v_pk_fma_f32 v[174:175], v[172:173], v[186:187], v[194:195] op_sel:[1,1,0] op_sel_hi:[1,0,1] neg_lo:[0,1,0]
    v_cvt_pk_bf16_f32 v251, v174, v175
    ds_write_addtid_b32 v242 offset:5440
    ds_write_addtid_b32 v243 offset:5712
    ds_write_addtid_b32 v244 offset:5984
    ds_write_addtid_b32 v245 offset:6256
    ds_write_addtid_b32 v246 offset:6528
    ds_write_addtid_b32 v247 offset:6800
    ds_write_addtid_b32 v248 offset:7072
    ds_write_addtid_b32 v249 offset:7344
    ds_write_addtid_b32 v250 offset:7616
    ds_write_addtid_b32 v251 offset:7888
    v_pk_mul_f32 v[194:195], v[174:175], v[186:187] op_sel:[0,0] op_sel_hi:[0,1]
    v_pk_fma_f32 v[172:173], v[174:175], v[186:187], v[194:195] op_sel:[1,1,0] op_sel_hi:[1,0,1] neg_lo:[0,1,0]
    v_cvt_pk_bf16_f32 v242, v172, v173
    v_pk_mul_f32 v[194:195], v[172:173], v[186:187] op_sel:[0,0] op_sel_hi:[0,1]
    v_pk_fma_f32 v[174:175], v[172:173], v[186:187], v[194:195] op_sel:[1,1,0] op_sel_hi:[1,0,1] neg_lo:[0,1,0]
    v_cvt_pk_bf16_f32 v243, v174, v175
    ds_write_addtid_b32 v242 offset:8160
    ds_write_addtid_b32 v243 offset:8432
    ds_read_b128 a[160:163], v252 offset:0
    ds_read_b128 a[164:167], v252 offset:32
    ds_read_b128 a[168:171], v252 offset:64
    ds_read_b128 a[172:175], v252 offset:96
    ds_read_b128 a[176:179], v252 offset:128
    ds_read_b128 a[180:183], v252 offset:160
    ds_read_b128 a[184:187], v252 offset:192
    ds_read_b128 a[188:191], v252 offset:224
    v_pk_mul_f32 v[194:195], v[180:181], v[180:181] op_sel:[0,0] op_sel_hi:[0,1]
    v_pk_fma_f32 v[182:183], v[180:181], v[180:181], v[194:195] op_sel:[1,1,0] op_sel_hi:[1,0,1] neg_lo:[0,1,0]
    v_pk_mul_f32 v[194:195], v[182:183], v[182:183] op_sel:[0,0] op_sel_hi:[0,1]
    v_pk_fma_f32 v[184:185], v[182:183], v[182:183], v[194:195] op_sel:[1,1,0] op_sel_hi:[1,0,1] neg_lo:[0,1,0]
    v_cvt_pk_bf16_f32 v242, v192, -v193
    v_pk_mul_f32 v[194:195], v[192:193], v[180:181] op_sel:[0,0] op_sel_hi:[0,1]
    v_pk_fma_f32 v[174:175], v[192:193], v[180:181], v[194:195] op_sel:[1,1,0] op_sel_hi:[1,0,1] neg_lo:[0,1,0]
    v_cvt_pk_bf16_f32 v243, v174, -v175
    v_pk_mul_f32 v[194:195], v[174:175], v[180:181] op_sel:[0,0] op_sel_hi:[0,1]
    v_pk_fma_f32 v[172:173], v[174:175], v[180:181], v[194:195] op_sel:[1,1,0] op_sel_hi:[1,0,1] neg_lo:[0,1,0]
    v_cvt_pk_bf16_f32 v244, v172, -v173
    v_pk_mul_f32 v[194:195], v[172:173], v[180:181] op_sel:[0,0] op_sel_hi:[0,1]
    v_pk_fma_f32 v[174:175], v[172:173], v[180:181], v[194:195] op_sel:[1,1,0] op_sel_hi:[1,0,1] neg_lo:[0,1,0]
    v_cvt_pk_bf16_f32 v245, v174, -v175
    v_pk_mul_f32 v[194:195], v[174:175], v[180:181] op_sel:[0,0] op_sel_hi:[0,1]
    v_pk_fma_f32 v[172:173], v[174:175], v[180:181], v[194:195] op_sel:[1,1,0] op_sel_hi:[1,0,1] neg_lo:[0,1,0]
    v_cvt_pk_bf16_f32 v246, v172, -v173
    v_pk_mul_f32 v[194:195], v[172:173], v[180:181] op_sel:[0,0] op_sel_hi:[0,1]
    v_pk_fma_f32 v[174:175], v[172:173], v[180:181], v[194:195] op_sel:[1,1,0] op_sel_hi:[1,0,1] neg_lo:[0,1,0]
    v_cvt_pk_bf16_f32 v247, v174, -v175
    v_pk_mul_f32 v[194:195], v[174:175], v[180:181] op_sel:[0,0] op_sel_hi:[0,1]
    s_add_u32 s88, s88, 4096
    buffer_store_dwordx4 v[144:147], v148, s[16:19], s88 offen sc1
    v_pk_fma_f32 v[172:173], v[174:175], v[180:181], v[194:195] op_sel:[1,1,0] op_sel_hi:[1,0,1] neg_lo:[0,1,0]
    v_cvt_pk_bf16_f32 v248, v172, -v173
    v_pk_mul_f32 v[194:195], v[172:173], v[180:181] op_sel:[0,0] op_sel_hi:[0,1]
    v_pk_fma_f32 v[174:175], v[172:173], v[180:181], v[194:195] op_sel:[1,1,0] op_sel_hi:[1,0,1] neg_lo:[0,1,0]
    v_cvt_pk_bf16_f32 v249, v174, -v175
    v_pk_mul_f32 v[194:195], v[192:193], v[190:191] op_sel:[0,0] op_sel_hi:[0,1]
    v_pk_fma_f32 v[176:177], v[192:193], v[190:191], v[194:195] op_sel:[1,1,0] op_sel_hi:[1,0,1] neg_lo:[0,1,0]
    v_cvt_pk_bf16_f32 v250, v176, -v177
    v_pk_mul_f32 v[194:195], v[176:177], v[182:183] op_sel:[0,0] op_sel_hi:[0,1]
    v_pk_fma_f32 v[174:175], v[176:177], v[182:183], v[194:195] op_sel:[1,1,0] op_sel_hi:[1,0,1] neg_lo:[0,1,0]
    v_cvt_pk_bf16_f32 v251, v174, -v175
    ds_write_addtid_b32 v242 offset:0
    ds_write_addtid_b32 v243 offset:272
    ds_write_addtid_b32 v244 offset:544
    ds_write_addtid_b32 v245 offset:816
    ds_write_addtid_b32 v246 offset:1088
    ds_write_addtid_b32 v247 offset:1360
    ds_write_addtid_b32 v248 offset:1632
    ds_write_addtid_b32 v249 offset:1904
    ds_write_addtid_b32 v250 offset:2176
    ds_write_addtid_b32 v251 offset:2448
    v_pk_mul_f32 v[194:195], v[174:175], v[182:183] op_sel:[0,0] op_sel_hi:[0,1]
    v_pk_fma_f32 v[172:173], v[174:175], v[182:183], v[194:195] op_sel:[1,1,0] op_sel_hi:[1,0,1] neg_lo:[0,1,0]
    v_cvt_pk_bf16_f32 v242, v172, -v173
    v_pk_mul_f32 v[194:195], v[172:173], v[182:183] op_sel:[0,0] op_sel_hi:[0,1]
    v_pk_fma_f32 v[174:175], v[172:173], v[182:183], v[194:195] op_sel:[1,1,0] op_sel_hi:[1,0,1] neg_lo:[0,1,0]
    v_cvt_pk_bf16_f32 v243, v174, -v175
    v_pk_mul_f32 v[194:195], v[174:175], v[182:183] op_sel:[0,0] op_sel_hi:[0,1]
    v_pk_fma_f32 v[172:173], v[174:175], v[182:183], v[194:195] op_sel:[1,1,0] op_sel_hi:[1,0,1] neg_lo:[0,1,0]
    v_cvt_pk_bf16_f32 v244, v172, -v173
    v_pk_mul_f32 v[194:195], v[176:177], v[190:191] op_sel:[0,0] op_sel_hi:[0,1]
    v_pk_fma_f32 v[178:179], v[176:177], v[190:191], v[194:195] op_sel:[1,1,0] op_sel_hi:[1,0,1] neg_lo:[0,1,0]
    v_cvt_pk_bf16_f32 v245, v178, -v179
    v_pk_mul_f32 v[194:195], v[178:179], v[184:185] op_sel:[0,0] op_sel_hi:[0,1]
    v_pk_fma_f32 v[174:175], v[178:179], v[184:185], v[194:195] op_sel:[1,1,0] op_sel_hi:[1,0,1] neg_lo:[0,1,0]
    v_cvt_pk_bf16_f32 v246, v174, -v175
    v_pk_mul_f32 v[194:195], v[174:175], v[184:185] op_sel:[0,0] op_sel_hi:[0,1]
    v_pk_fma_f32 v[172:173], v[174:175], v[184:185], v[194:195] op_sel:[1,1,0] op_sel_hi:[1,0,1] neg_lo:[0,1,0]
    v_cvt_pk_bf16_f32 v247, v172, -v173
    v_pk_mul_f32 v[194:195], v[178:179], v[190:191] op_sel:[0,0] op_sel_hi:[0,1]
    v_pk_fma_f32 v[176:177], v[178:179], v[190:191], v[194:195] op_sel:[1,1,0] op_sel_hi:[1,0,1] neg_lo:[0,1,0]
    v_cvt_pk_bf16_f32 v248, v176, -v177
    v_pk_mul_f32 v[194:195], v[176:177], v[184:185] op_sel:[0,0] op_sel_hi:[0,1]
    v_pk_fma_f32 v[174:175], v[176:177], v[184:185], v[194:195] op_sel:[1,1,0] op_sel_hi:[1,0,1] neg_lo:[0,1,0]
    v_cvt_pk_bf16_f32 v249, v174, -v175
    v_pk_mul_f32 v[194:195], v[174:175], v[184:185] op_sel:[0,0] op_sel_hi:[0,1]
    v_pk_fma_f32 v[172:173], v[174:175], v[184:185], v[194:195] op_sel:[1,1,0] op_sel_hi:[1,0,1] neg_lo:[0,1,0]
    v_cvt_pk_bf16_f32 v250, v172, -v173
    v_pk_mul_f32 v[194:195], v[176:177], v[190:191] op_sel:[0,0] op_sel_hi:[0,1]
    v_pk_fma_f32 v[178:179], v[176:177], v[190:191], v[194:195] op_sel:[1,1,0] op_sel_hi:[1,0,1] neg_lo:[0,1,0]
    s_add_u32 s88, s88, 4096
    buffer_store_dwordx4 v[144:147], v148, s[16:19], s88 offen sc1
    v_cvt_pk_bf16_f32 v251, v178, -v179
    ds_write_addtid_b32 v242 offset:2720
    ds_write_addtid_b32 v242 offset:3264
    ds_write_addtid_b32 v243 offset:3536
    ds_write_addtid_b32 v244 offset:3808
    ds_write_addtid_b32 v245 offset:4352
    ds_write_addtid_b32 v246 offset:4624
    ds_write_addtid_b32 v247 offset:4896
    ds_write_addtid_b32 v248 offset:5440
    ds_write_addtid_b32 v249 offset:5712
    ds_write_addtid_b32 v250 offset:5984
    ds_write_addtid_b32 v251 offset:6528
    v_pk_mul_f32 v[194:195], v[178:179], v[186:187] op_sel:[0,0] op_sel_hi:[0,1]
    v_pk_fma_f32 v[174:175], v[178:179], v[186:187], v[194:195] op_sel:[1,1,0] op_sel_hi:[1,0,1] neg_lo:[0,1,0]
    v_cvt_pk_bf16_f32 v242, v174, -v175
    v_pk_mul_f32 v[194:195], v[178:179], v[190:191] op_sel:[0,0] op_sel_hi:[0,1]
    v_pk_fma_f32 v[176:177], v[178:179], v[190:191], v[194:195] op_sel:[1,1,0] op_sel_hi:[1,0,1] neg_lo:[0,1,0]
    v_cvt_pk_bf16_f32 v243, v176, -v177
    v_pk_mul_f32 v[194:195], v[176:177], v[186:187] op_sel:[0,0] op_sel_hi:[0,1]
    v_pk_fma_f32 v[174:175], v[176:177], v[186:187], v[194:195] op_sel:[1,1,0] op_sel_hi:[1,0,1] neg_lo:[0,1,0]
    v_cvt_pk_bf16_f32 v244, v174, -v175
    v_pk_mul_f32 v[194:195], v[176:177], v[190:191] op_sel:[0,0] op_sel_hi:[0,1]
    v_pk_fma_f32 v[178:179], v[176:177], v[190:191], v[194:195] op_sel:[1,1,0] op_sel_hi:[1,0,1] neg_lo:[0,1,0]
    v_cvt_pk_bf16_f32 v245, v178, -v179
    v_pk_mul_f32 v[194:195], v[178:179], v[186:187] op_sel:[0,0] op_sel_hi:[0,1]
    v_pk_fma_f32 v[174:175], v[178:179], v[186:187], v[194:195] op_sel:[1,1,0] op_sel_hi:[1,0,1] neg_lo:[0,1,0]
    v_cvt_pk_bf16_f32 v246, v174, -v175
    v_pk_mul_f32 v[194:195], v[178:179], v[190:191] op_sel:[0,0] op_sel_hi:[0,1]
    v_pk_fma_f32 v[176:177], v[178:179], v[190:191], v[194:195] op_sel:[1,1,0] op_sel_hi:[1,0,1] neg_lo:[0,1,0]
    v_cvt_pk_bf16_f32 v247, v176, -v177
    v_pk_mul_f32 v[194:195], v[176:177], v[186:187] op_sel:[0,0] op_sel_hi:[0,1]
    v_pk_fma_f32 v[174:175], v[176:177], v[186:187], v[194:195] op_sel:[1,1,0] op_sel_hi:[1,0,1] neg_lo:[0,1,0]
    v_cvt_pk_bf16_f32 v248, v174, -v175
    ds_write_addtid_b32 v242 offset:6800
    ds_write_addtid_b32 v243 offset:7072
    ds_write_addtid_b32 v244 offset:7344
    ds_write_addtid_b32 v245 offset:7616
    ds_write_addtid_b32 v246 offset:7888
    ds_write_addtid_b32 v247 offset:8160
    ds_write_addtid_b32 v248 offset:8432
    ds_read_b128 a[192:195], v252 offset:0
    ds_read_b128 a[196:199], v252 offset:32
    ds_read_b128 a[200:203], v252 offset:64
    ds_read_b128 a[204:207], v252 offset:96
    ds_read_b128 a[208:211], v252 offset:128
    ds_read_b128 a[212:215], v252 offset:160
    ds_read_b128 a[216:219], v252 offset:192
    ds_read_b128 a[220:223], v252 offset:224
    s_add_u32 m0, s92, 36352
    s_nop 0
    buffer_load_dwordx4 v73, s[4:7], s99 offen offset:0  lds
    v_mov_b32 v134, 0x3f803f80
    v_mov_b32 v132, 0
    v_mov_b32 v133, 0
    s_waitcnt vmcnt(11)
    v_dot2c_f32_bf16 v132, v120, v134
    v_dot2c_f32_bf16 v133, v120, v120
    v_dot2c_f32_bf16 v132, v121, v134
    v_dot2c_f32_bf16 v133, v121, v121
    v_dot2c_f32_bf16 v132, v122, v134
    v_dot2c_f32_bf16 v133, v122, v122
    v_dot2c_f32_bf16 v132, v123, v134
    v_dot2c_f32_bf16 v133, v123, v123
    s_waitcnt vmcnt(10)
    v_dot2c_f32_bf16 v132, v124, v134
    v_dot2c_f32_bf16 v133, v124, v124
    v_dot2c_f32_bf16 v132, v125, v134
    v_dot2c_f32_bf16 v133, v125, v125
    v_dot2c_f32_bf16 v132, v126, v134
    v_dot2c_f32_bf16 v133, v126, v126
    v_dot2c_f32_bf16 v132, v127, v134
    v_dot2c_f32_bf16 v133, v127, v127
    s_waitcnt vmcnt(9)
    v_dot2c_f32_bf16 v132, v128, v134
    v_dot2c_f32_bf16 v133, v128, v128
    v_dot2c_f32_bf16 v132, v129, v134
    v_dot2c_f32_bf16 v133, v129, v129
    v_dot2c_f32_bf16 v132, v130, v134
    v_dot2c_f32_bf16 v133, v130, v130
    v_dot2c_f32_bf16 v132, v131, v134
    v_dot2c_f32_bf16 v133, v131, v131
    v_lshrrev_b32 v135, 5, v0
    v_and_b32 v121, 3, v135
    v_lshrrev_b32_e64 v135, 2, v135
    v_add_f32_dpp v132, v132, v132 row_shr:1 row_mask:0xf bank_mask:0xf bound_ctrl:0
    v_add_f32_dpp v133, v133, v133 row_shr:1 row_mask:0xf bank_mask:0xf bound_ctrl:0
    v_lshlrev_b32_e64 v135, 3, v135
    v_add_f32_dpp v132, v132, v132 row_shr:2 row_mask:0xf bank_mask:0xf bound_ctrl:0
    v_add_f32_dpp v133, v133, v133 row_shr:2 row_mask:0xf bank_mask:0xf bound_ctrl:0
    v_lshl_add_u32 v135, v121, 12, v135
    v_add_f32_dpp v132, v132, v132 row_shr:4 row_mask:0xf bank_mask:0xf bound_ctrl:0
    v_add_f32_dpp v133, v133, v133 row_shr:4 row_mask:0xf bank_mask:0xf bound_ctrl:0
    v_and_b32_e64 v121, 31, v0
    v_add_f32_dpp v132, v132, v132 row_shr:8 row_mask:0xf bank_mask:0xf bound_ctrl:0
    v_add_f32_dpp v133, v133, v133 row_shr:8 row_mask:0xf bank_mask:0xf bound_ctrl:0
    v_cmp_eq_u32_e64 vcc, 31, v121
    v_add_f32_dpp v132, v132, v132 row_bcast:15 row_mask:0xa bank_mask:0xf
    v_add_f32_dpp v133, v133, v133 row_bcast:15 row_mask:0xa bank_mask:0xf
    v_mov_b32 v121, 1073741824
    v_cndmask_b32_e64 v120, v121, v135, vcc
    s_lshl_b32 s96, s2, 4
    s_add_u32 s96, s96, 3440640
    v_mul_f32 v135, 0x3acccccd, v132
    v_mul_f32 v133, 0x3acccccd, v133
    v_fma_f32 v133, -v135, v135, v133
    v_max_f32 v133, 0, v133
    v_add_f32 v133, 0x3727c5ac, v133
    v_rsq_f32_e64 v132, v133
    s_nop 0
    v_mul_f32 v133, -v135, v132
    buffer_store_dwordx2 v[132:133], v120, s[16:19], s96 offen sc1
    v_lshlrev_b32 v199, 16, v236
    v_mul_f32 v199, 0x3fb8aa3b, v199
    v_exp_f32 v199, v199
    v_lshlrev_b32 v255, 16, v237
    v_mul_f32 v255, v255, v253
    v_mul_f32 v255, 0x3e22f983, v255
    v_cvt_pk_bf16_f32 v199, v199, v199
    v_lshlrev_b32 v199, 16, v199
    v_mul_f32 v254, v199, v253
    v_mul_f32 v254, 0xbfb8aa3b, v254
    s_waitcnt lgkmcnt(7)
    v_mfma_f32_32x32x16_bf16 v[216:231], a[192:195], a[160:163], v[216:231]
    s_add_u32 m0, s92, 36352
    s_nop 0
    buffer_load_dwordx4 v74, s[4:7], s99 offen offset:1088  lds
    v_mul_f32 v182, 0x41000000, v254
    v_mul_f32 v185, 0x41000000, v255
    v_mul_f32 v184, 0x43800000, v254
    v_mul_f32 v189, 0x43800000, v255
    s_waitcnt lgkmcnt(6)
    v_mfma_f32_32x32x16_bf16 v[216:231], a[196:199], a[164:167], v[216:231]
    s_add_u32 m0, s92, 36352
    s_nop 0
    buffer_load_dwordx4 v75, s[4:7], s99 offen offset:2176  lds
    v_fract_f32 v185, v185
    v_fract_f32 v188, v255
    v_fract_f32 v189, v189
    v_exp_f32 v182, v182
    s_waitcnt lgkmcnt(5)
    v_mfma_f32_32x32x16_bf16 v[216:231], a[200:203], a[168:171], v[216:231]
    s_add_u32 m0, s92, 36352
    s_nop 0
    buffer_load_dwordx4 v76, s[4:7], s99 offen offset:3264  lds
    v_exp_f32 v183, v254
    v_exp_f32 v184, v184
    v_cos_f32 v186, v185
    v_sin_f32 v187, v185
    s_waitcnt lgkmcnt(4)
    v_mfma_f32_32x32x16_bf16 v[216:231], a[204:207], a[172:175], v[216:231]
    s_add_u32 m0, s93, 53760
    s_add_u32 s99, s99, 256
    s_mov_b64 exec, s[80:81]
    buffer_load_dwordx4 v77, s[4:7], s100 offen  lds
    s_mov_b64 exec, -1
    s_add_u32 s100, s100, 256
    v_cos_f32 v180, v188
    v_sin_f32 v181, v188
    v_cos_f32 v190, v189
    v_sin_f32_e64 v191, v189
    s_waitcnt lgkmcnt(3)
    v_mfma_f32_32x32x16_bf16 v[216:231], a[208:211], a[176:179], v[216:231]
    s_add_u32 m0, s92, 55936
    s_nop 0
    buffer_load_dwordx4 v73, s[4:7], s99 offen offset:0  lds
    v_lshlrev_b32 v192, 16, v238
    v_lshlrev_b32 v193, 16, v239
    v_add_f32 v199, v253, v253
    v_mul_f32 v192, v192, v199
    s_waitcnt lgkmcnt(2)
    v_mfma_f32_32x32x16_bf16 v[216:231], a[212:215], a[180:183], v[216:231]
    s_add_u32 m0, s92, 55936
    s_nop 0
    buffer_load_dwordx4 v74, s[4:7], s99 offen offset:1088  lds
    v_mul_f32 v193, v193, v199
    v_mul_f32 v186, v186, v182
    v_mul_f32 v187, v187, v182
    v_mul_f32 v180, v180, v183
    s_waitcnt lgkmcnt(1)
    v_mfma_f32_32x32x16_bf16 v[216:231], a[216:219], a[184:187], v[216:231]
    s_add_u32 m0, s92, 55936
    s_nop 0
    buffer_load_dwordx4 v75, s[4:7], s99 offen offset:2176  lds
    v_mul_f32 v181, v181, v183
    buffer_load_dword v7, v4, s[16:19], s87 offen offset:0 sc1
    v_mul_f32 v190, v190, v184
    v_mul_f32_e64 v191, v191, v184
    s_waitcnt lgkmcnt(0)
    v_mfma_f32_32x32x16_bf16 v[216:231], a[220:223], a[188:191], v[216:231]
    s_add_u32 m0, s92, 55936
    s_nop 0
    buffer_load_dwordx4 v76, s[4:7], s99 offen offset:3264  lds
    s_add_u32 m0, s93, 73344
    s_add_u32 s99, s99, 256
    s_mov_b64 exec, s[80:81]
    buffer_load_dwordx4 v77, s[4:7], s100 offen  lds
    s_mov_b64 exec, -1
    s_add_u32 s100, s100, 256
    s_add_u32 m0, s92, 75520
    s_nop 0
    buffer_load_dwordx4 v73, s[4:7], s99 offen offset:0  lds
    s_add_u32 m0, s92, 75520
    s_nop 0
    buffer_load_dwordx4 v74, s[4:7], s99 offen offset:1088  lds
    s_mov_b32 m0, s37
    v_mov_b32 v242, 0x3f80
    v_cvt_pk_bf16_f32 v243, v186, v187
    v_pk_mul_f32 v[194:195], v[186:187], v[186:187] op_sel:[0,0] op_sel_hi:[0,1]
    v_pk_fma_f32 v[172:173], v[186:187], v[186:187], v[194:195] op_sel:[1,1,0] op_sel_hi:[1,0,1] neg_lo:[0,1,0]
    v_cvt_pk_bf16_f32 v244, v172, v173
    v_pk_mul_f32 v[194:195], v[172:173], v[186:187] op_sel:[0,0] op_sel_hi:[0,1]
    v_pk_fma_f32 v[174:175], v[172:173], v[186:187], v[194:195] op_sel:[1,1,0] op_sel_hi:[1,0,1] neg_lo:[0,1,0]
    v_cvt_pk_bf16_f32 v245, v174, v175
    v_pk_mul_f32 v[194:195], v[174:175], v[186:187] op_sel:[0,0] op_sel_hi:[0,1]
    v_pk_fma_f32 v[172:173], v[174:175], v[186:187], v[194:195] op_sel:[1,1,0] op_sel_hi:[1,0,1] neg_lo:[0,1,0]
    v_cvt_pk_bf16_f32 v246, v172, v173
    v_pk_mul_f32 v[194:195], v[172:173], v[186:187] op_sel:[0,0] op_sel_hi:[0,1]
    v_pk_fma_f32 v[174:175], v[172:173], v[186:187], v[194:195] op_sel:[1,1,0] op_sel_hi:[1,0,1] neg_lo:[0,1,0]
    v_cvt_pk_bf16_f32 v247, v174, v175
    v_pk_mul_f32 v[194:195], v[174:175], v[186:187] op_sel:[0,0] op_sel_hi:[0,1]
    v_pk_fma_f32 v[172:173], v[174:175], v[186:187], v[194:195] op_sel:[1,1,0] op_sel_hi:[1,0,1] neg_lo:[0,1,0]
    v_cvt_pk_bf16_f32 v248, v172, v173
    v_pk_mul_f32 v[194:195], v[172:173], v[186:187] op_sel:[0,0] op_sel_hi:[0,1]
    v_pk_fma_f32 v[174:175], v[172:173], v[186:187], v[194:195] op_sel:[1,1,0] op_sel_hi:[1,0,1] neg_lo:[0,1,0]
    v_cvt_pk_bf16_f32 v249, v174, v175
    v_pk_mul_f32 v[194:195], v[174:175], v[186:187] op_sel:[0,0] op_sel_hi:[0,1]
    v_pk_fma_f32 v[172:173], v[174:175], v[186:187], v[194:195] op_sel:[1,1,0] op_sel_hi:[1,0,1] neg_lo:[0,1,0]
    v_cvt_pk_bf16_f32 v250, v172, v173
    v_pk_mul_f32 v[194:195], v[172:173], v[186:187] op_sel:[0,0] op_sel_hi:[0,1]
    v_pk_fma_f32 v[174:175], v[172:173], v[186:187], v[194:195] op_sel:[1,1,0] op_sel_hi:[1,0,1] neg_lo:[0,1,0]
    v_cvt_pk_bf16_f32 v251, v174, v175
    ds_write_addtid_b32 v242 offset:0
    ds_write_addtid_b32 v243 offset:272
    ds_write_addtid_b32 v244 offset:544
    ds_write_addtid_b32 v245 offset:816
    ds_write_addtid_b32 v246 offset:1088
    ds_write_addtid_b32 v247 offset:1360
    ds_write_addtid_b32 v248 offset:1632
    ds_write_addtid_b32 v249 offset:1904
    ds_write_addtid_b32 v250 offset:2176
    ds_write_addtid_b32 v251 offset:2448
    v_pk_mul_f32 v[194:195], v[174:175], v[186:187] op_sel:[0,0] op_sel_hi:[0,1]
    v_pk_fma_f32 v[172:173], v[174:175], v[186:187], v[194:195] op_sel:[1,1,0] op_sel_hi:[1,0,1] neg_lo:[0,1,0]
    v_cvt_pk_bf16_f32 v242, v172, v173
    v_pk_mul_f32 v[194:195], v[172:173], v[186:187] op_sel:[0,0] op_sel_hi:[0,1]
    v_pk_fma_f32 v[174:175], v[172:173], v[186:187], v[194:195] op_sel:[1,1,0] op_sel_hi:[1,0,1] neg_lo:[0,1,0]
    v_cvt_pk_bf16_f32 v243, v174, v175
    v_pk_mul_f32 v[194:195], v[174:175], v[186:187] op_sel:[0,0] op_sel_hi:[0,1]
    v_pk_fma_f32 v[172:173], v[174:175], v[186:187], v[194:195] op_sel:[1,1,0] op_sel_hi:[1,0,1] neg_lo:[0,1,0]
    v_cvt_pk_bf16_f32 v244, v172, v173
    v_pk_mul_f32 v[194:195], v[172:173], v[186:187] op_sel:[0,0] op_sel_hi:[0,1]
    v_pk_fma_f32 v[174:175], v[172:173], v[186:187], v[194:195] op_sel:[1,1,0] op_sel_hi:[1,0,1] neg_lo:[0,1,0]
    v_cvt_pk_bf16_f32 v245, v174, v175
    v_pk_mul_f32 v[194:195], v[174:175], v[186:187] op_sel:[0,0] op_sel_hi:[0,1]
    v_pk_fma_f32 v[172:173], v[174:175], v[186:187], v[194:195] op_sel:[1,1,0] op_sel_hi:[1,0,1] neg_lo:[0,1,0]
    v_cvt_pk_bf16_f32 v246, v172, v173
    v_pk_mul_f32 v[194:195], v[172:173], v[186:187] op_sel:[0,0] op_sel_hi:[0,1]
    v_pk_fma_f32 v[174:175], v[172:173], v[186:187], v[194:195] op_sel:[1,1,0] op_sel_hi:[1,0,1] neg_lo:[0,1,0]
    v_cvt_pk_bf16_f32 v247, v174, v175
    v_pk_mul_f32 v[194:195], v[174:175], v[186:187] op_sel:[0,0] op_sel_hi:[0,1]
    v_pk_fma_f32 v[172:173], v[174:175], v[186:187], v[194:195] op_sel:[1,1,0] op_sel_hi:[1,0,1] neg_lo:[0,1,0]
    v_cvt_pk_bf16_f32 v248, v172, v173
    v_pk_mul_f32 v[194:195], v[172:173], v[186:187] op_sel:[0,0] op_sel_hi:[0,1]
    v_pk_fma_f32 v[174:175], v[172:173], v[186:187], v[194:195] op_sel:[1,1,0] op_sel_hi:[1,0,1] neg_lo:[0,1,0]
    v_cvt_pk_bf16_f32 v249, v174, v175
    v_pk_mul_f32 v[194:195], v[174:175], v[186:187] op_sel:[0,0] op_sel_hi:[0,1]
    v_pk_fma_f32 v[172:173], v[174:175], v[186:187], v[194:195] op_sel:[1,1,0] op_sel_hi:[1,0,1] neg_lo:[0,1,0]
    v_cvt_pk_bf16_f32 v250, v172, v173
    v_pk_mul_f32 v[194:195], v[172:173], v[186:187] op_sel:[0,0] op_sel_hi:[0,1]
    s_waitcnt vmcnt(4)
    v_cmp_gt_u32 vcc, 32, v7
    s_nop 0
    s_and_b64 vcc, vcc, s[50:51]
    s_cbranch_scc1 ps_7
pc_9:
    s_barrier
    v_pk_fma_f32 v[174:175], v[172:173], v[186:187], v[194:195] op_sel:[1,1,0] op_sel_hi:[1,0,1] neg_lo:[0,1,0]
    v_cvt_pk_bf16_f32 v251, v174, v175
    ds_write_addtid_b32 v242 offset:2720
    ds_write_addtid_b32 v243 offset:2992
    ds_write_addtid_b32 v244 offset:3264
    ds_write_addtid_b32 v245 offset:3536
    ds_write_addtid_b32 v246 offset:3808
    ds_write_addtid_b32 v247 offset:4080
    ds_write_addtid_b32 v248 offset:4352
    ds_write_addtid_b32 v249 offset:4624
    ds_write_addtid_b32 v250 offset:4896
    ds_write_addtid_b32 v251 offset:5168
    v_pk_mul_f32 v[194:195], v[174:175], v[186:187] op_sel:[0,0] op_sel_hi:[0,1]
    v_pk_fma_f32 v[172:173], v[174:175], v[186:187], v[194:195] op_sel:[1,1,0] op_sel_hi:[1,0,1] neg_lo:[0,1,0]
    v_cvt_pk_bf16_f32 v242, v172, v173
    buffer_load_dwordx4 a[0:3], v200, s[16:19], s101 offen offset:0 sc1
    v_pk_mul_f32 v[194:195], v[172:173], v[186:187] op_sel:[0,0] op_sel_hi:[0,1]
    v_pk_fma_f32 v[174:175], v[172:173], v[186:187], v[194:195] op_sel:[1,1,0] op_sel_hi:[1,0,1] neg_lo:[0,1,0]
    v_cvt_pk_bf16_f32 v243, v174, v175
    v_pk_mul_f32 v[194:195], v[174:175], v[186:187] op_sel:[0,0] op_sel_hi:[0,1]
    v_pk_fma_f32 v[172:173], v[174:175], v[186:187], v[194:195] op_sel:[1,1,0] op_sel_hi:[1,0,1] neg_lo:[0,1,0]
    v_cvt_pk_bf16_f32 v244, v172, v173
    v_pk_mul_f32 v[194:195], v[172:173], v[186:187] op_sel:[0,0] op_sel_hi:[0,1]
    v_pk_fma_f32 v[174:175], v[172:173], v[186:187], v[194:195] op_sel:[1,1,0] op_sel_hi:[1,0,1] neg_lo:[0,1,0]
    v_cvt_pk_bf16_f32 v245, v174, v175
    v_pk_mul_f32 v[194:195], v[174:175], v[186:187] op_sel:[0,0] op_sel_hi:[0,1]
    v_pk_fma_f32 v[172:173], v[174:175], v[186:187], v[194:195] op_sel:[1,1,0] op_sel_hi:[1,0,1] neg_lo:[0,1,0]
    v_cvt_pk_bf16_f32 v246, v172, v173
    v_pk_mul_f32 v[194:195], v[172:173], v[186:187] op_sel:[0,0] op_sel_hi:[0,1]
    v_pk_fma_f32 v[174:175], v[172:173], v[186:187], v[194:195] op_sel:[1,1,0] op_sel_hi:[1,0,1] neg_lo:[0,1,0]
    v_cvt_pk_bf16_f32 v247, v174, v175
    buffer_load_dwordx4 a[4:7], v200, s[16:19], s101 offen offset:1024 sc1
    v_pk_mul_f32 v[194:195], v[174:175], v[186:187] op_sel:[0,0] op_sel_hi:[0,1]
    v_pk_fma_f32 v[172:173], v[174:175], v[186:187], v[194:195] op_sel:[1,1,0] op_sel_hi:[1,0,1] neg_lo:[0,1,0]
    v_cvt_pk_bf16_f32 v248, v172, v173
    v_pk_mul_f32 v[194:195], v[172:173], v[186:187] op_sel:[0,0] op_sel_hi:[0,1]
    v_pk_fma_f32 v[174:175], v[172:173], v[186:187], v[194:195] op_sel:[1,1,0] op_sel_hi:[1,0,1] neg_lo:[0,1,0]
    v_cvt_pk_bf16_f32 v249, v174, v175
    v_pk_mul_f32 v[194:195], v[174:175], v[186:187] op_sel:[0,0] op_sel_hi:[0,1]
    v_pk_fma_f32 v[172:173], v[174:175], v[186:187], v[194:195] op_sel:[1,1,0] op_sel_hi:[1,0,1] neg_lo:[0,1,0]
    v_cvt_pk_bf16_f32 v250, v172, v173
    v_pk_mul_f32 v[194:195], v[172:173], v[186:187] op_sel:[0,0] op_sel_hi:[0,1]
    v_pk_fma_f32 v[174:175], v[172:173], v[186:187], v[194:195] op_sel:[1,1,0] op_sel_hi:[1,0,1] neg_lo:[0,1,0]
    v_cvt_pk_bf16_f32 v251, v174, v175
    ds_write_addtid_b32 v242 offset:5440
    ds_write_addtid_b32 v243 offset:5712
    ds_write_addtid_b32 v244 offset:5984
    buffer_load_dwordx4 a[8:11], v200, s[16:19], s101 offen offset:2048 sc1
    ds_write_addtid_b32 v245 offset:6256
    ds_write_addtid_b32 v246 offset:6528
    ds_write_addtid_b32 v247 offset:6800
    ds_write_addtid_b32 v248 offset:7072
    ds_write_addtid_b32 v249 offset:7344
    ds_write_addtid_b32 v250 offset:7616
    ds_write_addtid_b32 v251 offset:7888
    v_pk_mul_f32 v[194:195], v[174:175], v[186:187] op_sel:[0,0] op_sel_hi:[0,1]
    v_pk_fma_f32 v[172:173], v[174:175], v[186:187], v[194:195] op_sel:[1,1,0] op_sel_hi:[1,0,1] neg_lo:[0,1,0]
    v_cvt_pk_bf16_f32 v242, v172, v173
    v_pk_mul_f32 v[194:195], v[172:173], v[186:187] op_sel:[0,0] op_sel_hi:[0,1]
    v_pk_fma_f32 v[174:175], v[172:173], v[186:187], v[194:195] op_sel:[1,1,0] op_sel_hi:[1,0,1] neg_lo:[0,1,0]
    v_cvt_pk_bf16_f32 v243, v174, v175
    ds_write_addtid_b32 v242 offset:8160
    ds_write_addtid_b32 v243 offset:8432
    buffer_load_dwordx4 a[12:15], v200, s[16:19], s101 offen offset:3072 sc1
    ds_read_b128 a[160:163], v252 offset:0
    ds_read_b128 a[164:167], v252 offset:32
    ds_read_b128 a[168:171], v252 offset:64
    ds_read_b128 a[172:175], v252 offset:96
    ds_read_b128 a[176:179], v252 offset:128
    ds_read_b128 a[180:183], v252 offset:160
    ds_read_b128 a[184:187], v252 offset:192
    ds_read_b128 a[188:191], v252 offset:224
    v_pk_mul_f32 v[194:195], v[180:181], v[180:181] op_sel:[0,0] op_sel_hi:[0,1]
    v_pk_fma_f32 v[182:183], v[180:181], v[180:181], v[194:195] op_sel:[1,1,0] op_sel_hi:[1,0,1] neg_lo:[0,1,0]
    v_pk_mul_f32 v[194:195], v[182:183], v[182:183] op_sel:[0,0] op_sel_hi:[0,1]
    v_pk_fma_f32 v[184:185], v[182:183], v[182:183], v[194:195] op_sel:[1,1,0] op_sel_hi:[1,0,1] neg_lo:[0,1,0]
    v_cvt_pk_bf16_f32 v242, v192, -v193
    v_pk_mul_f32 v[194:195], v[192:193], v[180:181] op_sel:[0,0] op_sel_hi:[0,1]
    v_pk_fma_f32 v[174:175], v[192:193], v[180:181], v[194:195] op_sel:[1,1,0] op_sel_hi:[1,0,1] neg_lo:[0,1,0]
    s_add_u32 s101, s101, 4096
    buffer_load_dwordx4 a[16:19], v200, s[16:19], s101 offen offset:0 sc1
    v_cvt_pk_bf16_f32 v243, v174, -v175
    v_pk_mul_f32 v[194:195], v[174:175], v[180:181] op_sel:[0,0] op_sel_hi:[0,1]
    v_pk_fma_f32 v[172:173], v[174:175], v[180:181], v[194:195] op_sel:[1,1,0] op_sel_hi:[1,0,1] neg_lo:[0,1,0]
    v_cvt_pk_bf16_f32 v244, v172, -v173
    v_pk_mul_f32 v[194:195], v[172:173], v[180:181] op_sel:[0,0] op_sel_hi:[0,1]
    v_pk_fma_f32 v[174:175], v[172:173], v[180:181], v[194:195] op_sel:[1,1,0] op_sel_hi:[1,0,1] neg_lo:[0,1,0]
    v_cvt_pk_bf16_f32 v245, v174, -v175
    v_pk_mul_f32 v[194:195], v[174:175], v[180:181] op_sel:[0,0] op_sel_hi:[0,1]
    v_pk_fma_f32 v[172:173], v[174:175], v[180:181], v[194:195] op_sel:[1,1,0] op_sel_hi:[1,0,1] neg_lo:[0,1,0]
    v_cvt_pk_bf16_f32 v246, v172, -v173
    v_pk_mul_f32 v[194:195], v[172:173], v[180:181] op_sel:[0,0] op_sel_hi:[0,1]
    v_pk_fma_f32 v[174:175], v[172:173], v[180:181], v[194:195] op_sel:[1,1,0] op_sel_hi:[1,0,1] neg_lo:[0,1,0]
    v_cvt_pk_bf16_f32 v247, v174, -v175
    v_pk_mul_f32 v[194:195], v[174:175], v[180:181] op_sel:[0,0] op_sel_hi:[0,1]
    v_pk_fma_f32 v[172:173], v[174:175], v[180:181], v[194:195] op_sel:[1,1,0] op_sel_hi:[1,0,1] neg_lo:[0,1,0]
    buffer_load_dwordx4 a[20:23], v200, s[16:19], s101 offen offset:1024 sc1
    v_cvt_pk_bf16_f32 v248, v172, -v173
    v_pk_mul_f32 v[194:195], v[172:173], v[180:181] op_sel:[0,0] op_sel_hi:[0,1]
    v_pk_fma_f32 v[174:175], v[172:173], v[180:181], v[194:195] op_sel:[1,1,0] op_sel_hi:[1,0,1] neg_lo:[0,1,0]
    v_cvt_pk_bf16_f32 v249, v174, -v175
    v_pk_mul_f32 v[194:195], v[192:193], v[190:191] op_sel:[0,0] op_sel_hi:[0,1]
    v_pk_fma_f32 v[176:177], v[192:193], v[190:191], v[194:195] op_sel:[1,1,0] op_sel_hi:[1,0,1] neg_lo:[0,1,0]
    v_cvt_pk_bf16_f32 v250, v176, -v177
    v_pk_mul_f32 v[194:195], v[176:177], v[182:183] op_sel:[0,0] op_sel_hi:[0,1]
    v_pk_fma_f32 v[174:175], v[176:177], v[182:183], v[194:195] op_sel:[1,1,0] op_sel_hi:[1,0,1] neg_lo:[0,1,0]
    v_cvt_pk_bf16_f32 v251, v174, -v175
    ds_write_addtid_b32 v242 offset:0
    ds_write_addtid_b32 v243 offset:272
    ds_write_addtid_b32 v244 offset:544
    ds_write_addtid_b32 v245 offset:816
    ds_write_addtid_b32 v246 offset:1088
    buffer_load_dwordx4 a[24:27], v200, s[16:19], s101 offen offset:2048 sc1
    ds_write_addtid_b32 v247 offset:1360
    ds_write_addtid_b32 v248 offset:1632
    ds_write_addtid_b32 v249 offset:1904
    ds_write_addtid_b32 v250 offset:2176
    ds_write_addtid_b32 v251 offset:2448
    v_pk_mul_f32 v[194:195], v[174:175], v[182:183] op_sel:[0,0] op_sel_hi:[0,1]
    v_pk_fma_f32 v[172:173], v[174:175], v[182:183], v[194:195] op_sel:[1,1,0] op_sel_hi:[1,0,1] neg_lo:[0,1,0]
    v_cvt_pk_bf16_f32 v242, v172, -v173
    v_pk_mul_f32 v[194:195], v[172:173], v[182:183] op_sel:[0,0] op_sel_hi:[0,1]
    v_pk_fma_f32 v[174:175], v[172:173], v[182:183], v[194:195] op_sel:[1,1,0] op_sel_hi:[1,0,1] neg_lo:[0,1,0]
    v_cvt_pk_bf16_f32 v243, v174, -v175
    v_pk_mul_f32 v[194:195], v[174:175], v[182:183] op_sel:[0,0] op_sel_hi:[0,1]
    v_pk_fma_f32 v[172:173], v[174:175], v[182:183], v[194:195] op_sel:[1,1,0] op_sel_hi:[1,0,1] neg_lo:[0,1,0]
    v_cvt_pk_bf16_f32 v244, v172, -v173
    v_pk_mul_f32 v[194:195], v[176:177], v[190:191] op_sel:[0,0] op_sel_hi:[0,1]
    buffer_load_dwordx4 a[28:31], v200, s[16:19], s101 offen offset:3072 sc1
    v_pk_fma_f32 v[178:179], v[176:177], v[190:191], v[194:195] op_sel:[1,1,0] op_sel_hi:[1,0,1] neg_lo:[0,1,0]
    v_cvt_pk_bf16_f32 v245, v178, -v179
    v_pk_mul_f32 v[194:195], v[178:179], v[184:185] op_sel:[0,0] op_sel_hi:[0,1]
    v_pk_fma_f32 v[174:175], v[178:179], v[184:185], v[194:195] op_sel:[1,1,0] op_sel_hi:[1,0,1] neg_lo:[0,1,0]
    v_cvt_pk_bf16_f32 v246, v174, -v175
    v_pk_mul_f32 v[194:195], v[174:175], v[184:185] op_sel:[0,0] op_sel_hi:[0,1]
    v_pk_fma_f32 v[172:173], v[174:175], v[184:185], v[194:195] op_sel:[1,1,0] op_sel_hi:[1,0,1] neg_lo:[0,1,0]
    v_cvt_pk_bf16_f32 v247, v172, -v173
    v_pk_mul_f32 v[194:195], v[178:179], v[190:191] op_sel:[0,0] op_sel_hi:[0,1]
    v_pk_fma_f32 v[176:177], v[178:179], v[190:191], v[194:195] op_sel:[1,1,0] op_sel_hi:[1,0,1] neg_lo:[0,1,0]
    v_cvt_pk_bf16_f32 v248, v176, -v177
    v_pk_mul_f32 v[194:195], v[176:177], v[184:185] op_sel:[0,0] op_sel_hi:[0,1]
    v_pk_fma_f32 v[174:175], v[176:177], v[184:185], v[194:195] op_sel:[1,1,0] op_sel_hi:[1,0,1] neg_lo:[0,1,0]
    v_cvt_pk_bf16_f32 v249, v174, -v175
    v_pk_mul_f32 v[194:195], v[174:175], v[184:185] op_sel:[0,0] op_sel_hi:[0,1]
    s_add_u32 s101, s101, 4096
    buffer_load_dwordx4 a[32:35], v200, s[16:19], s101 offen offset:0 sc1
    v_pk_fma_f32 v[172:173], v[174:175], v[184:185], v[194:195] op_sel:[1,1,0] op_sel_hi:[1,0,1] neg_lo:[0,1,0]
    v_cvt_pk_bf16_f32 v250, v172, -v173
    v_pk_mul_f32 v[194:195], v[176:177], v[190:191] op_sel:[0,0] op_sel_hi:[0,1]
    v_pk_fma_f32 v[178:179], v[176:177], v[190:191], v[194:195] op_sel:[1,1,0] op_sel_hi:[1,0,1] neg_lo:[0,1,0]
    v_cvt_pk_bf16_f32 v251, v178, -v179
    ds_write_addtid_b32 v242 offset:2720
    ds_write_addtid_b32 v242 offset:3264
    ds_write_addtid_b32 v243 offset:3536
    ds_write_addtid_b32 v244 offset:3808
    ds_write_addtid_b32 v245 offset:4352
    ds_write_addtid_b32 v246 offset:4624
    ds_write_addtid_b32 v247 offset:4896
    ds_write_addtid_b32 v248 offset:5440
    ds_write_addtid_b32 v249 offset:5712
    ds_write_addtid_b32 v250 offset:5984
    buffer_load_dwordx4 a[36:39], v200, s[16:19], s101 offen offset:1024 sc1
    ds_write_addtid_b32 v251 offset:6528
    v_pk_mul_f32 v[194:195], v[178:179], v[186:187] op_sel:[0,0] op_sel_hi:[0,1]
    v_pk_fma_f32 v[174:175], v[178:179], v[186:187], v[194:195] op_sel:[1,1,0] op_sel_hi:[1,0,1] neg_lo:[0,1,0]
    v_cvt_pk_bf16_f32 v242, v174, -v175
    v_pk_mul_f32 v[194:195], v[178:179], v[190:191] op_sel:[0,0] op_sel_hi:[0,1]
    v_pk_fma_f32 v[176:177], v[178:179], v[190:191], v[194:195] op_sel:[1,1,0] op_sel_hi:[1,0,1] neg_lo:[0,1,0]
    v_cvt_pk_bf16_f32 v243, v176, -v177
    v_pk_mul_f32 v[194:195], v[176:177], v[186:187] op_sel:[0,0] op_sel_hi:[0,1]
    v_pk_fma_f32 v[174:175], v[176:177], v[186:187], v[194:195] op_sel:[1,1,0] op_sel_hi:[1,0,1] neg_lo:[0,1,0]
    v_cvt_pk_bf16_f32 v244, v174, -v175
    v_pk_mul_f32 v[194:195], v[176:177], v[190:191] op_sel:[0,0] op_sel_hi:[0,1]
    v_pk_fma_f32 v[178:179], v[176:177], v[190:191], v[194:195] op_sel:[1,1,0] op_sel_hi:[1,0,1] neg_lo:[0,1,0]
    v_cvt_pk_bf16_f32 v245, v178, -v179
    v_pk_mul_f32 v[194:195], v[178:179], v[186:187] op_sel:[0,0] op_sel_hi:[0,1]
    v_pk_fma_f32 v[174:175], v[178:179], v[186:187], v[194:195] op_sel:[1,1,0] op_sel_hi:[1,0,1] neg_lo:[0,1,0]
    buffer_load_dwordx4 a[40:43], v200, s[16:19], s101 offen offset:2048 sc1
    v_cvt_pk_bf16_f32 v246, v174, -v175
    v_pk_mul_f32 v[194:195], v[178:179], v[190:191] op_sel:[0,0] op_sel_hi:[0,1]
    v_pk_fma_f32 v[176:177], v[178:179], v[190:191], v[194:195] op_sel:[1,1,0] op_sel_hi:[1,0,1] neg_lo:[0,1,0]
    v_cvt_pk_bf16_f32 v247, v176, -v177
    v_pk_mul_f32 v[194:195], v[176:177], v[186:187] op_sel:[0,0] op_sel_hi:[0,1]
    v_pk_fma_f32 v[174:175], v[176:177], v[186:187], v[194:195] op_sel:[1,1,0] op_sel_hi:[1,0,1] neg_lo:[0,1,0]
    v_cvt_pk_bf16_f32 v248, v174, -v175
    ds_write_addtid_b32 v242 offset:6800
    ds_write_addtid_b32 v243 offset:7072
    ds_write_addtid_b32 v244 offset:7344
    ds_write_addtid_b32 v245 offset:7616
    ds_write_addtid_b32 v246 offset:7888
    ds_write_addtid_b32 v247 offset:8160
    ds_write_addtid_b32 v248 offset:8432
    ds_read_b128 a[192:195], v252 offset:0
    buffer_load_dwordx4 a[44:47], v200, s[16:19], s101 offen offset:3072 sc1
    ds_read_b128 a[196:199], v252 offset:32
    ds_read_b128 a[200:203], v252 offset:64
    ds_read_b128 a[204:207], v252 offset:96
    ds_read_b128 a[208:211], v252 offset:128
    ds_read_b128 a[212:215], v252 offset:160
    ds_read_b128 a[216:219], v252 offset:192
    ds_read_b128 a[220:223], v252 offset:224
    s_add_u32 m0, s92, 75520
    s_nop 0
    buffer_load_dwordx4 v75, s[4:7], s99 offen offset:2176  lds
    s_waitcnt lgkmcnt(7)
    v_mfma_f32_32x32x16_bf16 v[216:231], a[192:195], a[160:163], v[216:231]
    s_add_u32 m0, s92, 75520
    s_nop 0
    buffer_load_dwordx4 v76, s[4:7], s99 offen offset:3264  lds
    s_waitcnt lgkmcnt(6)
    v_mfma_f32_32x32x16_bf16 v[216:231], a[196:199], a[164:167], v[216:231]
    s_add_u32 m0, s93, 92928
    s_add_u32 s99, s99, 256
    s_add_u32 s101, s101, 4096
    buffer_load_dwordx4 a[48:51], v200, s[16:19], s101 offen offset:0 sc1
    s_mov_b64 exec, s[80:81]
    buffer_load_dwordx4 v77, s[4:7], s100 offen  lds
    s_mov_b64 exec, -1
    s_add_u32 s100, s100, 256
    s_waitcnt lgkmcnt(5)
    v_mfma_f32_32x32x16_bf16 v[216:231], a[200:203], a[168:171], v[216:231]
    s_add_u32 m0, s92, 95104
    s_nop 0
    buffer_load_dwordx4 v73, s[4:7], s99 offen offset:0  lds
    s_waitcnt lgkmcnt(4)
    v_mfma_f32_32x32x16_bf16 v[216:231], a[204:207], a[172:175], v[216:231]
    s_add_u32 m0, s92, 95104
    s_nop 0
    buffer_load_dwordx4 v74, s[4:7], s99 offen offset:1088  lds
    s_waitcnt lgkmcnt(3)
    v_mfma_f32_32x32x16_bf16 v[216:231], a[208:211], a[176:179], v[216:231]
    s_add_u32 m0, s92, 95104
    s_nop 0
    buffer_load_dwordx4 v75, s[4:7], s99 offen offset:2176  lds
    s_waitcnt lgkmcnt(2)
    v_mfma_f32_32x32x16_bf16 v[216:231], a[212:215], a[180:183], v[216:231]
    s_add_u32 m0, s92, 95104
    buffer_load_dwordx4 a[52:55], v200, s[16:19], s101 offen offset:1024 sc1
    buffer_load_dwordx4 v76, s[4:7], s99 offen offset:3264  lds
    s_waitcnt lgkmcnt(1)
    v_mfma_f32_32x32x16_bf16 v[216:231], a[216:219], a[184:187], v[216:231]
    s_add_u32 m0, s93, 112512
    s_add_u32 s99, s99, 256
    s_mov_b64 exec, s[80:81]
    buffer_load_dwordx4 v77, s[4:7], s100 offen  lds
    s_mov_b64 exec, -1
    s_add_u32 s100, s100, 256
    s_waitcnt lgkmcnt(0)
    v_mfma_f32_32x32x16_bf16 v[216:231], a[220:223], a[188:191], v[216:231]
    s_add_u32 m0, s92, 114688
    s_nop 0
    buffer_load_dwordx4 v73, s[4:7], s99 offen offset:0  lds
    s_add_u32 m0, s92, 114688
    s_nop 0
    buffer_load_dwordx4 v74, s[4:7], s99 offen offset:1088  lds
    s_add_u32 m0, s92, 114688
    s_nop 0
    buffer_load_dwordx4 v75, s[4:7], s99 offen offset:2176  lds
    s_add_u32 m0, s92, 114688
    s_nop 0
    buffer_load_dwordx4 v76, s[4:7], s99 offen offset:3264  lds
    s_add_u32 m0, s93, 132096
    s_add_u32 s99, s99, 256
    s_mov_b64 exec, s[80:81]
    buffer_load_dwordx4 v77, s[4:7], s100 offen  lds
    s_mov_b64 exec, -1
    s_add_u32 s100, s100, 256
    s_mov_b32 m0, s37
    s_branch ec_3
nc_2:
    s_cmp_lg_u32 s2, 255
    s_cbranch_scc1 fr_10
    v_mov_b32 v2, 1
    s_waitcnt vmcnt(9)
    s_barrier
    s_mov_b64 exec, 1
    global_store_dword v5, v2, s[66:67] sc1
    s_mov_b64 exec, -1
fr_10:
    s_sub_u32 s33, s2, 160
    s_min_u32 s33, s33, 159
    s_mul_i32 s29, s33, 3277
    s_lshr_b32 s29, s29, 16
    s_mul_i32 s30, s29, 20
    s_sub_u32 s30, s33, s30
    s_mul_i32 s31, s30, 13108
    s_lshr_b32 s31, s31, 16
    s_mul_i32 s32, s31, 5
    s_sub_u32 s32, s30, s32
    s_lshl_b32 s28, s24, 10
    s_lshr_b32 s34, s32, 1
    s_mul_i32 s34, s34, 20
    s_and_b32 s35, s32, 1
    s_lshl_b32 s35, s35, 3
    s_add_u32 s34, s34, s35
    s_cmp_eq_u32 s32, 4
    s_cselect_b32 s34, 16, s34
    s_cselect_b32 s35, 20, 4
    s_mul_i32 s36, s31, 160
    s_add_u32 s34, s34, s36
    s_mul_i32 s34, s34, 1280
    s_mul_i32 s36, s29, 160
    s_add_u32 s34, s34, s36
    v_add_u32 v162, 0, v0
    v_mul_u32_u24 v160, 6554, v162
    v_lshrrev_b32 v160, 16, v160
    v_mul_u32_u24 v161, 10, v160
    v_sub_u32 v161, v162, v161
    v_lshrrev_b32 v163, 3, v160
    v_mul_u32_u24 v163, 40, v163
    v_bfe_u32 v164, v160, 2, 1
    v_mul_u32_u24 v164, s35, v164
    v_and_b32 v160, 3, v160
    v_add3_u32 v160, v160, v163, v164
    v_mul_u32_u24 v160, 1280, v160
    v_lshl_add_u32 v162, v161, 4, v160
    s_add_u32 m0, s28, 0
    s_nop 0
    buffer_load_dwordx4 v162, s[12:15], s34 offen lds
    v_add_u32 v162, 256, v0
    v_min_u32 v162, 319, v162
    v_mul_u32_u24 v160, 6554, v162
    v_lshrrev_b32 v160, 16, v160
    v_mul_u32_u24 v161, 10, v160
    v_sub_u32 v161, v162, v161
    v_lshrrev_b32 v163, 3, v160
    v_mul_u32_u24 v163, 40, v163
    v_bfe_u32 v164, v160, 2, 1
    v_mul_u32_u24 v164, s35, v164
    v_and_b32_e64 v160, 3, v160
    v_add3_u32 v160, v160, v163, v164
    v_mul_u32_u24 v160, 1280, v160
    v_lshl_add_u32 v162, v161, 4, v160
    s_add_u32 m0, s28, 4096
    s_nop 0
    buffer_load_dwordx4 v162, s[12:15], s34 offen lds
    v_bfe_u32 v163, v0, 4, 2
    v_bfe_u32 v164, v0, 2, 2
    v_lshl_add_u32 v163, v163, 3, v164
    v_mul_u32_u24 v163, 160, v163
    v_and_b32 v164, 3, v0
    v_lshl_add_u32 v165, v164, 3, v163
    v_add_u32 v165, 0, v165
    s_lshl_b32 s36, s24, 5
    v_add_u32_e64 v166, s36, v165
    s_mul_i32 s33, s33, 5120
    s_add_u32 s33, s33, 2621440
    v_lshl_add_u32 v167, v1, 4, s33
    v_add_u32 v164, 4096, v167
    v_mov_b32 v163, 1073741824
    v_cmp_gt_u32 vcc, 64, v0
    s_sub_u32 s36, s24, s31
    s_and_b32 s36, s36, 3
    s_lshl_b32 s36, s36, 10
    v_cndmask_b32 v168, v163, v164, vcc
    v_add_u32 v167, s36, v167
    s_sub_u32 s33, s2, 64
    s_min_u32 s33, s33, 159
    s_mul_i32 s29, s33, 3277
    s_lshr_b32 s29, s29, 16
    s_mul_i32 s30, s29, 20
    s_sub_u32 s30, s33, s30
    s_mul_i32 s31, s30, 13108
    s_lshr_b32 s31, s31, 16
    s_mul_i32 s32, s31, 5
    s_sub_u32 s32, s30, s32
    s_lshl_b32 s28, s24, 10
    s_lshr_b32 s34, s32, 1
    s_mul_i32 s34, s34, 20
    s_and_b32 s35, s32, 1
    s_lshl_b32 s35, s35, 3
    s_add_u32 s34, s34, s35
    s_cmp_eq_u32 s32, 4
    s_cselect_b32 s34, 16, s34
    s_cselect_b32 s35, 20, 4
    s_mul_i32 s36, s31, 160
    s_add_u32 s34, s34, s36
    s_mul_i32 s34, s34, 1280
    s_mul_i32 s36, s29, 160
    s_add_u32 s34, s34, s36
    v_add_u32 v182, 0, v0
    v_mul_u32_u24 v180, 6554, v182
    v_lshrrev_b32 v180, 16, v180
    v_mul_u32_u24 v181, 10, v180
    v_sub_u32 v181, v182, v181
    v_lshrrev_b32 v183, 3, v180
    v_mul_u32_u24 v183, 40, v183
    v_bfe_u32 v184, v180, 2, 1
    v_mul_u32_u24 v184, s35, v184
    v_and_b32_e64 v180, 3, v180
    v_add3_u32 v180, v180, v183, v184
    v_mul_u32_u24 v180, 1280, v180
    v_lshl_add_u32 v182, v181, 4, v180
    s_add_u32 m0, s28, 8192
    s_nop 0
    buffer_load_dwordx4 v182, s[12:15], s34 offen lds
    v_add_u32 v182, 256, v0
    v_min_u32 v182, 319, v182
    v_mul_u32_u24 v180, 6554, v182
    v_lshrrev_b32 v180, 16, v180
    v_mul_u32_u24 v181, 10, v180
    v_sub_u32 v181, v182, v181
    v_lshrrev_b32 v183, 3, v180
    v_mul_u32_u24 v183, 40, v183
    v_bfe_u32 v184, v180, 2, 1
    v_mul_u32_u24 v184, s35, v184
    v_and_b32 v180, 3, v180
    v_add3_u32 v180, v180, v183, v184
    v_mul_u32_u24 v180, 1280, v180
    v_lshl_add_u32 v182, v181, 4, v180
    s_add_u32 m0, s28, 12288
    s_nop 0
    buffer_load_dwordx4 v182, s[12:15], s34 offen lds
    v_bfe_u32 v183, v0, 4, 2
    v_bfe_u32 v184, v0, 2, 2
    v_lshl_add_u32 v183, v183, 3, v184
    v_mul_u32_u24 v183, 160, v183
    v_and_b32 v184, 3, v0
    v_lshl_add_u32 v185, v184, 3, v183
    v_add_u32 v185, 8192, v185
    s_lshl_b32 s36, s24, 5
    v_add_u32 v186, s36, v185
    s_mul_i32 s33, s33, 5120
    s_add_u32 s33, s33, 2621440
    v_lshl_add_u32 v187, v1, 4, s33
    v_add_u32 v184, 4096, v187
    v_mov_b32 v183, 1073741824
    v_cmp_gt_u32 vcc, 64, v0
    s_sub_u32 s36, s24, s31
    s_and_b32 s36, s36, 3
    s_lshl_b32 s36, s36, 10
    v_cndmask_b32 v188, v183, v184, vcc
    v_add_u32 v187, s36, v187
    v_mov_b32 v216, 0
    v_mov_b32 v217, 0
    v_mov_b32 v218, 0
    v_mov_b32 v219, 0
    v_mov_b32 v220, 0
    v_mov_b32 v221, 0
    v_mov_b32 v222, 0
    v_mov_b32 v223, 0
    v_mov_b32 v224, 0
    v_mov_b32 v225, 0
    v_mov_b32 v226, 0
    v_mov_b32 v227, 0
    v_mov_b32 v228, 0
    v_mov_b32 v229, 0
    v_mov_b32 v230, 0
    v_mov_b32_e64 v231, 0
    s_waitcnt vmcnt(5)
    s_barrier
    ds_read_b64_tr_b16 v[96:97], v111
    ds_read_b64_tr_b16 v[98:99], v111 offset:2560
    ds_read_b64_tr_b16 v[100:101], v112
    ds_read_b64_tr_b16 v[102:103], v112 offset:2560
    ds_read_b64_tr_b16 v[104:105], v113
    ds_read_b64_tr_b16 v[106:107], v113 offset:2560
    s_waitcnt lgkmcnt(4)
    buffer_store_dwordx4 v[96:99], v108, s[16:19], 0 offen sc1
    s_waitcnt lgkmcnt(2)
    buffer_store_dwordx4 v[100:103], v109, s[16:19], 0 offen sc1
    s_waitcnt lgkmcnt(0)
    buffer_store_dwordx4 v[104:107], v110, s[16:19], 0 offen sc1
    global_load_dword v7, v5, s[66:67] sc1
    v_lshrrev_b32 v132, 5, v0
    v_and_b32_e64 v133, 31, v0
    v_mul_u32_u24 v132, 1280, v132
    v_lshl_add_u32 v134, v133, 4, v132
    v_mov_b32 v135, 1073741824
    v_cmp_gt_u32 vcc, 16, v133
    s_mul_i32 s96, s2, 10240
    buffer_load_dwordx4 v[120:123], v134, s[4:7], s96 offen
    v_cndmask_b32_e64 v135, v135, v134, vcc
    buffer_load_dwordx4 v[124:127], v134, s[4:7], s96 offen offset:512
    buffer_load_dwordx4 v[128:131], v135, s[4:7], s96 offen offset:1024
    s_waitcnt vmcnt(4)
    s_waitcnt vmcnt(3)
    v_cmp_gt_u32 vcc, 1, v7
    s_nop 0
    s_and_b64 vcc, vcc, s[50:51]
    s_and_b64 vcc, vcc, 1
    s_cbranch_scc1 ps_11
pc_13:
    s_barrier
    v_lshlrev_b32 v2, 3, v4
    v_mov_b32 v5, 1
    v_cndmask_b32 v2, v4, v2, s[50:51]
    buffer_atomic_add v5, v2, s[16:19], s86 offen offset:0 sc1
    ds_read_b64_tr_b16 v[172:173], v166
    ds_read_b64_tr_b16 v[174:175], v166 offset:640
    ds_read_b64_tr_b16 v[176:177], v165 offset:128
    ds_read_b64_tr_b16 v[178:179], v165 offset:768
    s_waitcnt lgkmcnt(2)
    buffer_store_dwordx4 v[172:175], v167, s[16:19], 0 offen sc1
    s_waitcnt lgkmcnt(0)
    buffer_store_dwordx4 v[176:179], v168, s[16:19], 0 offen sc1
    ds_read_b64_tr_b16 v[192:193], v186
    ds_read_b64_tr_b16 v[194:195], v186 offset:640
    ds_read_b64_tr_b16 v[196:197], v185 offset:128
    ds_read_b64_tr_b16 v[198:199], v185 offset:768
    s_waitcnt lgkmcnt(2)
    buffer_store_dwordx4 v[192:195], v187, s[16:19], 0 offen sc1
    s_waitcnt lgkmcnt(0)
    buffer_store_dwordx4 v[196:199], v188, s[16:19], 0 offen sc1
    v_mov_b32 v134, 0x3f803f80
    v_mov_b32 v132, 0
    v_mov_b32 v133, 0
    s_waitcnt vmcnt(7)
    v_dot2c_f32_bf16 v132, v120, v134
    v_dot2c_f32_bf16 v133, v120, v120
    v_dot2c_f32_bf16 v132, v121, v134
    v_dot2c_f32_bf16 v133, v121, v121
    v_dot2c_f32_bf16 v132, v122, v134
    v_dot2c_f32_bf16 v133, v122, v122
    v_dot2c_f32_bf16 v132, v123, v134
    v_dot2c_f32_bf16 v133, v123, v123
    s_waitcnt vmcnt(6)
    v_dot2c_f32_bf16 v132, v124, v134
    v_dot2c_f32_bf16 v133, v124, v124
    v_dot2c_f32_bf16 v132, v125, v134
    v_dot2c_f32_bf16 v133, v125, v125
    v_dot2c_f32_bf16 v132, v126, v134
    v_dot2c_f32_bf16 v133, v126, v126
    v_dot2c_f32_bf16 v132, v127, v134
    v_dot2c_f32_bf16 v133, v127, v127
    s_waitcnt vmcnt(5)
    v_dot2c_f32_bf16 v132, v128, v134
    v_dot2c_f32_bf16 v133, v128, v128
    v_dot2c_f32_bf16 v132, v129, v134
    v_dot2c_f32_bf16 v133, v129, v129
    v_dot2c_f32_bf16 v132, v130, v134
    v_dot2c_f32_bf16 v133, v130, v130
    v_dot2c_f32_bf16 v132, v131, v134
    v_dot2c_f32_bf16 v133, v131, v131
    v_lshrrev_b32 v135, 5, v0
    v_and_b32 v121, 3, v135
    v_lshrrev_b32 v135, 2, v135
    v_add_f32_dpp v132, v132, v132 row_shr:1 row_mask:0xf bank_mask:0xf bound_ctrl:0
    v_add_f32_dpp v133, v133, v133 row_shr:1 row_mask:0xf bank_mask:0xf bound_ctrl:0
    v_lshlrev_b32_e64 v135, 3, v135
    v_add_f32_dpp v132, v132, v132 row_shr:2 row_mask:0xf bank_mask:0xf bound_ctrl:0
    v_add_f32_dpp v133, v133, v133 row_shr:2 row_mask:0xf bank_mask:0xf bound_ctrl:0
    v_lshl_add_u32 v135, v121, 12, v135
    v_add_f32_dpp v132, v132, v132 row_shr:4 row_mask:0xf bank_mask:0xf bound_ctrl:0
    v_add_f32_dpp v133, v133, v133 row_shr:4 row_mask:0xf bank_mask:0xf bound_ctrl:0
    v_and_b32_e64 v121, 31, v0
    v_add_f32_dpp v132, v132, v132 row_shr:8 row_mask:0xf bank_mask:0xf bound_ctrl:0
    v_add_f32_dpp v133, v133, v133 row_shr:8 row_mask:0xf bank_mask:0xf bound_ctrl:0
    v_cmp_eq_u32_e64 vcc, 31, v121
    v_add_f32_dpp v132, v132, v132 row_bcast:15 row_mask:0xa bank_mask:0xf
    v_add_f32_dpp v133, v133, v133 row_bcast:15 row_mask:0xa bank_mask:0xf
    v_mov_b32 v121, 1073741824
    v_cndmask_b32_e64 v120, v121, v135, vcc
    s_lshl_b32 s96, s2, 4
    s_add_u32 s96, s96, 3440640
    v_mul_f32 v135, 0x3acccccd, v132
    v_mul_f32 v133, 0x3acccccd, v133
    v_fma_f32 v133, -v135, v135, v133
    v_max_f32 v133, 0, v133
    v_add_f32 v133, 0x3727c5ac, v133
    v_rsq_f32_e64 v132, v133
    s_nop 0
    v_mul_f32 v133, -v135, v132
    buffer_store_dwordx2 v[132:133], v120, s[16:19], s96 offen sc1
    s_add_u32 m0, s92, 36352
    s_nop 0
    s_nop 0
    buffer_load_dwordx4 v73, s[4:7], s99 offen offset:0  lds
    buffer_load_dwordx4 v74, s[4:7], s99 offen offset:1088  lds
    buffer_load_dwordx4 v75, s[4:7], s99 offen offset:2176  lds
    buffer_load_dwordx4 v76, s[4:7], s99 offen offset:3264  lds
    s_add_u32 m0, s93, 53760
    s_add_u32 s99, s99, 256
    s_mov_b64 exec, s[80:81]
    buffer_load_dwordx4 v77, s[4:7], s100 offen  lds
    s_mov_b64 exec, -1
    s_add_u32 s100, s100, 256
    s_add_u32 m0, s92, 55936
    s_nop 0
    s_nop 0
    buffer_load_dwordx4 v73, s[4:7], s99 offen offset:0  lds
    buffer_load_dwordx4 v74, s[4:7], s99 offen offset:1088  lds
    buffer_load_dwordx4 v75, s[4:7], s99 offen offset:2176  lds
    buffer_load_dwordx4 v76, s[4:7], s99 offen offset:3264  lds
    s_add_u32 m0, s93, 73344
    s_add_u32 s99, s99, 256
    s_mov_b64 exec, s[80:81]
    buffer_load_dwordx4 v77, s[4:7], s100 offen  lds
    s_mov_b64 exec, -1
    s_add_u32 s100, s100, 256
    v_mov_b32 v140, 1073741824
    v_lshlrev_b32 v141, 2, v0
    v_cmp_gt_u32 vcc, 64, v0
    s_nop 1
    v_cndmask_b32 v141, v140, v141, vcc
    v_mov_b32_e64 v140, 0
    s_lshl_b32 s97, s2, 8
    s_add_u32 s97, s97, 3473408
    buffer_store_dword v140, v141, s[16:19], s97 offen sc1
    v_mov_b32 v142, 1073741824
    v_lshlrev_b32 v143, 2, v0
    v_cmp_gt_u32 vcc, 16, v0
    s_nop 1
    v_cndmask_b32 v143, v142, v143, vcc
    v_mov_b32_e64 v142, -1
    s_lshl_b32 s97, s2, 6
    s_add_u32 s97, s97, 3457024
    buffer_store_dword v142, v143, s[16:19], s97 offen sc1
    v_mov_b32 v144, -1
    v_mov_b32 v145, -1
    v_mov_b32 v146, -1
    v_mov_b32 v147, -1
    v_lshlrev_b32 v148, 4, v0
    s_sub_u32 s88, s2, 0
    s_mul_i32 s88, s88, 20480
    s_min_u32 s88, s88, 5222400
    s_add_u32 s88, s88, 4194304
    buffer_store_dwordx4 v[144:147], v148, s[16:19], s88 offen sc1
    s_add_u32 s88, s88, 4096
    buffer_store_dwordx4 v[144:147], v148, s[16:19], s88 offen sc1
    s_add_u32 s88, s88, 4096
    buffer_store_dwordx4 v[144:147], v148, s[16:19], s88 offen sc1
    s_add_u32 s88, s88, 4096
    buffer_store_dwordx4 v[144:147], v148, s[16:19], s88 offen sc1
    s_add_u32 s88, s88, 4096
    buffer_store_dwordx4 v[144:147], v148, s[16:19], s88 offen sc1
    s_add_u32 m0, s92, 75520
    s_nop 0
    s_nop 0
    buffer_load_dwordx4 v73, s[4:7], s99 offen offset:0  lds
    buffer_load_dwordx4 v74, s[4:7], s99 offen offset:1088  lds
    buffer_load_dwordx4 v75, s[4:7], s99 offen offset:2176  lds
    buffer_load_dwordx4 v76, s[4:7], s99 offen offset:3264  lds
    s_add_u32 m0, s93, 92928
    s_add_u32 s99, s99, 256
    s_mov_b64 exec, s[80:81]
    buffer_load_dwordx4 v77, s[4:7], s100 offen  lds
    s_mov_b64 exec, -1
    s_add_u32 s100, s100, 256
    s_add_u32 m0, s92, 95104
    s_nop 0
    s_nop 0
    buffer_load_dwordx4 v73, s[4:7], s99 offen offset:0  lds
    buffer_load_dwordx4 v74, s[4:7], s99 offen offset:1088  lds
    buffer_load_dwordx4 v75, s[4:7], s99 offen offset:2176  lds
    buffer_load_dwordx4 v76, s[4:7], s99 offen offset:3264  lds
    s_add_u32 m0, s93, 112512
    s_add_u32 s99, s99, 256
    s_mov_b64 exec, s[80:81]
    buffer_load_dwordx4 v77, s[4:7], s100 offen  lds
    s_mov_b64 exec, -1
    s_add_u32 s100, s100, 256
    s_add_u32 m0, s92, 114688
    s_nop 0
    s_nop 0
    buffer_load_dwordx4 v73, s[4:7], s99 offen offset:0  lds
    buffer_load_dwordx4 v74, s[4:7], s99 offen offset:1088  lds
    buffer_load_dwordx4 v75, s[4:7], s99 offen offset:2176  lds
    buffer_load_dwordx4 v76, s[4:7], s99 offen offset:3264  lds
    s_add_u32 m0, s93, 132096
    s_add_u32 s99, s99, 256
    s_mov_b64 exec, s[80:81]
    buffer_load_dwordx4 v77, s[4:7], s100 offen  lds
    s_mov_b64 exec, -1
    s_add_u32 s100, s100, 256
    s_waitcnt vmcnt(15)
    buffer_load_dword v7, v4, s[16:19], s87 offen offset:0 sc1
    s_waitcnt vmcnt(0)
    v_cmp_gt_u32_e64 vcc, 32, v7
    s_nop 0
    s_and_b64 vcc, vcc, s[50:51]
    s_cbranch_scc1 ps_14
pc_16:
    s_barrier
    buffer_load_dwordx4 a[0:3], v200, s[16:19], s101 offen offset:0 sc1
    buffer_load_dwordx4 a[4:7], v200, s[16:19], s101 offen offset:1024 sc1
    buffer_load_dwordx4 a[8:11], v200, s[16:19], s101 offen offset:2048 sc1
    buffer_load_dwordx4 a[12:15], v200, s[16:19], s101 offen offset:3072 sc1
    s_add_u32 s101, s101, 4096
    buffer_load_dwordx4 a[16:19], v200, s[16:19], s101 offen offset:0 sc1
    buffer_load_dwordx4 a[20:23], v200, s[16:19], s101 offen offset:1024 sc1
    buffer_load_dwordx4 a[24:27], v200, s[16:19], s101 offen offset:2048 sc1
    buffer_load_dwordx4 a[28:31], v200, s[16:19], s101 offen offset:3072 sc1
    s_add_u32 s101, s101, 4096
    buffer_load_dwordx4 a[32:35], v200, s[16:19], s101 offen offset:0 sc1
    buffer_load_dwordx4 a[36:39], v200, s[16:19], s101 offen offset:1024 sc1
    buffer_load_dwordx4 a[40:43], v200, s[16:19], s101 offen offset:2048 sc1
    buffer_load_dwordx4 a[44:47], v200, s[16:19], s101 offen offset:3072 sc1
    s_add_u32 s101, s101, 4096
    buffer_load_dwordx4 a[48:51], v200, s[16:19], s101 offen offset:0 sc1
    buffer_load_dwordx4 a[52:55], v200, s[16:19], s101 offen offset:1024 sc1
ec_3:
    s_mul_i32 s25, s3, 18
    s_lshl_b32 s26, s72, 7
    s_add_u32 s25, s25, s26
    s_add_u32 s25, s25, s71
    s_add_u32 s25, s25, 1008
    s_max_i32 s25, s25, 0
    s_mul_i32 s25, s25, 1280
    v_lshrrev_b32 v206, 1, v0
    v_min_u32 v206, 89, v206
    v_mul_u32_u24 v207, 6554, v206
    v_lshrrev_b32_e64 v207, 16, v207
    v_mul_u32_u24 v207, 1280, v207
    v_lshl_add_u32 v206, v206, 7, v207
    buffer_load_dword v206, v206, s[4:7], s25 offen
    v_add_u32 v196, 36352, v78
    v_mov_b32 v198, v79
    v_xor_b32 v197, 32, v196
    s_barrier
    s_add_u32 s82, s86, 16384
    v_lshlrev_b32 v2, 3, v4
    v_mov_b32_e64 v5, 1
    v_cndmask_b32 v2, v4, v2, s[50:51]
    buffer_atomic_add v5, v2, s[16:19], s82 offen offset:8 sc1
    ds_read_b128 v[160:163], v198 offset:0
    ds_read_b128 v[164:167], v196 offset:0
    ds_read_b128 v[168:171], v196 offset:8704
    ds_read_b128 v[172:175], v198 offset:32
    ds_read_b128 v[176:179], v197 offset:0
    ds_read_b128 v[180:183], v197 offset:8704
    s_waitcnt lgkmcnt(3)
    s_waitcnt vmcnt(15)
    v_mfma_f32_16x16x32_bf16 v[112:115], a[0:3], v[160:163], 0
    ds_read_b128 v[184:187], v198 offset:64
    v_mfma_f32_32x32x16_bf16 v[80:95], a[0:3], v[164:167], 0
    ds_read_b128 v[188:191], v196 offset:64
    v_mov_b32 v208, 0
    v_mov_b32 v209, 0
    v_lshrrev_b32_e64 v210, 5, v0
    v_mul_u32_u24 v210, 1600, v210
    v_mfma_f32_32x32x16_bf16 v[96:111], a[0:3], v[168:171], 0
    ds_read_b128 v[192:195], v196 offset:8768
    buffer_load_dwordx4 a[56:59], v200, s[16:19], s101 offen offset:2048 sc1
    v_and_b32 v211, 31, v0
    v_min_u32 v211, 19, v211
    s_waitcnt lgkmcnt(3)
    s_waitcnt vmcnt(15)
    v_mfma_f32_16x16x32_bf16 v[112:115], a[4:7], v[172:175], v[112:115]
    ds_read_b128 v[160:163], v198 offset:96
    v_mfma_f32_32x32x16_bf16 v[80:95], a[4:7], v[176:179], v[80:95]
    ds_read_b128 v[164:167], v197 offset:64
    v_lshl_add_u32 v210, v211, 3, v210
    v_add_u32 v210, 6400, v210
    ds_write_b64 v210, v[208:209]
    s_mul_i32 s33, s24, 4160
    v_mfma_f32_32x32x16_bf16 v[96:111], a[4:7], v[180:183], v[96:111]
    ds_read_b128 v[168:171], v197 offset:8768
    buffer_load_dwordx4 a[60:63], v200, s[16:19], s101 offen offset:3072 sc1
    s_add_u32 s33, s33, 134272
    v_and_b32_e64 v250, 31, v1
    s_waitcnt lgkmcnt(4)
    s_waitcnt vmcnt(15)
    v_mfma_f32_16x16x32_bf16 v[112:115], a[8:11], v[184:187], v[112:115]
    ds_read_b128 v[172:175], v198 offset:128
    v_mfma_f32_32x32x16_bf16 v[80:95], a[8:11], v[188:191], v[80:95]
    ds_read_b128 v[176:179], v196 offset:128
    v_lshl_add_u32 v250, v250, 4, s33
    v_lshrrev_b32_e64 v253, 5, v1
    v_lshl_add_u32 v251, v253, 3, v250
    v_lshl_add_u32 v252, v253, 9, v250
    v_mfma_f32_32x32x16_bf16 v[96:111], a[8:11], v[192:195], v[96:111]
    ds_read_b128 v[180:183], v196 offset:8832
    s_add_u32 s101, s101, 4096
    buffer_load_dwordx4 a[64:67], v200, s[16:19], s101 offen offset:0 sc1
    v_lshl_add_u32 v250, v253, 10, v250
    s_waitcnt lgkmcnt(3)
    s_waitcnt vmcnt(15)
    v_mfma_f32_16x16x32_bf16 v[112:115], a[12:15], v[160:163], v[112:115]
    ds_read_b128 v[184:187], v198 offset:160
    v_mfma_f32_32x32x16_bf16 v[80:95], a[12:15], v[164:167], v[80:95]
    ds_read_b128 v[188:191], v197 offset:128
    v_cmp_eq_u32 vcc, 0, v1
    v_lshlrev_b32 v254, 16, v241
    v_min_u32 v253, 15, v1
    v_cndmask_b32 v254, 0, v254, vcc
    v_mfma_f32_32x32x16_bf16 v[96:111], a[12:15], v[168:171], v[96:111]
    ds_read_b128 v[192:195], v197 offset:8832
    buffer_load_dwordx4 a[68:71], v200, s[16:19], s101 offen offset:1024 sc1
    v_lshl_add_u32 v253, v253, 2, s33
    v_add_f32_e64 v216, v216, v254
    s_waitcnt lgkmcnt(3)
    s_waitcnt vmcnt(15)
    v_mfma_f32_16x16x32_bf16 v[112:115], a[16:19], v[172:175], v[112:115]
    ds_read_b128 v[160:163], v198 offset:192
    v_mfma_f32_32x32x16_bf16 v[80:95], a[16:19], v[176:179], v[80:95]
    ds_read_b128 v[164:167], v196 offset:192
    v_and_b32 v254, 1, v1
    v_cmp_eq_u32 vcc, 1, v254
    v_mov_b32_e64 v254, 0
    v_cvt_pk_bf16_f32 v242, v216, v217
    v_mfma_f32_32x32x16_bf16 v[96:111], a[16:19], v[180:183], v[96:111]
    ds_read_b128 v[168:171], v196 offset:8896
    buffer_load_dwordx4 a[72:75], v200, s[16:19], s101 offen offset:2048 sc1
    v_cvt_pk_bf16_f32 v243, v218, v219
    v_cvt_pk_bf16_f32 v244, v220, v220
    s_waitcnt lgkmcnt(3)
    s_waitcnt vmcnt(15)
    v_mfma_f32_16x16x32_bf16 v[112:115], a[20:23], v[184:187], v[112:115]
    ds_read_b128 v[172:175], v198 offset:224
    v_mfma_f32_32x32x16_bf16 v[80:95], a[20:23], v[188:191], v[80:95]
    ds_read_b128 v[176:179], v197 offset:192
    v_cvt_pk_bf16_f32 v245, v221, v222
    v_cvt_pk_bf16_f32 v246, v224, v224
    v_cvt_pk_bf16_f32 v247, v224, v225
    v_cvt_pk_bf16_f32 v248, v225, v225
    v_mfma_f32_32x32x16_bf16 v[96:111], a[20:23], v[192:195], v[96:111]
    ds_read_b128 v[180:183], v197 offset:8896
    buffer_load_dwordx4 a[76:79], v200, s[16:19], s101 offen offset:3072 sc1
    v_cvt_pk_bf16_f32 v249, v226, v226
    ds_write_b32 v253, v254
    s_barrier
    s_waitcnt lgkmcnt(4)
    s_waitcnt vmcnt(15)
    v_mfma_f32_16x16x32_bf16 v[112:115], a[24:27], v[160:163], v[112:115]
    v_add_u32 v198, v49, v198
    v_mfma_f32_32x32x16_bf16 v[80:95], a[24:27], v[164:167], v[80:95]
    v_add_u32 v196, 19584, v196
    v_add_u32 v197, 19584, v197
    ds_read_b128 v[184:187], v198 offset:0
    ds_write_b64 v251, v[242:243] offset:64
    ds_write_b64 v251, v[244:245] offset:576
    v_mfma_f32_32x32x16_bf16 v[96:111], a[24:27], v[168:171], v[96:111]
    ds_read_b128 v[188:191], v196 offset:0
    ds_read_b128 v[192:195], v196 offset:8704
    s_add_u32 s101, s101, 4096
    buffer_load_dwordx4 a[80:83], v200, s[16:19], s101 offen offset:0 sc1
    s_waitcnt lgkmcnt(6)
    s_waitcnt vmcnt(15)
    v_mfma_f32_16x16x32_bf16 v[112:115], a[28:31], v[172:175], v[112:115]
    ds_read_b128 v[160:163], v198 offset:32
    v_mfma_f32_32x32x16_bf16 v[80:95], a[28:31], v[176:179], v[80:95]
    ds_read_b128 v[164:167], v197 offset:0
    ds_write_b128 v252, v[246:249] offset:1088
    v_cndmask_b32 v255, v228, v229, vcc
    v_cvt_pk_bf16_f32 v216, v228, v228
    v_mov_b32 v217, v216
    v_mfma_f32_32x32x16_bf16 v[96:111], a[28:31], v[180:183], v[96:111]
    ds_read_b128 v[168:171], v197 offset:8704
    buffer_load_dwordx4 a[84:87], v200, s[16:19], s101 offen offset:1024 sc1
    v_cvt_pk_bf16_f32 v218, v255, v229
    v_cvt_pk_bf16_f32 v219, v229, v229
    s_waitcnt lgkmcnt(4)
    s_waitcnt vmcnt(15)
    v_mfma_f32_16x16x32_bf16 v[112:115], a[32:35], v[184:187], v[112:115]
    ds_read_b128 v[172:175], v198 offset:64
    v_mfma_f32_32x32x16_bf16 v[80:95], a[32:35], v[188:191], v[80:95]
    ds_read_b128 v[176:179], v196 offset:64
    ds_write_b128 v250, v[216:219] offset:2112
    v_cndmask_b32 v255, v230, v231, vcc
    v_cvt_pk_bf16_f32 v220, v230, v230
    v_mov_b32 v221, v220
    v_mfma_f32_32x32x16_bf16 v[96:111], a[32:35], v[192:195], v[96:111]
    ds_read_b128 v[180:183], v196 offset:8768
    buffer_load_dwordx4 a[88:91], v200, s[16:19], s101 offen offset:2048 sc1
    v_cvt_pk_bf16_f32 v222, v255, v231
    v_cvt_pk_bf16_f32 v223, v231, v231
    s_waitcnt lgkmcnt(4)
    s_waitcnt vmcnt(15)
    v_mfma_f32_16x16x32_bf16 v[112:115], a[36:39], v[160:163], v[112:115]
    ds_read_b128 v[184:187], v198 offset:96
    v_mfma_f32_32x32x16_bf16 v[80:95], a[36:39], v[164:167], v[80:95]
    ds_read_b128 v[188:191], v197 offset:64
    ds_write_b128 v250, v[220:223] offset:2624
    v_mfma_f32_32x32x16_bf16 v[96:111], a[36:39], v[168:171], v[96:111]
    ds_read_b128 v[192:195], v197 offset:8768
    buffer_load_dwordx4 a[92:95], v200, s[16:19], s101 offen offset:3072 sc1
    s_waitcnt lgkmcnt(4)
    s_waitcnt vmcnt(15)
    v_mfma_f32_16x16x32_bf16 v[112:115], a[40:43], v[172:175], v[112:115]
    ds_read_b128 v[160:163], v198 offset:128
    v_mfma_f32_32x32x16_bf16 v[80:95], a[40:43], v[176:179], v[80:95]
    ds_read_b128 v[164:167], v196 offset:128
    v_mfma_f32_32x32x16_bf16 v[96:111], a[40:43], v[180:183], v[96:111]
    ds_read_b128 v[168:171], v196 offset:8832
    s_add_u32 s101, s101, 4096
    buffer_load_dwordx4 a[96:99], v200, s[16:19], s101 offen offset:0 sc1
    s_waitcnt lgkmcnt(3)
    s_waitcnt vmcnt(15)
    v_mfma_f32_16x16x32_bf16 v[112:115], a[44:47], v[184:187], v[112:115]
    ds_read_b128 v[172:175], v198 offset:160
    v_mfma_f32_32x32x16_bf16 v[80:95], a[44:47], v[188:191], v[80:95]
    ds_read_b128 v[176:179], v197 offset:128
    v_mfma_f32_32x32x16_bf16 v[96:111], a[44:47], v[192:195], v[96:111]
    ds_read_b128 v[180:183], v197 offset:8832
    buffer_load_dwordx4 a[100:103], v200, s[16:19], s101 offen offset:1024 sc1
    s_waitcnt lgkmcnt(3)
    s_waitcnt vmcnt(15)
    v_mfma_f32_16x16x32_bf16 v[112:115], a[48:51], v[160:163], v[112:115]
    ds_read_b128 v[184:187], v198 offset:192
    v_mfma_f32_32x32x16_bf16 v[80:95], a[48:51], v[164:167], v[80:95]
    ds_read_b128 v[188:191], v196 offset:192
    v_mfma_f32_32x32x16_bf16 v[96:111], a[48:51], v[168:171], v[96:111]
    ds_read_b128 v[192:195], v196 offset:8896
    buffer_load_dwordx4 a[104:107], v200, s[16:19], s101 offen offset:2048 sc1
    s_waitcnt lgkmcnt(3)
    s_waitcnt vmcnt(15)
    v_mfma_f32_16x16x32_bf16 v[112:115], a[52:55], v[172:175], v[112:115]
    ds_read_b128 v[160:163], v198 offset:224
    v_mfma_f32_32x32x16_bf16 v[80:95], a[52:55], v[176:179], v[80:95]
    ds_read_b128 v[164:167], v197 offset:192
    v_mfma_f32_32x32x16_bf16 v[96:111], a[52:55], v[180:183], v[96:111]
    ds_read_b128 v[168:171], v197 offset:8896
    buffer_load_dwordx4 a[108:111], v200, s[16:19], s101 offen offset:3072 sc1
    s_barrier
    s_waitcnt lgkmcnt(3)
    s_waitcnt vmcnt(13)
    v_mfma_f32_16x16x32_bf16 v[112:115], a[56:59], v[184:187], v[112:115]
    v_add_u32 v198, v49, v198
    v_mfma_f32_32x32x16_bf16 v[80:95], a[56:59], v[188:191], v[80:95]
    v_add_u32 v196, 19584, v196
    v_add_u32 v197, 19584, v197
    ds_read_b128 v[172:175], v198 offset:0
    v_mfma_f32_32x32x16_bf16 v[96:111], a[56:59], v[192:195], v[96:111]
    ds_read_b128 v[176:179], v196 offset:0
    ds_read_b128 v[180:183], v196 offset:8704
    s_add_u32 s101, s101, 4096
    buffer_load_dwordx4 a[112:115], v200, s[16:19], s101 offen offset:0 sc1
    s_waitcnt lgkmcnt(3)
    s_waitcnt vmcnt(13)
    v_mfma_f32_16x16x32_bf16 v[112:115], a[60:63], v[160:163], v[112:115]
    ds_read_b128 v[184:187], v198 offset:32
    v_mfma_f32_32x32x16_bf16 v[80:95], a[60:63], v[164:167], v[80:95]
    ds_read_b128 v[188:191], v197 offset:0
    v_mfma_f32_32x32x16_bf16 v[96:111], a[60:63], v[168:171], v[96:111]
    ds_read_b128 v[192:195], v197 offset:8704
    buffer_load_dwordx4 a[116:119], v200, s[16:19], s101 offen offset:1024 sc1
    s_waitcnt lgkmcnt(3)
    s_waitcnt vmcnt(13)
    v_mfma_f32_16x16x32_bf16 v[112:115], a[64:67], v[172:175], v[112:115]
    ds_read_b128 v[160:163], v198 offset:64
    v_mfma_f32_32x32x16_bf16 v[80:95], a[64:67], v[176:179], v[80:95]
    ds_read_b128 v[164:167], v196 offset:64
    v_mfma_f32_32x32x16_bf16 v[96:111], a[64:67], v[180:183], v[96:111]
    ds_read_b128 v[168:171], v196 offset:8768
    buffer_load_dwordx4 a[120:123], v200, s[16:19], s101 offen offset:2048 sc1
    s_waitcnt lgkmcnt(3)
    s_waitcnt vmcnt(13)
    v_mfma_f32_16x16x32_bf16 v[112:115], a[68:71], v[184:187], v[112:115]
    ds_read_b128 v[172:175], v198 offset:96
    v_mfma_f32_32x32x16_bf16 v[80:95], a[68:71], v[188:191], v[80:95]
    ds_read_b128 v[176:179], v197 offset:64
    v_mfma_f32_32x32x16_bf16 v[96:111], a[68:71], v[192:195], v[96:111]
    ds_read_b128 v[180:183], v197 offset:8768
    buffer_load_dwordx4 a[124:127], v200, s[16:19], s101 offen offset:3072 sc1
    s_waitcnt lgkmcnt(3)
    s_waitcnt vmcnt(13)
    v_mfma_f32_16x16x32_bf16 v[112:115], a[72:75], v[160:163], v[112:115]
    ds_read_b128 v[184:187], v198 offset:128
    v_mfma_f32_32x32x16_bf16 v[80:95], a[72:75], v[164:167], v[80:95]
    ds_read_b128 v[188:191], v196 offset:128
    v_mfma_f32_32x32x16_bf16 v[96:111], a[72:75], v[168:171], v[96:111]
    ds_read_b128 v[192:195], v196 offset:8832
    s_add_u32 s101, s101, 4096
    buffer_load_dwordx4 a[128:131], v200, s[16:19], s101 offen offset:0 sc1
    s_waitcnt lgkmcnt(3)
    s_waitcnt vmcnt(13)
    v_mfma_f32_16x16x32_bf16 v[112:115], a[76:79], v[172:175], v[112:115]
    ds_read_b128 v[160:163], v198 offset:160
    v_mfma_f32_32x32x16_bf16 v[80:95], a[76:79], v[176:179], v[80:95]
    ds_read_b128 v[164:167], v197 offset:128
    v_mfma_f32_32x32x16_bf16 v[96:111], a[76:79], v[180:183], v[96:111]
    ds_read_b128 v[168:171], v197 offset:8832
    buffer_load_dwordx4 a[132:135], v200, s[16:19], s101 offen offset:1024 sc1
    s_waitcnt lgkmcnt(3)
    s_waitcnt vmcnt(13)
    v_mfma_f32_16x16x32_bf16 v[112:115], a[80:83], v[184:187], v[112:115]
    ds_read_b128 v[172:175], v198 offset:192
    v_mfma_f32_32x32x16_bf16 v[80:95], a[80:83], v[188:191], v[80:95]
    ds_read_b128 v[176:179], v196 offset:192
    v_mfma_f32_32x32x16_bf16 v[96:111], a[80:83], v[192:195], v[96:111]
    ds_read_b128 v[180:183], v196 offset:8896
    buffer_load_dwordx4 a[136:139], v200, s[16:19], s101 offen offset:2048 sc1
    s_waitcnt lgkmcnt(3)
    s_waitcnt vmcnt(13)
    v_mfma_f32_16x16x32_bf16 v[112:115], a[84:87], v[160:163], v[112:115]
    ds_read_b128 v[184:187], v198 offset:224
    v_mfma_f32_32x32x16_bf16 v[80:95], a[84:87], v[164:167], v[80:95]
    ds_read_b128 v[188:191], v197 offset:192
    v_mfma_f32_32x32x16_bf16 v[96:111], a[84:87], v[168:171], v[96:111]
    ds_read_b128 v[192:195], v197 offset:8896
    buffer_load_dwordx4 a[140:143], v200, s[16:19], s101 offen offset:3072 sc1
    s_barrier
    s_waitcnt lgkmcnt(3)
    s_waitcnt vmcnt(13)
    v_mfma_f32_16x16x32_bf16 v[112:115], a[88:91], v[172:175], v[112:115]
    v_add_u32 v198, v49, v198
    v_mfma_f32_32x32x16_bf16 v[80:95], a[88:91], v[176:179], v[80:95]
    v_add_u32 v196, 19584, v196
    v_add_u32 v197, 19584, v197
    ds_read_b128 v[160:163], v198 offset:0
    v_mfma_f32_32x32x16_bf16 v[96:111], a[88:91], v[180:183], v[96:111]
    ds_read_b128 v[164:167], v196 offset:0
    ds_read_b128 v[168:171], v196 offset:8704
    s_add_u32 s101, s101, 4096
    buffer_load_dword v7, v4, s[16:19], s89 offen offset:8 sc1
    s_waitcnt lgkmcnt(3)
    s_waitcnt vmcnt(13)
    v_mfma_f32_16x16x32_bf16 v[112:115], a[92:95], v[184:187], v[112:115]
    ds_read_b128 v[172:175], v198 offset:32
    v_mfma_f32_32x32x16_bf16 v[80:95], a[92:95], v[188:191], v[80:95]
    ds_read_b128 v[176:179], v197 offset:0
    v_mfma_f32_32x32x16_bf16 v[96:111], a[92:95], v[192:195], v[96:111]
    ds_read_b128 v[180:183], v197 offset:8704
    buffer_load_dwordx4 a[144:147], v200, s[16:19], s101 offen offset:0 sc1
    s_waitcnt lgkmcnt(3)
    s_waitcnt vmcnt(13)
    v_mfma_f32_16x16x32_bf16 v[112:115], a[96:99], v[160:163], v[112:115]
    ds_read_b128 v[184:187], v198 offset:64
    v_mfma_f32_32x32x16_bf16 v[80:95], a[96:99], v[164:167], v[80:95]
    ds_read_b128 v[188:191], v196 offset:64
    v_mfma_f32_32x32x16_bf16 v[96:111], a[96:99], v[168:171], v[96:111]
    ds_read_b128 v[192:195], v196 offset:8768
    buffer_load_dwordx4 a[148:151], v200, s[16:19], s101 offen offset:1024 sc1
    s_waitcnt lgkmcnt(3)
    s_waitcnt vmcnt(13)
    v_mfma_f32_16x16x32_bf16 v[112:115], a[100:103], v[172:175], v[112:115]
    ds_read_b128 v[160:163], v198 offset:96
    v_mfma_f32_32x32x16_bf16 v[80:95], a[100:103], v[176:179], v[80:95]
    ds_read_b128 v[164:167], v197 offset:64
    v_mfma_f32_32x32x16_bf16 v[96:111], a[100:103], v[180:183], v[96:111]
    ds_read_b128 v[168:171], v197 offset:8768
    buffer_load_dwordx4 a[152:155], v200, s[16:19], s101 offen offset:2048 sc1
    s_waitcnt lgkmcnt(3)
    s_waitcnt vmcnt(13)
    v_mfma_f32_16x16x32_bf16 v[112:115], a[104:107], v[184:187], v[112:115]
    ds_read_b128 v[172:175], v198 offset:128
    v_mfma_f32_32x32x16_bf16 v[80:95], a[104:107], v[188:191], v[80:95]
    ds_read_b128 v[176:179], v196 offset:128
    v_mfma_f32_32x32x16_bf16 v[96:111], a[104:107], v[192:195], v[96:111]
    ds_read_b128 v[180:183], v196 offset:8832
    buffer_load_dwordx4 a[156:159], v200, s[16:19], s101 offen offset:3072 sc1
    s_waitcnt lgkmcnt(3)
    s_waitcnt vmcnt(13)
    v_mfma_f32_16x16x32_bf16 v[112:115], a[108:111], v[160:163], v[112:115]
    ds_read_b128 v[184:187], v198 offset:160
    v_mfma_f32_32x32x16_bf16 v[80:95], a[108:111], v[164:167], v[80:95]
    ds_read_b128 v[188:191], v197 offset:128
    v_mfma_f32_32x32x16_bf16 v[96:111], a[108:111], v[168:171], v[96:111]
    ds_read_b128 v[192:195], v197 offset:8832
    s_add_u32 s101, s101, 4096
    s_lshl_b32 s25, s72, 5
    s_add_u32 s25, s25, 256
    s_sub_u32 s26, s25, 4
    s_max_i32 s26, s26, 0
    s_mul_i32 s27, s71, 1280
    s_mul_i32 s99, s25, 5120
    s_mul_i32 s100, s26, 5120
    s_mul_i32 s92, s24, 4352
    s_mul_i32 s93, s24, 544
    s_add_u32 s99, s99, s27
    s_add_u32 s100, s100, s27
    s_waitcnt lgkmcnt(3)
    s_waitcnt vmcnt(12)
    v_mfma_f32_16x16x32_bf16 v[112:115], a[112:115], v[172:175], v[112:115]
    ds_read_b128 v[160:163], v198 offset:192
    v_mfma_f32_32x32x16_bf16 v[80:95], a[112:115], v[176:179], v[80:95]
    ds_read_b128 v[164:167], v196 offset:192
    v_mfma_f32_32x32x16_bf16 v[96:111], a[112:115], v[180:183], v[96:111]
    ds_read_b128 v[168:171], v196 offset:8896
    s_waitcnt lgkmcnt(3)
    s_waitcnt vmcnt(11)
    v_mfma_f32_16x16x32_bf16 v[112:115], a[116:119], v[184:187], v[112:115]
    ds_read_b128 v[172:175], v198 offset:224
    v_mfma_f32_32x32x16_bf16 v[80:95], a[116:119], v[188:191], v[80:95]
    ds_read_b128 v[176:179], v197 offset:192
    v_mfma_f32_32x32x16_bf16 v[96:111], a[116:119], v[192:195], v[96:111]
    ds_read_b128 v[180:183], v197 offset:8896
    s_waitcnt vmcnt(4)
    v_cmp_gt_u32 vcc, 32, v7
    s_nop 0
    s_and_b64 vcc, vcc, s[50:51]
    s_cbranch_scc1 ps_17
pc_19:
    s_barrier
    s_waitcnt lgkmcnt(3)
    v_mfma_f32_16x16x32_bf16 v[112:115], a[120:123], v[160:163], v[112:115]
    v_add_u32_e64 v198, v49, v198
    v_mfma_f32_32x32x16_bf16 v[80:95], a[120:123], v[164:167], v[80:95]
    v_add_u32 v196, 19584, v196
    v_add_u32 v197, 19584, v197
    s_lshl_b32 s31, s24, 7
    s_add_u32 s31, s31, 159744
    v_bfe_u32 v132, v1, 3, 1
    v_mfma_f32_32x32x16_bf16 v[96:111], a[120:123], v[168:171], v[96:111]
    ds_read_b128 v[184:187], v198 offset:0
    ds_read_b128 v[188:191], v196 offset:0
    s_lshl_b32 s98, s72, 5
    s_add_u32 s98, s98, 0
    s_sub_u32 s95, s98, 4
    s_max_i32 s95, s95, 0
    s_lshl_b32 s94, s98, 3
    s_lshl_b32 s95, s95, 3
    s_add_u32 s94, s94, 3440640
    s_add_u32 s95, s95, 3440640
    s_add_u32 s96, s94, 8192
    buffer_load_dwordx2 v[152:153], v47, s[16:19], s94 offen sc1
    v_lshrrev_b32 v133, 4, v1
    v_lshl_add_u32 v132, v132, 2, v133
    s_waitcnt lgkmcnt(2)
    v_mfma_f32_16x16x32_bf16 v[112:115], a[124:127], v[172:175], v[112:115]
    ds_read_b128 v[192:195], v198 offset:32
    v_mfma_f32_32x32x16_bf16 v[80:95], a[124:127], v[176:179], v[80:95]
    ds_read_b128 v[160:163], v197 offset:0
    v_lshl_add_u32 v132, v132, 4, s31
    v_lshrrev_b32 v133, 5, v1
    v_lshl_add_u32 v133, v133, 4, s31
    v_mfma_f32_32x32x16_bf16 v[96:111], a[124:127], v[180:183], v[96:111]
    buffer_load_dwordx2 v[154:155], v47, s[16:19], s96 offen sc1
    s_waitcnt lgkmcnt(2)
    v_mfma_f32_16x16x32_bf16 v[112:115], a[128:131], v[184:187], v[112:115]
    ds_read_b128 v[164:167], v198 offset:64
    v_mfma_f32_32x32x16_bf16 v[80:95], a[128:131], v[188:191], v[80:95]
    ds_read_b128 v[168:171], v196 offset:64
    s_waitcnt lgkmcnt(2)
    v_mfma_f32_16x16x32_bf16 v[112:115], a[132:135], v[192:195], v[112:115]
    ds_read_b128 v[172:175], v198 offset:96
    v_mfma_f32_32x32x16_bf16 v[80:95], a[132:135], v[160:163], v[80:95]
    ds_read_b128 v[176:179], v197 offset:64
    buffer_load_dwordx2 v[156:157], v48, s[16:19], s95 offen sc1
    s_waitcnt lgkmcnt(2)
    v_mfma_f32_16x16x32_bf16 v[112:115], a[136:139], v[164:167], v[112:115]
    ds_read_b128 v[180:183], v198 offset:128
    v_mfma_f32_32x32x16_bf16 v[80:95], a[136:139], v[168:171], v[80:95]
    ds_read_b128 v[184:187], v196 offset:128
    s_waitcnt lgkmcnt(2)
    v_mfma_f32_16x16x32_bf16 v[112:115], a[140:143], v[172:175], v[112:115]
    ds_read_b128 v[188:191], v198 offset:160
    v_mfma_f32_32x32x16_bf16 v[80:95], a[140:143], v[176:179], v[80:95]
    ds_read_b128 v[192:195], v197 offset:128
    s_add_u32 m0, s92, 36352
    s_nop 0
    buffer_load_dwordx4 v73, s[4:7], s99 offen offset:0  lds
    s_waitcnt lgkmcnt(2)
    s_waitcnt vmcnt(7)
    v_mfma_f32_16x16x32_bf16 v[112:115], a[144:147], v[180:183], v[112:115]
    ds_read_b128 v[160:163], v198 offset:192
    v_mfma_f32_32x32x16_bf16 v[80:95], a[144:147], v[184:187], v[80:95]
    ds_read_b128 v[164:167], v196 offset:192
    s_waitcnt lgkmcnt(2)
    s_waitcnt vmcnt(6)
    v_mfma_f32_16x16x32_bf16 v[112:115], a[148:151], v[188:191], v[112:115]
    ds_read_b128 v[168:171], v198 offset:224
    v_mfma_f32_32x32x16_bf16 v[80:95], a[148:151], v[192:195], v[80:95]
    ds_read_b128 v[172:175], v197 offset:192
    buffer_load_dwordx4 v74, s[4:7], s99 offen offset:1088  lds
    s_waitcnt lgkmcnt(2)
    s_waitcnt vmcnt(6)
    v_mfma_f32_16x16x32_bf16 v[112:115], a[152:155], v[160:163], v[112:115]
    ds_read_b128 v[176:179], v196 offset:8704
    v_mfma_f32_32x32x16_bf16 v[80:95], a[152:155], v[164:167], v[80:95]
    ds_read_b128 v[180:183], v197 offset:8704
    s_waitcnt lgkmcnt(2)
    s_waitcnt vmcnt(5)
    v_mfma_f32_16x16x32_bf16 v[112:115], a[156:159], v[168:171], v[112:115]
    ds_read_b128 v[184:187], v196 offset:8768
    v_mfma_f32_32x32x16_bf16 v[80:95], a[156:159], v[172:175], v[80:95]
    ds_read_b128 v[188:191], v197 offset:8768
    buffer_load_dwordx4 v75, s[4:7], s99 offen offset:2176  lds
    s_waitcnt lgkmcnt(2)
    v_mfma_f32_32x32x16_bf16 v[96:111], a[128:131], v[176:179], v[96:111]
    ds_read_b128 v[192:195], v196 offset:8832
    v_mfma_f32_32x32x16_bf16 v[96:111], a[132:135], v[180:183], v[96:111]
    ds_read_b128 v[160:163], v197 offset:8832
    buffer_load_dwordx4 v76, s[4:7], s99 offen offset:3264  lds
    s_mov_b32 exec_lo, 0x01010101
    s_mov_b32 exec_hi, 0x01010101
    ds_write_b128 v132, v[112:115]
    s_mov_b64 exec, -1
    s_waitcnt lgkmcnt(3)
    v_mfma_f32_32x32x16_bf16 v[96:111], a[136:139], v[184:187], v[96:111]
    ds_read_b128 v[164:167], v196 offset:8896
    ds_read_b128 v[24:27], v132
    ds_read_b128 v[8:11], v133 offset:0
    ds_read_b128 v[12:15], v133 offset:32
    ds_read_b128 v[16:19], v133 offset:64
    v_mfma_f32_32x32x16_bf16 v[96:111], a[140:143], v[188:191], v[96:111]
    ds_read_b128 v[168:171], v197 offset:8896
    s_add_u32 m0, s93, 53760
    s_add_u32 s99, s99, 256
    s_mov_b64 exec, s[80:81]
    buffer_load_dwordx4 v77, s[4:7], s100 offen  lds
    s_mov_b64 exec, -1
    s_add_u32 s100, s100, 256
    ds_read_b128 v[20:23], v133 offset:96
    s_waitcnt vmcnt(5) lgkmcnt(5)
    v_mul_f32 v148, v24, v157
    v_mfma_f32_32x32x16_bf16 v[96:111], a[144:147], v[192:195], v[96:111]
    v_mul_f32 v149, v25, v157
    v_mul_f32 v150, v26, v157
    v_mul_f32 v151, v27, v157
    s_waitcnt lgkmcnt(4)
    v_mul_f32 v116, v8, v153
    v_mul_f32 v117, v9, v153
    v_mfma_f32_32x32x16_bf16 v[96:111], a[148:151], v[160:163], v[96:111]
    v_mul_f32 v118, v10, v153
    v_mul_f32 v119, v11, v153
    s_waitcnt lgkmcnt(3)
    v_mul_f32 v120, v12, v153
    v_mul_f32 v121, v13, v153
    s_waitcnt lgkmcnt(1)
    v_mfma_f32_32x32x16_bf16 v[96:111], a[152:155], v[164:167], v[96:111]
    v_mul_f32 v122, v14, v153
    v_mul_f32 v123, v15, v153
    v_mul_f32 v124, v16, v153
    v_mul_f32 v125, v17, v153
    v_mul_f32_e64 v126, v18, v153
    v_mfma_f32_32x32x16_bf16 v[96:111], a[156:159], v[168:171], v[96:111]
    s_add_u32 m0, s92, 55936
    s_nop 0
    buffer_load_dwordx4 v73, s[4:7], s99 offen offset:0  lds
    v_mul_f32 v127, v19, v153
    s_waitcnt lgkmcnt(0)
    v_mul_f32 v128, v20, v153
    v_mul_f32 v129, v21, v153
    v_mul_f32 v130, v22, v153
    v_mul_f32_e64 v131, v23, v153
    v_fma_f32 v112, v112, v156, v148
    v_fma_f32 v113, v113, v156, v149
    v_fma_f32 v114, v114, v156, v150
    v_fma_f32 v115, v115, v156, v151
    v_cvt_pk_bf16_f32 v112, v112, v113
    v_cvt_pk_bf16_f32 v113, v114, v115
    v_fma_f32 v80, v80, v152, v116
    v_fma_f32 v81, v81, v152, v117
    v_fma_f32 v82, v82, v152, v118
    v_fma_f32 v83, v83, v152, v119
    v_cvt_pk_bf16_f32 v80, v80, v81
    v_cvt_pk_bf16_f32 v81, v82, v83
    ds_write_b64 v40, v[112:113] offset:0
    ds_write_b64 v38, v[80:81] offset:0
    v_fma_f32 v84, v84, v152, v120
    v_fma_f32 v85, v85, v152, v121
    v_fma_f32 v86, v86, v152, v122
    v_fma_f32 v87, v87, v152, v123
    v_cvt_pk_bf16_f32 v84, v84, v85
    v_cvt_pk_bf16_f32 v85, v86, v87
    v_fma_f32 v88, v88, v152, v124
    v_fma_f32 v89, v89, v152, v125
    v_fma_f32 v90, v90, v152, v126
    v_fma_f32 v91, v91, v152, v127
    v_cvt_pk_bf16_f32 v88, v88, v89
    v_cvt_pk_bf16_f32 v89, v90, v91
    ds_write_b64 v38, v[84:85] offset:6400
    ds_write_b64 v38, v[88:89] offset:12800
    v_fma_f32 v92, v92, v152, v128
    v_fma_f32 v93, v93, v152, v129
    v_fma_f32 v94, v94, v152, v130
    v_fma_f32 v95, v95, v152, v131
    v_cvt_pk_bf16_f32 v92, v92, v93
    v_cvt_pk_bf16_f32 v93, v94, v95
    ds_write_b64 v39, v[92:93] offset:0
    v_mul_f32 v132, v8, v155
    v_mul_f32 v133, v9, v155
    v_mul_f32 v134, v10, v155
    v_mul_f32 v135, v11, v155
    v_mul_f32 v136, v12, v155
    v_mul_f32 v137, v13, v155
    v_mul_f32 v138, v14, v155
    v_mul_f32 v139, v15, v155
    v_mul_f32 v140, v16, v155
    v_mul_f32 v141, v17, v155
    v_mul_f32 v142, v18, v155
    v_mul_f32 v143, v19, v155
    v_mul_f32 v144, v20, v155
    v_mul_f32 v145, v21, v155
    v_mul_f32 v146, v22, v155
    v_mul_f32 v147, v23, v155
    v_pk_fma_f32 v[96:97], v[96:97], v[154:155], v[132:133] op_sel_hi:[1,0,1]
    v_pk_fma_f32 v[98:99], v[98:99], v[154:155], v[134:135] op_sel_hi:[1,0,1]
    v_cvt_pk_bf16_f32 v96, v96, v97
    v_cvt_pk_bf16_f32 v97, v98, v99
    v_pk_fma_f32 v[100:101], v[100:101], v[154:155], v[136:137] op_sel_hi:[1,0,1]
    v_pk_fma_f32 v[102:103], v[102:103], v[154:155], v[138:139] op_sel_hi:[1,0,1]
    v_cvt_pk_bf16_f32 v100, v100, v101
    v_cvt_pk_bf16_f32 v101, v102, v103
    ds_write_b64 v38, v[96:97] offset:1600
    ds_write_b64 v38, v[100:101] offset:8000
    v_pk_fma_f32 v[104:105], v[104:105], v[154:155], v[140:141] op_sel_hi:[1,0,1]
    v_pk_fma_f32 v[106:107], v[106:107], v[154:155], v[142:143] op_sel_hi:[1,0,1]
    v_cvt_pk_bf16_f32 v104, v104, v105
    v_cvt_pk_bf16_f32 v105, v106, v107
    v_pk_fma_f32 v[108:109], v[108:109], v[154:155], v[144:145] op_sel_hi:[1,0,1]
    v_pk_fma_f32 v[110:111], v[110:111], v[154:155], v[146:147] op_sel_hi:[1,0,1]
    v_cvt_pk_bf16_f32 v108, v108, v109
    v_cvt_pk_bf16_f32 v109, v110, v111
    ds_write_b64 v38, v[104:105] offset:14400
    ds_write_b64 v39, v[108:109] offset:1600
    s_waitcnt lgkmcnt(0)
    s_barrier
    v_mov_b32 v94, 0
    v_mov_b32 v95, 0
    v_mov_b32 v98, 0
    v_mov_b32 v99, 0
    s_mov_b64 exec, 0xffff
    ds_read_b64 v[94:95], v42 offset:320
    ds_read_b64 v[98:99], v42 offset:640
    s_mov_b64 exec, -1
    s_nop 0
    ds_read_b64 v[92:93], v41 offset:320
    ds_read_b64 v[96:97], v41 offset:640
    ds_read_b64 v[84:85], v41 offset:6720
    ds_read_b64 v[86:87], v42 offset:6720
    ds_read_b64 v[80:81], v41 offset:6400
    ds_read_b64 v[82:83], v42 offset:6400
    ds_read_b64 v[88:89], v41 offset:7040
    ds_read_b64 v[90:91], v42 offset:7040
    ds_read_b64_tr_b16 v[106:107], v44 offset:0
    ds_read_b64_tr_b16 v[100:101], v43 offset:0
    ds_read_b64_tr_b16 v[108:109], v44 offset:320
    ds_read_b64_tr_b16 v[102:103], v43 offset:320
    buffer_load_dwordx4 v74, s[4:7], s99 offen offset:1088  lds
    ds_read_b64_tr_b16 v[110:111], v44 offset:640
    ds_read_b64_tr_b16 v[104:105], v43 offset:640
    v_mov_b32 v156, 0xf149f2ca
    v_cndmask_b32 v152, v32, v156, s[90:91]
    v_cndmask_b32 v153, v33, v156, s[90:91]
    v_cndmask_b32 v154, v34, v156, s[90:91]
    v_cndmask_b32 v155, v35, v156, s[90:91]
    s_mov_b32 s82, 0x3ea52b5c
    buffer_load_dwordx4 v75, s[4:7], s99 offen offset:2176  lds
    s_lshl_b32 s25, s98, 4
    s_add_u32 s25, s25, 4194304
    s_lshl_b32 s26, s98, 3
    s_add_u32 s26, s26, 4194304
    s_waitcnt lgkmcnt(10)
    v_mfma_f32_16x16x32_bf16 v[116:119], v[84:87], v[92:95], v[28:31]
    v_mfma_f32_16x16x32_bf16 v[120:123], v[84:87], v[96:99], v[32:35]
    s_waitcnt lgkmcnt(8)
    v_mfma_f32_16x16x32_bf16 v[112:115], v[80:83], v[92:95], v[152:155]
    s_waitcnt lgkmcnt(6)
    v_mfma_f32_16x16x32_bf16 v[124:127], v[88:91], v[96:99], v[28:31]
    buffer_load_dwordx4 v76, s[4:7], s99 offen offset:3264  lds
    s_nop 4
    v_max_f32 v112, v112, v116
    v_max_f32 v113, v113, v117
    v_max_f32 v114, v114, v118
    v_max_f32 v115, v115, v119
    v_max3_f32 v156, v112, v113, v114
    v_max_f32 v156, v156, v115
    v_max_f32 v120, v120, v124
    v_max_f32_e64 v121, v121, v125
    s_add_u32 m0, s93, 73344
    s_add_u32 s99, s99, 256
    s_mov_b64 exec, s[80:81]
    buffer_load_dwordx4 v77, s[4:7], s100 offen  lds
    s_mov_b64 exec, -1
    s_add_u32 s100, s100, 256
    v_max_f32 v122, v122, v126
    v_max_f32 v123, v123, v127
    v_max3_f32 v157, v120, v121, v122
    v_max_f32 v157, v157, v123
    s_nop 1
    v_permlane16_swap_b32 v156, v157
    v_max_f32 v156, v156, v157
    v_mov_b32 v157, v156
    s_nop 1
    v_permlane32_swap_b32 v156, v157
    s_add_u32 m0, s92, 75520
    s_nop 0
    buffer_load_dwordx4 v73, s[4:7], s99 offen offset:0  lds
    v_max_f32 v156, v156, v157
    v_mul_f32 v156, s82, v156
    v_mov_b32 v157, v156
    s_nop 1
    v_permlane16_swap_b32_e64 v156, v157
    v_fma_f32 v112, v112, s82, -v156
    v_fma_f32 v113, v113, s82, -v156
    v_fma_f32 v114, v114, s82, -v156
    v_fma_f32 v115, v115, s82, -v156
    buffer_load_dwordx4 v74, s[4:7], s99 offen offset:1088  lds
    v_exp_f32 v112, v112
    v_exp_f32 v113, v113
    v_exp_f32 v114, v114
    v_exp_f32 v115, v115
    v_cvt_pk_bf16_f32 v116, v112, v113
    v_cvt_pk_bf16_f32 v117, v114, v115
    v_bfi_b32 v128, v36, 0, v116
    v_and_b32_e64 v130, v36, v116
    buffer_load_dwordx4 v75, s[4:7], s99 offen offset:2176  lds
    v_bfi_b32 v129, v37, 0, v117
    v_and_b32 v131, v37, v117
    s_waitcnt lgkmcnt(3)
    s_nop 0
    v_mfma_f32_16x16x32_bf16 v[144:147], v[106:109], v[128:131], 0
    s_waitcnt lgkmcnt(2)
    v_mfma_f32_16x16x32_bf16 v[136:139], v[100:103], v[128:131], 0
    v_fma_f32 v120, v120, s82, -v157
    v_fma_f32 v121, v121, s82, -v157
    v_fma_f32 v122, v122, s82, -v157
    v_fma_f32 v123, v123, s82, -v157
    buffer_load_dwordx4 v76, s[4:7], s99 offen offset:3264  lds
    v_exp_f32 v120, v120
    v_exp_f32 v121, v121
    v_exp_f32 v122, v122
    v_exp_f32 v123, v123
    v_cvt_pk_bf16_f32 v124, v120, v121
    v_cvt_pk_bf16_f32 v125, v122, v123
    v_bfi_b32 v132, v36, 0, v124
    v_and_b32_e64 v134, v36, v124
    s_add_u32 m0, s93, 92928
    s_add_u32 s99, s99, 256
    s_mov_b64 exec, s[80:81]
    buffer_load_dwordx4 v77, s[4:7], s100 offen  lds
    s_mov_b64 exec, -1
    s_add_u32 s100, s100, 256
    v_bfi_b32 v133, v37, 0, v125
    v_and_b32 v135, v37, v125
    s_waitcnt lgkmcnt(1)
    s_nop 0
    v_mfma_f32_16x16x32_bf16 v[148:151], v[108:111], v[132:135], 0
    s_waitcnt lgkmcnt(0)
    v_mfma_f32_16x16x32_bf16 v[140:143], v[102:105], v[132:135], 0
    v_mov_b32 v158, v144
    s_nop 1
    v_permlane16_swap_b32 v144, v158
    v_rcp_f32 v158, v158
    s_nop 0
    v_pk_mul_f32 v[136:137], v[136:137], v[158:159] op_sel_hi:[1,0]
    s_lshl_b32 s97, s73, 2
    s_add_u32 s97, s97, s24
    s_nop 0
    s_mul_i32 s97, s97, 25600
    s_add_u32 s97, s97, 2621440
    buffer_load_dwordx4 a[160:163], v58, s[16:19], s97 offen offset:0 sc1
    v_pk_mul_f32 v[138:139], v[138:139], v[158:159] op_sel_hi:[1,0]
    v_pk_mul_f32 v[144:145], v[144:145], v[158:159] op_sel_hi:[1,0]
    v_pk_mul_f32 v[146:147], v[146:147], v[158:159] op_sel_hi:[1,0]
    v_cvt_pk_bf16_f32 v112, v136, v137
    v_cvt_pk_bf16_f32 v116, v144, v145
    v_cvt_pk_bf16_f32 v113, v138, v139
    v_cvt_pk_bf16_f32 v117, v146, v147
    v_mov_b32 v160, v148
    buffer_load_dwordx4 a[164:167], v58, s[16:19], s97 offen offset:1024 sc1
    s_nop 0
    v_permlane16_swap_b32 v148, v160
    v_rcp_f32_e64 v160, v160
    s_nop 0
    v_pk_mul_f32 v[140:141], v[140:141], v[160:161] op_sel_hi:[1,0]
    v_pk_mul_f32 v[142:143], v[142:143], v[160:161] op_sel_hi:[1,0]
    v_pk_mul_f32 v[148:149], v[148:149], v[160:161] op_sel_hi:[1,0]
    v_pk_mul_f32 v[150:151], v[150:151], v[160:161] op_sel_hi:[1,0]
    v_cvt_pk_bf16_f32 v114, v140, v141
    v_cvt_pk_bf16_f32 v118, v148, v149
    buffer_load_dwordx4 a[168:171], v58, s[16:19], s97 offen offset:2048 sc1
    v_cvt_pk_bf16_f32 v115, v142, v143
    v_cvt_pk_bf16_f32 v119, v150, v151
    v_permlane16_swap_b32 v112, v114
    v_permlane16_swap_b32 v113, v115
    v_permlane16_swap_b32 v116, v118
    v_permlane16_swap_b32 v117, v119
    buffer_store_dwordx4 v[112:115], v45, s[16:19], s25 offen sc1
    s_mov_b64 exec, s[80:81]
    buffer_store_dwordx2 v[116:117], v46, s[16:19], s26 offen sc1
    s_mov_b64 exec, -1
    buffer_load_dwordx4 a[172:175], v58, s[16:19], s97 offen offset:3072 sc1
    s_add_u32 s97, s97, 4096
    buffer_load_dwordx4 a[176:179], v58, s[16:19], s97 offen offset:0 sc1
    v_add_u32 v196, 36352, v78
    v_mov_b32 v198, v79
    v_xor_b32 v197, 32, v196
    s_waitcnt vmcnt(17)
    s_barrier
    ds_read_b128 v[160:163], v198 offset:0
    ds_read_b128 v[164:167], v196 offset:0
    ds_read_b128 v[168:171], v196 offset:8704
    ds_read_b128 v[172:175], v198 offset:32
    ds_read_b128 v[176:179], v197 offset:0
    ds_read_b128 v[180:183], v197 offset:8704
    s_waitcnt lgkmcnt(3)
    v_mfma_f32_16x16x32_bf16 v[112:115], a[0:3], v[160:163], 0
    ds_read_b128 v[184:187], v198 offset:64
    v_mfma_f32_32x32x16_bf16 v[80:95], a[0:3], v[164:167], 0
    ds_read_b128 v[188:191], v196 offset:64
    v_mfma_f32_32x32x16_bf16 v[96:111], a[0:3], v[168:171], 0
    ds_read_b128 v[192:195], v196 offset:8768
    s_add_u32 m0, s92, 95104
    s_nop 0
    buffer_load_dwordx4 v73, s[4:7], s99 offen offset:0  lds
    s_waitcnt lgkmcnt(3)
    v_mfma_f32_16x16x32_bf16 v[112:115], a[4:7], v[172:175], v[112:115]
    ds_read_b128 v[160:163], v198 offset:96
    v_mfma_f32_32x32x16_bf16 v[80:95], a[4:7], v[176:179], v[80:95]
    ds_read_b128 v[164:167], v197 offset:64
    v_mfma_f32_32x32x16_bf16 v[96:111], a[4:7], v[180:183], v[96:111]
    ds_read_b128 v[168:171], v197 offset:8768
    buffer_load_dwordx4 v74, s[4:7], s99 offen offset:1088  lds
    s_waitcnt lgkmcnt(3)
    v_mfma_f32_16x16x32_bf16 v[112:115], a[8:11], v[184:187], v[112:115]
    ds_read_b128 v[172:175], v198 offset:128
    v_mfma_f32_32x32x16_bf16 v[80:95], a[8:11], v[188:191], v[80:95]
    ds_read_b128 v[176:179], v196 offset:128
    v_mfma_f32_32x32x16_bf16 v[96:111], a[8:11], v[192:195], v[96:111]
    ds_read_b128 v[180:183], v196 offset:8832
    buffer_load_dwordx4 v75, s[4:7], s99 offen offset:2176  lds
    s_waitcnt lgkmcnt(3)
    v_mfma_f32_16x16x32_bf16 v[112:115], a[12:15], v[160:163], v[112:115]
    ds_read_b128 v[184:187], v198 offset:160
    v_mfma_f32_32x32x16_bf16 v[80:95], a[12:15], v[164:167], v[80:95]
    ds_read_b128 v[188:191], v197 offset:128
    v_mfma_f32_32x32x16_bf16 v[96:111], a[12:15], v[168:171], v[96:111]
    ds_read_b128 v[192:195], v197 offset:8832
    buffer_load_dwordx4 v76, s[4:7], s99 offen offset:3264  lds
    s_waitcnt lgkmcnt(3)
    v_mfma_f32_16x16x32_bf16 v[112:115], a[16:19], v[172:175], v[112:115]
    ds_read_b128 v[160:163], v198 offset:192
    v_mfma_f32_32x32x16_bf16 v[80:95], a[16:19], v[176:179], v[80:95]
    ds_read_b128 v[164:167], v196 offset:192
    v_mfma_f32_32x32x16_bf16 v[96:111], a[16:19], v[180:183], v[96:111]
    ds_read_b128 v[168:171], v196 offset:8896
    s_add_u32 m0, s93, 112512
    s_add_u32 s99, s99, 256
    s_mov_b64 exec, s[80:81]
    buffer_load_dwordx4 v77, s[4:7], s100 offen  lds
    s_mov_b64 exec, -1
    s_add_u32 s100, s100, 256
    s_waitcnt lgkmcnt(3)
    v_mfma_f32_16x16x32_bf16 v[112:115], a[20:23], v[184:187], v[112:115]
    ds_read_b128 v[172:175], v198 offset:224
    v_mfma_f32_32x32x16_bf16 v[80:95], a[20:23], v[188:191], v[80:95]
    ds_read_b128 v[176:179], v197 offset:192
    v_mfma_f32_32x32x16_bf16 v[96:111], a[20:23], v[192:195], v[96:111]
    ds_read_b128 v[180:183], v197 offset:8896
    s_add_u32 m0, s92, 114688
    s_nop 0
    buffer_load_dwordx4 v73, s[4:7], s99 offen offset:0  lds
    s_waitcnt vmcnt(18)
    s_barrier
    s_waitcnt lgkmcnt(3)
    v_mfma_f32_16x16x32_bf16 v[112:115], a[24:27], v[160:163], v[112:115]
    v_add_u32 v198, v49, v198
    v_mfma_f32_32x32x16_bf16 v[80:95], a[24:27], v[164:167], v[80:95]
    v_add_u32 v196, 19584, v196
    v_add_u32 v197, 19584, v197
    ds_read_b128 v[184:187], v198 offset:0
    v_mfma_f32_32x32x16_bf16 v[96:111], a[24:27], v[168:171], v[96:111]
    ds_read_b128 v[188:191], v196 offset:0
    ds_read_b128 v[192:195], v196 offset:8704
    buffer_load_dwordx4 v74, s[4:7], s99 offen offset:1088  lds
    s_waitcnt lgkmcnt(3)
    v_mfma_f32_16x16x32_bf16 v[112:115], a[28:31], v[172:175], v[112:115]
    ds_read_b128 v[160:163], v198 offset:32
    v_mfma_f32_32x32x16_bf16 v[80:95], a[28:31], v[176:179], v[80:95]
    ds_read_b128 v[164:167], v197 offset:0
    v_mfma_f32_32x32x16_bf16 v[96:111], a[28:31], v[180:183], v[96:111]
    ds_read_b128 v[168:171], v197 offset:8704
    buffer_load_dwordx4 v75, s[4:7], s99 offen offset:2176  lds
    s_waitcnt lgkmcnt(3)
    v_mfma_f32_16x16x32_bf16 v[112:115], a[32:35], v[184:187], v[112:115]
    ds_read_b128 v[172:175], v198 offset:64
    v_mfma_f32_32x32x16_bf16 v[80:95], a[32:35], v[188:191], v[80:95]
    ds_read_b128 v[176:179], v196 offset:64
    v_mfma_f32_32x32x16_bf16 v[96:111], a[32:35], v[192:195], v[96:111]
    ds_read_b128 v[180:183], v196 offset:8768
    buffer_load_dwordx4 v76, s[4:7], s99 offen offset:3264  lds
    s_waitcnt lgkmcnt(3)
    v_mfma_f32_16x16x32_bf16 v[112:115], a[36:39], v[160:163], v[112:115]
    ds_read_b128 v[184:187], v198 offset:96
    v_mfma_f32_32x32x16_bf16 v[80:95], a[36:39], v[164:167], v[80:95]
    ds_read_b128 v[188:191], v197 offset:64
    v_mfma_f32_32x32x16_bf16 v[96:111], a[36:39], v[168:171], v[96:111]
    ds_read_b128 v[192:195], v197 offset:8768
    s_add_u32 m0, s93, 132096
    s_add_u32 s99, s99, 256
    s_mov_b64 exec, s[80:81]
    buffer_load_dwordx4 v77, s[4:7], s100 offen  lds
    s_mov_b64 exec, -1
    s_add_u32 s100, s100, 256
    s_waitcnt lgkmcnt(3)
    v_mfma_f32_16x16x32_bf16 v[112:115], a[40:43], v[172:175], v[112:115]
    ds_read_b128 v[160:163], v198 offset:128
    v_mfma_f32_32x32x16_bf16 v[80:95], a[40:43], v[176:179], v[80:95]
    ds_read_b128 v[164:167], v196 offset:128
    s_lshl_b32 s25, s24, 6
    s_and_b32 s35, s74, 3
    s_lshl_b32 s35, s35, 13
    s_add_u32 s35, s35, s25
    v_mfma_f32_32x32x16_bf16 v[96:111], a[40:43], v[180:183], v[96:111]
    ds_read_b128 v[168:171], v196 offset:8832
    s_lshl_b32 s98, s72, 5
    s_add_u32 s98, s98, 256
    s_sub_u32 s95, s98, 4
    s_max_i32 s95, s95, 0
    s_lshl_b32 s94, s98, 3
    s_lshl_b32 s95, s95, 3
    s_add_u32 s94, s94, 3440640
    s_add_u32 s95, s95, 3440640
    s_add_u32 s96, s94, 8192
    buffer_load_dwordx2 v[152:153], v47, s[16:19], s94 offen sc1
    s_waitcnt lgkmcnt(3)
    v_mfma_f32_16x16x32_bf16 v[112:115], a[44:47], v[184:187], v[112:115]
    ds_read_b128 v[172:175], v198 offset:160
    v_mfma_f32_32x32x16_bf16 v[80:95], a[44:47], v[188:191], v[80:95]
    ds_read_b128 v[176:179], v197 offset:128
    s_lshr_b32 s25, s74, 4
    s_lshl_b32 s25, s25, 11
    s_add_u32 s35, s35, s25
    s_and_b32 s25, s74, 12
    v_mfma_f32_32x32x16_bf16 v[96:111], a[44:47], v[192:195], v[96:111]
    ds_read_b128 v[180:183], v197 offset:8832
    buffer_load_dwordx2 v[154:155], v47, s[16:19], s96 offen sc1
    s_lshl_b32 s25, s25, 6
    s_add_u32 s35, s35, s25
    s_waitcnt lgkmcnt(3)
    v_mfma_f32_16x16x32_bf16 v[112:115], a[48:51], v[160:163], v[112:115]
    ds_read_b128 v[184:187], v198 offset:192
    v_mfma_f32_32x32x16_bf16 v[80:95], a[48:51], v[164:167], v[80:95]
    ds_read_b128 v[188:191], v196 offset:192
    s_mul_i32 s36, s73, 20
    s_add_u32 s36, s36, s24
    s_add_u32 s36, s36, 16
    s_lshl_b32 s36, s36, 14
    v_mfma_f32_32x32x16_bf16 v[96:111], a[48:51], v[168:171], v[96:111]
    ds_read_b128 v[192:195], v196 offset:8896
    buffer_load_dwordx2 v[156:157], v48, s[16:19], s95 offen sc1
    v_add_u32 v199, 36352, v58
    s_lshl_b32 s32, s24, 11
    s_waitcnt lgkmcnt(3)
    v_mfma_f32_16x16x32_bf16 v[112:115], a[52:55], v[172:175], v[112:115]
    ds_read_b128 v[160:163], v198 offset:224
    v_mfma_f32_32x32x16_bf16 v[80:95], a[52:55], v[176:179], v[80:95]
    ds_read_b128 v[164:167], v197 offset:192
    v_add_u32 v203, s32, v199
    s_add_u32 s32, s24, 1
    s_and_b32 s32, s32, 3
    s_mul_i32 s32, s32, 6144
    v_mfma_f32_32x32x16_bf16 v[96:111], a[52:55], v[180:183], v[96:111]
    ds_read_b128 v[168:171], v197 offset:8896
    buffer_load_dwordx4 a[180:183], v58, s[16:19], s97 offen offset:1024 sc1
    v_add_u32 v200, s32, v199
    s_add_u32 s32, s24, 2
    s_waitcnt vmcnt(21)
    s_barrier
    s_waitcnt lgkmcnt(3)
    v_mfma_f32_16x16x32_bf16 v[112:115], a[56:59], v[184:187], v[112:115]
    v_add_u32 v198, v49, v198
    v_mfma_f32_32x32x16_bf16 v[80:95], a[56:59], v[188:191], v[80:95]
    v_add_u32 v196, 19584, v196
    v_add_u32 v197, 19584, v197
    ds_read_b128 v[172:175], v198 offset:0
    s_and_b32 s32, s32, 3
    s_mul_i32 s32, s32, 6144
    v_mfma_f32_32x32x16_bf16 v[96:111], a[56:59], v[192:195], v[96:111]
    ds_read_b128 v[176:179], v196 offset:0
    ds_read_b128 v[180:183], v196 offset:8704
    buffer_load_dwordx4 a[184:187], v58, s[16:19], s97 offen offset:2048 sc1
    v_add_u32_e64 v201, s32, v199
    s_waitcnt lgkmcnt(3)
    v_mfma_f32_16x16x32_bf16 v[112:115], a[60:63], v[160:163], v[112:115]
    ds_read_b128 v[184:187], v198 offset:32
    v_mfma_f32_32x32x16_bf16 v[80:95], a[60:63], v[164:167], v[80:95]
    ds_read_b128 v[188:191], v197 offset:0
    s_add_u32 s32, s24, 3
    s_and_b32 s32, s32, 3
    s_mul_i32 s32, s32, 6144
    v_add_u32_e64 v202, s32, v199
    v_mfma_f32_32x32x16_bf16 v[96:111], a[60:63], v[168:171], v[96:111]
    ds_read_b128 v[192:195], v197 offset:8704
    buffer_load_dwordx4 a[188:191], v58, s[16:19], s97 offen offset:3072 sc1
    s_mul_i32 s32, s24, 6144
    v_add_u32 v204, s32, v199
    s_waitcnt lgkmcnt(3)
    v_mfma_f32_16x16x32_bf16 v[112:115], a[64:67], v[172:175], v[112:115]
    ds_read_b128 v[160:163], v198 offset:64
    v_mfma_f32_32x32x16_bf16 v[80:95], a[64:67], v[176:179], v[80:95]
    ds_read_b128 v[164:167], v196 offset:64
    s_lshl_b32 s32, s24, 8
    s_add_u32 s32, s32, 36352
    v_and_b32 v214, 15, v1
    v_lshl_add_u32 v206, v214, 4, s32
    v_mfma_f32_32x32x16_bf16 v[96:111], a[64:67], v[180:183], v[96:111]
    ds_read_b128 v[168:171], v196 offset:8768
    s_add_u32 s97, s97, 4096
    buffer_load_dwordx4 a[192:195], v58, s[16:19], s97 offen offset:0 sc1
    v_lshrrev_b32 v215, 5, v1
    s_waitcnt lgkmcnt(3)
    v_mfma_f32_16x16x32_bf16 v[112:115], a[68:71], v[184:187], v[112:115]
    ds_read_b128 v[172:175], v198 offset:96
    v_mfma_f32_32x32x16_bf16 v[80:95], a[68:71], v[188:191], v[80:95]
    ds_read_b128 v[176:179], v197 offset:64
    v_lshl_add_u32 v205, v215, 10, v206
    v_bfe_u32 v215, v1, 4, 1
    v_lshl_add_u32 v205, v215, 3, v205
    v_lshlrev_b32_e64 v214, 2, v214
    v_mfma_f32_32x32x16_bf16 v[96:111], a[68:71], v[192:195], v[96:111]
    ds_read_b128 v[180:183], v197 offset:8768
    buffer_load_dwordx4 a[196:199], v58, s[16:19], s97 offen offset:1024 sc1
    v_lshl_add_u32 v214, v215, 10, v214
    s_lshl_b32 s32, s24, 6
    s_waitcnt lgkmcnt(3)
    v_mfma_f32_16x16x32_bf16 v[112:115], a[72:75], v[160:163], v[112:115]
    ds_read_b128 v[184:187], v198 offset:128
    v_mfma_f32_32x32x16_bf16 v[80:95], a[72:75], v[164:167], v[80:95]
    ds_read_b128 v[188:191], v196 offset:128
    v_lshl_add_u32 v207, v215, 3, s32
    v_and_b32 v215, 12, v1
    v_lshl_add_u32 v207, v215, 2, v207
    v_and_b32 v215, 2, v1
    v_mfma_f32_32x32x16_bf16 v[96:111], a[72:75], v[168:171], v[96:111]
    ds_read_b128 v[192:195], v196 offset:8832
    buffer_load_dwordx4 a[200:203], v58, s[16:19], s97 offen offset:2048 sc1
    v_lshl_add_u32 v207, v215, 1, v207
    v_add_u32 v207, 69120, v207
    s_waitcnt lgkmcnt(3)
    v_mfma_f32_16x16x32_bf16 v[112:115], a[76:79], v[172:175], v[112:115]
    ds_read_b128 v[160:163], v198 offset:160
    v_mfma_f32_32x32x16_bf16 v[80:95], a[76:79], v[176:179], v[80:95]
    ds_read_b128 v[164:167], v197 offset:128
    v_lshrrev_b32 v215, 4, v1
    v_lshl_add_u32 v206, v215, 2, v206
    v_mov_b32 v215, 0x3f803f80
    v_mfma_f32_32x32x16_bf16 v[96:111], a[76:79], v[180:183], v[96:111]
    ds_read_b128 v[168:171], v197 offset:8832
    buffer_load_dwordx4 a[204:207], v58, s[16:19], s97 offen offset:3072 sc1
    s_waitcnt lgkmcnt(3)
    v_mfma_f32_16x16x32_bf16 v[112:115], a[80:83], v[184:187], v[112:115]
    ds_read_b128 v[172:175], v198 offset:192
    v_mfma_f32_32x32x16_bf16 v[80:95], a[80:83], v[188:191], v[80:95]
    ds_read_b128 v[176:179], v196 offset:192
    v_mfma_f32_32x32x16_bf16 v[96:111], a[80:83], v[192:195], v[96:111]
    ds_read_b128 v[180:183], v196 offset:8896
    s_add_u32 s97, s97, 4096
    buffer_load_dwordx4 a[208:211], v58, s[16:19], s97 offen offset:0 sc1
    s_waitcnt lgkmcnt(3)
    v_mfma_f32_16x16x32_bf16 v[112:115], a[84:87], v[160:163], v[112:115]
    ds_read_b128 v[184:187], v198 offset:224
    v_mfma_f32_32x32x16_bf16 v[80:95], a[84:87], v[164:167], v[80:95]
    ds_read_b128 v[188:191], v197 offset:192
    v_mfma_f32_32x32x16_bf16 v[96:111], a[84:87], v[168:171], v[96:111]
    ds_read_b128 v[192:195], v197 offset:8896
    buffer_load_dwordx4 a[212:215], v58, s[16:19], s97 offen offset:1024 sc1
    s_waitcnt vmcnt(17)
    s_barrier
    s_waitcnt lgkmcnt(3)
    v_mfma_f32_16x16x32_bf16 v[112:115], a[88:91], v[172:175], v[112:115]
    v_add_u32 v198, v49, v198
    v_mfma_f32_32x32x16_bf16 v[80:95], a[88:91], v[176:179], v[80:95]
    v_add_u32 v196, 19584, v196
    v_add_u32 v197, 19584, v197
    ds_read_b128 v[160:163], v198 offset:0
    v_mfma_f32_32x32x16_bf16 v[96:111], a[88:91], v[180:183], v[96:111]
    ds_read_b128 v[164:167], v196 offset:0
    ds_read_b128 v[168:171], v196 offset:8704
    buffer_load_dwordx4 a[216:219], v58, s[16:19], s97 offen offset:2048 sc1
    s_waitcnt lgkmcnt(3)
    v_mfma_f32_16x16x32_bf16 v[112:115], a[92:95], v[184:187], v[112:115]
    ds_read_b128 v[172:175], v198 offset:32
    v_mfma_f32_32x32x16_bf16 v[80:95], a[92:95], v[188:191], v[80:95]
    ds_read_b128 v[176:179], v197 offset:0
    v_mfma_f32_32x32x16_bf16 v[96:111], a[92:95], v[192:195], v[96:111]
    ds_read_b128 v[180:183], v197 offset:8704
    buffer_load_dwordx4 a[220:223], v58, s[16:19], s97 offen offset:3072 sc1
    s_waitcnt lgkmcnt(3)
    v_mfma_f32_16x16x32_bf16 v[112:115], a[96:99], v[160:163], v[112:115]
    ds_read_b128 v[184:187], v198 offset:64
    v_mfma_f32_32x32x16_bf16 v[80:95], a[96:99], v[164:167], v[80:95]
    ds_read_b128 v[188:191], v196 offset:64
    v_mfma_f32_32x32x16_bf16 v[96:111], a[96:99], v[168:171], v[96:111]
    ds_read_b128 v[192:195], v196 offset:8768
    s_add_u32 s97, s97, 4096
    buffer_load_dwordx4 a[224:227], v58, s[16:19], s97 offen offset:0 sc1
    s_waitcnt lgkmcnt(3)
    v_mfma_f32_16x16x32_bf16 v[112:115], a[100:103], v[172:175], v[112:115]
    ds_read_b128 v[160:163], v198 offset:96
    v_mfma_f32_32x32x16_bf16 v[80:95], a[100:103], v[176:179], v[80:95]
    ds_read_b128 v[164:167], v197 offset:64
    v_mfma_f32_32x32x16_bf16 v[96:111], a[100:103], v[180:183], v[96:111]
    ds_read_b128 v[168:171], v197 offset:8768
    buffer_load_dwordx4 a[228:231], v58, s[16:19], s97 offen offset:1024 sc1
    s_waitcnt lgkmcnt(3)
    v_mfma_f32_16x16x32_bf16 v[112:115], a[104:107], v[184:187], v[112:115]
    ds_read_b128 v[172:175], v198 offset:128
    v_mfma_f32_32x32x16_bf16 v[80:95], a[104:107], v[188:191], v[80:95]
    ds_read_b128 v[176:179], v196 offset:128
    v_mfma_f32_32x32x16_bf16 v[96:111], a[104:107], v[192:195], v[96:111]
    ds_read_b128 v[180:183], v196 offset:8832
    buffer_load_dwordx4 a[232:235], v58, s[16:19], s97 offen offset:2048 sc1
    s_waitcnt lgkmcnt(3)
    v_mfma_f32_16x16x32_bf16 v[112:115], a[108:111], v[160:163], v[112:115]
    ds_read_b128 v[184:187], v198 offset:160
    v_mfma_f32_32x32x16_bf16 v[80:95], a[108:111], v[164:167], v[80:95]
    ds_read_b128 v[188:191], v197 offset:128
    v_mfma_f32_32x32x16_bf16 v[96:111], a[108:111], v[168:171], v[96:111]
    ds_read_b128 v[192:195], v197 offset:8832
    buffer_load_dwordx4 a[236:239], v58, s[16:19], s97 offen offset:3072 sc1
    s_waitcnt lgkmcnt(3)
    v_mfma_f32_16x16x32_bf16 v[112:115], a[112:115], v[172:175], v[112:115]
    ds_read_b128 v[160:163], v198 offset:192
    v_mfma_f32_32x32x16_bf16 v[80:95], a[112:115], v[176:179], v[80:95]
    ds_read_b128 v[164:167], v196 offset:192
    v_mfma_f32_32x32x16_bf16 v[96:111], a[112:115], v[180:183], v[96:111]
    ds_read_b128 v[168:171], v196 offset:8896
    s_add_u32 s97, s97, 4096
    buffer_load_dwordx4 a[240:243], v58, s[16:19], s97 offen offset:0 sc1
    s_waitcnt lgkmcnt(3)
    v_mfma_f32_16x16x32_bf16 v[112:115], a[116:119], v[184:187], v[112:115]
    ds_read_b128 v[172:175], v198 offset:224
    v_mfma_f32_32x32x16_bf16 v[80:95], a[116:119], v[188:191], v[80:95]
    ds_read_b128 v[176:179], v197 offset:192
    v_mfma_f32_32x32x16_bf16 v[96:111], a[116:119], v[192:195], v[96:111]
    ds_read_b128 v[180:183], v197 offset:8896
    buffer_load_dwordx4 a[244:247], v58, s[16:19], s97 offen offset:1024 sc1
    s_waitcnt vmcnt(20)
    s_barrier
    s_waitcnt lgkmcnt(3)
    v_mfma_f32_16x16x32_bf16 v[112:115], a[120:123], v[160:163], v[112:115]
    v_add_u32_e64 v198, v49, v198
    v_mfma_f32_32x32x16_bf16 v[80:95], a[120:123], v[164:167], v[80:95]
    v_add_u32 v196, 19584, v196
    v_add_u32 v197, 19584, v197
    s_waitcnt vmcnt(17)
    v_mul_f32 v148, v24, v157
    v_mul_f32 v149, v25, v157
    v_mul_f32 v150, v26, v157
    v_mfma_f32_32x32x16_bf16 v[96:111], a[120:123], v[168:171], v[96:111]
    ds_read_b128 v[184:187], v198 offset:0
    ds_read_b128 v[188:191], v196 offset:0
    buffer_load_dwordx4 a[248:251], v58, s[16:19], s97 offen offset:2048 sc1
    v_mul_f32 v151, v27, v157
    v_mul_f32_e64 v116, v8, v153
    s_waitcnt lgkmcnt(2)
    v_mfma_f32_16x16x32_bf16 v[112:115], a[124:127], v[172:175], v[112:115]
    ds_read_b128 v[192:195], v198 offset:32
    v_mfma_f32_32x32x16_bf16 v[80:95], a[124:127], v[176:179], v[80:95]
    ds_read_b128 v[160:163], v197 offset:0
    v_mul_f32 v117, v9, v153
    v_mul_f32 v118, v10, v153
    v_mul_f32 v119, v11, v153
    v_mul_f32 v120, v12, v153
    v_mfma_f32_32x32x16_bf16 v[96:111], a[124:127], v[180:183], v[96:111]
    buffer_load_dwordx4 a[252:255], v58, s[16:19], s97 offen offset:3072 sc1
    v_mul_f32 v121, v13, v153
    v_mul_f32 v122, v14, v153
    v_mul_f32 v123, v15, v153
    s_waitcnt lgkmcnt(2)
    v_mfma_f32_16x16x32_bf16 v[112:115], a[128:131], v[184:187], v[112:115]
    ds_read_b128 v[164:167], v198 offset:64
    v_mfma_f32_32x32x16_bf16 v[80:95], a[128:131], v[188:191], v[80:95]
    ds_read_b128 v[168:171], v196 offset:64
    v_mul_f32 v124, v16, v153
    v_mul_f32 v125, v17, v153
    v_mul_f32 v126, v18, v153
    s_waitcnt lgkmcnt(2)
    v_mfma_f32_16x16x32_bf16 v[112:115], a[132:135], v[192:195], v[112:115]
    ds_read_b128 v[172:175], v198 offset:96
    v_mfma_f32_32x32x16_bf16 v[80:95], a[132:135], v[160:163], v[80:95]
    ds_read_b128 v[176:179], v197 offset:64
    s_add_u32 s97, s97, 4096
    buffer_load_dwordx4 v[52:55], v58, s[16:19], s97 offen offset:0 sc1
    v_mul_f32 v127, v19, v153
    v_mul_f32_e64 v128, v20, v153
    s_waitcnt lgkmcnt(2)
    v_mfma_f32_16x16x32_bf16 v[112:115], a[136:139], v[164:167], v[112:115]
    ds_read_b128 v[180:183], v198 offset:128
    v_mfma_f32_32x32x16_bf16 v[80:95], a[136:139], v[168:171], v[80:95]
    ds_read_b128 v[184:187], v196 offset:128
    v_mul_f32 v129, v21, v153
    v_mul_f32 v130, v22, v153
    v_mul_f32 v131, v23, v153
    s_waitcnt lgkmcnt(2)
    v_mfma_f32_16x16x32_bf16 v[112:115], a[140:143], v[172:175], v[112:115]
    ds_read_b128 v[188:191], v198 offset:160
    v_mfma_f32_32x32x16_bf16 v[80:95], a[140:143], v[176:179], v[80:95]
    ds_read_b128 v[192:195], v197 offset:128
    s_mov_b32 s96, 4194304
    buffer_load_dwordx4 v[216:219], v56, s[16:19], s96 offen offset:0 sc1
    v_mul_f32 v132, v8, v155
    v_mul_f32_e64 v133, v9, v155
    s_waitcnt lgkmcnt(2)
    v_mfma_f32_16x16x32_bf16 v[112:115], a[144:147], v[180:183], v[112:115]
    ds_read_b128 v[160:163], v198 offset:192
    v_mfma_f32_32x32x16_bf16 v[80:95], a[144:147], v[184:187], v[80:95]
    ds_read_b128 v[164:167], v196 offset:192
    v_mul_f32 v134, v10, v155
    v_mul_f32 v135, v11, v155
    v_mul_f32 v136, v12, v155
    s_waitcnt lgkmcnt(2)
    v_mfma_f32_16x16x32_bf16 v[112:115], a[148:151], v[188:191], v[112:115]
    ds_read_b128 v[168:171], v198 offset:224
    v_mfma_f32_32x32x16_bf16 v[80:95], a[148:151], v[192:195], v[80:95]
    ds_read_b128 v[172:175], v197 offset:192
    buffer_load_dwordx4 v[220:223], v56, s[16:19], s96 offen offset:256 sc1
    v_mul_f32 v137, v13, v155
    v_mul_f32_e64 v138, v14, v155
    s_waitcnt lgkmcnt(2)
    v_mfma_f32_16x16x32_bf16 v[112:115], a[152:155], v[160:163], v[112:115]
    ds_read_b128 v[176:179], v196 offset:8704
    v_mfma_f32_32x32x16_bf16 v[80:95], a[152:155], v[164:167], v[80:95]
    ds_read_b128 v[180:183], v197 offset:8704
    v_mul_f32 v139, v15, v155
    v_mul_f32 v140, v16, v155
    v_mul_f32 v141, v17, v155
    s_waitcnt lgkmcnt(2)
    v_mfma_f32_16x16x32_bf16 v[112:115], a[156:159], v[168:171], v[112:115]
    ds_read_b128 v[184:187], v196 offset:8768
    v_mfma_f32_32x32x16_bf16 v[80:95], a[156:159], v[172:175], v[80:95]
    ds_read_b128 v[188:191], v197 offset:8768
    s_mov_b32 s96, 4227072
    buffer_load_dwordx4 v[224:227], v56, s[16:19], s96 offen offset:0 sc1
    v_mul_f32 v142, v18, v155
    v_mul_f32 v143, v19, v155
    v_mul_f32 v144, v20, v155
    v_mul_f32 v145, v21, v155
    v_mul_f32 v146, v22, v155
    v_mul_f32_e64 v147, v23, v155
    s_waitcnt lgkmcnt(2)
    v_mfma_f32_32x32x16_bf16 v[96:111], a[128:131], v[176:179], v[96:111]
    ds_read_b128 v[192:195], v196 offset:8832
    v_mfma_f32_32x32x16_bf16 v[96:111], a[132:135], v[180:183], v[96:111]
    ds_read_b128 v[160:163], v197 offset:8832
    buffer_load_dwordx4 v[228:231], v56, s[16:19], s96 offen offset:256 sc1
    v_fma_f32 v112, v112, v156, v148
    v_fma_f32 v113, v113, v156, v149
    s_waitcnt lgkmcnt(2)
    v_mfma_f32_32x32x16_bf16 v[96:111], a[136:139], v[184:187], v[96:111]
    ds_read_b128 v[164:167], v196 offset:8896
    v_fma_f32 v114, v114, v156, v150
    v_fma_f32 v115, v115, v156, v151
    v_cvt_pk_bf16_f32 v112, v112, v113
    v_cvt_pk_bf16_f32 v113, v114, v115
    v_mfma_f32_32x32x16_bf16 v[96:111], a[140:143], v[188:191], v[96:111]
    ds_read_b128 v[168:171], v197 offset:8896
    s_mov_b32 s96, 4259840
    buffer_load_dwordx4 v[232:235], v56, s[16:19], s96 offen offset:0 sc1
    v_fma_f32 v80, v80, v152, v116
    v_fma_f32 v81, v81, v152, v117
    s_waitcnt lgkmcnt(2)
    v_mfma_f32_32x32x16_bf16 v[96:111], a[144:147], v[192:195], v[96:111]
    v_fma_f32 v82, v82, v152, v118
    v_fma_f32 v83, v83, v152, v119
    v_cvt_pk_bf16_f32 v80, v80, v81
    v_cvt_pk_bf16_f32 v81, v82, v83
    ds_write_b64 v40, v[112:113] offset:0
    v_mfma_f32_32x32x16_bf16 v[96:111], a[148:151], v[160:163], v[96:111]
    ds_write_b64 v38, v[80:81] offset:0
    v_fma_f32 v84, v84, v152, v120
    v_fma_f32 v85, v85, v152, v121
    v_fma_f32 v86, v86, v152, v122
    s_waitcnt lgkmcnt(2)
    v_mfma_f32_32x32x16_bf16 v[96:111], a[152:155], v[164:167], v[96:111]
    v_fma_f32 v87, v87, v152, v123
    v_cvt_pk_bf16_f32 v84, v84, v85
    v_cvt_pk_bf16_f32 v85, v86, v87
    v_fma_f32 v88, v88, v152, v124
    v_fma_f32 v89, v89, v152, v125
    v_mfma_f32_32x32x16_bf16 v[96:111], a[156:159], v[168:171], v[96:111]
    buffer_load_dwordx4 v[236:239], v56, s[16:19], s96 offen offset:256 sc1
    v_fma_f32 v90, v90, v152, v126
    v_fma_f32 v91, v91, v152, v127
    v_cvt_pk_bf16_f32 v88, v88, v89
    v_cvt_pk_bf16_f32 v89, v90, v91
    ds_write_b64 v38, v[84:85] offset:6400
    ds_write_b64 v38, v[88:89] offset:12800
    v_fma_f32 v92, v92, v152, v128
    v_fma_f32 v93, v93, v152, v129
    v_fma_f32 v94, v94, v152, v130
    v_fma_f32 v95, v95, v152, v131
    v_cvt_pk_bf16_f32 v92, v92, v93
    v_cvt_pk_bf16_f32 v93, v94, v95
    ds_write_b64 v39, v[92:93] offset:0
    v_pk_fma_f32 v[96:97], v[96:97], v[154:155], v[132:133] op_sel_hi:[1,0,1]
    v_pk_fma_f32 v[98:99], v[98:99], v[154:155], v[134:135] op_sel_hi:[1,0,1]
    v_cvt_pk_bf16_f32 v96, v96, v97
    v_cvt_pk_bf16_f32 v97, v98, v99
    v_pk_fma_f32 v[100:101], v[100:101], v[154:155], v[136:137] op_sel_hi:[1,0,1]
    v_pk_fma_f32 v[102:103], v[102:103], v[154:155], v[138:139] op_sel_hi:[1,0,1]
    v_cvt_pk_bf16_f32 v100, v100, v101
    v_cvt_pk_bf16_f32 v101, v102, v103
    ds_write_b64 v38, v[96:97] offset:1600
    ds_write_b64 v38, v[100:101] offset:8000
    v_pk_fma_f32 v[104:105], v[104:105], v[154:155], v[140:141] op_sel_hi:[1,0,1]
    v_pk_fma_f32 v[106:107], v[106:107], v[154:155], v[142:143] op_sel_hi:[1,0,1]
    v_cvt_pk_bf16_f32 v104, v104, v105
    v_cvt_pk_bf16_f32 v105, v106, v107
    v_pk_fma_f32 v[108:109], v[108:109], v[154:155], v[144:145] op_sel_hi:[1,0,1]
    v_pk_fma_f32 v[110:111], v[110:111], v[154:155], v[146:147] op_sel_hi:[1,0,1]
    v_cvt_pk_bf16_f32 v108, v108, v109
    v_cvt_pk_bf16_f32 v109, v110, v111
    ds_write_b64 v38, v[104:105] offset:14400
    ds_write_b64 v39, v[108:109] offset:1600
    s_waitcnt lgkmcnt(0)
    s_barrier
    v_mov_b32 v94, 0
    v_mov_b32 v95, 0
    v_mov_b32 v98, 0
    v_mov_b32_e64 v99, 0
    s_mov_b64 exec, 0xffff
    ds_read_b64 v[94:95], v42 offset:320
    ds_read_b64 v[98:99], v42 offset:640
    s_mov_b64 exec, -1
    s_nop 0
    ds_read_b64 v[92:93], v41 offset:320
    ds_read_b64 v[96:97], v41 offset:640
    ds_read_b64 v[84:85], v41 offset:6720
    ds_read_b64 v[86:87], v42 offset:6720
    ds_read_b64 v[80:81], v41 offset:6400
    ds_read_b64 v[82:83], v42 offset:6400
    ds_read_b64 v[88:89], v41 offset:7040
    ds_read_b64 v[90:91], v42 offset:7040
    ds_read_b64_tr_b16 v[106:107], v44 offset:0
    ds_read_b64_tr_b16 v[100:101], v43 offset:0
    ds_read_b64_tr_b16 v[108:109], v44 offset:320
    ds_read_b64_tr_b16 v[102:103], v43 offset:320
    s_mov_b32 s96, 4292608
    buffer_load_dwordx4 v[240:243], v56, s[16:19], s96 offen offset:0 sc1
    ds_read_b64_tr_b16 v[110:111], v44 offset:640
    ds_read_b64_tr_b16 v[104:105], v43 offset:640
    s_mov_b32 s82, 0x3ea52b5c
    s_lshl_b32 s25, s98, 4
    s_add_u32 s25, s25, 4194304
    s_lshl_b32 s26, s98, 3
    s_add_u32 s26, s26, 4194304
    s_waitcnt lgkmcnt(10)
    v_mfma_f32_16x16x32_bf16 v[116:119], v[84:87], v[92:95], v[28:31]
    buffer_load_dwordx4 v[244:247], v56, s[16:19], s96 offen offset:256 sc1
    v_mfma_f32_16x16x32_bf16 v[120:123], v[84:87], v[96:99], v[32:35]
    s_waitcnt lgkmcnt(8)
    v_mfma_f32_16x16x32_bf16 v[112:115], v[80:83], v[92:95], v[32:35]
    s_waitcnt lgkmcnt(6)
    v_mfma_f32_16x16x32_bf16 v[124:127], v[88:91], v[96:99], v[28:31]
    s_nop 5
    v_max_f32 v112, v112, v116
    v_max_f32 v113, v113, v117
    v_max_f32 v114, v114, v118
    v_max_f32 v115, v115, v119
    v_max3_f32 v156, v112, v113, v114
    s_mov_b32 s96, 4194304
    buffer_load_dwordx2 v[248:249], v57, s[16:19], s96 offen offset:0 sc1
    v_max_f32 v156, v156, v115
    v_max_f32 v120, v120, v124
    v_max_f32 v121, v121, v125
    v_max_f32 v122, v122, v126
    v_max_f32 v123, v123, v127
    v_max3_f32 v157, v120, v121, v122
    v_max_f32 v157, v157, v123
    s_nop 1
    v_permlane16_swap_b32 v156, v157
    buffer_load_dwordx2 v[252:253], v57, s[16:19], s96 offen offset:128 sc1
    v_max_f32 v156, v156, v157
    v_mov_b32 v157, v156
    s_nop 1
    v_permlane32_swap_b32 v156, v157
    v_max_f32 v156, v156, v157
    v_mul_f32 v156, s82, v156
    v_mov_b32 v157, v156
    s_nop 1
    v_permlane16_swap_b32_e64 v156, v157
    v_fma_f32 v112, v112, s82, -v156
    s_mov_b32 s96, 4210688
    buffer_load_dwordx2 v[250:251], v57, s[16:19], s96 offen offset:0 sc1
    v_fma_f32 v113, v113, s82, -v156
    v_fma_f32 v114, v114, s82, -v156
    v_fma_f32 v115, v115, s82, -v156
    v_exp_f32 v112, v112
    v_exp_f32 v113, v113
    v_exp_f32 v114, v114
    v_exp_f32 v115, v115
    v_cvt_pk_bf16_f32 v116, v112, v113
    buffer_load_dwordx2 v[254:255], v57, s[16:19], s96 offen offset:128 sc1
    v_cvt_pk_bf16_f32 v117, v114, v115
    v_bfi_b32 v128, v36, 0, v116
    v_and_b32 v130, v36, v116
    v_bfi_b32 v129, v37, 0, v117
    v_and_b32 v131, v37, v117
    s_waitcnt lgkmcnt(3)
    s_nop 0
    v_mfma_f32_16x16x32_bf16 v[144:147], v[106:109], v[128:131], 0
    s_waitcnt lgkmcnt(2)
    v_mfma_f32_16x16x32_bf16 v[136:139], v[100:103], v[128:131], 0
    v_fma_f32 v120, v120, s82, -v157
    s_mov_b32 s96, 0
    s_mov_b32 s97, 5120
    buffer_load_dwordx2 v[208:209], v60, s[4:7], s96 offen
    v_fma_f32 v121, v121, s82, -v157
    v_fma_f32 v122, v122, s82, -v157
    v_fma_f32 v123, v123, s82, -v157
    v_exp_f32 v120, v120
    v_exp_f32 v121, v121
    v_exp_f32 v122, v122
    v_exp_f32 v123, v123
    v_cvt_pk_bf16_f32 v124, v120, v121
    buffer_load_dwordx2 v[210:211], v60, s[4:7], s97 offen
    v_cvt_pk_bf16_f32 v125, v122, v123
    v_bfi_b32 v132, v36, 0, v124
    v_and_b32 v134, v36, v124
    v_bfi_b32 v133, v37, 0, v125
    v_and_b32 v135, v37, v125
    s_waitcnt lgkmcnt(1)
    s_nop 0
    v_mfma_f32_16x16x32_bf16 v[148:151], v[108:111], v[132:135], 0
    s_waitcnt lgkmcnt(0)
    v_mfma_f32_16x16x32_bf16 v[140:143], v[102:105], v[132:135], 0
    v_mov_b32 v158, v144
    v_lshrrev_b32_e64 v212, 5, v1
    v_mul_u32_u24 v212, 5104, v212
    v_bfe_u32 v213, v1, 4, 1
    v_lshlrev_b32 v213, 2, v213
    v_sub_u32 v212, v212, v213
    v_add_u32 v212, v212, v60
    s_mul_i32 s97, s24, 24
    s_sub_u32 s97, 128, s97
    buffer_load_dword v212, v212, s[4:7], s97 offen
    v_permlane16_swap_b32 v144, v158
    v_rcp_f32_e64 v158, v158
    s_nop 0
    v_pk_mul_f32 v[136:137], v[136:137], v[158:159] op_sel_hi:[1,0]
    v_pk_mul_f32 v[138:139], v[138:139], v[158:159] op_sel_hi:[1,0]
    v_pk_mul_f32 v[144:145], v[144:145], v[158:159] op_sel_hi:[1,0]
    v_pk_mul_f32 v[146:147], v[146:147], v[158:159] op_sel_hi:[1,0]
    v_cvt_pk_bf16_f32 v112, v136, v137
    v_cvt_pk_bf16_f32 v116, v144, v145
    v_cvt_pk_bf16_f32 v113, v138, v139
    v_cvt_pk_bf16_f32 v117, v146, v147
    v_mov_b32 v160, v148
    s_nop 1
    v_permlane16_swap_b32 v148, v160
    v_rcp_f32_e64 v160, v160
    s_nop 0
    v_pk_mul_f32 v[140:141], v[140:141], v[160:161] op_sel_hi:[1,0]
    v_pk_mul_f32 v[142:143], v[142:143], v[160:161] op_sel_hi:[1,0]
    v_pk_mul_f32 v[148:149], v[148:149], v[160:161] op_sel_hi:[1,0]
    v_pk_mul_f32 v[150:151], v[150:151], v[160:161] op_sel_hi:[1,0]
    v_cvt_pk_bf16_f32 v114, v140, v141
    v_cvt_pk_bf16_f32 v118, v148, v149
    v_cvt_pk_bf16_f32 v115, v142, v143
    v_cvt_pk_bf16_f32 v119, v150, v151
    v_permlane16_swap_b32 v112, v114
    v_permlane16_swap_b32 v113, v115
    v_permlane16_swap_b32 v116, v118
    v_permlane16_swap_b32 v117, v119
    buffer_store_dwordx4 v[112:115], v45, s[16:19], s25 offen sc1
    s_mov_b64 exec, s[80:81]
    buffer_store_dwordx2 v[116:117], v46, s[16:19], s26 offen sc1
    s_mov_b64 exec, -1
oe_20:
    s_waitcnt vmcnt(16)
    v_mfma_f32_16x16x32_bf16 v[112:115], a[176:179], v[216:219], 0
    v_mov_b32 v136, 0
    v_mov_b32 v137, 0
    s_waitcnt vmcnt(15)
    v_mfma_f32_16x16x32_bf16 v[116:119], a[176:179], v[220:223], 0
    v_mov_b32 v138, 0
    v_mov_b32 v139, 0
    s_waitcnt vmcnt(14)
    v_mfma_f32_16x16x32_bf16 v[112:115], a[196:199], v[224:227], v[112:115]
    v_mov_b32 v140, 0
    v_mov_b32 v141, 0
    s_waitcnt vmcnt(13)
    v_mfma_f32_16x16x32_bf16 v[116:119], a[196:199], v[228:231], v[116:119]
    s_mov_b32 s25, 6815744
    s_add_u32 s26, s36, 6815744
    s_waitcnt vmcnt(12)
    v_mfma_f32_16x16x32_bf16 v[112:115], a[216:219], v[232:235], v[112:115]
    s_add_u32 s27, s35, 3473408
    s_mov_b32 s28, 0x99999999
    s_waitcnt vmcnt(11)
    v_mfma_f32_16x16x32_bf16 v[116:119], a[216:219], v[236:239], v[116:119]
    s_mov_b32 s29, 0x99999999
    s_waitcnt vmcnt(10)
    v_mfma_f32_16x16x32_bf16 v[112:115], a[236:239], v[240:243], v[112:115]
    s_waitcnt vmcnt(9)
    v_mfma_f32_16x16x32_bf16 v[116:119], a[236:239], v[244:247], v[116:119]
    s_waitcnt vmcnt(6)
    v_mfma_f32_16x16x32_bf16 v[112:115], v[52:55], v[248:251], v[112:115]
    s_waitcnt vmcnt(5)
    v_mfma_f32_16x16x32_bf16 v[116:119], v[52:55], v[252:255], v[116:119]
    v_mfma_f32_16x16x32_bf16 v[88:91], a[164:167], v[216:219], 0
    v_mfma_f32_16x16x32_bf16 v[92:95], a[164:167], v[220:223], 0
    v_mfma_f32_16x16x32_bf16 v[88:91], a[184:187], v[224:227], v[88:91]
    v_mfma_f32_16x16x32_bf16 v[92:95], a[184:187], v[228:231], v[92:95]
    v_mfma_f32_16x16x32_bf16 v[88:91], a[204:207], v[232:235], v[88:91]
    v_mfma_f32_16x16x32_bf16 v[92:95], a[204:207], v[236:239], v[92:95]
    s_nop 1
    v_cmp_u_f32 vcc, v112, v116
    s_nop 0
    s_cbranch_vccnz rd_21
rc_22:
    v_mfma_f32_16x16x32_bf16 v[88:91], a[224:227], v[240:243], v[88:91]
    ds_write_b128 v203, v[112:115] offset:24576
    v_mfma_f32_16x16x32_bf16 v[92:95], a[224:227], v[244:247], v[92:95]
    v_mfma_f32_16x16x32_bf16 v[88:91], a[244:247], v[248:251], v[88:91]
    ds_write_b128 v203, v[116:119] offset:25600
    v_mfma_f32_16x16x32_bf16 v[92:95], a[244:247], v[252:255], v[92:95]
    v_mfma_f32_16x16x32_bf16 v[96:99], a[168:171], v[216:219], 0
    s_waitcnt vmcnt(4)
    v_lshlrev_b32 v120, 16, v208
    v_and_b32 v121, 0xffff0000, v208
    v_mfma_f32_16x16x32_bf16 v[100:103], a[168:171], v[220:223], 0
    v_lshlrev_b32_e64 v122, 16, v209
    v_and_b32 v123, 0xffff0000, v209
    v_mfma_f32_16x16x32_bf16 v[96:99], a[188:191], v[224:227], v[96:99]
    s_waitcnt vmcnt(3)
    v_lshlrev_b32 v124, 16, v210
    v_and_b32 v125, 0xffff0000, v210
    v_mfma_f32_16x16x32_bf16 v[100:103], a[188:191], v[228:231], v[100:103]
    v_lshlrev_b32_e64 v126, 16, v211
    v_and_b32 v127, 0xffff0000, v211
    v_mfma_f32_16x16x32_bf16 v[96:99], a[208:211], v[232:235], v[96:99]
    s_waitcnt vmcnt(2)
    v_lshlrev_b32 v128, 16, v212
    v_and_b32 v129, 0xffff0000, v212
    v_mfma_f32_16x16x32_bf16 v[100:103], a[208:211], v[236:239], v[100:103]
    v_mfma_f32_16x16x32_bf16 v[96:99], a[228:231], v[240:243], v[96:99]
    ds_write_b128 v200, v[88:91] offset:0
    v_mfma_f32_16x16x32_bf16 v[100:103], a[228:231], v[244:247], v[100:103]
    v_mfma_f32_16x16x32_bf16 v[96:99], a[248:251], v[248:251], v[96:99]
    ds_write_b128 v200, v[92:95] offset:1024
    v_mfma_f32_16x16x32_bf16 v[100:103], a[248:251], v[252:255], v[100:103]
    v_mfma_f32_16x16x32_bf16 v[104:107], a[172:175], v[216:219], 0
    v_mfma_f32_16x16x32_bf16 v[108:111], a[172:175], v[220:223], 0
    v_mfma_f32_16x16x32_bf16 v[104:107], a[192:195], v[224:227], v[104:107]
    v_mfma_f32_16x16x32_bf16 v[108:111], a[192:195], v[228:231], v[108:111]
    v_mfma_f32_16x16x32_bf16 v[104:107], a[212:215], v[232:235], v[104:107]
    v_mfma_f32_16x16x32_bf16 v[108:111], a[212:215], v[236:239], v[108:111]
    v_mfma_f32_16x16x32_bf16 v[104:107], a[232:235], v[240:243], v[104:107]
    ds_write_b128 v201, v[96:99] offset:2048
    v_mfma_f32_16x16x32_bf16 v[108:111], a[232:235], v[244:247], v[108:111]
    v_mfma_f32_16x16x32_bf16 v[104:107], a[252:255], v[248:251], v[104:107]
    ds_write_b128 v201, v[100:103] offset:3072
    v_mfma_f32_16x16x32_bf16 v[108:111], a[252:255], v[252:255], v[108:111]
    v_mfma_f32_16x16x32_bf16 v[80:83], a[160:163], v[216:219], v[120:123]
    v_mfma_f32_16x16x32_bf16 v[84:87], a[160:163], v[220:223], v[124:127]
    v_mfma_f32_16x16x32_bf16 v[80:83], a[180:183], v[224:227], v[80:83]
    v_mfma_f32_16x16x32_bf16 v[84:87], a[180:183], v[228:231], v[84:87]
    v_mfma_f32_16x16x32_bf16 v[80:83], a[200:203], v[232:235], v[80:83]
    s_nop 0
    ds_write_b128 v202, v[104:107] offset:4096
    v_mfma_f32_16x16x32_bf16 v[84:87], a[200:203], v[236:239], v[84:87]
    ds_write_b128 v202, v[108:111] offset:5120
    v_mfma_f32_16x16x32_bf16 v[80:83], a[220:223], v[240:243], v[80:83]
    v_mfma_f32_16x16x32_bf16 v[84:87], a[220:223], v[244:247], v[84:87]
    v_mfma_f32_16x16x32_bf16 v[80:83], a[240:243], v[248:251], v[80:83]
    v_mfma_f32_16x16x32_bf16 v[84:87], a[240:243], v[252:255], v[84:87]
    s_waitcnt lgkmcnt(0)
    s_barrier
    s_nop 0
    ds_read_b128 v[88:91], v204 offset:0
    ds_read_b128 v[92:95], v204 offset:1024
    ds_read_b128 v[96:99], v204 offset:2048
    ds_read_b128 v[100:103], v204 offset:3072
    ds_read_b128 v[104:107], v204 offset:4096
    ds_read_b128 v[108:111], v204 offset:5120
    ds_read_b64 v[112:113], v205 offset:24576
    ds_read_b64 v[114:115], v205 offset:26624
    ds_read_b64 v[116:117], v205 offset:28672
    ds_read_b64 v[118:119], v205 offset:30720
    s_waitcnt lgkmcnt(9)
    v_pk_add_f32 v[80:81], v[80:81], v[88:89]
    v_pk_add_f32 v[82:83], v[82:83], v[90:91]
    s_waitcnt lgkmcnt(8)
    v_pk_add_f32 v[84:85], v[84:85], v[92:93]
    v_pk_add_f32 v[86:87], v[86:87], v[94:95]
    s_waitcnt lgkmcnt(7)
    v_pk_add_f32 v[80:81], v[80:81], v[96:97]
    v_pk_add_f32 v[82:83], v[82:83], v[98:99]
    s_waitcnt lgkmcnt(6)
    v_pk_add_f32 v[84:85], v[84:85], v[100:101]
    v_pk_add_f32 v[86:87], v[86:87], v[102:103]
    s_waitcnt lgkmcnt(5)
    v_pk_add_f32 v[80:81], v[80:81], v[104:105]
    v_pk_add_f32 v[82:83], v[82:83], v[106:107]
    s_waitcnt lgkmcnt(4)
    v_pk_add_f32 v[84:85], v[84:85], v[108:109]
    v_pk_add_f32 v[86:87], v[86:87], v[110:111]
    v_cvt_pk_bf16_f32 v132, v80, v81
    v_cvt_pk_bf16_f32 v133, v82, v83
    v_cvt_pk_bf16_f32 v134, v84, v85
    v_cvt_pk_bf16_f32 v135, v86, v87
    s_waitcnt lgkmcnt(3)
    v_pk_add_f32 v[128:129], v[128:129], v[112:113]
    s_waitcnt lgkmcnt(2)
    v_pk_add_f32 v[128:129], v[128:129], v[114:115]
    s_waitcnt lgkmcnt(1)
    v_pk_add_f32 v[128:129], v[128:129], v[116:117]
    s_waitcnt lgkmcnt(0)
    v_pk_add_f32 v[128:129], v[128:129], v[118:119]
    v_cvt_pk_bf16_f32 v130, v128, v129
    buffer_store_dwordx4 v[132:135], v59, s[16:19], s25 offen sc1
    buffer_store_dword v130, v61, s[16:19], s26 offen sc1
    v_dot2c_f32_bf16 v136, v132, v215
    v_dot2c_f32_bf16 v137, v132, v132
    v_dot2c_f32_bf16 v136, v133, v215
    v_dot2c_f32_bf16 v137, v133, v133
    v_dot2c_f32_bf16 v138, v134, v215
    v_dot2c_f32_bf16 v139, v134, v134
    v_dot2c_f32_bf16 v138, v135, v215
    v_dot2c_f32_bf16 v139, v135, v135
    v_dot2c_f32_bf16 v140, v130, v215
    v_dot2c_f32_bf16 v141, v130, v130
    v_permlane32_swap_b32 v136, v138
    v_permlane32_swap_b32 v137, v139
    v_pk_add_f32 v[136:137], v[136:137], v[138:139]
    v_pk_add_f32 v[136:137], v[136:137], v[140:141]
    s_nop 1
    v_permlane16_swap_b32 v136, v137
    v_add_f32_e64 v136, v136, v137
    ds_write_b32 v206, v136 offset:32768
    s_mov_b32 s96, 4198400
    buffer_load_dwordx4 v[216:219], v56, s[16:19], s96 offen offset:0 sc1
    buffer_load_dwordx4 v[220:223], v56, s[16:19], s96 offen offset:256 sc1
    s_mov_b32 s96, 4231168
    buffer_load_dwordx4 v[224:227], v56, s[16:19], s96 offen offset:0 sc1
    buffer_load_dwordx4 v[228:231], v56, s[16:19], s96 offen offset:256 sc1
    s_mov_b32 s96, 4263936
    buffer_load_dwordx4 v[232:235], v56, s[16:19], s96 offen offset:0 sc1
    buffer_load_dwordx4 v[236:239], v56, s[16:19], s96 offen offset:256 sc1
    s_waitcnt lgkmcnt(0)
    s_barrier
    ds_read2st64_b32 v[136:137], v207 offset0:0 offset1:1
    ds_read2st64_b32 v[138:139], v207 offset0:2 offset1:3
    ds_read_b64_tr_b16 v[144:145], v65 offset:32
    ds_read_b64_tr_b16 v[146:147], v65 offset:0
    ds_read_b64_tr_b16 v[148:149], v65 offset:160
    ds_read_b64_tr_b16 v[150:151], v65 offset:128
    ds_read_b64_tr_b16 v[152:153], v65 offset:288
    ds_read_b64_tr_b16 v[154:155], v65 offset:256
    ds_read_b64_tr_b16 v[156:157], v65 offset:416
    ds_read_b64_tr_b16 v[158:159], v65 offset:384
    ds_read_b64_tr_b16 v[160:161], v65 offset:544
    ds_read_b64_tr_b16 v[162:163], v65 offset:512
    ds_read_b64_tr_b16 v[164:165], v65 offset:672
    ds_read_b64_tr_b16 v[166:167], v65 offset:640
    ds_read_b64_tr_b16 v[168:169], v65 offset:800
    ds_read_b64_tr_b16 v[170:171], v65 offset:768
    ds_read_b64_tr_b16 v[172:173], v65 offset:928
    ds_read_b64_tr_b16 v[174:175], v65 offset:896
    s_waitcnt lgkmcnt(15)
    v_pk_add_f32 v[136:137], v[136:137], v[138:139]
    v_add_f32 v136, v136, v137
    v_cndmask_b32 v136, v136, 1.0, s[28:29]
    s_mov_b64 exec, s[80:81]
    buffer_atomic_add_f32 v136, v214, s[16:19], s27 offen
    s_mov_b64 exec, -1
    s_mov_b32 s96, 4296704
    buffer_load_dwordx4 v[240:243], v56, s[16:19], s96 offen offset:0 sc1
    buffer_load_dwordx4 v[244:247], v56, s[16:19], s96 offen offset:256 sc1
    s_mov_b32 s96, 4196352
    buffer_load_dwordx2 v[248:249], v57, s[16:19], s96 offen offset:0 sc1
    buffer_load_dwordx2 v[252:253], v57, s[16:19], s96 offen offset:128 sc1
    s_mov_b32 s96, 4212736
    buffer_load_dwordx2 v[250:251], v57, s[16:19], s96 offen offset:0 sc1
    buffer_load_dwordx2 v[254:255], v57, s[16:19], s96 offen offset:128 sc1
    s_mov_b32 s96, 1310720
    s_mov_b32 s97, 1315840
    buffer_load_dwordx2 v[208:209], v60, s[4:7], s96 offen
    buffer_load_dwordx2 v[210:211], v60, s[4:7], s97 offen
    v_lshrrev_b32_e64 v212, 5, v1
    v_mul_u32_u24 v212, 5104, v212
    v_bfe_u32 v213, v1, 4, 1
    v_lshlrev_b32 v213, 2, v213
    v_sub_u32 v212, v212, v213
    v_add_u32 v212, v212, v60
    s_mul_i32 s97, s24, 24
    s_sub_u32 s97, 1310848, s97
    buffer_load_dword v212, v212, s[4:7], s97 offen
    v_lshrrev_b32 v176, 4, v0
    v_mul_u32_u24 v176, 1216, v176
    v_and_b32 v177, 15, v0
    v_lshl_add_u32 v176, v177, 3, v176
    v_add_u32 v176, 64, v176
    v_mov_b32 v178, 0
    v_mov_b32 v179, 0
    ds_write_b64 v176, v[178:179]
    v_mov_b32 v70, 0
    v_mov_b32 v71, 0
    v_mov_b32 v72, 0
    s_lshl_b32 s25, s24, 17
    v_lshrrev_b32 v176, 5, v1
    v_lshl_add_u32 v176, v176, 14, s25
    v_bfe_u32 v177, v1, 4, 1
    v_lshl_add_u32 v176, v177, 13, v176
    v_and_b32_e64 v177, 15, v1
    v_lshl_add_u32 v73, v177, 4, v176
    v_bfe_u32 v176, v1, 2, 3
    v_lshl_add_u32 v176, v176, 14, s25
    v_bfe_u32 v177, v1, 1, 1
    v_lshl_add_u32 v176, v177, 13, v176
    v_and_b32 v177, 1, v1
    v_lshl_add_u32 v77, v177, 4, v176
    v_lshrrev_b32 v177, 5, v1
    v_and_b32 v176, 31, v1
    v_lshlrev_b32 v176, 3, v176
    v_lshl_add_u32 v78, v177, 10, v176
    v_and_b32 v176, 7, v1
    v_lshlrev_b32 v176, 3, v176
    v_lshl_add_u32 v178, v177, 7, v176
    v_add_u32 v74, 31744, v73
    v_add_u32 v75, 63488, v73
    v_add_u32 v76, 95232, v73
    v_add_u32 v178, 53760, v178
    v_and_b32 v176, 31, v1
    v_cmp_eq_u32 vcc, 0, v176
    v_cmp_eq_u32 s[82:83], 24, v176
    s_nop 0
    s_or_b64 vcc, vcc, s[82:83]
    v_mov_b32 v176, 155648
    v_mov_b32 v177, 157696
    v_cndmask_b32 v176, v176, v177, vcc
    v_cndmask_b32 v79, v176, v178, s[78:79]
oe_23:
    s_waitcnt vmcnt(15)
    v_mfma_f32_16x16x32_bf16 v[112:115], a[176:179], v[216:219], 0
    v_mov_b32 v136, 0
    v_mov_b32 v137, 0
    s_waitcnt vmcnt(14)
    v_mfma_f32_16x16x32_bf16 v[116:119], a[176:179], v[220:223], 0
    v_mov_b32 v138, 0
    v_mov_b32 v139, 0
    s_waitcnt vmcnt(13)
    v_mfma_f32_16x16x32_bf16 v[112:115], a[196:199], v[224:227], v[112:115]
    v_mov_b32 v140, 0
    v_mov_b32_e64 v141, 0
    s_waitcnt vmcnt(12)
    v_mfma_f32_16x16x32_bf16 v[116:119], a[196:199], v[228:231], v[116:119]
    s_mov_b32 s25, 6817792
    s_add_u32 s26, s36, 6817792
    s_waitcnt vmcnt(11)
    v_mfma_f32_16x16x32_bf16 v[112:115], a[216:219], v[232:235], v[112:115]
    s_add_u32 s27, s35, 3477504
    s_mov_b32 s28, 0x99999999
    s_waitcnt vmcnt(10)
    v_mfma_f32_16x16x32_bf16 v[116:119], a[216:219], v[236:239], v[116:119]
    s_mov_b32 s29, 0x99999999
    s_waitcnt vmcnt(8)
    v_mfma_f32_16x16x32_bf16 v[112:115], a[236:239], v[240:243], v[112:115]
    s_waitcnt vmcnt(7)
    v_mfma_f32_16x16x32_bf16 v[116:119], a[236:239], v[244:247], v[116:119]
    s_waitcnt vmcnt(4)
    v_mfma_f32_16x16x32_bf16 v[112:115], v[52:55], v[248:251], v[112:115]
    s_waitcnt vmcnt(3)
    v_mfma_f32_16x16x32_bf16 v[116:119], v[52:55], v[252:255], v[116:119]
    v_mfma_f32_16x16x32_bf16 v[88:91], a[164:167], v[216:219], 0
    v_mfma_f32_16x16x32_bf16 v[92:95], a[164:167], v[220:223], 0
    v_mfma_f32_16x16x32_bf16 v[88:91], a[184:187], v[224:227], v[88:91]
    v_mfma_f32_16x16x32_bf16 v[92:95], a[184:187], v[228:231], v[92:95]
    v_mfma_f32_16x16x32_bf16 v[88:91], a[204:207], v[232:235], v[88:91]
    v_mfma_f32_16x16x32_bf16 v[92:95], a[204:207], v[236:239], v[92:95]
    s_nop 1
    v_cmp_u_f32 vcc, v112, v116
    s_nop 0
    s_cbranch_vccnz rd_24
rc_25:
    v_mfma_f32_16x16x32_bf16 v[88:91], a[224:227], v[240:243], v[88:91]
    ds_write_b128 v203, v[112:115] offset:24576
    v_mfma_f32_16x16x32_bf16 v[92:95], a[224:227], v[244:247], v[92:95]
    v_mfma_f32_16x16x32_bf16 v[88:91], a[244:247], v[248:251], v[88:91]
    ds_write_b128 v203, v[116:119] offset:25600
    v_mfma_f32_16x16x32_bf16 v[92:95], a[244:247], v[252:255], v[92:95]
    v_mfma_f32_16x16x32_bf16 v[96:99], a[168:171], v[216:219], 0
    s_waitcnt vmcnt(2)
    v_lshlrev_b32 v120, 16, v208
    v_and_b32 v121, 0xffff0000, v208
    v_mfma_f32_16x16x32_bf16 v[100:103], a[168:171], v[220:223], 0
    v_lshlrev_b32_e64 v122, 16, v209
    v_and_b32 v123, 0xffff0000, v209
    v_mfma_f32_16x16x32_bf16 v[96:99], a[188:191], v[224:227], v[96:99]
    s_waitcnt vmcnt(1)
    v_lshlrev_b32 v124, 16, v210
    v_and_b32 v125, 0xffff0000, v210
    v_mfma_f32_16x16x32_bf16 v[100:103], a[188:191], v[228:231], v[100:103]
    v_lshlrev_b32_e64 v126, 16, v211
    v_and_b32 v127, 0xffff0000, v211
    v_mfma_f32_16x16x32_bf16 v[96:99], a[208:211], v[232:235], v[96:99]
    s_waitcnt vmcnt(0)
    v_lshlrev_b32 v128, 16, v212
    v_and_b32 v129, 0xffff0000, v212
    v_mfma_f32_16x16x32_bf16 v[100:103], a[208:211], v[236:239], v[100:103]
    v_mfma_f32_16x16x32_bf16 v[96:99], a[228:231], v[240:243], v[96:99]
    ds_write_b128 v200, v[88:91] offset:0
    v_mfma_f32_16x16x32_bf16 v[100:103], a[228:231], v[244:247], v[100:103]
    v_mfma_f32_16x16x32_bf16 v[96:99], a[248:251], v[248:251], v[96:99]
    ds_write_b128 v200, v[92:95] offset:1024
    v_mfma_f32_16x16x32_bf16 v[100:103], a[248:251], v[252:255], v[100:103]
    v_mfma_f32_16x16x32_bf16 v[104:107], a[172:175], v[216:219], 0
    v_mfma_f32_16x16x32_bf16 v[108:111], a[172:175], v[220:223], 0
    v_mfma_f32_16x16x32_bf16 v[104:107], a[192:195], v[224:227], v[104:107]
    v_mfma_f32_16x16x32_bf16 v[108:111], a[192:195], v[228:231], v[108:111]
    v_mfma_f32_16x16x32_bf16 v[104:107], a[212:215], v[232:235], v[104:107]
    v_mfma_f32_16x16x32_bf16 v[108:111], a[212:215], v[236:239], v[108:111]
    v_mfma_f32_16x16x32_bf16 v[104:107], a[232:235], v[240:243], v[104:107]
    ds_write_b128 v201, v[96:99] offset:2048
    v_mfma_f32_16x16x32_bf16 v[108:111], a[232:235], v[244:247], v[108:111]
    v_mfma_f32_16x16x32_bf16 v[104:107], a[252:255], v[248:251], v[104:107]
    ds_write_b128 v201, v[100:103] offset:3072
    v_mfma_f32_16x16x32_bf16 v[108:111], a[252:255], v[252:255], v[108:111]
    v_mfma_f32_16x16x32_bf16 v[80:83], a[160:163], v[216:219], v[120:123]
    v_mfma_f32_16x16x32_bf16 v[84:87], a[160:163], v[220:223], v[124:127]
    v_mfma_f32_16x16x32_bf16 v[80:83], a[180:183], v[224:227], v[80:83]
    v_mfma_f32_16x16x32_bf16 v[84:87], a[180:183], v[228:231], v[84:87]
    v_mfma_f32_16x16x32_bf16 v[80:83], a[200:203], v[232:235], v[80:83]
    s_nop 0
    ds_write_b128 v202, v[104:107] offset:4096
    v_mfma_f32_16x16x32_bf16 v[84:87], a[200:203], v[236:239], v[84:87]
    ds_write_b128 v202, v[108:111] offset:5120
    v_mfma_f32_16x16x32_bf16 v[80:83], a[220:223], v[240:243], v[80:83]
    v_mfma_f32_16x16x32_bf16 v[84:87], a[220:223], v[244:247], v[84:87]
    v_mfma_f32_16x16x32_bf16 v[80:83], a[240:243], v[248:251], v[80:83]
    v_mfma_f32_16x16x32_bf16 v[84:87], a[240:243], v[252:255], v[84:87]
    s_waitcnt lgkmcnt(0)
    s_barrier
    s_nop 0
    ds_read_b128 v[88:91], v204 offset:0
    ds_read_b128 v[92:95], v204 offset:1024
    ds_read_b128 v[96:99], v204 offset:2048
    ds_read_b128 v[100:103], v204 offset:3072
    ds_read_b128 v[104:107], v204 offset:4096
    ds_read_b128 v[108:111], v204 offset:5120
    ds_read_b64 v[112:113], v205 offset:24576
    ds_read_b64 v[114:115], v205 offset:26624
    ds_read_b64 v[116:117], v205 offset:28672
    ds_read_b64 v[118:119], v205 offset:30720
    s_waitcnt lgkmcnt(9)
    v_pk_add_f32 v[80:81], v[80:81], v[88:89]
    v_pk_add_f32 v[82:83], v[82:83], v[90:91]
    s_waitcnt lgkmcnt(8)
    v_pk_add_f32 v[84:85], v[84:85], v[92:93]
    v_pk_add_f32 v[86:87], v[86:87], v[94:95]
    s_waitcnt lgkmcnt(7)
    v_pk_add_f32 v[80:81], v[80:81], v[96:97]
    v_pk_add_f32 v[82:83], v[82:83], v[98:99]
    s_waitcnt lgkmcnt(6)
    v_pk_add_f32 v[84:85], v[84:85], v[100:101]
    v_pk_add_f32 v[86:87], v[86:87], v[102:103]
    s_waitcnt lgkmcnt(5)
    v_pk_add_f32 v[80:81], v[80:81], v[104:105]
    v_pk_add_f32 v[82:83], v[82:83], v[106:107]
    s_waitcnt lgkmcnt(4)
    v_pk_add_f32 v[84:85], v[84:85], v[108:109]
    v_pk_add_f32 v[86:87], v[86:87], v[110:111]
    v_cvt_pk_bf16_f32 v132, v80, v81
    v_cvt_pk_bf16_f32 v133, v82, v83
    v_cvt_pk_bf16_f32 v134, v84, v85
    v_cvt_pk_bf16_f32 v135, v86, v87
    s_waitcnt lgkmcnt(3)
    v_pk_add_f32 v[128:129], v[128:129], v[112:113]
    s_waitcnt lgkmcnt(2)
    v_pk_add_f32 v[128:129], v[128:129], v[114:115]
    s_waitcnt lgkmcnt(1)
    v_pk_add_f32 v[128:129], v[128:129], v[116:117]
    s_waitcnt lgkmcnt(0)
    v_pk_add_f32 v[128:129], v[128:129], v[118:119]
    v_cvt_pk_bf16_f32 v130, v128, v129
    buffer_store_dwordx4 v[132:135], v59, s[16:19], s25 offen sc1
    buffer_store_dword v130, v61, s[16:19], s26 offen sc1
    v_dot2c_f32_bf16 v136, v132, v215
    v_dot2c_f32_bf16 v137, v132, v132
    v_dot2c_f32_bf16 v136, v133, v215
    v_dot2c_f32_bf16 v137, v133, v133
    v_dot2c_f32_bf16 v138, v134, v215
    v_dot2c_f32_bf16 v139, v134, v134
    v_dot2c_f32_bf16 v138, v135, v215
    v_dot2c_f32_bf16 v139, v135, v135
    v_dot2c_f32_bf16 v140, v130, v215
    v_dot2c_f32_bf16 v141, v130, v130
    v_permlane32_swap_b32 v136, v138
    v_permlane32_swap_b32 v137, v139
    v_pk_add_f32 v[136:137], v[136:137], v[138:139]
    v_pk_add_f32 v[136:137], v[136:137], v[140:141]
    s_nop 1
    v_permlane16_swap_b32 v136, v137
    v_add_f32 v136, v136, v137
    ds_write_b32 v206, v136 offset:32768
    s_lshl_b32 s96, s75, 14
    s_add_u32 s96, s96, 6815744
    s_lshl_b32 s97, s24, 12
    s_nop 0
    s_add_u32 s97, s97, 3473408
    buffer_load_dwordx4 v[176:179], v62, s[16:19], s96 offen offset:0 sc1
    buffer_load_dwordx4 v[180:183], v62, s[16:19], s96 offen offset:1024 sc1
    buffer_load_dwordx4 v[184:187], v62, s[16:19], s97 offen offset:0 sc1
    buffer_load_dwordx4 v[188:191], v62, s[16:19], s97 offen offset:1024 sc1
    buffer_load_dwordx4 v[192:195], v62, s[16:19], s97 offen offset:2048 sc1
    buffer_load_dwordx4 v[196:199], v62, s[16:19], s97 offen offset:3072 sc1
    s_waitcnt lgkmcnt(0)
    s_barrier
    ds_read2st64_b32 v[136:137], v207 offset0:0 offset1:1
    ds_read2st64_b32 v[138:139], v207 offset0:2 offset1:3
    s_waitcnt lgkmcnt(0)
    v_pk_add_f32 v[136:137], v[136:137], v[138:139]
    v_add_f32 v136, v136, v137
    v_cndmask_b32 v136, v136, 1.0, s[28:29]
    s_mov_b64 exec, s[80:81]
    buffer_atomic_add_f32 v136, v214, s[16:19], s27 offen
    s_mov_b64 exec, -1
    s_cmp_ge_u32 s2, 160
    s_cbranch_scc1 nc_26
    s_waitcnt vmcnt(1)
ce_28:
    v_max3_u32 v208, v176, v177, v178
    v_max3_u32 v208, v208, v179, v180
    v_max3_u32 v208, v208, v181, v182
    v_max_u32_e64 v208, v208, v183
    v_cmp_eq_u32 s[82:83], -1, v208
    v_min3_f32 v209, v184, v187, v188
    v_min3_f32 v209, v209, v191, v192
    v_min3_f32 v209, v209, v195, v196
    v_min_f32 v209, v209, v199
    v_cmp_neq_f32 vcc, 0x41000000, v209
    s_nop 0
    s_or_b64 vcc, vcc, s[82:83]
    s_cbranch_vccnz rd_29
rc_30:
    v_mul_f32 v208, 0x3acccccd, v185
    v_mul_f32 v209, 0x3acccccd, v189
    v_mul_f32 v186, 0x3acccccd, v186
    v_mul_f32 v190, 0x3acccccd, v190
    v_fma_f32 v186, -v208, v208, v186
    v_fma_f32 v190, -v209, v209, v190
    v_max_f32 v186, 0, v186
    v_max_f32 v190, 0, v190
    v_add_f32 v186, 0x3727c5ac, v186
    v_add_f32 v190, 0x3727c5ac, v190
    v_rsq_f32 v185, v186
    v_rsq_f32 v189, v190
    v_mul_f32 v186, -v208, v185
    v_mul_f32 v190, -v209, v189
    v_lshlrev_b32 v80, 16, v176
    v_and_b32 v82, 0xffff0000, v176
    v_lshlrev_b32 v84, 16, v177
    v_and_b32 v86, 0xffff0000, v177
    v_lshlrev_b32 v81, 16, v178
    v_and_b32 v83, 0xffff0000, v178
    v_lshlrev_b32 v85, 16, v179
    v_and_b32 v87, 0xffff0000, v179
    v_fma_f32 v208, v80, v185, v186
    v_fma_f32 v209, v81, v189, v190
    v_cvt_pk_bf16_f32 v176, v208, v209
    v_fma_f32 v208, v82, v185, v186
    v_fma_f32 v209, v83, v189, v190
    v_cvt_pk_bf16_f32 v177, v208, v209
    v_fma_f32 v208, v84, v185, v186
    v_fma_f32 v209, v85, v189, v190
    v_cvt_pk_bf16_f32 v178, v208, v209
    v_fma_f32 v208, v86, v185, v186
    v_fma_f32 v209, v87, v189, v190
    v_cvt_pk_bf16_f32 v179, v208, v209
    ds_write_b32 v63, v176 offset:0
    ds_write_b32 v63, v177 offset:4864
    ds_write_b32 v63, v178 offset:9728
    ds_write_b32 v63, v179 offset:14592
    v_mul_f32 v208, 0x3acccccd, v193
    v_mul_f32 v209, 0x3acccccd, v197
    v_mul_f32 v194, 0x3acccccd, v194
    v_mul_f32 v198, 0x3acccccd, v198
    v_fma_f32 v194, -v208, v208, v194
    v_fma_f32 v198, -v209, v209, v198
    v_max_f32 v194, 0, v194
    v_max_f32 v198, 0, v198
    v_add_f32 v194, 0x3727c5ac, v194
    v_add_f32 v198, 0x3727c5ac, v198
    v_rsq_f32 v193, v194
    v_rsq_f32 v197, v198
    v_mul_f32 v194, -v208, v193
    v_mul_f32 v198, -v209, v197
    v_lshlrev_b32 v88, 16, v180
    v_and_b32 v90, 0xffff0000, v180
    v_lshlrev_b32 v92, 16, v181
    v_and_b32 v94, 0xffff0000, v181
    v_lshlrev_b32 v89, 16, v182
    v_and_b32 v91, 0xffff0000, v182
    v_lshlrev_b32 v93, 16, v183
    v_and_b32 v95, 0xffff0000, v183
    v_fma_f32 v208, v88, v193, v194
    v_fma_f32 v209, v89, v197, v198
    v_cvt_pk_bf16_f32 v180, v208, v209
    v_fma_f32 v208, v90, v193, v194
    v_fma_f32 v209, v91, v197, v198
    v_cvt_pk_bf16_f32 v181, v208, v209
    v_fma_f32 v208, v92, v193, v194
    v_fma_f32 v209, v93, v197, v198
    v_cvt_pk_bf16_f32 v182, v208, v209
    v_fma_f32 v208, v94, v193, v194
    v_fma_f32 v209, v95, v197, v198
    v_cvt_pk_bf16_f32 v183, v208, v209
    ds_write_b32 v63, v180 offset:256
    ds_write_b32 v63, v181 offset:5120
    ds_write_b32 v63, v182 offset:9984
    ds_write_b32 v63, v183 offset:14848
    s_waitcnt lgkmcnt(0)
    s_barrier
    ds_read_b128 v[212:215], v64 offset:96
    ds_read_b128 v[216:219], v64 offset:64
    ds_read_b128 v[220:223], v64 offset:32
    ds_read_b128 v[224:227], v64 offset:0
    s_waitcnt lgkmcnt(3)
    v_mfma_f32_32x32x16_bf16 v[96:111], v[212:215], v[144:147], 0
    ds_read_b128 v[228:231], v64 offset:224
    ds_read_b64_tr_b16 v[176:177], v65 offset:1056
    ds_read_b64_tr_b16 v[178:179], v65 offset:1024
    ds_read_b64_tr_b16 v[180:181], v65 offset:1184
    ds_read_b64_tr_b16 v[182:183], v65 offset:1152
    s_waitcnt lgkmcnt(7)
    v_mfma_f32_32x32x16_bf16 v[96:111], v[216:219], v[148:151], v[96:111]
    ds_read_b128 v[232:235], v64 offset:192
    ds_read_b64_tr_b16 v[184:185], v65 offset:1312
    ds_read_b64_tr_b16 v[186:187], v65 offset:1280
    ds_read_b64_tr_b16 v[188:189], v65 offset:1440
    ds_read_b64_tr_b16 v[190:191], v65 offset:1408
    s_waitcnt lgkmcnt(11)
    v_mfma_f32_32x32x16_bf16 v[96:111], v[220:223], v[152:155], v[96:111]
    ds_read_b128 v[236:239], v64 offset:160
    ds_read_b64_tr_b16 v[192:193], v65 offset:1568
    ds_read_b64_tr_b16 v[194:195], v65 offset:1536
    ds_read_b64_tr_b16 v[196:197], v65 offset:1696
    ds_read_b64_tr_b16 v[198:199], v65 offset:1664
    s_waitcnt lgkmcnt(15)
    v_mfma_f32_32x32x16_bf16 v[96:111], v[224:227], v[156:159], v[96:111]
    ds_read_b128 v[240:243], v64 offset:128
    ds_read_b64_tr_b16 v[200:201], v65 offset:1824
    ds_read_b64_tr_b16 v[202:203], v65 offset:1792
    ds_read_b64_tr_b16 v[204:205], v65 offset:1952
    ds_read_b64_tr_b16 v[206:207], v65 offset:1920
    s_waitcnt lgkmcnt(15)
    v_mfma_f32_32x32x16_bf16 v[112:127], v[228:231], v[144:147], 0
    v_mov_b32 v248, -1
    v_mov_b32 v249, -1
    v_mov_b32 v250, -1
    v_mov_b32 v251, -1
    s_lshl_b32 s88, s75, 14
    s_add_u32 s88, s88, 9437184
    buffer_store_dwordx4 v[248:251], v62, s[16:19], s88 offen offset:0 sc1
    s_waitcnt lgkmcnt(14)
    v_mfma_f32_32x32x16_bf16 v[112:127], v[232:235], v[148:151], v[112:127]
    v_cndmask_b32 v208, v99, v72, s[76:77]
    v_cndmask_b32 v209, v103, v99, s[76:77]
    v_cndmask_b32 v210, v107, v103, s[76:77]
    v_cndmask_b32 v211, v111, v107, s[76:77]
    v_mov_b32_e64 v72, v111
    s_waitcnt lgkmcnt(9)
    v_mfma_f32_32x32x16_bf16 v[112:127], v[236:239], v[152:155], v[112:127]
    v_add_f32_dpp v98, v208, v98 wave_ror:1 row_mask:0xf bank_mask:0xf
    v_add_f32_dpp v102, v209, v102 wave_ror:1 row_mask:0xf bank_mask:0xf
    v_add_f32_dpp v106, v210, v106 wave_ror:1 row_mask:0xf bank_mask:0xf
    v_add_f32_dpp v110, v211, v110 wave_ror:1 row_mask:0xf bank_mask:0xf
    v_cndmask_b32 v208, v98, v71, s[76:77]
    s_waitcnt lgkmcnt(4)
    v_mfma_f32_32x32x16_bf16 v[112:127], v[240:243], v[156:159], v[112:127]
    v_cndmask_b32 v209, v102, v98, s[76:77]
    v_cndmask_b32 v210, v106, v102, s[76:77]
    v_cndmask_b32 v211, v110, v106, s[76:77]
    v_mov_b32 v71, v110
    v_add_f32_dpp v97, v208, v97 wave_ror:1 row_mask:0xf bank_mask:0xf
    v_add_f32_dpp v101, v209, v101 wave_ror:1 row_mask:0xf bank_mask:0xf
    v_mfma_f32_32x32x16_bf16 v[112:127], v[212:215], v[160:163], v[112:127]
    ds_read_b128 v[244:247], v64 offset:352
    v_add_f32_dpp v105, v210, v105 wave_ror:1 row_mask:0xf bank_mask:0xf
    v_add_f32_dpp v109, v211, v109 wave_ror:1 row_mask:0xf bank_mask:0xf
    v_cndmask_b32 v208, v97, v70, s[76:77]
    v_cndmask_b32 v209, v101, v97, s[76:77]
    v_cndmask_b32 v210, v105, v101, s[76:77]
    v_mfma_f32_32x32x16_bf16 v[112:127], v[216:219], v[164:167], v[112:127]
    ds_read_b128 v[216:219], v64 offset:320
    v_cndmask_b32 v211, v109, v105, s[76:77]
    v_mov_b32_e64 v70, v109
    v_add_f32_dpp v96, v208, v96 wave_ror:1 row_mask:0xf bank_mask:0xf
    v_add_f32_dpp v100, v209, v100 wave_ror:1 row_mask:0xf bank_mask:0xf
    v_add_f32_dpp v104, v210, v104 wave_ror:1 row_mask:0xf bank_mask:0xf
    v_mfma_f32_32x32x16_bf16 v[112:127], v[220:223], v[168:171], v[112:127]
    ds_read_b128 v[220:223], v64 offset:288
    buffer_store_dwordx4 v[248:251], v62, s[16:19], s88 offen offset:1024 sc1
    v_add_f32_dpp v108, v211, v108 wave_ror:1 row_mask:0xf bank_mask:0xf
    v_mfma_f32_32x32x16_bf16 v[112:127], v[224:227], v[172:175], v[112:127]
    ds_read_b128 v[224:227], v64 offset:256
    ds_write_b32 v66, v96 offset:0
    ds_write_b32 v66, v100 offset:64
    s_waitcnt lgkmcnt(5)
    v_mfma_f32_32x32x16_bf16 v[128:143], v[244:247], v[144:147], 0
    ds_write_b32 v66, v104 offset:128
    ds_write_b32 v66, v108 offset:192
    s_nop 0
    s_waitcnt lgkmcnt(6)
    v_mfma_f32_32x32x16_bf16 v[128:143], v[216:219], v[148:151], v[128:143]
    s_nop 3
    v_cndmask_b32 v208, v115, v72, s[76:77]
    s_waitcnt lgkmcnt(5)
    v_mfma_f32_32x32x16_bf16 v[128:143], v[220:223], v[152:155], v[128:143]
    v_cndmask_b32 v209, v119, v115, s[76:77]
    v_cndmask_b32 v210, v123, v119, s[76:77]
    v_cndmask_b32 v211, v127, v123, s[76:77]
    v_mov_b32 v72, v127
    v_add_f32_dpp v114, v208, v114 wave_ror:1 row_mask:0xf bank_mask:0xf
    s_waitcnt lgkmcnt(4)
    v_mfma_f32_32x32x16_bf16 v[128:143], v[224:227], v[156:159], v[128:143]
    v_add_f32_dpp v118, v209, v118 wave_ror:1 row_mask:0xf bank_mask:0xf
    v_add_f32_dpp v122, v210, v122 wave_ror:1 row_mask:0xf bank_mask:0xf
    v_add_f32_dpp v126, v211, v126 wave_ror:1 row_mask:0xf bank_mask:0xf
    v_cndmask_b32 v208, v114, v71, s[76:77]
    v_cndmask_b32 v209, v118, v114, s[76:77]
    v_cndmask_b32 v210, v122, v118, s[76:77]
    v_mfma_f32_32x32x16_bf16 v[128:143], v[228:231], v[160:163], v[128:143]
    buffer_store_dwordx4 v[248:251], v62, s[16:19], s88 offen offset:2048 sc1
    v_cndmask_b32 v211, v126, v122, s[76:77]
    v_mov_b32 v71, v126
    v_add_f32_dpp v113, v208, v113 wave_ror:1 row_mask:0xf bank_mask:0xf
    v_add_f32_dpp v117, v209, v117 wave_ror:1 row_mask:0xf bank_mask:0xf
    v_add_f32_dpp v121, v210, v121 wave_ror:1 row_mask:0xf bank_mask:0xf
    v_mfma_f32_32x32x16_bf16 v[128:143], v[232:235], v[164:167], v[128:143]
    ds_read_b128 v[232:235], v64 offset:64
    v_add_f32_dpp v125, v211, v125 wave_ror:1 row_mask:0xf bank_mask:0xf
    v_cndmask_b32 v208, v113, v70, s[76:77]
    v_cndmask_b32 v209, v117, v113, s[76:77]
    v_cndmask_b32 v210, v121, v117, s[76:77]
    v_cndmask_b32 v211, v125, v121, s[76:77]
    v_mfma_f32_32x32x16_bf16 v[128:143], v[236:239], v[168:171], v[128:143]
    ds_read_b128 v[236:239], v64 offset:32
    v_mov_b32_e64 v70, v125
    v_add_f32_dpp v112, v208, v112 wave_ror:1 row_mask:0xf bank_mask:0xf
    v_add_f32_dpp v116, v209, v116 wave_ror:1 row_mask:0xf bank_mask:0xf
    v_add_f32_dpp v120, v210, v120 wave_ror:1 row_mask:0xf bank_mask:0xf
    v_add_f32_dpp v124, v211, v124 wave_ror:1 row_mask:0xf bank_mask:0xf
    v_mfma_f32_32x32x16_bf16 v[128:143], v[240:243], v[172:175], v[128:143]
    ds_read_b128 v[240:243], v64 offset:0
    ds_write_b32 v66, v112 offset:256
    ds_write_b32 v66, v116 offset:320
    v_mfma_f32_32x32x16_bf16 v[128:143], v[212:215], v[176:179], v[128:143]
    ds_read_b128 v[212:215], v64 offset:480
    ds_write_b32 v66, v120 offset:384
    ds_write_b32 v66, v124 offset:448
    s_waitcnt lgkmcnt(7)
    v_mfma_f32_32x32x16_bf16 v[128:143], v[232:235], v[180:183], v[128:143]
    ds_read_b128 v[232:235], v64 offset:448
    s_waitcnt lgkmcnt(7)
    v_mfma_f32_32x32x16_bf16 v[128:143], v[236:239], v[184:187], v[128:143]
    ds_read_b128 v[236:239], v64 offset:416
    buffer_store_dwordx4 v[248:251], v62, s[16:19], s88 offen offset:3072 sc1
    s_waitcnt lgkmcnt(7)
    v_mfma_f32_32x32x16_bf16 v[128:143], v[240:243], v[188:191], v[128:143]
    ds_read_b128 v[240:243], v64 offset:384
    s_nop 3
    s_waitcnt lgkmcnt(5)
    v_mfma_f32_32x32x16_bf16 v[112:127], v[212:215], v[144:147], 0
    s_nop 4
    s_waitcnt lgkmcnt(2)
    v_mfma_f32_32x32x16_bf16 v[112:127], v[232:235], v[148:151], v[112:127]
    v_cndmask_b32 v208, v131, v72, s[76:77]
    v_cndmask_b32 v209, v135, v131, s[76:77]
    v_cndmask_b32 v210, v139, v135, s[76:77]
    v_cndmask_b32 v211, v143, v139, s[76:77]
    v_mov_b32_e64 v72, v143
    s_waitcnt lgkmcnt(1)
    v_mfma_f32_32x32x16_bf16 v[112:127], v[236:239], v[152:155], v[112:127]
    v_add_f32_dpp v130, v208, v130 wave_ror:1 row_mask:0xf bank_mask:0xf
    v_add_f32_dpp v134, v209, v134 wave_ror:1 row_mask:0xf bank_mask:0xf
    v_add_f32_dpp v138, v210, v138 wave_ror:1 row_mask:0xf bank_mask:0xf
    v_add_f32_dpp v142, v211, v142 wave_ror:1 row_mask:0xf bank_mask:0xf
    v_cndmask_b32 v208, v130, v71, s[76:77]
    s_waitcnt lgkmcnt(0)
    v_mfma_f32_32x32x16_bf16 v[112:127], v[240:243], v[156:159], v[112:127]
    v_cndmask_b32 v209, v134, v130, s[76:77]
    v_cndmask_b32 v210, v138, v134, s[76:77]
    v_cndmask_b32 v211, v142, v138, s[76:77]
    v_mov_b32 v71, v142
    v_add_f32_dpp v129, v208, v129 wave_ror:1 row_mask:0xf bank_mask:0xf
    v_add_f32_dpp v133, v209, v133 wave_ror:1 row_mask:0xf bank_mask:0xf
    v_mfma_f32_32x32x16_bf16 v[112:127], v[244:247], v[160:163], v[112:127]
    v_add_f32_dpp v137, v210, v137 wave_ror:1 row_mask:0xf bank_mask:0xf
    v_add_f32_dpp v141, v211, v141 wave_ror:1 row_mask:0xf bank_mask:0xf
    v_cndmask_b32 v208, v129, v70, s[76:77]
    v_cndmask_b32 v209, v133, v129, s[76:77]
    v_cndmask_b32 v210, v137, v133, s[76:77]
    v_cndmask_b32 v211, v141, v137, s[76:77]
    v_mfma_f32_32x32x16_bf16 v[112:127], v[216:219], v[164:167], v[112:127]
    ds_read_b128 v[240:243], v64 offset:192
    v_mov_b32_e64 v70, v141
    v_add_f32_dpp v128, v208, v128 wave_ror:1 row_mask:0xf bank_mask:0xf
    v_add_f32_dpp v132, v209, v132 wave_ror:1 row_mask:0xf bank_mask:0xf
    v_add_f32_dpp v136, v210, v136 wave_ror:1 row_mask:0xf bank_mask:0xf
    v_add_f32_dpp v140, v211, v140 wave_ror:1 row_mask:0xf bank_mask:0xf
    v_mfma_f32_32x32x16_bf16 v[112:127], v[220:223], v[168:171], v[112:127]
    ds_read_b128 v[220:223], v64 offset:160
    ds_write_b32 v66, v128 offset:512
    ds_write_b32 v66, v132 offset:576
    v_mfma_f32_32x32x16_bf16 v[112:127], v[224:227], v[172:175], v[112:127]
    ds_read_b128 v[224:227], v64 offset:128
    ds_write_b32 v66, v136 offset:640
    ds_write_b32 v66, v140 offset:704
    v_mfma_f32_32x32x16_bf16 v[112:127], v[228:231], v[176:179], v[112:127]
    ds_read_b128 v[236:239], v64 offset:96
    s_waitcnt lgkmcnt(7)
    v_mfma_f32_32x32x16_bf16 v[112:127], v[240:243], v[180:183], v[112:127]
    ds_read_b128 v[240:243], v64 offset:64
    s_waitcnt lgkmcnt(7)
    v_mfma_f32_32x32x16_bf16 v[112:127], v[220:223], v[184:187], v[112:127]
    ds_read_b128 v[220:223], v64 offset:32
    s_waitcnt lgkmcnt(5)
    v_mfma_f32_32x32x16_bf16 v[112:127], v[224:227], v[188:191], v[112:127]
    ds_read_b128 v[224:227], v64 offset:0
    s_waitcnt lgkmcnt(3)
    v_mfma_f32_32x32x16_bf16 v[112:127], v[236:239], v[192:195], v[112:127]
    ds_read_b64_tr_b16 v[216:217], v65 offset:544
    ds_read_b64_tr_b16 v[218:219], v65 offset:512
    s_waitcnt lgkmcnt(4)
    v_mfma_f32_32x32x16_bf16 v[112:127], v[240:243], v[196:199], v[112:127]
    ds_read_b64_tr_b16 v[240:241], v65 offset:1056
    ds_read_b64_tr_b16 v[242:243], v65 offset:1024
    s_waitcnt lgkmcnt(5)
    v_mfma_f32_32x32x16_bf16 v[112:127], v[220:223], v[200:203], v[112:127]
    s_waitcnt lgkmcnt(4)
    v_mfma_f32_32x32x16_bf16 v[112:127], v[224:227], v[204:207], v[112:127]
    ds_read_b64_tr_b16 v[224:225], v65 offset:1568
    ds_read_b64_tr_b16 v[226:227], v65 offset:1536
    s_lshl_b32 s96, s75, 14
    s_add_u32 s96, s96, 6815744
    s_lshl_b32 s97, s24, 12
    s_add_u32 s97, s97, 3477504
    buffer_load_dwordx4 v[248:251], v62, s[16:19], s96 offen offset:2048 sc1
    s_waitcnt lgkmcnt(4)
    v_mfma_f32_32x32x16_bf16 v[144:159], v[212:215], v[216:219], 0
    s_nop 3
    v_cndmask_b32 v208, v115, v72, s[76:77]
    s_waitcnt lgkmcnt(2)
    v_mfma_f32_32x32x16_bf16 v[144:159], v[244:247], v[240:243], v[144:159]
    buffer_load_dwordx4 v[252:255], v62, s[16:19], s96 offen offset:3072 sc1
    v_cndmask_b32 v209, v119, v115, s[76:77]
    v_cndmask_b32 v210, v123, v119, s[76:77]
    v_cndmask_b32 v211, v127, v123, s[76:77]
    v_mov_b32_e64 v72, v127
    v_add_f32_dpp v114, v208, v114 wave_ror:1 row_mask:0xf bank_mask:0xf
    v_mfma_f32_32x32x16_bf16 v[160:175], v[212:215], v[240:243], 0
    ds_read_b64_tr_b16 v[216:217], v65 offset:2080
    ds_read_b64_tr_b16 v[218:219], v65 offset:2048
    v_add_f32_dpp v118, v209, v118 wave_ror:1 row_mask:0xf bank_mask:0xf
    v_add_f32_dpp v122, v210, v122 wave_ror:1 row_mask:0xf bank_mask:0xf
    v_add_f32_dpp v126, v211, v126 wave_ror:1 row_mask:0xf bank_mask:0xf
    s_waitcnt lgkmcnt(2)
    v_mfma_f32_32x32x16_bf16 v[144:159], v[228:231], v[224:227], v[144:159]
    buffer_load_dwordx4 v[96:99], v62, s[16:19], s97 offen offset:0 sc1
    v_cndmask_b32 v208, v114, v71, s[76:77]
    v_cndmask_b32 v209, v118, v114, s[76:77]
    v_cndmask_b32 v210, v122, v118, s[76:77]
    v_cndmask_b32 v211, v126, v122, s[76:77]
    v_mov_b32 v71, v126
    v_mfma_f32_32x32x16_bf16 v[160:175], v[244:247], v[224:227], v[160:175]
    v_add_f32_dpp v113, v208, v113 wave_ror:1 row_mask:0xf bank_mask:0xf
    v_add_f32_dpp v117, v209, v117 wave_ror:1 row_mask:0xf bank_mask:0xf
    v_add_f32_dpp v121, v210, v121 wave_ror:1 row_mask:0xf bank_mask:0xf
    v_add_f32_dpp v125, v211, v125 wave_ror:1 row_mask:0xf bank_mask:0xf
    v_cndmask_b32 v208, v113, v70, s[76:77]
    v_cndmask_b32 v209, v117, v113, s[76:77]
    v_mfma_f32_32x32x16_bf16 v[176:191], v[212:215], v[224:227], 0
    buffer_load_dwordx4 v[100:103], v62, s[16:19], s97 offen offset:1024 sc1
    v_cndmask_b32 v210, v121, v117, s[76:77]
    v_cndmask_b32 v211, v125, v121, s[76:77]
    v_mov_b32 v70, v125
    v_add_f32_dpp v112, v208, v112 wave_ror:1 row_mask:0xf bank_mask:0xf
    s_waitcnt lgkmcnt(0)
    v_mfma_f32_32x32x16_bf16 v[144:159], v[236:239], v[216:219], v[144:159]
    ds_read_b64_tr_b16 v[240:241], v65 offset:2592
    ds_read_b64_tr_b16 v[242:243], v65 offset:2560
    v_add_f32_dpp v116, v209, v116 wave_ror:1 row_mask:0xf bank_mask:0xf
    v_add_f32_dpp v120, v210, v120 wave_ror:1 row_mask:0xf bank_mask:0xf
    v_add_f32_dpp v124, v211, v124 wave_ror:1 row_mask:0xf bank_mask:0xf
    v_mfma_f32_32x32x16_bf16 v[160:175], v[228:231], v[216:219], v[160:175]
    buffer_load_dwordx4 v[104:107], v62, s[16:19], s97 offen offset:2048 sc1
    ds_write_b32 v66, v112 offset:768
    ds_write_b32 v66, v116 offset:832
    v_mfma_f32_32x32x16_bf16 v[176:191], v[244:247], v[216:219], v[176:191]
    ds_write_b32 v66, v120 offset:896
    ds_write_b32 v66, v124 offset:960
    v_mfma_f32_32x32x16_bf16 v[192:207], v[212:215], v[216:219], 0
    ds_read_b64_tr_b16 v[212:213], v65 offset:3104
    ds_read_b64_tr_b16 v[214:215], v65 offset:3072
    buffer_load_dwordx4 v[108:111], v62, s[16:19], s97 offen offset:3072 sc1
    s_waitcnt lgkmcnt(6)
    v_mfma_f32_32x32x16_bf16 v[160:175], v[236:239], v[240:243], v[160:175]
    v_mfma_f32_32x32x16_bf16 v[176:191], v[228:231], v[240:243], v[176:191]
    ds_read_b64_tr_b16 v[224:225], v65 offset:3616
    ds_read_b64_tr_b16 v[226:227], v65 offset:3584
    s_waitcnt vmcnt(6) lgkmcnt(4)
    s_barrier
    v_mfma_f32_32x32x16_bf16 v[192:207], v[244:247], v[240:243], v[192:207]
    ds_read_b64_tr_b16 v[244:245], v65 offset:672
    ds_read_b64_tr_b16 v[246:247], v65 offset:640
    ds_read_b64 v[112:113], v67 offset:0
    ds_read_b64 v[114:115], v67 offset:4224
    ds_read_b64 v[116:117], v67 offset:8448
    s_waitcnt lgkmcnt(7)
    v_mfma_f32_32x32x16_bf16 v[176:191], v[236:239], v[212:215], v[176:191]
    ds_read_b128 v[216:219], v64 offset:320
    ds_read_b64_tr_b16 v[240:241], v65 offset:1184
    ds_read_b64_tr_b16 v[242:243], v65 offset:1152
    ds_read_b64 v[118:119], v67 offset:12672
    ds_read_b64 v[120:121], v67 offset:512
    ds_read_b64 v[122:123], v67 offset:4736
    v_mfma_f32_32x32x16_bf16 v[192:207], v[228:231], v[212:215], v[192:207]
    ds_read_b64 v[124:125], v67 offset:8960
    ds_read_b64 v[126:127], v67 offset:13184
    s_lshl_b32 s25, s75, 14
    s_add_u32 s25, s25, 9437184
    s_waitcnt lgkmcnt(13)
    v_mfma_f32_32x32x16_bf16 v[192:207], v[236:239], v[224:227], v[192:207]
    ds_read_b128 v[228:231], v64 offset:192
    ds_read_b64_tr_b16 v[236:237], v65 offset:1696
    ds_read_b64_tr_b16 v[238:239], v65 offset:1664
    s_waitcnt lgkmcnt(14)
    v_mfma_f32_32x32x16_bf16 v[144:159], v[232:235], v[244:247], v[144:159]
    v_mov_b32 v5, 1
    s_add_u32 s82, s86, 24576
    buffer_atomic_add v5, v6, s[16:19], s82 offen offset:0 sc0 sc1
    s_waitcnt lgkmcnt(8)
    v_mfma_f32_32x32x16_bf16 v[144:159], v[216:219], v[240:243], v[144:159]
    v_mfma_f32_32x32x16_bf16 v[160:175], v[232:235], v[240:243], v[160:175]
    ds_read_b128 v[212:215], v64 offset:64
    ds_read_b64_tr_b16 v[224:225], v65 offset:2208
    ds_read_b64_tr_b16 v[226:227], v65 offset:2176
    s_waitcnt lgkmcnt(3)
    v_mfma_f32_32x32x16_bf16 v[144:159], v[228:231], v[236:239], v[144:159]
    v_mfma_f32_32x32x16_bf16 v[160:175], v[216:219], v[236:239], v[160:175]
    v_add_f32 v112, v112, v80
    v_add_f32 v113, v113, v81
    v_add_f32 v114, v114, v82
    v_add_f32 v115, v115, v83
    v_add_f32 v116, v116, v84
    v_mfma_f32_32x32x16_bf16 v[176:191], v[232:235], v[236:239], v[176:191]
    v_add_f32 v117, v117, v85
    v_add_f32 v118, v118, v86
    v_add_f32 v119, v119, v87
    v_cvt_pk_bf16_f32 v128, v112, v114
    v_cvt_pk_bf16_f32 v129, v116, v118
    s_waitcnt lgkmcnt(0)
    v_mfma_f32_32x32x16_bf16 v[144:159], v[212:215], v[224:227], v[144:159]
    ds_read_b64_tr_b16 v[244:245], v65 offset:2720
    ds_read_b64_tr_b16 v[246:247], v65 offset:2688
    v_cvt_pk_bf16_f32 v130, v113, v115
    v_cvt_pk_bf16_f32 v131, v117, v119
    v_mfma_f32_32x32x16_bf16 v[160:175], v[228:231], v[224:227], v[160:175]
    buffer_store_dwordx4 v[128:131], v62, s[16:19], s25 offen offset:0 sc1
    v_add_f32 v120, v120, v88
    v_add_f32 v121, v121, v89
    v_add_f32 v122, v122, v90
    v_add_f32 v123, v123, v91
    v_add_f32 v124, v124, v92
    v_mfma_f32_32x32x16_bf16 v[176:191], v[216:219], v[224:227], v[176:191]
    v_add_f32 v125, v125, v93
    v_add_f32 v126, v126, v94
    v_add_f32_e64 v127, v127, v95
    v_cvt_pk_bf16_f32 v132, v120, v122
    v_cvt_pk_bf16_f32 v133, v124, v126
    v_cvt_pk_bf16_f32 v134, v121, v123
    v_mfma_f32_32x32x16_bf16 v[192:207], v[232:235], v[224:227], v[192:207]
    ds_read_b64_tr_b16 v[232:233], v65 offset:3232
    ds_read_b64_tr_b16 v[234:235], v65 offset:3200
    v_cvt_pk_bf16_f32 v135, v125, v127
    s_waitcnt lgkmcnt(2)
    v_mfma_f32_32x32x16_bf16 v[160:175], v[212:215], v[244:247], v[160:175]
    buffer_store_dwordx4 v[132:135], v62, s[16:19], s25 offen offset:1024 sc1
    ds_read_b64_tr_b16 v[112:113], v65 offset:32
    ds_read_b64_tr_b16 v[114:115], v65 offset:0
    ds_read_b64_tr_b16 v[116:117], v65 offset:160
    ds_read_b64_tr_b16 v[118:119], v65 offset:128
    ds_read_b64_tr_b16 v[120:121], v65 offset:288
    v_mfma_f32_32x32x16_bf16 v[176:191], v[228:231], v[244:247], v[176:191]
    ds_read_b64_tr_b16 v[240:241], v65 offset:3744
    ds_read_b64_tr_b16 v[242:243], v65 offset:3712
    ds_read_b64_tr_b16 v[122:123], v65 offset:256
    ds_read_b64_tr_b16 v[124:125], v65 offset:416
    ds_read_b64_tr_b16 v[126:127], v65 offset:384
    ds_read_b64_tr_b16 v[128:129], v65 offset:544
    v_mfma_f32_32x32x16_bf16 v[192:207], v[216:219], v[244:247], v[192:207]
    ds_read_b128 v[216:219], v64 offset:416
    ds_read_b64_tr_b16 v[236:237], v65 offset:800
    ds_read_b64_tr_b16 v[238:239], v65 offset:768
    ds_read_b64_tr_b16 v[130:131], v65 offset:512
    ds_read_b64_tr_b16 v[132:133], v65 offset:672
    s_waitcnt lgkmcnt(15)
    v_mfma_f32_32x32x16_bf16 v[176:191], v[212:215], v[232:235], v[176:191]
    ds_read_b128 v[224:227], v64 offset:288
    ds_read_b64_tr_b16 v[244:245], v65 offset:1312
    ds_read_b64_tr_b16 v[246:247], v65 offset:1280
    ds_read_b64_tr_b16 v[134:135], v65 offset:640
    ds_read_b64_tr_b16 v[136:137], v65 offset:800
    ds_read_b64_tr_b16 v[138:139], v65 offset:768
    v_mfma_f32_32x32x16_bf16 v[192:207], v[228:231], v[232:235], v[192:207]
    ds_read_b64_tr_b16 v[140:141], v65 offset:928
    ds_read_b64_tr_b16 v[142:143], v65 offset:896
    s_waitcnt lgkmcnt(15)
    v_mfma_f32_32x32x16_bf16 v[192:207], v[212:215], v[240:243], v[192:207]
    ds_read_b128 v[228:231], v64 offset:160
    ds_read_b64_tr_b16 v[212:213], v65 offset:1824
    ds_read_b64_tr_b16 v[214:215], v65 offset:1792
    s_waitcnt vmcnt(3)
ce_31:
    v_max3_u32 v208, v248, v249, v250
    v_max3_u32 v208, v208, v251, v252
    v_max3_u32 v208, v208, v253, v254
    v_max_u32_e64 v208, v208, v255
    v_cmp_eq_u32 s[82:83], -1, v208
    v_min3_f32 v209, v96, v99, v100
    v_min3_f32 v209, v209, v103, v104
    v_min3_f32 v209, v209, v107, v108
    v_min_f32 v209, v209, v111
    v_cmp_neq_f32 vcc, 0x41000000, v209
    s_nop 0
    s_or_b64 vcc, vcc, s[82:83]
    s_cbranch_vccnz rd_32
rc_33:
    s_waitcnt lgkmcnt(13)
    v_mfma_f32_32x32x16_bf16 v[144:159], v[216:219], v[236:239], v[144:159]
    v_mul_f32 v208, 0x3acccccd, v97
    v_mul_f32 v209, 0x3acccccd, v101
    v_mul_f32 v98, 0x3acccccd, v98
    v_mul_f32 v102, 0x3acccccd, v102
    v_fma_f32 v98, -v208, v208, v98
    s_waitcnt lgkmcnt(8)
    v_mfma_f32_32x32x16_bf16 v[144:159], v[224:227], v[244:247], v[144:159]
    v_fma_f32 v102, -v209, v209, v102
    v_max_f32 v98, 0, v98
    v_max_f32 v102, 0, v102
    v_add_f32 v98, 0x3727c5ac, v98
    v_add_f32 v102, 0x3727c5ac, v102
    v_mfma_f32_32x32x16_bf16 v[160:175], v[216:219], v[244:247], v[160:175]
    ds_read_b64_tr_b16 v[232:233], v65 offset:2336
    ds_read_b64_tr_b16 v[234:235], v65 offset:2304
    v_rsq_f32 v97, v98
    s_waitcnt lgkmcnt(2)
    v_mfma_f32_32x32x16_bf16 v[144:159], v[228:231], v[212:215], v[144:159]
    v_rsq_f32_e64 v101, v102
    v_mul_f32 v98, -v208, v97
    v_mul_f32 v102, -v209, v101
    v_lshlrev_b32_e64 v80, 16, v248
    v_and_b32 v82, 0xffff0000, v248
    v_mfma_f32_32x32x16_bf16 v[160:175], v[224:227], v[212:215], v[160:175]
    v_lshlrev_b32 v84, 16, v249
    v_and_b32 v86, 0xffff0000, v249
    v_lshlrev_b32 v81, 16, v250
    v_and_b32 v83, 0xffff0000, v250
    v_lshlrev_b32_e64 v85, 16, v251
    v_and_b32 v87, 0xffff0000, v251
    v_mfma_f32_32x32x16_bf16 v[176:191], v[216:219], v[212:215], v[176:191]
    v_fma_f32 v208, v80, v97, v98
    v_fma_f32 v209, v81, v101, v102
    v_cvt_pk_bf16_f32 v248, v208, v209
    v_fma_f32 v208, v82, v97, v98
    v_fma_f32 v209, v83, v101, v102
    s_waitcnt lgkmcnt(0)
    v_mfma_f32_32x32x16_bf16 v[144:159], v[220:223], v[232:235], v[144:159]
    ds_read_b64_tr_b16 v[240:241], v65 offset:2848
    ds_read_b64_tr_b16 v[242:243], v65 offset:2816
    v_cvt_pk_bf16_f32 v249, v208, v209
    v_fma_f32 v208, v84, v97, v98
    v_fma_f32 v209, v85, v101, v102
    v_cvt_pk_bf16_f32 v250, v208, v209
    v_mfma_f32_32x32x16_bf16 v[160:175], v[228:231], v[232:235], v[160:175]
    v_fma_f32 v208, v86, v97, v98
    v_fma_f32 v209, v87, v101, v102
    v_cvt_pk_bf16_f32 v251, v208, v209
    v_mfma_f32_32x32x16_bf16 v[176:191], v[224:227], v[232:235], v[176:191]
    ds_write_b32 v63, v248 offset:512
    ds_write_b32 v63, v249 offset:5376
    ds_write_b32 v63, v250 offset:10240
    v_mfma_f32_32x32x16_bf16 v[192:207], v[216:219], v[232:235], v[192:207]
    ds_read_b64_tr_b16 v[216:217], v65 offset:3360
    ds_read_b64_tr_b16 v[218:219], v65 offset:3328
    ds_write_b32 v63, v251 offset:15104
    v_mul_f32 v208, 0x3acccccd, v105
    s_waitcnt lgkmcnt(6)
    v_mfma_f32_32x32x16_bf16 v[160:175], v[220:223], v[240:243], v[160:175]
    v_mul_f32 v209, 0x3acccccd, v109
    v_mul_f32 v106, 0x3acccccd, v106
    v_mul_f32 v110, 0x3acccccd, v110
    v_fma_f32 v106, -v208, v208, v106
    v_fma_f32 v110, -v209, v209, v110
    v_max_f32_e64 v106, 0, v106
    v_mfma_f32_32x32x16_bf16 v[176:191], v[228:231], v[240:243], v[176:191]
    ds_read_b64_tr_b16 v[236:237], v65 offset:3872
    ds_read_b64_tr_b16 v[238:239], v65 offset:3840
    v_max_f32_e64 v110, 0, v110
    v_add_f32 v106, 0x3727c5ac, v106
    v_add_f32 v110, 0x3727c5ac, v110
    v_mfma_f32_32x32x16_bf16 v[192:207], v[224:227], v[240:243], v[192:207]
    ds_read_b128 v[224:227], v64 offset:384
    ds_read_b64_tr_b16 v[244:245], v65 offset:928
    ds_read_b64_tr_b16 v[246:247], v65 offset:896
    v_rsq_f32 v105, v106
    s_waitcnt lgkmcnt(6)
    v_mfma_f32_32x32x16_bf16 v[176:191], v[220:223], v[216:219], v[176:191]
    ds_read_b128 v[212:215], v64 offset:256
    ds_read_b64_tr_b16 v[232:233], v65 offset:1440
    ds_read_b64_tr_b16 v[234:235], v65 offset:1408
    v_rsq_f32_e64 v109, v110
    v_mul_f32 v106, -v208, v105
    v_mfma_f32_32x32x16_bf16 v[192:207], v[228:231], v[216:219], v[192:207]
    v_mul_f32 v110, -v209, v109
    v_lshlrev_b32 v88, 16, v252
    v_and_b32 v90, 0xffff0000, v252
    v_lshlrev_b32 v92, 16, v253
    v_and_b32 v94, 0xffff0000, v253
    s_waitcnt lgkmcnt(6)
    v_mfma_f32_32x32x16_bf16 v[192:207], v[220:223], v[236:239], v[192:207]
    ds_read_b128 v[220:223], v64 offset:128
    ds_read_b64_tr_b16 v[228:229], v65 offset:1952
    ds_read_b64_tr_b16 v[230:231], v65 offset:1920
    v_lshlrev_b32 v89, 16, v254
    v_and_b32 v91, 0xffff0000, v254
    s_waitcnt lgkmcnt(6)
    v_mfma_f32_32x32x16_bf16 v[144:159], v[224:227], v[244:247], v[144:159]
    v_lshlrev_b32 v93, 16, v255
    v_and_b32 v95, 0xffff0000, v255
    v_fma_f32 v208, v88, v105, v106
    v_fma_f32 v209, v89, v109, v110
    v_cvt_pk_bf16_f32 v252, v208, v209
    s_waitcnt lgkmcnt(3)
    v_mfma_f32_32x32x16_bf16 v[144:159], v[212:215], v[232:235], v[144:159]
    v_fma_f32 v208, v90, v105, v106
    v_fma_f32 v209, v91, v109, v110
    v_cvt_pk_bf16_f32 v253, v208, v209
    v_fma_f32 v208, v92, v105, v106
    v_fma_f32 v209, v93, v109, v110
    v_cvt_pk_bf16_f32 v254, v208, v209
    v_mfma_f32_32x32x16_bf16 v[160:175], v[224:227], v[232:235], v[160:175]
    ds_read_b128 v[240:243], v64 offset:0
    ds_read_b64_tr_b16 v[216:217], v65 offset:2464
    ds_read_b64_tr_b16 v[218:219], v65 offset:2432
    v_fma_f32 v208, v94, v105, v106
    v_fma_f32 v209, v95, v109, v110
    s_waitcnt lgkmcnt(3)
    v_mfma_f32_32x32x16_bf16 v[144:159], v[220:223], v[228:231], v[144:159]
    v_cvt_pk_bf16_f32 v255, v208, v209
    ds_write_b32 v63, v252 offset:768
    v_mfma_f32_32x32x16_bf16 v[160:175], v[212:215], v[228:231], v[160:175]
    ds_write_b32 v63, v253 offset:5632
    ds_write_b32 v63, v254 offset:10496
    ds_write_b32 v63, v255 offset:15360
    v_mfma_f32_32x32x16_bf16 v[176:191], v[224:227], v[228:231], v[176:191]
    s_waitcnt vmcnt(2)
    v_cmp_eq_u32 vcc, 19, v5
    s_nop 0
    s_cbranch_vccnz gl_34
gc_35:
    s_lshl_b32 s25, s72, 5
    s_add_u32 s25, s25, 0
    s_sub_u32 s26, s25, 4
    s_waitcnt lgkmcnt(4)
    v_mfma_f32_32x32x16_bf16 v[144:159], v[240:243], v[216:219], v[144:159]
    ds_read_b64_tr_b16 v[236:237], v65 offset:2976
    ds_read_b64_tr_b16 v[238:239], v65 offset:2944
    s_max_i32 s26, s26, 0
    s_lshl_b32 s27, s71, 12
    s_add_u32 s27, s27, 9437184
    s_lshl_b32 s99, s25, 3
    v_mfma_f32_32x32x16_bf16 v[160:175], v[220:223], v[216:219], v[160:175]
    s_lshl_b32 s100, s26, 3
    s_lshl_b32 s92, s24, 12
    s_lshl_b32 s93, s24, 9
    s_add_u32 s99, s99, s27
    s_add_u32 s100, s100, s27
    v_mfma_f32_32x32x16_bf16 v[176:191], v[212:215], v[216:219], v[176:191]
    v_mfma_f32_32x32x16_bf16 v[192:207], v[224:227], v[216:219], v[192:207]
    ds_read_b64_tr_b16 v[224:225], v65 offset:3488
    ds_read_b64_tr_b16 v[226:227], v65 offset:3456
    s_waitcnt lgkmcnt(2)
    v_mfma_f32_32x32x16_bf16 v[160:175], v[240:243], v[236:239], v[160:175]
    v_mfma_f32_32x32x16_bf16 v[176:191], v[220:223], v[236:239], v[176:191]
    ds_read_b64_tr_b16 v[244:245], v65 offset:4000
    ds_read_b64_tr_b16 v[246:247], v65 offset:3968
    v_mfma_f32_32x32x16_bf16 v[192:207], v[212:215], v[236:239], v[192:207]
    s_waitcnt lgkmcnt(2)
    v_mfma_f32_32x32x16_bf16 v[176:191], v[240:243], v[224:227], v[176:191]
    v_mfma_f32_32x32x16_bf16 v[192:207], v[220:223], v[224:227], v[192:207]
    s_waitcnt lgkmcnt(0)
    v_mfma_f32_32x32x16_bf16 v[192:207], v[240:243], v[244:247], v[192:207]
    s_waitcnt lgkmcnt(0)
    s_barrier
    ds_read_b128 v[212:215], v64 offset:608
    ds_read_b128 v[216:219], v64 offset:576
    ds_read_b128 v[220:223], v64 offset:544
    ds_read_b128 v[224:227], v64 offset:512
    s_waitcnt lgkmcnt(3)
    v_mfma_f32_32x32x16_bf16 v[144:159], v[212:215], v[112:115], v[144:159]
    ds_read_b128 v[228:231], v64 offset:736
    s_waitcnt lgkmcnt(3)
    v_mfma_f32_32x32x16_bf16 v[144:159], v[216:219], v[116:119], v[144:159]
    ds_read_b128 v[232:235], v64 offset:704
    s_waitcnt lgkmcnt(3)
    v_mfma_f32_32x32x16_bf16 v[144:159], v[220:223], v[120:123], v[144:159]
    ds_read_b128 v[236:239], v64 offset:672
    s_waitcnt lgkmcnt(3)
    v_mfma_f32_32x32x16_bf16 v[144:159], v[224:227], v[124:127], v[144:159]
    ds_read_b128 v[240:243], v64 offset:640
    s_nop 3
    s_waitcnt lgkmcnt(3)
    v_mfma_f32_32x32x16_bf16 v[160:175], v[228:231], v[112:115], v[160:175]
    s_nop 4
    s_waitcnt lgkmcnt(2)
    v_mfma_f32_32x32x16_bf16 v[160:175], v[232:235], v[116:119], v[160:175]
    v_cndmask_b32 v208, v147, v72, s[76:77]
    v_cndmask_b32 v209, v151, v147, s[76:77]
    v_cndmask_b32 v210, v155, v151, s[76:77]
    v_cndmask_b32 v211, v159, v155, s[76:77]
    v_mov_b32_e64 v72, v159
    s_waitcnt lgkmcnt(1)
    v_mfma_f32_32x32x16_bf16 v[160:175], v[236:239], v[120:123], v[160:175]
    v_add_f32_dpp v146, v208, v146 wave_ror:1 row_mask:0xf bank_mask:0xf
    v_add_f32_dpp v150, v209, v150 wave_ror:1 row_mask:0xf bank_mask:0xf
    v_add_f32_dpp v154, v210, v154 wave_ror:1 row_mask:0xf bank_mask:0xf
    v_add_f32_dpp v158, v211, v158 wave_ror:1 row_mask:0xf bank_mask:0xf
    v_cndmask_b32 v208, v146, v71, s[76:77]
    s_waitcnt lgkmcnt(0)
    v_mfma_f32_32x32x16_bf16 v[160:175], v[240:243], v[124:127], v[160:175]
    v_cndmask_b32 v209, v150, v146, s[76:77]
    v_cndmask_b32 v210, v154, v150, s[76:77]
    v_cndmask_b32 v211, v158, v154, s[76:77]
    v_mov_b32 v71, v158
    v_add_f32_dpp v145, v208, v145 wave_ror:1 row_mask:0xf bank_mask:0xf
    v_add_f32_dpp v149, v209, v149 wave_ror:1 row_mask:0xf bank_mask:0xf
    v_mfma_f32_32x32x16_bf16 v[160:175], v[212:215], v[128:131], v[160:175]
    ds_read_b128 v[244:247], v64 offset:864
    v_add_f32_dpp v153, v210, v153 wave_ror:1 row_mask:0xf bank_mask:0xf
    v_add_f32_dpp v157, v211, v157 wave_ror:1 row_mask:0xf bank_mask:0xf
    v_cndmask_b32 v208, v145, v70, s[76:77]
    v_cndmask_b32 v209, v149, v145, s[76:77]
    v_cndmask_b32 v210, v153, v149, s[76:77]
    v_mfma_f32_32x32x16_bf16 v[160:175], v[216:219], v[132:135], v[160:175]
    ds_read_b128 v[248:251], v64 offset:832
    v_cndmask_b32 v211, v157, v153, s[76:77]
    v_mov_b32_e64 v70, v157
    v_add_f32_dpp v144, v208, v144 wave_ror:1 row_mask:0xf bank_mask:0xf
    v_add_f32_dpp v148, v209, v148 wave_ror:1 row_mask:0xf bank_mask:0xf
    v_add_f32_dpp v152, v210, v152 wave_ror:1 row_mask:0xf bank_mask:0xf
    v_mfma_f32_32x32x16_bf16 v[160:175], v[220:223], v[136:139], v[160:175]
    ds_read_b128 v[252:255], v64 offset:800
    v_add_f32_dpp v156, v211, v156 wave_ror:1 row_mask:0xf bank_mask:0xf
    ds_write_b32 v66, v144 offset:0
    v_mfma_f32_32x32x16_bf16 v[160:175], v[224:227], v[140:143], v[160:175]
    ds_read_b128 v[224:227], v64 offset:768
    ds_write_b32 v66, v148 offset:64
    ds_write_b32 v66, v152 offset:128
    s_waitcnt lgkmcnt(6)
    v_mfma_f32_32x32x16_bf16 v[176:191], v[244:247], v[112:115], v[176:191]
    ds_write_b32 v66, v156 offset:192
    s_nop 2
    s_waitcnt lgkmcnt(6)
    v_mfma_f32_32x32x16_bf16 v[176:191], v[248:251], v[116:119], v[176:191]
    s_nop 2
    v_cndmask_b32 v208, v163, v72, s[76:77]
    v_cndmask_b32 v209, v167, v163, s[76:77]
    s_waitcnt lgkmcnt(5)
    v_mfma_f32_32x32x16_bf16 v[176:191], v[252:255], v[120:123], v[176:191]
    v_cndmask_b32 v210, v171, v167, s[76:77]
    v_cndmask_b32 v211, v175, v171, s[76:77]
    v_mov_b32 v72, v175
    v_add_f32_dpp v162, v208, v162 wave_ror:1 row_mask:0xf bank_mask:0xf
    v_add_f32_dpp v166, v209, v166 wave_ror:1 row_mask:0xf bank_mask:0xf
    s_waitcnt lgkmcnt(3)
    v_mfma_f32_32x32x16_bf16 v[176:191], v[224:227], v[124:127], v[176:191]
    v_add_f32_dpp v170, v210, v170 wave_ror:1 row_mask:0xf bank_mask:0xf
    v_add_f32_dpp v174, v211, v174 wave_ror:1 row_mask:0xf bank_mask:0xf
    v_cndmask_b32 v208, v162, v71, s[76:77]
    v_cndmask_b32 v209, v166, v162, s[76:77]
    v_cndmask_b32 v210, v170, v166, s[76:77]
    v_cndmask_b32 v211, v174, v170, s[76:77]
    v_mfma_f32_32x32x16_bf16 v[176:191], v[228:231], v[128:131], v[176:191]
    ds_read_b64_tr_b16 v[228:229], v65 offset:1056
    ds_read_b64_tr_b16 v[230:231], v65 offset:1024
    v_mov_b32 v71, v174
    v_add_f32_dpp v161, v208, v161 wave_ror:1 row_mask:0xf bank_mask:0xf
    v_add_f32_dpp v165, v209, v165 wave_ror:1 row_mask:0xf bank_mask:0xf
    v_add_f32_dpp v169, v210, v169 wave_ror:1 row_mask:0xf bank_mask:0xf
    v_mfma_f32_32x32x16_bf16 v[176:191], v[232:235], v[132:135], v[176:191]
    ds_read_b64_tr_b16 v[232:233], v65 offset:1184
    ds_read_b64_tr_b16 v[234:235], v65 offset:1152
    v_add_f32_dpp v173, v211, v173 wave_ror:1 row_mask:0xf bank_mask:0xf
    v_cndmask_b32 v208, v161, v70, s[76:77]
    v_cndmask_b32 v209, v165, v161, s[76:77]
    v_cndmask_b32 v210, v169, v165, s[76:77]
    v_mfma_f32_32x32x16_bf16 v[176:191], v[236:239], v[136:139], v[176:191]
    ds_read_b64_tr_b16 v[236:237], v65 offset:1312
    ds_read_b64_tr_b16 v[238:239], v65 offset:1280
    v_cndmask_b32 v211, v173, v169, s[76:77]
    v_mov_b32_e64 v70, v173
    v_add_f32_dpp v160, v208, v160 wave_ror:1 row_mask:0xf bank_mask:0xf
    v_add_f32_dpp v164, v209, v164 wave_ror:1 row_mask:0xf bank_mask:0xf
    v_mfma_f32_32x32x16_bf16 v[176:191], v[240:243], v[140:143], v[176:191]
    ds_read_b128 v[240:243], v64 offset:512
    ds_read_b64_tr_b16 v[224:225], v65 offset:1440
    ds_read_b64_tr_b16 v[226:227], v65 offset:1408
    v_add_f32_dpp v168, v210, v168 wave_ror:1 row_mask:0xf bank_mask:0xf
    v_add_f32_dpp v172, v211, v172 wave_ror:1 row_mask:0xf bank_mask:0xf
    s_waitcnt lgkmcnt(7)
    v_mfma_f32_32x32x16_bf16 v[176:191], v[212:215], v[228:231], v[176:191]
    ds_read_b128 v[212:215], v64 offset:992
    ds_write_b32 v66, v160 offset:256
    ds_write_b32 v66, v164 offset:320
    s_waitcnt lgkmcnt(8)
    v_mfma_f32_32x32x16_bf16 v[176:191], v[216:219], v[232:235], v[176:191]
    ds_read_b128 v[216:219], v64 offset:960
    ds_write_b32 v66, v168 offset:384
    ds_write_b32 v66, v172 offset:448
    s_waitcnt lgkmcnt(9)
    v_mfma_f32_32x32x16_bf16 v[176:191], v[220:223], v[236:239], v[176:191]
    ds_read_b128 v[220:223], v64 offset:928
    s_waitcnt lgkmcnt(7)
    v_mfma_f32_32x32x16_bf16 v[176:191], v[240:243], v[224:227], v[176:191]
    ds_read_b128 v[240:243], v64 offset:896
    s_waitcnt lgkmcnt(2)
    s_barrier
    v_mfma_f32_32x32x16_bf16 v[192:207], v[212:215], v[112:115], v[192:207]
    ds_read_b64 v[144:145], v67 offset:0
    ds_read_b64 v[146:147], v67 offset:4224
    ds_read_b64 v[148:149], v67 offset:8448
    ds_read_b64 v[150:151], v67 offset:12672
    s_lshl_b32 s25, s75, 14
    v_mfma_f32_32x32x16_bf16 v[192:207], v[216:219], v[116:119], v[192:207]
    buffer_load_dword v7, v4, s[16:19], s89 offen offset:0 sc1
    s_add_u32 s25, s25, 9437184
    s_nop 0
    v_cndmask_b32 v208, v179, v72, s[76:77]
    v_cndmask_b32 v209, v183, v179, s[76:77]
    s_waitcnt lgkmcnt(5)
    v_mfma_f32_32x32x16_bf16 v[192:207], v[220:223], v[120:123], v[192:207]
    v_cndmask_b32 v210, v187, v183, s[76:77]
    v_cndmask_b32 v211, v191, v187, s[76:77]
    v_mov_b32 v72, v191
    v_add_f32_dpp v178, v208, v178 wave_ror:1 row_mask:0xf bank_mask:0xf
    v_add_f32_dpp v182, v209, v182 wave_ror:1 row_mask:0xf bank_mask:0xf
    s_waitcnt lgkmcnt(4)
    v_mfma_f32_32x32x16_bf16 v[192:207], v[240:243], v[124:127], v[192:207]
    ds_read_b128 v[212:215], v64 offset:768
    v_add_f32_dpp v186, v210, v186 wave_ror:1 row_mask:0xf bank_mask:0xf
    v_add_f32_dpp v190, v211, v190 wave_ror:1 row_mask:0xf bank_mask:0xf
    v_cndmask_b32 v208, v178, v71, s[76:77]
    v_cndmask_b32 v209, v182, v178, s[76:77]
    v_cndmask_b32 v210, v186, v182, s[76:77]
    v_mfma_f32_32x32x16_bf16 v[192:207], v[244:247], v[128:131], v[192:207]
    ds_read_b128 v[244:247], v64 offset:736
    v_cndmask_b32 v211, v190, v186, s[76:77]
    v_mov_b32 v71, v190
    v_add_f32_dpp v177, v208, v177 wave_ror:1 row_mask:0xf bank_mask:0xf
    v_add_f32_dpp v181, v209, v181 wave_ror:1 row_mask:0xf bank_mask:0xf
    v_add_f32_dpp v185, v210, v185 wave_ror:1 row_mask:0xf bank_mask:0xf
    v_mfma_f32_32x32x16_bf16 v[192:207], v[248:251], v[132:135], v[192:207]
    ds_read_b128 v[248:251], v64 offset:704
    v_add_f32_dpp v189, v211, v189 wave_ror:1 row_mask:0xf bank_mask:0xf
    v_cndmask_b32 v208, v177, v70, s[76:77]
    v_cndmask_b32 v209, v181, v177, s[76:77]
    v_cndmask_b32 v210, v185, v181, s[76:77]
    v_cndmask_b32 v211, v189, v185, s[76:77]
    v_mfma_f32_32x32x16_bf16 v[192:207], v[252:255], v[136:139], v[192:207]
    ds_read_b128 v[252:255], v64 offset:672
    v_mov_b32_e64 v70, v189
    v_add_f32_dpp v176, v208, v176 wave_ror:1 row_mask:0xf bank_mask:0xf
    v_add_f32_dpp v180, v209, v180 wave_ror:1 row_mask:0xf bank_mask:0xf
    v_add_f32_dpp v184, v210, v184 wave_ror:1 row_mask:0xf bank_mask:0xf
    s_waitcnt lgkmcnt(3)
    v_mfma_f32_32x32x16_bf16 v[192:207], v[212:215], v[140:143], v[192:207]
    ds_read_b128 v[216:219], v64 offset:640
    v_add_f32_dpp v188, v211, v188 wave_ror:1 row_mask:0xf bank_mask:0xf
    s_waitcnt lgkmcnt(3)
    v_mfma_f32_32x32x16_bf16 v[192:207], v[244:247], v[228:231], v[192:207]
    ds_read_b128 v[228:231], v64 offset:608
    ds_read_b64_tr_b16 v[220:221], v65 offset:1568
    ds_read_b64_tr_b16 v[222:223], v65 offset:1536
    ds_write_b32 v66, v176 offset:512
    s_waitcnt lgkmcnt(6)
    v_mfma_f32_32x32x16_bf16 v[192:207], v[248:251], v[232:235], v[192:207]
    ds_read_b128 v[232:235], v64 offset:576
    ds_read_b64_tr_b16 v[240:241], v65 offset:1696
    ds_read_b64_tr_b16 v[242:243], v65 offset:1664
    ds_write_b32 v66, v180 offset:576
    s_waitcnt lgkmcnt(9)
    v_mfma_f32_32x32x16_bf16 v[192:207], v[252:255], v[236:239], v[192:207]
    ds_read_b128 v[236:239], v64 offset:544
    ds_read_b64_tr_b16 v[212:213], v65 offset:1824
    ds_read_b64_tr_b16 v[214:215], v65 offset:1792
    ds_write_b32 v66, v184 offset:640
    s_waitcnt lgkmcnt(12)
    v_mfma_f32_32x32x16_bf16 v[192:207], v[216:219], v[224:227], v[192:207]
    ds_read_b128 v[224:227], v64 offset:512
    ds_read_b64_tr_b16 v[244:245], v65 offset:1952
    ds_read_b64_tr_b16 v[246:247], v65 offset:1920
    ds_write_b32 v66, v188 offset:704
    s_waitcnt lgkmcnt(13)
    v_mfma_f32_32x32x16_bf16 v[192:207], v[228:231], v[220:223], v[192:207]
    v_add_f32 v144, v144, v80
    v_add_f32 v145, v145, v81
    v_add_f32 v146, v146, v82
    v_add_f32 v147, v147, v83
    s_waitcnt lgkmcnt(9)
    v_mfma_f32_32x32x16_bf16 v[192:207], v[232:235], v[240:243], v[192:207]
    v_add_f32 v148, v148, v84
    v_add_f32 v149, v149, v85
    v_add_f32 v150, v150, v86
    v_add_f32 v151, v151, v87
    v_cvt_pk_bf16_f32 v160, v144, v146
    s_waitcnt lgkmcnt(5)
    v_mfma_f32_32x32x16_bf16 v[192:207], v[236:239], v[212:215], v[192:207]
    v_cvt_pk_bf16_f32 v161, v148, v150
    v_cvt_pk_bf16_f32 v162, v145, v147
    v_cvt_pk_bf16_f32 v163, v149, v151
    s_waitcnt lgkmcnt(1)
    v_mfma_f32_32x32x16_bf16 v[192:207], v[224:227], v[244:247], v[192:207]
    buffer_store_dwordx4 v[160:163], v62, s[16:19], s25 offen offset:2048 sc1
    s_nop 10
    v_cndmask_b32 v208, v195, v72, s[76:77]
    v_cndmask_b32 v209, v199, v195, s[76:77]
    v_cndmask_b32 v210, v203, v199, s[76:77]
    v_cndmask_b32 v211, v207, v203, s[76:77]
    v_mov_b32_e64 v72, v207
    v_add_f32_dpp v194, v208, v194 wave_ror:1 row_mask:0xf bank_mask:0xf
    v_add_f32_dpp v198, v209, v198 wave_ror:1 row_mask:0xf bank_mask:0xf
    v_add_f32_dpp v202, v210, v202 wave_ror:1 row_mask:0xf bank_mask:0xf
    v_add_f32_dpp v206, v211, v206 wave_ror:1 row_mask:0xf bank_mask:0xf
    v_cndmask_b32 v208, v194, v71, s[76:77]
    v_cndmask_b32 v209, v198, v194, s[76:77]
    v_cndmask_b32 v210, v202, v198, s[76:77]
    v_cndmask_b32 v211, v206, v202, s[76:77]
    v_mov_b32_e64 v71, v206
    v_add_f32_dpp v193, v208, v193 wave_ror:1 row_mask:0xf bank_mask:0xf
    v_add_f32_dpp v197, v209, v197 wave_ror:1 row_mask:0xf bank_mask:0xf
    v_add_f32_dpp v201, v210, v201 wave_ror:1 row_mask:0xf bank_mask:0xf
    v_add_f32_dpp v205, v211, v205 wave_ror:1 row_mask:0xf bank_mask:0xf
    v_cndmask_b32 v208, v193, v70, s[76:77]
    v_cndmask_b32 v209, v197, v193, s[76:77]
    v_cndmask_b32 v210, v201, v197, s[76:77]
    v_cndmask_b32 v211, v205, v201, s[76:77]
    v_mov_b32_e64 v70, v205
    v_add_f32_dpp v192, v208, v192 wave_ror:1 row_mask:0xf bank_mask:0xf
    v_add_f32_dpp v196, v209, v196 wave_ror:1 row_mask:0xf bank_mask:0xf
    v_add_f32_dpp v200, v210, v200 wave_ror:1 row_mask:0xf bank_mask:0xf
    v_add_f32_dpp v204, v211, v204 wave_ror:1 row_mask:0xf bank_mask:0xf
    ds_write_b32 v66, v192 offset:768
    ds_write_b32 v66, v196 offset:832
    ds_write_b32 v66, v200 offset:896
    ds_write_b32 v66, v204 offset:960
    s_waitcnt lgkmcnt(0)
    s_waitcnt vmcnt(1)
    v_cmp_gt_u32_e64 vcc, 1, v7
    s_nop 0
    s_and_b64 vcc, vcc, s[50:51]
    s_cbranch_scc1 ps_36
pc_38:
    s_barrier
    ds_read_b64 v[152:153], v67 offset:512
    ds_read_b64 v[154:155], v67 offset:4736
    ds_read_b64 v[156:157], v67 offset:8960
    ds_read_b64 v[158:159], v67 offset:13184
    s_add_u32 m0, s92, 36352
    s_nop 0
    s_nop 0
    buffer_load_dwordx4 v73, s[16:19], s99 offen offset:0 sc1 lds
    buffer_load_dwordx4 v74, s[16:19], s99 offen offset:1024 sc1 lds
    buffer_load_dwordx4 v75, s[16:19], s99 offen offset:2048 sc1 lds
    buffer_load_dwordx4 v76, s[16:19], s99 offen offset:3072 sc1 lds
    s_add_u32 m0, s93, 53760
    s_add_u32 s99, s99, 524288
    s_mov_b64 exec, s[80:81]
    buffer_load_dwordx4 v77, s[16:19], s100 offen sc1 lds
    s_mov_b64 exec, -1
    s_add_u32 s100, s100, 524288
    s_lshl_b32 s25, s75, 14
    s_add_u32 s25, s25, 9437184
    s_waitcnt lgkmcnt(0)
    v_add_f32 v152, v152, v88
    v_add_f32 v153, v153, v89
    v_add_f32 v154, v154, v90
    v_add_f32 v155, v155, v91
    v_add_f32 v156, v156, v92
    v_add_f32 v157, v157, v93
    v_add_f32 v158, v158, v94
    v_add_f32 v159, v159, v95
    v_cvt_pk_bf16_f32 v164, v152, v154
    v_cvt_pk_bf16_f32 v165, v156, v158
    v_cvt_pk_bf16_f32 v166, v153, v155
    v_cvt_pk_bf16_f32 v167, v157, v159
    buffer_store_dwordx4 v[164:167], v62, s[16:19], s25 offen offset:3072 sc1
    v_mov_b32_e64 v5, 1
    s_add_u32 s82, s86, 24576
    buffer_atomic_add v5, v6, s[16:19], s82 offen offset:4 sc0 sc1
    s_add_u32 m0, s92, 55936
    s_nop 0
    s_nop 0
    buffer_load_dwordx4 v73, s[16:19], s99 offen offset:0 sc1 lds
    buffer_load_dwordx4 v74, s[16:19], s99 offen offset:1024 sc1 lds
    buffer_load_dwordx4 v75, s[16:19], s99 offen offset:2048 sc1 lds
    buffer_load_dwordx4 v76, s[16:19], s99 offen offset:3072 sc1 lds
    s_add_u32 m0, s93, 73344
    s_add_u32 s99, s99, 524288
    s_mov_b64 exec, s[80:81]
    buffer_load_dwordx4 v77, s[16:19], s100 offen sc1 lds
    s_mov_b64 exec, -1
    s_add_u32 s100, s100, 524288
    s_branch ec_27
nc_26:
    v_lshlrev_b32 v2, 3, v4
    v_mov_b32_e64 v5, 1
    v_cndmask_b32 v2, v4, v2, s[50:51]
    buffer_atomic_add v5, v2, s[16:19], s86 offen offset:8 sc1
    buffer_load_dword v7, v4, s[16:19], s87 offen offset:8 sc1
    s_waitcnt vmcnt(0)
    v_cmp_gt_u32 vcc, 12, v7
    s_nop 0
    s_and_b64 vcc, vcc, s[50:51]
    s_cbranch_scc1 ps_39
pc_41:
    v_mov_b32 v100, -1
    v_mov_b32 v101, -1
    v_mov_b32 v102, -1
    v_mov_b32 v103, -1
    v_lshlrev_b32 v104, 4, v0
    s_sub_u32 s88, s2, 160
    s_mul_i32 s88, s88, 57344
    s_min_u32 s88, s88, 5185536
    s_add_u32 s88, s88, 12058624
    buffer_store_dwordx4 v[100:103], v104, s[16:19], s88 offen sc1
    s_add_u32 s88, s88, 4096
    buffer_store_dwordx4 v[100:103], v104, s[16:19], s88 offen sc1
    s_add_u32 s88, s88, 4096
    buffer_store_dwordx4 v[100:103], v104, s[16:19], s88 offen sc1
    s_add_u32 s88, s88, 4096
    buffer_store_dwordx4 v[100:103], v104, s[16:19], s88 offen sc1
    s_add_u32 s88, s88, 4096
    buffer_store_dwordx4 v[100:103], v104, s[16:19], s88 offen sc1
    s_add_u32 s88, s88, 4096
    buffer_store_dwordx4 v[100:103], v104, s[16:19], s88 offen sc1
    s_add_u32 s88, s88, 4096
    buffer_store_dwordx4 v[100:103], v104, s[16:19], s88 offen sc1
    s_add_u32 s88, s88, 4096
    buffer_store_dwordx4 v[100:103], v104, s[16:19], s88 offen sc1
    s_add_u32 s88, s88, 4096
    buffer_store_dwordx4 v[100:103], v104, s[16:19], s88 offen sc1
    s_add_u32 s88, s88, 4096
    buffer_store_dwordx4 v[100:103], v104, s[16:19], s88 offen sc1
    s_add_u32 s88, s88, 4096
    buffer_store_dwordx4 v[100:103], v104, s[16:19], s88 offen sc1
    s_add_u32 s88, s88, 4096
    buffer_store_dwordx4 v[100:103], v104, s[16:19], s88 offen sc1
    s_add_u32 s88, s88, 4096
    buffer_store_dwordx4 v[100:103], v104, s[16:19], s88 offen sc1
    s_add_u32 s88, s88, 4096
    buffer_store_dwordx4 v[100:103], v104, s[16:19], s88 offen sc1
    s_waitcnt vmcnt(0)
    s_barrier
    v_mov_b32_e64 v5, 1
    s_add_u32 s82, s86, 8192
    buffer_atomic_add v5, v6, s[16:19], s82 offen offset:12 sc0 sc1
    s_waitcnt vmcnt(0)
    v_cmp_eq_u32 vcc, 11, v5
    s_nop 0
    s_cbranch_vccnz gl_42
gc_43:
    buffer_load_dword v7, v4, s[16:19], s89 offen offset:0 sc1
    s_waitcnt vmcnt(0)
    v_cmp_gt_u32 vcc, 1, v7
    s_nop 0
    s_and_b64 vcc, vcc, s[50:51]
    s_cbranch_scc1 ps_44
pc_46:
    s_barrier
    s_sub_u32 s3, s2, 160
    s_and_b32 s3, s3, 63
    s_add_u32 s3, s3, 0
    s_and_b32 s25, s3, 3
    s_lshl_b32 s25, s25, 12
    s_lshr_b32 s26, s3, 2
    s_lshl_b32 s26, s26, 7
    s_add_u32 s3, s25, s26
    v_lshrrev_b32 v236, 3, v0
    v_and_b32 v237, 7, v0
    v_lshlrev_b32 v237, 4, v237
    v_lshl_add_u32 v236, v236, 14, v237
    s_sub_u32 s25, s2, 160
    s_cmp_lt_u32 s25, 64
    s_cselect_b32 s25, 0, 1073741824
    v_add_u32_e64 v236, s25, v236
    s_add_u32 s26, s3, 9437184
    buffer_load_dwordx4 v[216:219], v236, s[16:19], s26 offen sc1
    s_add_u32 s26, s26, 524288
    buffer_load_dwordx4 v[220:223], v236, s[16:19], s26 offen sc1
    s_add_u32 s26, s26, 524288
    buffer_load_dwordx4 v[224:227], v236, s[16:19], s26 offen sc1
    s_add_u32 s26, s26, 524288
    buffer_load_dwordx4 v[228:231], v236, s[16:19], s26 offen sc1
    s_add_u32 s26, s26, 524288
    buffer_load_dwordx4 v[232:235], v236, s[16:19], s26 offen sc1
    s_lshl_b32 s25, s72, 5
    s_add_u32 s25, s25, 0
    s_sub_u32 s26, s25, 4
    s_max_i32 s26, s26, 0
    s_lshl_b32 s27, s71, 12
    s_add_u32 s27, s27, 9437184
    s_lshl_b32 s99, s25, 3
    s_lshl_b32 s100, s26, 3
    s_lshl_b32 s92, s24, 12
    s_lshl_b32 s93, s24, 9
    s_add_u32 s99, s99, s27
    s_add_u32 s100, s100, s27
    s_add_u32 m0, s92, 36352
    s_nop 0
    buffer_load_dwordx4 v73, s[16:19], s99 offen offset:0 sc1 lds
    buffer_load_dwordx4 v74, s[16:19], s99 offen offset:1024 sc1 lds
    buffer_load_dwordx4 v75, s[16:19], s99 offen offset:2048 sc1 lds
    buffer_load_dwordx4 v76, s[16:19], s99 offen offset:3072 sc1 lds
    s_add_u32 m0, s93, 53760
    s_add_u32 s99, s99, 524288
    s_mov_b64 exec, s[80:81]
    buffer_load_dwordx4 v77, s[16:19], s100 offen sc1 lds
    s_mov_b64 exec, -1
    s_add_u32 s100, s100, 524288
    s_add_u32 m0, s92, 55936
    s_nop 0
    s_nop 0
    buffer_load_dwordx4 v73, s[16:19], s99 offen offset:0 sc1 lds
    buffer_load_dwordx4 v74, s[16:19], s99 offen offset:1024 sc1 lds
    buffer_load_dwordx4 v75, s[16:19], s99 offen offset:2048 sc1 lds
    buffer_load_dwordx4 v76, s[16:19], s99 offen offset:3072 sc1 lds
    s_add_u32 m0, s93, 73344
    s_add_u32 s99, s99, 524288
    s_mov_b64 exec, s[80:81]
    buffer_load_dwordx4 v77, s[16:19], s100 offen sc1 lds
    s_mov_b64 exec, -1
    s_add_u32 s100, s100, 524288
    s_sub_u32 s85, s2, 160
    s_cmp_ge_u32 s85, 64
    s_cbranch_scc1 s2_47
    v_mov_b32 v238, 0x3f803f80
    s_lshl_b32 s25, s24, 7
    s_add_u32 s25, s25, 134272
    v_lshrrev_b32 v239, 4, v1
    v_lshl_add_u32 v237, v239, 2, v237
    v_add_u32 v237, s25, v237
se_48:
    v_mov_b32 v240, 0
    v_mov_b32 v241, 0
    v_mov_b32 v242, 0
    v_mov_b32 v243, 0
    s_waitcnt vmcnt(14)
    v_dot2c_f32_bf16 v240, v216, v238
    v_dot2c_f32_bf16 v241, v216, v216
    v_dot2c_f32_bf16 v240, v217, v238
    v_dot2c_f32_bf16 v241, v217, v217
    v_dot2c_f32_bf16 v242, v218, v238
    v_dot2c_f32_bf16 v243, v218, v218
    v_dot2c_f32_bf16 v242, v219, v238
    v_dot2c_f32_bf16 v243, v219, v219
    s_waitcnt vmcnt(13)
    v_dot2c_f32_bf16 v240, v220, v238
    v_dot2c_f32_bf16 v241, v220, v220
    v_dot2c_f32_bf16 v240, v221, v238
    v_dot2c_f32_bf16 v241, v221, v221
    v_dot2c_f32_bf16 v242, v222, v238
    v_dot2c_f32_bf16 v243, v222, v222
    v_dot2c_f32_bf16 v242, v223, v238
    v_dot2c_f32_bf16 v243, v223, v223
    s_waitcnt vmcnt(12)
    v_dot2c_f32_bf16 v240, v224, v238
    v_dot2c_f32_bf16 v241, v224, v224
    v_dot2c_f32_bf16 v240, v225, v238
    v_dot2c_f32_bf16 v241, v225, v225
    v_dot2c_f32_bf16 v242, v226, v238
    v_dot2c_f32_bf16 v243, v226, v226
    v_dot2c_f32_bf16 v242, v227, v238
    v_dot2c_f32_bf16 v243, v227, v227
    s_waitcnt vmcnt(11)
    v_dot2c_f32_bf16 v240, v228, v238
    v_dot2c_f32_bf16 v241, v228, v228
    v_dot2c_f32_bf16 v240, v229, v238
    v_dot2c_f32_bf16 v241, v229, v229
    v_dot2c_f32_bf16 v242, v230, v238
    v_dot2c_f32_bf16 v243, v230, v230
    v_dot2c_f32_bf16 v242, v231, v238
    v_dot2c_f32_bf16 v243, v231, v231
    s_waitcnt vmcnt(10)
    v_dot2c_f32_bf16 v240, v232, v238
    v_dot2c_f32_bf16 v241, v232, v232
    v_dot2c_f32_bf16 v240, v233, v238
    v_dot2c_f32_bf16 v241, v233, v233
    v_dot2c_f32_bf16 v242, v234, v238
    v_dot2c_f32_bf16 v243, v234, v234
    v_dot2c_f32_bf16 v242, v235, v238
    v_dot2c_f32_bf16 v243, v235, v235
    s_nop 2
    v_cmp_u_f32 vcc, v241, v243
    s_nop 0
    s_cbranch_vccnz rd_49
rc_50:
    v_permlane32_swap_b32 v240, v242
    v_permlane32_swap_b32 v241, v243
    v_pk_add_f32 v[240:241], v[240:241], v[242:243]
    s_nop 1
    v_permlane16_swap_b32 v240, v241
    v_add_f32 v240, v240, v241
    s_nop 1
    v_add_f32_dpp v240, v240, v240 row_ror:8 row_mask:0xf bank_mask:0xf
    ds_write_b32 v237, v240
    v_and_b32 v236, 15, v0
    v_lshlrev_b32 v236, 3, v236
    v_add_u32 v237, 134272, v236
    v_mov_b32 v239, 1073741824
    v_cmp_gt_u32 vcc, 16, v0
    s_nop 1
    v_cndmask_b32 v236, v239, v236, vcc
    s_add_u32 s25, s3, 3457024
    s_waitcnt lgkmcnt(0)
    s_barrier
    ds_read_b64 v[216:217], v237 offset:0
    ds_read_b64 v[218:219], v237 offset:128
    ds_read_b64 v[220:221], v237 offset:256
    ds_read_b64 v[222:223], v237 offset:384
    s_waitcnt lgkmcnt(2)
    v_pk_add_f32 v[216:217], v[216:217], v[218:219]
    s_waitcnt lgkmcnt(0)
    v_pk_add_f32 v[220:221], v[220:221], v[222:223]
    v_pk_add_f32 v[216:217], v[216:217], v[220:221]
    v_mul_f32 v239, 0x3acccccd, v216
    v_mul_f32 v217, 0x3acccccd, v217
    v_fma_f32 v217, -v239, v239, v217
    v_max_f32 v217, 0, v217
    v_add_f32 v217, 0x3727c5ac, v217
    v_rsq_f32_e64 v216, v217
    s_nop 0
    v_mul_f32 v217, -v239, v216
    buffer_store_dwordx2 v[216:217], v236, s[16:19], s25 offen sc1
s2_47:
ec_27:
ge_51:
    v_add_u32 v196, 36352, v78
    v_mov_b32_e64 v198, v79
    s_waitcnt vmcnt(5)
    s_barrier
    ds_read_b64 v[160:161], v198 offset:0
    ds_read_b64 v[162:163], v198 offset:64
    ds_read_b64 v[164:165], v196 offset:0
    ds_read_b64 v[166:167], v196 offset:512
    ds_read_b64 v[168:169], v196 offset:256
    ds_read_b64 v[170:171], v196 offset:768
    ds_read_b64 v[172:173], v198 offset:256
    ds_read_b64 v[174:175], v198 offset:320
    ds_read_b64 v[176:177], v196 offset:2048
    ds_read_b64 v[178:179], v196 offset:2560
    ds_read_b64 v[180:181], v196 offset:2304
    ds_read_b64 v[182:183], v196 offset:2816
    s_waitcnt lgkmcnt(6)
    v_mfma_f32_16x16x32_bf16 v[112:115], a[0:3], v[160:163], 0
    ds_read_b64 v[184:185], v198 offset:512
    v_mfma_f32_32x32x16_bf16 v[80:95], a[0:3], v[164:167], 0
    ds_read_b64 v[186:187], v198 offset:576
    ds_read_b64 v[188:189], v196 offset:4096
    ds_read_b64 v[190:191], v196 offset:4608
    v_mov_b32 v208, 0
    v_mov_b32_e64 v209, 0
    v_mfma_f32_32x32x16_bf16 v[96:111], a[0:3], v[168:171], 0
    ds_read_b64 v[192:193], v196 offset:4352
    ds_read_b64 v[194:195], v196 offset:4864
    s_add_u32 m0, s92, 75520
    s_nop 0
    buffer_load_dwordx4 v73, s[16:19], s99 offen offset:0 sc1 lds
    s_waitcnt lgkmcnt(6)
    v_mfma_f32_16x16x32_bf16 v[112:115], a[4:7], v[172:175], v[112:115]
    ds_read_b64 v[160:161], v198 offset:768
    v_mfma_f32_32x32x16_bf16 v[80:95], a[4:7], v[176:179], v[80:95]
    ds_read_b64 v[162:163], v198 offset:832
    ds_read_b64 v[164:165], v196 offset:6144
    ds_read_b64 v[166:167], v196 offset:6656
    v_lshrrev_b32_e64 v210, 5, v0
    v_mul_u32_u24 v210, 1600, v210
    v_mfma_f32_32x32x16_bf16 v[96:111], a[4:7], v[180:183], v[96:111]
    ds_read_b64 v[168:169], v196 offset:6400
    ds_read_b64 v[170:171], v196 offset:6912
    buffer_load_dwordx4 v74, s[16:19], s99 offen offset:1024 sc1 lds
    v_and_b32 v211, 31, v0
    s_waitcnt lgkmcnt(6)
    v_mfma_f32_16x16x32_bf16 v[112:115], a[8:11], v[184:187], v[112:115]
    ds_read_b64 v[172:173], v198 offset:1024
    v_mfma_f32_32x32x16_bf16 v[80:95], a[8:11], v[188:191], v[80:95]
    ds_read_b64 v[174:175], v198 offset:1088
    ds_read_b64 v[176:177], v196 offset:8192
    ds_read_b64 v[178:179], v196 offset:8704
    v_min_u32_e64 v211, 19, v211
    v_lshl_add_u32 v210, v211, 3, v210
    v_mfma_f32_32x32x16_bf16 v[96:111], a[8:11], v[192:195], v[96:111]
    ds_read_b64 v[180:181], v196 offset:8448
    ds_read_b64 v[182:183], v196 offset:8960
    buffer_load_dwordx4 v75, s[16:19], s99 offen offset:2048 sc1 lds
    v_add_u32 v210, 6400, v210
    s_waitcnt lgkmcnt(6)
    v_mfma_f32_16x16x32_bf16 v[112:115], a[12:15], v[160:163], v[112:115]
    ds_read_b64 v[184:185], v198 offset:1280
    v_mfma_f32_32x32x16_bf16 v[80:95], a[12:15], v[164:167], v[80:95]
    ds_read_b64 v[186:187], v198 offset:1344
    ds_read_b64 v[188:189], v196 offset:10240
    ds_read_b64 v[190:191], v196 offset:10752
    ds_write_b64 v210, v[208:209]
    v_mfma_f32_32x32x16_bf16 v[96:111], a[12:15], v[168:171], v[96:111]
    ds_read_b64 v[192:193], v196 offset:10496
    ds_read_b64 v[194:195], v196 offset:11008
    buffer_load_dwordx4 v76, s[16:19], s99 offen offset:3072 sc1 lds
    s_waitcnt lgkmcnt(7)
    v_mfma_f32_16x16x32_bf16 v[112:115], a[16:19], v[172:175], v[112:115]
    ds_read_b64 v[160:161], v198 offset:1536
    v_mfma_f32_32x32x16_bf16 v[80:95], a[16:19], v[176:179], v[80:95]
    ds_read_b64 v[162:163], v198 offset:1600
    ds_read_b64 v[164:165], v196 offset:12288
    ds_read_b64 v[166:167], v196 offset:12800
    v_mfma_f32_32x32x16_bf16 v[96:111], a[16:19], v[180:183], v[96:111]
    ds_read_b64 v[168:169], v196 offset:12544
    ds_read_b64 v[170:171], v196 offset:13056
    s_add_u32 m0, s93, 92928
    s_add_u32 s99, s99, 524288
    s_mov_b64 exec, s[80:81]
    buffer_load_dwordx4 v77, s[16:19], s100 offen sc1 lds
    s_mov_b64 exec, -1
    s_add_u32 s100, s100, 524288
    s_waitcnt lgkmcnt(6)
    v_mfma_f32_16x16x32_bf16 v[112:115], a[20:23], v[184:187], v[112:115]
    ds_read_b64 v[172:173], v198 offset:1792
    v_mfma_f32_32x32x16_bf16 v[80:95], a[20:23], v[188:191], v[80:95]
    ds_read_b64 v[174:175], v198 offset:1856
    ds_read_b64 v[176:177], v196 offset:14336
    ds_read_b64 v[178:179], v196 offset:14848
    v_mfma_f32_32x32x16_bf16 v[96:111], a[20:23], v[192:195], v[96:111]
    ds_read_b64 v[180:181], v196 offset:14592
    ds_read_b64 v[182:183], v196 offset:15104
    buffer_load_dword v7, v4, s[16:19], s87 offen offset:12 sc1
    v_cmp_eq_u32 vcc, 19, v5
    s_nop 0
    s_cbranch_vccnz gl_52
gc_53:
    s_waitcnt vmcnt(6)
    s_barrier
    s_waitcnt lgkmcnt(6)
    v_mfma_f32_16x16x32_bf16 v[112:115], a[24:27], v[160:163], v[112:115]
    v_add_u32 v198, v49, v198
    v_mfma_f32_32x32x16_bf16 v[80:95], a[24:27], v[164:167], v[80:95]
    v_add_u32 v196, 19584, v196
    ds_read_b64 v[184:185], v198 offset:0
    ds_read_b64 v[186:187], v198 offset:64
    ds_read_b64 v[188:189], v196 offset:0
    v_mfma_f32_32x32x16_bf16 v[96:111], a[24:27], v[168:171], v[96:111]
    ds_read_b64 v[190:191], v196 offset:512
    ds_read_b64 v[192:193], v196 offset:256
    ds_read_b64 v[194:195], v196 offset:768
    s_add_u32 m0, s92, 95104
    s_nop 0
    buffer_load_dwordx4 v73, s[16:19], s99 offen offset:0 sc1 lds
    s_waitcnt lgkmcnt(6)
    v_mfma_f32_16x16x32_bf16 v[112:115], a[28:31], v[172:175], v[112:115]
    ds_read_b64 v[160:161], v198 offset:256
    v_mfma_f32_32x32x16_bf16 v[80:95], a[28:31], v[176:179], v[80:95]
    ds_read_b64 v[162:163], v198 offset:320
    ds_read_b64 v[164:165], v196 offset:2048
    ds_read_b64 v[166:167], v196 offset:2560
    v_mfma_f32_32x32x16_bf16 v[96:111], a[28:31], v[180:183], v[96:111]
    ds_read_b64 v[168:169], v196 offset:2304
    ds_read_b64 v[170:171], v196 offset:2816
    buffer_load_dwordx4 v74, s[16:19], s99 offen offset:1024 sc1 lds
    s_waitcnt lgkmcnt(6)
    v_mfma_f32_16x16x32_bf16 v[112:115], a[32:35], v[184:187], v[112:115]
    ds_read_b64 v[172:173], v198 offset:512
    v_mfma_f32_32x32x16_bf16 v[80:95], a[32:35], v[188:191], v[80:95]
    ds_read_b64 v[174:175], v198 offset:576
    ds_read_b64 v[176:177], v196 offset:4096
    ds_read_b64 v[178:179], v196 offset:4608
    v_mfma_f32_32x32x16_bf16 v[96:111], a[32:35], v[192:195], v[96:111]
    ds_read_b64 v[180:181], v196 offset:4352
    ds_read_b64 v[182:183], v196 offset:4864
    buffer_load_dwordx4 v75, s[16:19], s99 offen offset:2048 sc1 lds
    s_waitcnt lgkmcnt(6)
    v_mfma_f32_16x16x32_bf16 v[112:115], a[36:39], v[160:163], v[112:115]
    ds_read_b64 v[184:185], v198 offset:768
    v_mfma_f32_32x32x16_bf16 v[80:95], a[36:39], v[164:167], v[80:95]
    ds_read_b64 v[186:187], v198 offset:832
    ds_read_b64 v[188:189], v196 offset:6144
    ds_read_b64 v[190:191], v196 offset:6656
    v_mfma_f32_32x32x16_bf16 v[96:111], a[36:39], v[168:171], v[96:111]
    ds_read_b64 v[192:193], v196 offset:6400
    ds_read_b64 v[194:195], v196 offset:6912
    buffer_load_dwordx4 v76, s[16:19], s99 offen offset:3072 sc1 lds
    s_waitcnt lgkmcnt(6)
    v_mfma_f32_16x16x32_bf16 v[112:115], a[40:43], v[172:175], v[112:115]
    ds_read_b64 v[160:161], v198 offset:1024
    v_mfma_f32_32x32x16_bf16 v[80:95], a[40:43], v[176:179], v[80:95]
    ds_read_b64 v[162:163], v198 offset:1088
    ds_read_b64 v[164:165], v196 offset:8192
    ds_read_b64 v[166:167], v196 offset:8704
    v_mfma_f32_32x32x16_bf16 v[96:111], a[40:43], v[180:183], v[96:111]
    ds_read_b64 v[168:169], v196 offset:8448
    ds_read_b64 v[170:171], v196 offset:8960
    s_add_u32 m0, s93, 112512
    s_add_u32 s99, s99, 524288
    s_mov_b64 exec, s[80:81]
    buffer_load_dwordx4 v77, s[16:19], s100 offen sc1 lds
    s_mov_b64 exec, -1
    s_add_u32 s100, s100, 524288
    s_waitcnt lgkmcnt(6)
    v_mfma_f32_16x16x32_bf16 v[112:115], a[44:47], v[184:187], v[112:115]
    ds_read_b64 v[172:173], v198 offset:1280
    v_mfma_f32_32x32x16_bf16 v[80:95], a[44:47], v[188:191], v[80:95]
    ds_read_b64 v[174:175], v198 offset:1344
    ds_read_b64 v[176:177], v196 offset:10240
    ds_read_b64 v[178:179], v196 offset:10752
    v_mfma_f32_32x32x16_bf16 v[96:111], a[44:47], v[192:195], v[96:111]
    ds_read_b64 v[180:181], v196 offset:10496
    ds_read_b64 v[182:183], v196 offset:11008
    s_add_u32 m0, s92, 114688
    s_nop 0
    buffer_load_dwordx4 v73, s[16:19], s99 offen offset:0 sc1 lds
    s_waitcnt lgkmcnt(6)
    v_mfma_f32_16x16x32_bf16 v[112:115], a[48:51], v[160:163], v[112:115]
    ds_read_b64 v[184:185], v198 offset:1536
    v_mfma_f32_32x32x16_bf16 v[80:95], a[48:51], v[164:167], v[80:95]
    ds_read_b64 v[186:187], v198 offset:1600
    ds_read_b64 v[188:189], v196 offset:12288
    ds_read_b64 v[190:191], v196 offset:12800
    v_mfma_f32_32x32x16_bf16 v[96:111], a[48:51], v[168:171], v[96:111]
    ds_read_b64 v[192:193], v196 offset:12544
    ds_read_b64 v[194:195], v196 offset:13056
    buffer_load_dwordx4 v74, s[16:19], s99 offen offset:1024 sc1 lds
    s_waitcnt lgkmcnt(6)
    v_mfma_f32_16x16x32_bf16 v[112:115], a[52:55], v[172:175], v[112:115]
    ds_read_b64 v[160:161], v198 offset:1792
    v_mfma_f32_32x32x16_bf16 v[80:95], a[52:55], v[176:179], v[80:95]
    ds_read_b64 v[162:163], v198 offset:1856
    ds_read_b64 v[164:165], v196 offset:14336
    ds_read_b64 v[166:167], v196 offset:14848
    v_mfma_f32_32x32x16_bf16 v[96:111], a[52:55], v[180:183], v[96:111]
    ds_read_b64 v[168:169], v196 offset:14592
    ds_read_b64 v[170:171], v196 offset:15104
    buffer_load_dwordx4 v75, s[16:19], s99 offen offset:2048 sc1 lds
    s_waitcnt vmcnt(8)
    v_cmp_gt_u32 vcc, 1, v7
    s_nop 0
    s_and_b64 vcc, vcc, s[50:51]
    s_cbranch_scc1 ps_54
pc_56:
    s_barrier
    s_waitcnt lgkmcnt(6)
    v_mfma_f32_16x16x32_bf16 v[112:115], a[56:59], v[184:187], v[112:115]
    v_add_u32_e64 v198, v49, v198
    v_mfma_f32_32x32x16_bf16 v[80:95], a[56:59], v[188:191], v[80:95]
    v_add_u32 v196, 19584, v196
    ds_read_b64 v[172:173], v198 offset:0
    ds_read_b64 v[174:175], v198 offset:64
    ds_read_b64 v[176:177], v196 offset:0
    v_mfma_f32_32x32x16_bf16 v[96:111], a[56:59], v[192:195], v[96:111]
    ds_read_b64 v[178:179], v196 offset:512
    ds_read_b64 v[180:181], v196 offset:256
    ds_read_b64 v[182:183], v196 offset:768
    buffer_load_dwordx4 v76, s[16:19], s99 offen offset:3072 sc1 lds
    s_waitcnt lgkmcnt(6)
    v_mfma_f32_16x16x32_bf16 v[112:115], a[60:63], v[160:163], v[112:115]
    ds_read_b64 v[184:185], v198 offset:256
    v_mfma_f32_32x32x16_bf16 v[80:95], a[60:63], v[164:167], v[80:95]
    ds_read_b64 v[186:187], v198 offset:320
    ds_read_b64 v[188:189], v196 offset:2048
    ds_read_b64 v[190:191], v196 offset:2560
    v_mfma_f32_32x32x16_bf16 v[96:111], a[60:63], v[168:171], v[96:111]
    ds_read_b64 v[192:193], v196 offset:2304
    ds_read_b64 v[194:195], v196 offset:2816
    s_add_u32 m0, s93, 132096
    s_add_u32 s99, s99, 524288
    s_mov_b64 exec, s[80:81]
    buffer_load_dwordx4 v77, s[16:19], s100 offen sc1 lds
    s_mov_b64 exec, -1
    s_add_u32 s100, s100, 524288
    s_waitcnt lgkmcnt(6)
    v_mfma_f32_16x16x32_bf16 v[112:115], a[64:67], v[172:175], v[112:115]
    ds_read_b64 v[160:161], v198 offset:512
    v_mfma_f32_32x32x16_bf16 v[80:95], a[64:67], v[176:179], v[80:95]
    ds_read_b64 v[162:163], v198 offset:576
    ds_read_b64 v[164:165], v196 offset:4096
    ds_read_b64 v[166:167], v196 offset:4608
    v_mfma_f32_32x32x16_bf16 v[96:111], a[64:67], v[180:183], v[96:111]
    ds_read_b64 v[168:169], v196 offset:4352
    ds_read_b64 v[170:171], v196 offset:4864
    s_lshl_b32 s25, s72, 5
    s_add_u32 s25, s25, 256
    s_sub_u32 s26, s25, 4
    s_max_i32 s26, s26, 0
    s_lshl_b32 s27, s71, 12
    s_add_u32 s27, s27, 9437184
    s_lshl_b32 s99, s25, 3
    s_lshl_b32 s100, s26, 3
    s_lshl_b32 s92, s24, 12
    s_lshl_b32 s93, s24, 9
    s_add_u32 s99, s99, s27
    s_add_u32 s100, s100, s27
    s_waitcnt lgkmcnt(6)
    v_mfma_f32_16x16x32_bf16 v[112:115], a[68:71], v[184:187], v[112:115]
    ds_read_b64 v[172:173], v198 offset:768
    v_mfma_f32_32x32x16_bf16 v[80:95], a[68:71], v[188:191], v[80:95]
    ds_read_b64 v[174:175], v198 offset:832
    ds_read_b64 v[176:177], v196 offset:6144
    ds_read_b64 v[178:179], v196 offset:6656
    v_mfma_f32_32x32x16_bf16 v[96:111], a[68:71], v[192:195], v[96:111]
    ds_read_b64 v[180:181], v196 offset:6400
    ds_read_b64 v[182:183], v196 offset:6912
    s_waitcnt lgkmcnt(6)
    v_mfma_f32_16x16x32_bf16 v[112:115], a[72:75], v[160:163], v[112:115]
    ds_read_b64 v[184:185], v198 offset:1024
    v_mfma_f32_32x32x16_bf16 v[80:95], a[72:75], v[164:167], v[80:95]
    ds_read_b64 v[186:187], v198 offset:1088
    ds_read_b64 v[188:189], v196 offset:8192
    ds_read_b64 v[190:191], v196 offset:8704
    v_mfma_f32_32x32x16_bf16 v[96:111], a[72:75], v[168:171], v[96:111]
    ds_read_b64 v[192:193], v196 offset:8448
    ds_read_b64 v[194:195], v196 offset:8960
    s_waitcnt lgkmcnt(6)
    v_mfma_f32_16x16x32_bf16 v[112:115], a[76:79], v[172:175], v[112:115]
    ds_read_b64 v[160:161], v198 offset:1280
    v_mfma_f32_32x32x16_bf16 v[80:95], a[76:79], v[176:179], v[80:95]
    ds_read_b64 v[162:163], v198 offset:1344
    ds_read_b64 v[164:165], v196 offset:10240
    ds_read_b64 v[166:167], v196 offset:10752
    v_mfma_f32_32x32x16_bf16 v[96:111], a[76:79], v[180:183], v[96:111]
    ds_read_b64 v[168:169], v196 offset:10496
    ds_read_b64 v[170:171], v196 offset:11008
    s_waitcnt lgkmcnt(6)
    v_mfma_f32_16x16x32_bf16 v[112:115], a[80:83], v[184:187], v[112:115]
    ds_read_b64 v[172:173], v198 offset:1536
    v_mfma_f32_32x32x16_bf16 v[80:95], a[80:83], v[188:191], v[80:95]
    ds_read_b64 v[174:175], v198 offset:1600
    ds_read_b64 v[176:177], v196 offset:12288
    ds_read_b64 v[178:179], v196 offset:12800
    v_mfma_f32_32x32x16_bf16 v[96:111], a[80:83], v[192:195], v[96:111]
    ds_read_b64 v[180:181], v196 offset:12544
    ds_read_b64 v[182:183], v196 offset:13056
    s_lshl_b32 s98, s72, 5
    s_add_u32 s98, s98, 0
    s_sub_u32 s95, s98, 4
    s_max_i32 s95, s95, 0
    s_lshl_b32 s94, s98, 3
    s_lshl_b32 s95, s95, 3
    s_add_u32 s94, s94, 3457024
    s_add_u32 s95, s95, 3457024
    s_add_u32 s96, s94, 8192
    buffer_load_dwordx2 v[152:153], v47, s[16:19], s94 offen sc1
    s_waitcnt lgkmcnt(6)
    v_mfma_f32_16x16x32_bf16 v[112:115], a[84:87], v[160:163], v[112:115]
    ds_read_b64 v[184:185], v198 offset:1792
    v_mfma_f32_32x32x16_bf16 v[80:95], a[84:87], v[164:167], v[80:95]
    ds_read_b64 v[186:187], v198 offset:1856
    ds_read_b64 v[188:189], v196 offset:14336
    ds_read_b64 v[190:191], v196 offset:14848
    v_mfma_f32_32x32x16_bf16 v[96:111], a[84:87], v[168:171], v[96:111]
    ds_read_b64 v[192:193], v196 offset:14592
    ds_read_b64 v[194:195], v196 offset:15104
    buffer_load_dwordx2 v[154:155], v47, s[16:19], s96 offen sc1
    s_waitcnt vmcnt(7)
    s_barrier
    s_waitcnt lgkmcnt(6)
    v_mfma_f32_16x16x32_bf16 v[112:115], a[88:91], v[172:175], v[112:115]
    v_add_u32_e64 v198, v49, v198
    v_mfma_f32_32x32x16_bf16 v[80:95], a[88:91], v[176:179], v[80:95]
    v_add_u32 v196, 19584, v196
    ds_read_b64 v[160:161], v198 offset:0
    ds_read_b64 v[162:163], v198 offset:64
    ds_read_b64 v[164:165], v196 offset:0
    v_mfma_f32_32x32x16_bf16 v[96:111], a[88:91], v[180:183], v[96:111]
    ds_read_b64 v[166:167], v196 offset:512
    ds_read_b64 v[168:169], v196 offset:256
    ds_read_b64 v[170:171], v196 offset:768
    buffer_load_dwordx2 v[156:157], v48, s[16:19], s95 offen sc1
    s_waitcnt lgkmcnt(6)
    v_mfma_f32_16x16x32_bf16 v[112:115], a[92:95], v[184:187], v[112:115]
    ds_read_b64 v[172:173], v198 offset:256
    v_mfma_f32_32x32x16_bf16 v[80:95], a[92:95], v[188:191], v[80:95]
    ds_read_b64 v[174:175], v198 offset:320
    ds_read_b64 v[176:177], v196 offset:2048
    ds_read_b64 v[178:179], v196 offset:2560
    v_mfma_f32_32x32x16_bf16 v[96:111], a[92:95], v[192:195], v[96:111]
    ds_read_b64 v[180:181], v196 offset:2304
    ds_read_b64 v[182:183], v196 offset:2816
    buffer_load_dword v7, v4, s[16:19], s89 offen offset:4 sc1
    s_waitcnt lgkmcnt(6)
    v_mfma_f32_16x16x32_bf16 v[112:115], a[96:99], v[160:163], v[112:115]
    ds_read_b64 v[184:185], v198 offset:512
    v_mfma_f32_32x32x16_bf16 v[80:95], a[96:99], v[164:167], v[80:95]
    ds_read_b64 v[186:187], v198 offset:576
    ds_read_b64 v[188:189], v196 offset:4096
    ds_read_b64 v[190:191], v196 offset:4608
    v_mfma_f32_32x32x16_bf16 v[96:111], a[96:99], v[168:171], v[96:111]
    ds_read_b64 v[192:193], v196 offset:4352
    ds_read_b64 v[194:195], v196 offset:4864
    s_waitcnt lgkmcnt(6)
    v_mfma_f32_16x16x32_bf16 v[112:115], a[100:103], v[172:175], v[112:115]
    ds_read_b64 v[160:161], v198 offset:768
    v_mfma_f32_32x32x16_bf16 v[80:95], a[100:103], v[176:179], v[80:95]
    ds_read_b64 v[162:163], v198 offset:832
    ds_read_b64 v[164:165], v196 offset:6144
    ds_read_b64 v[166:167], v196 offset:6656
    v_mfma_f32_32x32x16_bf16 v[96:111], a[100:103], v[180:183], v[96:111]
    ds_read_b64 v[168:169], v196 offset:6400
    ds_read_b64 v[170:171], v196 offset:6912
    s_waitcnt lgkmcnt(6)
    v_mfma_f32_16x16x32_bf16 v[112:115], a[104:107], v[184:187], v[112:115]
    ds_read_b64 v[172:173], v198 offset:1024
    v_mfma_f32_32x32x16_bf16 v[80:95], a[104:107], v[188:191], v[80:95]
    ds_read_b64 v[174:175], v198 offset:1088
    ds_read_b64 v[176:177], v196 offset:8192
    ds_read_b64 v[178:179], v196 offset:8704
    v_mfma_f32_32x32x16_bf16 v[96:111], a[104:107], v[192:195], v[96:111]
    ds_read_b64 v[180:181], v196 offset:8448
    ds_read_b64 v[182:183], v196 offset:8960
    s_waitcnt lgkmcnt(6)
    v_mfma_f32_16x16x32_bf16 v[112:115], a[108:111], v[160:163], v[112:115]
    ds_read_b64 v[184:185], v198 offset:1280
    v_mfma_f32_32x32x16_bf16 v[80:95], a[108:111], v[164:167], v[80:95]
    ds_read_b64 v[186:187], v198 offset:1344
    ds_read_b64 v[188:189], v196 offset:10240
    ds_read_b64 v[190:191], v196 offset:10752
    v_mfma_f32_32x32x16_bf16 v[96:111], a[108:111], v[168:171], v[96:111]
    ds_read_b64 v[192:193], v196 offset:10496
    ds_read_b64 v[194:195], v196 offset:11008
    s_waitcnt lgkmcnt(6)
    v_mfma_f32_16x16x32_bf16 v[112:115], a[112:115], v[172:175], v[112:115]
    ds_read_b64 v[160:161], v198 offset:1536
    v_mfma_f32_32x32x16_bf16 v[80:95], a[112:115], v[176:179], v[80:95]
    ds_read_b64 v[162:163], v198 offset:1600
    ds_read_b64 v[164:165], v196 offset:12288
    ds_read_b64 v[166:167], v196 offset:12800
    v_mfma_f32_32x32x16_bf16 v[96:111], a[112:115], v[180:183], v[96:111]
    ds_read_b64 v[168:169], v196 offset:12544
    ds_read_b64 v[170:171], v196 offset:13056
    s_waitcnt lgkmcnt(6)
    v_mfma_f32_16x16x32_bf16 v[112:115], a[116:119], v[184:187], v[112:115]
    ds_read_b64 v[172:173], v198 offset:1792
    v_mfma_f32_32x32x16_bf16 v[80:95], a[116:119], v[188:191], v[80:95]
    ds_read_b64 v[174:175], v198 offset:1856
    ds_read_b64 v[176:177], v196 offset:14336
    ds_read_b64 v[178:179], v196 offset:14848
    v_mfma_f32_32x32x16_bf16 v[96:111], a[116:119], v[192:195], v[96:111]
    ds_read_b64 v[180:181], v196 offset:14592
    ds_read_b64 v[182:183], v196 offset:15104
sl_57:
    s_waitcnt vmcnt(2)
    v_max3_u32 v2, v152, v153, v154
    s_waitcnt vmcnt(1)
    v_max3_u32 v2, v2, v155, v156
    v_max_u32 v2, v2, v157
    v_cmp_eq_u32 vcc, -1, v2
    s_nop 0
    s_cbranch_vccnz rd_58
rc_59:
    s_waitcnt vmcnt(0)
    v_cmp_gt_u32 vcc, 1, v7
    s_nop 0
    s_and_b64 vcc, vcc, s[50:51]
    s_cbranch_scc1 ps_60
pc_62:
    s_barrier
    s_waitcnt lgkmcnt(6)
    v_mfma_f32_16x16x32_bf16 v[112:115], a[120:123], v[160:163], v[112:115]
    v_add_u32_e64 v198, v49, v198
    v_mfma_f32_32x32x16_bf16 v[80:95], a[120:123], v[164:167], v[80:95]
    v_add_u32 v196, 19584, v196
    ds_read_b64 v[184:185], v198 offset:0
    ds_read_b64 v[186:187], v198 offset:64
    v_mul_f32 v148, v24, v157
    v_mul_f32 v149, v25, v157
    v_mfma_f32_32x32x16_bf16 v[96:111], a[120:123], v[168:171], v[96:111]
    ds_read_b64 v[188:189], v196 offset:0
    ds_read_b64 v[190:191], v196 offset:512
    s_sub_u32 s3, s2, 160
    s_and_b32 s3, s3, 63
    s_add_u32 s3, s3, 64
    s_and_b32 s25, s3, 3
    s_lshl_b32 s25, s25, 12
    s_lshr_b32 s26, s3, 2
    s_lshl_b32 s26, s26, 7
    s_add_u32 s3, s25, s26
    v_lshrrev_b32 v236, 3, v0
    v_and_b32 v237, 7, v0
    v_lshlrev_b32 v237, 4, v237
    v_lshl_add_u32 v236, v236, 14, v237
    s_sub_u32 s25, s2, 160
    s_cmp_lt_u32 s25, 64
    s_cselect_b32 s25, 0, 1073741824
    v_add_u32_e64 v236, s25, v236
    s_add_u32 s26, s3, 9437184
    buffer_load_dwordx4 v[216:219], v236, s[16:19], s26 offen sc1
    v_mul_f32 v150, v26, v157
    v_mul_f32_e64 v151, v27, v157
    s_waitcnt lgkmcnt(4)
    v_mfma_f32_16x16x32_bf16 v[112:115], a[124:127], v[172:175], v[112:115]
    ds_read_b64 v[192:193], v198 offset:256
    v_mfma_f32_32x32x16_bf16 v[80:95], a[124:127], v[176:179], v[80:95]
    ds_read_b64 v[194:195], v198 offset:320
    ds_read_b64 v[160:161], v196 offset:2048
    v_mul_f32 v116, v8, v153
    v_mul_f32 v117, v9, v153
    v_mul_f32_e64 v118, v10, v153
    v_mfma_f32_32x32x16_bf16 v[96:111], a[124:127], v[180:183], v[96:111]
    ds_read_b64 v[162:163], v196 offset:2560
    s_add_u32 s26, s26, 524288
    buffer_load_dwordx4 v[220:223], v236, s[16:19], s26 offen sc1
    v_mul_f32 v119, v11, v153
    v_mul_f32_e64 v120, v12, v153
    s_waitcnt lgkmcnt(4)
    v_mfma_f32_16x16x32_bf16 v[112:115], a[128:131], v[184:187], v[112:115]
    ds_read_b64 v[164:165], v198 offset:512
    v_mfma_f32_32x32x16_bf16 v[80:95], a[128:131], v[188:191], v[80:95]
    ds_read_b64 v[166:167], v198 offset:576
    ds_read_b64 v[168:169], v196 offset:4096
    ds_read_b64 v[170:171], v196 offset:4608
    v_mul_f32 v121, v13, v153
    v_mul_f32_e64 v122, v14, v153
    s_waitcnt lgkmcnt(4)
    v_mfma_f32_16x16x32_bf16 v[112:115], a[132:135], v[192:195], v[112:115]
    ds_read_b64 v[172:173], v198 offset:768
    v_mfma_f32_32x32x16_bf16 v[80:95], a[132:135], v[160:163], v[80:95]
    ds_read_b64 v[174:175], v198 offset:832
    ds_read_b64 v[176:177], v196 offset:6144
    ds_read_b64 v[178:179], v196 offset:6656
    s_add_u32 s26, s26, 524288
    buffer_load_dwordx4 v[224:227], v236, s[16:19], s26 offen sc1
    v_mul_f32 v123, v15, v153
    v_mul_f32_e64 v124, v16, v153
    s_waitcnt lgkmcnt(4)
    v_mfma_f32_16x16x32_bf16 v[112:115], a[136:139], v[164:167], v[112:115]
    ds_read_b64 v[180:181], v198 offset:1024
    v_mfma_f32_32x32x16_bf16 v[80:95], a[136:139], v[168:171], v[80:95]
    ds_read_b64 v[182:183], v198 offset:1088
    ds_read_b64 v[184:185], v196 offset:8192
    ds_read_b64 v[186:187], v196 offset:8704
    v_mul_f32 v125, v17, v153
    v_mul_f32_e64 v126, v18, v153
    s_waitcnt lgkmcnt(4)
    v_mfma_f32_16x16x32_bf16 v[112:115], a[140:143], v[172:175], v[112:115]
    ds_read_b64 v[188:189], v198 offset:1280
    v_mfma_f32_32x32x16_bf16 v[80:95], a[140:143], v[176:179], v[80:95]
    ds_read_b64 v[190:191], v198 offset:1344
    ds_read_b64 v[192:193], v196 offset:10240
    ds_read_b64 v[194:195], v196 offset:10752
    s_add_u32 s26, s26, 524288
    buffer_load_dwordx4 v[228:231], v236, s[16:19], s26 offen sc1
    v_mul_f32 v127, v19, v153
    v_mul_f32_e64 v128, v20, v153
    s_waitcnt lgkmcnt(4)
    v_mfma_f32_16x16x32_bf16 v[112:115], a[144:147], v[180:183], v[112:115]
    ds_read_b64 v[160:161], v198 offset:1536
    v_mfma_f32_32x32x16_bf16 v[80:95], a[144:147], v[184:187], v[80:95]
    ds_read_b64 v[162:163], v198 offset:1600
    ds_read_b64 v[164:165], v196 offset:12288
    ds_read_b64 v[166:167], v196 offset:12800
    v_mul_f32 v129, v21, v153
    v_mul_f32_e64 v130, v22, v153
    s_waitcnt lgkmcnt(4)
    v_mfma_f32_16x16x32_bf16 v[112:115], a[148:151], v[188:191], v[112:115]
    ds_read_b64 v[168:169], v198 offset:1792
    v_mfma_f32_32x32x16_bf16 v[80:95], a[148:151], v[192:195], v[80:95]
    ds_read_b64 v[170:171], v198 offset:1856
    ds_read_b64 v[172:173], v196 offset:14336
    ds_read_b64 v[174:175], v196 offset:14848
    s_add_u32 s26, s26, 524288
    buffer_load_dwordx4 v[232:235], v236, s[16:19], s26 offen sc1
    v_mul_f32 v131, v23, v153
    v_mul_f32_e64 v132, v8, v155
    s_waitcnt lgkmcnt(4)
    v_mfma_f32_16x16x32_bf16 v[112:115], a[152:155], v[160:163], v[112:115]
    ds_read_b64 v[176:177], v196 offset:256
    v_mfma_f32_32x32x16_bf16 v[80:95], a[152:155], v[164:167], v[80:95]
    ds_read_b64 v[178:179], v196 offset:768
    ds_read_b64 v[180:181], v196 offset:2304
    ds_read_b64 v[182:183], v196 offset:2816
    v_mul_f32 v133, v9, v155
    v_mul_f32_e64 v134, v10, v155
    s_waitcnt lgkmcnt(4)
    v_mfma_f32_16x16x32_bf16 v[112:115], a[156:159], v[168:171], v[112:115]
    ds_read_b64 v[184:185], v196 offset:4352
    v_mfma_f32_32x32x16_bf16 v[80:95], a[156:159], v[172:175], v[80:95]
    ds_read_b64 v[186:187], v196 offset:4864
    ds_read_b64 v[188:189], v196 offset:6400
    ds_read_b64 v[190:191], v196 offset:6912
    s_add_u32 m0, s92, 36352
    s_nop 0
    buffer_load_dwordx4 v73, s[16:19], s99 offen offset:0 sc1 lds
    v_mul_f32 v135, v11, v155
    v_mul_f32 v136, v12, v155
    v_mul_f32 v137, v13, v155
    v_mul_f32 v138, v14, v155
    v_mul_f32 v139, v15, v155
    v_mul_f32 v140, v16, v155
    v_mul_f32 v141, v17, v155
    v_mul_f32 v142, v18, v155
    v_mul_f32 v143, v19, v155
    v_mul_f32 v144, v20, v155
    v_mul_f32 v145, v21, v155
    v_mul_f32 v146, v22, v155
    v_mul_f32_e64 v147, v23, v155
    s_waitcnt lgkmcnt(4)
    v_mfma_f32_32x32x16_bf16 v[96:111], a[128:131], v[176:179], v[96:111]
    ds_read_b64 v[192:193], v196 offset:8448
    ds_read_b64 v[194:195], v196 offset:8960
    v_mfma_f32_32x32x16_bf16 v[96:111], a[132:135], v[180:183], v[96:111]
    ds_read_b64 v[160:161], v196 offset:10496
    ds_read_b64 v[162:163], v196 offset:11008
    buffer_load_dwordx4 v74, s[16:19], s99 offen offset:1024 sc1 lds
    v_fma_f32 v112, v112, v156, v148
    v_fma_f32 v113, v113, v156, v149
    s_waitcnt lgkmcnt(4)
    v_mfma_f32_32x32x16_bf16 v[96:111], a[136:139], v[184:187], v[96:111]
    ds_read_b64 v[164:165], v196 offset:12544
    ds_read_b64 v[166:167], v196 offset:13056
    v_fma_f32 v114, v114, v156, v150
    v_fma_f32 v115, v115, v156, v151
    v_cvt_pk_bf16_f32 v112, v112, v113
    v_mfma_f32_32x32x16_bf16 v[96:111], a[140:143], v[188:191], v[96:111]
    ds_read_b64 v[168:169], v196 offset:14592
    ds_read_b64 v[170:171], v196 offset:15104
    buffer_load_dwordx4 v75, s[16:19], s99 offen offset:2048 sc1 lds
    v_cvt_pk_bf16_f32 v113, v114, v115
    v_fma_f32 v80, v80, v152, v116
    s_waitcnt lgkmcnt(4)
    v_mfma_f32_32x32x16_bf16 v[96:111], a[144:147], v[192:195], v[96:111]
    v_fma_f32 v81, v81, v152, v117
    v_fma_f32 v82, v82, v152, v118
    v_fma_f32 v83, v83, v152, v119
    v_cvt_pk_bf16_f32 v80, v80, v81
    v_cvt_pk_bf16_f32 v81, v82, v83
    v_mfma_f32_32x32x16_bf16 v[96:111], a[148:151], v[160:163], v[96:111]
    ds_write_b64 v40, v[112:113] offset:0
    ds_write_b64 v38, v[80:81] offset:0
    v_fma_f32 v84, v84, v152, v120
    v_fma_f32 v85, v85, v152, v121
    s_waitcnt lgkmcnt(2)
    v_mfma_f32_32x32x16_bf16 v[96:111], a[152:155], v[164:167], v[96:111]
    v_fma_f32 v86, v86, v152, v122
    v_fma_f32 v87, v87, v152, v123
    v_cvt_pk_bf16_f32 v84, v84, v85
    v_cvt_pk_bf16_f32 v85, v86, v87
    v_fma_f32 v88, v88, v152, v124
    v_mfma_f32_32x32x16_bf16 v[96:111], a[156:159], v[168:171], v[96:111]
    buffer_load_dwordx4 v76, s[16:19], s99 offen offset:3072 sc1 lds
    v_fma_f32 v89, v89, v152, v125
    v_fma_f32 v90, v90, v152, v126
    v_fma_f32 v91, v91, v152, v127
    v_cvt_pk_bf16_f32 v88, v88, v89
    v_cvt_pk_bf16_f32 v89, v90, v91
    ds_write_b64 v38, v[84:85] offset:6400
    ds_write_b64 v38, v[88:89] offset:12800
    v_fma_f32 v92, v92, v152, v128
    v_fma_f32 v93, v93, v152, v129
    v_fma_f32 v94, v94, v152, v130
    v_fma_f32 v95, v95, v152, v131
    v_cvt_pk_bf16_f32 v92, v92, v93
    v_cvt_pk_bf16_f32 v93, v94, v95
    ds_write_b64 v39, v[92:93] offset:0
    v_pk_fma_f32 v[96:97], v[96:97], v[154:155], v[132:133] op_sel_hi:[1,0,1]
    v_pk_fma_f32 v[98:99], v[98:99], v[154:155], v[134:135] op_sel_hi:[1,0,1]
    v_cvt_pk_bf16_f32 v96, v96, v97
    v_cvt_pk_bf16_f32 v97, v98, v99
    v_pk_fma_f32 v[100:101], v[100:101], v[154:155], v[136:137] op_sel_hi:[1,0,1]
    v_pk_fma_f32 v[102:103], v[102:103], v[154:155], v[138:139] op_sel_hi:[1,0,1]
    v_cvt_pk_bf16_f32 v100, v100, v101
    v_cvt_pk_bf16_f32 v101, v102, v103
    ds_write_b64 v38, v[96:97] offset:1600
    ds_write_b64 v38, v[100:101] offset:8000
    v_pk_fma_f32 v[104:105], v[104:105], v[154:155], v[140:141] op_sel_hi:[1,0,1]
    v_pk_fma_f32 v[106:107], v[106:107], v[154:155], v[142:143] op_sel_hi:[1,0,1]
    v_cvt_pk_bf16_f32 v104, v104, v105
    v_cvt_pk_bf16_f32 v105, v106, v107
    v_pk_fma_f32 v[108:109], v[108:109], v[154:155], v[144:145] op_sel_hi:[1,0,1]
    v_pk_fma_f32 v[110:111], v[110:111], v[154:155], v[146:147] op_sel_hi:[1,0,1]
    v_cvt_pk_bf16_f32 v108, v108, v109
    v_cvt_pk_bf16_f32 v109, v110, v111
    ds_write_b64 v38, v[104:105] offset:14400
    ds_write_b64 v39, v[108:109] offset:1600
    v_cmp_u_f32 vcc, v82, v114
    v_cmp_u_f32 s[82:83], v98, v98
    s_lshl_b32 s25, s24, 2
    s_add_u32 s25, s25, 160256
    s_or_b64 vcc, vcc, s[82:83]
    s_cselect_b32 s26, 1, 0
    v_mov_b32 v196, s25
    v_mov_b32 v197, s26
    ds_write_b32 v196, v197
    s_waitcnt lgkmcnt(0)
    s_barrier
    s_sub_u32 s85, s2, 160
    s_cmp_ge_u32 s85, 64
    s_cbranch_scc1 s2_63
    v_mov_b32 v238, 0x3f803f80
    s_lshl_b32 s25, s24, 7
    s_add_u32 s25, s25, 134272
    v_lshrrev_b32 v239, 4, v1
    v_lshl_add_u32 v237, v239, 2, v237
    v_add_u32 v237, s25, v237
se_64:
    v_mov_b32 v240, 0
    v_mov_b32 v241, 0
    v_mov_b32 v242, 0
    v_mov_b32 v243, 0
    s_waitcnt vmcnt(8)
    v_dot2c_f32_bf16 v240, v216, v238
    v_dot2c_f32_bf16 v241, v216, v216
    v_dot2c_f32_bf16 v240, v217, v238
    v_dot2c_f32_bf16 v241, v217, v217
    v_dot2c_f32_bf16 v242, v218, v238
    v_dot2c_f32_bf16 v243, v218, v218
    v_dot2c_f32_bf16 v242, v219, v238
    v_dot2c_f32_bf16 v243, v219, v219
    s_waitcnt vmcnt(7)
    v_dot2c_f32_bf16 v240, v220, v238
    v_dot2c_f32_bf16 v241, v220, v220
    v_dot2c_f32_bf16 v240, v221, v238
    v_dot2c_f32_bf16 v241, v221, v221
    v_dot2c_f32_bf16 v242, v222, v238
    v_dot2c_f32_bf16 v243, v222, v222
    v_dot2c_f32_bf16 v242, v223, v238
    v_dot2c_f32_bf16 v243, v223, v223
    s_waitcnt vmcnt(6)
    v_dot2c_f32_bf16 v240, v224, v238
    v_dot2c_f32_bf16 v241, v224, v224
    v_dot2c_f32_bf16 v240, v225, v238
    v_dot2c_f32_bf16 v241, v225, v225
    v_dot2c_f32_bf16 v242, v226, v238
    v_dot2c_f32_bf16 v243, v226, v226
    v_dot2c_f32_bf16 v242, v227, v238
    v_dot2c_f32_bf16 v243, v227, v227
    s_waitcnt vmcnt(5)
    v_dot2c_f32_bf16 v240, v228, v238
    v_dot2c_f32_bf16 v241, v228, v228
    v_dot2c_f32_bf16 v240, v229, v238
    v_dot2c_f32_bf16 v241, v229, v229
    v_dot2c_f32_bf16 v242, v230, v238
    v_dot2c_f32_bf16 v243, v230, v230
    v_dot2c_f32_bf16 v242, v231, v238
    v_dot2c_f32_bf16 v243, v231, v231
    s_waitcnt vmcnt(4)
    v_dot2c_f32_bf16 v240, v232, v238
    v_dot2c_f32_bf16 v241, v232, v232
    v_dot2c_f32_bf16 v240, v233, v238
    v_dot2c_f32_bf16 v241, v233, v233
    v_dot2c_f32_bf16 v242, v234, v238
    v_dot2c_f32_bf16 v243, v234, v234
    v_dot2c_f32_bf16 v242, v235, v238
    v_dot2c_f32_bf16 v243, v235, v235
    s_nop 2
    v_cmp_u_f32 vcc, v241, v243
    s_nop 0
    s_cbranch_vccnz rd_65
rc_66:
    v_permlane32_swap_b32 v240, v242
    v_permlane32_swap_b32 v241, v243
    v_pk_add_f32 v[240:241], v[240:241], v[242:243]
    s_nop 1
    v_permlane16_swap_b32 v240, v241
    v_add_f32_e64 v240, v240, v241
    s_nop 1
    v_add_f32_dpp v240, v240, v240 row_ror:8 row_mask:0xf bank_mask:0xf
    ds_write_b32 v237, v240
    v_and_b32 v236, 15, v0
    v_lshlrev_b32 v236, 3, v236
    v_add_u32 v237, 134272, v236
    v_mov_b32 v239, 1073741824
    v_cmp_gt_u32 vcc, 16, v0
    s_nop 1
    v_cndmask_b32 v236, v239, v236, vcc
    s_add_u32 s25, s3, 3457024
    s_waitcnt lgkmcnt(0)
    s_barrier
    ds_read_b64 v[216:217], v237 offset:0
    ds_read_b64 v[218:219], v237 offset:128
    ds_read_b64 v[220:221], v237 offset:256
    ds_read_b64 v[222:223], v237 offset:384
    s_waitcnt lgkmcnt(2)
    v_pk_add_f32 v[216:217], v[216:217], v[218:219]
    s_waitcnt lgkmcnt(0)
    v_pk_add_f32 v[220:221], v[220:221], v[222:223]
    v_pk_add_f32 v[216:217], v[216:217], v[220:221]
    v_mul_f32 v239, 0x3acccccd, v216
    v_mul_f32 v217, 0x3acccccd, v217
    v_fma_f32 v217, -v239, v239, v217
    v_max_f32 v217, 0, v217
    v_add_f32 v217, 0x3727c5ac, v217
    v_rsq_f32_e64 v216, v217
    s_nop 0
    v_mul_f32 v217, -v239, v216
    buffer_store_dwordx2 v[216:217], v236, s[16:19], s25 offen sc1
s2_63:
    v_mov_b32 v158, 160256
    ds_read_b128 v[128:131], v158
    v_mov_b32 v94, 0
    v_mov_b32 v95, 0
    v_mov_b32 v98, 0
    v_mov_b32 v99, 0
    s_mov_b64 exec, 0xffff
    ds_read_b64 v[94:95], v42 offset:320
    ds_read_b64 v[98:99], v42 offset:640
    s_mov_b64 exec, -1
    s_nop 0
    ds_read_b64 v[92:93], v41 offset:320
    ds_read_b64 v[96:97], v41 offset:640
    ds_read_b64 v[84:85], v41 offset:6720
    ds_read_b64 v[86:87], v42 offset:6720
    ds_read_b64 v[80:81], v41 offset:6400
    ds_read_b64 v[82:83], v42 offset:6400
    ds_read_b64 v[88:89], v41 offset:7040
    ds_read_b64 v[90:91], v42 offset:7040
    ds_read_b64_tr_b16 v[106:107], v44 offset:0
    ds_read_b64_tr_b16 v[100:101], v43 offset:0
    s_add_u32 m0, s93, 53760
    s_add_u32 s99, s99, 524288
    s_mov_b64 exec, s[80:81]
    buffer_load_dwordx4 v77, s[16:19], s100 offen sc1 lds
    s_mov_b64 exec, -1
    s_add_u32 s100, s100, 524288
    ds_read_b64_tr_b16 v[108:109], v44 offset:320
    ds_read_b64_tr_b16 v[102:103], v43 offset:320
    ds_read_b64_tr_b16 v[110:111], v44 offset:640
    ds_read_b64_tr_b16 v[104:105], v43 offset:640
    v_mov_b32 v156, 0xf149f2ca
    v_cndmask_b32 v152, v32, v156, s[90:91]
    v_cndmask_b32 v153, v33, v156, s[90:91]
    v_cndmask_b32 v154, v34, v156, s[90:91]
    s_add_u32 m0, s92, 55936
    s_nop 0
    buffer_load_dwordx4 v73, s[16:19], s99 offen offset:0 sc1 lds
    v_cndmask_b32 v155, v35, v156, s[90:91]
    s_mov_b32 s82, 0x3ea52b5c
    s_lshl_b32 s25, s98, 4
    s_add_u32 s25, s25, 12058624
    s_lshl_b32 s26, s98, 3
    s_add_u32 s26, s26, 12058624
    s_waitcnt lgkmcnt(15)
    v_or3_b32 v128, v128, v129, v130
    v_or_b32 v128, v128, v131
    buffer_load_dwordx4 v74, s[16:19], s99 offen offset:1024 sc1 lds
    v_cmp_ne_u32_e64 vcc, 0, v128
    s_nop 0
    s_cbranch_vccnz rd_67
rc_68:
    s_waitcnt lgkmcnt(10)
    v_mfma_f32_16x16x32_bf16 v[116:119], v[84:87], v[92:95], v[28:31]
    v_mfma_f32_16x16x32_bf16 v[120:123], v[84:87], v[96:99], v[32:35]
    s_waitcnt lgkmcnt(8)
    v_mfma_f32_16x16x32_bf16 v[112:115], v[80:83], v[92:95], v[152:155]
    s_waitcnt lgkmcnt(6)
    v_mfma_f32_16x16x32_bf16 v[124:127], v[88:91], v[96:99], v[28:31]
    s_nop 5
    v_max_f32 v112, v112, v116
    v_max_f32 v113, v113, v117
    v_max_f32 v114, v114, v118
    buffer_load_dwordx4 v75, s[16:19], s99 offen offset:2048 sc1 lds
    v_max_f32 v115, v115, v119
    v_max3_f32 v156, v112, v113, v114
    v_max_f32 v156, v156, v115
    v_max_f32 v120, v120, v124
    v_max_f32 v121, v121, v125
    v_max_f32 v122, v122, v126
    v_max_f32 v123, v123, v127
    v_max3_f32 v157, v120, v121, v122
    buffer_load_dwordx4 v76, s[16:19], s99 offen offset:3072 sc1 lds
    v_max_f32 v157, v157, v123
    s_nop 1
    v_permlane16_swap_b32 v156, v157
    v_max_f32 v156, v156, v157
    v_mov_b32 v157, v156
    s_nop 1
    v_permlane32_swap_b32 v156, v157
    v_max_f32 v156, v156, v157
    v_mul_f32 v156, s82, v156
    v_mov_b32 v157, v156
    s_add_u32 m0, s93, 73344
    s_add_u32 s99, s99, 524288
    s_mov_b64 exec, s[80:81]
    buffer_load_dwordx4 v77, s[16:19], s100 offen sc1 lds
    s_mov_b64 exec, -1
    s_add_u32 s100, s100, 524288
    v_permlane16_swap_b32_e64 v156, v157
    v_fma_f32 v112, v112, s82, -v156
    v_fma_f32 v113, v113, s82, -v156
    v_fma_f32 v114, v114, s82, -v156
    v_fma_f32 v115, v115, s82, -v156
    v_exp_f32 v112, v112
    v_exp_f32 v113, v113
    v_exp_f32 v114, v114
    s_add_u32 m0, s92, 75520
    s_nop 0
    buffer_load_dwordx4 v73, s[16:19], s99 offen offset:0 sc1 lds
    v_exp_f32_e64 v115, v115
    v_cvt_pk_bf16_f32 v116, v112, v113
    v_cvt_pk_bf16_f32 v117, v114, v115
    v_bfi_b32 v128, v36, 0, v116
    v_and_b32 v130, v36, v116
    v_bfi_b32 v129, v37, 0, v117
    v_and_b32 v131, v37, v117
    s_waitcnt lgkmcnt(3)
    s_nop 0
    v_mfma_f32_16x16x32_bf16 v[144:147], v[106:109], v[128:131], 0
    buffer_load_dwordx4 v74, s[16:19], s99 offen offset:1024 sc1 lds
    s_waitcnt lgkmcnt(2)
    v_mfma_f32_16x16x32_bf16 v[136:139], v[100:103], v[128:131], 0
    v_fma_f32 v120, v120, s82, -v157
    v_fma_f32 v121, v121, s82, -v157
    v_fma_f32 v122, v122, s82, -v157
    v_fma_f32 v123, v123, s82, -v157
    v_exp_f32 v120, v120
    v_exp_f32 v121, v121
    v_exp_f32 v122, v122
    buffer_load_dwordx4 v75, s[16:19], s99 offen offset:2048 sc1 lds
    v_exp_f32_e64 v123, v123
    v_cvt_pk_bf16_f32 v124, v120, v121
    v_cvt_pk_bf16_f32 v125, v122, v123
    v_bfi_b32 v132, v36, 0, v124
    v_and_b32 v134, v36, v124
    v_bfi_b32 v133, v37, 0, v125
    v_and_b32 v135, v37, v125
    s_waitcnt lgkmcnt(1)
    s_nop 0
    v_mfma_f32_16x16x32_bf16 v[148:151], v[108:111], v[132:135], 0
    buffer_load_dwordx4 v76, s[16:19], s99 offen offset:3072 sc1 lds
    s_waitcnt lgkmcnt(0)
    v_mfma_f32_16x16x32_bf16 v[140:143], v[102:105], v[132:135], 0
    v_mov_b32 v158, v144
    s_nop 1
    v_permlane16_swap_b32 v144, v158
    v_rcp_f32 v158, v158
    s_nop 0
    v_pk_mul_f32 v[136:137], v[136:137], v[158:159] op_sel_hi:[1,0]
    v_pk_mul_f32 v[138:139], v[138:139], v[158:159] op_sel_hi:[1,0]
    v_pk_mul_f32 v[144:145], v[144:145], v[158:159] op_sel_hi:[1,0]
    v_pk_mul_f32 v[146:147], v[146:147], v[158:159] op_sel_hi:[1,0]
    s_add_u32 m0, s93, 92928
    s_add_u32 s99, s99, 524288
    s_mov_b64 exec, s[80:81]
    buffer_load_dwordx4 v77, s[16:19], s100 offen sc1 lds
    s_mov_b64 exec, -1
    s_add_u32 s100, s100, 524288
    v_cvt_pk_bf16_f32 v112, v136, v137
    v_cvt_pk_bf16_f32 v116, v144, v145
    v_cvt_pk_bf16_f32 v113, v138, v139
    v_cvt_pk_bf16_f32 v117, v146, v147
    v_mov_b32 v160, v148
    s_nop 1
    v_permlane16_swap_b32 v148, v160
    v_rcp_f32_e64 v160, v160
    s_nop 0
    v_pk_mul_f32 v[140:141], v[140:141], v[160:161] op_sel_hi:[1,0]
    v_pk_mul_f32 v[142:143], v[142:143], v[160:161] op_sel_hi:[1,0]
    v_pk_mul_f32 v[148:149], v[148:149], v[160:161] op_sel_hi:[1,0]
    v_pk_mul_f32 v[150:151], v[150:151], v[160:161] op_sel_hi:[1,0]
    v_cvt_pk_bf16_f32 v114, v140, v141
    v_cvt_pk_bf16_f32 v118, v148, v149
    v_cvt_pk_bf16_f32 v115, v142, v143
    v_cvt_pk_bf16_f32 v119, v150, v151
    v_permlane16_swap_b32 v112, v114
    v_permlane16_swap_b32 v113, v115
    v_permlane16_swap_b32 v116, v118
    v_permlane16_swap_b32 v117, v119
    buffer_store_dwordx4 v[112:115], v45, s[16:19], s25 offen sc1
    s_mov_b64 exec, s[80:81]
    buffer_store_dwordx2 v[116:117], v46, s[16:19], s26 offen sc1
    s_mov_b64 exec, -1
ge_69:
    v_add_u32 v196, 36352, v78
    v_mov_b32_e64 v198, v79
    s_waitcnt vmcnt(12)
    s_barrier
    ds_read_b64 v[160:161], v198 offset:0
    ds_read_b64 v[162:163], v198 offset:64
    ds_read_b64 v[164:165], v196 offset:0
    ds_read_b64 v[166:167], v196 offset:512
    ds_read_b64 v[168:169], v196 offset:256
    ds_read_b64 v[170:171], v196 offset:768
    ds_read_b64 v[172:173], v198 offset:256
    ds_read_b64 v[174:175], v198 offset:320
    ds_read_b64 v[176:177], v196 offset:2048
    ds_read_b64 v[178:179], v196 offset:2560
    ds_read_b64 v[180:181], v196 offset:2304
    ds_read_b64 v[182:183], v196 offset:2816
    s_waitcnt lgkmcnt(6)
    v_mfma_f32_16x16x32_bf16 v[112:115], a[0:3], v[160:163], 0
    ds_read_b64 v[184:185], v198 offset:512
    v_mfma_f32_32x32x16_bf16 v[80:95], a[0:3], v[164:167], 0
    ds_read_b64 v[186:187], v198 offset:576
    ds_read_b64 v[188:189], v196 offset:4096
    ds_read_b64 v[190:191], v196 offset:4608
    v_mfma_f32_32x32x16_bf16 v[96:111], a[0:3], v[168:171], 0
    ds_read_b64 v[192:193], v196 offset:4352
    ds_read_b64 v[194:195], v196 offset:4864
    s_add_u32 m0, s92, 95104
    s_nop 0
    buffer_load_dwordx4 v73, s[16:19], s99 offen offset:0 sc1 lds
    s_waitcnt lgkmcnt(6)
    v_mfma_f32_16x16x32_bf16 v[112:115], a[4:7], v[172:175], v[112:115]
    ds_read_b64 v[160:161], v198 offset:768
    v_mfma_f32_32x32x16_bf16 v[80:95], a[4:7], v[176:179], v[80:95]
    ds_read_b64 v[162:163], v198 offset:832
    ds_read_b64 v[164:165], v196 offset:6144
    ds_read_b64 v[166:167], v196 offset:6656
    v_mfma_f32_32x32x16_bf16 v[96:111], a[4:7], v[180:183], v[96:111]
    ds_read_b64 v[168:169], v196 offset:6400
    ds_read_b64 v[170:171], v196 offset:6912
    buffer_load_dwordx4 v74, s[16:19], s99 offen offset:1024 sc1 lds
    s_waitcnt lgkmcnt(6)
    v_mfma_f32_16x16x32_bf16 v[112:115], a[8:11], v[184:187], v[112:115]
    ds_read_b64 v[172:173], v198 offset:1024
    v_mfma_f32_32x32x16_bf16 v[80:95], a[8:11], v[188:191], v[80:95]
    ds_read_b64 v[174:175], v198 offset:1088
    ds_read_b64 v[176:177], v196 offset:8192
    ds_read_b64 v[178:179], v196 offset:8704
    v_mfma_f32_32x32x16_bf16 v[96:111], a[8:11], v[192:195], v[96:111]
    ds_read_b64 v[180:181], v196 offset:8448
    ds_read_b64 v[182:183], v196 offset:8960
    buffer_load_dwordx4 v75, s[16:19], s99 offen offset:2048 sc1 lds
    s_waitcnt lgkmcnt(6)
    v_mfma_f32_16x16x32_bf16 v[112:115], a[12:15], v[160:163], v[112:115]
    ds_read_b64 v[184:185], v198 offset:1280
    v_mfma_f32_32x32x16_bf16 v[80:95], a[12:15], v[164:167], v[80:95]
    ds_read_b64 v[186:187], v198 offset:1344
    ds_read_b64 v[188:189], v196 offset:10240
    ds_read_b64 v[190:191], v196 offset:10752
    v_mfma_f32_32x32x16_bf16 v[96:111], a[12:15], v[168:171], v[96:111]
    ds_read_b64 v[192:193], v196 offset:10496
    ds_read_b64 v[194:195], v196 offset:11008
    buffer_load_dwordx4 v76, s[16:19], s99 offen offset:3072 sc1 lds
    s_waitcnt lgkmcnt(6)
    v_mfma_f32_16x16x32_bf16 v[112:115], a[16:19], v[172:175], v[112:115]
    ds_read_b64 v[160:161], v198 offset:1536
    v_mfma_f32_32x32x16_bf16 v[80:95], a[16:19], v[176:179], v[80:95]
    ds_read_b64 v[162:163], v198 offset:1600
    ds_read_b64 v[164:165], v196 offset:12288
    ds_read_b64 v[166:167], v196 offset:12800
    v_mfma_f32_32x32x16_bf16 v[96:111], a[16:19], v[180:183], v[96:111]
    ds_read_b64 v[168:169], v196 offset:12544
    ds_read_b64 v[170:171], v196 offset:13056
    s_add_u32 m0, s93, 112512
    s_add_u32 s99, s99, 524288
    s_mov_b64 exec, s[80:81]
    buffer_load_dwordx4 v77, s[16:19], s100 offen sc1 lds
    s_mov_b64 exec, -1
    s_add_u32 s100, s100, 524288
    s_waitcnt lgkmcnt(6)
    v_mfma_f32_16x16x32_bf16 v[112:115], a[20:23], v[184:187], v[112:115]
    ds_read_b64 v[172:173], v198 offset:1792
    v_mfma_f32_32x32x16_bf16 v[80:95], a[20:23], v[188:191], v[80:95]
    ds_read_b64 v[174:175], v198 offset:1856
    ds_read_b64 v[176:177], v196 offset:14336
    ds_read_b64 v[178:179], v196 offset:14848
    v_mfma_f32_32x32x16_bf16 v[96:111], a[20:23], v[192:195], v[96:111]
    ds_read_b64 v[180:181], v196 offset:14592
    ds_read_b64 v[182:183], v196 offset:15104
    s_add_u32 m0, s92, 114688
    s_nop 0
    buffer_load_dwordx4 v73, s[16:19], s99 offen offset:0 sc1 lds
    s_waitcnt vmcnt(13)
    s_barrier
    s_waitcnt lgkmcnt(6)
    v_mfma_f32_16x16x32_bf16 v[112:115], a[24:27], v[160:163], v[112:115]
    v_add_u32 v198, v49, v198
    v_mfma_f32_32x32x16_bf16 v[80:95], a[24:27], v[164:167], v[80:95]
    v_add_u32 v196, 19584, v196
    ds_read_b64 v[184:185], v198 offset:0
    ds_read_b64 v[186:187], v198 offset:64
    ds_read_b64 v[188:189], v196 offset:0
    v_mfma_f32_32x32x16_bf16 v[96:111], a[24:27], v[168:171], v[96:111]
    ds_read_b64 v[190:191], v196 offset:512
    ds_read_b64 v[192:193], v196 offset:256
    ds_read_b64 v[194:195], v196 offset:768
    buffer_load_dwordx4 v74, s[16:19], s99 offen offset:1024 sc1 lds
    s_waitcnt lgkmcnt(6)
    v_mfma_f32_16x16x32_bf16 v[112:115], a[28:31], v[172:175], v[112:115]
    ds_read_b64 v[160:161], v198 offset:256
    v_mfma_f32_32x32x16_bf16 v[80:95], a[28:31], v[176:179], v[80:95]
    ds_read_b64 v[162:163], v198 offset:320
    ds_read_b64 v[164:165], v196 offset:2048
    ds_read_b64 v[166:167], v196 offset:2560
    v_mfma_f32_32x32x16_bf16 v[96:111], a[28:31], v[180:183], v[96:111]
    ds_read_b64 v[168:169], v196 offset:2304
    ds_read_b64 v[170:171], v196 offset:2816
    buffer_load_dwordx4 v75, s[16:19], s99 offen offset:2048 sc1 lds
    s_waitcnt lgkmcnt(6)
    v_mfma_f32_16x16x32_bf16 v[112:115], a[32:35], v[184:187], v[112:115]
    ds_read_b64 v[172:173], v198 offset:512
    v_mfma_f32_32x32x16_bf16 v[80:95], a[32:35], v[188:191], v[80:95]
    ds_read_b64 v[174:175], v198 offset:576
    ds_read_b64 v[176:177], v196 offset:4096
    ds_read_b64 v[178:179], v196 offset:4608
    v_mfma_f32_32x32x16_bf16 v[96:111], a[32:35], v[192:195], v[96:111]
    ds_read_b64 v[180:181], v196 offset:4352
    ds_read_b64 v[182:183], v196 offset:4864
    buffer_load_dwordx4 v76, s[16:19], s99 offen offset:3072 sc1 lds
    s_waitcnt lgkmcnt(6)
    v_mfma_f32_16x16x32_bf16 v[112:115], a[36:39], v[160:163], v[112:115]
    ds_read_b64 v[184:185], v198 offset:768
    v_mfma_f32_32x32x16_bf16 v[80:95], a[36:39], v[164:167], v[80:95]
    ds_read_b64 v[186:187], v198 offset:832
    ds_read_b64 v[188:189], v196 offset:6144
    ds_read_b64 v[190:191], v196 offset:6656
    v_mfma_f32_32x32x16_bf16 v[96:111], a[36:39], v[168:171], v[96:111]
    ds_read_b64 v[192:193], v196 offset:6400
    ds_read_b64 v[194:195], v196 offset:6912
    s_add_u32 m0, s93, 132096
    s_add_u32 s99, s99, 524288
    s_mov_b64 exec, s[80:81]
    buffer_load_dwordx4 v77, s[16:19], s100 offen sc1 lds
    s_mov_b64 exec, -1
    s_add_u32 s100, s100, 524288
    s_waitcnt lgkmcnt(6)
    v_mfma_f32_16x16x32_bf16 v[112:115], a[40:43], v[172:175], v[112:115]
    ds_read_b64 v[160:161], v198 offset:1024
    v_mfma_f32_32x32x16_bf16 v[80:95], a[40:43], v[176:179], v[80:95]
    ds_read_b64 v[162:163], v198 offset:1088
    ds_read_b64 v[164:165], v196 offset:8192
    ds_read_b64 v[166:167], v196 offset:8704
    v_add_u32 v199, 36352, v58
    s_lshl_b32 s32, s24, 11
    v_mfma_f32_32x32x16_bf16 v[96:111], a[40:43], v[180:183], v[96:111]
    ds_read_b64 v[168:169], v196 offset:8448
    ds_read_b64 v[170:171], v196 offset:8960
    v_add_u32 v203, s32, v199
    s_add_u32 s32, s24, 1
    s_waitcnt lgkmcnt(6)
    v_mfma_f32_16x16x32_bf16 v[112:115], a[44:47], v[184:187], v[112:115]
    ds_read_b64 v[172:173], v198 offset:1280
    v_mfma_f32_32x32x16_bf16 v[80:95], a[44:47], v[188:191], v[80:95]
    ds_read_b64 v[174:175], v198 offset:1344
    ds_read_b64 v[176:177], v196 offset:10240
    ds_read_b64 v[178:179], v196 offset:10752
    s_and_b32 s32, s32, 3
    s_mul_i32 s32, s32, 6144
    v_mfma_f32_32x32x16_bf16 v[96:111], a[44:47], v[192:195], v[96:111]
    ds_read_b64 v[180:181], v196 offset:10496
    ds_read_b64 v[182:183], v196 offset:11008
    v_add_u32 v200, s32, v199
    s_add_u32 s32, s24, 2
    s_waitcnt lgkmcnt(6)
    v_mfma_f32_16x16x32_bf16 v[112:115], a[48:51], v[160:163], v[112:115]
    ds_read_b64 v[184:185], v198 offset:1536
    v_mfma_f32_32x32x16_bf16 v[80:95], a[48:51], v[164:167], v[80:95]
    ds_read_b64 v[186:187], v198 offset:1600
    ds_read_b64 v[188:189], v196 offset:12288
    ds_read_b64 v[190:191], v196 offset:12800
    s_and_b32 s32, s32, 3
    s_mul_i32 s32, s32, 6144
    v_mfma_f32_32x32x16_bf16 v[96:111], a[48:51], v[168:171], v[96:111]
    ds_read_b64 v[192:193], v196 offset:12544
    ds_read_b64 v[194:195], v196 offset:13056
    v_add_u32 v201, s32, v199
    s_add_u32 s32, s24, 3
    s_waitcnt lgkmcnt(6)
    v_mfma_f32_16x16x32_bf16 v[112:115], a[52:55], v[172:175], v[112:115]
    ds_read_b64 v[160:161], v198 offset:1792
    v_mfma_f32_32x32x16_bf16 v[80:95], a[52:55], v[176:179], v[80:95]
    ds_read_b64 v[162:163], v198 offset:1856
    ds_read_b64 v[164:165], v196 offset:14336
    ds_read_b64 v[166:167], v196 offset:14848
    s_and_b32 s32, s32, 3
    s_mul_i32 s32, s32, 6144
    v_mfma_f32_32x32x16_bf16 v[96:111], a[52:55], v[180:183], v[96:111]
    ds_read_b64 v[168:169], v196 offset:14592
    ds_read_b64 v[170:171], v196 offset:15104
    v_add_u32 v202, s32, v199
    s_mul_i32 s32, s24, 6144
    s_waitcnt vmcnt(12)
    s_barrier
    s_waitcnt lgkmcnt(6)
    v_mfma_f32_16x16x32_bf16 v[112:115], a[56:59], v[184:187], v[112:115]
    v_add_u32 v198, v49, v198
    v_mfma_f32_32x32x16_bf16 v[80:95], a[56:59], v[188:191], v[80:95]
    v_add_u32 v196, 19584, v196
    ds_read_b64 v[172:173], v198 offset:0
    ds_read_b64 v[174:175], v198 offset:64
    ds_read_b64 v[176:177], v196 offset:0
    v_add_u32_e64 v204, s32, v199
    v_mfma_f32_32x32x16_bf16 v[96:111], a[56:59], v[192:195], v[96:111]
    ds_read_b64 v[178:179], v196 offset:512
    ds_read_b64 v[180:181], v196 offset:256
    ds_read_b64 v[182:183], v196 offset:768
    s_lshl_b32 s32, s24, 8
    s_waitcnt lgkmcnt(6)
    v_mfma_f32_16x16x32_bf16 v[112:115], a[60:63], v[160:163], v[112:115]
    ds_read_b64 v[184:185], v198 offset:256
    v_mfma_f32_32x32x16_bf16 v[80:95], a[60:63], v[164:167], v[80:95]
    ds_read_b64 v[186:187], v198 offset:320
    ds_read_b64 v[188:189], v196 offset:2048
    ds_read_b64 v[190:191], v196 offset:2560
    s_add_u32 s32, s32, 36352
    v_and_b32_e64 v214, 15, v1
    v_mfma_f32_32x32x16_bf16 v[96:111], a[60:63], v[168:171], v[96:111]
    ds_read_b64 v[192:193], v196 offset:2304
    ds_read_b64 v[194:195], v196 offset:2816
    v_lshl_add_u32 v206, v214, 4, s32
    v_lshrrev_b32 v215, 5, v1
    s_waitcnt lgkmcnt(6)
    v_mfma_f32_16x16x32_bf16 v[112:115], a[64:67], v[172:175], v[112:115]
    ds_read_b64 v[160:161], v198 offset:512
    v_mfma_f32_32x32x16_bf16 v[80:95], a[64:67], v[176:179], v[80:95]
    ds_read_b64 v[162:163], v198 offset:576
    ds_read_b64 v[164:165], v196 offset:4096
    ds_read_b64 v[166:167], v196 offset:4608
    v_lshl_add_u32 v205, v215, 10, v206
    v_bfe_u32 v215, v1, 4, 1
    v_mfma_f32_32x32x16_bf16 v[96:111], a[64:67], v[180:183], v[96:111]
    ds_read_b64 v[168:169], v196 offset:4352
    ds_read_b64 v[170:171], v196 offset:4864
    v_lshl_add_u32 v205, v215, 3, v205
    v_lshlrev_b32 v214, 2, v214
    s_waitcnt lgkmcnt(6)
    v_mfma_f32_16x16x32_bf16 v[112:115], a[68:71], v[184:187], v[112:115]
    ds_read_b64 v[172:173], v198 offset:768
    v_mfma_f32_32x32x16_bf16 v[80:95], a[68:71], v[188:191], v[80:95]
    ds_read_b64 v[174:175], v198 offset:832
    ds_read_b64 v[176:177], v196 offset:6144
    ds_read_b64 v[178:179], v196 offset:6656
    v_lshl_add_u32 v214, v215, 10, v214
    s_lshl_b32 s32, s24, 6
    v_mfma_f32_32x32x16_bf16 v[96:111], a[68:71], v[192:195], v[96:111]
    ds_read_b64 v[180:181], v196 offset:6400
    ds_read_b64 v[182:183], v196 offset:6912
    v_lshl_add_u32 v207, v215, 3, s32
    v_and_b32_e64 v215, 12, v1
    s_waitcnt lgkmcnt(6)
    v_mfma_f32_16x16x32_bf16 v[112:115], a[72:75], v[160:163], v[112:115]
    ds_read_b64 v[184:185], v198 offset:1024
    v_mfma_f32_32x32x16_bf16 v[80:95], a[72:75], v[164:167], v[80:95]
    ds_read_b64 v[186:187], v198 offset:1088
    ds_read_b64 v[188:189], v196 offset:8192
    ds_read_b64 v[190:191], v196 offset:8704
    v_lshl_add_u32 v207, v215, 2, v207
    v_and_b32_e64 v215, 2, v1
    v_mfma_f32_32x32x16_bf16 v[96:111], a[72:75], v[168:171], v[96:111]
    ds_read_b64 v[192:193], v196 offset:8448
    ds_read_b64 v[194:195], v196 offset:8960
    s_lshl_b32 s98, s72, 5
    s_add_u32 s98, s98, 256
    s_sub_u32 s95, s98, 4
    s_max_i32 s95, s95, 0
    s_lshl_b32 s94, s98, 3
    s_lshl_b32 s95, s95, 3
    s_add_u32 s94, s94, 3457024
    s_add_u32 s95, s95, 3457024
    s_add_u32 s96, s94, 8192
    buffer_load_dwordx2 v[152:153], v47, s[16:19], s94 offen sc1
    s_waitcnt lgkmcnt(6)
    v_mfma_f32_16x16x32_bf16 v[112:115], a[76:79], v[172:175], v[112:115]
    ds_read_b64 v[160:161], v198 offset:1280
    v_mfma_f32_32x32x16_bf16 v[80:95], a[76:79], v[176:179], v[80:95]
    ds_read_b64 v[162:163], v198 offset:1344
    ds_read_b64 v[164:165], v196 offset:10240
    ds_read_b64 v[166:167], v196 offset:10752
    v_lshl_add_u32 v207, v215, 1, v207
    v_add_u32 v207, 69120, v207
    v_mfma_f32_32x32x16_bf16 v[96:111], a[76:79], v[180:183], v[96:111]
    ds_read_b64 v[168:169], v196 offset:10496
    ds_read_b64 v[170:171], v196 offset:11008
    buffer_load_dwordx2 v[154:155], v47, s[16:19], s96 offen sc1
    v_lshrrev_b32 v215, 4, v1
    s_waitcnt lgkmcnt(6)
    v_mfma_f32_16x16x32_bf16 v[112:115], a[80:83], v[184:187], v[112:115]
    ds_read_b64 v[172:173], v198 offset:1536
    v_mfma_f32_32x32x16_bf16 v[80:95], a[80:83], v[188:191], v[80:95]
    ds_read_b64 v[174:175], v198 offset:1600
    ds_read_b64 v[176:177], v196 offset:12288
    ds_read_b64 v[178:179], v196 offset:12800
    v_lshl_add_u32 v206, v215, 2, v206
    v_mov_b32 v215, 0x3f803f80
    v_mfma_f32_32x32x16_bf16 v[96:111], a[80:83], v[192:195], v[96:111]
    ds_read_b64 v[180:181], v196 offset:12544
    ds_read_b64 v[182:183], v196 offset:13056
    buffer_load_dwordx2 v[156:157], v48, s[16:19], s95 offen sc1
    s_waitcnt lgkmcnt(6)
    v_mfma_f32_16x16x32_bf16 v[112:115], a[84:87], v[160:163], v[112:115]
    ds_read_b64 v[184:185], v198 offset:1792
    v_mfma_f32_32x32x16_bf16 v[80:95], a[84:87], v[164:167], v[80:95]
    ds_read_b64 v[186:187], v198 offset:1856
    ds_read_b64 v[188:189], v196 offset:14336
    ds_read_b64 v[190:191], v196 offset:14848
    v_mfma_f32_32x32x16_bf16 v[96:111], a[84:87], v[168:171], v[96:111]
    ds_read_b64 v[192:193], v196 offset:14592
    ds_read_b64 v[194:195], v196 offset:15104
    s_waitcnt vmcnt(8)
    s_barrier
    s_waitcnt lgkmcnt(6)
    v_mfma_f32_16x16x32_bf16 v[112:115], a[88:91], v[172:175], v[112:115]
    v_add_u32_e64 v198, v49, v198
    v_mfma_f32_32x32x16_bf16 v[80:95], a[88:91], v[176:179], v[80:95]
    v_add_u32 v196, 19584, v196
    ds_read_b64 v[160:161], v198 offset:0
    ds_read_b64 v[162:163], v198 offset:64
    ds_read_b64 v[164:165], v196 offset:0
    v_mfma_f32_32x32x16_bf16 v[96:111], a[88:91], v[180:183], v[96:111]
    ds_read_b64 v[166:167], v196 offset:512
    ds_read_b64 v[168:169], v196 offset:256
    ds_read_b64 v[170:171], v196 offset:768
    s_waitcnt lgkmcnt(6)
    v_mfma_f32_16x16x32_bf16 v[112:115], a[92:95], v[184:187], v[112:115]
    ds_read_b64 v[172:173], v198 offset:256
    v_mfma_f32_32x32x16_bf16 v[80:95], a[92:95], v[188:191], v[80:95]
    ds_read_b64 v[174:175], v198 offset:320
    ds_read_b64 v[176:177], v196 offset:2048
    ds_read_b64 v[178:179], v196 offset:2560
    v_mfma_f32_32x32x16_bf16 v[96:111], a[92:95], v[192:195], v[96:111]
    ds_read_b64 v[180:181], v196 offset:2304
    ds_read_b64 v[182:183], v196 offset:2816
    s_waitcnt lgkmcnt(6)
    v_mfma_f32_16x16x32_bf16 v[112:115], a[96:99], v[160:163], v[112:115]
    ds_read_b64 v[184:185], v198 offset:512
    v_mfma_f32_32x32x16_bf16 v[80:95], a[96:99], v[164:167], v[80:95]
    ds_read_b64 v[186:187], v198 offset:576
    ds_read_b64 v[188:189], v196 offset:4096
    ds_read_b64 v[190:191], v196 offset:4608
    v_mfma_f32_32x32x16_bf16 v[96:111], a[96:99], v[168:171], v[96:111]
    ds_read_b64 v[192:193], v196 offset:4352
    ds_read_b64 v[194:195], v196 offset:4864
    s_waitcnt lgkmcnt(6)
    v_mfma_f32_16x16x32_bf16 v[112:115], a[100:103], v[172:175], v[112:115]
    ds_read_b64 v[160:161], v198 offset:768
    v_mfma_f32_32x32x16_bf16 v[80:95], a[100:103], v[176:179], v[80:95]
    ds_read_b64 v[162:163], v198 offset:832
    ds_read_b64 v[164:165], v196 offset:6144
    ds_read_b64 v[166:167], v196 offset:6656
    v_mfma_f32_32x32x16_bf16 v[96:111], a[100:103], v[180:183], v[96:111]
    ds_read_b64 v[168:169], v196 offset:6400
    ds_read_b64 v[170:171], v196 offset:6912
    s_waitcnt lgkmcnt(6)
    v_mfma_f32_16x16x32_bf16 v[112:115], a[104:107], v[184:187], v[112:115]
    ds_read_b64 v[172:173], v198 offset:1024
    v_mfma_f32_32x32x16_bf16 v[80:95], a[104:107], v[188:191], v[80:95]
    ds_read_b64 v[174:175], v198 offset:1088
    ds_read_b64 v[176:177], v196 offset:8192
    ds_read_b64 v[178:179], v196 offset:8704
    v_mfma_f32_32x32x16_bf16 v[96:111], a[104:107], v[192:195], v[96:111]
    ds_read_b64 v[180:181], v196 offset:8448
    ds_read_b64 v[182:183], v196 offset:8960
    s_mov_b32 s96, 12058624
    buffer_load_dwordx4 v[216:219], v56, s[16:19], s96 offen offset:0 sc1
    s_waitcnt lgkmcnt(6)
    v_mfma_f32_16x16x32_bf16 v[112:115], a[108:111], v[160:163], v[112:115]
    ds_read_b64 v[184:185], v198 offset:1280
    v_mfma_f32_32x32x16_bf16 v[80:95], a[108:111], v[164:167], v[80:95]
    ds_read_b64 v[186:187], v198 offset:1344
    ds_read_b64 v[188:189], v196 offset:10240
    ds_read_b64 v[190:191], v196 offset:10752
    v_mfma_f32_32x32x16_bf16 v[96:111], a[108:111], v[168:171], v[96:111]
    ds_read_b64 v[192:193], v196 offset:10496
    ds_read_b64 v[194:195], v196 offset:11008
    buffer_load_dwordx4 v[220:223], v56, s[16:19], s96 offen offset:256 sc1
    s_waitcnt lgkmcnt(6)
    v_mfma_f32_16x16x32_bf16 v[112:115], a[112:115], v[172:175], v[112:115]
    ds_read_b64 v[160:161], v198 offset:1536
    v_mfma_f32_32x32x16_bf16 v[80:95], a[112:115], v[176:179], v[80:95]
    ds_read_b64 v[162:163], v198 offset:1600
    ds_read_b64 v[164:165], v196 offset:12288
    ds_read_b64 v[166:167], v196 offset:12800
    v_mfma_f32_32x32x16_bf16 v[96:111], a[112:115], v[180:183], v[96:111]
    ds_read_b64 v[168:169], v196 offset:12544
    ds_read_b64 v[170:171], v196 offset:13056
    s_mov_b32 s96, 12091392
    buffer_load_dwordx4 v[224:227], v56, s[16:19], s96 offen offset:0 sc1
    s_waitcnt lgkmcnt(6)
    v_mfma_f32_16x16x32_bf16 v[112:115], a[116:119], v[184:187], v[112:115]
    ds_read_b64 v[172:173], v198 offset:1792
    v_mfma_f32_32x32x16_bf16 v[80:95], a[116:119], v[188:191], v[80:95]
    ds_read_b64 v[174:175], v198 offset:1856
    ds_read_b64 v[176:177], v196 offset:14336
    ds_read_b64 v[178:179], v196 offset:14848
    v_mfma_f32_32x32x16_bf16 v[96:111], a[116:119], v[192:195], v[96:111]
    ds_read_b64 v[180:181], v196 offset:14592
    ds_read_b64 v[182:183], v196 offset:15104
    buffer_load_dwordx4 v[228:231], v56, s[16:19], s96 offen offset:256 sc1
sl_70:
    s_waitcnt vmcnt(5)
    v_max3_u32 v2, v152, v153, v154
    s_waitcnt vmcnt(4)
    v_max3_u32 v2, v2, v155, v156
    v_max_u32 v2, v2, v157
    v_cmp_eq_u32 vcc, -1, v2
    s_nop 0
    s_cbranch_vccnz rd_71
rc_72:
    s_barrier
    s_waitcnt lgkmcnt(6)
    v_mfma_f32_16x16x32_bf16 v[112:115], a[120:123], v[160:163], v[112:115]
    v_add_u32 v198, v49, v198
    v_mfma_f32_32x32x16_bf16 v[80:95], a[120:123], v[164:167], v[80:95]
    v_add_u32 v196, 19584, v196
    ds_read_b64 v[184:185], v198 offset:0
    ds_read_b64 v[186:187], v198 offset:64
    v_mul_f32 v148, v24, v157
    v_mul_f32 v149, v25, v157
    v_mfma_f32_32x32x16_bf16 v[96:111], a[120:123], v[168:171], v[96:111]
    ds_read_b64 v[188:189], v196 offset:0
    ds_read_b64 v[190:191], v196 offset:512
    s_mov_b32 s96, 12124160
    buffer_load_dwordx4 v[232:235], v56, s[16:19], s96 offen offset:0 sc1
    v_mul_f32 v150, v26, v157
    v_mul_f32_e64 v151, v27, v157
    s_waitcnt lgkmcnt(4)
    v_mfma_f32_16x16x32_bf16 v[112:115], a[124:127], v[172:175], v[112:115]
    ds_read_b64 v[192:193], v198 offset:256
    v_mfma_f32_32x32x16_bf16 v[80:95], a[124:127], v[176:179], v[80:95]
    ds_read_b64 v[194:195], v198 offset:320
    ds_read_b64 v[160:161], v196 offset:2048
    v_mul_f32 v116, v8, v153
    v_mul_f32 v117, v9, v153
    v_mul_f32_e64 v118, v10, v153
    v_mfma_f32_32x32x16_bf16 v[96:111], a[124:127], v[180:183], v[96:111]
    ds_read_b64 v[162:163], v196 offset:2560
    buffer_load_dwordx4 v[236:239], v56, s[16:19], s96 offen offset:256 sc1
    v_mul_f32 v119, v11, v153
    v_mul_f32_e64 v120, v12, v153
    s_waitcnt lgkmcnt(4)
    v_mfma_f32_16x16x32_bf16 v[112:115], a[128:131], v[184:187], v[112:115]
    ds_read_b64 v[164:165], v198 offset:512
    v_mfma_f32_32x32x16_bf16 v[80:95], a[128:131], v[188:191], v[80:95]
    ds_read_b64 v[166:167], v198 offset:576
    ds_read_b64 v[168:169], v196 offset:4096
    ds_read_b64 v[170:171], v196 offset:4608
    v_mul_f32 v121, v13, v153
    v_mul_f32_e64 v122, v14, v153
    s_waitcnt lgkmcnt(4)
    v_mfma_f32_16x16x32_bf16 v[112:115], a[132:135], v[192:195], v[112:115]
    ds_read_b64 v[172:173], v198 offset:768
    v_mfma_f32_32x32x16_bf16 v[80:95], a[132:135], v[160:163], v[80:95]
    ds_read_b64 v[174:175], v198 offset:832
    ds_read_b64 v[176:177], v196 offset:6144
    ds_read_b64 v[178:179], v196 offset:6656
    s_mov_b32 s96, 12156928
    buffer_load_dwordx4 v[240:243], v56, s[16:19], s96 offen offset:0 sc1
    v_mul_f32 v123, v15, v153
    v_mul_f32_e64 v124, v16, v153
    s_waitcnt lgkmcnt(4)
    v_mfma_f32_16x16x32_bf16 v[112:115], a[136:139], v[164:167], v[112:115]
    ds_read_b64 v[180:181], v198 offset:1024
    v_mfma_f32_32x32x16_bf16 v[80:95], a[136:139], v[168:171], v[80:95]
    ds_read_b64 v[182:183], v198 offset:1088
    ds_read_b64 v[184:185], v196 offset:8192
    ds_read_b64 v[186:187], v196 offset:8704
    v_mul_f32 v125, v17, v153
    v_mul_f32_e64 v126, v18, v153
    s_waitcnt lgkmcnt(4)
    v_mfma_f32_16x16x32_bf16 v[112:115], a[140:143], v[172:175], v[112:115]
    ds_read_b64 v[188:189], v198 offset:1280
    v_mfma_f32_32x32x16_bf16 v[80:95], a[140:143], v[176:179], v[80:95]
    ds_read_b64 v[190:191], v198 offset:1344
    ds_read_b64 v[192:193], v196 offset:10240
    ds_read_b64 v[194:195], v196 offset:10752
    buffer_load_dwordx4 v[244:247], v56, s[16:19], s96 offen offset:256 sc1
    v_mul_f32 v127, v19, v153
    v_mul_f32_e64 v128, v20, v153
    s_waitcnt lgkmcnt(4)
    v_mfma_f32_16x16x32_bf16 v[112:115], a[144:147], v[180:183], v[112:115]
    ds_read_b64 v[160:161], v198 offset:1536
    v_mfma_f32_32x32x16_bf16 v[80:95], a[144:147], v[184:187], v[80:95]
    ds_read_b64 v[162:163], v198 offset:1600
    ds_read_b64 v[164:165], v196 offset:12288
    ds_read_b64 v[166:167], v196 offset:12800
    v_mul_f32 v129, v21, v153
    v_mul_f32_e64 v130, v22, v153
    s_waitcnt lgkmcnt(4)
    v_mfma_f32_16x16x32_bf16 v[112:115], a[148:151], v[188:191], v[112:115]
    ds_read_b64 v[168:169], v198 offset:1792
    v_mfma_f32_32x32x16_bf16 v[80:95], a[148:151], v[192:195], v[80:95]
    ds_read_b64 v[170:171], v198 offset:1856
    ds_read_b64 v[172:173], v196 offset:14336
    ds_read_b64 v[174:175], v196 offset:14848
    s_mov_b32 s96, 12058624
    buffer_load_dwordx2 v[248:249], v57, s[16:19], s96 offen offset:0 sc1
    v_mul_f32 v131, v23, v153
    v_mul_f32_e64 v132, v8, v155
    s_waitcnt lgkmcnt(4)
    v_mfma_f32_16x16x32_bf16 v[112:115], a[152:155], v[160:163], v[112:115]
    ds_read_b64 v[176:177], v196 offset:256
    v_mfma_f32_32x32x16_bf16 v[80:95], a[152:155], v[164:167], v[80:95]
    ds_read_b64 v[178:179], v196 offset:768
    ds_read_b64 v[180:181], v196 offset:2304
    ds_read_b64 v[182:183], v196 offset:2816
    v_mul_f32 v133, v9, v155
    v_mul_f32_e64 v134, v10, v155
    s_waitcnt lgkmcnt(4)
    v_mfma_f32_16x16x32_bf16 v[112:115], a[156:159], v[168:171], v[112:115]
    ds_read_b64 v[184:185], v196 offset:4352
    v_mfma_f32_32x32x16_bf16 v[80:95], a[156:159], v[172:175], v[80:95]
    ds_read_b64 v[186:187], v196 offset:4864
    ds_read_b64 v[188:189], v196 offset:6400
    ds_read_b64 v[190:191], v196 offset:6912
    buffer_load_dwordx2 v[252:253], v57, s[16:19], s96 offen offset:128 sc1
    v_mul_f32 v135, v11, v155
    v_mul_f32 v136, v12, v155
    v_mul_f32 v137, v13, v155
    v_mul_f32 v138, v14, v155
    v_mul_f32 v139, v15, v155
    v_mul_f32 v140, v16, v155
    v_mul_f32 v141, v17, v155
    v_mul_f32 v142, v18, v155
    v_mul_f32 v143, v19, v155
    v_mul_f32 v144, v20, v155
    v_mul_f32 v145, v21, v155
    v_mul_f32 v146, v22, v155
    v_mul_f32 v147, v23, v155
    s_waitcnt lgkmcnt(4)
    v_mfma_f32_32x32x16_bf16 v[96:111], a[128:131], v[176:179], v[96:111]
    ds_read_b64 v[192:193], v196 offset:8448
    ds_read_b64 v[194:195], v196 offset:8960
    v_mfma_f32_32x32x16_bf16 v[96:111], a[132:135], v[180:183], v[96:111]
    ds_read_b64 v[160:161], v196 offset:10496
    ds_read_b64 v[162:163], v196 offset:11008
    s_mov_b32 s96, 12075008
    buffer_load_dwordx2 v[250:251], v57, s[16:19], s96 offen offset:0 sc1
    v_fma_f32 v112, v112, v156, v148
    v_fma_f32 v113, v113, v156, v149
    s_waitcnt lgkmcnt(4)
    v_mfma_f32_32x32x16_bf16 v[96:111], a[136:139], v[184:187], v[96:111]
    ds_read_b64 v[164:165], v196 offset:12544
    ds_read_b64 v[166:167], v196 offset:13056
    v_fma_f32 v114, v114, v156, v150
    v_fma_f32 v115, v115, v156, v151
    v_cvt_pk_bf16_f32 v112, v112, v113
    v_mfma_f32_32x32x16_bf16 v[96:111], a[140:143], v[188:191], v[96:111]
    ds_read_b64 v[168:169], v196 offset:14592
    ds_read_b64 v[170:171], v196 offset:15104
    buffer_load_dwordx2 v[254:255], v57, s[16:19], s96 offen offset:128 sc1
    v_cvt_pk_bf16_f32 v113, v114, v115
    v_fma_f32 v80, v80, v152, v116
    s_waitcnt lgkmcnt(4)
    v_mfma_f32_32x32x16_bf16 v[96:111], a[144:147], v[192:195], v[96:111]
    v_fma_f32 v81, v81, v152, v117
    v_fma_f32 v82, v82, v152, v118
    v_fma_f32 v83, v83, v152, v119
    v_cvt_pk_bf16_f32 v80, v80, v81
    v_cvt_pk_bf16_f32 v81, v82, v83
    v_mfma_f32_32x32x16_bf16 v[96:111], a[148:151], v[160:163], v[96:111]
    ds_write_b64 v40, v[112:113] offset:0
    ds_write_b64 v38, v[80:81] offset:0
    v_fma_f32 v84, v84, v152, v120
    v_fma_f32 v85, v85, v152, v121
    s_waitcnt lgkmcnt(2)
    v_mfma_f32_32x32x16_bf16 v[96:111], a[152:155], v[164:167], v[96:111]
    v_fma_f32 v86, v86, v152, v122
    v_fma_f32 v87, v87, v152, v123
    v_cvt_pk_bf16_f32 v84, v84, v85
    v_cvt_pk_bf16_f32 v85, v86, v87
    v_fma_f32 v88, v88, v152, v124
    v_mfma_f32_32x32x16_bf16 v[96:111], a[156:159], v[168:171], v[96:111]
    s_mov_b32 s96, 9437184
    buffer_load_dwordx4 v[208:211], v59, s[16:19], s96 offen sc1
    v_fma_f32 v89, v89, v152, v125
    v_fma_f32 v90, v90, v152, v126
    v_fma_f32 v91, v91, v152, v127
    v_cvt_pk_bf16_f32 v88, v88, v89
    v_cvt_pk_bf16_f32 v89, v90, v91
    ds_write_b64 v38, v[84:85] offset:6400
    ds_write_b64 v38, v[88:89] offset:12800
    v_fma_f32 v92, v92, v152, v128
    v_fma_f32 v93, v93, v152, v129
    v_fma_f32 v94, v94, v152, v130
    v_fma_f32 v95, v95, v152, v131
    v_cvt_pk_bf16_f32 v92, v92, v93
    v_cvt_pk_bf16_f32 v93, v94, v95
    ds_write_b64 v39, v[92:93] offset:0
    v_pk_fma_f32 v[96:97], v[96:97], v[154:155], v[132:133] op_sel_hi:[1,0,1]
    v_pk_fma_f32 v[98:99], v[98:99], v[154:155], v[134:135] op_sel_hi:[1,0,1]
    v_cvt_pk_bf16_f32 v96, v96, v97
    v_cvt_pk_bf16_f32 v97, v98, v99
    v_pk_fma_f32 v[100:101], v[100:101], v[154:155], v[136:137] op_sel_hi:[1,0,1]
    v_pk_fma_f32 v[102:103], v[102:103], v[154:155], v[138:139] op_sel_hi:[1,0,1]
    v_cvt_pk_bf16_f32 v100, v100, v101
    v_cvt_pk_bf16_f32 v101, v102, v103
    ds_write_b64 v38, v[96:97] offset:1600
    ds_write_b64 v38, v[100:101] offset:8000
    v_pk_fma_f32 v[104:105], v[104:105], v[154:155], v[140:141] op_sel_hi:[1,0,1]
    v_pk_fma_f32 v[106:107], v[106:107], v[154:155], v[142:143] op_sel_hi:[1,0,1]
    v_cvt_pk_bf16_f32 v104, v104, v105
    v_cvt_pk_bf16_f32 v105, v106, v107
    v_pk_fma_f32 v[108:109], v[108:109], v[154:155], v[144:145] op_sel_hi:[1,0,1]
    v_pk_fma_f32 v[110:111], v[110:111], v[154:155], v[146:147] op_sel_hi:[1,0,1]
    v_cvt_pk_bf16_f32 v108, v108, v109
    v_cvt_pk_bf16_f32 v109, v110, v111
    ds_write_b64 v38, v[104:105] offset:14400
    ds_write_b64 v39, v[108:109] offset:1600
    v_cmp_u_f32 vcc, v82, v114
    v_cmp_u_f32 s[82:83], v98, v98
    s_lshl_b32 s25, s24, 2
    s_add_u32 s25, s25, 160256
    s_or_b64 vcc, vcc, s[82:83]
    s_cselect_b32 s26, 1, 0
    v_mov_b32 v196, s25
    v_mov_b32 v197, s26
    ds_write_b32 v196, v197
    s_waitcnt lgkmcnt(0)
    s_barrier
    v_mov_b32 v158, 160256
    ds_read_b128 v[128:131], v158
    v_mov_b32 v94, 0
    v_mov_b32 v95, 0
    v_mov_b32 v98, 0
    v_mov_b32_e64 v99, 0
    s_mov_b64 exec, 0xffff
    ds_read_b64 v[94:95], v42 offset:320
    ds_read_b64 v[98:99], v42 offset:640
    s_mov_b64 exec, -1
    s_nop 0
    ds_read_b64 v[92:93], v41 offset:320
    ds_read_b64 v[96:97], v41 offset:640
    ds_read_b64 v[84:85], v41 offset:6720
    ds_read_b64 v[86:87], v42 offset:6720
    ds_read_b64 v[80:81], v41 offset:6400
    ds_read_b64 v[82:83], v42 offset:6400
    ds_read_b64 v[88:89], v41 offset:7040
    ds_read_b64 v[90:91], v42 offset:7040
    ds_read_b64_tr_b16 v[106:107], v44 offset:0
    ds_read_b64_tr_b16 v[100:101], v43 offset:0
    s_add_u32 s97, s36, 9437184
    buffer_load_dword v212, v61, s[16:19], s97 offen sc1
    ds_read_b64_tr_b16 v[108:109], v44 offset:320
    ds_read_b64_tr_b16 v[102:103], v43 offset:320
    ds_read_b64_tr_b16 v[110:111], v44 offset:640
    ds_read_b64_tr_b16 v[104:105], v43 offset:640
    s_mov_b32 s82, 0x3ea52b5c
    s_lshl_b32 s25, s98, 4
    s_add_u32 s25, s25, 12058624
    s_lshl_b32 s26, s98, 3
    s_add_u32 s26, s26, 12058624
    s_waitcnt lgkmcnt(15)
    v_or3_b32 v128, v128, v129, v130
    v_or_b32 v128, v128, v131
    v_cmp_ne_u32 vcc, 0, v128
    s_nop 0
    s_cbranch_vccnz rd_73
rc_74:
    s_waitcnt lgkmcnt(10)
    v_mfma_f32_16x16x32_bf16 v[116:119], v[84:87], v[92:95], v[28:31]
    v_mfma_f32_16x16x32_bf16 v[120:123], v[84:87], v[96:99], v[32:35]
    s_waitcnt lgkmcnt(8)
    v_mfma_f32_16x16x32_bf16 v[112:115], v[80:83], v[92:95], v[32:35]
    s_waitcnt lgkmcnt(6)
    v_mfma_f32_16x16x32_bf16 v[124:127], v[88:91], v[96:99], v[28:31]
    s_nop 5
    v_max_f32 v112, v112, v116
    v_max_f32 v113, v113, v117
    v_max_f32 v114, v114, v118
    v_max_f32 v115, v115, v119
    v_max3_f32 v156, v112, v113, v114
    v_max_f32 v156, v156, v115
    v_max_f32 v120, v120, v124
    v_max_f32 v121, v121, v125
    v_max_f32 v122, v122, v126
    v_max_f32 v123, v123, v127
    v_max3_f32 v157, v120, v121, v122
    v_max_f32 v157, v157, v123
    s_nop 1
    v_permlane16_swap_b32 v156, v157
    v_max_f32 v156, v156, v157
    v_mov_b32 v157, v156
    s_nop 1
    v_permlane32_swap_b32 v156, v157
    v_max_f32 v156, v156, v157
    v_mul_f32 v156, s82, v156
    v_mov_b32 v157, v156
    s_nop 1
    v_permlane16_swap_b32 v156, v157
    v_fma_f32 v112, v112, s82, -v156
    v_fma_f32 v113, v113, s82, -v156
    v_fma_f32 v114, v114, s82, -v156
    v_fma_f32 v115, v115, s82, -v156
    v_exp_f32 v112, v112
    v_exp_f32 v113, v113
    v_exp_f32 v114, v114
    v_exp_f32 v115, v115
    v_cvt_pk_bf16_f32 v116, v112, v113
    v_cvt_pk_bf16_f32 v117, v114, v115
    v_bfi_b32 v128, v36, 0, v116
    v_and_b32 v130, v36, v116
    v_bfi_b32 v129, v37, 0, v117
    v_and_b32 v131, v37, v117
    s_waitcnt lgkmcnt(3)
    s_nop 0
    v_mfma_f32_16x16x32_bf16 v[144:147], v[106:109], v[128:131], 0
    s_waitcnt lgkmcnt(2)
    v_mfma_f32_16x16x32_bf16 v[136:139], v[100:103], v[128:131], 0
    v_fma_f32 v120, v120, s82, -v157
    v_fma_f32 v121, v121, s82, -v157
    v_fma_f32 v122, v122, s82, -v157
    v_fma_f32 v123, v123, s82, -v157
    v_exp_f32 v120, v120
    v_exp_f32 v121, v121
    v_exp_f32 v122, v122
    v_exp_f32_e64 v123, v123
    v_cvt_pk_bf16_f32 v124, v120, v121
    v_cvt_pk_bf16_f32 v125, v122, v123
    v_bfi_b32 v132, v36, 0, v124
    v_and_b32 v134, v36, v124
    v_bfi_b32 v133, v37, 0, v125
    v_and_b32 v135, v37, v125
    s_waitcnt lgkmcnt(1)
    s_nop 0
    v_mfma_f32_16x16x32_bf16 v[148:151], v[108:111], v[132:135], 0
    s_waitcnt lgkmcnt(0)
    v_mfma_f32_16x16x32_bf16 v[140:143], v[102:105], v[132:135], 0
    v_mov_b32 v158, v144
    s_nop 1
    v_permlane16_swap_b32 v144, v158
    v_rcp_f32 v158, v158
    s_nop 0
    v_pk_mul_f32 v[136:137], v[136:137], v[158:159] op_sel_hi:[1,0]
    v_pk_mul_f32 v[138:139], v[138:139], v[158:159] op_sel_hi:[1,0]
    v_pk_mul_f32 v[144:145], v[144:145], v[158:159] op_sel_hi:[1,0]
    v_pk_mul_f32 v[146:147], v[146:147], v[158:159] op_sel_hi:[1,0]
    v_cvt_pk_bf16_f32 v112, v136, v137
    v_cvt_pk_bf16_f32 v116, v144, v145
    v_cvt_pk_bf16_f32 v113, v138, v139
    v_cvt_pk_bf16_f32 v117, v146, v147
    v_mov_b32 v160, v148
    s_nop 1
    v_permlane16_swap_b32 v148, v160
    v_rcp_f32_e64 v160, v160
    s_nop 0
    v_pk_mul_f32 v[140:141], v[140:141], v[160:161] op_sel_hi:[1,0]
    v_pk_mul_f32 v[142:143], v[142:143], v[160:161] op_sel_hi:[1,0]
    v_pk_mul_f32 v[148:149], v[148:149], v[160:161] op_sel_hi:[1,0]
    v_pk_mul_f32 v[150:151], v[150:151], v[160:161] op_sel_hi:[1,0]
    v_cvt_pk_bf16_f32 v114, v140, v141
    v_cvt_pk_bf16_f32 v118, v148, v149
    v_cvt_pk_bf16_f32 v115, v142, v143
    v_cvt_pk_bf16_f32 v119, v150, v151
    v_permlane16_swap_b32 v112, v114
    v_permlane16_swap_b32 v113, v115
    v_permlane16_swap_b32 v116, v118
    v_permlane16_swap_b32 v117, v119
    buffer_store_dwordx4 v[112:115], v45, s[16:19], s25 offen sc1
    s_mov_b64 exec, s[80:81]
    buffer_store_dwordx2 v[116:117], v46, s[16:19], s26 offen sc1
    s_mov_b64 exec, -1
oe_75:
    s_waitcnt vmcnt(15)
    v_mfma_f32_16x16x32_bf16 v[112:115], a[176:179], v[216:219], 0
    v_mov_b32 v136, 0
    v_mov_b32 v137, 0
    s_waitcnt vmcnt(14)
    v_mfma_f32_16x16x32_bf16 v[116:119], a[176:179], v[220:223], 0
    v_mov_b32 v138, 0
    v_mov_b32 v139, 0
    s_waitcnt vmcnt(13)
    v_mfma_f32_16x16x32_bf16 v[112:115], a[196:199], v[224:227], v[112:115]
    v_mov_b32 v140, 0
    v_mov_b32 v141, 0
    s_waitcnt vmcnt(12)
    v_mfma_f32_16x16x32_bf16 v[116:119], a[196:199], v[228:231], v[116:119]
    s_mov_b32 s25, 14680064
    s_add_u32 s26, s36, 14680064
    s_waitcnt vmcnt(11)
    v_mfma_f32_16x16x32_bf16 v[112:115], a[216:219], v[232:235], v[112:115]
    s_add_u32 s27, s35, 3506176
    s_mov_b32 s28, 0x99999999
    s_waitcnt vmcnt(10)
    v_mfma_f32_16x16x32_bf16 v[116:119], a[216:219], v[236:239], v[116:119]
    s_mov_b32 s29, 0x99999999
    s_waitcnt vmcnt(9)
    v_mfma_f32_16x16x32_bf16 v[112:115], a[236:239], v[240:243], v[112:115]
    s_waitcnt vmcnt(8)
    v_mfma_f32_16x16x32_bf16 v[116:119], a[236:239], v[244:247], v[116:119]
    s_waitcnt vmcnt(5)
    v_mfma_f32_16x16x32_bf16 v[112:115], v[52:55], v[248:251], v[112:115]
    s_waitcnt vmcnt(4)
    v_mfma_f32_16x16x32_bf16 v[116:119], v[52:55], v[252:255], v[116:119]
    v_mfma_f32_16x16x32_bf16 v[88:91], a[164:167], v[216:219], 0
    v_mfma_f32_16x16x32_bf16 v[92:95], a[164:167], v[220:223], 0
    v_mfma_f32_16x16x32_bf16 v[88:91], a[184:187], v[224:227], v[88:91]
    s_waitcnt vmcnt(3)
    v_max3_u32 v132, v208, v209, v210
    s_waitcnt vmcnt(2)
    v_max3_u32 v132, v132, v211, v212
    v_mfma_f32_16x16x32_bf16 v[92:95], a[184:187], v[228:231], v[92:95]
    v_cmp_eq_u32 s[82:83], -1, v132
    v_mfma_f32_16x16x32_bf16 v[88:91], a[204:207], v[232:235], v[88:91]
    v_mfma_f32_16x16x32_bf16 v[92:95], a[204:207], v[236:239], v[92:95]
    v_cmp_u_f32 vcc, v112, v116
    s_nop 0
    s_or_b64 vcc, vcc, s[82:83]
    s_cbranch_vccnz rd_76
rc_77:
    v_mfma_f32_16x16x32_bf16 v[88:91], a[224:227], v[240:243], v[88:91]
    ds_write_b128 v203, v[112:115] offset:24576
    v_mfma_f32_16x16x32_bf16 v[92:95], a[224:227], v[244:247], v[92:95]
    v_mfma_f32_16x16x32_bf16 v[88:91], a[244:247], v[248:251], v[88:91]
    ds_write_b128 v203, v[116:119] offset:25600
    v_mfma_f32_16x16x32_bf16 v[92:95], a[244:247], v[252:255], v[92:95]
    v_mfma_f32_16x16x32_bf16 v[96:99], a[168:171], v[216:219], 0
    v_lshlrev_b32_e64 v120, 16, v208
    v_and_b32 v121, 0xffff0000, v208
    v_mfma_f32_16x16x32_bf16 v[100:103], a[168:171], v[220:223], 0
    v_lshlrev_b32_e64 v122, 16, v209
    v_and_b32 v123, 0xffff0000, v209
    v_mfma_f32_16x16x32_bf16 v[96:99], a[188:191], v[224:227], v[96:99]
    v_lshlrev_b32_e64 v124, 16, v210
    v_and_b32 v125, 0xffff0000, v210
    v_mfma_f32_16x16x32_bf16 v[100:103], a[188:191], v[228:231], v[100:103]
    v_lshlrev_b32_e64 v126, 16, v211
    v_and_b32 v127, 0xffff0000, v211
    v_mfma_f32_16x16x32_bf16 v[96:99], a[208:211], v[232:235], v[96:99]
    v_lshlrev_b32_e64 v128, 16, v212
    v_and_b32 v129, 0xffff0000, v212
    v_mfma_f32_16x16x32_bf16 v[100:103], a[208:211], v[236:239], v[100:103]
    v_mfma_f32_16x16x32_bf16 v[96:99], a[228:231], v[240:243], v[96:99]
    ds_write_b128 v200, v[88:91] offset:0
    v_mfma_f32_16x16x32_bf16 v[100:103], a[228:231], v[244:247], v[100:103]
    v_mfma_f32_16x16x32_bf16 v[96:99], a[248:251], v[248:251], v[96:99]
    ds_write_b128 v200, v[92:95] offset:1024
    v_mfma_f32_16x16x32_bf16 v[100:103], a[248:251], v[252:255], v[100:103]
    v_mfma_f32_16x16x32_bf16 v[104:107], a[172:175], v[216:219], 0
    v_mfma_f32_16x16x32_bf16 v[108:111], a[172:175], v[220:223], 0
    v_mfma_f32_16x16x32_bf16 v[104:107], a[192:195], v[224:227], v[104:107]
    v_mfma_f32_16x16x32_bf16 v[108:111], a[192:195], v[228:231], v[108:111]
    v_mfma_f32_16x16x32_bf16 v[104:107], a[212:215], v[232:235], v[104:107]
    v_mfma_f32_16x16x32_bf16 v[108:111], a[212:215], v[236:239], v[108:111]
    v_mfma_f32_16x16x32_bf16 v[104:107], a[232:235], v[240:243], v[104:107]
    ds_write_b128 v201, v[96:99] offset:2048
    v_mfma_f32_16x16x32_bf16 v[108:111], a[232:235], v[244:247], v[108:111]
    v_mfma_f32_16x16x32_bf16 v[104:107], a[252:255], v[248:251], v[104:107]
    ds_write_b128 v201, v[100:103] offset:3072
    v_mfma_f32_16x16x32_bf16 v[108:111], a[252:255], v[252:255], v[108:111]
    v_mfma_f32_16x16x32_bf16 v[80:83], a[160:163], v[216:219], v[120:123]
    v_mfma_f32_16x16x32_bf16 v[84:87], a[160:163], v[220:223], v[124:127]
    v_mfma_f32_16x16x32_bf16 v[80:83], a[180:183], v[224:227], v[80:83]
    v_mfma_f32_16x16x32_bf16 v[84:87], a[180:183], v[228:231], v[84:87]
    v_mfma_f32_16x16x32_bf16 v[80:83], a[200:203], v[232:235], v[80:83]
    s_nop 0
    ds_write_b128 v202, v[104:107] offset:4096
    v_mfma_f32_16x16x32_bf16 v[84:87], a[200:203], v[236:239], v[84:87]
    ds_write_b128 v202, v[108:111] offset:5120
    v_mfma_f32_16x16x32_bf16 v[80:83], a[220:223], v[240:243], v[80:83]
    v_mfma_f32_16x16x32_bf16 v[84:87], a[220:223], v[244:247], v[84:87]
    v_mfma_f32_16x16x32_bf16 v[80:83], a[240:243], v[248:251], v[80:83]
    v_mfma_f32_16x16x32_bf16 v[84:87], a[240:243], v[252:255], v[84:87]
    s_waitcnt lgkmcnt(0)
    s_barrier
    s_nop 0
    ds_read_b128 v[88:91], v204 offset:0
    ds_read_b128 v[92:95], v204 offset:1024
    ds_read_b128 v[96:99], v204 offset:2048
    ds_read_b128 v[100:103], v204 offset:3072
    ds_read_b128 v[104:107], v204 offset:4096
    ds_read_b128 v[108:111], v204 offset:5120
    ds_read_b64 v[112:113], v205 offset:24576
    ds_read_b64 v[114:115], v205 offset:26624
    ds_read_b64 v[116:117], v205 offset:28672
    ds_read_b64 v[118:119], v205 offset:30720
    s_mov_b32 s96, 12062720
    buffer_load_dwordx4 v[216:219], v56, s[16:19], s96 offen offset:0 sc1
    buffer_load_dwordx4 v[220:223], v56, s[16:19], s96 offen offset:256 sc1
    s_mov_b32 s96, 12095488
    buffer_load_dwordx4 v[224:227], v56, s[16:19], s96 offen offset:0 sc1
    buffer_load_dwordx4 v[228:231], v56, s[16:19], s96 offen offset:256 sc1
    s_mov_b32 s96, 12128256
    buffer_load_dwordx4 v[232:235], v56, s[16:19], s96 offen offset:0 sc1
    buffer_load_dwordx4 v[236:239], v56, s[16:19], s96 offen offset:256 sc1
    s_waitcnt lgkmcnt(9)
    v_pk_add_f32 v[80:81], v[80:81], v[88:89]
    v_pk_add_f32 v[82:83], v[82:83], v[90:91]
    s_waitcnt lgkmcnt(8)
    v_pk_add_f32 v[84:85], v[84:85], v[92:93]
    v_pk_add_f32 v[86:87], v[86:87], v[94:95]
    s_waitcnt lgkmcnt(7)
    v_pk_add_f32 v[80:81], v[80:81], v[96:97]
    v_pk_add_f32 v[82:83], v[82:83], v[98:99]
    s_waitcnt lgkmcnt(6)
    v_pk_add_f32 v[84:85], v[84:85], v[100:101]
    v_pk_add_f32 v[86:87], v[86:87], v[102:103]
    s_waitcnt lgkmcnt(5)
    v_pk_add_f32 v[80:81], v[80:81], v[104:105]
    v_pk_add_f32 v[82:83], v[82:83], v[106:107]
    s_waitcnt lgkmcnt(4)
    v_pk_add_f32 v[84:85], v[84:85], v[108:109]
    v_pk_add_f32 v[86:87], v[86:87], v[110:111]
    v_cvt_pk_bf16_f32 v132, v80, v81
    v_cvt_pk_bf16_f32 v133, v82, v83
    v_cvt_pk_bf16_f32 v134, v84, v85
    v_cvt_pk_bf16_f32 v135, v86, v87
    s_waitcnt lgkmcnt(3)
    v_pk_add_f32 v[128:129], v[128:129], v[112:113]
    s_waitcnt lgkmcnt(2)
    v_pk_add_f32 v[128:129], v[128:129], v[114:115]
    s_waitcnt lgkmcnt(1)
    v_pk_add_f32 v[128:129], v[128:129], v[116:117]
    s_waitcnt lgkmcnt(0)
    v_pk_add_f32 v[128:129], v[128:129], v[118:119]
    v_cvt_pk_bf16_f32 v130, v128, v129
    buffer_store_dwordx4 v[132:135], v59, s[16:19], s25 offen sc1
    buffer_store_dword v130, v61, s[16:19], s26 offen sc1
    v_dot2c_f32_bf16 v136, v132, v215
    v_dot2c_f32_bf16 v137, v132, v132
    v_dot2c_f32_bf16 v136, v133, v215
    v_dot2c_f32_bf16 v137, v133, v133
    v_dot2c_f32_bf16 v138, v134, v215
    v_dot2c_f32_bf16 v139, v134, v134
    v_dot2c_f32_bf16 v138, v135, v215
    v_dot2c_f32_bf16 v139, v135, v135
    v_dot2c_f32_bf16 v140, v130, v215
    v_dot2c_f32_bf16 v141, v130, v130
    v_permlane32_swap_b32 v136, v138
    v_permlane32_swap_b32 v137, v139
    v_pk_add_f32 v[136:137], v[136:137], v[138:139]
    v_pk_add_f32 v[136:137], v[136:137], v[140:141]
    s_nop 1
    v_permlane16_swap_b32 v136, v137
    v_add_f32_e64 v136, v136, v137
    ds_write_b32 v206, v136 offset:32768
    s_mov_b32 s96, 12161024
    buffer_load_dwordx4 v[240:243], v56, s[16:19], s96 offen offset:0 sc1
    buffer_load_dwordx4 v[244:247], v56, s[16:19], s96 offen offset:256 sc1
    s_mov_b32 s96, 12060672
    buffer_load_dwordx2 v[248:249], v57, s[16:19], s96 offen offset:0 sc1
    buffer_load_dwordx2 v[252:253], v57, s[16:19], s96 offen offset:128 sc1
    s_mov_b32 s96, 12077056
    buffer_load_dwordx2 v[250:251], v57, s[16:19], s96 offen offset:0 sc1
    buffer_load_dwordx2 v[254:255], v57, s[16:19], s96 offen offset:128 sc1
    s_mov_b32 s96, 9439232
    buffer_load_dwordx4 v[208:211], v59, s[16:19], s96 offen sc1
    s_add_u32 s97, s36, 9439232
    buffer_load_dword v212, v61, s[16:19], s97 offen sc1
    s_waitcnt lgkmcnt(0)
    s_barrier
    ds_read2st64_b32 v[136:137], v207 offset0:0 offset1:1
    ds_read2st64_b32 v[138:139], v207 offset0:2 offset1:3
    ds_read_b64_tr_b16 v[144:145], v65 offset:32
    ds_read_b64_tr_b16 v[146:147], v65 offset:0
    ds_read_b64_tr_b16 v[148:149], v65 offset:160
    ds_read_b64_tr_b16 v[150:151], v65 offset:128
    ds_read_b64_tr_b16 v[152:153], v65 offset:288
    ds_read_b64_tr_b16 v[154:155], v65 offset:256
    ds_read_b64_tr_b16 v[156:157], v65 offset:416
    ds_read_b64_tr_b16 v[158:159], v65 offset:384
    ds_read_b64_tr_b16 v[160:161], v65 offset:544
    ds_read_b64_tr_b16 v[162:163], v65 offset:512
    ds_read_b64_tr_b16 v[164:165], v65 offset:672
    ds_read_b64_tr_b16 v[166:167], v65 offset:640
    ds_read_b64_tr_b16 v[168:169], v65 offset:800
    ds_read_b64_tr_b16 v[170:171], v65 offset:768
    ds_read_b64_tr_b16 v[172:173], v65 offset:928
    ds_read_b64_tr_b16 v[174:175], v65 offset:896
    s_waitcnt lgkmcnt(15)
    v_pk_add_f32 v[136:137], v[136:137], v[138:139]
    v_add_f32 v136, v136, v137
    v_cndmask_b32 v136, v136, 1.0, s[28:29]
    s_mov_b64 exec, s[80:81]
    buffer_atomic_add_f32 v136, v214, s[16:19], s27 offen
    s_mov_b64 exec, -1
    v_lshrrev_b32 v176, 4, v0
    v_mul_u32_u24 v176, 1216, v176
    v_and_b32 v177, 15, v0
    v_lshl_add_u32 v176, v177, 3, v176
    v_add_u32 v176, 64, v176
    v_mov_b32 v178, 0
    v_mov_b32 v179, 0
    ds_write_b64 v176, v[178:179]
    v_mov_b32 v70, 0
    v_mov_b32 v71, 0
    v_mov_b32 v72, 0
oe_78:
    s_waitcnt vmcnt(16)
    v_mfma_f32_16x16x32_bf16 v[112:115], a[176:179], v[216:219], 0
    v_mov_b32 v136, 0
    v_mov_b32 v137, 0
    s_waitcnt vmcnt(15)
    v_mfma_f32_16x16x32_bf16 v[116:119], a[176:179], v[220:223], 0
    v_mov_b32 v138, 0
    v_mov_b32 v139, 0
    s_waitcnt vmcnt(14)
    v_mfma_f32_16x16x32_bf16 v[112:115], a[196:199], v[224:227], v[112:115]
    v_mov_b32 v140, 0
    v_mov_b32 v141, 0
    s_waitcnt vmcnt(13)
    v_mfma_f32_16x16x32_bf16 v[116:119], a[196:199], v[228:231], v[116:119]
    s_mov_b32 s25, 14682112
    s_add_u32 s26, s36, 14682112
    s_waitcnt vmcnt(12)
    v_mfma_f32_16x16x32_bf16 v[112:115], a[216:219], v[232:235], v[112:115]
    s_add_u32 s27, s35, 3510272
    s_mov_b32 s28, 0x99999999
    s_waitcnt vmcnt(11)
    v_mfma_f32_16x16x32_bf16 v[116:119], a[216:219], v[236:239], v[116:119]
    s_mov_b32 s29, 0x99999999
    s_waitcnt vmcnt(8)
    v_mfma_f32_16x16x32_bf16 v[112:115], a[236:239], v[240:243], v[112:115]
    s_waitcnt vmcnt(7)
    v_mfma_f32_16x16x32_bf16 v[116:119], a[236:239], v[244:247], v[116:119]
    s_waitcnt vmcnt(4)
    v_mfma_f32_16x16x32_bf16 v[112:115], v[52:55], v[248:251], v[112:115]
    s_waitcnt vmcnt(3)
    v_mfma_f32_16x16x32_bf16 v[116:119], v[52:55], v[252:255], v[116:119]
    v_mfma_f32_16x16x32_bf16 v[88:91], a[164:167], v[216:219], 0
    v_mfma_f32_16x16x32_bf16 v[92:95], a[164:167], v[220:223], 0
    v_mfma_f32_16x16x32_bf16 v[88:91], a[184:187], v[224:227], v[88:91]
    s_waitcnt vmcnt(2)
    v_max3_u32 v132, v208, v209, v210
    s_waitcnt vmcnt(1)
    v_max3_u32 v132, v132, v211, v212
    v_mfma_f32_16x16x32_bf16 v[92:95], a[184:187], v[228:231], v[92:95]
    v_cmp_eq_u32 s[82:83], -1, v132
    v_mfma_f32_16x16x32_bf16 v[88:91], a[204:207], v[232:235], v[88:91]
    v_mfma_f32_16x16x32_bf16 v[92:95], a[204:207], v[236:239], v[92:95]
    v_cmp_u_f32 vcc, v112, v116
    s_nop 0
    s_or_b64 vcc, vcc, s[82:83]
    s_cbranch_vccnz rd_79
rc_80:
    v_mfma_f32_16x16x32_bf16 v[88:91], a[224:227], v[240:243], v[88:91]
    ds_write_b128 v203, v[112:115] offset:24576
    v_mfma_f32_16x16x32_bf16 v[92:95], a[224:227], v[244:247], v[92:95]
    v_mfma_f32_16x16x32_bf16 v[88:91], a[244:247], v[248:251], v[88:91]
    ds_write_b128 v203, v[116:119] offset:25600
    v_mfma_f32_16x16x32_bf16 v[92:95], a[244:247], v[252:255], v[92:95]
    v_mfma_f32_16x16x32_bf16 v[96:99], a[168:171], v[216:219], 0
    v_lshlrev_b32_e64 v120, 16, v208
    v_and_b32 v121, 0xffff0000, v208
    v_mfma_f32_16x16x32_bf16 v[100:103], a[168:171], v[220:223], 0
    v_lshlrev_b32_e64 v122, 16, v209
    v_and_b32 v123, 0xffff0000, v209
    v_mfma_f32_16x16x32_bf16 v[96:99], a[188:191], v[224:227], v[96:99]
    v_lshlrev_b32_e64 v124, 16, v210
    v_and_b32 v125, 0xffff0000, v210
    v_mfma_f32_16x16x32_bf16 v[100:103], a[188:191], v[228:231], v[100:103]
    v_lshlrev_b32_e64 v126, 16, v211
    v_and_b32 v127, 0xffff0000, v211
    v_mfma_f32_16x16x32_bf16 v[96:99], a[208:211], v[232:235], v[96:99]
    v_lshlrev_b32_e64 v128, 16, v212
    v_and_b32 v129, 0xffff0000, v212
    v_mfma_f32_16x16x32_bf16 v[100:103], a[208:211], v[236:239], v[100:103]
    v_mfma_f32_16x16x32_bf16 v[96:99], a[228:231], v[240:243], v[96:99]
    ds_write_b128 v200, v[88:91] offset:0
    v_mfma_f32_16x16x32_bf16 v[100:103], a[228:231], v[244:247], v[100:103]
    v_mfma_f32_16x16x32_bf16 v[96:99], a[248:251], v[248:251], v[96:99]
    ds_write_b128 v200, v[92:95] offset:1024
    v_mfma_f32_16x16x32_bf16 v[100:103], a[248:251], v[252:255], v[100:103]
    v_mfma_f32_16x16x32_bf16 v[104:107], a[172:175], v[216:219], 0
    v_mfma_f32_16x16x32_bf16 v[108:111], a[172:175], v[220:223], 0
    v_mfma_f32_16x16x32_bf16 v[104:107], a[192:195], v[224:227], v[104:107]
    v_mfma_f32_16x16x32_bf16 v[108:111], a[192:195], v[228:231], v[108:111]
    v_mfma_f32_16x16x32_bf16 v[104:107], a[212:215], v[232:235], v[104:107]
    v_mfma_f32_16x16x32_bf16 v[108:111], a[212:215], v[236:239], v[108:111]
    v_mfma_f32_16x16x32_bf16 v[104:107], a[232:235], v[240:243], v[104:107]
    ds_write_b128 v201, v[96:99] offset:2048
    v_mfma_f32_16x16x32_bf16 v[108:111], a[232:235], v[244:247], v[108:111]
    v_mfma_f32_16x16x32_bf16 v[104:107], a[252:255], v[248:251], v[104:107]
    ds_write_b128 v201, v[100:103] offset:3072
    v_mfma_f32_16x16x32_bf16 v[108:111], a[252:255], v[252:255], v[108:111]
    v_mfma_f32_16x16x32_bf16 v[80:83], a[160:163], v[216:219], v[120:123]
    v_mfma_f32_16x16x32_bf16 v[84:87], a[160:163], v[220:223], v[124:127]
    v_mfma_f32_16x16x32_bf16 v[80:83], a[180:183], v[224:227], v[80:83]
    v_mfma_f32_16x16x32_bf16 v[84:87], a[180:183], v[228:231], v[84:87]
    v_mfma_f32_16x16x32_bf16 v[80:83], a[200:203], v[232:235], v[80:83]
    s_nop 0
    ds_write_b128 v202, v[104:107] offset:4096
    v_mfma_f32_16x16x32_bf16 v[84:87], a[200:203], v[236:239], v[84:87]
    ds_write_b128 v202, v[108:111] offset:5120
    v_mfma_f32_16x16x32_bf16 v[80:83], a[220:223], v[240:243], v[80:83]
    v_mfma_f32_16x16x32_bf16 v[84:87], a[220:223], v[244:247], v[84:87]
    v_mfma_f32_16x16x32_bf16 v[80:83], a[240:243], v[248:251], v[80:83]
    v_mfma_f32_16x16x32_bf16 v[84:87], a[240:243], v[252:255], v[84:87]
    s_waitcnt lgkmcnt(0)
    s_barrier
    s_nop 0
    ds_read_b128 v[88:91], v204 offset:0
    ds_read_b128 v[92:95], v204 offset:1024
    ds_read_b128 v[96:99], v204 offset:2048
    ds_read_b128 v[100:103], v204 offset:3072
    ds_read_b128 v[104:107], v204 offset:4096
    ds_read_b128 v[108:111], v204 offset:5120
    ds_read_b64 v[112:113], v205 offset:24576
    ds_read_b64 v[114:115], v205 offset:26624
    ds_read_b64 v[116:117], v205 offset:28672
    ds_read_b64 v[118:119], v205 offset:30720
    s_lshl_b32 s96, s75, 14
    s_add_u32 s96, s96, 14680064
    s_lshl_b32 s97, s24, 12
    s_add_u32 s97, s97, 3506176
    buffer_load_dwordx4 v[176:179], v62, s[16:19], s96 offen offset:0 sc1
    buffer_load_dwordx4 v[180:183], v62, s[16:19], s96 offen offset:1024 sc1
    buffer_load_dwordx4 v[184:187], v62, s[16:19], s97 offen offset:0 sc1
    buffer_load_dwordx4 v[188:191], v62, s[16:19], s97 offen offset:1024 sc1
    buffer_load_dwordx4 v[192:195], v62, s[16:19], s97 offen offset:2048 sc1
    buffer_load_dwordx4 v[196:199], v62, s[16:19], s97 offen offset:3072 sc1
    s_waitcnt lgkmcnt(9)
    v_pk_add_f32 v[80:81], v[80:81], v[88:89]
    v_pk_add_f32 v[82:83], v[82:83], v[90:91]
    s_waitcnt lgkmcnt(8)
    v_pk_add_f32 v[84:85], v[84:85], v[92:93]
    v_pk_add_f32 v[86:87], v[86:87], v[94:95]
    s_waitcnt lgkmcnt(7)
    v_pk_add_f32 v[80:81], v[80:81], v[96:97]
    v_pk_add_f32 v[82:83], v[82:83], v[98:99]
    s_waitcnt lgkmcnt(6)
    v_pk_add_f32 v[84:85], v[84:85], v[100:101]
    v_pk_add_f32 v[86:87], v[86:87], v[102:103]
    s_waitcnt lgkmcnt(5)
    v_pk_add_f32 v[80:81], v[80:81], v[104:105]
    v_pk_add_f32 v[82:83], v[82:83], v[106:107]
    s_waitcnt lgkmcnt(4)
    v_pk_add_f32 v[84:85], v[84:85], v[108:109]
    v_pk_add_f32 v[86:87], v[86:87], v[110:111]
    v_cvt_pk_bf16_f32 v132, v80, v81
    v_cvt_pk_bf16_f32 v133, v82, v83
    v_cvt_pk_bf16_f32 v134, v84, v85
    v_cvt_pk_bf16_f32 v135, v86, v87
    s_waitcnt lgkmcnt(3)
    v_pk_add_f32 v[128:129], v[128:129], v[112:113]
    s_waitcnt lgkmcnt(2)
    v_pk_add_f32 v[128:129], v[128:129], v[114:115]
    s_waitcnt lgkmcnt(1)
    v_pk_add_f32 v[128:129], v[128:129], v[116:117]
    s_waitcnt lgkmcnt(0)
    v_pk_add_f32 v[128:129], v[128:129], v[118:119]
    v_cvt_pk_bf16_f32 v130, v128, v129
    buffer_store_dwordx4 v[132:135], v59, s[16:19], s25 offen sc1
    buffer_store_dword v130, v61, s[16:19], s26 offen sc1
    v_dot2c_f32_bf16 v136, v132, v215
    v_dot2c_f32_bf16 v137, v132, v132
    v_dot2c_f32_bf16 v136, v133, v215
    v_dot2c_f32_bf16 v137, v133, v133
    v_dot2c_f32_bf16 v138, v134, v215
    v_dot2c_f32_bf16 v139, v134, v134
    v_dot2c_f32_bf16 v138, v135, v215
    v_dot2c_f32_bf16 v139, v135, v135
    v_dot2c_f32_bf16 v140, v130, v215
    v_dot2c_f32_bf16 v141, v130, v130
    v_permlane32_swap_b32 v136, v138
    v_permlane32_swap_b32 v137, v139
    v_pk_add_f32 v[136:137], v[136:137], v[138:139]
    v_pk_add_f32 v[136:137], v[136:137], v[140:141]
    s_nop 1
    v_permlane16_swap_b32 v136, v137
    v_add_f32 v136, v136, v137
    ds_write_b32 v206, v136 offset:32768
    s_waitcnt lgkmcnt(0)
    s_barrier
    ds_read2st64_b32 v[136:137], v207 offset0:0 offset1:1
    ds_read2st64_b32 v[138:139], v207 offset0:2 offset1:3
    s_waitcnt lgkmcnt(0)
    v_pk_add_f32 v[136:137], v[136:137], v[138:139]
    v_add_f32 v136, v136, v137
    v_cndmask_b32 v136, v136, 1.0, s[28:29]
    s_mov_b64 exec, s[80:81]
    buffer_atomic_add_f32 v136, v214, s[16:19], s27 offen
    s_mov_b64 exec, -1
    s_cmp_ge_u32 s2, 160
    s_cbranch_scc1 nc_81
    s_waitcnt vmcnt(3)
ce_83:
    v_max3_u32 v208, v176, v177, v178
    v_max3_u32 v208, v208, v179, v180
    v_max3_u32 v208, v208, v181, v182
    v_max_u32 v208, v208, v183
    v_cmp_eq_u32 s[82:83], -1, v208
    v_min3_f32 v209, v184, v187, v188
    v_min3_f32 v209, v209, v191, v192
    v_min3_f32 v209, v209, v195, v196
    v_min_f32 v209, v209, v199
    v_cmp_neq_f32 vcc, 0x41000000, v209
    s_nop 0
    s_or_b64 vcc, vcc, s[82:83]
    s_cbranch_vccnz rd_84
rc_85:
    v_mul_f32 v208, 0x3acccccd, v185
    v_mul_f32 v209, 0x3acccccd, v189
    v_mul_f32 v186, 0x3acccccd, v186
    v_mul_f32 v190, 0x3acccccd, v190
    v_fma_f32 v186, -v208, v208, v186
    v_fma_f32 v190, -v209, v209, v190
    v_max_f32 v186, 0, v186
    v_max_f32 v190, 0, v190
    v_add_f32 v186, 0x3727c5ac, v186
    v_add_f32 v190, 0x3727c5ac, v190
    v_rsq_f32 v185, v186
    v_rsq_f32 v189, v190
    v_mul_f32 v186, -v208, v185
    v_mul_f32 v190, -v209, v189
    v_lshlrev_b32 v80, 16, v176
    v_and_b32 v82, 0xffff0000, v176
    v_lshlrev_b32 v84, 16, v177
    v_and_b32 v86, 0xffff0000, v177
    v_lshlrev_b32 v81, 16, v178
    v_and_b32 v83, 0xffff0000, v178
    v_lshlrev_b32 v85, 16, v179
    v_and_b32 v87, 0xffff0000, v179
    v_fma_f32 v208, v80, v185, v186
    v_fma_f32 v209, v81, v189, v190
    v_cvt_pk_bf16_f32 v176, v208, v209
    v_fma_f32 v208, v82, v185, v186
    v_fma_f32 v209, v83, v189, v190
    v_cvt_pk_bf16_f32 v177, v208, v209
    v_fma_f32 v208, v84, v185, v186
    v_fma_f32 v209, v85, v189, v190
    v_cvt_pk_bf16_f32 v178, v208, v209
    v_fma_f32 v208, v86, v185, v186
    v_fma_f32 v209, v87, v189, v190
    v_cvt_pk_bf16_f32 v179, v208, v209
    ds_write_b32 v63, v176 offset:0
    ds_write_b32 v63, v177 offset:4864
    ds_write_b32 v63, v178 offset:9728
    ds_write_b32 v63, v179 offset:14592
    v_mul_f32 v208, 0x3acccccd, v193
    v_mul_f32 v209, 0x3acccccd, v197
    v_mul_f32 v194, 0x3acccccd, v194
    v_mul_f32 v198, 0x3acccccd, v198
    v_fma_f32 v194, -v208, v208, v194
    v_fma_f32 v198, -v209, v209, v198
    v_max_f32 v194, 0, v194
    v_max_f32 v198, 0, v198
    v_add_f32 v194, 0x3727c5ac, v194
    v_add_f32 v198, 0x3727c5ac, v198
    v_rsq_f32 v193, v194
    v_rsq_f32 v197, v198
    v_mul_f32 v194, -v208, v193
    v_mul_f32 v198, -v209, v197
    v_lshlrev_b32 v88, 16, v180
    v_and_b32 v90, 0xffff0000, v180
    v_lshlrev_b32 v92, 16, v181
    v_and_b32 v94, 0xffff0000, v181
    v_lshlrev_b32 v89, 16, v182
    v_and_b32 v91, 0xffff0000, v182
    v_lshlrev_b32 v93, 16, v183
    v_and_b32 v95, 0xffff0000, v183
    v_fma_f32 v208, v88, v193, v194
    v_fma_f32 v209, v89, v197, v198
    v_cvt_pk_bf16_f32 v180, v208, v209
    v_fma_f32 v208, v90, v193, v194
    v_fma_f32 v209, v91, v197, v198
    v_cvt_pk_bf16_f32 v181, v208, v209
    v_fma_f32 v208, v92, v193, v194
    v_fma_f32 v209, v93, v197, v198
    v_cvt_pk_bf16_f32 v182, v208, v209
    v_fma_f32 v208, v94, v193, v194
    v_fma_f32 v209, v95, v197, v198
    v_cvt_pk_bf16_f32 v183, v208, v209
    ds_write_b32 v63, v180 offset:256
    ds_write_b32 v63, v181 offset:5120
    ds_write_b32 v63, v182 offset:9984
    ds_write_b32 v63, v183 offset:14848
    s_waitcnt lgkmcnt(0)
    s_barrier
    ds_read_b128 v[212:215], v64 offset:96
    ds_read_b128 v[216:219], v64 offset:64
    ds_read_b128 v[220:223], v64 offset:32
    ds_read_b128 v[224:227], v64 offset:0
    s_waitcnt lgkmcnt(3)
    v_mfma_f32_32x32x16_bf16 v[96:111], v[212:215], v[144:147], 0
    ds_read_b128 v[228:231], v64 offset:224
    ds_read_b64_tr_b16 v[176:177], v65 offset:1056
    ds_read_b64_tr_b16 v[178:179], v65 offset:1024
    ds_read_b64_tr_b16 v[180:181], v65 offset:1184
    ds_read_b64_tr_b16 v[182:183], v65 offset:1152
    s_waitcnt lgkmcnt(7)
    v_mfma_f32_32x32x16_bf16 v[96:111], v[216:219], v[148:151], v[96:111]
    ds_read_b128 v[232:235], v64 offset:192
    ds_read_b64_tr_b16 v[184:185], v65 offset:1312
    ds_read_b64_tr_b16 v[186:187], v65 offset:1280
    ds_read_b64_tr_b16 v[188:189], v65 offset:1440
    ds_read_b64_tr_b16 v[190:191], v65 offset:1408
    s_waitcnt lgkmcnt(11)
    v_mfma_f32_32x32x16_bf16 v[96:111], v[220:223], v[152:155], v[96:111]
    ds_read_b128 v[236:239], v64 offset:160
    ds_read_b64_tr_b16 v[192:193], v65 offset:1568
    ds_read_b64_tr_b16 v[194:195], v65 offset:1536
    ds_read_b64_tr_b16 v[196:197], v65 offset:1696
    ds_read_b64_tr_b16 v[198:199], v65 offset:1664
    s_waitcnt lgkmcnt(15)
    v_mfma_f32_32x32x16_bf16 v[96:111], v[224:227], v[156:159], v[96:111]
    ds_read_b128 v[240:243], v64 offset:128
    ds_read_b64_tr_b16 v[200:201], v65 offset:1824
    ds_read_b64_tr_b16 v[202:203], v65 offset:1792
    ds_read_b64_tr_b16 v[204:205], v65 offset:1952
    ds_read_b64_tr_b16 v[206:207], v65 offset:1920
    s_waitcnt lgkmcnt(15)
    v_mfma_f32_32x32x16_bf16 v[112:127], v[228:231], v[144:147], 0
    s_nop 4
    s_waitcnt lgkmcnt(14)
    v_mfma_f32_32x32x16_bf16 v[112:127], v[232:235], v[148:151], v[112:127]
    v_cndmask_b32 v208, v99, v72, s[76:77]
    v_cndmask_b32 v209, v103, v99, s[76:77]
    v_cndmask_b32 v210, v107, v103, s[76:77]
    v_cndmask_b32 v211, v111, v107, s[76:77]
    v_mov_b32_e64 v72, v111
    s_waitcnt lgkmcnt(9)
    v_mfma_f32_32x32x16_bf16 v[112:127], v[236:239], v[152:155], v[112:127]
    v_add_f32_dpp v98, v208, v98 wave_ror:1 row_mask:0xf bank_mask:0xf
    v_add_f32_dpp v102, v209, v102 wave_ror:1 row_mask:0xf bank_mask:0xf
    v_add_f32_dpp v106, v210, v106 wave_ror:1 row_mask:0xf bank_mask:0xf
    v_add_f32_dpp v110, v211, v110 wave_ror:1 row_mask:0xf bank_mask:0xf
    v_cndmask_b32 v208, v98, v71, s[76:77]
    s_waitcnt lgkmcnt(4)
    v_mfma_f32_32x32x16_bf16 v[112:127], v[240:243], v[156:159], v[112:127]
    v_cndmask_b32 v209, v102, v98, s[76:77]
    v_cndmask_b32 v210, v106, v102, s[76:77]
    v_cndmask_b32 v211, v110, v106, s[76:77]
    v_mov_b32 v71, v110
    v_add_f32_dpp v97, v208, v97 wave_ror:1 row_mask:0xf bank_mask:0xf
    v_add_f32_dpp v101, v209, v101 wave_ror:1 row_mask:0xf bank_mask:0xf
    v_mfma_f32_32x32x16_bf16 v[112:127], v[212:215], v[160:163], v[112:127]
    ds_read_b128 v[244:247], v64 offset:352
    v_add_f32_dpp v105, v210, v105 wave_ror:1 row_mask:0xf bank_mask:0xf
    v_add_f32_dpp v109, v211, v109 wave_ror:1 row_mask:0xf bank_mask:0xf
    v_cndmask_b32 v208, v97, v70, s[76:77]
    v_cndmask_b32 v209, v101, v97, s[76:77]
    v_cndmask_b32 v210, v105, v101, s[76:77]
    v_mfma_f32_32x32x16_bf16 v[112:127], v[216:219], v[164:167], v[112:127]
    ds_read_b128 v[216:219], v64 offset:320
    v_cndmask_b32 v211, v109, v105, s[76:77]
    v_mov_b32_e64 v70, v109
    v_add_f32_dpp v96, v208, v96 wave_ror:1 row_mask:0xf bank_mask:0xf
    v_add_f32_dpp v100, v209, v100 wave_ror:1 row_mask:0xf bank_mask:0xf
    v_add_f32_dpp v104, v210, v104 wave_ror:1 row_mask:0xf bank_mask:0xf
    v_mfma_f32_32x32x16_bf16 v[112:127], v[220:223], v[168:171], v[112:127]
    ds_read_b128 v[220:223], v64 offset:288
    v_add_f32_dpp v108, v211, v108 wave_ror:1 row_mask:0xf bank_mask:0xf
    ds_write_b32 v66, v96 offset:0
    v_mfma_f32_32x32x16_bf16 v[112:127], v[224:227], v[172:175], v[112:127]
    ds_read_b128 v[224:227], v64 offset:256
    ds_write_b32 v66, v100 offset:64
    ds_write_b32 v66, v104 offset:128
    s_waitcnt lgkmcnt(6)
    v_mfma_f32_32x32x16_bf16 v[128:143], v[244:247], v[144:147], 0
    ds_write_b32 v66, v108 offset:192
    s_nop 2
    s_waitcnt lgkmcnt(6)
    v_mfma_f32_32x32x16_bf16 v[128:143], v[216:219], v[148:151], v[128:143]
    s_nop 2
    v_cndmask_b32 v208, v115, v72, s[76:77]
    v_cndmask_b32 v209, v119, v115, s[76:77]
    s_waitcnt lgkmcnt(5)
    v_mfma_f32_32x32x16_bf16 v[128:143], v[220:223], v[152:155], v[128:143]
    v_cndmask_b32 v210, v123, v119, s[76:77]
    v_cndmask_b32 v211, v127, v123, s[76:77]
    v_mov_b32 v72, v127
    v_add_f32_dpp v114, v208, v114 wave_ror:1 row_mask:0xf bank_mask:0xf
    v_add_f32_dpp v118, v209, v118 wave_ror:1 row_mask:0xf bank_mask:0xf
    s_waitcnt lgkmcnt(3)
    v_mfma_f32_32x32x16_bf16 v[128:143], v[224:227], v[156:159], v[128:143]
    v_add_f32_dpp v122, v210, v122 wave_ror:1 row_mask:0xf bank_mask:0xf
    v_add_f32_dpp v126, v211, v126 wave_ror:1 row_mask:0xf bank_mask:0xf
    v_cndmask_b32 v208, v114, v71, s[76:77]
    v_cndmask_b32 v209, v118, v114, s[76:77]
    v_cndmask_b32 v210, v122, v118, s[76:77]
    v_cndmask_b32 v211, v126, v122, s[76:77]
    v_mfma_f32_32x32x16_bf16 v[128:143], v[228:231], v[160:163], v[128:143]
    v_mov_b32 v71, v126
    v_add_f32_dpp v113, v208, v113 wave_ror:1 row_mask:0xf bank_mask:0xf
    v_add_f32_dpp v117, v209, v117 wave_ror:1 row_mask:0xf bank_mask:0xf
    v_add_f32_dpp v121, v210, v121 wave_ror:1 row_mask:0xf bank_mask:0xf
    v_add_f32_dpp v125, v211, v125 wave_ror:1 row_mask:0xf bank_mask:0xf
    v_cndmask_b32 v208, v113, v70, s[76:77]
    v_mfma_f32_32x32x16_bf16 v[128:143], v[232:235], v[164:167], v[128:143]
    ds_read_b128 v[232:235], v64 offset:64
    v_cndmask_b32 v209, v117, v113, s[76:77]
    v_cndmask_b32 v210, v121, v117, s[76:77]
    v_cndmask_b32 v211, v125, v121, s[76:77]
    v_mov_b32_e64 v70, v125
    v_add_f32_dpp v112, v208, v112 wave_ror:1 row_mask:0xf bank_mask:0xf
    v_mfma_f32_32x32x16_bf16 v[128:143], v[236:239], v[168:171], v[128:143]
    ds_read_b128 v[236:239], v64 offset:32
    v_add_f32_dpp v116, v209, v116 wave_ror:1 row_mask:0xf bank_mask:0xf
    v_add_f32_dpp v120, v210, v120 wave_ror:1 row_mask:0xf bank_mask:0xf
    v_add_f32_dpp v124, v211, v124 wave_ror:1 row_mask:0xf bank_mask:0xf
    v_mfma_f32_32x32x16_bf16 v[128:143], v[240:243], v[172:175], v[128:143]
    ds_read_b128 v[240:243], v64 offset:0
    ds_write_b32 v66, v112 offset:256
    ds_write_b32 v66, v116 offset:320
    v_mfma_f32_32x32x16_bf16 v[128:143], v[212:215], v[176:179], v[128:143]
    ds_read_b128 v[212:215], v64 offset:480
    ds_write_b32 v66, v120 offset:384
    ds_write_b32 v66, v124 offset:448
    s_waitcnt lgkmcnt(7)
    v_mfma_f32_32x32x16_bf16 v[128:143], v[232:235], v[180:183], v[128:143]
    ds_read_b128 v[232:235], v64 offset:448
    s_waitcnt lgkmcnt(7)
    v_mfma_f32_32x32x16_bf16 v[128:143], v[236:239], v[184:187], v[128:143]
    ds_read_b128 v[236:239], v64 offset:416
    s_waitcnt lgkmcnt(7)
    v_mfma_f32_32x32x16_bf16 v[128:143], v[240:243], v[188:191], v[128:143]
    ds_read_b128 v[240:243], v64 offset:384
    s_nop 3
    s_waitcnt lgkmcnt(5)
    v_mfma_f32_32x32x16_bf16 v[112:127], v[212:215], v[144:147], 0
    s_nop 4
    s_waitcnt lgkmcnt(2)
    v_mfma_f32_32x32x16_bf16 v[112:127], v[232:235], v[148:151], v[112:127]
    v_cndmask_b32 v208, v131, v72, s[76:77]
    v_cndmask_b32 v209, v135, v131, s[76:77]
    v_cndmask_b32 v210, v139, v135, s[76:77]
    v_cndmask_b32 v211, v143, v139, s[76:77]
    v_mov_b32_e64 v72, v143
    s_waitcnt lgkmcnt(1)
    v_mfma_f32_32x32x16_bf16 v[112:127], v[236:239], v[152:155], v[112:127]
    v_add_f32_dpp v130, v208, v130 wave_ror:1 row_mask:0xf bank_mask:0xf
    v_add_f32_dpp v134, v209, v134 wave_ror:1 row_mask:0xf bank_mask:0xf
    v_add_f32_dpp v138, v210, v138 wave_ror:1 row_mask:0xf bank_mask:0xf
    v_add_f32_dpp v142, v211, v142 wave_ror:1 row_mask:0xf bank_mask:0xf
    v_cndmask_b32 v208, v130, v71, s[76:77]
    s_waitcnt lgkmcnt(0)
    v_mfma_f32_32x32x16_bf16 v[112:127], v[240:243], v[156:159], v[112:127]
    v_cndmask_b32 v209, v134, v130, s[76:77]
    v_cndmask_b32 v210, v138, v134, s[76:77]
    v_cndmask_b32 v211, v142, v138, s[76:77]
    v_mov_b32 v71, v142
    v_add_f32_dpp v129, v208, v129 wave_ror:1 row_mask:0xf bank_mask:0xf
    v_add_f32_dpp v133, v209, v133 wave_ror:1 row_mask:0xf bank_mask:0xf
    v_mfma_f32_32x32x16_bf16 v[112:127], v[244:247], v[160:163], v[112:127]
    v_add_f32_dpp v137, v210, v137 wave_ror:1 row_mask:0xf bank_mask:0xf
    v_add_f32_dpp v141, v211, v141 wave_ror:1 row_mask:0xf bank_mask:0xf
    v_cndmask_b32 v208, v129, v70, s[76:77]
    v_cndmask_b32 v209, v133, v129, s[76:77]
    v_cndmask_b32 v210, v137, v133, s[76:77]
    v_cndmask_b32 v211, v141, v137, s[76:77]
    v_mfma_f32_32x32x16_bf16 v[112:127], v[216:219], v[164:167], v[112:127]
    ds_read_b128 v[240:243], v64 offset:192
    v_mov_b32_e64 v70, v141
    v_add_f32_dpp v128, v208, v128 wave_ror:1 row_mask:0xf bank_mask:0xf
    v_add_f32_dpp v132, v209, v132 wave_ror:1 row_mask:0xf bank_mask:0xf
    v_add_f32_dpp v136, v210, v136 wave_ror:1 row_mask:0xf bank_mask:0xf
    v_add_f32_dpp v140, v211, v140 wave_ror:1 row_mask:0xf bank_mask:0xf
    v_mfma_f32_32x32x16_bf16 v[112:127], v[220:223], v[168:171], v[112:127]
    ds_read_b128 v[220:223], v64 offset:160
    ds_write_b32 v66, v128 offset:512
    ds_write_b32 v66, v132 offset:576
    v_mfma_f32_32x32x16_bf16 v[112:127], v[224:227], v[172:175], v[112:127]
    ds_read_b128 v[224:227], v64 offset:128
    ds_write_b32 v66, v136 offset:640
    ds_write_b32 v66, v140 offset:704
    v_mfma_f32_32x32x16_bf16 v[112:127], v[228:231], v[176:179], v[112:127]
    ds_read_b128 v[236:239], v64 offset:96
    s_waitcnt lgkmcnt(7)
    v_mfma_f32_32x32x16_bf16 v[112:127], v[240:243], v[180:183], v[112:127]
    ds_read_b128 v[240:243], v64 offset:64
    s_waitcnt lgkmcnt(7)
    v_mfma_f32_32x32x16_bf16 v[112:127], v[220:223], v[184:187], v[112:127]
    ds_read_b128 v[220:223], v64 offset:32
    s_waitcnt lgkmcnt(5)
    v_mfma_f32_32x32x16_bf16 v[112:127], v[224:227], v[188:191], v[112:127]
    ds_read_b128 v[224:227], v64 offset:0
    s_waitcnt lgkmcnt(3)
    v_mfma_f32_32x32x16_bf16 v[112:127], v[236:239], v[192:195], v[112:127]
    ds_read_b64_tr_b16 v[216:217], v65 offset:544
    ds_read_b64_tr_b16 v[218:219], v65 offset:512
    s_waitcnt lgkmcnt(4)
    v_mfma_f32_32x32x16_bf16 v[112:127], v[240:243], v[196:199], v[112:127]
    ds_read_b64_tr_b16 v[240:241], v65 offset:1056
    ds_read_b64_tr_b16 v[242:243], v65 offset:1024
    s_waitcnt lgkmcnt(5)
    v_mfma_f32_32x32x16_bf16 v[112:127], v[220:223], v[200:203], v[112:127]
    s_waitcnt lgkmcnt(4)
    v_mfma_f32_32x32x16_bf16 v[112:127], v[224:227], v[204:207], v[112:127]
    ds_read_b64_tr_b16 v[224:225], v65 offset:1568
    ds_read_b64_tr_b16 v[226:227], v65 offset:1536
    s_lshl_b32 s96, s75, 14
    s_add_u32 s96, s96, 14680064
    s_lshl_b32 s97, s24, 12
    s_add_u32 s97, s97, 3510272
    buffer_load_dwordx4 v[248:251], v62, s[16:19], s96 offen offset:2048 sc1
    s_waitcnt lgkmcnt(4)
    v_mfma_f32_32x32x16_bf16 v[144:159], v[212:215], v[216:219], 0
    s_nop 3
    v_cndmask_b32 v208, v115, v72, s[76:77]
    s_waitcnt lgkmcnt(2)
    v_mfma_f32_32x32x16_bf16 v[144:159], v[244:247], v[240:243], v[144:159]
    buffer_load_dwordx4 v[252:255], v62, s[16:19], s96 offen offset:3072 sc1
    v_cndmask_b32 v209, v119, v115, s[76:77]
    v_cndmask_b32 v210, v123, v119, s[76:77]
    v_cndmask_b32 v211, v127, v123, s[76:77]
    v_mov_b32_e64 v72, v127
    v_add_f32_dpp v114, v208, v114 wave_ror:1 row_mask:0xf bank_mask:0xf
    v_mfma_f32_32x32x16_bf16 v[160:175], v[212:215], v[240:243], 0
    ds_read_b64_tr_b16 v[216:217], v65 offset:2080
    ds_read_b64_tr_b16 v[218:219], v65 offset:2048
    v_add_f32_dpp v118, v209, v118 wave_ror:1 row_mask:0xf bank_mask:0xf
    v_add_f32_dpp v122, v210, v122 wave_ror:1 row_mask:0xf bank_mask:0xf
    v_add_f32_dpp v126, v211, v126 wave_ror:1 row_mask:0xf bank_mask:0xf
    s_waitcnt lgkmcnt(2)
    v_mfma_f32_32x32x16_bf16 v[144:159], v[228:231], v[224:227], v[144:159]
    buffer_load_dwordx4 v[96:99], v62, s[16:19], s97 offen offset:0 sc1
    v_cndmask_b32 v208, v114, v71, s[76:77]
    v_cndmask_b32 v209, v118, v114, s[76:77]
    v_cndmask_b32 v210, v122, v118, s[76:77]
    v_cndmask_b32 v211, v126, v122, s[76:77]
    v_mov_b32 v71, v126
    v_mfma_f32_32x32x16_bf16 v[160:175], v[244:247], v[224:227], v[160:175]
    v_add_f32_dpp v113, v208, v113 wave_ror:1 row_mask:0xf bank_mask:0xf
    v_add_f32_dpp v117, v209, v117 wave_ror:1 row_mask:0xf bank_mask:0xf
    v_add_f32_dpp v121, v210, v121 wave_ror:1 row_mask:0xf bank_mask:0xf
    v_add_f32_dpp v125, v211, v125 wave_ror:1 row_mask:0xf bank_mask:0xf
    v_cndmask_b32 v208, v113, v70, s[76:77]
    v_cndmask_b32 v209, v117, v113, s[76:77]
    v_mfma_f32_32x32x16_bf16 v[176:191], v[212:215], v[224:227], 0
    buffer_load_dwordx4 v[100:103], v62, s[16:19], s97 offen offset:1024 sc1
    v_cndmask_b32 v210, v121, v117, s[76:77]
    v_cndmask_b32 v211, v125, v121, s[76:77]
    v_mov_b32 v70, v125
    v_add_f32_dpp v112, v208, v112 wave_ror:1 row_mask:0xf bank_mask:0xf
    s_waitcnt lgkmcnt(0)
    v_mfma_f32_32x32x16_bf16 v[144:159], v[236:239], v[216:219], v[144:159]
    ds_read_b64_tr_b16 v[240:241], v65 offset:2592
    ds_read_b64_tr_b16 v[242:243], v65 offset:2560
    v_add_f32_dpp v116, v209, v116 wave_ror:1 row_mask:0xf bank_mask:0xf
    v_add_f32_dpp v120, v210, v120 wave_ror:1 row_mask:0xf bank_mask:0xf
    v_add_f32_dpp v124, v211, v124 wave_ror:1 row_mask:0xf bank_mask:0xf
    v_mfma_f32_32x32x16_bf16 v[160:175], v[228:231], v[216:219], v[160:175]
    buffer_load_dwordx4 v[104:107], v62, s[16:19], s97 offen offset:2048 sc1
    ds_write_b32 v66, v112 offset:768
    ds_write_b32 v66, v116 offset:832
    v_mfma_f32_32x32x16_bf16 v[176:191], v[244:247], v[216:219], v[176:191]
    ds_write_b32 v66, v120 offset:896
    ds_write_b32 v66, v124 offset:960
    v_mfma_f32_32x32x16_bf16 v[192:207], v[212:215], v[216:219], 0
    ds_read_b64_tr_b16 v[212:213], v65 offset:3104
    ds_read_b64_tr_b16 v[214:215], v65 offset:3072
    buffer_load_dwordx4 v[108:111], v62, s[16:19], s97 offen offset:3072 sc1
    s_waitcnt lgkmcnt(6)
    v_mfma_f32_32x32x16_bf16 v[160:175], v[236:239], v[240:243], v[160:175]
    v_mfma_f32_32x32x16_bf16 v[176:191], v[228:231], v[240:243], v[176:191]
    ds_read_b64_tr_b16 v[224:225], v65 offset:3616
    ds_read_b64_tr_b16 v[226:227], v65 offset:3584
    s_waitcnt lgkmcnt(4)
    s_barrier
    v_mfma_f32_32x32x16_bf16 v[192:207], v[244:247], v[240:243], v[192:207]
    ds_read_b64_tr_b16 v[244:245], v65 offset:672
    ds_read_b64_tr_b16 v[246:247], v65 offset:640
    ds_read_b64 v[112:113], v67 offset:0
    ds_read_b64 v[114:115], v67 offset:4224
    ds_read_b64 v[116:117], v67 offset:8448
    s_waitcnt lgkmcnt(7)
    v_mfma_f32_32x32x16_bf16 v[176:191], v[236:239], v[212:215], v[176:191]
    ds_read_b128 v[216:219], v64 offset:320
    ds_read_b64_tr_b16 v[240:241], v65 offset:1184
    ds_read_b64_tr_b16 v[242:243], v65 offset:1152
    ds_read_b64 v[118:119], v67 offset:12672
    ds_read_b64 v[120:121], v67 offset:512
    ds_read_b64 v[122:123], v67 offset:4736
    v_mfma_f32_32x32x16_bf16 v[192:207], v[228:231], v[212:215], v[192:207]
    ds_read_b64 v[124:125], v67 offset:8960
    ds_read_b64 v[126:127], v67 offset:13184
    s_waitcnt lgkmcnt(13)
    v_mfma_f32_32x32x16_bf16 v[192:207], v[236:239], v[224:227], v[192:207]
    ds_read_b128 v[228:231], v64 offset:192
    ds_read_b64_tr_b16 v[236:237], v65 offset:1696
    ds_read_b64_tr_b16 v[238:239], v65 offset:1664
    s_waitcnt lgkmcnt(14)
    v_mfma_f32_32x32x16_bf16 v[144:159], v[232:235], v[244:247], v[144:159]
    s_waitcnt lgkmcnt(8)
    v_mfma_f32_32x32x16_bf16 v[144:159], v[216:219], v[240:243], v[144:159]
    v_mfma_f32_32x32x16_bf16 v[160:175], v[232:235], v[240:243], v[160:175]
    ds_read_b128 v[212:215], v64 offset:64
    ds_read_b64_tr_b16 v[224:225], v65 offset:2208
    ds_read_b64_tr_b16 v[226:227], v65 offset:2176
    s_waitcnt lgkmcnt(6)
    v_add_f32 v112, v112, v80
    s_waitcnt lgkmcnt(3)
    v_mfma_f32_32x32x16_bf16 v[144:159], v[228:231], v[236:239], v[144:159]
    v_add_f32 v113, v113, v81
    v_add_f32 v114, v114, v82
    v_add_f32 v115, v115, v83
    v_add_f32 v116, v116, v84
    v_add_f32 v117, v117, v85
    v_add_f32 v118, v118, v86
    v_mfma_f32_32x32x16_bf16 v[160:175], v[216:219], v[236:239], v[160:175]
    v_add_f32_e64 v119, v119, v87
    v_cvt_pk_bf16_f32 v128, v112, v114
    v_cvt_pk_bf16_f32 v129, v116, v118
    v_cvt_pk_bf16_f32 v130, v113, v115
    v_cvt_pk_bf16_f32 v131, v117, v119
    s_mov_b32 s25, 0
    v_mfma_f32_32x32x16_bf16 v[176:191], v[232:235], v[236:239], v[176:191]
    buffer_store_dwordx2 v[128:129], v68, s[20:23], s25 offen
    s_mov_b32 s25, 5120
    buffer_store_dwordx2 v[130:131], v68, s[20:23], s25 offen
    v_add_f32 v120, v120, v88
    v_add_f32 v121, v121, v89
    s_waitcnt lgkmcnt(0)
    v_mfma_f32_32x32x16_bf16 v[144:159], v[212:215], v[224:227], v[144:159]
    ds_read_b64_tr_b16 v[244:245], v65 offset:2720
    ds_read_b64_tr_b16 v[246:247], v65 offset:2688
    v_add_f32 v122, v122, v90
    v_add_f32 v123, v123, v91
    v_add_f32 v124, v124, v92
    v_add_f32 v125, v125, v93
    v_mfma_f32_32x32x16_bf16 v[160:175], v[228:231], v[224:227], v[160:175]
    v_add_f32 v126, v126, v94
    v_add_f32 v127, v127, v95
    v_cvt_pk_bf16_f32 v132, v120, v122
    v_cvt_pk_bf16_f32 v133, v124, v126
    v_cvt_pk_bf16_f32 v134, v121, v123
    v_cvt_pk_bf16_f32 v135, v125, v127
    v_mfma_f32_32x32x16_bf16 v[176:191], v[216:219], v[224:227], v[176:191]
    s_mov_b32 s25, 655360
    buffer_store_dwordx2 v[132:133], v68, s[20:23], s25 offen
    s_mov_b32 s25, 660480
    buffer_store_dwordx2 v[134:135], v68, s[20:23], s25 offen
    ds_read_b64_tr_b16 v[112:113], v65 offset:32
    ds_read_b64_tr_b16 v[114:115], v65 offset:0
    v_mfma_f32_32x32x16_bf16 v[192:207], v[232:235], v[224:227], v[192:207]
    ds_read_b64_tr_b16 v[232:233], v65 offset:3232
    ds_read_b64_tr_b16 v[234:235], v65 offset:3200
    ds_read_b64_tr_b16 v[116:117], v65 offset:160
    ds_read_b64_tr_b16 v[118:119], v65 offset:128
    ds_read_b64_tr_b16 v[120:121], v65 offset:288
    s_waitcnt lgkmcnt(7)
    v_mfma_f32_32x32x16_bf16 v[160:175], v[212:215], v[244:247], v[160:175]
    ds_read_b64_tr_b16 v[122:123], v65 offset:256
    ds_read_b64_tr_b16 v[124:125], v65 offset:416
    ds_read_b64_tr_b16 v[126:127], v65 offset:384
    ds_read_b64_tr_b16 v[128:129], v65 offset:544
    ds_read_b64_tr_b16 v[130:131], v65 offset:512
    ds_read_b64_tr_b16 v[132:133], v65 offset:672
    v_mfma_f32_32x32x16_bf16 v[176:191], v[228:231], v[244:247], v[176:191]
    ds_read_b64_tr_b16 v[240:241], v65 offset:3744
    ds_read_b64_tr_b16 v[242:243], v65 offset:3712
    ds_read_b64_tr_b16 v[134:135], v65 offset:640
    ds_read_b64_tr_b16 v[136:137], v65 offset:800
    ds_read_b64_tr_b16 v[138:139], v65 offset:768
    ds_read_b64_tr_b16 v[140:141], v65 offset:928
    v_mfma_f32_32x32x16_bf16 v[192:207], v[216:219], v[244:247], v[192:207]
    ds_read_b128 v[216:219], v64 offset:416
    ds_read_b64_tr_b16 v[236:237], v65 offset:800
    ds_read_b64_tr_b16 v[238:239], v65 offset:768
    ds_read_b64_tr_b16 v[142:143], v65 offset:896
    s_waitcnt lgkmcnt(15)
    v_mfma_f32_32x32x16_bf16 v[176:191], v[212:215], v[232:235], v[176:191]
    ds_read_b128 v[224:227], v64 offset:288
    ds_read_b64_tr_b16 v[244:245], v65 offset:1312
    ds_read_b64_tr_b16 v[246:247], v65 offset:1280
    s_waitcnt vmcnt(4)
ce_86:
    v_max3_u32 v208, v248, v249, v250
    v_max3_u32 v208, v208, v251, v252
    v_max3_u32 v208, v208, v253, v254
    v_max_u32 v208, v208, v255
    v_cmp_eq_u32 s[82:83], -1, v208
    v_min3_f32 v209, v96, v99, v100
    v_min3_f32 v209, v209, v103, v104
    v_min3_f32 v209, v209, v107, v108
    v_min_f32 v209, v209, v111
    v_cmp_neq_f32 vcc, 0x41000000, v209
    s_nop 0
    s_or_b64 vcc, vcc, s[82:83]
    s_cbranch_vccnz rd_87
rc_88:
    v_mfma_f32_32x32x16_bf16 v[192:207], v[228:231], v[232:235], v[192:207]
    v_mul_f32 v208, 0x3acccccd, v97
    v_mul_f32 v209, 0x3acccccd, v101
    v_mul_f32 v98, 0x3acccccd, v98
    v_mul_f32 v102, 0x3acccccd, v102
    v_fma_f32 v98, -v208, v208, v98
    s_waitcnt lgkmcnt(11)
    v_mfma_f32_32x32x16_bf16 v[192:207], v[212:215], v[240:243], v[192:207]
    ds_read_b128 v[228:231], v64 offset:160
    ds_read_b64_tr_b16 v[212:213], v65 offset:1824
    ds_read_b64_tr_b16 v[214:215], v65 offset:1792
    v_fma_f32 v102, -v209, v209, v102
    v_max_f32 v98, 0, v98
    s_waitcnt lgkmcnt(7)
    v_mfma_f32_32x32x16_bf16 v[144:159], v[216:219], v[236:239], v[144:159]
    v_max_f32 v102, 0, v102
    v_add_f32 v98, 0x3727c5ac, v98
    v_add_f32 v102, 0x3727c5ac, v102
    v_rsq_f32 v97, v98
    s_waitcnt lgkmcnt(3)
    v_mfma_f32_32x32x16_bf16 v[144:159], v[224:227], v[244:247], v[144:159]
    v_rsq_f32_e64 v101, v102
    v_mul_f32 v98, -v208, v97
    v_mul_f32 v102, -v209, v101
    v_lshlrev_b32_e64 v80, 16, v248
    v_and_b32 v82, 0xffff0000, v248
    v_mfma_f32_32x32x16_bf16 v[160:175], v[216:219], v[244:247], v[160:175]
    ds_read_b64_tr_b16 v[232:233], v65 offset:2336
    ds_read_b64_tr_b16 v[234:235], v65 offset:2304
    v_lshlrev_b32 v84, 16, v249
    v_and_b32 v86, 0xffff0000, v249
    v_lshlrev_b32_e64 v81, 16, v250
    s_waitcnt lgkmcnt(2)
    v_mfma_f32_32x32x16_bf16 v[144:159], v[228:231], v[212:215], v[144:159]
    v_and_b32 v83, 0xffff0000, v250
    v_lshlrev_b32_e64 v85, 16, v251
    v_and_b32 v87, 0xffff0000, v251
    v_fma_f32 v208, v80, v97, v98
    v_fma_f32 v209, v81, v101, v102
    v_cvt_pk_bf16_f32 v248, v208, v209
    v_mfma_f32_32x32x16_bf16 v[160:175], v[224:227], v[212:215], v[160:175]
    v_fma_f32 v208, v82, v97, v98
    v_fma_f32 v209, v83, v101, v102
    v_cvt_pk_bf16_f32 v249, v208, v209
    v_fma_f32 v208, v84, v97, v98
    v_fma_f32 v209, v85, v101, v102
    v_cvt_pk_bf16_f32 v250, v208, v209
    v_mfma_f32_32x32x16_bf16 v[176:191], v[216:219], v[212:215], v[176:191]
    v_fma_f32 v208, v86, v97, v98
    v_fma_f32 v209, v87, v101, v102
    v_cvt_pk_bf16_f32 v251, v208, v209
    s_waitcnt lgkmcnt(0)
    v_mfma_f32_32x32x16_bf16 v[144:159], v[220:223], v[232:235], v[144:159]
    ds_read_b64_tr_b16 v[240:241], v65 offset:2848
    ds_read_b64_tr_b16 v[242:243], v65 offset:2816
    ds_write_b32 v63, v248 offset:512
    ds_write_b32 v63, v249 offset:5376
    v_mfma_f32_32x32x16_bf16 v[160:175], v[228:231], v[232:235], v[160:175]
    ds_write_b32 v63, v250 offset:10240
    ds_write_b32 v63, v251 offset:15104
    v_mul_f32 v208, 0x3acccccd, v105
    v_mul_f32 v209, 0x3acccccd, v109
    v_mfma_f32_32x32x16_bf16 v[176:191], v[224:227], v[232:235], v[176:191]
    v_mul_f32 v106, 0x3acccccd, v106
    v_mul_f32 v110, 0x3acccccd, v110
    v_fma_f32 v106, -v208, v208, v106
    v_fma_f32 v110, -v209, v209, v110
    v_max_f32 v106, 0, v106
    v_max_f32_e64 v110, 0, v110
    v_mfma_f32_32x32x16_bf16 v[192:207], v[216:219], v[232:235], v[192:207]
    ds_read_b64_tr_b16 v[216:217], v65 offset:3360
    ds_read_b64_tr_b16 v[218:219], v65 offset:3328
    v_add_f32 v106, 0x3727c5ac, v106
    v_add_f32 v110, 0x3727c5ac, v110
    s_waitcnt lgkmcnt(6)
    v_mfma_f32_32x32x16_bf16 v[160:175], v[220:223], v[240:243], v[160:175]
    v_rsq_f32 v105, v106
    v_rsq_f32_e64 v109, v110
    v_mul_f32 v106, -v208, v105
    v_mul_f32 v110, -v209, v109
    v_mfma_f32_32x32x16_bf16 v[176:191], v[228:231], v[240:243], v[176:191]
    ds_read_b64_tr_b16 v[236:237], v65 offset:3872
    ds_read_b64_tr_b16 v[238:239], v65 offset:3840
    v_lshlrev_b32 v88, 16, v252
    v_and_b32 v90, 0xffff0000, v252
    v_lshlrev_b32 v92, 16, v253
    v_and_b32 v94, 0xffff0000, v253
    v_mfma_f32_32x32x16_bf16 v[192:207], v[224:227], v[240:243], v[192:207]
    ds_read_b128 v[224:227], v64 offset:384
    ds_read_b64_tr_b16 v[244:245], v65 offset:928
    ds_read_b64_tr_b16 v[246:247], v65 offset:896
    v_lshlrev_b32 v89, 16, v254
    v_and_b32 v91, 0xffff0000, v254
    s_waitcnt lgkmcnt(5)
    v_mfma_f32_32x32x16_bf16 v[176:191], v[220:223], v[216:219], v[176:191]
    ds_read_b128 v[212:215], v64 offset:256
    ds_read_b64_tr_b16 v[232:233], v65 offset:1440
    ds_read_b64_tr_b16 v[234:235], v65 offset:1408
    v_lshlrev_b32_e64 v93, 16, v255
    v_and_b32 v95, 0xffff0000, v255
    v_fma_f32 v208, v88, v105, v106
    v_mfma_f32_32x32x16_bf16 v[192:207], v[228:231], v[216:219], v[192:207]
    v_fma_f32 v209, v89, v109, v110
    v_cvt_pk_bf16_f32 v252, v208, v209
    v_fma_f32 v208, v90, v105, v106
    v_fma_f32 v209, v91, v109, v110
    v_cvt_pk_bf16_f32 v253, v208, v209
    s_waitcnt lgkmcnt(6)
    v_mfma_f32_32x32x16_bf16 v[192:207], v[220:223], v[236:239], v[192:207]
    ds_read_b128 v[220:223], v64 offset:128
    ds_read_b64_tr_b16 v[228:229], v65 offset:1952
    ds_read_b64_tr_b16 v[230:231], v65 offset:1920
    v_fma_f32 v208, v92, v105, v106
    v_fma_f32 v209, v93, v109, v110
    s_waitcnt lgkmcnt(6)
    v_mfma_f32_32x32x16_bf16 v[144:159], v[224:227], v[244:247], v[144:159]
    v_cvt_pk_bf16_f32 v254, v208, v209
    v_fma_f32 v208, v94, v105, v106
    v_fma_f32 v209, v95, v109, v110
    v_cvt_pk_bf16_f32 v255, v208, v209
    s_waitcnt lgkmcnt(3)
    v_mfma_f32_32x32x16_bf16 v[144:159], v[212:215], v[232:235], v[144:159]
    ds_write_b32 v63, v252 offset:768
    ds_write_b32 v63, v253 offset:5632
    ds_write_b32 v63, v254 offset:10496
    v_mfma_f32_32x32x16_bf16 v[160:175], v[224:227], v[232:235], v[160:175]
    ds_read_b128 v[240:243], v64 offset:0
    ds_read_b64_tr_b16 v[216:217], v65 offset:2464
    ds_read_b64_tr_b16 v[218:219], v65 offset:2432
    ds_write_b32 v63, v255 offset:15360
    s_waitcnt lgkmcnt(7)
    v_mfma_f32_32x32x16_bf16 v[144:159], v[220:223], v[228:231], v[144:159]
    v_mfma_f32_32x32x16_bf16 v[160:175], v[212:215], v[228:231], v[160:175]
    v_mfma_f32_32x32x16_bf16 v[176:191], v[224:227], v[228:231], v[176:191]
    s_waitcnt lgkmcnt(1)
    v_mfma_f32_32x32x16_bf16 v[144:159], v[240:243], v[216:219], v[144:159]
    ds_read_b64_tr_b16 v[236:237], v65 offset:2976
    ds_read_b64_tr_b16 v[238:239], v65 offset:2944
    v_mfma_f32_32x32x16_bf16 v[160:175], v[220:223], v[216:219], v[160:175]
    v_mfma_f32_32x32x16_bf16 v[176:191], v[212:215], v[216:219], v[176:191]
    v_mfma_f32_32x32x16_bf16 v[192:207], v[224:227], v[216:219], v[192:207]
    ds_read_b64_tr_b16 v[224:225], v65 offset:3488
    ds_read_b64_tr_b16 v[226:227], v65 offset:3456
    s_waitcnt lgkmcnt(2)
    v_mfma_f32_32x32x16_bf16 v[160:175], v[240:243], v[236:239], v[160:175]
    v_mfma_f32_32x32x16_bf16 v[176:191], v[220:223], v[236:239], v[176:191]
    ds_read_b64_tr_b16 v[244:245], v65 offset:4000
    ds_read_b64_tr_b16 v[246:247], v65 offset:3968
    v_mfma_f32_32x32x16_bf16 v[192:207], v[212:215], v[236:239], v[192:207]
    s_waitcnt lgkmcnt(2)
    v_mfma_f32_32x32x16_bf16 v[176:191], v[240:243], v[224:227], v[176:191]
    v_mfma_f32_32x32x16_bf16 v[192:207], v[220:223], v[224:227], v[192:207]
    s_waitcnt lgkmcnt(0)
    v_mfma_f32_32x32x16_bf16 v[192:207], v[240:243], v[244:247], v[192:207]
    s_waitcnt lgkmcnt(0)
    s_barrier
    ds_read_b128 v[212:215], v64 offset:608
    ds_read_b128 v[216:219], v64 offset:576
    ds_read_b128 v[220:223], v64 offset:544
    ds_read_b128 v[224:227], v64 offset:512
    s_waitcnt lgkmcnt(3)
    v_mfma_f32_32x32x16_bf16 v[144:159], v[212:215], v[112:115], v[144:159]
    ds_read_b128 v[228:231], v64 offset:736
    s_waitcnt lgkmcnt(3)
    v_mfma_f32_32x32x16_bf16 v[144:159], v[216:219], v[116:119], v[144:159]
    ds_read_b128 v[232:235], v64 offset:704
    s_waitcnt lgkmcnt(3)
    v_mfma_f32_32x32x16_bf16 v[144:159], v[220:223], v[120:123], v[144:159]
    ds_read_b128 v[236:239], v64 offset:672
    s_waitcnt lgkmcnt(3)
    v_mfma_f32_32x32x16_bf16 v[144:159], v[224:227], v[124:127], v[144:159]
    ds_read_b128 v[240:243], v64 offset:640
    s_nop 3
    s_waitcnt lgkmcnt(3)
    v_mfma_f32_32x32x16_bf16 v[160:175], v[228:231], v[112:115], v[160:175]
    s_nop 4
    s_waitcnt lgkmcnt(2)
    v_mfma_f32_32x32x16_bf16 v[160:175], v[232:235], v[116:119], v[160:175]
    v_cndmask_b32 v208, v147, v72, s[76:77]
    v_cndmask_b32 v209, v151, v147, s[76:77]
    v_cndmask_b32 v210, v155, v151, s[76:77]
    v_cndmask_b32 v211, v159, v155, s[76:77]
    v_mov_b32 v72, v159
    s_waitcnt lgkmcnt(1)
    v_mfma_f32_32x32x16_bf16 v[160:175], v[236:239], v[120:123], v[160:175]
    v_add_f32_dpp v146, v208, v146 wave_ror:1 row_mask:0xf bank_mask:0xf
    v_add_f32_dpp v150, v209, v150 wave_ror:1 row_mask:0xf bank_mask:0xf
    v_add_f32_dpp v154, v210, v154 wave_ror:1 row_mask:0xf bank_mask:0xf
    v_add_f32_dpp v158, v211, v158 wave_ror:1 row_mask:0xf bank_mask:0xf
    v_cndmask_b32 v208, v146, v71, s[76:77]
    s_waitcnt lgkmcnt(0)
    v_mfma_f32_32x32x16_bf16 v[160:175], v[240:243], v[124:127], v[160:175]
    v_cndmask_b32 v209, v150, v146, s[76:77]
    v_cndmask_b32 v210, v154, v150, s[76:77]
    v_cndmask_b32 v211, v158, v154, s[76:77]
    v_mov_b32 v71, v158
    v_add_f32_dpp v145, v208, v145 wave_ror:1 row_mask:0xf bank_mask:0xf
    v_add_f32_dpp v149, v209, v149 wave_ror:1 row_mask:0xf bank_mask:0xf
    v_mfma_f32_32x32x16_bf16 v[160:175], v[212:215], v[128:131], v[160:175]
    ds_read_b128 v[244:247], v64 offset:864
    v_add_f32_dpp v153, v210, v153 wave_ror:1 row_mask:0xf bank_mask:0xf
    v_add_f32_dpp v157, v211, v157 wave_ror:1 row_mask:0xf bank_mask:0xf
    v_cndmask_b32 v208, v145, v70, s[76:77]
    v_cndmask_b32 v209, v149, v145, s[76:77]
    v_cndmask_b32 v210, v153, v149, s[76:77]
    v_mfma_f32_32x32x16_bf16 v[160:175], v[216:219], v[132:135], v[160:175]
    ds_read_b128 v[248:251], v64 offset:832
    v_cndmask_b32 v211, v157, v153, s[76:77]
    v_mov_b32_e64 v70, v157
    v_add_f32_dpp v144, v208, v144 wave_ror:1 row_mask:0xf bank_mask:0xf
    v_add_f32_dpp v148, v209, v148 wave_ror:1 row_mask:0xf bank_mask:0xf
    v_add_f32_dpp v152, v210, v152 wave_ror:1 row_mask:0xf bank_mask:0xf
    v_mfma_f32_32x32x16_bf16 v[160:175], v[220:223], v[136:139], v[160:175]
    ds_read_b128 v[252:255], v64 offset:800
    v_add_f32_dpp v156, v211, v156 wave_ror:1 row_mask:0xf bank_mask:0xf
    ds_write_b32 v66, v144 offset:0
    v_mfma_f32_32x32x16_bf16 v[160:175], v[224:227], v[140:143], v[160:175]
    ds_read_b128 v[224:227], v64 offset:768
    ds_write_b32 v66, v148 offset:64
    ds_write_b32 v66, v152 offset:128
    s_waitcnt lgkmcnt(6)
    v_mfma_f32_32x32x16_bf16 v[176:191], v[244:247], v[112:115], v[176:191]
    ds_write_b32 v66, v156 offset:192
    s_nop 2
    s_waitcnt lgkmcnt(6)
    v_mfma_f32_32x32x16_bf16 v[176:191], v[248:251], v[116:119], v[176:191]
    s_nop 2
    v_cndmask_b32 v208, v163, v72, s[76:77]
    v_cndmask_b32 v209, v167, v163, s[76:77]
    s_waitcnt lgkmcnt(5)
    v_mfma_f32_32x32x16_bf16 v[176:191], v[252:255], v[120:123], v[176:191]
    v_cndmask_b32 v210, v171, v167, s[76:77]
    v_cndmask_b32 v211, v175, v171, s[76:77]
    v_mov_b32 v72, v175
    v_add_f32_dpp v162, v208, v162 wave_ror:1 row_mask:0xf bank_mask:0xf
    v_add_f32_dpp v166, v209, v166 wave_ror:1 row_mask:0xf bank_mask:0xf
    s_waitcnt lgkmcnt(3)
    v_mfma_f32_32x32x16_bf16 v[176:191], v[224:227], v[124:127], v[176:191]
    v_add_f32_dpp v170, v210, v170 wave_ror:1 row_mask:0xf bank_mask:0xf
    v_add_f32_dpp v174, v211, v174 wave_ror:1 row_mask:0xf bank_mask:0xf
    v_cndmask_b32 v208, v162, v71, s[76:77]
    v_cndmask_b32 v209, v166, v162, s[76:77]
    v_cndmask_b32 v210, v170, v166, s[76:77]
    v_cndmask_b32 v211, v174, v170, s[76:77]
    v_mfma_f32_32x32x16_bf16 v[176:191], v[228:231], v[128:131], v[176:191]
    ds_read_b64_tr_b16 v[228:229], v65 offset:1056
    ds_read_b64_tr_b16 v[230:231], v65 offset:1024
    v_mov_b32 v71, v174
    v_add_f32_dpp v161, v208, v161 wave_ror:1 row_mask:0xf bank_mask:0xf
    v_add_f32_dpp v165, v209, v165 wave_ror:1 row_mask:0xf bank_mask:0xf
    v_add_f32_dpp v169, v210, v169 wave_ror:1 row_mask:0xf bank_mask:0xf
    v_mfma_f32_32x32x16_bf16 v[176:191], v[232:235], v[132:135], v[176:191]
    ds_read_b64_tr_b16 v[232:233], v65 offset:1184
    ds_read_b64_tr_b16 v[234:235], v65 offset:1152
    v_add_f32_dpp v173, v211, v173 wave_ror:1 row_mask:0xf bank_mask:0xf
    v_cndmask_b32 v208, v161, v70, s[76:77]
    v_cndmask_b32 v209, v165, v161, s[76:77]
    v_cndmask_b32 v210, v169, v165, s[76:77]
    v_mfma_f32_32x32x16_bf16 v[176:191], v[236:239], v[136:139], v[176:191]
    ds_read_b64_tr_b16 v[236:237], v65 offset:1312
    ds_read_b64_tr_b16 v[238:239], v65 offset:1280
    v_cndmask_b32 v211, v173, v169, s[76:77]
    v_mov_b32_e64 v70, v173
    v_add_f32_dpp v160, v208, v160 wave_ror:1 row_mask:0xf bank_mask:0xf
    v_add_f32_dpp v164, v209, v164 wave_ror:1 row_mask:0xf bank_mask:0xf
    v_mfma_f32_32x32x16_bf16 v[176:191], v[240:243], v[140:143], v[176:191]
    ds_read_b128 v[240:243], v64 offset:512
    ds_read_b64_tr_b16 v[224:225], v65 offset:1440
    ds_read_b64_tr_b16 v[226:227], v65 offset:1408
    v_add_f32_dpp v168, v210, v168 wave_ror:1 row_mask:0xf bank_mask:0xf
    v_add_f32_dpp v172, v211, v172 wave_ror:1 row_mask:0xf bank_mask:0xf
    s_waitcnt lgkmcnt(7)
    v_mfma_f32_32x32x16_bf16 v[176:191], v[212:215], v[228:231], v[176:191]
    ds_read_b128 v[212:215], v64 offset:992
    ds_write_b32 v66, v160 offset:256
    ds_write_b32 v66, v164 offset:320
    s_waitcnt lgkmcnt(8)
    v_mfma_f32_32x32x16_bf16 v[176:191], v[216:219], v[232:235], v[176:191]
    ds_read_b128 v[216:219], v64 offset:960
    ds_write_b32 v66, v168 offset:384
    ds_write_b32 v66, v172 offset:448
    s_waitcnt lgkmcnt(9)
    v_mfma_f32_32x32x16_bf16 v[176:191], v[220:223], v[236:239], v[176:191]
    ds_read_b128 v[220:223], v64 offset:928
    s_waitcnt lgkmcnt(7)
    v_mfma_f32_32x32x16_bf16 v[176:191], v[240:243], v[224:227], v[176:191]
    ds_read_b128 v[240:243], v64 offset:896
    s_waitcnt lgkmcnt(2)
    s_barrier
    v_mfma_f32_32x32x16_bf16 v[192:207], v[212:215], v[112:115], v[192:207]
    ds_read_b64 v[144:145], v67 offset:0
    ds_read_b64 v[146:147], v67 offset:4224
    ds_read_b64 v[148:149], v67 offset:8448
    ds_read_b64 v[150:151], v67 offset:12672
    s_nop 0
    v_mfma_f32_32x32x16_bf16 v[192:207], v[216:219], v[116:119], v[192:207]
    s_nop 2
    v_cndmask_b32 v208, v179, v72, s[76:77]
    v_cndmask_b32 v209, v183, v179, s[76:77]
    s_waitcnt lgkmcnt(5)
    v_mfma_f32_32x32x16_bf16 v[192:207], v[220:223], v[120:123], v[192:207]
    v_cndmask_b32 v210, v187, v183, s[76:77]
    v_cndmask_b32 v211, v191, v187, s[76:77]
    v_mov_b32 v72, v191
    v_add_f32_dpp v178, v208, v178 wave_ror:1 row_mask:0xf bank_mask:0xf
    v_add_f32_dpp v182, v209, v182 wave_ror:1 row_mask:0xf bank_mask:0xf
    s_waitcnt lgkmcnt(4)
    v_mfma_f32_32x32x16_bf16 v[192:207], v[240:243], v[124:127], v[192:207]
    ds_read_b128 v[212:215], v64 offset:768
    v_add_f32_dpp v186, v210, v186 wave_ror:1 row_mask:0xf bank_mask:0xf
    v_add_f32_dpp v190, v211, v190 wave_ror:1 row_mask:0xf bank_mask:0xf
    v_cndmask_b32 v208, v178, v71, s[76:77]
    v_cndmask_b32 v209, v182, v178, s[76:77]
    v_cndmask_b32 v210, v186, v182, s[76:77]
    v_mfma_f32_32x32x16_bf16 v[192:207], v[244:247], v[128:131], v[192:207]
    ds_read_b128 v[244:247], v64 offset:736
    v_cndmask_b32 v211, v190, v186, s[76:77]
    v_mov_b32 v71, v190
    v_add_f32_dpp v177, v208, v177 wave_ror:1 row_mask:0xf bank_mask:0xf
    v_add_f32_dpp v181, v209, v181 wave_ror:1 row_mask:0xf bank_mask:0xf
    v_add_f32_dpp v185, v210, v185 wave_ror:1 row_mask:0xf bank_mask:0xf
    v_mfma_f32_32x32x16_bf16 v[192:207], v[248:251], v[132:135], v[192:207]
    ds_read_b128 v[248:251], v64 offset:704
    v_add_f32_dpp v189, v211, v189 wave_ror:1 row_mask:0xf bank_mask:0xf
    v_cndmask_b32 v208, v177, v70, s[76:77]
    v_cndmask_b32 v209, v181, v177, s[76:77]
    v_cndmask_b32 v210, v185, v181, s[76:77]
    v_cndmask_b32 v211, v189, v185, s[76:77]
    v_mfma_f32_32x32x16_bf16 v[192:207], v[252:255], v[136:139], v[192:207]
    ds_read_b128 v[252:255], v64 offset:672
    v_mov_b32_e64 v70, v189
    v_add_f32_dpp v176, v208, v176 wave_ror:1 row_mask:0xf bank_mask:0xf
    v_add_f32_dpp v180, v209, v180 wave_ror:1 row_mask:0xf bank_mask:0xf
    v_add_f32_dpp v184, v210, v184 wave_ror:1 row_mask:0xf bank_mask:0xf
    s_waitcnt lgkmcnt(3)
    v_mfma_f32_32x32x16_bf16 v[192:207], v[212:215], v[140:143], v[192:207]
    ds_read_b128 v[216:219], v64 offset:640
    v_add_f32_dpp v188, v211, v188 wave_ror:1 row_mask:0xf bank_mask:0xf
    s_waitcnt lgkmcnt(3)
    v_mfma_f32_32x32x16_bf16 v[192:207], v[244:247], v[228:231], v[192:207]
    ds_read_b128 v[228:231], v64 offset:608
    ds_read_b64_tr_b16 v[220:221], v65 offset:1568
    ds_read_b64_tr_b16 v[222:223], v65 offset:1536
    ds_write_b32 v66, v176 offset:512
    s_waitcnt lgkmcnt(6)
    v_mfma_f32_32x32x16_bf16 v[192:207], v[248:251], v[232:235], v[192:207]
    ds_read_b128 v[232:235], v64 offset:576
    ds_read_b64_tr_b16 v[240:241], v65 offset:1696
    ds_read_b64_tr_b16 v[242:243], v65 offset:1664
    ds_write_b32 v66, v180 offset:576
    s_waitcnt lgkmcnt(9)
    v_mfma_f32_32x32x16_bf16 v[192:207], v[252:255], v[236:239], v[192:207]
    ds_read_b128 v[236:239], v64 offset:544
    ds_read_b64_tr_b16 v[212:213], v65 offset:1824
    ds_read_b64_tr_b16 v[214:215], v65 offset:1792
    ds_write_b32 v66, v184 offset:640
    s_waitcnt lgkmcnt(12)
    v_mfma_f32_32x32x16_bf16 v[192:207], v[216:219], v[224:227], v[192:207]
    ds_read_b128 v[224:227], v64 offset:512
    ds_read_b64_tr_b16 v[244:245], v65 offset:1952
    ds_read_b64_tr_b16 v[246:247], v65 offset:1920
    ds_write_b32 v66, v188 offset:704
    s_waitcnt lgkmcnt(13)
    v_mfma_f32_32x32x16_bf16 v[192:207], v[228:231], v[220:223], v[192:207]
    v_add_f32 v144, v144, v80
    v_add_f32 v145, v145, v81
    v_add_f32 v146, v146, v82
    v_add_f32 v147, v147, v83
    s_waitcnt lgkmcnt(9)
    v_mfma_f32_32x32x16_bf16 v[192:207], v[232:235], v[240:243], v[192:207]
    v_add_f32 v148, v148, v84
    v_add_f32 v149, v149, v85
    v_add_f32 v150, v150, v86
    v_add_f32 v151, v151, v87
    v_cvt_pk_bf16_f32 v160, v144, v146
    s_waitcnt lgkmcnt(5)
    v_mfma_f32_32x32x16_bf16 v[192:207], v[236:239], v[212:215], v[192:207]
    v_cvt_pk_bf16_f32 v161, v148, v150
    v_cvt_pk_bf16_f32 v162, v145, v147
    v_cvt_pk_bf16_f32 v163, v149, v151
    s_mov_b32 s25, 1310720
    s_waitcnt lgkmcnt(1)
    v_mfma_f32_32x32x16_bf16 v[192:207], v[224:227], v[244:247], v[192:207]
    buffer_store_dwordx2 v[160:161], v68, s[20:23], s25 offen
    s_mov_b32 s25, 1315840
    buffer_store_dwordx2 v[162:163], v68, s[20:23], s25 offen
    s_nop 8
    v_cndmask_b32 v208, v195, v72, s[76:77]
    v_cndmask_b32 v209, v199, v195, s[76:77]
    v_cndmask_b32 v210, v203, v199, s[76:77]
    v_cndmask_b32 v211, v207, v203, s[76:77]
    v_mov_b32_e64 v72, v207
    v_add_f32_dpp v194, v208, v194 wave_ror:1 row_mask:0xf bank_mask:0xf
    v_add_f32_dpp v198, v209, v198 wave_ror:1 row_mask:0xf bank_mask:0xf
    v_add_f32_dpp v202, v210, v202 wave_ror:1 row_mask:0xf bank_mask:0xf
    v_add_f32_dpp v206, v211, v206 wave_ror:1 row_mask:0xf bank_mask:0xf
    v_cndmask_b32 v208, v194, v71, s[76:77]
    v_cndmask_b32 v209, v198, v194, s[76:77]
    v_cndmask_b32 v210, v202, v198, s[76:77]
    v_cndmask_b32 v211, v206, v202, s[76:77]
    v_mov_b32_e64 v71, v206
    v_add_f32_dpp v193, v208, v193 wave_ror:1 row_mask:0xf bank_mask:0xf
    v_add_f32_dpp v197, v209, v197 wave_ror:1 row_mask:0xf bank_mask:0xf
    v_add_f32_dpp v201, v210, v201 wave_ror:1 row_mask:0xf bank_mask:0xf
    v_add_f32_dpp v205, v211, v205 wave_ror:1 row_mask:0xf bank_mask:0xf
    v_cndmask_b32 v208, v193, v70, s[76:77]
    v_cndmask_b32 v209, v197, v193, s[76:77]
    v_cndmask_b32 v210, v201, v197, s[76:77]
    v_cndmask_b32 v211, v205, v201, s[76:77]
    v_mov_b32_e64 v70, v205
    v_add_f32_dpp v192, v208, v192 wave_ror:1 row_mask:0xf bank_mask:0xf
    v_add_f32_dpp v196, v209, v196 wave_ror:1 row_mask:0xf bank_mask:0xf
    v_add_f32_dpp v200, v210, v200 wave_ror:1 row_mask:0xf bank_mask:0xf
    v_add_f32_dpp v204, v211, v204 wave_ror:1 row_mask:0xf bank_mask:0xf
    ds_write_b32 v66, v192 offset:768
    ds_write_b32 v66, v196 offset:832
    ds_write_b32 v66, v200 offset:896
    ds_write_b32 v66, v204 offset:960
    s_waitcnt lgkmcnt(0)
    s_barrier
    ds_read_b64 v[152:153], v67 offset:512
    ds_read_b64 v[154:155], v67 offset:4736
    ds_read_b64 v[156:157], v67 offset:8960
    ds_read_b64 v[158:159], v67 offset:13184
    s_waitcnt lgkmcnt(0)
    v_add_f32 v152, v152, v88
    v_add_f32 v153, v153, v89
    v_add_f32 v154, v154, v90
    v_add_f32 v155, v155, v91
    v_add_f32 v156, v156, v92
    v_add_f32 v157, v157, v93
    v_add_f32 v158, v158, v94
    v_add_f32_e64 v159, v159, v95
    v_cvt_pk_bf16_f32 v164, v152, v154
    v_cvt_pk_bf16_f32 v165, v156, v158
    v_cvt_pk_bf16_f32 v166, v153, v155
    v_cvt_pk_bf16_f32 v167, v157, v159
    s_mov_b32 s25, 1966080
    buffer_store_dwordx2 v[164:165], v68, s[20:23], s25 offen
    s_mov_b32 s25, 1971200
    buffer_store_dwordx2 v[166:167], v68, s[20:23], s25 offen
    s_branch ec_82
nc_81:
ec_82:
L_end:
    s_endpgm
ps_4:
    s_mov_b32 s84, 1048576
pl_5:
    global_load_dword v7, v5, s[66:67] sc1
    s_waitcnt vmcnt(0)
    s_sub_u32 s84, s84, 1
    s_cbranch_scc1 pc_6
    v_cmp_gt_u32_e64 vcc, 1, v7
    s_nop 0
    s_and_b64 vcc, vcc, s[50:51]
    s_and_b64 vcc, vcc, 1
    s_cbranch_scc1 pl_5
    s_branch pc_6
ps_7:
    s_mov_b32 s84, 1048576
pl_8:
    buffer_load_dword v7, v4, s[16:19], s87 offen offset:0 sc1
    s_waitcnt vmcnt(0)
    s_sub_u32 s84, s84, 1
    s_cbranch_scc1 pc_9
    v_cmp_gt_u32 vcc, 32, v7
    s_nop 0
    s_and_b64 vcc, vcc, s[50:51]
    s_cbranch_scc1 pl_8
    s_branch pc_9
ps_11:
    s_mov_b32 s84, 1048576
pl_12:
    global_load_dword v7, v5, s[66:67] sc1
    s_waitcnt vmcnt(0)
    s_sub_u32 s84, s84, 1
    s_cbranch_scc1 pc_13
    v_cmp_gt_u32_e64 vcc, 1, v7
    s_nop 0
    s_and_b64 vcc, vcc, s[50:51]
    s_and_b64 vcc, vcc, 1
    s_cbranch_scc1 pl_12
    s_branch pc_13
ps_14:
    s_mov_b32 s84, 1048576
pl_15:
    buffer_load_dword v7, v4, s[16:19], s87 offen offset:0 sc1
    s_waitcnt vmcnt(0)
    s_sub_u32 s84, s84, 1
    s_cbranch_scc1 pc_16
    v_cmp_gt_u32 vcc, 32, v7
    s_nop 0
    s_and_b64 vcc, vcc, s[50:51]
    s_cbranch_scc1 pl_15
    s_branch pc_16
ps_17:
    s_mov_b32 s84, 1048576
pl_18:
    buffer_load_dword v7, v4, s[16:19], s89 offen offset:8 sc1
    s_waitcnt vmcnt(0)
    s_sub_u32 s84, s84, 1
    s_cbranch_scc1 pc_19
    v_cmp_gt_u32_e64 vcc, 32, v7
    s_nop 0
    s_and_b64 vcc, vcc, s[50:51]
    s_cbranch_scc1 pl_18
    s_branch pc_19
rd_21:
    s_cmp_eq_u32 s38, 0
    s_cbranch_scc1 rc_22
    s_sub_u32 s38, s38, 1
    s_nop 7
    s_nop 7
    s_sleep 4
    s_mov_b64 exec, vcc
    s_mov_b32 s96, 4194304
    buffer_load_dwordx4 v[216:219], v56, s[16:19], s96 offen offset:0 sc1
    buffer_load_dwordx4 v[220:223], v56, s[16:19], s96 offen offset:256 sc1
    s_mov_b32 s96, 4227072
    buffer_load_dwordx4 v[224:227], v56, s[16:19], s96 offen offset:0 sc1
    buffer_load_dwordx4 v[228:231], v56, s[16:19], s96 offen offset:256 sc1
    s_mov_b32 s96, 4259840
    buffer_load_dwordx4 v[232:235], v56, s[16:19], s96 offen offset:0 sc1
    buffer_load_dwordx4 v[236:239], v56, s[16:19], s96 offen offset:256 sc1
    s_mov_b32 s96, 4292608
    buffer_load_dwordx4 v[240:243], v56, s[16:19], s96 offen offset:0 sc1
    buffer_load_dwordx4 v[244:247], v56, s[16:19], s96 offen offset:256 sc1
    s_mov_b32 s96, 4194304
    buffer_load_dwordx2 v[248:249], v57, s[16:19], s96 offen offset:0 sc1
    buffer_load_dwordx2 v[252:253], v57, s[16:19], s96 offen offset:128 sc1
    s_mov_b32 s96, 4210688
    buffer_load_dwordx2 v[250:251], v57, s[16:19], s96 offen offset:0 sc1
    buffer_load_dwordx2 v[254:255], v57, s[16:19], s96 offen offset:128 sc1
    s_mov_b32 s96, 0
    s_mov_b32 s97, 5120
    s_waitcnt vmcnt(16)
    buffer_load_dwordx2 v[208:209], v60, s[4:7], s96 offen
    s_waitcnt vmcnt(16)
    buffer_load_dwordx2 v[210:211], v60, s[4:7], s97 offen
    s_waitcnt vmcnt(16)
    v_lshrrev_b32_e64 v212, 5, v1
    v_mul_u32_u24 v212, 5104, v212
    v_bfe_u32 v213, v1, 4, 1
    v_lshlrev_b32 v213, 2, v213
    v_sub_u32 v212, v212, v213
    v_add_u32 v212, v212, v60
    s_mul_i32 s97, s24, 24
    s_sub_u32 s97, 128, s97
    buffer_load_dword v212, v212, s[4:7], s97 offen
    s_mov_b64 exec, -1
    s_waitcnt vmcnt(0) lgkmcnt(0)
    s_branch oe_20
rd_24:
    s_cmp_eq_u32 s38, 0
    s_cbranch_scc1 rc_25
    s_sub_u32 s38, s38, 1
    s_nop 7
    s_nop 7
    s_sleep 4
    s_mov_b64 exec, vcc
    s_mov_b32 s96, 4198400
    buffer_load_dwordx4 v[216:219], v56, s[16:19], s96 offen offset:0 sc1
    buffer_load_dwordx4 v[220:223], v56, s[16:19], s96 offen offset:256 sc1
    s_mov_b32 s96, 4231168
    buffer_load_dwordx4 v[224:227], v56, s[16:19], s96 offen offset:0 sc1
    buffer_load_dwordx4 v[228:231], v56, s[16:19], s96 offen offset:256 sc1
    s_mov_b32 s96, 4263936
    buffer_load_dwordx4 v[232:235], v56, s[16:19], s96 offen offset:0 sc1
    buffer_load_dwordx4 v[236:239], v56, s[16:19], s96 offen offset:256 sc1
    s_mov_b32 s96, 4296704
    buffer_load_dwordx4 v[240:243], v56, s[16:19], s96 offen offset:0 sc1
    buffer_load_dwordx4 v[244:247], v56, s[16:19], s96 offen offset:256 sc1
    s_mov_b32 s96, 4196352
    buffer_load_dwordx2 v[248:249], v57, s[16:19], s96 offen offset:0 sc1
    buffer_load_dwordx2 v[252:253], v57, s[16:19], s96 offen offset:128 sc1
    s_mov_b32 s96, 4212736
    buffer_load_dwordx2 v[250:251], v57, s[16:19], s96 offen offset:0 sc1
    buffer_load_dwordx2 v[254:255], v57, s[16:19], s96 offen offset:128 sc1
    s_mov_b32 s96, 1310720
    s_mov_b32 s97, 1315840
    s_waitcnt vmcnt(14)
    buffer_load_dwordx2 v[208:209], v60, s[4:7], s96 offen
    s_waitcnt vmcnt(14)
    buffer_load_dwordx2 v[210:211], v60, s[4:7], s97 offen
    s_waitcnt vmcnt(14)
    v_lshrrev_b32 v212, 5, v1
    v_mul_u32_u24 v212, 5104, v212
    v_bfe_u32 v213, v1, 4, 1
    v_lshlrev_b32 v213, 2, v213
    v_sub_u32 v212, v212, v213
    v_add_u32 v212, v212, v60
    s_mul_i32 s97, s24, 24
    s_sub_u32 s97, 1310848, s97
    buffer_load_dword v212, v212, s[4:7], s97 offen
    s_mov_b64 exec, -1
    s_waitcnt vmcnt(0) lgkmcnt(0)
    s_branch oe_23
rd_29:
    s_cmp_eq_u32 s38, 0
    s_cbranch_scc1 rc_30
    s_sub_u32 s38, s38, 1
    s_nop 7
    s_nop 7
    s_sleep 4
    s_mov_b64 exec, vcc
    s_lshl_b32 s96, s75, 14
    s_add_u32 s96, s96, 6815744
    s_lshl_b32 s97, s24, 12
    s_add_u32 s97, s97, 3473408
    buffer_load_dwordx4 v[176:179], v62, s[16:19], s96 offen offset:0 sc1
    buffer_load_dwordx4 v[180:183], v62, s[16:19], s96 offen offset:1024 sc1
    buffer_load_dwordx4 v[184:187], v62, s[16:19], s97 offen offset:0 sc1
    buffer_load_dwordx4 v[188:191], v62, s[16:19], s97 offen offset:1024 sc1
    buffer_load_dwordx4 v[192:195], v62, s[16:19], s97 offen offset:2048 sc1
    buffer_load_dwordx4 v[196:199], v62, s[16:19], s97 offen offset:3072 sc1
    s_mov_b64 exec, -1
    s_waitcnt vmcnt(0) lgkmcnt(0)
    s_branch ce_28
rd_32:
    s_cmp_eq_u32 s38, 0
    s_cbranch_scc1 rc_33
    s_sub_u32 s38, s38, 1
    s_nop 7
    s_nop 7
    s_sleep 4
    s_mov_b64 exec, vcc
    s_lshl_b32 s96, s75, 14
    s_add_u32 s96, s96, 6815744
    s_lshl_b32 s97, s24, 12
    s_add_u32 s97, s97, 3477504
    buffer_load_dwordx4 v[248:251], v62, s[16:19], s96 offen offset:2048 sc1
    buffer_load_dwordx4 v[252:255], v62, s[16:19], s96 offen offset:3072 sc1
    buffer_load_dwordx4 v[96:99], v62, s[16:19], s97 offen offset:0 sc1
    buffer_load_dwordx4 v[100:103], v62, s[16:19], s97 offen offset:1024 sc1
    buffer_load_dwordx4 v[104:107], v62, s[16:19], s97 offen offset:2048 sc1
    buffer_load_dwordx4 v[108:111], v62, s[16:19], s97 offen offset:3072 sc1
    s_mov_b64 exec, -1
    s_waitcnt vmcnt(0) lgkmcnt(0)
    s_branch ce_31
gl_34:
    s_add_u32 s82, s86, 16384
    v_lshlrev_b32 v2, 10, v1
    v_mov_b32_e64 v5, 1
    s_mov_b64 exec, 255
    buffer_store_dword v5, v2, s[16:19], s82 offen offset:0 sc1
    s_mov_b64 exec, -1
    s_branch gc_35
ps_36:
    s_mov_b32 s84, 1048576
pl_37:
    buffer_load_dword v7, v4, s[16:19], s89 offen offset:0 sc1
    s_waitcnt vmcnt(0)
    s_sub_u32 s84, s84, 1
    s_cbranch_scc1 pc_38
    v_cmp_gt_u32 vcc, 1, v7
    s_nop 0
    s_and_b64 vcc, vcc, s[50:51]
    s_cbranch_scc1 pl_37
    s_branch pc_38
ps_39:
    s_mov_b32 s84, 1048576
pl_40:
    buffer_load_dword v7, v4, s[16:19], s87 offen offset:8 sc1
    s_waitcnt vmcnt(0)
    s_sub_u32 s84, s84, 1
    s_cbranch_scc1 pc_41
    v_cmp_gt_u32 vcc, 12, v7
    s_nop 0
    s_and_b64 vcc, vcc, s[50:51]
    s_cbranch_scc1 pl_40
    s_branch pc_41
gl_42:
    s_add_u32 s82, s86, 0
    v_lshlrev_b32 v2, 10, v1
    v_mov_b32_e64 v5, 1
    s_mov_b64 exec, 255
    buffer_store_dword v5, v2, s[16:19], s82 offen offset:12 sc1
    s_mov_b64 exec, -1
    s_branch gc_43
ps_44:
    s_mov_b32 s84, 1048576
pl_45:
    buffer_load_dword v7, v4, s[16:19], s89 offen offset:0 sc1
    s_waitcnt vmcnt(0)
    s_sub_u32 s84, s84, 1
    s_cbranch_scc1 pc_46
    v_cmp_gt_u32_e64 vcc, 1, v7
    s_nop 0
    s_and_b64 vcc, vcc, s[50:51]
    s_cbranch_scc1 pl_45
    s_branch pc_46
rd_49:
    s_cmp_eq_u32 s38, 0
    s_cbranch_scc1 rc_50
    s_sub_u32 s38, s38, 1
    s_nop 7
    s_nop 7
    s_sleep 4
    s_mov_b64 exec, vcc
    s_add_u32 s26, s3, 9437184
    buffer_load_dwordx4 v[216:219], v236, s[16:19], s26 offen sc1
    s_add_u32 s26, s26, 524288
    buffer_load_dwordx4 v[220:223], v236, s[16:19], s26 offen sc1
    s_add_u32 s26, s26, 524288
    buffer_load_dwordx4 v[224:227], v236, s[16:19], s26 offen sc1
    s_add_u32 s26, s26, 524288
    buffer_load_dwordx4 v[228:231], v236, s[16:19], s26 offen sc1
    s_add_u32 s26, s26, 524288
    buffer_load_dwordx4 v[232:235], v236, s[16:19], s26 offen sc1
    s_mov_b64 exec, -1
    s_waitcnt vmcnt(0) lgkmcnt(0)
    s_branch se_48
gl_52:
    s_add_u32 s82, s86, 16384
    v_lshlrev_b32 v2, 10, v1
    v_mov_b32_e64 v5, 1
    s_mov_b64 exec, 255
    buffer_store_dword v5, v2, s[16:19], s82 offen offset:4 sc1
    s_mov_b64 exec, -1
    s_branch gc_53
ps_54:
    s_mov_b32 s84, 1048576
pl_55:
    buffer_load_dword v7, v4, s[16:19], s87 offen offset:12 sc1
    s_waitcnt vmcnt(0)
    s_sub_u32 s84, s84, 1
    s_cbranch_scc1 pc_56
    v_cmp_gt_u32_e64 vcc, 1, v7
    s_nop 0
    s_and_b64 vcc, vcc, s[50:51]
    s_cbranch_scc1 pl_55
    s_branch pc_56
rd_58:
    s_cmp_eq_u32 s38, 0
    s_cbranch_scc1 rc_59
    s_sub_u32 s38, s38, 1
    s_nop 7
    s_nop 7
    s_sleep 4
    s_mov_b64 exec, vcc
    s_lshl_b32 s98, s72, 5
    s_add_u32 s98, s98, 0
    s_sub_u32 s95, s98, 4
    s_max_i32 s95, s95, 0
    s_lshl_b32 s94, s98, 3
    s_lshl_b32 s95, s95, 3
    s_add_u32 s94, s94, 3457024
    s_add_u32 s95, s95, 3457024
    s_add_u32 s96, s94, 8192
    buffer_load_dwordx2 v[152:153], v47, s[16:19], s94 offen sc1
    buffer_load_dwordx2 v[154:155], v47, s[16:19], s96 offen sc1
    buffer_load_dwordx2 v[156:157], v48, s[16:19], s95 offen sc1
    s_mov_b64 exec, -1
    s_waitcnt vmcnt(0) lgkmcnt(0)
    s_branch sl_57
ps_60:
    s_mov_b32 s84, 1048576
pl_61:
    buffer_load_dword v7, v4, s[16:19], s89 offen offset:4 sc1
    s_waitcnt vmcnt(0)
    s_sub_u32 s84, s84, 1
    s_cbranch_scc1 pc_62
    v_cmp_gt_u32 vcc, 1, v7
    s_nop 0
    s_and_b64 vcc, vcc, s[50:51]
    s_cbranch_scc1 pl_61
    s_branch pc_62
rd_65:
    s_cmp_eq_u32 s38, 0
    s_cbranch_scc1 rc_66
    s_sub_u32 s38, s38, 1
    s_nop 7
    s_nop 7
    s_sleep 4
    s_mov_b64 exec, vcc
    s_add_u32 s26, s3, 9437184
    buffer_load_dwordx4 v[216:219], v236, s[16:19], s26 offen sc1
    s_add_u32 s26, s26, 524288
    buffer_load_dwordx4 v[220:223], v236, s[16:19], s26 offen sc1
    s_add_u32 s26, s26, 524288
    buffer_load_dwordx4 v[224:227], v236, s[16:19], s26 offen sc1
    s_add_u32 s26, s26, 524288
    buffer_load_dwordx4 v[228:231], v236, s[16:19], s26 offen sc1
    s_add_u32 s26, s26, 524288
    buffer_load_dwordx4 v[232:235], v236, s[16:19], s26 offen sc1
    s_mov_b64 exec, -1
    s_waitcnt vmcnt(0) lgkmcnt(0)
    s_branch se_64
rd_67:
    s_cmp_eq_u32 s39, 0
    s_cbranch_scc1 rc_68
    s_sub_u32 s39, s39, 1
    s_nop 7
    s_nop 7
    s_waitcnt vmcnt(0) lgkmcnt(0)
    s_barrier
    s_lshl_b32 s25, s72, 5
    s_add_u32 s25, s25, 0
    s_sub_u32 s26, s25, 4
    s_max_i32 s26, s26, 0
    s_lshl_b32 s27, s71, 12
    s_add_u32 s27, s27, 9437184
    s_lshl_b32 s99, s25, 3
    s_lshl_b32 s100, s26, 3
    s_lshl_b32 s92, s24, 12
    s_lshl_b32 s93, s24, 9
    s_add_u32 s99, s99, s27
    s_add_u32 s100, s100, s27
    s_add_u32 m0, s92, 36352
    s_nop 0
    buffer_load_dwordx4 v73, s[16:19], s99 offen offset:0 sc1 lds
    buffer_load_dwordx4 v74, s[16:19], s99 offen offset:1024 sc1 lds
    buffer_load_dwordx4 v75, s[16:19], s99 offen offset:2048 sc1 lds
    buffer_load_dwordx4 v76, s[16:19], s99 offen offset:3072 sc1 lds
    s_add_u32 m0, s93, 53760
    s_add_u32 s99, s99, 524288
    s_mov_b64 exec, s[80:81]
    buffer_load_dwordx4 v77, s[16:19], s100 offen sc1 lds
    s_mov_b64 exec, -1
    s_add_u32 s100, s100, 524288
    s_add_u32 m0, s92, 55936
    s_nop 0
    s_nop 0
    buffer_load_dwordx4 v73, s[16:19], s99 offen offset:0 sc1 lds
    buffer_load_dwordx4 v74, s[16:19], s99 offen offset:1024 sc1 lds
    buffer_load_dwordx4 v75, s[16:19], s99 offen offset:2048 sc1 lds
    buffer_load_dwordx4 v76, s[16:19], s99 offen offset:3072 sc1 lds
    s_add_u32 m0, s93, 73344
    s_add_u32 s99, s99, 524288
    s_mov_b64 exec, s[80:81]
    buffer_load_dwordx4 v77, s[16:19], s100 offen sc1 lds
    s_mov_b64 exec, -1
    s_add_u32 s100, s100, 524288
    s_mov_b64 exec, -1
    s_waitcnt vmcnt(0) lgkmcnt(0)
    s_branch ge_51
rd_71:
    s_cmp_eq_u32 s38, 0
    s_cbranch_scc1 rc_72
    s_sub_u32 s38, s38, 1
    s_nop 7
    s_nop 7
    s_sleep 4
    s_mov_b64 exec, vcc
    s_lshl_b32 s98, s72, 5
    s_add_u32 s98, s98, 256
    s_sub_u32 s95, s98, 4
    s_max_i32 s95, s95, 0
    s_lshl_b32 s94, s98, 3
    s_lshl_b32 s95, s95, 3
    s_nop 0
    s_add_u32 s94, s94, 3457024
    s_add_u32 s95, s95, 3457024
    s_add_u32 s96, s94, 8192
    buffer_load_dwordx2 v[152:153], v47, s[16:19], s94 offen sc1
    buffer_load_dwordx2 v[154:155], v47, s[16:19], s96 offen sc1
    buffer_load_dwordx2 v[156:157], v48, s[16:19], s95 offen sc1
    s_mov_b64 exec, -1
    s_waitcnt vmcnt(0) lgkmcnt(0)
    s_branch sl_70
rd_73:
    s_cmp_eq_u32 s39, 0
    s_cbranch_scc1 rc_74
    s_sub_u32 s39, s39, 1
    s_nop 7
    s_nop 7
    s_waitcnt vmcnt(0) lgkmcnt(0)
    s_barrier
    s_lshl_b32 s25, s72, 5
    s_add_u32 s25, s25, 256
    s_sub_u32 s26, s25, 4
    s_max_i32 s26, s26, 0
    s_lshl_b32 s27, s71, 12
    s_add_u32 s27, s27, 9437184
    s_lshl_b32 s99, s25, 3
    s_lshl_b32 s100, s26, 3
    s_lshl_b32 s92, s24, 12
    s_lshl_b32 s93, s24, 9
    s_add_u32 s99, s99, s27
    s_add_u32 s100, s100, s27
    s_add_u32 m0, s92, 36352
    s_nop 0
    s_nop 0
    buffer_load_dwordx4 v73, s[16:19], s99 offen offset:0 sc1 lds
    buffer_load_dwordx4 v74, s[16:19], s99 offen offset:1024 sc1 lds
    buffer_load_dwordx4 v75, s[16:19], s99 offen offset:2048 sc1 lds
    buffer_load_dwordx4 v76, s[16:19], s99 offen offset:3072 sc1 lds
    s_add_u32 m0, s93, 53760
    s_add_u32 s99, s99, 524288
    s_mov_b64 exec, s[80:81]
    buffer_load_dwordx4 v77, s[16:19], s100 offen sc1 lds
    s_mov_b64 exec, -1
    s_add_u32 s100, s100, 524288
    s_add_u32 m0, s92, 55936
    s_nop 0
    s_nop 0
    buffer_load_dwordx4 v73, s[16:19], s99 offen offset:0 sc1 lds
    buffer_load_dwordx4 v74, s[16:19], s99 offen offset:1024 sc1 lds
    buffer_load_dwordx4 v75, s[16:19], s99 offen offset:2048 sc1 lds
    buffer_load_dwordx4 v76, s[16:19], s99 offen offset:3072 sc1 lds
    s_add_u32 m0, s93, 73344
    s_add_u32 s99, s99, 524288
    s_mov_b64 exec, s[80:81]
    buffer_load_dwordx4 v77, s[16:19], s100 offen sc1 lds
    s_mov_b64 exec, -1
    s_add_u32 s100, s100, 524288
    s_add_u32 m0, s92, 75520
    s_nop 0
    s_nop 0
    buffer_load_dwordx4 v73, s[16:19], s99 offen offset:0 sc1 lds
    buffer_load_dwordx4 v74, s[16:19], s99 offen offset:1024 sc1 lds
    buffer_load_dwordx4 v75, s[16:19], s99 offen offset:2048 sc1 lds
    buffer_load_dwordx4 v76, s[16:19], s99 offen offset:3072 sc1 lds
    s_add_u32 m0, s93, 92928
    s_add_u32 s99, s99, 524288
    s_mov_b64 exec, s[80:81]
    buffer_load_dwordx4 v77, s[16:19], s100 offen sc1 lds
    s_mov_b64 exec, -1
    s_add_u32 s100, s100, 524288
    s_mov_b64 exec, -1
    s_waitcnt vmcnt(0) lgkmcnt(0)
    s_branch ge_69
rd_76:
    s_cmp_eq_u32 s38, 0
    s_cbranch_scc1 rc_77
    s_sub_u32 s38, s38, 1
    s_nop 7
    s_nop 7
    s_sleep 4
    s_mov_b64 exec, vcc
    s_mov_b32 s96, 12058624
    buffer_load_dwordx4 v[216:219], v56, s[16:19], s96 offen offset:0 sc1
    buffer_load_dwordx4 v[220:223], v56, s[16:19], s96 offen offset:256 sc1
    s_mov_b32 s96, 12091392
    buffer_load_dwordx4 v[224:227], v56, s[16:19], s96 offen offset:0 sc1
    buffer_load_dwordx4 v[228:231], v56, s[16:19], s96 offen offset:256 sc1
    s_mov_b32 s96, 12124160
    buffer_load_dwordx4 v[232:235], v56, s[16:19], s96 offen offset:0 sc1
    buffer_load_dwordx4 v[236:239], v56, s[16:19], s96 offen offset:256 sc1
    s_mov_b32 s96, 12156928
    buffer_load_dwordx4 v[240:243], v56, s[16:19], s96 offen offset:0 sc1
    buffer_load_dwordx4 v[244:247], v56, s[16:19], s96 offen offset:256 sc1
    s_mov_b32 s96, 12058624
    buffer_load_dwordx2 v[248:249], v57, s[16:19], s96 offen offset:0 sc1
    buffer_load_dwordx2 v[252:253], v57, s[16:19], s96 offen offset:128 sc1
    s_mov_b32 s96, 12075008
    buffer_load_dwordx2 v[250:251], v57, s[16:19], s96 offen offset:0 sc1
    buffer_load_dwordx2 v[254:255], v57, s[16:19], s96 offen offset:128 sc1
    s_mov_b32 s96, 9437184
    buffer_load_dwordx4 v[208:211], v59, s[16:19], s96 offen sc1
    s_add_u32 s97, s36, 9437184
    buffer_load_dword v212, v61, s[16:19], s97 offen sc1
    s_mov_b64 exec, -1
    s_waitcnt vmcnt(0) lgkmcnt(0)
    s_branch oe_75
rd_79:
    s_cmp_eq_u32 s38, 0
    s_cbranch_scc1 rc_80
    s_sub_u32 s38, s38, 1
    s_nop 7
    s_nop 7
    s_sleep 4
    s_mov_b64 exec, vcc
    s_mov_b32 s96, 12062720
    buffer_load_dwordx4 v[216:219], v56, s[16:19], s96 offen offset:0 sc1
    buffer_load_dwordx4 v[220:223], v56, s[16:19], s96 offen offset:256 sc1
    s_mov_b32 s96, 12095488
    buffer_load_dwordx4 v[224:227], v56, s[16:19], s96 offen offset:0 sc1
    buffer_load_dwordx4 v[228:231], v56, s[16:19], s96 offen offset:256 sc1
    s_mov_b32 s96, 12128256
    buffer_load_dwordx4 v[232:235], v56, s[16:19], s96 offen offset:0 sc1
    buffer_load_dwordx4 v[236:239], v56, s[16:19], s96 offen offset:256 sc1
    s_mov_b32 s96, 12161024
    buffer_load_dwordx4 v[240:243], v56, s[16:19], s96 offen offset:0 sc1
    buffer_load_dwordx4 v[244:247], v56, s[16:19], s96 offen offset:256 sc1
    s_mov_b32 s96, 12060672
    buffer_load_dwordx2 v[248:249], v57, s[16:19], s96 offen offset:0 sc1
    buffer_load_dwordx2 v[252:253], v57, s[16:19], s96 offen offset:128 sc1
    s_mov_b32 s96, 12077056
    buffer_load_dwordx2 v[250:251], v57, s[16:19], s96 offen offset:0 sc1
    buffer_load_dwordx2 v[254:255], v57, s[16:19], s96 offen offset:128 sc1
    s_mov_b32 s96, 9439232
    buffer_load_dwordx4 v[208:211], v59, s[16:19], s96 offen sc1
    s_add_u32 s97, s36, 9439232
    buffer_load_dword v212, v61, s[16:19], s97 offen sc1
    s_mov_b64 exec, -1
    s_waitcnt vmcnt(0) lgkmcnt(0)
    s_branch oe_78
rd_84:
    s_cmp_eq_u32 s38, 0
    s_cbranch_scc1 rc_85
    s_sub_u32 s38, s38, 1
    s_nop 7
    s_nop 7
    s_sleep 4
    s_mov_b64 exec, vcc
    s_lshl_b32 s96, s75, 14
    s_add_u32 s96, s96, 14680064
    s_lshl_b32 s97, s24, 12
    s_add_u32 s97, s97, 3506176
    buffer_load_dwordx4 v[176:179], v62, s[16:19], s96 offen offset:0 sc1
    buffer_load_dwordx4 v[180:183], v62, s[16:19], s96 offen offset:1024 sc1
    buffer_load_dwordx4 v[184:187], v62, s[16:19], s97 offen offset:0 sc1
    buffer_load_dwordx4 v[188:191], v62, s[16:19], s97 offen offset:1024 sc1
    buffer_load_dwordx4 v[192:195], v62, s[16:19], s97 offen offset:2048 sc1
    buffer_load_dwordx4 v[196:199], v62, s[16:19], s97 offen offset:3072 sc1
    s_mov_b64 exec, -1
    s_waitcnt vmcnt(0) lgkmcnt(0)
    s_branch ce_83
rd_87:
    s_cmp_eq_u32 s38, 0
    s_cbranch_scc1 rc_88
    s_sub_u32 s38, s38, 1
    s_nop 7
    s_nop 7
    s_sleep 4
    s_mov_b64 exec, vcc
    s_lshl_b32 s96, s75, 14
    s_add_u32 s96, s96, 14680064
    s_lshl_b32 s97, s24, 12
    s_add_u32 s97, s97, 3510272
    buffer_load_dwordx4 v[248:251], v62, s[16:19], s96 offen offset:2048 sc1
    buffer_load_dwordx4 v[252:255], v62, s[16:19], s96 offen offset:3072 sc1
    buffer_load_dwordx4 v[96:99], v62, s[16:19], s97 offen offset:0 sc1
    buffer_load_dwordx4 v[100:103], v62, s[16:19], s97 offen offset:1024 sc1
    buffer_load_dwordx4 v[104:107], v62, s[16:19], s97 offen offset:2048 sc1
    buffer_load_dwordx4 v[108:111], v62, s[16:19], s97 offen offset:3072 sc1
    s_mov_b64 exec, -1
    s_waitcnt vmcnt(0) lgkmcnt(0)
    s_branch ce_86
L_last:
    s_endpgm
.section .rodata,"a"
.p2align 6
.amdhsa_kernel interleave_layers__sliding_local_dilated__ssm_conv_s4d__prompt_kernel
  .amdhsa_next_free_vgpr 512
  .amdhsa_next_free_sgpr 102
  .amdhsa_accum_offset 256
  .amdhsa_group_segment_fixed_size 0
  .amdhsa_kernarg_size 104
  .amdhsa_user_sgpr_count 2
  .amdhsa_user_sgpr_kernarg_segment_ptr 1
  .amdhsa_system_sgpr_workgroup_id_x 1
.end_amdhsa_kernel
```

```asm
; @launch grid=(256,1,1) block=(256,1,1) lds=163840
.amdgcn_target "amdgcn-amd-amdhsa--gfx950"
.text
.globl interleave_layers__sliding_local_dilated__ssm_conv_s4d__prompt_kernel
.p2align 8
.type interleave_layers__sliding_local_dilated__ssm_conv_s4d__prompt_kernel,@function
interleave_layers__sliding_local_dilated__ssm_conv_s4d__prompt_kernel:
    s_getpc_b64 s[42:43]
L_start:
    s_cmp_ge_u32 s2, 256
    s_cbranch_scc1 L_end
    s_load_dwordx16 s[44:59], s[0:1], 0
    s_load_dwordx8 s[60:67], s[0:1], 64
    s_load_dwordx2 s[68:69], s[0:1], 96
    v_and_b32 v1, 63, v0
    v_lshrrev_b32 v2, 6, v0
    s_nop 0
    v_readfirstlane_b32 s24, v2
    s_bfe_u32 s82, s2, 0x40003
    s_lshl_b32 s82, s82, 13
    v_lshrrev_b32 v159, 2, v0
    v_lshl_add_u32 v159, v159, 7, s82
    v_min_u32 v159, L_last-L_start, v159
    global_load_dword v159, v159, s[42:43]
    s_and_b32 s25, s2, 7
    s_lshr_b32 s26, s2, 3
    s_and_b32 s27, s26, 3
    s_lshr_b32 s28, s26, 4
    s_lshl_b32 s28, s28, 2
    s_add_u32 s3, s27, s28
    s_lshl_b32 s27, s3, 2
    s_lshr_b32 s70, 0x75206431, s27
    s_and_b32 s70, s70, 7
    s_and_b32 s27, s25, 1
    s_lshl_b32 s27, s27, 3
    s_add_u32 s70, s70, s27
    s_bfe_u32 s71, s26, 0x10002
    s_bfe_u32 s28, s26, 0x10003
    s_and_b32 s72, s25, 6
    s_add_u32 s72, s72, s28
    s_and_b32 s73, s26, 7
    s_lshr_b32 s28, s26, 3
    s_lshl_b32 s74, s25, 2
    s_add_u32 s74, s74, s28
    s_mul_i32 s75, s25, 20
    s_add_u32 s75, s75, s26
    s_min_u32 s27, s2, 239
    s_mul_i32 s25, s27, 10923
    s_lshr_b32 s25, s25, 16
    s_mul_i32 s26, s25, 6
    s_sub_u32 s26, s27, s26
    s_mul_i32 s27, s25, 61440
    s_mul_i32 s28, s26, 640
    s_add_u32 s27, s27, s28
    s_lshl_b32 s28, s24, 10
    v_add_u32 v85, 0, v0
    v_mul_u32_u24 v84, 1639, v85
    v_lshrrev_b32 v84, 16, v84
    v_mul_u32_u24 v84, 3200, v84
    v_lshl_add_u32 v85, v85, 4, v84
    v_add_u32 v86, 256, v0
    v_mul_u32_u24 v84, 1639, v86
    v_lshrrev_b32_e64 v84, 16, v84
    v_mul_u32_u24 v84, 3200, v84
    v_lshl_add_u32 v86, v86, 4, v84
    v_add_u32 v87, 512, v0
    v_min_u32 v87, 639, v87
    v_mul_u32_u24 v84, 1639, v87
    v_lshrrev_b32_e64 v84, 16, v84
    v_mul_u32_u24 v84, 3200, v84
    v_lshl_add_u32 v87, v87, 4, v84
    s_mov_b32 s76, 0
    s_mov_b32 s77, 0x80000000
    s_mov_b32 s80, -1
    s_mov_b32 s81, 0
    s_nop 0
    s_mov_b32 s78, 0xfe0000fe
    s_mov_b32 s79, 0xfe0000fe
    s_mov_b32 s6, 2621440
    s_mov_b32 s7, 0x20000
    s_mov_b32 s10, 2457600
    s_mov_b32 s11, 0x20000
    s_mov_b32 s14, 819200
    s_mov_b32 s15, 0x20000
    s_mov_b32 s18, 22061056
    s_mov_b32 s19, 0x20000
    s_mov_b32 s22, 2621440
    s_mov_b32 s23, 0x20000
    s_waitcnt lgkmcnt(0)
    s_mov_b32 s4, s44
    s_and_b32 s5, s45, 0xffff
    s_mov_b32 s8, s46
    s_and_b32 s9, s47, 0xffff
    s_mov_b32 s12, s48
    s_and_b32 s13, s49, 0xffff
    s_mov_b32 s16, s68
    s_and_b32 s17, s69, 0xffff
    s_mov_b32 s20, s64
    s_and_b32 s21, s65, 0xffff
    s_cmp_lg_u32 s2, 255
    s_cbranch_scc1 fz_1
    v_mov_b32 v120, 0
    v_mov_b32 v121, 0
    v_mov_b32 v122, 0
    v_mov_b32 v123, 0
    v_lshlrev_b32 v124, 4, v0
    s_mov_b32 s88, 3538944
    buffer_store_dwordx4 v[120:123], v124, s[16:19], s88 offen sc1
    s_mov_b32 s88, 3543040
    buffer_store_dwordx4 v[120:123], v124, s[16:19], s88 offen sc1
    s_mov_b32 s88, 3547136
    buffer_store_dwordx4 v[120:123], v124, s[16:19], s88 offen sc1
    s_mov_b32 s88, 3555328
    buffer_store_dwordx4 v[120:123], v124, s[16:19], s88 offen sc1
    s_mov_b32 s88, 3559424
    buffer_store_dwordx4 v[120:123], v124, s[16:19], s88 offen sc1
    s_mov_b32 s88, 3563520
    buffer_store_dwordx4 v[120:123], v124, s[16:19], s88 offen sc1
fz_1:
    s_min_u32 s96, s75, 159
    s_lshl_b32 s96, s96, 2
    s_add_u32 s96, s96, s24
    s_mul_i32 s97, s96, 384
    s_lshl_b32 s96, s96, 1
    v_lshl_add_u32 v2, v1, 2, s97
    v_mov_b32 v241, s96
    global_load_dword v232, v2, s[52:53]
    global_load_dword v233, v2, s[54:55]
    global_load_dword v234, v2, s[56:57]
    global_load_dword v235, v2, s[58:59]
    global_load_ushort v240, v241, s[60:61]
    s_add_u32 m0, s28, 134272
    s_nop 0
    buffer_load_dwordx4 v85, s[8:11], s27 offen lds
    s_add_u32 m0, s28, 138368
    s_nop 0
    buffer_load_dwordx4 v86, s[8:11], s27 offen lds
    s_add_u32 m0, s28, 142464
    s_nop 0
    buffer_load_dwordx4 v87, s[8:11], s27 offen lds
    s_lshr_b32 s29, s26, 1
    s_and_b32 s30, s26, 1
    s_lshl_b32 s30, s30, 3
    s_lshl_b32 s31, s25, 10
    s_add_u32 s31, s31, 0
    s_cmp_ge_u32 s2, 240
    s_cselect_b32 s31, 1073741824, s31
    v_bfe_u32 v93, v0, 2, 2
    v_bfe_u32 v92, v0, 1, 1
    v_lshl_add_u32 v92, v92, 3, v93
    v_mul_u32_u24 v92, 640, v92
    v_and_b32 v93, 1, v0
    v_mul_u32_u24 v93, 40, v93
    v_add_u32 v91, v92, v93
    v_add_u32 v91, 134272, v91
    v_lshrrev_b32 v88, 4, v0
    v_add_u32 v88, 0, v88
    v_cmp_gt_u32 vcc, 40, v88
    v_min_u32 v88, 39, v88
    v_mul_u32_u24 v89, 13108, v88
    v_lshrrev_b32 v89, 16, v89
    v_mul_u32_u24 v90, 5, v89
    v_sub_u32_e64 v90, v88, v90
    v_mul_u32_u24 v92, 80, v89
    v_lshl_add_u32 v92, v90, 3, v92
    v_add_u32 v111, v92, v91
    v_add_u32 v89, s30, v89
    v_cmp_eq_u32 s[82:83], 4, v90
    v_mov_b32 v92, s29
    s_nop 0
    v_cndmask_b32 v93, v90, v92, s[82:83]
    v_cndmask_b32 v92, v92, 3, s[82:83]
    v_lshl_add_u32 v89, v89, 2, v93
    v_mul_u32_u24 v89, 40960, v89
    v_lshl_add_u32 v89, v92, 8, v89
    v_and_b32 v92, 15, v0
    v_lshl_add_u32 v89, v92, 4, v89
    v_mov_b32 v92, 1073741824
    v_cndmask_b32 v89, v92, v89, vcc
    v_add_u32 v108, s31, v89
    v_lshrrev_b32 v88, 4, v0
    v_add_u32 v88, 16, v88
    v_cmp_gt_u32 vcc, 40, v88
    v_min_u32 v88, 39, v88
    v_mul_u32_u24 v89, 13108, v88
    v_lshrrev_b32 v89, 16, v89
    v_mul_u32_u24 v90, 5, v89
    v_sub_u32_e64 v90, v88, v90
    v_mul_u32_u24 v92, 80, v89
    v_lshl_add_u32 v92, v90, 3, v92
    v_add_u32 v112, v92, v91
    v_add_u32 v89, s30, v89
    v_cmp_eq_u32 s[82:83], 4, v90
    v_mov_b32 v92, s29
    s_nop 0
    v_cndmask_b32 v93, v90, v92, s[82:83]
    v_cndmask_b32 v92, v92, 3, s[82:83]
    v_lshl_add_u32 v89, v89, 2, v93
    v_mul_u32_u24 v89, 40960, v89
    v_lshl_add_u32 v89, v92, 8, v89
    v_and_b32 v92, 15, v0
    v_lshl_add_u32 v89, v92, 4, v89
    v_mov_b32 v92, 1073741824
    v_cndmask_b32 v89, v92, v89, vcc
    v_add_u32 v109, s31, v89
    v_lshrrev_b32 v88, 4, v0
    v_add_u32 v88, 32, v88
    v_cmp_gt_u32 vcc, 40, v88
    v_min_u32 v88, 39, v88
    v_mul_u32_u24 v89, 13108, v88
    v_lshrrev_b32 v89, 16, v89
    v_mul_u32_u24 v90, 5, v89
    v_sub_u32_e64 v90, v88, v90
    v_mul_u32_u24 v92, 80, v89
    v_lshl_add_u32 v92, v90, 3, v92
    v_add_u32 v113, v92, v91
    v_add_u32 v89, s30, v89
    v_cmp_eq_u32 s[82:83], 4, v90
    v_mov_b32 v92, s29
    s_nop 0
    v_cndmask_b32 v93, v90, v92, s[82:83]
    v_cndmask_b32 v92, v92, 3, s[82:83]
    v_lshl_add_u32 v89, v89, 2, v93
    v_mul_u32_u24 v89, 40960, v89
    v_lshl_add_u32 v89, v92, 8, v89
    v_and_b32 v92, 15, v0
    v_lshl_add_u32 v89, v92, 4, v89
    v_mov_b32 v92, 1073741824
    v_cndmask_b32 v89, v92, v89, vcc
    v_add_u32 v110, s31, v89
    s_mul_i32 s25, s3, 18
    s_lshl_b32 s26, s72, 7
    s_add_u32 s25, s25, s26
    s_add_u32 s25, s25, s71
    s_add_u32 s25, s25, -16
    s_max_i32 s25, s25, 0
    s_mul_i32 s25, s25, 1280
    v_lshrrev_b32_e64 v204, 1, v0
    v_min_u32 v204, 89, v204
    v_mul_u32_u24 v205, 6554, v204
    v_lshrrev_b32_e64 v205, 16, v205
    v_mul_u32_u24 v205, 1280, v205
    v_lshl_add_u32 v204, v204, 7, v205
    buffer_load_dword v204, v204, s[4:7], s25 offen
    s_and_b32 s25, s2, 7
    s_lshl_b32 s86, s25, 7
    s_add_u32 s86, s86, 3538944
    s_lshl_b32 s87, s25, 10
    s_add_u32 s87, s87, 3538944
    s_add_u32 s89, s87, 16384
    v_cmp_gt_u32 s[50:51], 8, v0
    v_cmp_eq_u32 vcc, 0, v0
    v_lshlrev_b32 v4, 7, v1
    v_mov_b32 v6, 1073741824
    v_cndmask_b32 v4, v6, v4, s[50:51]
    v_cndmask_b32 v6, v6, 0, vcc
    v_mov_b32 v5, 0
    v_mov_b32 v140, 0
    v_mov_b32_e64 v141, 0
    v_mov_b32 v142, 0x3f803f80
    v_mov_b32 v143, 0x3f803f80
    v_lshlrev_b32_e64 v144, 3, v0
    v_add_u32 v144, 155648, v144
    ds_write_b64 v144, v[140:141]
    ds_write_b64 v144, v[142:143] offset:2048
    v_and_b32 v50, 31, v1
    v_lshrrev_b32 v51, 5, v1
    v_mul_u32_u24 v52, 40, v50
    v_mul_u32_u24 v53, 3200, v51
    v_add_u32 v53, v52, v53
    s_lshl_b32 s25, s24, 3
    s_add_u32 s25, s25, 320
    v_add_u32 v38, s25, v53
    s_mul_i32 s25, s24, 6400
    s_add_u32 s25, s25, 352
    v_add_u32 v39, s25, v53
    s_lshl_b32 s31, s71, 12
    v_lshl_add_u32 v47, v50, 3, s31
    v_bfe_u32 v52, v1, 2, 1
    v_and_b32 v53, 3, v1
    v_lshlrev_b32 v54, 13, v52
    v_lshl_add_u32 v54, v53, 3, v54
    v_add_u32_e64 v48, s31, v54
    v_bfe_u32 v54, v1, 4, 1
    v_lshl_add_u32 v52, v54, 1, v52
    v_mul_u32_u24 v52, 40, v52
    v_add_u32 v52, v52, v53
    v_mul_u32_u24_e64 v52, 40, v52
    v_bfe_u32 v53, v1, 3, 1
    v_cmp_eq_u32 s[82:83], v53, v54
    v_lshl_add_u32 v53, v53, 1, v51
    v_cmp_eq_u32 vcc, 3, v53
    v_mov_b32 v54, s24
    s_nop 0
    v_cndmask_b32 v53, v53, v54, vcc
    v_cndmask_b32 v54, v54, 4, vcc
    v_mul_u32_u24 v53, 6400, v53
    v_lshl_add_u32 v52, v54, 3, v52
    v_add_u32_e64 v52, v52, v53
    v_add_u32 v40, 160, v52
    v_mov_b32 v52, 19584
    v_cndmask_b32 v49, 0, v52, s[78:79]
    v_and_b32 v50, 15, v1
    v_lshrrev_b32 v51, 4, v1
    s_and_b32 s25, s24, 1
    s_and_b32 s26, s24, 2
    s_mul_i32 s27, s25, 3200
    s_mul_i32 s28, s26, 320
    s_add_u32 s27, s27, s28
    s_add_u32 s27, s27, 0
    v_and_b32 v52, 1, v1
    v_mul_u32_u24 v52, 1600, v52
    v_lshrrev_b32 v53, 1, v50
    v_mul_u32_u24_e64 v54, 40, v53
    v_add3_u32 v52, v52, v54, s27
    v_lshl_add_u32 v41, v51, 3, v52
    v_add_u32_e64 v42, 32, v52
    v_bfe_u32 v52, v1, 2, 1
    v_mul_u32_u24 v52, 1600, v52
    v_lshrrev_b32 v54, 3, v1
    v_mul_u32_u24 v54, 40, v54
    v_add3_u32 v52, v52, v54, s27
    v_add_u32 v52, 12800, v52
    v_and_b32 v54, 3, v1
    v_lshl_add_u32 v43, v54, 3, v52
    v_add_u32 v52, 32, v52
    v_cmp_eq_u32 vcc, 0, v54
    v_mov_b32 v54, 157696
    s_nop 0
    v_cndmask_b32 v44, v54, v52, vcc
    v_and_b32 v52, 1, v51
    v_add_u32 v52, s26, v52
    v_lshrrev_b32 v54, 2, v50
    v_lshl_add_u32 v52, v52, 2, v54
    v_and_b32 v53, 1, v53
    v_lshl_add_u32 v52, v53, 4, v52
    v_and_b32 v53, 1, v50
    v_lshl_add_u32 v52, v53, 10, v52
    s_lshl_b32 s30, s70, 1
    s_add_u32 s30, s30, s25
    s_lshl_b32 s29, s30, 3
    s_add_u32 s29, s29, s71
    s_lshl_b32 s29, s29, 13
    v_lshrrev_b32 v53, 1, v51
    v_lshlrev_b32 v53, 15, v53
    v_lshl_add_u32 v53, v52, 4, v53
    v_add_u32_e64 v45, s29, v53
    s_lshl_b32 s29, s30, 2
    s_add_u32 s29, s29, s71
    s_lshl_b32 s29, s29, 12
    s_add_u32 s29, s29, 2097152
    v_lshl_add_u32 v46, v52, 3, s29
    s_or_b32 s29, s26, s72
    s_cmp_eq_u32 s29, 0
    s_cselect_b64 s[90:91], -1, 0
    v_lshlrev_b32 v52, 2, v51
    v_sub_u32 v52, v50, v52
    v_mov_b32 v55, 0xf149f2ca
    v_subrev_u32 v53, 0, v52
    v_cmp_lt_u32 vcc, 7, v53
    s_nop 1
    v_cndmask_b32 v28, 0, v55, vcc
    v_cmp_lt_i32 vcc, -9, v53
    s_nop 1
    v_cndmask_b32 v32, 0, v55, vcc
    v_cmp_le_i32 vcc, 0, v53
    v_mov_b32 v54, 0xffff
    s_nop 0
    v_cndmask_b32 v54, 0, v54, vcc
    v_mov_b32 v36, v54
    v_subrev_u32 v53, 1, v52
    v_cmp_lt_u32 vcc, 7, v53
    s_nop 1
    v_cndmask_b32 v29, 0, v55, vcc
    v_cmp_lt_i32 vcc, -9, v53
    s_nop 1
    v_cndmask_b32 v33, 0, v55, vcc
    v_cmp_le_i32 vcc, 0, v53
    v_mov_b32 v54, 0xffff0000
    s_nop 0
    v_cndmask_b32 v54, 0, v54, vcc
    v_or_b32 v36, v36, v54
    v_subrev_u32 v53, 2, v52
    v_cmp_lt_u32 vcc, 7, v53
    s_nop 1
    v_cndmask_b32 v30, 0, v55, vcc
    v_cmp_lt_i32 vcc, -9, v53
    s_nop 1
    v_cndmask_b32 v34, 0, v55, vcc
    v_cmp_le_i32 vcc, 0, v53
    v_mov_b32 v54, 0xffff
    s_nop 0
    v_cndmask_b32 v54, 0, v54, vcc
    v_mov_b32 v37, v54
    v_subrev_u32 v53, 3, v52
    v_cmp_lt_u32 vcc, 7, v53
    s_nop 1
    v_cndmask_b32 v31, 0, v55, vcc
    v_cmp_lt_i32 vcc, -9, v53
    s_nop 1
    v_cndmask_b32 v35, 0, v55, vcc
    v_cmp_le_i32 vcc, 0, v53
    v_mov_b32 v54, 0xffff0000
    s_nop 0
    v_cndmask_b32 v54, 0, v54, vcc
    v_or_b32 v37, v37, v54
    v_and_b32 v62, 15, v1
    v_lshrrev_b32 v63, 4, v1
    s_and_b32 s25, s74, 3
    s_lshr_b32 s26, s74, 2
    s_lshl_b32 s27, s24, 6
    s_add_u32 s27, s27, s25
    s_lshl_b32 s27, s27, 13
    s_lshl_b32 s28, s26, 9
    s_add_u32 s27, s27, s28
    v_lshl_add_u32 v64, v63, 17, s27
    v_lshl_add_u32 v56, v62, 4, v64
    s_lshl_b32 s27, s24, 5
    s_add_u32 s27, s27, s25
    s_lshl_b32 s27, s27, 12
    s_lshl_b32 s28, s26, 8
    s_add_u32 s27, s27, s28
    s_add_u32 s27, s27, 2097152
    v_lshl_add_u32 v64, v63, 15, s27
    v_lshl_add_u32 v57, v62, 3, v64
    v_lshlrev_b32 v58, 4, v1
    s_lshl_b32 s29, s25, 12
    s_add_u32 s29, s29, s28
    v_lshl_add_u32 v64, v62, 4, s29
    v_lshl_add_u32 v61, v63, 2, v64
    s_mul_i32 s30, s73, 20
    s_lshl_b32 s31, s24, 2
    s_add_u32 s30, s30, s31
    s_lshl_b32 s31, s30, 14
    v_lshl_add_u32 v64, v63, 14, v64
    v_add_u32 v59, s31, v64
    s_lshl_b32 s31, s26, 7
    s_add_u32 s31, s31, s25
    s_mul_i32 s31, s31, 1280
    s_lshl_b32 s30, s30, 3
    s_add_u32 s31, s31, s30
    v_mul_u32_u24 v64, 10240, v62
    v_lshl_add_u32 v64, v63, 3, v64
    v_add_u32_e64 v60, s31, v64
    s_lshl_b32 s25, s24, 12
    v_lshl_add_u32 v62, v1, 4, s25
    s_mul_i32 s25, s24, 1216
    s_add_u32 s25, s25, 192
    v_lshl_add_u32 v63, v1, 2, s25
    s_mul_i32 s25, s24, 4864
    s_add_u32 s25, s25, 80
    v_and_b32_e64 v70, 3, v1
    v_mul_u32_u24 v70, 1216, v70
    v_bfe_u32 v71, v1, 2, 3
    v_lshl_add_u32 v70, v71, 4, v70
    v_lshrrev_b32 v71, 5, v1
    v_lshl_add_u32 v70, v71, 4, v70
    v_add_u32 v64, s25, v70
    s_mul_i32 s25, s24, 4160
    s_add_u32 s25, s25, 134368
    v_lshlrev_b32 v71, 6, v71
    v_sub_u32 v71, s25, v71
    v_bfe_u32 v70, v1, 4, 1
    v_lshl_add_u32 v71, v70, 5, v71
    v_and_b32_e64 v70, 3, v1
    v_lshl_add_u32 v71, v70, 3, v71
    v_bfe_u32 v70, v1, 2, 2
    v_lshlrev_b32 v70, 3, v70
    v_sub_u32 v65, v71, v70
    s_mul_i32 s25, s24, 4224
    s_add_u32 s25, s25, 19456
    v_and_b32 v70, 3, v1
    v_mul_u32_u24 v70, 1056, v70
    v_and_b32 v71, 60, v1
    v_add3_u32 v66, v70, v71, s25
    s_mul_i32 s25, s24, 1056
    s_add_u32 s25, s25, 19456
    v_lshl_add_u32 v67, v1, 3, s25
    s_mul_i32 s25, s24, 1280
    s_lshl_b32 s26, s75, 3
    s_add_u32 s25, s25, s26
    v_mul_u32_u24 v70, 10240, v1
    v_add_u32 v68, s25, v70
    s_and_b32 s25, s24, 1
    s_lshl_b32 s25, s25, 6
    s_and_b32 s26, s24, 2
    s_add_u32 s25, s25, s26
    s_mul_i32 s25, s25, 1280
    v_lshrrev_b32 v140, 4, v1
    v_and_b32 v141, 15, v1
    v_xor_b32 v141, v140, v141
    v_lshlrev_b32_e64 v141, 4, v141
    v_mul_u32_u24 v142, 5120, v140
    v_add3_u32 v73, v141, v142, s25
    s_and_b32 s25, s24, 1
    s_lshl_b32 s25, s25, 3
    s_add_u32 s25, s25, s26
    s_mul_i32 s25, s25, 1280
    v_add3_u32 v77, v141, v142, s25
    v_lshrrev_b32 v141, 5, v1
    v_and_b32 v140, 3, v1
    v_xor_b32 v142, v140, v141
    v_lshlrev_b32_e64 v142, 4, v142
    v_lshl_add_u32 v142, v140, 8, v142
    v_bfe_u32 v140, v1, 2, 3
    v_mul_u32_u24 v140, 1088, v140
    v_add_u32 v78, v140, v142
    v_and_b32 v140, 1, v1
    v_xor_b32 v142, v140, v141
    v_lshlrev_b32 v142, 4, v142
    v_lshl_add_u32 v142, v140, 8, v142
    v_bfe_u32 v140, v1, 1, 2
    v_mul_u32_u24 v140, 544, v140
    v_add_u32_e64 v142, v140, v142
    v_add_u32 v74, 19392, v73
    v_add_u32 v75, 38784, v73
    v_add_u32 v76, 58176, v73
    v_add_u32 v142, 53760, v142
    v_and_b32 v140, 31, v1
    v_cmp_eq_u32 vcc, 0, v140
    v_cmp_eq_u32 s[82:83], 24, v140
    s_nop 0
    s_or_b64 vcc, vcc, s[82:83]
    v_mov_b32 v140, 155648
    v_mov_b32 v141, 157696
    v_cndmask_b32_e64 v140, v140, v141, vcc
    v_cndmask_b32 v79, v140, v142, s[78:79]
    v_bfe_u32 v201, v1, 3, 2
    v_and_b32 v202, s24, v201
    v_cmp_eq_u32 vcc, 3, v202
    v_lshrrev_b32 v202, 5, v1
    v_lshl_add_u32 v201, v201, 1, v202
    v_and_b32 v202, 7, v1
    v_lshl_add_u32 v201, v201, 3, v202
    v_lshlrev_b32 v200, 4, v201
    v_mov_b32 v201, 1073741824
    v_cndmask_b32 v200, v200, v201, vcc
    s_lshl_b32 s101, s70, 2
    s_add_u32 s101, s101, s24
    s_mul_i32 s101, s101, 40960
    s_add_u32 s101, s101, 0
    s_lshl_b32 s25, s72, 5
    s_add_u32 s25, s25, 0
    s_sub_u32 s26, s25, 4
    s_max_i32 s26, s26, 0
    s_mul_i32 s27, s71, 1280
    s_mul_i32 s99, s25, 5120
    s_mul_i32 s100, s26, 5120
    s_mul_i32 s92, s24, 4352
    s_mul_i32 s93, s24, 544
    s_add_u32 s99, s99, s27
    s_add_u32 s100, s100, s27
    s_mov_b32 s38, 0x10000
    s_mov_b32 s39, 0x1000
    s_cmp_ge_u32 s2, 160
    s_cbranch_scc1 nc_2
    s_mul_i32 s37, s24, 8704
    s_add_u32 s25, s37, 0
    s_add_u32 s37, s37, 0
    s_mov_b32 m0, s37
    v_and_b32 v199, 31, v1
    v_mul_u32_u24 v199, 272, v199
    v_lshrrev_b32 v215, 5, v1
    v_lshl_add_u32 v199, v215, 4, v199
    v_add_u32 v252, s25, v199
    s_waitcnt vmcnt(4)
    v_lshlrev_b32 v253, 16, v240
    v_mul_f32 v253, 0x3fb8aa3b, v253
    v_exp_f32 v253, v253
    s_nop 0
    v_cvt_pk_bf16_f32 v253, v253, v253
    v_lshlrev_b32 v253, 16, v253
    v_lshlrev_b32 v199, 16, v232
    v_mul_f32 v199, 0x3fb8aa3b, v199
    v_exp_f32 v199, v199
    v_lshlrev_b32 v255, 16, v233
    v_mul_f32 v255, v255, v253
    v_mul_f32 v255, 0x3e22f983, v255
    v_cvt_pk_bf16_f32 v199, v199, v199
    v_lshlrev_b32 v199, 16, v199
    v_mul_f32_e64 v254, v199, v253
    v_mul_f32 v254, 0xbfb8aa3b, v254
    v_mul_f32 v182, 0x41000000, v254
    v_mul_f32 v185, 0x41000000, v255
    v_mul_f32 v184, 0x43800000, v254
    v_mul_f32 v189, 0x43800000, v255
    v_fract_f32 v185, v185
    v_fract_f32 v188, v255
    v_fract_f32 v189, v189
    v_exp_f32 v182, v182
    v_exp_f32 v183, v254
    v_exp_f32 v184, v184
    v_cos_f32 v186, v185
    v_sin_f32 v187, v185
    v_cos_f32 v180, v188
    v_sin_f32 v181, v188
    v_cos_f32 v190, v189
    v_sin_f32 v191, v189
    v_lshlrev_b32 v192, 16, v234
    v_lshlrev_b32 v193, 16, v235
    v_add_f32 v199, v253, v253
    v_mul_f32 v192, v192, v199
    v_mul_f32 v193, v193, v199
    v_mul_f32 v186, v186, v182
    v_mul_f32 v187, v187, v182
    v_mul_f32 v180, v180, v183
    v_mul_f32 v181, v181, v183
    v_mul_f32 v190, v190, v184
    v_mul_f32_e64 v191, v191, v184
    v_mov_b32 v242, 0x3f80
    v_cvt_pk_bf16_f32 v243, v186, v187
    v_pk_mul_f32 v[194:195], v[186:187], v[186:187] op_sel:[0,0] op_sel_hi:[0,1]
    v_pk_fma_f32 v[172:173], v[186:187], v[186:187], v[194:195] op_sel:[1,1,0] op_sel_hi:[1,0,1] neg_lo:[0,1,0]
    v_cvt_pk_bf16_f32 v244, v172, v173
    v_pk_mul_f32 v[194:195], v[172:173], v[186:187] op_sel:[0,0] op_sel_hi:[0,1]
    v_pk_fma_f32 v[174:175], v[172:173], v[186:187], v[194:195] op_sel:[1,1,0] op_sel_hi:[1,0,1] neg_lo:[0,1,0]
    v_cvt_pk_bf16_f32 v245, v174, v175
    v_pk_mul_f32 v[194:195], v[174:175], v[186:187] op_sel:[0,0] op_sel_hi:[0,1]
    v_pk_fma_f32 v[172:173], v[174:175], v[186:187], v[194:195] op_sel:[1,1,0] op_sel_hi:[1,0,1] neg_lo:[0,1,0]
    v_cvt_pk_bf16_f32 v246, v172, v173
    v_pk_mul_f32 v[194:195], v[172:173], v[186:187] op_sel:[0,0] op_sel_hi:[0,1]
    v_pk_fma_f32 v[174:175], v[172:173], v[186:187], v[194:195] op_sel:[1,1,0] op_sel_hi:[1,0,1] neg_lo:[0,1,0]
    v_cvt_pk_bf16_f32 v247, v174, v175
    v_pk_mul_f32 v[194:195], v[174:175], v[186:187] op_sel:[0,0] op_sel_hi:[0,1]
    v_pk_fma_f32 v[172:173], v[174:175], v[186:187], v[194:195] op_sel:[1,1,0] op_sel_hi:[1,0,1] neg_lo:[0,1,0]
    v_cvt_pk_bf16_f32 v248, v172, v173
    v_pk_mul_f32 v[194:195], v[172:173], v[186:187] op_sel:[0,0] op_sel_hi:[0,1]
    v_pk_fma_f32 v[174:175], v[172:173], v[186:187], v[194:195] op_sel:[1,1,0] op_sel_hi:[1,0,1] neg_lo:[0,1,0]
    v_cvt_pk_bf16_f32 v249, v174, v175
    v_pk_mul_f32 v[194:195], v[174:175], v[186:187] op_sel:[0,0] op_sel_hi:[0,1]
    v_pk_fma_f32 v[172:173], v[174:175], v[186:187], v[194:195] op_sel:[1,1,0] op_sel_hi:[1,0,1] neg_lo:[0,1,0]
    v_cvt_pk_bf16_f32 v250, v172, v173
    v_pk_mul_f32 v[194:195], v[172:173], v[186:187] op_sel:[0,0] op_sel_hi:[0,1]
    v_pk_fma_f32 v[174:175], v[172:173], v[186:187], v[194:195] op_sel:[1,1,0] op_sel_hi:[1,0,1] neg_lo:[0,1,0]
    v_cvt_pk_bf16_f32 v251, v174, v175
    ds_write_addtid_b32 v242 offset:0
    ds_write_addtid_b32 v243 offset:272
    ds_write_addtid_b32 v244 offset:544
    ds_write_addtid_b32 v245 offset:816
    ds_write_addtid_b32 v246 offset:1088
    ds_write_addtid_b32 v247 offset:1360
    ds_write_addtid_b32 v248 offset:1632
    ds_write_addtid_b32 v249 offset:1904
    ds_write_addtid_b32 v250 offset:2176
    ds_write_addtid_b32 v251 offset:2448
    v_pk_mul_f32 v[194:195], v[174:175], v[186:187] op_sel:[0,0] op_sel_hi:[0,1]
    v_pk_fma_f32 v[172:173], v[174:175], v[186:187], v[194:195] op_sel:[1,1,0] op_sel_hi:[1,0,1] neg_lo:[0,1,0]
    v_cvt_pk_bf16_f32 v242, v172, v173
    v_pk_mul_f32 v[194:195], v[172:173], v[186:187] op_sel:[0,0] op_sel_hi:[0,1]
    v_pk_fma_f32 v[174:175], v[172:173], v[186:187], v[194:195] op_sel:[1,1,0] op_sel_hi:[1,0,1] neg_lo:[0,1,0]
    v_cvt_pk_bf16_f32 v243, v174, v175
    v_pk_mul_f32 v[194:195], v[174:175], v[186:187] op_sel:[0,0] op_sel_hi:[0,1]
    v_pk_fma_f32 v[172:173], v[174:175], v[186:187], v[194:195] op_sel:[1,1,0] op_sel_hi:[1,0,1] neg_lo:[0,1,0]
    v_cvt_pk_bf16_f32 v244, v172, v173
    v_pk_mul_f32 v[194:195], v[172:173], v[186:187] op_sel:[0,0] op_sel_hi:[0,1]
    v_pk_fma_f32 v[174:175], v[172:173], v[186:187], v[194:195] op_sel:[1,1,0] op_sel_hi:[1,0,1] neg_lo:[0,1,0]
    v_cvt_pk_bf16_f32 v245, v174, v175
    v_pk_mul_f32 v[194:195], v[174:175], v[186:187] op_sel:[0,0] op_sel_hi:[0,1]
    v_pk_fma_f32 v[172:173], v[174:175], v[186:187], v[194:195] op_sel:[1,1,0] op_sel_hi:[1,0,1] neg_lo:[0,1,0]
    v_cvt_pk_bf16_f32 v246, v172, v173
    v_pk_mul_f32 v[194:195], v[172:173], v[186:187] op_sel:[0,0] op_sel_hi:[0,1]
    v_pk_fma_f32 v[174:175], v[172:173], v[186:187], v[194:195] op_sel:[1,1,0] op_sel_hi:[1,0,1] neg_lo:[0,1,0]
    v_cvt_pk_bf16_f32 v247, v174, v175
    v_pk_mul_f32 v[194:195], v[174:175], v[186:187] op_sel:[0,0] op_sel_hi:[0,1]
    v_pk_fma_f32 v[172:173], v[174:175], v[186:187], v[194:195] op_sel:[1,1,0] op_sel_hi:[1,0,1] neg_lo:[0,1,0]
    v_cvt_pk_bf16_f32 v248, v172, v173
    v_pk_mul_f32 v[194:195], v[172:173], v[186:187] op_sel:[0,0] op_sel_hi:[0,1]
    v_pk_fma_f32 v[174:175], v[172:173], v[186:187], v[194:195] op_sel:[1,1,0] op_sel_hi:[1,0,1] neg_lo:[0,1,0]
    v_cvt_pk_bf16_f32 v249, v174, v175
    v_pk_mul_f32 v[194:195], v[174:175], v[186:187] op_sel:[0,0] op_sel_hi:[0,1]
    v_pk_fma_f32 v[172:173], v[174:175], v[186:187], v[194:195] op_sel:[1,1,0] op_sel_hi:[1,0,1] neg_lo:[0,1,0]
    v_cvt_pk_bf16_f32 v250, v172, v173
    v_pk_mul_f32 v[194:195], v[172:173], v[186:187] op_sel:[0,0] op_sel_hi:[0,1]
    v_pk_fma_f32 v[174:175], v[172:173], v[186:187], v[194:195] op_sel:[1,1,0] op_sel_hi:[1,0,1] neg_lo:[0,1,0]
    v_cvt_pk_bf16_f32 v251, v174, v175
    ds_write_addtid_b32 v242 offset:2720
    ds_write_addtid_b32 v243 offset:2992
    ds_write_addtid_b32 v244 offset:3264
    s_waitcnt vmcnt(1)
    s_barrier
    ds_read_b64_tr_b16 v[96:97], v111
    ds_read_b64_tr_b16 v[98:99], v111 offset:2560
    ds_read_b64_tr_b16 v[100:101], v112
    ds_read_b64_tr_b16 v[102:103], v112 offset:2560
    ds_read_b64_tr_b16 v[104:105], v113
    ds_read_b64_tr_b16 v[106:107], v113 offset:2560
    s_waitcnt lgkmcnt(4)
    buffer_store_dwordx4 v[96:99], v108, s[16:19], 0 offen sc1
    s_waitcnt lgkmcnt(2)
    buffer_store_dwordx4 v[100:103], v109, s[16:19], 0 offen sc1
    s_waitcnt lgkmcnt(0)
    s_nop 0
    buffer_store_dwordx4 v[104:107], v110, s[16:19], 0 offen sc1
    global_load_dword v7, v5, s[66:67] sc1
    ds_write_addtid_b32 v245 offset:3536
    ds_write_addtid_b32 v246 offset:3808
    ds_write_addtid_b32 v247 offset:4080
    ds_write_addtid_b32 v248 offset:4352
    ds_write_addtid_b32 v249 offset:4624
    ds_write_addtid_b32 v250 offset:4896
    ds_write_addtid_b32 v251 offset:5168
    v_pk_mul_f32 v[194:195], v[174:175], v[186:187] op_sel:[0,0] op_sel_hi:[0,1]
    v_pk_fma_f32 v[172:173], v[174:175], v[186:187], v[194:195] op_sel:[1,1,0] op_sel_hi:[1,0,1] neg_lo:[0,1,0]
    v_cvt_pk_bf16_f32 v242, v172, v173
    v_pk_mul_f32 v[194:195], v[172:173], v[186:187] op_sel:[0,0] op_sel_hi:[0,1]
    v_pk_fma_f32 v[174:175], v[172:173], v[186:187], v[194:195] op_sel:[1,1,0] op_sel_hi:[1,0,1] neg_lo:[0,1,0]
    v_cvt_pk_bf16_f32 v243, v174, v175
    v_pk_mul_f32 v[194:195], v[174:175], v[186:187] op_sel:[0,0] op_sel_hi:[0,1]
    v_pk_fma_f32 v[172:173], v[174:175], v[186:187], v[194:195] op_sel:[1,1,0] op_sel_hi:[1,0,1] neg_lo:[0,1,0]
    v_cvt_pk_bf16_f32 v244, v172, v173
    v_pk_mul_f32 v[194:195], v[172:173], v[186:187] op_sel:[0,0] op_sel_hi:[0,1]
    v_pk_fma_f32 v[174:175], v[172:173], v[186:187], v[194:195] op_sel:[1,1,0] op_sel_hi:[1,0,1] neg_lo:[0,1,0]
    v_cvt_pk_bf16_f32 v245, v174, v175
    v_pk_mul_f32 v[194:195], v[174:175], v[186:187] op_sel:[0,0] op_sel_hi:[0,1]
    v_pk_fma_f32 v[172:173], v[174:175], v[186:187], v[194:195] op_sel:[1,1,0] op_sel_hi:[1,0,1] neg_lo:[0,1,0]
    v_cvt_pk_bf16_f32 v246, v172, v173
    v_pk_mul_f32 v[194:195], v[172:173], v[186:187] op_sel:[0,0] op_sel_hi:[0,1]
    v_pk_fma_f32 v[174:175], v[172:173], v[186:187], v[194:195] op_sel:[1,1,0] op_sel_hi:[1,0,1] neg_lo:[0,1,0]
    v_cvt_pk_bf16_f32 v247, v174, v175
    v_pk_mul_f32 v[194:195], v[174:175], v[186:187] op_sel:[0,0] op_sel_hi:[0,1]
    v_pk_fma_f32 v[172:173], v[174:175], v[186:187], v[194:195] op_sel:[1,1,0] op_sel_hi:[1,0,1] neg_lo:[0,1,0]
    v_cvt_pk_bf16_f32 v248, v172, v173
    v_pk_mul_f32 v[194:195], v[172:173], v[186:187] op_sel:[0,0] op_sel_hi:[0,1]
    v_pk_fma_f32 v[174:175], v[172:173], v[186:187], v[194:195] op_sel:[1,1,0] op_sel_hi:[1,0,1] neg_lo:[0,1,0]
    v_cvt_pk_bf16_f32 v249, v174, v175
    v_pk_mul_f32 v[194:195], v[174:175], v[186:187] op_sel:[0,0] op_sel_hi:[0,1]
    v_pk_fma_f32 v[172:173], v[174:175], v[186:187], v[194:195] op_sel:[1,1,0] op_sel_hi:[1,0,1] neg_lo:[0,1,0]
    v_cvt_pk_bf16_f32 v250, v172, v173
    v_pk_mul_f32 v[194:195], v[172:173], v[186:187] op_sel:[0,0] op_sel_hi:[0,1]
    v_pk_fma_f32 v[174:175], v[172:173], v[186:187], v[194:195] op_sel:[1,1,0] op_sel_hi:[1,0,1] neg_lo:[0,1,0]
    s_min_u32 s96, s75, 159
    s_lshl_b32 s96, s96, 2
    s_add_u32 s96, s96, s24
    s_mul_i32 s97, s96, 384
    s_lshl_b32 s96, s96, 1
    v_lshl_add_u32 v2, v1, 1, s97
    v_mov_b32 v241, s96
    global_load_ushort v236, v2, s[52:53] offset:256
    global_load_ushort v237, v2, s[54:55] offset:256
    global_load_ushort v238, v2, s[56:57] offset:256
    global_load_ushort v239, v2, s[58:59] offset:256
    global_load_ushort v241, v241, s[62:63]
    v_cvt_pk_bf16_f32 v251, v174, v175
    ds_write_addtid_b32 v242 offset:5440
    ds_write_addtid_b32 v243 offset:5712
    ds_write_addtid_b32 v244 offset:5984
    ds_write_addtid_b32 v245 offset:6256
    ds_write_addtid_b32 v246 offset:6528
    ds_write_addtid_b32 v247 offset:6800
    ds_write_addtid_b32 v248 offset:7072
    ds_write_addtid_b32 v249 offset:7344
    ds_write_addtid_b32 v250 offset:7616
    ds_write_addtid_b32 v251 offset:7888
    v_pk_mul_f32 v[194:195], v[174:175], v[186:187] op_sel:[0,0] op_sel_hi:[0,1]
    v_pk_fma_f32 v[172:173], v[174:175], v[186:187], v[194:195] op_sel:[1,1,0] op_sel_hi:[1,0,1] neg_lo:[0,1,0]
    v_cvt_pk_bf16_f32 v242, v172, v173
    v_pk_mul_f32 v[194:195], v[172:173], v[186:187] op_sel:[0,0] op_sel_hi:[0,1]
    v_pk_fma_f32 v[174:175], v[172:173], v[186:187], v[194:195] op_sel:[1,1,0] op_sel_hi:[1,0,1] neg_lo:[0,1,0]
    v_cvt_pk_bf16_f32 v243, v174, v175
    ds_write_addtid_b32 v242 offset:8160
    ds_write_addtid_b32 v243 offset:8432
    ds_read_b128 a[160:163], v252 offset:0
    ds_read_b128 a[164:167], v252 offset:32
    ds_read_b128 a[168:171], v252 offset:64
    ds_read_b128 a[172:175], v252 offset:96
    ds_read_b128 a[176:179], v252 offset:128
    ds_read_b128 a[180:183], v252 offset:160
    ds_read_b128 a[184:187], v252 offset:192
    ds_read_b128 a[188:191], v252 offset:224
    v_pk_mul_f32 v[194:195], v[180:181], v[180:181] op_sel:[0,0] op_sel_hi:[0,1]
    v_pk_fma_f32 v[182:183], v[180:181], v[180:181], v[194:195] op_sel:[1,1,0] op_sel_hi:[1,0,1] neg_lo:[0,1,0]
    v_pk_mul_f32 v[194:195], v[182:183], v[182:183] op_sel:[0,0] op_sel_hi:[0,1]
    v_pk_fma_f32 v[184:185], v[182:183], v[182:183], v[194:195] op_sel:[1,1,0] op_sel_hi:[1,0,1] neg_lo:[0,1,0]
    v_cvt_pk_bf16_f32 v242, v192, -v193
    v_pk_mul_f32 v[194:195], v[192:193], v[180:181] op_sel:[0,0] op_sel_hi:[0,1]
    v_pk_fma_f32 v[174:175], v[192:193], v[180:181], v[194:195] op_sel:[1,1,0] op_sel_hi:[1,0,1] neg_lo:[0,1,0]
    v_cvt_pk_bf16_f32 v243, v174, -v175
    v_pk_mul_f32 v[194:195], v[174:175], v[180:181] op_sel:[0,0] op_sel_hi:[0,1]
    v_lshrrev_b32 v132, 5, v0
    v_and_b32 v133, 31, v0
    v_mul_u32_u24 v132, 1280, v132
    v_lshl_add_u32 v134, v133, 4, v132
    v_mov_b32 v135, 1073741824
    v_cmp_gt_u32 vcc, 16, v133
    s_mul_i32 s96, s2, 10240
    buffer_load_dwordx4 v[120:123], v134, s[4:7], s96 offen
    v_cndmask_b32_e64 v135, v135, v134, vcc
    buffer_load_dwordx4 v[124:127], v134, s[4:7], s96 offen offset:512
    buffer_load_dwordx4 v[128:131], v135, s[4:7], s96 offen offset:1024
    v_pk_fma_f32 v[172:173], v[174:175], v[180:181], v[194:195] op_sel:[1,1,0] op_sel_hi:[1,0,1] neg_lo:[0,1,0]
    v_cvt_pk_bf16_f32 v244, v172, -v173
    v_pk_mul_f32 v[194:195], v[172:173], v[180:181] op_sel:[0,0] op_sel_hi:[0,1]
    v_pk_fma_f32 v[174:175], v[172:173], v[180:181], v[194:195] op_sel:[1,1,0] op_sel_hi:[1,0,1] neg_lo:[0,1,0]
    v_cvt_pk_bf16_f32 v245, v174, -v175
    v_pk_mul_f32 v[194:195], v[174:175], v[180:181] op_sel:[0,0] op_sel_hi:[0,1]
    v_pk_fma_f32 v[172:173], v[174:175], v[180:181], v[194:195] op_sel:[1,1,0] op_sel_hi:[1,0,1] neg_lo:[0,1,0]
    v_cvt_pk_bf16_f32 v246, v172, -v173
    v_pk_mul_f32 v[194:195], v[172:173], v[180:181] op_sel:[0,0] op_sel_hi:[0,1]
    v_pk_fma_f32 v[174:175], v[172:173], v[180:181], v[194:195] op_sel:[1,1,0] op_sel_hi:[1,0,1] neg_lo:[0,1,0]
    v_cvt_pk_bf16_f32 v247, v174, -v175
    v_pk_mul_f32 v[194:195], v[174:175], v[180:181] op_sel:[0,0] op_sel_hi:[0,1]
    v_pk_fma_f32 v[172:173], v[174:175], v[180:181], v[194:195] op_sel:[1,1,0] op_sel_hi:[1,0,1] neg_lo:[0,1,0]
    v_cvt_pk_bf16_f32 v248, v172, -v173
    v_pk_mul_f32 v[194:195], v[172:173], v[180:181] op_sel:[0,0] op_sel_hi:[0,1]
    v_pk_fma_f32 v[174:175], v[172:173], v[180:181], v[194:195] op_sel:[1,1,0] op_sel_hi:[1,0,1] neg_lo:[0,1,0]
    v_cvt_pk_bf16_f32 v249, v174, -v175
    v_pk_mul_f32 v[194:195], v[192:193], v[190:191] op_sel:[0,0] op_sel_hi:[0,1]
    v_pk_fma_f32 v[176:177], v[192:193], v[190:191], v[194:195] op_sel:[1,1,0] op_sel_hi:[1,0,1] neg_lo:[0,1,0]
    v_cvt_pk_bf16_f32 v250, v176, -v177
    v_pk_mul_f32 v[194:195], v[176:177], v[182:183] op_sel:[0,0] op_sel_hi:[0,1]
    v_pk_fma_f32 v[174:175], v[176:177], v[182:183], v[194:195] op_sel:[1,1,0] op_sel_hi:[1,0,1] neg_lo:[0,1,0]
    v_cvt_pk_bf16_f32 v251, v174, -v175
    ds_write_addtid_b32 v242 offset:0
    ds_write_addtid_b32 v243 offset:272
    ds_write_addtid_b32 v244 offset:544
    ds_write_addtid_b32 v245 offset:816
    ds_write_addtid_b32 v246 offset:1088
    ds_write_addtid_b32 v247 offset:1360
    ds_write_addtid_b32 v248 offset:1632
    ds_write_addtid_b32 v249 offset:1904
    ds_write_addtid_b32 v250 offset:2176
    ds_write_addtid_b32 v251 offset:2448
    v_pk_mul_f32 v[194:195], v[174:175], v[182:183] op_sel:[0,0] op_sel_hi:[0,1]
    v_pk_fma_f32 v[172:173], v[174:175], v[182:183], v[194:195] op_sel:[1,1,0] op_sel_hi:[1,0,1] neg_lo:[0,1,0]
    v_cvt_pk_bf16_f32 v242, v172, -v173
    v_mov_b32 v140, 1073741824
    v_lshlrev_b32 v141, 2, v0
    v_cmp_gt_u32 vcc, 64, v0
    s_nop 1
    v_cndmask_b32 v141, v140, v141, vcc
    v_mov_b32_e64 v140, 0
    s_lshl_b32 s97, s2, 8
    s_add_u32 s97, s97, 3473408
    buffer_store_dword v140, v141, s[16:19], s97 offen sc1
    v_pk_mul_f32 v[194:195], v[172:173], v[182:183] op_sel:[0,0] op_sel_hi:[0,1]
    v_pk_fma_f32 v[174:175], v[172:173], v[182:183], v[194:195] op_sel:[1,1,0] op_sel_hi:[1,0,1] neg_lo:[0,1,0]
    v_cvt_pk_bf16_f32 v243, v174, -v175
    v_pk_mul_f32 v[194:195], v[174:175], v[182:183] op_sel:[0,0] op_sel_hi:[0,1]
    v_pk_fma_f32 v[172:173], v[174:175], v[182:183], v[194:195] op_sel:[1,1,0] op_sel_hi:[1,0,1] neg_lo:[0,1,0]
    v_cvt_pk_bf16_f32 v244, v172, -v173
    v_pk_mul_f32 v[194:195], v[176:177], v[190:191] op_sel:[0,0] op_sel_hi:[0,1]
    v_pk_fma_f32 v[178:179], v[176:177], v[190:191], v[194:195] op_sel:[1,1,0] op_sel_hi:[1,0,1] neg_lo:[0,1,0]
    v_cvt_pk_bf16_f32 v245, v178, -v179
    v_pk_mul_f32 v[194:195], v[178:179], v[184:185] op_sel:[0,0] op_sel_hi:[0,1]
    v_pk_fma_f32 v[174:175], v[178:179], v[184:185], v[194:195] op_sel:[1,1,0] op_sel_hi:[1,0,1] neg_lo:[0,1,0]
    v_cvt_pk_bf16_f32 v246, v174, -v175
    v_pk_mul_f32 v[194:195], v[174:175], v[184:185] op_sel:[0,0] op_sel_hi:[0,1]
    v_pk_fma_f32 v[172:173], v[174:175], v[184:185], v[194:195] op_sel:[1,1,0] op_sel_hi:[1,0,1] neg_lo:[0,1,0]
    v_cvt_pk_bf16_f32 v247, v172, -v173
    v_pk_mul_f32 v[194:195], v[178:179], v[190:191] op_sel:[0,0] op_sel_hi:[0,1]
    v_pk_fma_f32 v[176:177], v[178:179], v[190:191], v[194:195] op_sel:[1,1,0] op_sel_hi:[1,0,1] neg_lo:[0,1,0]
    v_cvt_pk_bf16_f32 v248, v176, -v177
    v_pk_mul_f32 v[194:195], v[176:177], v[184:185] op_sel:[0,0] op_sel_hi:[0,1]
    v_pk_fma_f32 v[174:175], v[176:177], v[184:185], v[194:195] op_sel:[1,1,0] op_sel_hi:[1,0,1] neg_lo:[0,1,0]
    v_cvt_pk_bf16_f32 v249, v174, -v175
    v_pk_mul_f32 v[194:195], v[174:175], v[184:185] op_sel:[0,0] op_sel_hi:[0,1]
    v_pk_fma_f32 v[172:173], v[174:175], v[184:185], v[194:195] op_sel:[1,1,0] op_sel_hi:[1,0,1] neg_lo:[0,1,0]
    v_cvt_pk_bf16_f32 v250, v172, -v173
    v_pk_mul_f32 v[194:195], v[176:177], v[190:191] op_sel:[0,0] op_sel_hi:[0,1]
    v_pk_fma_f32 v[178:179], v[176:177], v[190:191], v[194:195] op_sel:[1,1,0] op_sel_hi:[1,0,1] neg_lo:[0,1,0]
    v_cvt_pk_bf16_f32 v251, v178, -v179
    ds_write_addtid_b32 v242 offset:2720
    ds_write_addtid_b32 v242 offset:3264
    ds_write_addtid_b32 v243 offset:3536
    ds_write_addtid_b32 v244 offset:3808
    ds_write_addtid_b32 v245 offset:4352
    ds_write_addtid_b32 v246 offset:4624
    ds_write_addtid_b32 v247 offset:4896
    ds_write_addtid_b32 v248 offset:5440
    ds_write_addtid_b32 v249 offset:5712
    v_mov_b32 v142, 1073741824
    v_lshlrev_b32 v143, 2, v0
    v_cmp_gt_u32 vcc, 16, v0
    s_nop 1
    v_cndmask_b32 v143, v142, v143, vcc
    v_mov_b32_e64 v142, -1
    s_lshl_b32 s97, s2, 6
    s_add_u32 s97, s97, 3457024
    buffer_store_dword v142, v143, s[16:19], s97 offen sc1
    ds_write_addtid_b32 v250 offset:5984
    ds_write_addtid_b32 v251 offset:6528
    v_pk_mul_f32 v[194:195], v[178:179], v[186:187] op_sel:[0,0] op_sel_hi:[0,1]
    v_pk_fma_f32 v[174:175], v[178:179], v[186:187], v[194:195] op_sel:[1,1,0] op_sel_hi:[1,0,1] neg_lo:[0,1,0]
    v_cvt_pk_bf16_f32 v242, v174, -v175
    v_pk_mul_f32 v[194:195], v[178:179], v[190:191] op_sel:[0,0] op_sel_hi:[0,1]
    v_pk_fma_f32 v[176:177], v[178:179], v[190:191], v[194:195] op_sel:[1,1,0] op_sel_hi:[1,0,1] neg_lo:[0,1,0]
    v_cvt_pk_bf16_f32 v243, v176, -v177
    v_pk_mul_f32 v[194:195], v[176:177], v[186:187] op_sel:[0,0] op_sel_hi:[0,1]
    v_pk_fma_f32 v[174:175], v[176:177], v[186:187], v[194:195] op_sel:[1,1,0] op_sel_hi:[1,0,1] neg_lo:[0,1,0]
    v_cvt_pk_bf16_f32 v244, v174, -v175
    v_pk_mul_f32 v[194:195], v[176:177], v[190:191] op_sel:[0,0] op_sel_hi:[0,1]
    v_pk_fma_f32 v[178:179], v[176:177], v[190:191], v[194:195] op_sel:[1,1,0] op_sel_hi:[1,0,1] neg_lo:[0,1,0]
    v_cvt_pk_bf16_f32 v245, v178, -v179
    v_pk_mul_f32 v[194:195], v[178:179], v[186:187] op_sel:[0,0] op_sel_hi:[0,1]
    v_pk_fma_f32 v[174:175], v[178:179], v[186:187], v[194:195] op_sel:[1,1,0] op_sel_hi:[1,0,1] neg_lo:[0,1,0]
    v_cvt_pk_bf16_f32 v246, v174, -v175
    v_pk_mul_f32 v[194:195], v[178:179], v[190:191] op_sel:[0,0] op_sel_hi:[0,1]
    v_pk_fma_f32 v[176:177], v[178:179], v[190:191], v[194:195] op_sel:[1,1,0] op_sel_hi:[1,0,1] neg_lo:[0,1,0]
    v_cvt_pk_bf16_f32 v247, v176, -v177
    v_pk_mul_f32 v[194:195], v[176:177], v[186:187] op_sel:[0,0] op_sel_hi:[0,1]
    v_pk_fma_f32 v[174:175], v[176:177], v[186:187], v[194:195] op_sel:[1,1,0] op_sel_hi:[1,0,1] neg_lo:[0,1,0]
    v_cvt_pk_bf16_f32 v248, v174, -v175
    ds_write_addtid_b32 v242 offset:6800
    ds_write_addtid_b32 v243 offset:7072
    ds_write_addtid_b32 v244 offset:7344
    ds_write_addtid_b32 v245 offset:7616
    ds_write_addtid_b32 v246 offset:7888
    ds_write_addtid_b32 v247 offset:8160
    ds_write_addtid_b32 v248 offset:8432
    ds_read_b128 a[192:195], v252 offset:0
    ds_read_b128 a[196:199], v252 offset:32
    ds_read_b128 a[200:203], v252 offset:64
    ds_read_b128 a[204:207], v252 offset:96
    ds_read_b128 a[208:211], v252 offset:128
    ds_read_b128 a[212:215], v252 offset:160
    s_waitcnt vmcnt(11)
    s_waitcnt vmcnt(10)
    v_cmp_gt_u32 vcc, 1, v7
    s_nop 0
    s_and_b64 vcc, vcc, s[50:51]
    s_and_b64 vcc, vcc, 1
    s_cbranch_scc1 ps_4
pc_6:
    s_barrier
    v_lshlrev_b32 v2, 3, v4
    v_mov_b32 v5, 1
    v_cndmask_b32 v2, v4, v2, s[50:51]
    buffer_atomic_add v5, v2, s[16:19], s86 offen offset:0 sc1
    ds_read_b128 a[216:219], v252 offset:192
    ds_read_b128 a[220:223], v252 offset:224
    v_and_b32 v199, 0xffff0000, v232
    v_mul_f32 v199, 0x3fb8aa3b, v199
    v_exp_f32 v199, v199
    v_and_b32 v255, 0xffff0000, v233
    v_mul_f32 v255, v255, v253
    v_mul_f32 v255, 0x3e22f983, v255
    v_cvt_pk_bf16_f32 v199, v199, v199
    v_lshlrev_b32 v199, 16, v199
    v_mul_f32 v254, v199, v253
    v_mul_f32 v254, 0xbfb8aa3b, v254
    s_waitcnt lgkmcnt(7)
    v_mfma_f32_32x32x16_bf16 v[216:231], a[192:195], a[160:163], 0
    v_mul_f32 v182, 0x41000000, v254
    v_mul_f32 v185, 0x41000000, v255
    v_mul_f32 v184, 0x43800000, v254
    v_mul_f32 v189, 0x43800000, v255
    s_waitcnt lgkmcnt(6)
    v_mfma_f32_32x32x16_bf16 v[216:231], a[196:199], a[164:167], v[216:231]
    v_fract_f32 v185, v185
    v_fract_f32 v188, v255
    v_fract_f32 v189, v189
    v_exp_f32 v182, v182
    s_waitcnt lgkmcnt(5)
    v_mfma_f32_32x32x16_bf16 v[216:231], a[200:203], a[168:171], v[216:231]
    v_exp_f32 v183, v254
    v_exp_f32 v184, v184
    v_cos_f32 v186, v185
    v_sin_f32 v187, v185
    s_waitcnt lgkmcnt(4)
    v_mfma_f32_32x32x16_bf16 v[216:231], a[204:207], a[172:175], v[216:231]
    v_cos_f32 v180, v188
    v_sin_f32 v181, v188
    v_cos_f32 v190, v189
    v_sin_f32 v191, v189
    s_waitcnt lgkmcnt(3)
    v_mfma_f32_32x32x16_bf16 v[216:231], a[208:211], a[176:179], v[216:231]
    v_and_b32 v192, 0xffff0000, v234
    v_and_b32 v193, 0xffff0000, v235
    v_add_f32 v199, v253, v253
    v_mul_f32 v192, v192, v199
    s_waitcnt lgkmcnt(2)
    v_mfma_f32_32x32x16_bf16 v[216:231], a[212:215], a[180:183], v[216:231]
    v_mul_f32 v193, v193, v199
    v_mul_f32 v186, v186, v182
    v_mul_f32 v187, v187, v182
    v_mul_f32 v180, v180, v183
    s_waitcnt lgkmcnt(1)
    v_mfma_f32_32x32x16_bf16 v[216:231], a[216:219], a[184:187], v[216:231]
    v_mul_f32 v181, v181, v183
    v_mul_f32 v190, v190, v184
    v_mul_f32 v191, v191, v184
    s_waitcnt lgkmcnt(0)
    v_mfma_f32_32x32x16_bf16 v[216:231], a[220:223], a[188:191], v[216:231]
    v_mov_b32 v242, 0x3f80
    v_cvt_pk_bf16_f32 v243, v186, v187
    v_pk_mul_f32 v[194:195], v[186:187], v[186:187] op_sel:[0,0] op_sel_hi:[0,1]
    v_mov_b32 v144, -1
    v_mov_b32 v145, -1
    v_mov_b32 v146, -1
    v_mov_b32 v147, -1
    v_lshlrev_b32 v148, 4, v0
    s_sub_u32 s88, s2, 0
    s_mul_i32 s88, s88, 20480
    s_min_u32 s88, s88, 5222400
    s_add_u32 s88, s88, 4194304
    buffer_store_dwordx4 v[144:147], v148, s[16:19], s88 offen sc1
    v_pk_fma_f32 v[172:173], v[186:187], v[186:187], v[194:195] op_sel:[1,1,0] op_sel_hi:[1,0,1] neg_lo:[0,1,0]
    v_cvt_pk_bf16_f32 v244, v172, v173
    v_pk_mul_f32 v[194:195], v[172:173], v[186:187] op_sel:[0,0] op_sel_hi:[0,1]
    v_pk_fma_f32 v[174:175], v[172:173], v[186:187], v[194:195] op_sel:[1,1,0] op_sel_hi:[1,0,1] neg_lo:[0,1,0]
    v_cvt_pk_bf16_f32 v245, v174, v175
    v_pk_mul_f32 v[194:195], v[174:175], v[186:187] op_sel:[0,0] op_sel_hi:[0,1]
    v_pk_fma_f32 v[172:173], v[174:175], v[186:187], v[194:195] op_sel:[1,1,0] op_sel_hi:[1,0,1] neg_lo:[0,1,0]
    v_cvt_pk_bf16_f32 v246, v172, v173
    v_pk_mul_f32 v[194:195], v[172:173], v[186:187] op_sel:[0,0] op_sel_hi:[0,1]
    v_pk_fma_f32 v[174:175], v[172:173], v[186:187], v[194:195] op_sel:[1,1,0] op_sel_hi:[1,0,1] neg_lo:[0,1,0]
    v_cvt_pk_bf16_f32 v247, v174, v175
    v_pk_mul_f32 v[194:195], v[174:175], v[186:187] op_sel:[0,0] op_sel_hi:[0,1]
    v_pk_fma_f32 v[172:173], v[174:175], v[186:187], v[194:195] op_sel:[1,1,0] op_sel_hi:[1,0,1] neg_lo:[0,1,0]
    v_cvt_pk_bf16_f32 v248, v172, v173
    v_pk_mul_f32 v[194:195], v[172:173], v[186:187] op_sel:[0,0] op_sel_hi:[0,1]
    v_pk_fma_f32 v[174:175], v[172:173], v[186:187], v[194:195] op_sel:[1,1,0] op_sel_hi:[1,0,1] neg_lo:[0,1,0]
    v_cvt_pk_bf16_f32 v249, v174, v175
    v_pk_mul_f32 v[194:195], v[174:175], v[186:187] op_sel:[0,0] op_sel_hi:[0,1]
    v_pk_fma_f32 v[172:173], v[174:175], v[186:187], v[194:195] op_sel:[1,1,0] op_sel_hi:[1,0,1] neg_lo:[0,1,0]
    v_cvt_pk_bf16_f32 v250, v172, v173
    v_pk_mul_f32 v[194:195], v[172:173], v[186:187] op_sel:[0,0] op_sel_hi:[0,1]
    v_pk_fma_f32 v[174:175], v[172:173], v[186:187], v[194:195] op_sel:[1,1,0] op_sel_hi:[1,0,1] neg_lo:[0,1,0]
    v_cvt_pk_bf16_f32 v251, v174, v175
    ds_write_addtid_b32 v242 offset:0
    ds_write_addtid_b32 v243 offset:272
    ds_write_addtid_b32 v244 offset:544
    ds_write_addtid_b32 v245 offset:816
    ds_write_addtid_b32 v246 offset:1088
    ds_write_addtid_b32 v247 offset:1360
    ds_write_addtid_b32 v248 offset:1632
    ds_write_addtid_b32 v249 offset:1904
    ds_write_addtid_b32 v250 offset:2176
    ds_write_addtid_b32 v251 offset:2448
    v_pk_mul_f32 v[194:195], v[174:175], v[186:187] op_sel:[0,0] op_sel_hi:[0,1]
    v_pk_fma_f32 v[172:173], v[174:175], v[186:187], v[194:195] op_sel:[1,1,0] op_sel_hi:[1,0,1] neg_lo:[0,1,0]
    v_cvt_pk_bf16_f32 v242, v172, v173
    v_pk_mul_f32 v[194:195], v[172:173], v[186:187] op_sel:[0,0] op_sel_hi:[0,1]
    v_pk_fma_f32 v[174:175], v[172:173], v[186:187], v[194:195] op_sel:[1,1,0] op_sel_hi:[1,0,1] neg_lo:[0,1,0]
    v_cvt_pk_bf16_f32 v243, v174, v175
    v_pk_mul_f32 v[194:195], v[174:175], v[186:187] op_sel:[0,0] op_sel_hi:[0,1]
    v_pk_fma_f32 v[172:173], v[174:175], v[186:187], v[194:195] op_sel:[1,1,0] op_sel_hi:[1,0,1] neg_lo:[0,1,0]
    v_cvt_pk_bf16_f32 v244, v172, v173
    v_pk_mul_f32 v[194:195], v[172:173], v[186:187] op_sel:[0,0] op_sel_hi:[0,1]
    v_pk_fma_f32 v[174:175], v[172:173], v[186:187], v[194:195] op_sel:[1,1,0] op_sel_hi:[1,0,1] neg_lo:[0,1,0]
    v_cvt_pk_bf16_f32 v245, v174, v175
    v_pk_mul_f32 v[194:195], v[174:175], v[186:187] op_sel:[0,0] op_sel_hi:[0,1]
    v_pk_fma_f32 v[172:173], v[174:175], v[186:187], v[194:195] op_sel:[1,1,0] op_sel_hi:[1,0,1] neg_lo:[0,1,0]
    v_cvt_pk_bf16_f32 v246, v172, v173
    v_pk_mul_f32 v[194:195], v[172:173], v[186:187] op_sel:[0,0] op_sel_hi:[0,1]
    v_pk_fma_f32 v[174:175], v[172:173], v[186:187], v[194:195] op_sel:[1,1,0] op_sel_hi:[1,0,1] neg_lo:[0,1,0]
    s_add_u32 s88, s88, 4096
    buffer_store_dwordx4 v[144:147], v148, s[16:19], s88 offen sc1
    v_cvt_pk_bf16_f32 v247, v174, v175
    v_pk_mul_f32 v[194:195], v[174:175], v[186:187] op_sel:[0,0] op_sel_hi:[0,1]
    v_pk_fma_f32 v[172:173], v[174:175], v[186:187], v[194:195] op_sel:[1,1,0] op_sel_hi:[1,0,1] neg_lo:[0,1,0]
    v_cvt_pk_bf16_f32 v248, v172, v173
    v_pk_mul_f32 v[194:195], v[172:173], v[186:187] op_sel:[0,0] op_sel_hi:[0,1]
    v_pk_fma_f32 v[174:175], v[172:173], v[186:187], v[194:195] op_sel:[1,1,0] op_sel_hi:[1,0,1] neg_lo:[0,1,0]
    v_cvt_pk_bf16_f32 v249, v174, v175
    v_pk_mul_f32 v[194:195], v[174:175], v[186:187] op_sel:[0,0] op_sel_hi:[0,1]
    v_pk_fma_f32 v[172:173], v[174:175], v[186:187], v[194:195] op_sel:[1,1,0] op_sel_hi:[1,0,1] neg_lo:[0,1,0]
    v_cvt_pk_bf16_f32 v250, v172, v173
    v_pk_mul_f32 v[194:195], v[172:173], v[186:187] op_sel:[0,0] op_sel_hi:[0,1]
    v_pk_fma_f32 v[174:175], v[172:173], v[186:187], v[194:195] op_sel:[1,1,0] op_sel_hi:[1,0,1] neg_lo:[0,1,0]
    v_cvt_pk_bf16_f32 v251, v174, v175
    ds_write_addtid_b32 v242 offset:2720
    ds_write_addtid_b32 v243 offset:2992
    ds_write_addtid_b32 v244 offset:3264
    ds_write_addtid_b32 v245 offset:3536
    ds_write_addtid_b32 v246 offset:3808
    ds_write_addtid_b32 v247 offset:4080
    ds_write_addtid_b32 v248 offset:4352
    ds_write_addtid_b32 v249 offset:4624
    ds_write_addtid_b32 v250 offset:4896
    ds_write_addtid_b32 v251 offset:5168
    v_pk_mul_f32 v[194:195], v[174:175], v[186:187] op_sel:[0,0] op_sel_hi:[0,1]
    v_pk_fma_f32 v[172:173], v[174:175], v[186:187], v[194:195] op_sel:[1,1,0] op_sel_hi:[1,0,1] neg_lo:[0,1,0]
    v_cvt_pk_bf16_f32 v242, v172, v173
    v_pk_mul_f32 v[194:195], v[172:173], v[186:187] op_sel:[0,0] op_sel_hi:[0,1]
    v_pk_fma_f32 v[174:175], v[172:173], v[186:187], v[194:195] op_sel:[1,1,0] op_sel_hi:[1,0,1] neg_lo:[0,1,0]
    v_cvt_pk_bf16_f32 v243, v174, v175
    v_pk_mul_f32 v[194:195], v[174:175], v[186:187] op_sel:[0,0] op_sel_hi:[0,1]
    v_pk_fma_f32 v[172:173], v[174:175], v[186:187], v[194:195] op_sel:[1,1,0] op_sel_hi:[1,0,1] neg_lo:[0,1,0]
    v_cvt_pk_bf16_f32 v244, v172, v173
    v_pk_mul_f32 v[194:195], v[172:173], v[186:187] op_sel:[0,0] op_sel_hi:[0,1]
    v_pk_fma_f32 v[174:175], v[172:173], v[186:187], v[194:195] op_sel:[1,1,0] op_sel_hi:[1,0,1] neg_lo:[0,1,0]
    v_cvt_pk_bf16_f32 v245, v174, v175
    v_pk_mul_f32 v[194:195], v[174:175], v[186:187] op_sel:[0,0] op_sel_hi:[0,1]
    v_pk_fma_f32 v[172:173], v[174:175], v[186:187], v[194:195] op_sel:[1,1,0] op_sel_hi:[1,0,1] neg_lo:[0,1,0]
    v_cvt_pk_bf16_f32 v246, v172, v173
    v_pk_mul_f32 v[194:195], v[172:173], v[186:187] op_sel:[0,0] op_sel_hi:[0,1]
    v_pk_fma_f32 v[174:175], v[172:173], v[186:187], v[194:195] op_sel:[1,1,0] op_sel_hi:[1,0,1] neg_lo:[0,1,0]
    v_cvt_pk_bf16_f32 v247, v174, v175
    v_pk_mul_f32 v[194:195], v[174:175], v[186:187] op_sel:[0,0] op_sel_hi:[0,1]
    v_pk_fma_f32 v[172:173], v[174:175], v[186:187], v[194:195] op_sel:[1,1,0] op_sel_hi:[1,0,1] neg_lo:[0,1,0]
    v_cvt_pk_bf16_f32 v248, v172, v173
    v_pk_mul_f32 v[194:195], v[172:173], v[186:187] op_sel:[0,0] op_sel_hi:[0,1]
    v_pk_fma_f32 v[174:175], v[172:173], v[186:187], v[194:195] op_sel:[1,1,0] op_sel_hi:[1,0,1] neg_lo:[0,1,0]
    v_cvt_pk_bf16_f32 v249, v174, v175
    v_pk_mul_f32 v[194:195], v[174:175], v[186:187] op_sel:[0,0] op_sel_hi:[0,1]
    v_pk_fma_f32 v[172:173], v[174:175], v[186:187], v[194:195] op_sel:[1,1,0] op_sel_hi:[1,0,1] neg_lo:[0,1,0]
    v_cvt_pk_bf16_f32 v250, v172, v173
    s_add_u32 s88, s88, 4096
    buffer_store_dwordx4 v[144:147], v148, s[16:19], s88 offen sc1
    v_pk_mul_f32 v[194:195], v[172:173], v[186:187] op_sel:[0,0] op_sel_hi:[0,1]
    v_pk_fma_f32 v[174:175], v[172:173], v[186:187], v[194:195] op_sel:[1,1,0] op_sel_hi:[1,0,1] neg_lo:[0,1,0]
    v_cvt_pk_bf16_f32 v251, v174, v175
    ds_write_addtid_b32 v242 offset:5440
    ds_write_addtid_b32 v243 offset:5712
    ds_write_addtid_b32 v244 offset:5984
    ds_write_addtid_b32 v245 offset:6256
    ds_write_addtid_b32 v246 offset:6528
    ds_write_addtid_b32 v247 offset:6800
    ds_write_addtid_b32 v248 offset:7072
    ds_write_addtid_b32 v249 offset:7344
    ds_write_addtid_b32 v250 offset:7616
    ds_write_addtid_b32 v251 offset:7888
    v_pk_mul_f32 v[194:195], v[174:175], v[186:187] op_sel:[0,0] op_sel_hi:[0,1]
    v_pk_fma_f32 v[172:173], v[174:175], v[186:187], v[194:195] op_sel:[1,1,0] op_sel_hi:[1,0,1] neg_lo:[0,1,0]
    v_cvt_pk_bf16_f32 v242, v172, v173
    v_pk_mul_f32 v[194:195], v[172:173], v[186:187] op_sel:[0,0] op_sel_hi:[0,1]
    v_pk_fma_f32 v[174:175], v[172:173], v[186:187], v[194:195] op_sel:[1,1,0] op_sel_hi:[1,0,1] neg_lo:[0,1,0]
    v_cvt_pk_bf16_f32 v243, v174, v175
    ds_write_addtid_b32 v242 offset:8160
    ds_write_addtid_b32 v243 offset:8432
    ds_read_b128 a[160:163], v252 offset:0
    ds_read_b128 a[164:167], v252 offset:32
    ds_read_b128 a[168:171], v252 offset:64
    ds_read_b128 a[172:175], v252 offset:96
    ds_read_b128 a[176:179], v252 offset:128
    ds_read_b128 a[180:183], v252 offset:160
    ds_read_b128 a[184:187], v252 offset:192
    ds_read_b128 a[188:191], v252 offset:224
    v_pk_mul_f32 v[194:195], v[180:181], v[180:181] op_sel:[0,0] op_sel_hi:[0,1]
    v_pk_fma_f32 v[182:183], v[180:181], v[180:181], v[194:195] op_sel:[1,1,0] op_sel_hi:[1,0,1] neg_lo:[0,1,0]
    v_pk_mul_f32 v[194:195], v[182:183], v[182:183] op_sel:[0,0] op_sel_hi:[0,1]
    v_pk_fma_f32 v[184:185], v[182:183], v[182:183], v[194:195] op_sel:[1,1,0] op_sel_hi:[1,0,1] neg_lo:[0,1,0]
    v_cvt_pk_bf16_f32 v242, v192, -v193
    v_pk_mul_f32 v[194:195], v[192:193], v[180:181] op_sel:[0,0] op_sel_hi:[0,1]
    v_pk_fma_f32 v[174:175], v[192:193], v[180:181], v[194:195] op_sel:[1,1,0] op_sel_hi:[1,0,1] neg_lo:[0,1,0]
    v_cvt_pk_bf16_f32 v243, v174, -v175
    v_pk_mul_f32 v[194:195], v[174:175], v[180:181] op_sel:[0,0] op_sel_hi:[0,1]
    v_pk_fma_f32 v[172:173], v[174:175], v[180:181], v[194:195] op_sel:[1,1,0] op_sel_hi:[1,0,1] neg_lo:[0,1,0]
    v_cvt_pk_bf16_f32 v244, v172, -v173
    v_pk_mul_f32 v[194:195], v[172:173], v[180:181] op_sel:[0,0] op_sel_hi:[0,1]
    v_pk_fma_f32 v[174:175], v[172:173], v[180:181], v[194:195] op_sel:[1,1,0] op_sel_hi:[1,0,1] neg_lo:[0,1,0]
    v_cvt_pk_bf16_f32 v245, v174, -v175
    v_pk_mul_f32 v[194:195], v[174:175], v[180:181] op_sel:[0,0] op_sel_hi:[0,1]
    v_pk_fma_f32 v[172:173], v[174:175], v[180:181], v[194:195] op_sel:[1,1,0] op_sel_hi:[1,0,1] neg_lo:[0,1,0]
    v_cvt_pk_bf16_f32 v246, v172, -v173
    v_pk_mul_f32 v[194:195], v[172:173], v[180:181] op_sel:[0,0] op_sel_hi:[0,1]
    v_pk_fma_f32 v[174:175], v[172:173], v[180:181], v[194:195] op_sel:[1,1,0] op_sel_hi:[1,0,1] neg_lo:[0,1,0]
    v_cvt_pk_bf16_f32 v247, v174, -v175
    v_pk_mul_f32 v[194:195], v[174:175], v[180:181] op_sel:[0,0] op_sel_hi:[0,1]
    s_add_u32 s88, s88, 4096
    buffer_store_dwordx4 v[144:147], v148, s[16:19], s88 offen sc1
    v_pk_fma_f32 v[172:173], v[174:175], v[180:181], v[194:195] op_sel:[1,1,0] op_sel_hi:[1,0,1] neg_lo:[0,1,0]
    v_cvt_pk_bf16_f32 v248, v172, -v173
    v_pk_mul_f32 v[194:195], v[172:173], v[180:181] op_sel:[0,0] op_sel_hi:[0,1]
    v_pk_fma_f32 v[174:175], v[172:173], v[180:181], v[194:195] op_sel:[1,1,0] op_sel_hi:[1,0,1] neg_lo:[0,1,0]
    v_cvt_pk_bf16_f32 v249, v174, -v175
    v_pk_mul_f32 v[194:195], v[192:193], v[190:191] op_sel:[0,0] op_sel_hi:[0,1]
    v_pk_fma_f32 v[176:177], v[192:193], v[190:191], v[194:195] op_sel:[1,1,0] op_sel_hi:[1,0,1] neg_lo:[0,1,0]
    v_cvt_pk_bf16_f32 v250, v176, -v177
    v_pk_mul_f32 v[194:195], v[176:177], v[182:183] op_sel:[0,0] op_sel_hi:[0,1]
    v_pk_fma_f32 v[174:175], v[176:177], v[182:183], v[194:195] op_sel:[1,1,0] op_sel_hi:[1,0,1] neg_lo:[0,1,0]
    v_cvt_pk_bf16_f32 v251, v174, -v175
    ds_write_addtid_b32 v242 offset:0
    ds_write_addtid_b32 v243 offset:272
    ds_write_addtid_b32 v244 offset:544
    ds_write_addtid_b32 v245 offset:816
    ds_write_addtid_b32 v246 offset:1088
    ds_write_addtid_b32 v247 offset:1360
    ds_write_addtid_b32 v248 offset:1632
    ds_write_addtid_b32 v249 offset:1904
    ds_write_addtid_b32 v250 offset:2176
    ds_write_addtid_b32 v251 offset:2448
    v_pk_mul_f32 v[194:195], v[174:175], v[182:183] op_sel:[0,0] op_sel_hi:[0,1]
    v_pk_fma_f32 v[172:173], v[174:175], v[182:183], v[194:195] op_sel:[1,1,0] op_sel_hi:[1,0,1] neg_lo:[0,1,0]
    v_cvt_pk_bf16_f32 v242, v172, -v173
    v_pk_mul_f32 v[194:195], v[172:173], v[182:183] op_sel:[0,0] op_sel_hi:[0,1]
    v_pk_fma_f32 v[174:175], v[172:173], v[182:183], v[194:195] op_sel:[1,1,0] op_sel_hi:[1,0,1] neg_lo:[0,1,0]
    v_cvt_pk_bf16_f32 v243, v174, -v175
    v_pk_mul_f32 v[194:195], v[174:175], v[182:183] op_sel:[0,0] op_sel_hi:[0,1]
    v_pk_fma_f32 v[172:173], v[174:175], v[182:183], v[194:195] op_sel:[1,1,0] op_sel_hi:[1,0,1] neg_lo:[0,1,0]
    v_cvt_pk_bf16_f32 v244, v172, -v173
    v_pk_mul_f32 v[194:195], v[176:177], v[190:191] op_sel:[0,0] op_sel_hi:[0,1]
    v_pk_fma_f32 v[178:179], v[176:177], v[190:191], v[194:195] op_sel:[1,1,0] op_sel_hi:[1,0,1] neg_lo:[0,1,0]
    v_cvt_pk_bf16_f32 v245, v178, -v179
    v_pk_mul_f32 v[194:195], v[178:179], v[184:185] op_sel:[0,0] op_sel_hi:[0,1]
    v_pk_fma_f32 v[174:175], v[178:179], v[184:185], v[194:195] op_sel:[1,1,0] op_sel_hi:[1,0,1] neg_lo:[0,1,0]
    v_cvt_pk_bf16_f32 v246, v174, -v175
    v_pk_mul_f32 v[194:195], v[174:175], v[184:185] op_sel:[0,0] op_sel_hi:[0,1]
    v_pk_fma_f32 v[172:173], v[174:175], v[184:185], v[194:195] op_sel:[1,1,0] op_sel_hi:[1,0,1] neg_lo:[0,1,0]
    v_cvt_pk_bf16_f32 v247, v172, -v173
    v_pk_mul_f32 v[194:195], v[178:179], v[190:191] op_sel:[0,0] op_sel_hi:[0,1]
    v_pk_fma_f32 v[176:177], v[178:179], v[190:191], v[194:195] op_sel:[1,1,0] op_sel_hi:[1,0,1] neg_lo:[0,1,0]
    v_cvt_pk_bf16_f32 v248, v176, -v177
    v_pk_mul_f32 v[194:195], v[176:177], v[184:185] op_sel:[0,0] op_sel_hi:[0,1]
    v_pk_fma_f32 v[174:175], v[176:177], v[184:185], v[194:195] op_sel:[1,1,0] op_sel_hi:[1,0,1] neg_lo:[0,1,0]
    v_cvt_pk_bf16_f32 v249, v174, -v175
    v_pk_mul_f32 v[194:195], v[174:175], v[184:185] op_sel:[0,0] op_sel_hi:[0,1]
    v_pk_fma_f32 v[172:173], v[174:175], v[184:185], v[194:195] op_sel:[1,1,0] op_sel_hi:[1,0,1] neg_lo:[0,1,0]
    v_cvt_pk_bf16_f32 v250, v172, -v173
    v_pk_mul_f32 v[194:195], v[176:177], v[190:191] op_sel:[0,0] op_sel_hi:[0,1]
    v_pk_fma_f32 v[178:179], v[176:177], v[190:191], v[194:195] op_sel:[1,1,0] op_sel_hi:[1,0,1] neg_lo:[0,1,0]
    s_add_u32 s88, s88, 4096
    buffer_store_dwordx4 v[144:147], v148, s[16:19], s88 offen sc1
    v_cvt_pk_bf16_f32 v251, v178, -v179
    ds_write_addtid_b32 v242 offset:2720
    ds_write_addtid_b32 v242 offset:3264
    ds_write_addtid_b32 v243 offset:3536
    ds_write_addtid_b32 v244 offset:3808
    ds_write_addtid_b32 v245 offset:4352
    ds_write_addtid_b32 v246 offset:4624
    ds_write_addtid_b32 v247 offset:4896
    ds_write_addtid_b32 v248 offset:5440
    ds_write_addtid_b32 v249 offset:5712
    ds_write_addtid_b32 v250 offset:5984
    ds_write_addtid_b32 v251 offset:6528
    v_pk_mul_f32 v[194:195], v[178:179], v[186:187] op_sel:[0,0] op_sel_hi:[0,1]
    v_pk_fma_f32 v[174:175], v[178:179], v[186:187], v[194:195] op_sel:[1,1,0] op_sel_hi:[1,0,1] neg_lo:[0,1,0]
    v_cvt_pk_bf16_f32 v242, v174, -v175
    v_pk_mul_f32 v[194:195], v[178:179], v[190:191] op_sel:[0,0] op_sel_hi:[0,1]
    v_pk_fma_f32 v[176:177], v[178:179], v[190:191], v[194:195] op_sel:[1,1,0] op_sel_hi:[1,0,1] neg_lo:[0,1,0]
    v_cvt_pk_bf16_f32 v243, v176, -v177
    v_pk_mul_f32 v[194:195], v[176:177], v[186:187] op_sel:[0,0] op_sel_hi:[0,1]
    v_pk_fma_f32 v[174:175], v[176:177], v[186:187], v[194:195] op_sel:[1,1,0] op_sel_hi:[1,0,1] neg_lo:[0,1,0]
    v_cvt_pk_bf16_f32 v244, v174, -v175
    v_pk_mul_f32 v[194:195], v[176:177], v[190:191] op_sel:[0,0] op_sel_hi:[0,1]
    v_pk_fma_f32 v[178:179], v[176:177], v[190:191], v[194:195] op_sel:[1,1,0] op_sel_hi:[1,0,1] neg_lo:[0,1,0]
    v_cvt_pk_bf16_f32 v245, v178, -v179
    v_pk_mul_f32 v[194:195], v[178:179], v[186:187] op_sel:[0,0] op_sel_hi:[0,1]
    v_pk_fma_f32 v[174:175], v[178:179], v[186:187], v[194:195] op_sel:[1,1,0] op_sel_hi:[1,0,1] neg_lo:[0,1,0]
    v_cvt_pk_bf16_f32 v246, v174, -v175
    v_pk_mul_f32 v[194:195], v[178:179], v[190:191] op_sel:[0,0] op_sel_hi:[0,1]
    v_pk_fma_f32 v[176:177], v[178:179], v[190:191], v[194:195] op_sel:[1,1,0] op_sel_hi:[1,0,1] neg_lo:[0,1,0]
    v_cvt_pk_bf16_f32 v247, v176, -v177
    v_pk_mul_f32 v[194:195], v[176:177], v[186:187] op_sel:[0,0] op_sel_hi:[0,1]
    v_pk_fma_f32 v[174:175], v[176:177], v[186:187], v[194:195] op_sel:[1,1,0] op_sel_hi:[1,0,1] neg_lo:[0,1,0]
    v_cvt_pk_bf16_f32 v248, v174, -v175
    ds_write_addtid_b32 v242 offset:6800
    ds_write_addtid_b32 v243 offset:7072
    ds_write_addtid_b32 v244 offset:7344
    ds_write_addtid_b32 v245 offset:7616
    ds_write_addtid_b32 v246 offset:7888
    ds_write_addtid_b32 v247 offset:8160
    ds_write_addtid_b32 v248 offset:8432
    ds_read_b128 a[192:195], v252 offset:0
    ds_read_b128 a[196:199], v252 offset:32
    ds_read_b128 a[200:203], v252 offset:64
    ds_read_b128 a[204:207], v252 offset:96
    ds_read_b128 a[208:211], v252 offset:128
    ds_read_b128 a[212:215], v252 offset:160
    ds_read_b128 a[216:219], v252 offset:192
    ds_read_b128 a[220:223], v252 offset:224
    s_add_u32 m0, s92, 36352
    s_nop 0
    buffer_load_dwordx4 v73, s[4:7], s99 offen offset:0  lds
    v_mov_b32 v134, 0x3f803f80
    v_mov_b32 v132, 0
    v_mov_b32 v133, 0
    s_waitcnt vmcnt(11)
    v_dot2c_f32_bf16 v132, v120, v134
    v_dot2c_f32_bf16 v133, v120, v120
    v_dot2c_f32_bf16 v132, v121, v134
    v_dot2c_f32_bf16 v133, v121, v121
    v_dot2c_f32_bf16 v132, v122, v134
    v_dot2c_f32_bf16 v133, v122, v122
    v_dot2c_f32_bf16 v132, v123, v134
    v_dot2c_f32_bf16 v133, v123, v123
    s_waitcnt vmcnt(10)
    v_dot2c_f32_bf16 v132, v124, v134
    v_dot2c_f32_bf16 v133, v124, v124
    v_dot2c_f32_bf16 v132, v125, v134
    v_dot2c_f32_bf16 v133, v125, v125
    v_dot2c_f32_bf16 v132, v126, v134
    v_dot2c_f32_bf16 v133, v126, v126
    v_dot2c_f32_bf16 v132, v127, v134
    v_dot2c_f32_bf16 v133, v127, v127
    s_waitcnt vmcnt(9)
    v_dot2c_f32_bf16 v132, v128, v134
    v_dot2c_f32_bf16 v133, v128, v128
    v_dot2c_f32_bf16 v132, v129, v134
    v_dot2c_f32_bf16 v133, v129, v129
    v_dot2c_f32_bf16 v132, v130, v134
    v_dot2c_f32_bf16 v133, v130, v130
    v_dot2c_f32_bf16 v132, v131, v134
    v_dot2c_f32_bf16 v133, v131, v131
    v_lshrrev_b32 v135, 5, v0
    v_and_b32 v121, 3, v135
    v_lshrrev_b32_e64 v135, 2, v135
    v_add_f32_dpp v132, v132, v132 row_shr:1 row_mask:0xf bank_mask:0xf bound_ctrl:0
    v_add_f32_dpp v133, v133, v133 row_shr:1 row_mask:0xf bank_mask:0xf bound_ctrl:0
    v_lshlrev_b32_e64 v135, 3, v135
    v_add_f32_dpp v132, v132, v132 row_shr:2 row_mask:0xf bank_mask:0xf bound_ctrl:0
    v_add_f32_dpp v133, v133, v133 row_shr:2 row_mask:0xf bank_mask:0xf bound_ctrl:0
    v_lshl_add_u32 v135, v121, 12, v135
    v_add_f32_dpp v132, v132, v132 row_shr:4 row_mask:0xf bank_mask:0xf bound_ctrl:0
    v_add_f32_dpp v133, v133, v133 row_shr:4 row_mask:0xf bank_mask:0xf bound_ctrl:0
    v_and_b32_e64 v121, 31, v0
    v_add_f32_dpp v132, v132, v132 row_shr:8 row_mask:0xf bank_mask:0xf bound_ctrl:0
    v_add_f32_dpp v133, v133, v133 row_shr:8 row_mask:0xf bank_mask:0xf bound_ctrl:0
    v_cmp_eq_u32_e64 vcc, 31, v121
    v_add_f32_dpp v132, v132, v132 row_bcast:15 row_mask:0xa bank_mask:0xf
    v_add_f32_dpp v133, v133, v133 row_bcast:15 row_mask:0xa bank_mask:0xf
    v_mov_b32 v121, 1073741824
    v_cndmask_b32_e64 v120, v121, v135, vcc
    s_lshl_b32 s96, s2, 4
    s_add_u32 s96, s96, 3440640
    v_mul_f32 v135, 0x3acccccd, v132
    v_mul_f32 v133, 0x3acccccd, v133
    v_fma_f32 v133, -v135, v135, v133
    v_max_f32 v133, 0, v133
    v_add_f32 v133, 0x3727c5ac, v133
    v_rsq_f32_e64 v132, v133
    s_nop 0
    v_mul_f32 v133, -v135, v132
    buffer_store_dwordx2 v[132:133], v120, s[16:19], s96 offen sc1
    v_lshlrev_b32 v199, 16, v236
    v_mul_f32 v199, 0x3fb8aa3b, v199
    v_exp_f32 v199, v199
    v_lshlrev_b32 v255, 16, v237
    v_mul_f32 v255, v255, v253
    v_mul_f32 v255, 0x3e22f983, v255
    v_cvt_pk_bf16_f32 v199, v199, v199
    v_lshlrev_b32 v199, 16, v199
    v_mul_f32 v254, v199, v253
    v_mul_f32 v254, 0xbfb8aa3b, v254
    s_waitcnt lgkmcnt(7)
    v_mfma_f32_32x32x16_bf16 v[216:231], a[192:195], a[160:163], v[216:231]
    s_add_u32 m0, s92, 36352
    s_nop 0
    buffer_load_dwordx4 v74, s[4:7], s99 offen offset:1088  lds
    v_mul_f32 v182, 0x41000000, v254
    v_mul_f32 v185, 0x41000000, v255
    v_mul_f32 v184, 0x43800000, v254
    v_mul_f32 v189, 0x43800000, v255
    s_waitcnt lgkmcnt(6)
    v_mfma_f32_32x32x16_bf16 v[216:231], a[196:199], a[164:167], v[216:231]
    s_add_u32 m0, s92, 36352
    s_nop 0
    buffer_load_dwordx4 v75, s[4:7], s99 offen offset:2176  lds
    v_fract_f32 v185, v185
    v_fract_f32 v188, v255
    v_fract_f32 v189, v189
    v_exp_f32 v182, v182
    s_waitcnt lgkmcnt(5)
    v_mfma_f32_32x32x16_bf16 v[216:231], a[200:203], a[168:171], v[216:231]
    s_add_u32 m0, s92, 36352
    s_nop 0
    buffer_load_dwordx4 v76, s[4:7], s99 offen offset:3264  lds
    v_exp_f32 v183, v254
    v_exp_f32 v184, v184
    v_cos_f32 v186, v185
    v_sin_f32 v187, v185
    s_waitcnt lgkmcnt(4)
    v_mfma_f32_32x32x16_bf16 v[216:231], a[204:207], a[172:175], v[216:231]
    s_add_u32 m0, s93, 53760
    s_add_u32 s99, s99, 256
    s_mov_b64 exec, s[80:81]
    buffer_load_dwordx4 v77, s[4:7], s100 offen  lds
    s_mov_b64 exec, -1
    s_add_u32 s100, s100, 256
    v_cos_f32 v180, v188
    v_sin_f32 v181, v188
    v_cos_f32 v190, v189
    v_sin_f32_e64 v191, v189
    s_waitcnt lgkmcnt(3)
    v_mfma_f32_32x32x16_bf16 v[216:231], a[208:211], a[176:179], v[216:231]
    s_add_u32 m0, s92, 55936
    s_nop 0
    buffer_load_dwordx4 v73, s[4:7], s99 offen offset:0  lds
    v_lshlrev_b32 v192, 16, v238
    v_lshlrev_b32 v193, 16, v239
    v_add_f32 v199, v253, v253
    v_mul_f32 v192, v192, v199
    s_waitcnt lgkmcnt(2)
    v_mfma_f32_32x32x16_bf16 v[216:231], a[212:215], a[180:183], v[216:231]
    s_add_u32 m0, s92, 55936
    s_nop 0
    buffer_load_dwordx4 v74, s[4:7], s99 offen offset:1088  lds
    v_mul_f32 v193, v193, v199
    v_mul_f32 v186, v186, v182
    v_mul_f32 v187, v187, v182
    v_mul_f32 v180, v180, v183
    s_waitcnt lgkmcnt(1)
    v_mfma_f32_32x32x16_bf16 v[216:231], a[216:219], a[184:187], v[216:231]
    s_add_u32 m0, s92, 55936
    s_nop 0
    buffer_load_dwordx4 v75, s[4:7], s99 offen offset:2176  lds
    v_mul_f32 v181, v181, v183
    buffer_load_dword v7, v4, s[16:19], s87 offen offset:0 sc1
    v_mul_f32 v190, v190, v184
    v_mul_f32_e64 v191, v191, v184
    s_waitcnt lgkmcnt(0)
    v_mfma_f32_32x32x16_bf16 v[216:231], a[220:223], a[188:191], v[216:231]
    s_add_u32 m0, s92, 55936
    s_nop 0
    buffer_load_dwordx4 v76, s[4:7], s99 offen offset:3264  lds
    s_add_u32 m0, s93, 73344
    s_add_u32 s99, s99, 256
    s_mov_b64 exec, s[80:81]
    buffer_load_dwordx4 v77, s[4:7], s100 offen  lds
    s_mov_b64 exec, -1
    s_add_u32 s100, s100, 256
    s_add_u32 m0, s92, 75520
    s_nop 0
    buffer_load_dwordx4 v73, s[4:7], s99 offen offset:0  lds
    s_add_u32 m0, s92, 75520
    s_nop 0
    buffer_load_dwordx4 v74, s[4:7], s99 offen offset:1088  lds
    s_mov_b32 m0, s37
    v_mov_b32 v242, 0x3f80
    v_cvt_pk_bf16_f32 v243, v186, v187
    v_pk_mul_f32 v[194:195], v[186:187], v[186:187] op_sel:[0,0] op_sel_hi:[0,1]
    v_pk_fma_f32 v[172:173], v[186:187], v[186:187], v[194:195] op_sel:[1,1,0] op_sel_hi:[1,0,1] neg_lo:[0,1,0]
    v_cvt_pk_bf16_f32 v244, v172, v173
    v_pk_mul_f32 v[194:195], v[172:173], v[186:187] op_sel:[0,0] op_sel_hi:[0,1]
    v_pk_fma_f32 v[174:175], v[172:173], v[186:187], v[194:195] op_sel:[1,1,0] op_sel_hi:[1,0,1] neg_lo:[0,1,0]
    v_cvt_pk_bf16_f32 v245, v174, v175
    v_pk_mul_f32 v[194:195], v[174:175], v[186:187] op_sel:[0,0] op_sel_hi:[0,1]
    v_pk_fma_f32 v[172:173], v[174:175], v[186:187], v[194:195] op_sel:[1,1,0] op_sel_hi:[1,0,1] neg_lo:[0,1,0]
    v_cvt_pk_bf16_f32 v246, v172, v173
    v_pk_mul_f32 v[194:195], v[172:173], v[186:187] op_sel:[0,0] op_sel_hi:[0,1]
    v_pk_fma_f32 v[174:175], v[172:173], v[186:187], v[194:195] op_sel:[1,1,0] op_sel_hi:[1,0,1] neg_lo:[0,1,0]
    v_cvt_pk_bf16_f32 v247, v174, v175
    v_pk_mul_f32 v[194:195], v[174:175], v[186:187] op_sel:[0,0] op_sel_hi:[0,1]
    v_pk_fma_f32 v[172:173], v[174:175], v[186:187], v[194:195] op_sel:[1,1,0] op_sel_hi:[1,0,1] neg_lo:[0,1,0]
    v_cvt_pk_bf16_f32 v248, v172, v173
    v_pk_mul_f32 v[194:195], v[172:173], v[186:187] op_sel:[0,0] op_sel_hi:[0,1]
    v_pk_fma_f32 v[174:175], v[172:173], v[186:187], v[194:195] op_sel:[1,1,0] op_sel_hi:[1,0,1] neg_lo:[0,1,0]
    v_cvt_pk_bf16_f32 v249, v174, v175
    v_pk_mul_f32 v[194:195], v[174:175], v[186:187] op_sel:[0,0] op_sel_hi:[0,1]
    v_pk_fma_f32 v[172:173], v[174:175], v[186:187], v[194:195] op_sel:[1,1,0] op_sel_hi:[1,0,1] neg_lo:[0,1,0]
    v_cvt_pk_bf16_f32 v250, v172, v173
    v_pk_mul_f32 v[194:195], v[172:173], v[186:187] op_sel:[0,0] op_sel_hi:[0,1]
    v_pk_fma_f32 v[174:175], v[172:173], v[186:187], v[194:195] op_sel:[1,1,0] op_sel_hi:[1,0,1] neg_lo:[0,1,0]
    v_cvt_pk_bf16_f32 v251, v174, v175
    ds_write_addtid_b32 v242 offset:0
    ds_write_addtid_b32 v243 offset:272
    ds_write_addtid_b32 v244 offset:544
    ds_write_addtid_b32 v245 offset:816
    ds_write_addtid_b32 v246 offset:1088
    ds_write_addtid_b32 v247 offset:1360
    ds_write_addtid_b32 v248 offset:1632
    ds_write_addtid_b32 v249 offset:1904
    ds_write_addtid_b32 v250 offset:2176
    ds_write_addtid_b32 v251 offset:2448
    v_pk_mul_f32 v[194:195], v[174:175], v[186:187] op_sel:[0,0] op_sel_hi:[0,1]
    v_pk_fma_f32 v[172:173], v[174:175], v[186:187], v[194:195] op_sel:[1,1,0] op_sel_hi:[1,0,1] neg_lo:[0,1,0]
    v_cvt_pk_bf16_f32 v242, v172, v173
    v_pk_mul_f32 v[194:195], v[172:173], v[186:187] op_sel:[0,0] op_sel_hi:[0,1]
    v_pk_fma_f32 v[174:175], v[172:173], v[186:187], v[194:195] op_sel:[1,1,0] op_sel_hi:[1,0,1] neg_lo:[0,1,0]
    v_cvt_pk_bf16_f32 v243, v174, v175
    v_pk_mul_f32 v[194:195], v[174:175], v[186:187] op_sel:[0,0] op_sel_hi:[0,1]
    v_pk_fma_f32 v[172:173], v[174:175], v[186:187], v[194:195] op_sel:[1,1,0] op_sel_hi:[1,0,1] neg_lo:[0,1,0]
    v_cvt_pk_bf16_f32 v244, v172, v173
    v_pk_mul_f32 v[194:195], v[172:173], v[186:187] op_sel:[0,0] op_sel_hi:[0,1]
    v_pk_fma_f32 v[174:175], v[172:173], v[186:187], v[194:195] op_sel:[1,1,0] op_sel_hi:[1,0,1] neg_lo:[0,1,0]
    v_cvt_pk_bf16_f32 v245, v174, v175
    v_pk_mul_f32 v[194:195], v[174:175], v[186:187] op_sel:[0,0] op_sel_hi:[0,1]
    v_pk_fma_f32 v[172:173], v[174:175], v[186:187], v[194:195] op_sel:[1,1,0] op_sel_hi:[1,0,1] neg_lo:[0,1,0]
    v_cvt_pk_bf16_f32 v246, v172, v173
    v_pk_mul_f32 v[194:195], v[172:173], v[186:187] op_sel:[0,0] op_sel_hi:[0,1]
    v_pk_fma_f32 v[174:175], v[172:173], v[186:187], v[194:195] op_sel:[1,1,0] op_sel_hi:[1,0,1] neg_lo:[0,1,0]
    v_cvt_pk_bf16_f32 v247, v174, v175
    v_pk_mul_f32 v[194:195], v[174:175], v[186:187] op_sel:[0,0] op_sel_hi:[0,1]
    v_pk_fma_f32 v[172:173], v[174:175], v[186:187], v[194:195] op_sel:[1,1,0] op_sel_hi:[1,0,1] neg_lo:[0,1,0]
    v_cvt_pk_bf16_f32 v248, v172, v173
    v_pk_mul_f32 v[194:195], v[172:173], v[186:187] op_sel:[0,0] op_sel_hi:[0,1]
    v_pk_fma_f32 v[174:175], v[172:173], v[186:187], v[194:195] op_sel:[1,1,0] op_sel_hi:[1,0,1] neg_lo:[0,1,0]
    v_cvt_pk_bf16_f32 v249, v174, v175
    v_pk_mul_f32 v[194:195], v[174:175], v[186:187] op_sel:[0,0] op_sel_hi:[0,1]
    v_pk_fma_f32 v[172:173], v[174:175], v[186:187], v[194:195] op_sel:[1,1,0] op_sel_hi:[1,0,1] neg_lo:[0,1,0]
    v_cvt_pk_bf16_f32 v250, v172, v173
    v_pk_mul_f32 v[194:195], v[172:173], v[186:187] op_sel:[0,0] op_sel_hi:[0,1]
    s_waitcnt vmcnt(4)
    v_cmp_gt_u32 vcc, 32, v7
    s_nop 0
    s_and_b64 vcc, vcc, s[50:51]
    s_cbranch_scc1 ps_7
pc_9:
    s_barrier
    v_pk_fma_f32 v[174:175], v[172:173], v[186:187], v[194:195] op_sel:[1,1,0] op_sel_hi:[1,0,1] neg_lo:[0,1,0]
    v_cvt_pk_bf16_f32 v251, v174, v175
    ds_write_addtid_b32 v242 offset:2720
    ds_write_addtid_b32 v243 offset:2992
    ds_write_addtid_b32 v244 offset:3264
    ds_write_addtid_b32 v245 offset:3536
    ds_write_addtid_b32 v246 offset:3808
    ds_write_addtid_b32 v247 offset:4080
    ds_write_addtid_b32 v248 offset:4352
    ds_write_addtid_b32 v249 offset:4624
    ds_write_addtid_b32 v250 offset:4896
    ds_write_addtid_b32 v251 offset:5168
    v_pk_mul_f32 v[194:195], v[174:175], v[186:187] op_sel:[0,0] op_sel_hi:[0,1]
    v_pk_fma_f32 v[172:173], v[174:175], v[186:187], v[194:195] op_sel:[1,1,0] op_sel_hi:[1,0,1] neg_lo:[0,1,0]
    v_cvt_pk_bf16_f32 v242, v172, v173
    buffer_load_dwordx4 a[0:3], v200, s[16:19], s101 offen offset:0 sc1
    v_pk_mul_f32 v[194:195], v[172:173], v[186:187] op_sel:[0,0] op_sel_hi:[0,1]
    v_pk_fma_f32 v[174:175], v[172:173], v[186:187], v[194:195] op_sel:[1,1,0] op_sel_hi:[1,0,1] neg_lo:[0,1,0]
    v_cvt_pk_bf16_f32 v243, v174, v175
    v_pk_mul_f32 v[194:195], v[174:175], v[186:187] op_sel:[0,0] op_sel_hi:[0,1]
    v_pk_fma_f32 v[172:173], v[174:175], v[186:187], v[194:195] op_sel:[1,1,0] op_sel_hi:[1,0,1] neg_lo:[0,1,0]
    v_cvt_pk_bf16_f32 v244, v172, v173
    v_pk_mul_f32 v[194:195], v[172:173], v[186:187] op_sel:[0,0] op_sel_hi:[0,1]
    v_pk_fma_f32 v[174:175], v[172:173], v[186:187], v[194:195] op_sel:[1,1,0] op_sel_hi:[1,0,1] neg_lo:[0,1,0]
    v_cvt_pk_bf16_f32 v245, v174, v175
    v_pk_mul_f32 v[194:195], v[174:175], v[186:187] op_sel:[0,0] op_sel_hi:[0,1]
    v_pk_fma_f32 v[172:173], v[174:175], v[186:187], v[194:195] op_sel:[1,1,0] op_sel_hi:[1,0,1] neg_lo:[0,1,0]
    v_cvt_pk_bf16_f32 v246, v172, v173
    v_pk_mul_f32 v[194:195], v[172:173], v[186:187] op_sel:[0,0] op_sel_hi:[0,1]
    v_pk_fma_f32 v[174:175], v[172:173], v[186:187], v[194:195] op_sel:[1,1,0] op_sel_hi:[1,0,1] neg_lo:[0,1,0]
    v_cvt_pk_bf16_f32 v247, v174, v175
    buffer_load_dwordx4 a[4:7], v200, s[16:19], s101 offen offset:1024 sc1
    v_pk_mul_f32 v[194:195], v[174:175], v[186:187] op_sel:[0,0] op_sel_hi:[0,1]
    v_pk_fma_f32 v[172:173], v[174:175], v[186:187], v[194:195] op_sel:[1,1,0] op_sel_hi:[1,0,1] neg_lo:[0,1,0]
    v_cvt_pk_bf16_f32 v248, v172, v173
    v_pk_mul_f32 v[194:195], v[172:173], v[186:187] op_sel:[0,0] op_sel_hi:[0,1]
    v_pk_fma_f32 v[174:175], v[172:173], v[186:187], v[194:195] op_sel:[1,1,0] op_sel_hi:[1,0,1] neg_lo:[0,1,0]
    v_cvt_pk_bf16_f32 v249, v174, v175
    v_pk_mul_f32 v[194:195], v[174:175], v[186:187] op_sel:[0,0] op_sel_hi:[0,1]
    v_pk_fma_f32 v[172:173], v[174:175], v[186:187], v[194:195] op_sel:[1,1,0] op_sel_hi:[1,0,1] neg_lo:[0,1,0]
    v_cvt_pk_bf16_f32 v250, v172, v173
    v_pk_mul_f32 v[194:195], v[172:173], v[186:187] op_sel:[0,0] op_sel_hi:[0,1]
    v_pk_fma_f32 v[174:175], v[172:173], v[186:187], v[194:195] op_sel:[1,1,0] op_sel_hi:[1,0,1] neg_lo:[0,1,0]
    v_cvt_pk_bf16_f32 v251, v174, v175
    ds_write_addtid_b32 v242 offset:5440
    ds_write_addtid_b32 v243 offset:5712
    ds_write_addtid_b32 v244 offset:5984
    buffer_load_dwordx4 a[8:11], v200, s[16:19], s101 offen offset:2048 sc1
    ds_write_addtid_b32 v245 offset:6256
    ds_write_addtid_b32 v246 offset:6528
    ds_write_addtid_b32 v247 offset:6800
    ds_write_addtid_b32 v248 offset:7072
    ds_write_addtid_b32 v249 offset:7344
    ds_write_addtid_b32 v250 offset:7616
    ds_write_addtid_b32 v251 offset:7888
    v_pk_mul_f32 v[194:195], v[174:175], v[186:187] op_sel:[0,0] op_sel_hi:[0,1]
    v_pk_fma_f32 v[172:173], v[174:175], v[186:187], v[194:195] op_sel:[1,1,0] op_sel_hi:[1,0,1] neg_lo:[0,1,0]
    v_cvt_pk_bf16_f32 v242, v172, v173
    v_pk_mul_f32 v[194:195], v[172:173], v[186:187] op_sel:[0,0] op_sel_hi:[0,1]
    v_pk_fma_f32 v[174:175], v[172:173], v[186:187], v[194:195] op_sel:[1,1,0] op_sel_hi:[1,0,1] neg_lo:[0,1,0]
    v_cvt_pk_bf16_f32 v243, v174, v175
    ds_write_addtid_b32 v242 offset:8160
    ds_write_addtid_b32 v243 offset:8432
    buffer_load_dwordx4 a[12:15], v200, s[16:19], s101 offen offset:3072 sc1
    ds_read_b128 a[160:163], v252 offset:0
    ds_read_b128 a[164:167], v252 offset:32
    ds_read_b128 a[168:171], v252 offset:64
    ds_read_b128 a[172:175], v252 offset:96
    ds_read_b128 a[176:179], v252 offset:128
    ds_read_b128 a[180:183], v252 offset:160
    ds_read_b128 a[184:187], v252 offset:192
    ds_read_b128 a[188:191], v252 offset:224
    v_pk_mul_f32 v[194:195], v[180:181], v[180:181] op_sel:[0,0] op_sel_hi:[0,1]
    v_pk_fma_f32 v[182:183], v[180:181], v[180:181], v[194:195] op_sel:[1,1,0] op_sel_hi:[1,0,1] neg_lo:[0,1,0]
    v_pk_mul_f32 v[194:195], v[182:183], v[182:183] op_sel:[0,0] op_sel_hi:[0,1]
    v_pk_fma_f32 v[184:185], v[182:183], v[182:183], v[194:195] op_sel:[1,1,0] op_sel_hi:[1,0,1] neg_lo:[0,1,0]
    v_cvt_pk_bf16_f32 v242, v192, -v193
    v_pk_mul_f32 v[194:195], v[192:193], v[180:181] op_sel:[0,0] op_sel_hi:[0,1]
    v_pk_fma_f32 v[174:175], v[192:193], v[180:181], v[194:195] op_sel:[1,1,0] op_sel_hi:[1,0,1] neg_lo:[0,1,0]
    s_add_u32 s101, s101, 4096
    buffer_load_dwordx4 a[16:19], v200, s[16:19], s101 offen offset:0 sc1
    v_cvt_pk_bf16_f32 v243, v174, -v175
    v_pk_mul_f32 v[194:195], v[174:175], v[180:181] op_sel:[0,0] op_sel_hi:[0,1]
    v_pk_fma_f32 v[172:173], v[174:175], v[180:181], v[194:195] op_sel:[1,1,0] op_sel_hi:[1,0,1] neg_lo:[0,1,0]
    v_cvt_pk_bf16_f32 v244, v172, -v173
    v_pk_mul_f32 v[194:195], v[172:173], v[180:181] op_sel:[0,0] op_sel_hi:[0,1]
    v_pk_fma_f32 v[174:175], v[172:173], v[180:181], v[194:195] op_sel:[1,1,0] op_sel_hi:[1,0,1] neg_lo:[0,1,0]
    v_cvt_pk_bf16_f32 v245, v174, -v175
    v_pk_mul_f32 v[194:195], v[174:175], v[180:181] op_sel:[0,0] op_sel_hi:[0,1]
    v_pk_fma_f32 v[172:173], v[174:175], v[180:181], v[194:195] op_sel:[1,1,0] op_sel_hi:[1,0,1] neg_lo:[0,1,0]
    v_cvt_pk_bf16_f32 v246, v172, -v173
    v_pk_mul_f32 v[194:195], v[172:173], v[180:181] op_sel:[0,0] op_sel_hi:[0,1]
    v_pk_fma_f32 v[174:175], v[172:173], v[180:181], v[194:195] op_sel:[1,1,0] op_sel_hi:[1,0,1] neg_lo:[0,1,0]
    v_cvt_pk_bf16_f32 v247, v174, -v175
    v_pk_mul_f32 v[194:195], v[174:175], v[180:181] op_sel:[0,0] op_sel_hi:[0,1]
    v_pk_fma_f32 v[172:173], v[174:175], v[180:181], v[194:195] op_sel:[1,1,0] op_sel_hi:[1,0,1] neg_lo:[0,1,0]
    buffer_load_dwordx4 a[20:23], v200, s[16:19], s101 offen offset:1024 sc1
    v_cvt_pk_bf16_f32 v248, v172, -v173
    v_pk_mul_f32 v[194:195], v[172:173], v[180:181] op_sel:[0,0] op_sel_hi:[0,1]
    v_pk_fma_f32 v[174:175], v[172:173], v[180:181], v[194:195] op_sel:[1,1,0] op_sel_hi:[1,0,1] neg_lo:[0,1,0]
    v_cvt_pk_bf16_f32 v249, v174, -v175
    v_pk_mul_f32 v[194:195], v[192:193], v[190:191] op_sel:[0,0] op_sel_hi:[0,1]
    v_pk_fma_f32 v[176:177], v[192:193], v[190:191], v[194:195] op_sel:[1,1,0] op_sel_hi:[1,0,1] neg_lo:[0,1,0]
    v_cvt_pk_bf16_f32 v250, v176, -v177
    v_pk_mul_f32 v[194:195], v[176:177], v[182:183] op_sel:[0,0] op_sel_hi:[0,1]
    v_pk_fma_f32 v[174:175], v[176:177], v[182:183], v[194:195] op_sel:[1,1,0] op_sel_hi:[1,0,1] neg_lo:[0,1,0]
    v_cvt_pk_bf16_f32 v251, v174, -v175
    ds_write_addtid_b32 v242 offset:0
    ds_write_addtid_b32 v243 offset:272
    ds_write_addtid_b32 v244 offset:544
    ds_write_addtid_b32 v245 offset:816
    ds_write_addtid_b32 v246 offset:1088
    buffer_load_dwordx4 a[24:27], v200, s[16:19], s101 offen offset:2048 sc1
    ds_write_addtid_b32 v247 offset:1360
    ds_write_addtid_b32 v248 offset:1632
    ds_write_addtid_b32 v249 offset:1904
    ds_write_addtid_b32 v250 offset:2176
    ds_write_addtid_b32 v251 offset:2448
    v_pk_mul_f32 v[194:195], v[174:175], v[182:183] op_sel:[0,0] op_sel_hi:[0,1]
    v_pk_fma_f32 v[172:173], v[174:175], v[182:183], v[194:195] op_sel:[1,1,0] op_sel_hi:[1,0,1] neg_lo:[0,1,0]
    v_cvt_pk_bf16_f32 v242, v172, -v173
    v_pk_mul_f32 v[194:195], v[172:173], v[182:183] op_sel:[0,0] op_sel_hi:[0,1]
    v_pk_fma_f32 v[174:175], v[172:173], v[182:183], v[194:195] op_sel:[1,1,0] op_sel_hi:[1,0,1] neg_lo:[0,1,0]
    v_cvt_pk_bf16_f32 v243, v174, -v175
    v_pk_mul_f32 v[194:195], v[174:175], v[182:183] op_sel:[0,0] op_sel_hi:[0,1]
    v_pk_fma_f32 v[172:173], v[174:175], v[182:183], v[194:195] op_sel:[1,1,0] op_sel_hi:[1,0,1] neg_lo:[0,1,0]
    v_cvt_pk_bf16_f32 v244, v172, -v173
    v_pk_mul_f32 v[194:195], v[176:177], v[190:191] op_sel:[0,0] op_sel_hi:[0,1]
    buffer_load_dwordx4 a[28:31], v200, s[16:19], s101 offen offset:3072 sc1
    v_pk_fma_f32 v[178:179], v[176:177], v[190:191], v[194:195] op_sel:[1,1,0] op_sel_hi:[1,0,1] neg_lo:[0,1,0]
    v_cvt_pk_bf16_f32 v245, v178, -v179
    v_pk_mul_f32 v[194:195], v[178:179], v[184:185] op_sel:[0,0] op_sel_hi:[0,1]
    v_pk_fma_f32 v[174:175], v[178:179], v[184:185], v[194:195] op_sel:[1,1,0] op_sel_hi:[1,0,1] neg_lo:[0,1,0]
    v_cvt_pk_bf16_f32 v246, v174, -v175
    v_pk_mul_f32 v[194:195], v[174:175], v[184:185] op_sel:[0,0] op_sel_hi:[0,1]
    v_pk_fma_f32 v[172:173], v[174:175], v[184:185], v[194:195] op_sel:[1,1,0] op_sel_hi:[1,0,1] neg_lo:[0,1,0]
    v_cvt_pk_bf16_f32 v247, v172, -v173
    v_pk_mul_f32 v[194:195], v[178:179], v[190:191] op_sel:[0,0] op_sel_hi:[0,1]
    v_pk_fma_f32 v[176:177], v[178:179], v[190:191], v[194:195] op_sel:[1,1,0] op_sel_hi:[1,0,1] neg_lo:[0,1,0]
    v_cvt_pk_bf16_f32 v248, v176, -v177
    v_pk_mul_f32 v[194:195], v[176:177], v[184:185] op_sel:[0,0] op_sel_hi:[0,1]
    v_pk_fma_f32 v[174:175], v[176:177], v[184:185], v[194:195] op_sel:[1,1,0] op_sel_hi:[1,0,1] neg_lo:[0,1,0]
    v_cvt_pk_bf16_f32 v249, v174, -v175
    v_pk_mul_f32 v[194:195], v[174:175], v[184:185] op_sel:[0,0] op_sel_hi:[0,1]
    s_add_u32 s101, s101, 4096
    buffer_load_dwordx4 a[32:35], v200, s[16:19], s101 offen offset:0 sc1
    v_pk_fma_f32 v[172:173], v[174:175], v[184:185], v[194:195] op_sel:[1,1,0] op_sel_hi:[1,0,1] neg_lo:[0,1,0]
    v_cvt_pk_bf16_f32 v250, v172, -v173
    v_pk_mul_f32 v[194:195], v[176:177], v[190:191] op_sel:[0,0] op_sel_hi:[0,1]
    v_pk_fma_f32 v[178:179], v[176:177], v[190:191], v[194:195] op_sel:[1,1,0] op_sel_hi:[1,0,1] neg_lo:[0,1,0]
    v_cvt_pk_bf16_f32 v251, v178, -v179
    ds_write_addtid_b32 v242 offset:2720
    ds_write_addtid_b32 v242 offset:3264
    ds_write_addtid_b32 v243 offset:3536
    ds_write_addtid_b32 v244 offset:3808
    ds_write_addtid_b32 v245 offset:4352
    ds_write_addtid_b32 v246 offset:4624
    ds_write_addtid_b32 v247 offset:4896
    ds_write_addtid_b32 v248 offset:5440
    ds_write_addtid_b32 v249 offset:5712
    ds_write_addtid_b32 v250 offset:5984
    buffer_load_dwordx4 a[36:39], v200, s[16:19], s101 offen offset:1024 sc1
    ds_write_addtid_b32 v251 offset:6528
    v_pk_mul_f32 v[194:195], v[178:179], v[186:187] op_sel:[0,0] op_sel_hi:[0,1]
    v_pk_fma_f32 v[174:175], v[178:179], v[186:187], v[194:195] op_sel:[1,1,0] op_sel_hi:[1,0,1] neg_lo:[0,1,0]
    v_cvt_pk_bf16_f32 v242, v174, -v175
    v_pk_mul_f32 v[194:195], v[178:179], v[190:191] op_sel:[0,0] op_sel_hi:[0,1]
    v_pk_fma_f32 v[176:177], v[178:179], v[190:191], v[194:195] op_sel:[1,1,0] op_sel_hi:[1,0,1] neg_lo:[0,1,0]
    v_cvt_pk_bf16_f32 v243, v176, -v177
    v_pk_mul_f32 v[194:195], v[176:177], v[186:187] op_sel:[0,0] op_sel_hi:[0,1]
    v_pk_fma_f32 v[174:175], v[176:177], v[186:187], v[194:195] op_sel:[1,1,0] op_sel_hi:[1,0,1] neg_lo:[0,1,0]
    v_cvt_pk_bf16_f32 v244, v174, -v175
    v_pk_mul_f32 v[194:195], v[176:177], v[190:191] op_sel:[0,0] op_sel_hi:[0,1]
    v_pk_fma_f32 v[178:179], v[176:177], v[190:191], v[194:195] op_sel:[1,1,0] op_sel_hi:[1,0,1] neg_lo:[0,1,0]
    v_cvt_pk_bf16_f32 v245, v178, -v179
    v_pk_mul_f32 v[194:195], v[178:179], v[186:187] op_sel:[0,0] op_sel_hi:[0,1]
    v_pk_fma_f32 v[174:175], v[178:179], v[186:187], v[194:195] op_sel:[1,1,0] op_sel_hi:[1,0,1] neg_lo:[0,1,0]
    buffer_load_dwordx4 a[40:43], v200, s[16:19], s101 offen offset:2048 sc1
    v_cvt_pk_bf16_f32 v246, v174, -v175
    v_pk_mul_f32 v[194:195], v[178:179], v[190:191] op_sel:[0,0] op_sel_hi:[0,1]
    v_pk_fma_f32 v[176:177], v[178:179], v[190:191], v[194:195] op_sel:[1,1,0] op_sel_hi:[1,0,1] neg_lo:[0,1,0]
    v_cvt_pk_bf16_f32 v247, v176, -v177
    v_pk_mul_f32 v[194:195], v[176:177], v[186:187] op_sel:[0,0] op_sel_hi:[0,1]
    v_pk_fma_f32 v[174:175], v[176:177], v[186:187], v[194:195] op_sel:[1,1,0] op_sel_hi:[1,0,1] neg_lo:[0,1,0]
    v_cvt_pk_bf16_f32 v248, v174, -v175
    ds_write_addtid_b32 v242 offset:6800
    ds_write_addtid_b32 v243 offset:7072
    ds_write_addtid_b32 v244 offset:7344
    ds_write_addtid_b32 v245 offset:7616
    ds_write_addtid_b32 v246 offset:7888
    ds_write_addtid_b32 v247 offset:8160
    ds_write_addtid_b32 v248 offset:8432
    ds_read_b128 a[192:195], v252 offset:0
    buffer_load_dwordx4 a[44:47], v200, s[16:19], s101 offen offset:3072 sc1
    ds_read_b128 a[196:199], v252 offset:32
    ds_read_b128 a[200:203], v252 offset:64
    ds_read_b128 a[204:207], v252 offset:96
    ds_read_b128 a[208:211], v252 offset:128
    ds_read_b128 a[212:215], v252 offset:160
    ds_read_b128 a[216:219], v252 offset:192
    ds_read_b128 a[220:223], v252 offset:224
    s_add_u32 m0, s92, 75520
    s_nop 0
    buffer_load_dwordx4 v75, s[4:7], s99 offen offset:2176  lds
    s_waitcnt lgkmcnt(7)
    v_mfma_f32_32x32x16_bf16 v[216:231], a[192:195], a[160:163], v[216:231]
    s_add_u32 m0, s92, 75520
    s_nop 0
    buffer_load_dwordx4 v76, s[4:7], s99 offen offset:3264  lds
    s_waitcnt lgkmcnt(6)
    v_mfma_f32_32x32x16_bf16 v[216:231], a[196:199], a[164:167], v[216:231]
    s_add_u32 m0, s93, 92928
    s_add_u32 s99, s99, 256
    s_add_u32 s101, s101, 4096
    buffer_load_dwordx4 a[48:51], v200, s[16:19], s101 offen offset:0 sc1
    s_mov_b64 exec, s[80:81]
    buffer_load_dwordx4 v77, s[4:7], s100 offen  lds
    s_mov_b64 exec, -1
    s_add_u32 s100, s100, 256
    s_waitcnt lgkmcnt(5)
    v_mfma_f32_32x32x16_bf16 v[216:231], a[200:203], a[168:171], v[216:231]
    s_add_u32 m0, s92, 95104
    s_nop 0
    buffer_load_dwordx4 v73, s[4:7], s99 offen offset:0  lds
    s_waitcnt lgkmcnt(4)
    v_mfma_f32_32x32x16_bf16 v[216:231], a[204:207], a[172:175], v[216:231]
    s_add_u32 m0, s92, 95104
    s_nop 0
    buffer_load_dwordx4 v74, s[4:7], s99 offen offset:1088  lds
    s_waitcnt lgkmcnt(3)
    v_mfma_f32_32x32x16_bf16 v[216:231], a[208:211], a[176:179], v[216:231]
    s_add_u32 m0, s92, 95104
    s_nop 0
    buffer_load_dwordx4 v75, s[4:7], s99 offen offset:2176  lds
    s_waitcnt lgkmcnt(2)
    v_mfma_f32_32x32x16_bf16 v[216:231], a[212:215], a[180:183], v[216:231]
    s_add_u32 m0, s92, 95104
    buffer_load_dwordx4 a[52:55], v200, s[16:19], s101 offen offset:1024 sc1
    buffer_load_dwordx4 v76, s[4:7], s99 offen offset:3264  lds
    s_waitcnt lgkmcnt(1)
    v_mfma_f32_32x32x16_bf16 v[216:231], a[216:219], a[184:187], v[216:231]
    s_add_u32 m0, s93, 112512
    s_add_u32 s99, s99, 256
    s_mov_b64 exec, s[80:81]
    buffer_load_dwordx4 v77, s[4:7], s100 offen  lds
    s_mov_b64 exec, -1
    s_add_u32 s100, s100, 256
    s_waitcnt lgkmcnt(0)
    v_mfma_f32_32x32x16_bf16 v[216:231], a[220:223], a[188:191], v[216:231]
    s_add_u32 m0, s92, 114688
    s_nop 0
    buffer_load_dwordx4 v73, s[4:7], s99 offen offset:0  lds
    s_add_u32 m0, s92, 114688
    s_nop 0
    buffer_load_dwordx4 v74, s[4:7], s99 offen offset:1088  lds
    s_add_u32 m0, s92, 114688
    s_nop 0
    buffer_load_dwordx4 v75, s[4:7], s99 offen offset:2176  lds
    s_add_u32 m0, s92, 114688
    s_nop 0
    buffer_load_dwordx4 v76, s[4:7], s99 offen offset:3264  lds
    s_add_u32 m0, s93, 132096
    s_add_u32 s99, s99, 256
    s_mov_b64 exec, s[80:81]
    buffer_load_dwordx4 v77, s[4:7], s100 offen  lds
    s_mov_b64 exec, -1
    s_add_u32 s100, s100, 256
    s_mov_b32 m0, s37
    s_branch ec_3
nc_2:
    s_cmp_lg_u32 s2, 255
    s_cbranch_scc1 fr_10
    v_mov_b32 v2, 1
    s_waitcnt vmcnt(9)
    s_barrier
    s_mov_b64 exec, 1
    global_store_dword v5, v2, s[66:67] sc1
    s_mov_b64 exec, -1
fr_10:
    s_sub_u32 s33, s2, 160
    s_min_u32 s33, s33, 159
    s_mul_i32 s29, s33, 3277
    s_lshr_b32 s29, s29, 16
    s_mul_i32 s30, s29, 20
    s_sub_u32 s30, s33, s30
    s_mul_i32 s31, s30, 13108
    s_lshr_b32 s31, s31, 16
    s_mul_i32 s32, s31, 5
    s_sub_u32 s32, s30, s32
    s_lshl_b32 s28, s24, 10
    s_lshr_b32 s34, s32, 1
    s_mul_i32 s34, s34, 20
    s_and_b32 s35, s32, 1
    s_lshl_b32 s35, s35, 3
    s_add_u32 s34, s34, s35
    s_cmp_eq_u32 s32, 4
    s_cselect_b32 s34, 16, s34
    s_cselect_b32 s35, 20, 4
    s_mul_i32 s36, s31, 160
    s_add_u32 s34, s34, s36
    s_mul_i32 s34, s34, 1280
    s_mul_i32 s36, s29, 160
    s_add_u32 s34, s34, s36
    v_add_u32 v162, 0, v0
    v_mul_u32_u24 v160, 6554, v162
    v_lshrrev_b32 v160, 16, v160
    v_mul_u32_u24 v161, 10, v160
    v_sub_u32 v161, v162, v161
    v_lshrrev_b32 v163, 3, v160
    v_mul_u32_u24 v163, 40, v163
    v_bfe_u32 v164, v160, 2, 1
    v_mul_u32_u24 v164, s35, v164
    v_and_b32 v160, 3, v160
    v_add3_u32 v160, v160, v163, v164
    v_mul_u32_u24 v160, 1280, v160
    v_lshl_add_u32 v162, v161, 4, v160
    s_add_u32 m0, s28, 0
    s_nop 0
    buffer_load_dwordx4 v162, s[12:15], s34 offen lds
    v_add_u32 v162, 256, v0
    v_min_u32 v162, 319, v162
    v_mul_u32_u24 v160, 6554, v162
    v_lshrrev_b32 v160, 16, v160
    v_mul_u32_u24 v161, 10, v160
    v_sub_u32 v161, v162, v161
    v_lshrrev_b32 v163, 3, v160
    v_mul_u32_u24 v163, 40, v163
    v_bfe_u32 v164, v160, 2, 1
    v_mul_u32_u24 v164, s35, v164
    v_and_b32_e64 v160, 3, v160
    v_add3_u32 v160, v160, v163, v164
    v_mul_u32_u24 v160, 1280, v160
    v_lshl_add_u32 v162, v161, 4, v160
    s_add_u32 m0, s28, 4096
    s_nop 0
    buffer_load_dwordx4 v162, s[12:15], s34 offen lds
    v_bfe_u32 v163, v0, 4, 2
    v_bfe_u32 v164, v0, 2, 2
    v_lshl_add_u32 v163, v163, 3, v164
    v_mul_u32_u24 v163, 160, v163
    v_and_b32 v164, 3, v0
    v_lshl_add_u32 v165, v164, 3, v163
    v_add_u32 v165, 0, v165
    s_lshl_b32 s36, s24, 5
    v_add_u32_e64 v166, s36, v165
    s_mul_i32 s33, s33, 5120
    s_add_u32 s33, s33, 2621440
    v_lshl_add_u32 v167, v1, 4, s33
    v_add_u32 v164, 4096, v167
    v_mov_b32 v163, 1073741824
    v_cmp_gt_u32 vcc, 64, v0
    s_sub_u32 s36, s24, s31
    s_and_b32 s36, s36, 3
    s_lshl_b32 s36, s36, 10
    v_cndmask_b32 v168, v163, v164, vcc
    v_add_u32 v167, s36, v167
    s_sub_u32 s33, s2, 64
    s_min_u32 s33, s33, 159
    s_mul_i32 s29, s33, 3277
    s_lshr_b32 s29, s29, 16
    s_mul_i32 s30, s29, 20
    s_sub_u32 s30, s33, s30
    s_mul_i32 s31, s30, 13108
    s_lshr_b32 s31, s31, 16
    s_mul_i32 s32, s31, 5
    s_sub_u32 s32, s30, s32
    s_lshl_b32 s28, s24, 10
    s_lshr_b32 s34, s32, 1
    s_mul_i32 s34, s34, 20
    s_and_b32 s35, s32, 1
    s_lshl_b32 s35, s35, 3
    s_add_u32 s34, s34, s35
    s_cmp_eq_u32 s32, 4
    s_cselect_b32 s34, 16, s34
    s_cselect_b32 s35, 20, 4
    s_mul_i32 s36, s31, 160
    s_add_u32 s34, s34, s36
    s_mul_i32 s34, s34, 1280
    s_mul_i32 s36, s29, 160
    s_add_u32 s34, s34, s36
    v_add_u32 v182, 0, v0
    v_mul_u32_u24 v180, 6554, v182
    v_lshrrev_b32 v180, 16, v180
    v_mul_u32_u24 v181, 10, v180
    v_sub_u32 v181, v182, v181
    v_lshrrev_b32 v183, 3, v180
    v_mul_u32_u24 v183, 40, v183
    v_bfe_u32 v184, v180, 2, 1
    v_mul_u32_u24 v184, s35, v184
    v_and_b32_e64 v180, 3, v180
    v_add3_u32 v180, v180, v183, v184
    v_mul_u32_u24 v180, 1280, v180
    v_lshl_add_u32 v182, v181, 4, v180
    s_add_u32 m0, s28, 8192
    s_nop 0
    buffer_load_dwordx4 v182, s[12:15], s34 offen lds
    v_add_u32 v182, 256, v0
    v_min_u32 v182, 319, v182
    v_mul_u32_u24 v180, 6554, v182
    v_lshrrev_b32 v180, 16, v180
    v_mul_u32_u24 v181, 10, v180
    v_sub_u32 v181, v182, v181
    v_lshrrev_b32 v183, 3, v180
    v_mul_u32_u24 v183, 40, v183
    v_bfe_u32 v184, v180, 2, 1
    v_mul_u32_u24 v184, s35, v184
    v_and_b32 v180, 3, v180
    v_add3_u32 v180, v180, v183, v184
    v_mul_u32_u24 v180, 1280, v180
    v_lshl_add_u32 v182, v181, 4, v180
    s_add_u32 m0, s28, 12288
    s_nop 0
    buffer_load_dwordx4 v182, s[12:15], s34 offen lds
    v_bfe_u32 v183, v0, 4, 2
    v_bfe_u32 v184, v0, 2, 2
    v_lshl_add_u32 v183, v183, 3, v184
    v_mul_u32_u24 v183, 160, v183
    v_and_b32 v184, 3, v0
    v_lshl_add_u32 v185, v184, 3, v183
    v_add_u32 v185, 8192, v185
    s_lshl_b32 s36, s24, 5
    v_add_u32 v186, s36, v185
    s_mul_i32 s33, s33, 5120
    s_add_u32 s33, s33, 2621440
    v_lshl_add_u32 v187, v1, 4, s33
    v_add_u32 v184, 4096, v187
    v_mov_b32 v183, 1073741824
    v_cmp_gt_u32 vcc, 64, v0
    s_sub_u32 s36, s24, s31
    s_and_b32 s36, s36, 3
    s_lshl_b32 s36, s36, 10
    v_cndmask_b32 v188, v183, v184, vcc
    v_add_u32 v187, s36, v187
    v_mov_b32 v216, 0
    v_mov_b32 v217, 0
    v_mov_b32 v218, 0
    v_mov_b32 v219, 0
    v_mov_b32 v220, 0
    v_mov_b32 v221, 0
    v_mov_b32 v222, 0
    v_mov_b32 v223, 0
    v_mov_b32 v224, 0
    v_mov_b32 v225, 0
    v_mov_b32 v226, 0
    v_mov_b32 v227, 0
    v_mov_b32 v228, 0
    v_mov_b32 v229, 0
    v_mov_b32 v230, 0
    v_mov_b32_e64 v231, 0
    s_waitcnt vmcnt(5)
    s_barrier
    ds_read_b64_tr_b16 v[96:97], v111
    ds_read_b64_tr_b16 v[98:99], v111 offset:2560
    ds_read_b64_tr_b16 v[100:101], v112
    ds_read_b64_tr_b16 v[102:103], v112 offset:2560
    ds_read_b64_tr_b16 v[104:105], v113
    ds_read_b64_tr_b16 v[106:107], v113 offset:2560
    s_waitcnt lgkmcnt(4)
    buffer_store_dwordx4 v[96:99], v108, s[16:19], 0 offen sc1
    s_waitcnt lgkmcnt(2)
    buffer_store_dwordx4 v[100:103], v109, s[16:19], 0 offen sc1
    s_waitcnt lgkmcnt(0)
    buffer_store_dwordx4 v[104:107], v110, s[16:19], 0 offen sc1
    global_load_dword v7, v5, s[66:67] sc1
    v_lshrrev_b32 v132, 5, v0
    v_and_b32_e64 v133, 31, v0
    v_mul_u32_u24 v132, 1280, v132
    v_lshl_add_u32 v134, v133, 4, v132
    v_mov_b32 v135, 1073741824
    v_cmp_gt_u32 vcc, 16, v133
    s_mul_i32 s96, s2, 10240
    buffer_load_dwordx4 v[120:123], v134, s[4:7], s96 offen
    v_cndmask_b32_e64 v135, v135, v134, vcc
    buffer_load_dwordx4 v[124:127], v134, s[4:7], s96 offen offset:512
    buffer_load_dwordx4 v[128:131], v135, s[4:7], s96 offen offset:1024
    s_waitcnt vmcnt(4)
    s_waitcnt vmcnt(3)
    v_cmp_gt_u32 vcc, 1, v7
    s_nop 0
    s_and_b64 vcc, vcc, s[50:51]
    s_and_b64 vcc, vcc, 1
    s_cbranch_scc1 ps_11
pc_13:
    s_barrier
    v_lshlrev_b32 v2, 3, v4
    v_mov_b32 v5, 1
    v_cndmask_b32 v2, v4, v2, s[50:51]
    buffer_atomic_add v5, v2, s[16:19], s86 offen offset:0 sc1
    ds_read_b64_tr_b16 v[172:173], v166
    ds_read_b64_tr_b16 v[174:175], v166 offset:640
    ds_read_b64_tr_b16 v[176:177], v165 offset:128
    ds_read_b64_tr_b16 v[178:179], v165 offset:768
    s_waitcnt lgkmcnt(2)
    buffer_store_dwordx4 v[172:175], v167, s[16:19], 0 offen sc1
    s_waitcnt lgkmcnt(0)
    buffer_store_dwordx4 v[176:179], v168, s[16:19], 0 offen sc1
    ds_read_b64_tr_b16 v[192:193], v186
    ds_read_b64_tr_b16 v[194:195], v186 offset:640
    ds_read_b64_tr_b16 v[196:197], v185 offset:128
    ds_read_b64_tr_b16 v[198:199], v185 offset:768
    s_waitcnt lgkmcnt(2)
    buffer_store_dwordx4 v[192:195], v187, s[16:19], 0 offen sc1
    s_waitcnt lgkmcnt(0)
    buffer_store_dwordx4 v[196:199], v188, s[16:19], 0 offen sc1
    v_mov_b32 v134, 0x3f803f80
    v_mov_b32 v132, 0
    v_mov_b32 v133, 0
    s_waitcnt vmcnt(7)
    v_dot2c_f32_bf16 v132, v120, v134
    v_dot2c_f32_bf16 v133, v120, v120
    v_dot2c_f32_bf16 v132, v121, v134
    v_dot2c_f32_bf16 v133, v121, v121
    v_dot2c_f32_bf16 v132, v122, v134
    v_dot2c_f32_bf16 v133, v122, v122
    v_dot2c_f32_bf16 v132, v123, v134
    v_dot2c_f32_bf16 v133, v123, v123
    s_waitcnt vmcnt(6)
    v_dot2c_f32_bf16 v132, v124, v134
    v_dot2c_f32_bf16 v133, v124, v124
    v_dot2c_f32_bf16 v132, v125, v134
    v_dot2c_f32_bf16 v133, v125, v125
    v_dot2c_f32_bf16 v132, v126, v134
    v_dot2c_f32_bf16 v133, v126, v126
    v_dot2c_f32_bf16 v132, v127, v134
    v_dot2c_f32_bf16 v133, v127, v127
    s_waitcnt vmcnt(5)
    v_dot2c_f32_bf16 v132, v128, v134
    v_dot2c_f32_bf16 v133, v128, v128
    v_dot2c_f32_bf16 v132, v129, v134
    v_dot2c_f32_bf16 v133, v129, v129
    v_dot2c_f32_bf16 v132, v130, v134
    v_dot2c_f32_bf16 v133, v130, v130
    v_dot2c_f32_bf16 v132, v131, v134
    v_dot2c_f32_bf16 v133, v131, v131
    v_lshrrev_b32 v135, 5, v0
    v_and_b32 v121, 3, v135
    v_lshrrev_b32 v135, 2, v135
    v_add_f32_dpp v132, v132, v132 row_shr:1 row_mask:0xf bank_mask:0xf bound_ctrl:0
    v_add_f32_dpp v133, v133, v133 row_shr:1 row_mask:0xf bank_mask:0xf bound_ctrl:0
    v_lshlrev_b32_e64 v135, 3, v135
    v_add_f32_dpp v132, v132, v132 row_shr:2 row_mask:0xf bank_mask:0xf bound_ctrl:0
    v_add_f32_dpp v133, v133, v133 row_shr:2 row_mask:0xf bank_mask:0xf bound_ctrl:0
    v_lshl_add_u32 v135, v121, 12, v135
    v_add_f32_dpp v132, v132, v132 row_shr:4 row_mask:0xf bank_mask:0xf bound_ctrl:0
    v_add_f32_dpp v133, v133, v133 row_shr:4 row_mask:0xf bank_mask:0xf bound_ctrl:0
    v_and_b32_e64 v121, 31, v0
    v_add_f32_dpp v132, v132, v132 row_shr:8 row_mask:0xf bank_mask:0xf bound_ctrl:0
    v_add_f32_dpp v133, v133, v133 row_shr:8 row_mask:0xf bank_mask:0xf bound_ctrl:0
    v_cmp_eq_u32_e64 vcc, 31, v121
    v_add_f32_dpp v132, v132, v132 row_bcast:15 row_mask:0xa bank_mask:0xf
    v_add_f32_dpp v133, v133, v133 row_bcast:15 row_mask:0xa bank_mask:0xf
    v_mov_b32 v121, 1073741824
    v_cndmask_b32_e64 v120, v121, v135, vcc
    s_lshl_b32 s96, s2, 4
    s_add_u32 s96, s96, 3440640
    v_mul_f32 v135, 0x3acccccd, v132
    v_mul_f32 v133, 0x3acccccd, v133
    v_fma_f32 v133, -v135, v135, v133
    v_max_f32 v133, 0, v133
    v_add_f32 v133, 0x3727c5ac, v133
    v_rsq_f32_e64 v132, v133
    s_nop 0
    v_mul_f32 v133, -v135, v132
    buffer_store_dwordx2 v[132:133], v120, s[16:19], s96 offen sc1
    s_add_u32 m0, s92, 36352
    s_nop 0
    s_nop 0
    buffer_load_dwordx4 v73, s[4:7], s99 offen offset:0  lds
    buffer_load_dwordx4 v74, s[4:7], s99 offen offset:1088  lds
    buffer_load_dwordx4 v75, s[4:7], s99 offen offset:2176  lds
    buffer_load_dwordx4 v76, s[4:7], s99 offen offset:3264  lds
    s_add_u32 m0, s93, 53760
    s_add_u32 s99, s99, 256
    s_mov_b64 exec, s[80:81]
    buffer_load_dwordx4 v77, s[4:7], s100 offen  lds
    s_mov_b64 exec, -1
    s_add_u32 s100, s100, 256
    s_add_u32 m0, s92, 55936
    s_nop 0
    s_nop 0
    buffer_load_dwordx4 v73, s[4:7], s99 offen offset:0  lds
    buffer_load_dwordx4 v74, s[4:7], s99 offen offset:1088  lds
    buffer_load_dwordx4 v75, s[4:7], s99 offen offset:2176  lds
    buffer_load_dwordx4 v76, s[4:7], s99 offen offset:3264  lds
    s_add_u32 m0, s93, 73344
    s_add_u32 s99, s99, 256
    s_mov_b64 exec, s[80:81]
    buffer_load_dwordx4 v77, s[4:7], s100 offen  lds
    s_mov_b64 exec, -1
    s_add_u32 s100, s100, 256
    v_mov_b32 v140, 1073741824
    v_lshlrev_b32 v141, 2, v0
    v_cmp_gt_u32 vcc, 64, v0
    s_nop 1
    v_cndmask_b32 v141, v140, v141, vcc
    v_mov_b32_e64 v140, 0
    s_lshl_b32 s97, s2, 8
    s_add_u32 s97, s97, 3473408
    buffer_store_dword v140, v141, s[16:19], s97 offen sc1
    v_mov_b32 v142, 1073741824
    v_lshlrev_b32 v143, 2, v0
    v_cmp_gt_u32 vcc, 16, v0
    s_nop 1
    v_cndmask_b32 v143, v142, v143, vcc
    v_mov_b32_e64 v142, -1
    s_lshl_b32 s97, s2, 6
    s_add_u32 s97, s97, 3457024
    buffer_store_dword v142, v143, s[16:19], s97 offen sc1
    v_mov_b32 v144, -1
    v_mov_b32 v145, -1
    v_mov_b32 v146, -1
    v_mov_b32 v147, -1
    v_lshlrev_b32 v148, 4, v0
    s_sub_u32 s88, s2, 0
    s_mul_i32 s88, s88, 20480
    s_min_u32 s88, s88, 5222400
    s_add_u32 s88, s88, 4194304
    buffer_store_dwordx4 v[144:147], v148, s[16:19], s88 offen sc1
    s_add_u32 s88, s88, 4096
    buffer_store_dwordx4 v[144:147], v148, s[16:19], s88 offen sc1
    s_add_u32 s88, s88, 4096
    buffer_store_dwordx4 v[144:147], v148, s[16:19], s88 offen sc1
    s_add_u32 s88, s88, 4096
    buffer_store_dwordx4 v[144:147], v148, s[16:19], s88 offen sc1
    s_add_u32 s88, s88, 4096
    buffer_store_dwordx4 v[144:147], v148, s[16:19], s88 offen sc1
    s_add_u32 m0, s92, 75520
    s_nop 0
    s_nop 0
    buffer_load_dwordx4 v73, s[4:7], s99 offen offset:0  lds
    buffer_load_dwordx4 v74, s[4:7], s99 offen offset:1088  lds
    buffer_load_dwordx4 v75, s[4:7], s99 offen offset:2176  lds
    buffer_load_dwordx4 v76, s[4:7], s99 offen offset:3264  lds
    s_add_u32 m0, s93, 92928
    s_add_u32 s99, s99, 256
    s_mov_b64 exec, s[80:81]
    buffer_load_dwordx4 v77, s[4:7], s100 offen  lds
    s_mov_b64 exec, -1
    s_add_u32 s100, s100, 256
    s_add_u32 m0, s92, 95104
    s_nop 0
    s_nop 0
    buffer_load_dwordx4 v73, s[4:7], s99 offen offset:0  lds
    buffer_load_dwordx4 v74, s[4:7], s99 offen offset:1088  lds
    buffer_load_dwordx4 v75, s[4:7], s99 offen offset:2176  lds
    buffer_load_dwordx4 v76, s[4:7], s99 offen offset:3264  lds
    s_add_u32 m0, s93, 112512
    s_add_u32 s99, s99, 256
    s_mov_b64 exec, s[80:81]
    buffer_load_dwordx4 v77, s[4:7], s100 offen  lds
    s_mov_b64 exec, -1
    s_add_u32 s100, s100, 256
    s_add_u32 m0, s92, 114688
    s_nop 0
    s_nop 0
    buffer_load_dwordx4 v73, s[4:7], s99 offen offset:0  lds
    buffer_load_dwordx4 v74, s[4:7], s99 offen offset:1088  lds
    buffer_load_dwordx4 v75, s[4:7], s99 offen offset:2176  lds
    buffer_load_dwordx4 v76, s[4:7], s99 offen offset:3264  lds
    s_add_u32 m0, s93, 132096
    s_add_u32 s99, s99, 256
    s_mov_b64 exec, s[80:81]
    buffer_load_dwordx4 v77, s[4:7], s100 offen  lds
    s_mov_b64 exec, -1
    s_add_u32 s100, s100, 256
    s_waitcnt vmcnt(15)
    buffer_load_dword v7, v4, s[16:19], s87 offen offset:0 sc1
    s_waitcnt vmcnt(0)
    v_cmp_gt_u32_e64 vcc, 32, v7
    s_nop 0
    s_and_b64 vcc, vcc, s[50:51]
    s_cbranch_scc1 ps_14
pc_16:
    s_barrier
    buffer_load_dwordx4 a[0:3], v200, s[16:19], s101 offen offset:0 sc1
    buffer_load_dwordx4 a[4:7], v200, s[16:19], s101 offen offset:1024 sc1
    buffer_load_dwordx4 a[8:11], v200, s[16:19], s101 offen offset:2048 sc1
    buffer_load_dwordx4 a[12:15], v200, s[16:19], s101 offen offset:3072 sc1
    s_add_u32 s101, s101, 4096
    buffer_load_dwordx4 a[16:19], v200, s[16:19], s101 offen offset:0 sc1
    buffer_load_dwordx4 a[20:23], v200, s[16:19], s101 offen offset:1024 sc1
    buffer_load_dwordx4 a[24:27], v200, s[16:19], s101 offen offset:2048 sc1
    buffer_load_dwordx4 a[28:31], v200, s[16:19], s101 offen offset:3072 sc1
    s_add_u32 s101, s101, 4096
    buffer_load_dwordx4 a[32:35], v200, s[16:19], s101 offen offset:0 sc1
    buffer_load_dwordx4 a[36:39], v200, s[16:19], s101 offen offset:1024 sc1
    buffer_load_dwordx4 a[40:43], v200, s[16:19], s101 offen offset:2048 sc1
    buffer_load_dwordx4 a[44:47], v200, s[16:19], s101 offen offset:3072 sc1
    s_add_u32 s101, s101, 4096
    buffer_load_dwordx4 a[48:51], v200, s[16:19], s101 offen offset:0 sc1
    buffer_load_dwordx4 a[52:55], v200, s[16:19], s101 offen offset:1024 sc1
ec_3:
    v_add_u32 v196, 36352, v78
    v_mov_b32 v198, v79
    v_xor_b32 v197, 32, v196
    s_barrier
    s_add_u32 s82, s86, 16384
    v_lshlrev_b32 v2, 3, v4
    v_mov_b32_e64 v5, 1
    v_cndmask_b32 v2, v4, v2, s[50:51]
    buffer_atomic_add v5, v2, s[16:19], s82 offen offset:8 sc1
    ds_read_b128 v[160:163], v198 offset:0
    ds_read_b128 v[164:167], v196 offset:0
    ds_read_b128 v[168:171], v196 offset:8704
    ds_read_b128 v[172:175], v198 offset:32
    ds_read_b128 v[176:179], v197 offset:0
    ds_read_b128 v[180:183], v197 offset:8704
    s_waitcnt lgkmcnt(3)
    s_waitcnt vmcnt(14)
    v_mfma_f32_16x16x32_bf16 v[112:115], a[0:3], v[160:163], 0
    ds_read_b128 v[184:187], v198 offset:64
    v_mfma_f32_32x32x16_bf16 v[80:95], a[0:3], v[164:167], 0
    ds_read_b128 v[188:191], v196 offset:64
    v_mov_b32 v208, 0
    v_mov_b32 v209, 0
    v_lshrrev_b32_e64 v210, 5, v0
    v_mul_u32_u24 v210, 1600, v210
    v_mfma_f32_32x32x16_bf16 v[96:111], a[0:3], v[168:171], 0
    ds_read_b128 v[192:195], v196 offset:8768
    buffer_load_dwordx4 a[56:59], v200, s[16:19], s101 offen offset:2048 sc1
    v_and_b32 v211, 31, v0
    v_min_u32 v211, 19, v211
    s_waitcnt lgkmcnt(3)
    s_waitcnt vmcnt(14)
    v_mfma_f32_16x16x32_bf16 v[112:115], a[4:7], v[172:175], v[112:115]
    ds_read_b128 v[160:163], v198 offset:96
    v_mfma_f32_32x32x16_bf16 v[80:95], a[4:7], v[176:179], v[80:95]
    ds_read_b128 v[164:167], v197 offset:64
    v_lshl_add_u32 v210, v211, 3, v210
    v_add_u32 v210, 6400, v210
    ds_write_b64 v210, v[208:209]
    s_mul_i32 s33, s24, 4160
    v_mfma_f32_32x32x16_bf16 v[96:111], a[4:7], v[180:183], v[96:111]
    ds_read_b128 v[168:171], v197 offset:8768
    buffer_load_dwordx4 a[60:63], v200, s[16:19], s101 offen offset:3072 sc1
    s_add_u32 s33, s33, 134272
    v_and_b32_e64 v250, 31, v1
    s_waitcnt lgkmcnt(4)
    s_waitcnt vmcnt(14)
    v_mfma_f32_16x16x32_bf16 v[112:115], a[8:11], v[184:187], v[112:115]
    ds_read_b128 v[172:175], v198 offset:128
    v_mfma_f32_32x32x16_bf16 v[80:95], a[8:11], v[188:191], v[80:95]
    ds_read_b128 v[176:179], v196 offset:128
    v_lshl_add_u32 v250, v250, 4, s33
    v_lshrrev_b32_e64 v253, 5, v1
    v_lshl_add_u32 v251, v253, 3, v250
    v_lshl_add_u32 v252, v253, 9, v250
    v_mfma_f32_32x32x16_bf16 v[96:111], a[8:11], v[192:195], v[96:111]
    ds_read_b128 v[180:183], v196 offset:8832
    s_add_u32 s101, s101, 4096
    buffer_load_dwordx4 a[64:67], v200, s[16:19], s101 offen offset:0 sc1
    v_lshl_add_u32 v250, v253, 10, v250
    s_waitcnt lgkmcnt(3)
    s_waitcnt vmcnt(14)
    v_mfma_f32_16x16x32_bf16 v[112:115], a[12:15], v[160:163], v[112:115]
    ds_read_b128 v[184:187], v198 offset:160
    v_mfma_f32_32x32x16_bf16 v[80:95], a[12:15], v[164:167], v[80:95]
    ds_read_b128 v[188:191], v197 offset:128
    v_cmp_eq_u32 vcc, 0, v1
    v_lshlrev_b32 v254, 16, v241
    v_min_u32 v253, 15, v1
    v_cndmask_b32 v254, 0, v254, vcc
    v_mfma_f32_32x32x16_bf16 v[96:111], a[12:15], v[168:171], v[96:111]
    ds_read_b128 v[192:195], v197 offset:8832
    buffer_load_dwordx4 a[68:71], v200, s[16:19], s101 offen offset:1024 sc1
    v_lshl_add_u32 v253, v253, 2, s33
    v_add_f32_e64 v216, v216, v254
    s_waitcnt lgkmcnt(3)
    s_waitcnt vmcnt(14)
    v_mfma_f32_16x16x32_bf16 v[112:115], a[16:19], v[172:175], v[112:115]
    ds_read_b128 v[160:163], v198 offset:192
    v_mfma_f32_32x32x16_bf16 v[80:95], a[16:19], v[176:179], v[80:95]
    ds_read_b128 v[164:167], v196 offset:192
    v_and_b32 v254, 1, v1
    v_cmp_eq_u32 vcc, 1, v254
    v_mov_b32_e64 v254, 0
    v_cvt_pk_bf16_f32 v242, v216, v217
    v_mfma_f32_32x32x16_bf16 v[96:111], a[16:19], v[180:183], v[96:111]
    ds_read_b128 v[168:171], v196 offset:8896
    buffer_load_dwordx4 a[72:75], v200, s[16:19], s101 offen offset:2048 sc1
    v_cvt_pk_bf16_f32 v243, v218, v219
    v_cvt_pk_bf16_f32 v244, v220, v220
    s_waitcnt lgkmcnt(3)
    s_waitcnt vmcnt(14)
    v_mfma_f32_16x16x32_bf16 v[112:115], a[20:23], v[184:187], v[112:115]
    ds_read_b128 v[172:175], v198 offset:224
    v_mfma_f32_32x32x16_bf16 v[80:95], a[20:23], v[188:191], v[80:95]
    ds_read_b128 v[176:179], v197 offset:192
    v_cvt_pk_bf16_f32 v245, v221, v222
    v_cvt_pk_bf16_f32 v246, v224, v224
    v_cvt_pk_bf16_f32 v247, v224, v225
    v_cvt_pk_bf16_f32 v248, v225, v225
    v_mfma_f32_32x32x16_bf16 v[96:111], a[20:23], v[192:195], v[96:111]
    ds_read_b128 v[180:183], v197 offset:8896
    buffer_load_dwordx4 a[76:79], v200, s[16:19], s101 offen offset:3072 sc1
    v_cvt_pk_bf16_f32 v249, v226, v226
    ds_write_b32 v253, v254
    s_barrier
    s_waitcnt lgkmcnt(4)
    s_waitcnt vmcnt(14)
    v_mfma_f32_16x16x32_bf16 v[112:115], a[24:27], v[160:163], v[112:115]
    v_add_u32 v198, v49, v198
    v_mfma_f32_32x32x16_bf16 v[80:95], a[24:27], v[164:167], v[80:95]
    v_add_u32 v196, 19584, v196
    v_add_u32 v197, 19584, v197
    ds_read_b128 v[184:187], v198 offset:0
    ds_write_b64 v251, v[242:243] offset:64
    ds_write_b64 v251, v[244:245] offset:576
    v_mfma_f32_32x32x16_bf16 v[96:111], a[24:27], v[168:171], v[96:111]
    ds_read_b128 v[188:191], v196 offset:0
    ds_read_b128 v[192:195], v196 offset:8704
    s_add_u32 s101, s101, 4096
    buffer_load_dwordx4 a[80:83], v200, s[16:19], s101 offen offset:0 sc1
    s_waitcnt lgkmcnt(6)
    s_waitcnt vmcnt(14)
    v_mfma_f32_16x16x32_bf16 v[112:115], a[28:31], v[172:175], v[112:115]
    ds_read_b128 v[160:163], v198 offset:32
    v_mfma_f32_32x32x16_bf16 v[80:95], a[28:31], v[176:179], v[80:95]
    ds_read_b128 v[164:167], v197 offset:0
    ds_write_b128 v252, v[246:249] offset:1088
    v_cndmask_b32 v255, v228, v229, vcc
    v_cvt_pk_bf16_f32 v216, v228, v228
    v_mov_b32 v217, v216
    v_mfma_f32_32x32x16_bf16 v[96:111], a[28:31], v[180:183], v[96:111]
    ds_read_b128 v[168:171], v197 offset:8704
    buffer_load_dwordx4 a[84:87], v200, s[16:19], s101 offen offset:1024 sc1
    v_cvt_pk_bf16_f32 v218, v255, v229
    v_cvt_pk_bf16_f32 v219, v229, v229
    s_waitcnt lgkmcnt(4)
    s_waitcnt vmcnt(14)
    v_mfma_f32_16x16x32_bf16 v[112:115], a[32:35], v[184:187], v[112:115]
    ds_read_b128 v[172:175], v198 offset:64
    v_mfma_f32_32x32x16_bf16 v[80:95], a[32:35], v[188:191], v[80:95]
    ds_read_b128 v[176:179], v196 offset:64
    ds_write_b128 v250, v[216:219] offset:2112
    v_cndmask_b32 v255, v230, v231, vcc
    v_cvt_pk_bf16_f32 v220, v230, v230
    v_mov_b32 v221, v220
    v_mfma_f32_32x32x16_bf16 v[96:111], a[32:35], v[192:195], v[96:111]
    ds_read_b128 v[180:183], v196 offset:8768
    buffer_load_dwordx4 a[88:91], v200, s[16:19], s101 offen offset:2048 sc1
    v_cvt_pk_bf16_f32 v222, v255, v231
    v_cvt_pk_bf16_f32 v223, v231, v231
    s_waitcnt lgkmcnt(4)
    s_waitcnt vmcnt(14)
    v_mfma_f32_16x16x32_bf16 v[112:115], a[36:39], v[160:163], v[112:115]
    ds_read_b128 v[184:187], v198 offset:96
    v_mfma_f32_32x32x16_bf16 v[80:95], a[36:39], v[164:167], v[80:95]
    ds_read_b128 v[188:191], v197 offset:64
    ds_write_b128 v250, v[220:223] offset:2624
    v_mfma_f32_32x32x16_bf16 v[96:111], a[36:39], v[168:171], v[96:111]
    ds_read_b128 v[192:195], v197 offset:8768
    buffer_load_dwordx4 a[92:95], v200, s[16:19], s101 offen offset:3072 sc1
    s_waitcnt lgkmcnt(4)
    s_waitcnt vmcnt(14)
    v_mfma_f32_16x16x32_bf16 v[112:115], a[40:43], v[172:175], v[112:115]
    ds_read_b128 v[160:163], v198 offset:128
    v_mfma_f32_32x32x16_bf16 v[80:95], a[40:43], v[176:179], v[80:95]
    ds_read_b128 v[164:167], v196 offset:128
    v_mfma_f32_32x32x16_bf16 v[96:111], a[40:43], v[180:183], v[96:111]
    ds_read_b128 v[168:171], v196 offset:8832
    s_add_u32 s101, s101, 4096
    buffer_load_dwordx4 a[96:99], v200, s[16:19], s101 offen offset:0 sc1
    s_waitcnt lgkmcnt(3)
    s_waitcnt vmcnt(14)
    v_mfma_f32_16x16x32_bf16 v[112:115], a[44:47], v[184:187], v[112:115]
    ds_read_b128 v[172:175], v198 offset:160
    v_mfma_f32_32x32x16_bf16 v[80:95], a[44:47], v[188:191], v[80:95]
    ds_read_b128 v[176:179], v197 offset:128
    v_mfma_f32_32x32x16_bf16 v[96:111], a[44:47], v[192:195], v[96:111]
    ds_read_b128 v[180:183], v197 offset:8832
    buffer_load_dwordx4 a[100:103], v200, s[16:19], s101 offen offset:1024 sc1
    s_waitcnt lgkmcnt(3)
    s_waitcnt vmcnt(14)
    v_mfma_f32_16x16x32_bf16 v[112:115], a[48:51], v[160:163], v[112:115]
    ds_read_b128 v[184:187], v198 offset:192
    v_mfma_f32_32x32x16_bf16 v[80:95], a[48:51], v[164:167], v[80:95]
    ds_read_b128 v[188:191], v196 offset:192
    v_mfma_f32_32x32x16_bf16 v[96:111], a[48:51], v[168:171], v[96:111]
    ds_read_b128 v[192:195], v196 offset:8896
    buffer_load_dwordx4 a[104:107], v200, s[16:19], s101 offen offset:2048 sc1
    s_waitcnt lgkmcnt(3)
    s_waitcnt vmcnt(14)
    v_mfma_f32_16x16x32_bf16 v[112:115], a[52:55], v[172:175], v[112:115]
    ds_read_b128 v[160:163], v198 offset:224
    v_mfma_f32_32x32x16_bf16 v[80:95], a[52:55], v[176:179], v[80:95]
    ds_read_b128 v[164:167], v197 offset:192
    v_mfma_f32_32x32x16_bf16 v[96:111], a[52:55], v[180:183], v[96:111]
    ds_read_b128 v[168:171], v197 offset:8896
    buffer_load_dwordx4 a[108:111], v200, s[16:19], s101 offen offset:3072 sc1
    s_barrier
    s_waitcnt lgkmcnt(3)
    s_waitcnt vmcnt(13)
    v_mfma_f32_16x16x32_bf16 v[112:115], a[56:59], v[184:187], v[112:115]
    v_add_u32 v198, v49, v198
    v_mfma_f32_32x32x16_bf16 v[80:95], a[56:59], v[188:191], v[80:95]
    v_add_u32 v196, 19584, v196
    v_add_u32 v197, 19584, v197
    ds_read_b128 v[172:175], v198 offset:0
    v_mfma_f32_32x32x16_bf16 v[96:111], a[56:59], v[192:195], v[96:111]
    ds_read_b128 v[176:179], v196 offset:0
    ds_read_b128 v[180:183], v196 offset:8704
    s_add_u32 s101, s101, 4096
    buffer_load_dwordx4 a[112:115], v200, s[16:19], s101 offen offset:0 sc1
    s_waitcnt lgkmcnt(3)
    s_waitcnt vmcnt(13)
    v_mfma_f32_16x16x32_bf16 v[112:115], a[60:63], v[160:163], v[112:115]
    ds_read_b128 v[184:187], v198 offset:32
    v_mfma_f32_32x32x16_bf16 v[80:95], a[60:63], v[164:167], v[80:95]
    ds_read_b128 v[188:191], v197 offset:0
    v_mfma_f32_32x32x16_bf16 v[96:111], a[60:63], v[168:171], v[96:111]
    ds_read_b128 v[192:195], v197 offset:8704
    buffer_load_dwordx4 a[116:119], v200, s[16:19], s101 offen offset:1024 sc1
    s_waitcnt lgkmcnt(3)
    s_waitcnt vmcnt(13)
    v_mfma_f32_16x16x32_bf16 v[112:115], a[64:67], v[172:175], v[112:115]
    ds_read_b128 v[160:163], v198 offset:64
    v_mfma_f32_32x32x16_bf16 v[80:95], a[64:67], v[176:179], v[80:95]
    ds_read_b128 v[164:167], v196 offset:64
    v_mfma_f32_32x32x16_bf16 v[96:111], a[64:67], v[180:183], v[96:111]
    ds_read_b128 v[168:171], v196 offset:8768
    buffer_load_dwordx4 a[120:123], v200, s[16:19], s101 offen offset:2048 sc1
    s_waitcnt lgkmcnt(3)
    s_waitcnt vmcnt(13)
    v_mfma_f32_16x16x32_bf16 v[112:115], a[68:71], v[184:187], v[112:115]
    ds_read_b128 v[172:175], v198 offset:96
    v_mfma_f32_32x32x16_bf16 v[80:95], a[68:71], v[188:191], v[80:95]
    ds_read_b128 v[176:179], v197 offset:64
    v_mfma_f32_32x32x16_bf16 v[96:111], a[68:71], v[192:195], v[96:111]
    ds_read_b128 v[180:183], v197 offset:8768
    buffer_load_dwordx4 a[124:127], v200, s[16:19], s101 offen offset:3072 sc1
    s_waitcnt lgkmcnt(3)
    s_waitcnt vmcnt(13)
    v_mfma_f32_16x16x32_bf16 v[112:115], a[72:75], v[160:163], v[112:115]
    ds_read_b128 v[184:187], v198 offset:128
    v_mfma_f32_32x32x16_bf16 v[80:95], a[72:75], v[164:167], v[80:95]
    ds_read_b128 v[188:191], v196 offset:128
    v_mfma_f32_32x32x16_bf16 v[96:111], a[72:75], v[168:171], v[96:111]
    ds_read_b128 v[192:195], v196 offset:8832
    s_add_u32 s101, s101, 4096
    buffer_load_dwordx4 a[128:131], v200, s[16:19], s101 offen offset:0 sc1
    s_waitcnt lgkmcnt(3)
    s_waitcnt vmcnt(13)
    v_mfma_f32_16x16x32_bf16 v[112:115], a[76:79], v[172:175], v[112:115]
    ds_read_b128 v[160:163], v198 offset:160
    v_mfma_f32_32x32x16_bf16 v[80:95], a[76:79], v[176:179], v[80:95]
    ds_read_b128 v[164:167], v197 offset:128
    v_mfma_f32_32x32x16_bf16 v[96:111], a[76:79], v[180:183], v[96:111]
    ds_read_b128 v[168:171], v197 offset:8832
    buffer_load_dwordx4 a[132:135], v200, s[16:19], s101 offen offset:1024 sc1
    s_waitcnt lgkmcnt(3)
    s_waitcnt vmcnt(13)
    v_mfma_f32_16x16x32_bf16 v[112:115], a[80:83], v[184:187], v[112:115]
    ds_read_b128 v[172:175], v198 offset:192
    v_mfma_f32_32x32x16_bf16 v[80:95], a[80:83], v[188:191], v[80:95]
    ds_read_b128 v[176:179], v196 offset:192
    v_mfma_f32_32x32x16_bf16 v[96:111], a[80:83], v[192:195], v[96:111]
    ds_read_b128 v[180:183], v196 offset:8896
    buffer_load_dwordx4 a[136:139], v200, s[16:19], s101 offen offset:2048 sc1
    s_waitcnt lgkmcnt(3)
    s_waitcnt vmcnt(13)
    v_mfma_f32_16x16x32_bf16 v[112:115], a[84:87], v[160:163], v[112:115]
    ds_read_b128 v[184:187], v198 offset:224
    v_mfma_f32_32x32x16_bf16 v[80:95], a[84:87], v[164:167], v[80:95]
    ds_read_b128 v[188:191], v197 offset:192
    v_mfma_f32_32x32x16_bf16 v[96:111], a[84:87], v[168:171], v[96:111]
    ds_read_b128 v[192:195], v197 offset:8896
    buffer_load_dwordx4 a[140:143], v200, s[16:19], s101 offen offset:3072 sc1
    s_barrier
    s_waitcnt lgkmcnt(3)
    s_waitcnt vmcnt(13)
    v_mfma_f32_16x16x32_bf16 v[112:115], a[88:91], v[172:175], v[112:115]
    v_add_u32 v198, v49, v198
    v_mfma_f32_32x32x16_bf16 v[80:95], a[88:91], v[176:179], v[80:95]
    v_add_u32 v196, 19584, v196
    v_add_u32 v197, 19584, v197
    ds_read_b128 v[160:163], v198 offset:0
    v_mfma_f32_32x32x16_bf16 v[96:111], a[88:91], v[180:183], v[96:111]
    ds_read_b128 v[164:167], v196 offset:0
    ds_read_b128 v[168:171], v196 offset:8704
    s_add_u32 s101, s101, 4096
    buffer_load_dword v7, v4, s[16:19], s89 offen offset:8 sc1
    s_waitcnt lgkmcnt(3)
    s_waitcnt vmcnt(13)
    v_mfma_f32_16x16x32_bf16 v[112:115], a[92:95], v[184:187], v[112:115]
    ds_read_b128 v[172:175], v198 offset:32
    v_mfma_f32_32x32x16_bf16 v[80:95], a[92:95], v[188:191], v[80:95]
    ds_read_b128 v[176:179], v197 offset:0
    v_mfma_f32_32x32x16_bf16 v[96:111], a[92:95], v[192:195], v[96:111]
    ds_read_b128 v[180:183], v197 offset:8704
    buffer_load_dwordx4 a[144:147], v200, s[16:19], s101 offen offset:0 sc1
    s_waitcnt lgkmcnt(3)
    s_waitcnt vmcnt(13)
    v_mfma_f32_16x16x32_bf16 v[112:115], a[96:99], v[160:163], v[112:115]
    ds_read_b128 v[184:187], v198 offset:64
    v_mfma_f32_32x32x16_bf16 v[80:95], a[96:99], v[164:167], v[80:95]
    ds_read_b128 v[188:191], v196 offset:64
    v_mfma_f32_32x32x16_bf16 v[96:111], a[96:99], v[168:171], v[96:111]
    ds_read_b128 v[192:195], v196 offset:8768
    buffer_load_dwordx4 a[148:151], v200, s[16:19], s101 offen offset:1024 sc1
    s_waitcnt lgkmcnt(3)
    s_waitcnt vmcnt(13)
    v_mfma_f32_16x16x32_bf16 v[112:115], a[100:103], v[172:175], v[112:115]
    ds_read_b128 v[160:163], v198 offset:96
    v_mfma_f32_32x32x16_bf16 v[80:95], a[100:103], v[176:179], v[80:95]
    ds_read_b128 v[164:167], v197 offset:64
    v_mfma_f32_32x32x16_bf16 v[96:111], a[100:103], v[180:183], v[96:111]
    ds_read_b128 v[168:171], v197 offset:8768
    buffer_load_dwordx4 a[152:155], v200, s[16:19], s101 offen offset:2048 sc1
    s_waitcnt lgkmcnt(3)
    s_waitcnt vmcnt(13)
    v_mfma_f32_16x16x32_bf16 v[112:115], a[104:107], v[184:187], v[112:115]
    ds_read_b128 v[172:175], v198 offset:128
    v_mfma_f32_32x32x16_bf16 v[80:95], a[104:107], v[188:191], v[80:95]
    ds_read_b128 v[176:179], v196 offset:128
    v_mfma_f32_32x32x16_bf16 v[96:111], a[104:107], v[192:195], v[96:111]
    ds_read_b128 v[180:183], v196 offset:8832
    buffer_load_dwordx4 a[156:159], v200, s[16:19], s101 offen offset:3072 sc1
    s_waitcnt lgkmcnt(3)
    s_waitcnt vmcnt(13)
    v_mfma_f32_16x16x32_bf16 v[112:115], a[108:111], v[160:163], v[112:115]
    ds_read_b128 v[184:187], v198 offset:160
    v_mfma_f32_32x32x16_bf16 v[80:95], a[108:111], v[164:167], v[80:95]
    ds_read_b128 v[188:191], v197 offset:128
    v_mfma_f32_32x32x16_bf16 v[96:111], a[108:111], v[168:171], v[96:111]
    ds_read_b128 v[192:195], v197 offset:8832
    s_add_u32 s101, s101, 4096
    s_lshl_b32 s25, s72, 5
    s_add_u32 s25, s25, 256
    s_sub_u32 s26, s25, 4
    s_max_i32 s26, s26, 0
    s_mul_i32 s27, s71, 1280
    s_mul_i32 s99, s25, 5120
    s_mul_i32 s100, s26, 5120
    s_mul_i32 s92, s24, 4352
    s_mul_i32 s93, s24, 544
    s_add_u32 s99, s99, s27
    s_add_u32 s100, s100, s27
    s_waitcnt lgkmcnt(3)
    s_waitcnt vmcnt(12)
    v_mfma_f32_16x16x32_bf16 v[112:115], a[112:115], v[172:175], v[112:115]
    ds_read_b128 v[160:163], v198 offset:192
    v_mfma_f32_32x32x16_bf16 v[80:95], a[112:115], v[176:179], v[80:95]
    ds_read_b128 v[164:167], v196 offset:192
    v_mfma_f32_32x32x16_bf16 v[96:111], a[112:115], v[180:183], v[96:111]
    ds_read_b128 v[168:171], v196 offset:8896
    s_waitcnt lgkmcnt(3)
    s_waitcnt vmcnt(11)
    v_mfma_f32_16x16x32_bf16 v[112:115], a[116:119], v[184:187], v[112:115]
    ds_read_b128 v[172:175], v198 offset:224
    v_mfma_f32_32x32x16_bf16 v[80:95], a[116:119], v[188:191], v[80:95]
    ds_read_b128 v[176:179], v197 offset:192
    v_mfma_f32_32x32x16_bf16 v[96:111], a[116:119], v[192:195], v[96:111]
    ds_read_b128 v[180:183], v197 offset:8896
    s_waitcnt vmcnt(4)
    v_cmp_gt_u32 vcc, 32, v7
    s_nop 0
    s_and_b64 vcc, vcc, s[50:51]
    s_cbranch_scc1 ps_17
pc_19:
    s_barrier
    s_waitcnt lgkmcnt(3)
    v_mfma_f32_16x16x32_bf16 v[112:115], a[120:123], v[160:163], v[112:115]
    v_add_u32_e64 v198, v49, v198
    v_mfma_f32_32x32x16_bf16 v[80:95], a[120:123], v[164:167], v[80:95]
    v_add_u32 v196, 19584, v196
    v_add_u32 v197, 19584, v197
    s_lshl_b32 s31, s24, 7
    s_add_u32 s31, s31, 159744
    v_bfe_u32 v132, v1, 3, 1
    v_mfma_f32_32x32x16_bf16 v[96:111], a[120:123], v[168:171], v[96:111]
    ds_read_b128 v[184:187], v198 offset:0
    ds_read_b128 v[188:191], v196 offset:0
    s_lshl_b32 s98, s72, 5
    s_add_u32 s98, s98, 0
    s_sub_u32 s95, s98, 4
    s_max_i32 s95, s95, 0
    s_lshl_b32 s94, s98, 3
    s_lshl_b32 s95, s95, 3
    s_add_u32 s94, s94, 3440640
    s_add_u32 s95, s95, 3440640
    s_add_u32 s96, s94, 8192
    buffer_load_dwordx2 v[152:153], v47, s[16:19], s94 offen sc1
    v_lshrrev_b32 v133, 4, v1
    v_lshl_add_u32 v132, v132, 2, v133
    s_waitcnt lgkmcnt(2)
    v_mfma_f32_16x16x32_bf16 v[112:115], a[124:127], v[172:175], v[112:115]
    ds_read_b128 v[192:195], v198 offset:32
    v_mfma_f32_32x32x16_bf16 v[80:95], a[124:127], v[176:179], v[80:95]
    ds_read_b128 v[160:163], v197 offset:0
    v_lshl_add_u32 v132, v132, 4, s31
    v_lshrrev_b32 v133, 5, v1
    v_lshl_add_u32 v133, v133, 4, s31
    v_mfma_f32_32x32x16_bf16 v[96:111], a[124:127], v[180:183], v[96:111]
    buffer_load_dwordx2 v[154:155], v47, s[16:19], s96 offen sc1
    s_waitcnt lgkmcnt(2)
    v_mfma_f32_16x16x32_bf16 v[112:115], a[128:131], v[184:187], v[112:115]
    ds_read_b128 v[164:167], v198 offset:64
    v_mfma_f32_32x32x16_bf16 v[80:95], a[128:131], v[188:191], v[80:95]
    ds_read_b128 v[168:171], v196 offset:64
    s_waitcnt lgkmcnt(2)
    v_mfma_f32_16x16x32_bf16 v[112:115], a[132:135], v[192:195], v[112:115]
    ds_read_b128 v[172:175], v198 offset:96
    v_mfma_f32_32x32x16_bf16 v[80:95], a[132:135], v[160:163], v[80:95]
    ds_read_b128 v[176:179], v197 offset:64
    buffer_load_dwordx2 v[156:157], v48, s[16:19], s95 offen sc1
    s_waitcnt lgkmcnt(2)
    v_mfma_f32_16x16x32_bf16 v[112:115], a[136:139], v[164:167], v[112:115]
    ds_read_b128 v[180:183], v198 offset:128
    v_mfma_f32_32x32x16_bf16 v[80:95], a[136:139], v[168:171], v[80:95]
    ds_read_b128 v[184:187], v196 offset:128
    s_waitcnt lgkmcnt(2)
    v_mfma_f32_16x16x32_bf16 v[112:115], a[140:143], v[172:175], v[112:115]
    ds_read_b128 v[188:191], v198 offset:160
    v_mfma_f32_32x32x16_bf16 v[80:95], a[140:143], v[176:179], v[80:95]
    ds_read_b128 v[192:195], v197 offset:128
    s_add_u32 m0, s92, 36352
    s_nop 0
    buffer_load_dwordx4 v73, s[4:7], s99 offen offset:0  lds
    s_waitcnt lgkmcnt(2)
    s_waitcnt vmcnt(7)
    v_mfma_f32_16x16x32_bf16 v[112:115], a[144:147], v[180:183], v[112:115]
    ds_read_b128 v[160:163], v198 offset:192
    v_mfma_f32_32x32x16_bf16 v[80:95], a[144:147], v[184:187], v[80:95]
    ds_read_b128 v[164:167], v196 offset:192
    s_waitcnt lgkmcnt(2)
    s_waitcnt vmcnt(6)
    v_mfma_f32_16x16x32_bf16 v[112:115], a[148:151], v[188:191], v[112:115]
    ds_read_b128 v[168:171], v198 offset:224
    v_mfma_f32_32x32x16_bf16 v[80:95], a[148:151], v[192:195], v[80:95]
    ds_read_b128 v[172:175], v197 offset:192
    buffer_load_dwordx4 v74, s[4:7], s99 offen offset:1088  lds
    s_waitcnt lgkmcnt(2)
    s_waitcnt vmcnt(6)
    v_mfma_f32_16x16x32_bf16 v[112:115], a[152:155], v[160:163], v[112:115]
    ds_read_b128 v[176:179], v196 offset:8704
    v_mfma_f32_32x32x16_bf16 v[80:95], a[152:155], v[164:167], v[80:95]
    ds_read_b128 v[180:183], v197 offset:8704
    s_waitcnt lgkmcnt(2)
    s_waitcnt vmcnt(5)
    v_mfma_f32_16x16x32_bf16 v[112:115], a[156:159], v[168:171], v[112:115]
    ds_read_b128 v[184:187], v196 offset:8768
    v_mfma_f32_32x32x16_bf16 v[80:95], a[156:159], v[172:175], v[80:95]
    ds_read_b128 v[188:191], v197 offset:8768
    buffer_load_dwordx4 v75, s[4:7], s99 offen offset:2176  lds
    s_waitcnt lgkmcnt(2)
    v_mfma_f32_32x32x16_bf16 v[96:111], a[128:131], v[176:179], v[96:111]
    ds_read_b128 v[192:195], v196 offset:8832
    v_mfma_f32_32x32x16_bf16 v[96:111], a[132:135], v[180:183], v[96:111]
    ds_read_b128 v[160:163], v197 offset:8832
    buffer_load_dwordx4 v76, s[4:7], s99 offen offset:3264  lds
    s_mov_b32 exec_lo, 0x01010101
    s_mov_b32 exec_hi, 0x01010101
    ds_write_b128 v132, v[112:115]
    s_mov_b64 exec, -1
    s_waitcnt lgkmcnt(3)
    v_mfma_f32_32x32x16_bf16 v[96:111], a[136:139], v[184:187], v[96:111]
    ds_read_b128 v[164:167], v196 offset:8896
    ds_read_b128 v[24:27], v132
    ds_read_b128 v[8:11], v133 offset:0
    ds_read_b128 v[12:15], v133 offset:32
    ds_read_b128 v[16:19], v133 offset:64
    v_mfma_f32_32x32x16_bf16 v[96:111], a[140:143], v[188:191], v[96:111]
    ds_read_b128 v[168:171], v197 offset:8896
    s_add_u32 m0, s93, 53760
    s_add_u32 s99, s99, 256
    s_mov_b64 exec, s[80:81]
    buffer_load_dwordx4 v77, s[4:7], s100 offen  lds
    s_mov_b64 exec, -1
    s_add_u32 s100, s100, 256
    ds_read_b128 v[20:23], v133 offset:96
    s_waitcnt vmcnt(5) lgkmcnt(5)
    v_mul_f32 v148, v24, v157
    v_mfma_f32_32x32x16_bf16 v[96:111], a[144:147], v[192:195], v[96:111]
    v_mul_f32 v149, v25, v157
    v_mul_f32 v150, v26, v157
    v_mul_f32 v151, v27, v157
    s_waitcnt lgkmcnt(4)
    v_mul_f32 v116, v8, v153
    v_mul_f32 v117, v9, v153
    v_mfma_f32_32x32x16_bf16 v[96:111], a[148:151], v[160:163], v[96:111]
    v_mul_f32 v118, v10, v153
    v_mul_f32 v119, v11, v153
    s_waitcnt lgkmcnt(3)
    v_mul_f32 v120, v12, v153
    v_mul_f32 v121, v13, v153
    s_waitcnt lgkmcnt(1)
    v_mfma_f32_32x32x16_bf16 v[96:111], a[152:155], v[164:167], v[96:111]
    v_mul_f32 v122, v14, v153
    v_mul_f32 v123, v15, v153
    v_mul_f32 v124, v16, v153
    v_mul_f32 v125, v17, v153
    v_mul_f32_e64 v126, v18, v153
    v_mfma_f32_32x32x16_bf16 v[96:111], a[156:159], v[168:171], v[96:111]
    s_add_u32 m0, s92, 55936
    s_nop 0
    buffer_load_dwordx4 v73, s[4:7], s99 offen offset:0  lds
    v_mul_f32 v127, v19, v153
    s_waitcnt lgkmcnt(0)
    v_mul_f32 v128, v20, v153
    v_mul_f32 v129, v21, v153
    v_mul_f32 v130, v22, v153
    v_mul_f32_e64 v131, v23, v153
    v_fma_f32 v112, v112, v156, v148
    v_fma_f32 v113, v113, v156, v149
    v_fma_f32 v114, v114, v156, v150
    v_fma_f32 v115, v115, v156, v151
    v_cvt_pk_bf16_f32 v112, v112, v113
    v_cvt_pk_bf16_f32 v113, v114, v115
    v_fma_f32 v80, v80, v152, v116
    v_fma_f32 v81, v81, v152, v117
    v_fma_f32 v82, v82, v152, v118
    v_fma_f32 v83, v83, v152, v119
    v_cvt_pk_bf16_f32 v80, v80, v81
    v_cvt_pk_bf16_f32 v81, v82, v83
    ds_write_b64 v40, v[112:113] offset:0
    ds_write_b64 v38, v[80:81] offset:0
    v_fma_f32 v84, v84, v152, v120
    v_fma_f32 v85, v85, v152, v121
    v_fma_f32 v86, v86, v152, v122
    v_fma_f32 v87, v87, v152, v123
    v_cvt_pk_bf16_f32 v84, v84, v85
    v_cvt_pk_bf16_f32 v85, v86, v87
    v_fma_f32 v88, v88, v152, v124
    v_fma_f32 v89, v89, v152, v125
    v_fma_f32 v90, v90, v152, v126
    v_fma_f32 v91, v91, v152, v127
    v_cvt_pk_bf16_f32 v88, v88, v89
    v_cvt_pk_bf16_f32 v89, v90, v91
    ds_write_b64 v38, v[84:85] offset:6400
    ds_write_b64 v38, v[88:89] offset:12800
    v_fma_f32 v92, v92, v152, v128
    v_fma_f32 v93, v93, v152, v129
    v_fma_f32 v94, v94, v152, v130
    v_fma_f32 v95, v95, v152, v131
    v_cvt_pk_bf16_f32 v92, v92, v93
    v_cvt_pk_bf16_f32 v93, v94, v95
    ds_write_b64 v39, v[92:93] offset:0
    v_mul_f32 v132, v8, v155
    v_mul_f32 v133, v9, v155
    v_mul_f32 v134, v10, v155
    v_mul_f32 v135, v11, v155
    v_mul_f32 v136, v12, v155
    v_mul_f32 v137, v13, v155
    v_mul_f32 v138, v14, v155
    v_mul_f32 v139, v15, v155
    v_mul_f32 v140, v16, v155
    v_mul_f32 v141, v17, v155
    v_mul_f32 v142, v18, v155
    v_mul_f32 v143, v19, v155
    v_mul_f32 v144, v20, v155
    v_mul_f32 v145, v21, v155
    v_mul_f32 v146, v22, v155
    v_mul_f32 v147, v23, v155
    v_pk_fma_f32 v[96:97], v[96:97], v[154:155], v[132:133] op_sel_hi:[1,0,1]
    v_pk_fma_f32 v[98:99], v[98:99], v[154:155], v[134:135] op_sel_hi:[1,0,1]
    v_cvt_pk_bf16_f32 v96, v96, v97
    v_cvt_pk_bf16_f32 v97, v98, v99
    v_pk_fma_f32 v[100:101], v[100:101], v[154:155], v[136:137] op_sel_hi:[1,0,1]
    v_pk_fma_f32 v[102:103], v[102:103], v[154:155], v[138:139] op_sel_hi:[1,0,1]
    v_cvt_pk_bf16_f32 v100, v100, v101
    v_cvt_pk_bf16_f32 v101, v102, v103
    ds_write_b64 v38, v[96:97] offset:1600
    ds_write_b64 v38, v[100:101] offset:8000
    v_pk_fma_f32 v[104:105], v[104:105], v[154:155], v[140:141] op_sel_hi:[1,0,1]
    v_pk_fma_f32 v[106:107], v[106:107], v[154:155], v[142:143] op_sel_hi:[1,0,1]
    v_cvt_pk_bf16_f32 v104, v104, v105
    v_cvt_pk_bf16_f32 v105, v106, v107
    v_pk_fma_f32 v[108:109], v[108:109], v[154:155], v[144:145] op_sel_hi:[1,0,1]
    v_pk_fma_f32 v[110:111], v[110:111], v[154:155], v[146:147] op_sel_hi:[1,0,1]
    v_cvt_pk_bf16_f32 v108, v108, v109
    v_cvt_pk_bf16_f32 v109, v110, v111
    ds_write_b64 v38, v[104:105] offset:14400
    ds_write_b64 v39, v[108:109] offset:1600
    s_waitcnt lgkmcnt(0)
    s_barrier
    v_mov_b32 v94, 0
    v_mov_b32 v95, 0
    v_mov_b32 v98, 0
    v_mov_b32 v99, 0
    s_mov_b64 exec, 0xffff
    ds_read_b64 v[94:95], v42 offset:320
    ds_read_b64 v[98:99], v42 offset:640
    s_mov_b64 exec, -1
    s_nop 0
    ds_read_b64 v[92:93], v41 offset:320
    ds_read_b64 v[96:97], v41 offset:640
    ds_read_b64 v[84:85], v41 offset:6720
    ds_read_b64 v[86:87], v42 offset:6720
    ds_read_b64 v[80:81], v41 offset:6400
    ds_read_b64 v[82:83], v42 offset:6400
    ds_read_b64 v[88:89], v41 offset:7040
    ds_read_b64 v[90:91], v42 offset:7040
    ds_read_b64_tr_b16 v[106:107], v44 offset:0
    ds_read_b64_tr_b16 v[100:101], v43 offset:0
    ds_read_b64_tr_b16 v[108:109], v44 offset:320
    ds_read_b64_tr_b16 v[102:103], v43 offset:320
    buffer_load_dwordx4 v74, s[4:7], s99 offen offset:1088  lds
    ds_read_b64_tr_b16 v[110:111], v44 offset:640
    ds_read_b64_tr_b16 v[104:105], v43 offset:640
    v_mov_b32 v156, 0xf149f2ca
    v_cndmask_b32 v152, v32, v156, s[90:91]
    v_cndmask_b32 v153, v33, v156, s[90:91]
    v_cndmask_b32 v154, v34, v156, s[90:91]
    v_cndmask_b32 v155, v35, v156, s[90:91]
    s_mov_b32 s82, 0x3ea52b5c
    buffer_load_dwordx4 v75, s[4:7], s99 offen offset:2176  lds
    s_lshl_b32 s25, s98, 4
    s_add_u32 s25, s25, 4194304
    s_lshl_b32 s26, s98, 3
    s_add_u32 s26, s26, 4194304
    s_waitcnt lgkmcnt(10)
    v_mfma_f32_16x16x32_bf16 v[116:119], v[84:87], v[92:95], v[28:31]
    v_mfma_f32_16x16x32_bf16 v[120:123], v[84:87], v[96:99], v[32:35]
    s_waitcnt lgkmcnt(8)
    v_mfma_f32_16x16x32_bf16 v[112:115], v[80:83], v[92:95], v[152:155]
    s_waitcnt lgkmcnt(6)
    v_mfma_f32_16x16x32_bf16 v[124:127], v[88:91], v[96:99], v[28:31]
    buffer_load_dwordx4 v76, s[4:7], s99 offen offset:3264  lds
    s_nop 4
    v_max_f32 v112, v112, v116
    v_max_f32 v113, v113, v117
    v_max_f32 v114, v114, v118
    v_max_f32 v115, v115, v119
    v_max3_f32 v156, v112, v113, v114
    v_max_f32 v156, v156, v115
    v_max_f32 v120, v120, v124
    v_max_f32_e64 v121, v121, v125
    s_add_u32 m0, s93, 73344
    s_add_u32 s99, s99, 256
    s_mov_b64 exec, s[80:81]
    buffer_load_dwordx4 v77, s[4:7], s100 offen  lds
    s_mov_b64 exec, -1
    s_add_u32 s100, s100, 256
    v_max_f32 v122, v122, v126
    v_max_f32 v123, v123, v127
    v_max3_f32 v157, v120, v121, v122
    v_max_f32 v157, v157, v123
    s_nop 1
    v_permlane16_swap_b32 v156, v157
    v_max_f32 v156, v156, v157
    v_mov_b32 v157, v156
    s_nop 1
    v_permlane32_swap_b32 v156, v157
    s_add_u32 m0, s92, 75520
    s_nop 0
    buffer_load_dwordx4 v73, s[4:7], s99 offen offset:0  lds
    v_max_f32 v156, v156, v157
    v_mul_f32 v156, s82, v156
    v_mov_b32 v157, v156
    s_nop 1
    v_permlane16_swap_b32_e64 v156, v157
    v_fma_f32 v112, v112, s82, -v156
    v_fma_f32 v113, v113, s82, -v156
    v_fma_f32 v114, v114, s82, -v156
    v_fma_f32 v115, v115, s82, -v156
    buffer_load_dwordx4 v74, s[4:7], s99 offen offset:1088  lds
    v_exp_f32 v112, v112
    v_exp_f32 v113, v113
    v_exp_f32 v114, v114
    v_exp_f32 v115, v115
    v_cvt_pk_bf16_f32 v116, v112, v113
    v_cvt_pk_bf16_f32 v117, v114, v115
    v_bfi_b32 v128, v36, 0, v116
    v_and_b32_e64 v130, v36, v116
    buffer_load_dwordx4 v75, s[4:7], s99 offen offset:2176  lds
    v_bfi_b32 v129, v37, 0, v117
    v_and_b32 v131, v37, v117
    s_waitcnt lgkmcnt(3)
    s_nop 0
    v_mfma_f32_16x16x32_bf16 v[144:147], v[106:109], v[128:131], 0
    s_waitcnt lgkmcnt(2)
    v_mfma_f32_16x16x32_bf16 v[136:139], v[100:103], v[128:131], 0
    v_fma_f32 v120, v120, s82, -v157
    v_fma_f32 v121, v121, s82, -v157
    v_fma_f32 v122, v122, s82, -v157
    v_fma_f32 v123, v123, s82, -v157
    buffer_load_dwordx4 v76, s[4:7], s99 offen offset:3264  lds
    v_exp_f32 v120, v120
    v_exp_f32 v121, v121
    v_exp_f32 v122, v122
    v_exp_f32 v123, v123
    v_cvt_pk_bf16_f32 v124, v120, v121
    v_cvt_pk_bf16_f32 v125, v122, v123
    v_bfi_b32 v132, v36, 0, v124
    v_and_b32_e64 v134, v36, v124
    s_add_u32 m0, s93, 92928
    s_add_u32 s99, s99, 256
    s_mov_b64 exec, s[80:81]
    buffer_load_dwordx4 v77, s[4:7], s100 offen  lds
    s_mov_b64 exec, -1
    s_add_u32 s100, s100, 256
    v_bfi_b32 v133, v37, 0, v125
    v_and_b32 v135, v37, v125
    s_waitcnt lgkmcnt(1)
    s_nop 0
    v_mfma_f32_16x16x32_bf16 v[148:151], v[108:111], v[132:135], 0
    s_waitcnt lgkmcnt(0)
    v_mfma_f32_16x16x32_bf16 v[140:143], v[102:105], v[132:135], 0
    v_mov_b32 v158, v144
    s_nop 1
    v_permlane16_swap_b32 v144, v158
    v_rcp_f32 v158, v158
    s_nop 0
    v_pk_mul_f32 v[136:137], v[136:137], v[158:159] op_sel_hi:[1,0]
    s_lshl_b32 s97, s73, 2
    s_add_u32 s97, s97, s24
    s_nop 0
    s_mul_i32 s97, s97, 25600
    s_add_u32 s97, s97, 2621440
    buffer_load_dwordx4 a[160:163], v58, s[16:19], s97 offen offset:0 sc1
    v_pk_mul_f32 v[138:139], v[138:139], v[158:159] op_sel_hi:[1,0]
    v_pk_mul_f32 v[144:145], v[144:145], v[158:159] op_sel_hi:[1,0]
    v_pk_mul_f32 v[146:147], v[146:147], v[158:159] op_sel_hi:[1,0]
    v_cvt_pk_bf16_f32 v112, v136, v137
    v_cvt_pk_bf16_f32 v116, v144, v145
    v_cvt_pk_bf16_f32 v113, v138, v139
    v_cvt_pk_bf16_f32 v117, v146, v147
    v_mov_b32 v160, v148
    buffer_load_dwordx4 a[164:167], v58, s[16:19], s97 offen offset:1024 sc1
    s_nop 0
    v_permlane16_swap_b32 v148, v160
    v_rcp_f32_e64 v160, v160
    s_nop 0
    v_pk_mul_f32 v[140:141], v[140:141], v[160:161] op_sel_hi:[1,0]
    v_pk_mul_f32 v[142:143], v[142:143], v[160:161] op_sel_hi:[1,0]
    v_pk_mul_f32 v[148:149], v[148:149], v[160:161] op_sel_hi:[1,0]
    v_pk_mul_f32 v[150:151], v[150:151], v[160:161] op_sel_hi:[1,0]
    v_cvt_pk_bf16_f32 v114, v140, v141
    v_cvt_pk_bf16_f32 v118, v148, v149
    buffer_load_dwordx4 a[168:171], v58, s[16:19], s97 offen offset:2048 sc1
    v_cvt_pk_bf16_f32 v115, v142, v143
    v_cvt_pk_bf16_f32 v119, v150, v151
    v_permlane16_swap_b32 v112, v114
    v_permlane16_swap_b32 v113, v115
    v_permlane16_swap_b32 v116, v118
    v_permlane16_swap_b32 v117, v119
    buffer_store_dwordx4 v[112:115], v45, s[16:19], s25 offen sc1
    s_mov_b64 exec, s[80:81]
    buffer_store_dwordx2 v[116:117], v46, s[16:19], s26 offen sc1
    s_mov_b64 exec, -1
    buffer_load_dwordx4 a[172:175], v58, s[16:19], s97 offen offset:3072 sc1
    s_add_u32 s97, s97, 4096
    buffer_load_dwordx4 a[176:179], v58, s[16:19], s97 offen offset:0 sc1
    v_add_u32 v196, 36352, v78
    v_mov_b32 v198, v79
    v_xor_b32 v197, 32, v196
    s_waitcnt vmcnt(17)
    s_barrier
    ds_read_b128 v[160:163], v198 offset:0
    ds_read_b128 v[164:167], v196 offset:0
    ds_read_b128 v[168:171], v196 offset:8704
    ds_read_b128 v[172:175], v198 offset:32
    ds_read_b128 v[176:179], v197 offset:0
    ds_read_b128 v[180:183], v197 offset:8704
    s_waitcnt lgkmcnt(3)
    v_mfma_f32_16x16x32_bf16 v[112:115], a[0:3], v[160:163], 0
    ds_read_b128 v[184:187], v198 offset:64
    v_mfma_f32_32x32x16_bf16 v[80:95], a[0:3], v[164:167], 0
    ds_read_b128 v[188:191], v196 offset:64
    v_mfma_f32_32x32x16_bf16 v[96:111], a[0:3], v[168:171], 0
    ds_read_b128 v[192:195], v196 offset:8768
    s_add_u32 m0, s92, 95104
    s_nop 0
    buffer_load_dwordx4 v73, s[4:7], s99 offen offset:0  lds
    s_waitcnt lgkmcnt(3)
    v_mfma_f32_16x16x32_bf16 v[112:115], a[4:7], v[172:175], v[112:115]
    ds_read_b128 v[160:163], v198 offset:96
    v_mfma_f32_32x32x16_bf16 v[80:95], a[4:7], v[176:179], v[80:95]
    ds_read_b128 v[164:167], v197 offset:64
    v_mfma_f32_32x32x16_bf16 v[96:111], a[4:7], v[180:183], v[96:111]
    ds_read_b128 v[168:171], v197 offset:8768
    buffer_load_dwordx4 v74, s[4:7], s99 offen offset:1088  lds
    s_waitcnt lgkmcnt(3)
    v_mfma_f32_16x16x32_bf16 v[112:115], a[8:11], v[184:187], v[112:115]
    ds_read_b128 v[172:175], v198 offset:128
    v_mfma_f32_32x32x16_bf16 v[80:95], a[8:11], v[188:191], v[80:95]
    ds_read_b128 v[176:179], v196 offset:128
    v_mfma_f32_32x32x16_bf16 v[96:111], a[8:11], v[192:195], v[96:111]
    ds_read_b128 v[180:183], v196 offset:8832
    buffer_load_dwordx4 v75, s[4:7], s99 offen offset:2176  lds
    s_waitcnt lgkmcnt(3)
    v_mfma_f32_16x16x32_bf16 v[112:115], a[12:15], v[160:163], v[112:115]
    ds_read_b128 v[184:187], v198 offset:160
    v_mfma_f32_32x32x16_bf16 v[80:95], a[12:15], v[164:167], v[80:95]
    ds_read_b128 v[188:191], v197 offset:128
    v_mfma_f32_32x32x16_bf16 v[96:111], a[12:15], v[168:171], v[96:111]
    ds_read_b128 v[192:195], v197 offset:8832
    buffer_load_dwordx4 v76, s[4:7], s99 offen offset:3264  lds
    s_waitcnt lgkmcnt(3)
    v_mfma_f32_16x16x32_bf16 v[112:115], a[16:19], v[172:175], v[112:115]
    ds_read_b128 v[160:163], v198 offset:192
    v_mfma_f32_32x32x16_bf16 v[80:95], a[16:19], v[176:179], v[80:95]
    ds_read_b128 v[164:167], v196 offset:192
    v_mfma_f32_32x32x16_bf16 v[96:111], a[16:19], v[180:183], v[96:111]
    ds_read_b128 v[168:171], v196 offset:8896
    s_add_u32 m0, s93, 112512
    s_add_u32 s99, s99, 256
    s_mov_b64 exec, s[80:81]
    buffer_load_dwordx4 v77, s[4:7], s100 offen  lds
    s_mov_b64 exec, -1
    s_add_u32 s100, s100, 256
    s_waitcnt lgkmcnt(3)
    v_mfma_f32_16x16x32_bf16 v[112:115], a[20:23], v[184:187], v[112:115]
    ds_read_b128 v[172:175], v198 offset:224
    v_mfma_f32_32x32x16_bf16 v[80:95], a[20:23], v[188:191], v[80:95]
    ds_read_b128 v[176:179], v197 offset:192
    v_mfma_f32_32x32x16_bf16 v[96:111], a[20:23], v[192:195], v[96:111]
    ds_read_b128 v[180:183], v197 offset:8896
    s_add_u32 m0, s92, 114688
    s_nop 0
    buffer_load_dwordx4 v73, s[4:7], s99 offen offset:0  lds
    s_waitcnt vmcnt(18)
    s_barrier
    s_waitcnt lgkmcnt(3)
    v_mfma_f32_16x16x32_bf16 v[112:115], a[24:27], v[160:163], v[112:115]
    v_add_u32 v198, v49, v198
    v_mfma_f32_32x32x16_bf16 v[80:95], a[24:27], v[164:167], v[80:95]
    v_add_u32 v196, 19584, v196
    v_add_u32 v197, 19584, v197
    ds_read_b128 v[184:187], v198 offset:0
    v_mfma_f32_32x32x16_bf16 v[96:111], a[24:27], v[168:171], v[96:111]
    ds_read_b128 v[188:191], v196 offset:0
    ds_read_b128 v[192:195], v196 offset:8704
    buffer_load_dwordx4 v74, s[4:7], s99 offen offset:1088  lds
    s_waitcnt lgkmcnt(3)
    v_mfma_f32_16x16x32_bf16 v[112:115], a[28:31], v[172:175], v[112:115]
    ds_read_b128 v[160:163], v198 offset:32
    v_mfma_f32_32x32x16_bf16 v[80:95], a[28:31], v[176:179], v[80:95]
    ds_read_b128 v[164:167], v197 offset:0
    v_mfma_f32_32x32x16_bf16 v[96:111], a[28:31], v[180:183], v[96:111]
    ds_read_b128 v[168:171], v197 offset:8704
    buffer_load_dwordx4 v75, s[4:7], s99 offen offset:2176  lds
    s_waitcnt lgkmcnt(3)
    v_mfma_f32_16x16x32_bf16 v[112:115], a[32:35], v[184:187], v[112:115]
    ds_read_b128 v[172:175], v198 offset:64
    v_mfma_f32_32x32x16_bf16 v[80:95], a[32:35], v[188:191], v[80:95]
    ds_read_b128 v[176:179], v196 offset:64
    v_mfma_f32_32x32x16_bf16 v[96:111], a[32:35], v[192:195], v[96:111]
    ds_read_b128 v[180:183], v196 offset:8768
    buffer_load_dwordx4 v76, s[4:7], s99 offen offset:3264  lds
    s_waitcnt lgkmcnt(3)
    v_mfma_f32_16x16x32_bf16 v[112:115], a[36:39], v[160:163], v[112:115]
    ds_read_b128 v[184:187], v198 offset:96
    v_mfma_f32_32x32x16_bf16 v[80:95], a[36:39], v[164:167], v[80:95]
    ds_read_b128 v[188:191], v197 offset:64
    v_mfma_f32_32x32x16_bf16 v[96:111], a[36:39], v[168:171], v[96:111]
    ds_read_b128 v[192:195], v197 offset:8768
    s_add_u32 m0, s93, 132096
    s_add_u32 s99, s99, 256
    s_mov_b64 exec, s[80:81]
    buffer_load_dwordx4 v77, s[4:7], s100 offen  lds
    s_mov_b64 exec, -1
    s_add_u32 s100, s100, 256
    s_waitcnt lgkmcnt(3)
    v_mfma_f32_16x16x32_bf16 v[112:115], a[40:43], v[172:175], v[112:115]
    ds_read_b128 v[160:163], v198 offset:128
    v_mfma_f32_32x32x16_bf16 v[80:95], a[40:43], v[176:179], v[80:95]
    ds_read_b128 v[164:167], v196 offset:128
    s_lshl_b32 s25, s24, 6
    s_and_b32 s35, s74, 3
    s_lshl_b32 s35, s35, 13
    s_add_u32 s35, s35, s25
    v_mfma_f32_32x32x16_bf16 v[96:111], a[40:43], v[180:183], v[96:111]
    ds_read_b128 v[168:171], v196 offset:8832
    s_lshl_b32 s98, s72, 5
    s_add_u32 s98, s98, 256
    s_sub_u32 s95, s98, 4
    s_max_i32 s95, s95, 0
    s_lshl_b32 s94, s98, 3
    s_lshl_b32 s95, s95, 3
    s_add_u32 s94, s94, 3440640
    s_add_u32 s95, s95, 3440640
    s_add_u32 s96, s94, 8192
    buffer_load_dwordx2 v[152:153], v47, s[16:19], s94 offen sc1
    s_waitcnt lgkmcnt(3)
    v_mfma_f32_16x16x32_bf16 v[112:115], a[44:47], v[184:187], v[112:115]
    ds_read_b128 v[172:175], v198 offset:160
    v_mfma_f32_32x32x16_bf16 v[80:95], a[44:47], v[188:191], v[80:95]
    ds_read_b128 v[176:179], v197 offset:128
    s_lshr_b32 s25, s74, 4
    s_lshl_b32 s25, s25, 11
    s_add_u32 s35, s35, s25
    s_and_b32 s25, s74, 12
    v_mfma_f32_32x32x16_bf16 v[96:111], a[44:47], v[192:195], v[96:111]
    ds_read_b128 v[180:183], v197 offset:8832
    buffer_load_dwordx2 v[154:155], v47, s[16:19], s96 offen sc1
    s_lshl_b32 s25, s25, 6
    s_add_u32 s35, s35, s25
    s_waitcnt lgkmcnt(3)
    v_mfma_f32_16x16x32_bf16 v[112:115], a[48:51], v[160:163], v[112:115]
    ds_read_b128 v[184:187], v198 offset:192
    v_mfma_f32_32x32x16_bf16 v[80:95], a[48:51], v[164:167], v[80:95]
    ds_read_b128 v[188:191], v196 offset:192
    s_mul_i32 s36, s73, 20
    s_add_u32 s36, s36, s24
    s_add_u32 s36, s36, 16
    s_lshl_b32 s36, s36, 14
    v_mfma_f32_32x32x16_bf16 v[96:111], a[48:51], v[168:171], v[96:111]
    ds_read_b128 v[192:195], v196 offset:8896
    buffer_load_dwordx2 v[156:157], v48, s[16:19], s95 offen sc1
    v_add_u32 v199, 36352, v58
    s_lshl_b32 s32, s24, 11
    s_waitcnt lgkmcnt(3)
    v_mfma_f32_16x16x32_bf16 v[112:115], a[52:55], v[172:175], v[112:115]
    ds_read_b128 v[160:163], v198 offset:224
    v_mfma_f32_32x32x16_bf16 v[80:95], a[52:55], v[176:179], v[80:95]
    ds_read_b128 v[164:167], v197 offset:192
    v_add_u32 v203, s32, v199
    s_add_u32 s32, s24, 1
    s_and_b32 s32, s32, 3
    s_mul_i32 s32, s32, 6144
    v_mfma_f32_32x32x16_bf16 v[96:111], a[52:55], v[180:183], v[96:111]
    ds_read_b128 v[168:171], v197 offset:8896
    buffer_load_dwordx4 a[180:183], v58, s[16:19], s97 offen offset:1024 sc1
    v_add_u32 v200, s32, v199
    s_add_u32 s32, s24, 2
    s_waitcnt vmcnt(21)
    s_barrier
    s_waitcnt lgkmcnt(3)
    v_mfma_f32_16x16x32_bf16 v[112:115], a[56:59], v[184:187], v[112:115]
    v_add_u32 v198, v49, v198
    v_mfma_f32_32x32x16_bf16 v[80:95], a[56:59], v[188:191], v[80:95]
    v_add_u32 v196, 19584, v196
    v_add_u32 v197, 19584, v197
    ds_read_b128 v[172:175], v198 offset:0
    s_and_b32 s32, s32, 3
    s_mul_i32 s32, s32, 6144
    v_mfma_f32_32x32x16_bf16 v[96:111], a[56:59], v[192:195], v[96:111]
    ds_read_b128 v[176:179], v196 offset:0
    ds_read_b128 v[180:183], v196 offset:8704
    buffer_load_dwordx4 a[184:187], v58, s[16:19], s97 offen offset:2048 sc1
    v_add_u32_e64 v201, s32, v199
    s_waitcnt lgkmcnt(3)
    v_mfma_f32_16x16x32_bf16 v[112:115], a[60:63], v[160:163], v[112:115]
    ds_read_b128 v[184:187], v198 offset:32
    v_mfma_f32_32x32x16_bf16 v[80:95], a[60:63], v[164:167], v[80:95]
    ds_read_b128 v[188:191], v197 offset:0
    s_add_u32 s32, s24, 3
    s_and_b32 s32, s32, 3
    s_mul_i32 s32, s32, 6144
    v_add_u32_e64 v202, s32, v199
    v_mfma_f32_32x32x16_bf16 v[96:111], a[60:63], v[168:171], v[96:111]
    ds_read_b128 v[192:195], v197 offset:8704
    buffer_load_dwordx4 a[188:191], v58, s[16:19], s97 offen offset:3072 sc1
    s_mul_i32 s32, s24, 6144
    v_add_u32 v204, s32, v199
    s_waitcnt lgkmcnt(3)
    v_mfma_f32_16x16x32_bf16 v[112:115], a[64:67], v[172:175], v[112:115]
    ds_read_b128 v[160:163], v198 offset:64
    v_mfma_f32_32x32x16_bf16 v[80:95], a[64:67], v[176:179], v[80:95]
    ds_read_b128 v[164:167], v196 offset:64
    s_lshl_b32 s32, s24, 8
    s_add_u32 s32, s32, 36352
    v_and_b32 v214, 15, v1
    v_lshl_add_u32 v206, v214, 4, s32
    v_mfma_f32_32x32x16_bf16 v[96:111], a[64:67], v[180:183], v[96:111]
    ds_read_b128 v[168:171], v196 offset:8768
    s_add_u32 s97, s97, 4096
    buffer_load_dwordx4 a[192:195], v58, s[16:19], s97 offen offset:0 sc1
    v_lshrrev_b32 v215, 5, v1
    s_waitcnt lgkmcnt(3)
    v_mfma_f32_16x16x32_bf16 v[112:115], a[68:71], v[184:187], v[112:115]
    ds_read_b128 v[172:175], v198 offset:96
    v_mfma_f32_32x32x16_bf16 v[80:95], a[68:71], v[188:191], v[80:95]
    ds_read_b128 v[176:179], v197 offset:64
    v_lshl_add_u32 v205, v215, 10, v206
    v_bfe_u32 v215, v1, 4, 1
    v_lshl_add_u32 v205, v215, 3, v205
    v_lshlrev_b32_e64 v214, 2, v214
    v_mfma_f32_32x32x16_bf16 v[96:111], a[68:71], v[192:195], v[96:111]
    ds_read_b128 v[180:183], v197 offset:8768
    buffer_load_dwordx4 a[196:199], v58, s[16:19], s97 offen offset:1024 sc1
    v_lshl_add_u32 v214, v215, 10, v214
    s_lshl_b32 s32, s24, 6
    s_waitcnt lgkmcnt(3)
    v_mfma_f32_16x16x32_bf16 v[112:115], a[72:75], v[160:163], v[112:115]
    ds_read_b128 v[184:187], v198 offset:128
    v_mfma_f32_32x32x16_bf16 v[80:95], a[72:75], v[164:167], v[80:95]
    ds_read_b128 v[188:191], v196 offset:128
    v_lshl_add_u32 v207, v215, 3, s32
    v_and_b32 v215, 12, v1
    v_lshl_add_u32 v207, v215, 2, v207
    v_and_b32 v215, 2, v1
    v_mfma_f32_32x32x16_bf16 v[96:111], a[72:75], v[168:171], v[96:111]
    ds_read_b128 v[192:195], v196 offset:8832
    buffer_load_dwordx4 a[200:203], v58, s[16:19], s97 offen offset:2048 sc1
    v_lshl_add_u32 v207, v215, 1, v207
    v_add_u32 v207, 69120, v207
    s_waitcnt lgkmcnt(3)
    v_mfma_f32_16x16x32_bf16 v[112:115], a[76:79], v[172:175], v[112:115]
    ds_read_b128 v[160:163], v198 offset:160
    v_mfma_f32_32x32x16_bf16 v[80:95], a[76:79], v[176:179], v[80:95]
    ds_read_b128 v[164:167], v197 offset:128
    v_lshrrev_b32 v215, 4, v1
    v_lshl_add_u32 v206, v215, 2, v206
    v_mov_b32 v215, 0x3f803f80
    v_mfma_f32_32x32x16_bf16 v[96:111], a[76:79], v[180:183], v[96:111]
    ds_read_b128 v[168:171], v197 offset:8832
    buffer_load_dwordx4 a[204:207], v58, s[16:19], s97 offen offset:3072 sc1
    s_waitcnt lgkmcnt(3)
    v_mfma_f32_16x16x32_bf16 v[112:115], a[80:83], v[184:187], v[112:115]
    ds_read_b128 v[172:175], v198 offset:192
    v_mfma_f32_32x32x16_bf16 v[80:95], a[80:83], v[188:191], v[80:95]
    ds_read_b128 v[176:179], v196 offset:192
    v_mfma_f32_32x32x16_bf16 v[96:111], a[80:83], v[192:195], v[96:111]
    ds_read_b128 v[180:183], v196 offset:8896
    s_add_u32 s97, s97, 4096
    buffer_load_dwordx4 a[208:211], v58, s[16:19], s97 offen offset:0 sc1
    s_waitcnt lgkmcnt(3)
    v_mfma_f32_16x16x32_bf16 v[112:115], a[84:87], v[160:163], v[112:115]
    ds_read_b128 v[184:187], v198 offset:224
    v_mfma_f32_32x32x16_bf16 v[80:95], a[84:87], v[164:167], v[80:95]
    ds_read_b128 v[188:191], v197 offset:192
    v_mfma_f32_32x32x16_bf16 v[96:111], a[84:87], v[168:171], v[96:111]
    ds_read_b128 v[192:195], v197 offset:8896
    buffer_load_dwordx4 a[212:215], v58, s[16:19], s97 offen offset:1024 sc1
    s_waitcnt vmcnt(17)
    s_barrier
    s_waitcnt lgkmcnt(3)
    v_mfma_f32_16x16x32_bf16 v[112:115], a[88:91], v[172:175], v[112:115]
    v_add_u32 v198, v49, v198
    v_mfma_f32_32x32x16_bf16 v[80:95], a[88:91], v[176:179], v[80:95]
    v_add_u32 v196, 19584, v196
    v_add_u32 v197, 19584, v197
    ds_read_b128 v[160:163], v198 offset:0
    v_mfma_f32_32x32x16_bf16 v[96:111], a[88:91], v[180:183], v[96:111]
    ds_read_b128 v[164:167], v196 offset:0
    ds_read_b128 v[168:171], v196 offset:8704
    buffer_load_dwordx4 a[216:219], v58, s[16:19], s97 offen offset:2048 sc1
    s_waitcnt lgkmcnt(3)
    v_mfma_f32_16x16x32_bf16 v[112:115], a[92:95], v[184:187], v[112:115]
    ds_read_b128 v[172:175], v198 offset:32
    v_mfma_f32_32x32x16_bf16 v[80:95], a[92:95], v[188:191], v[80:95]
    ds_read_b128 v[176:179], v197 offset:0
    v_mfma_f32_32x32x16_bf16 v[96:111], a[92:95], v[192:195], v[96:111]
    ds_read_b128 v[180:183], v197 offset:8704
    buffer_load_dwordx4 a[220:223], v58, s[16:19], s97 offen offset:3072 sc1
    s_waitcnt lgkmcnt(3)
    v_mfma_f32_16x16x32_bf16 v[112:115], a[96:99], v[160:163], v[112:115]
    ds_read_b128 v[184:187], v198 offset:64
    v_mfma_f32_32x32x16_bf16 v[80:95], a[96:99], v[164:167], v[80:95]
    ds_read_b128 v[188:191], v196 offset:64
    v_mfma_f32_32x32x16_bf16 v[96:111], a[96:99], v[168:171], v[96:111]
    ds_read_b128 v[192:195], v196 offset:8768
    s_add_u32 s97, s97, 4096
    buffer_load_dwordx4 a[224:227], v58, s[16:19], s97 offen offset:0 sc1
    s_waitcnt lgkmcnt(3)
    v_mfma_f32_16x16x32_bf16 v[112:115], a[100:103], v[172:175], v[112:115]
    ds_read_b128 v[160:163], v198 offset:96
    v_mfma_f32_32x32x16_bf16 v[80:95], a[100:103], v[176:179], v[80:95]
    ds_read_b128 v[164:167], v197 offset:64
    v_mfma_f32_32x32x16_bf16 v[96:111], a[100:103], v[180:183], v[96:111]
    ds_read_b128 v[168:171], v197 offset:8768
    buffer_load_dwordx4 a[228:231], v58, s[16:19], s97 offen offset:1024 sc1
    s_waitcnt lgkmcnt(3)
    v_mfma_f32_16x16x32_bf16 v[112:115], a[104:107], v[184:187], v[112:115]
    ds_read_b128 v[172:175], v198 offset:128
    v_mfma_f32_32x32x16_bf16 v[80:95], a[104:107], v[188:191], v[80:95]
    ds_read_b128 v[176:179], v196 offset:128
    v_mfma_f32_32x32x16_bf16 v[96:111], a[104:107], v[192:195], v[96:111]
    ds_read_b128 v[180:183], v196 offset:8832
    buffer_load_dwordx4 a[232:235], v58, s[16:19], s97 offen offset:2048 sc1
    s_waitcnt lgkmcnt(3)
    v_mfma_f32_16x16x32_bf16 v[112:115], a[108:111], v[160:163], v[112:115]
    ds_read_b128 v[184:187], v198 offset:160
    v_mfma_f32_32x32x16_bf16 v[80:95], a[108:111], v[164:167], v[80:95]
    ds_read_b128 v[188:191], v197 offset:128
    v_mfma_f32_32x32x16_bf16 v[96:111], a[108:111], v[168:171], v[96:111]
    ds_read_b128 v[192:195], v197 offset:8832
    buffer_load_dwordx4 a[236:239], v58, s[16:19], s97 offen offset:3072 sc1
    s_waitcnt lgkmcnt(3)
    v_mfma_f32_16x16x32_bf16 v[112:115], a[112:115], v[172:175], v[112:115]
    ds_read_b128 v[160:163], v198 offset:192
    v_mfma_f32_32x32x16_bf16 v[80:95], a[112:115], v[176:179], v[80:95]
    ds_read_b128 v[164:167], v196 offset:192
    v_mfma_f32_32x32x16_bf16 v[96:111], a[112:115], v[180:183], v[96:111]
    ds_read_b128 v[168:171], v196 offset:8896
    s_add_u32 s97, s97, 4096
    buffer_load_dwordx4 a[240:243], v58, s[16:19], s97 offen offset:0 sc1
    s_waitcnt lgkmcnt(3)
    v_mfma_f32_16x16x32_bf16 v[112:115], a[116:119], v[184:187], v[112:115]
    ds_read_b128 v[172:175], v198 offset:224
    v_mfma_f32_32x32x16_bf16 v[80:95], a[116:119], v[188:191], v[80:95]
    ds_read_b128 v[176:179], v197 offset:192
    v_mfma_f32_32x32x16_bf16 v[96:111], a[116:119], v[192:195], v[96:111]
    ds_read_b128 v[180:183], v197 offset:8896
    buffer_load_dwordx4 a[244:247], v58, s[16:19], s97 offen offset:1024 sc1
    s_waitcnt vmcnt(20)
    s_barrier
    s_waitcnt lgkmcnt(3)
    v_mfma_f32_16x16x32_bf16 v[112:115], a[120:123], v[160:163], v[112:115]
    v_add_u32_e64 v198, v49, v198
    v_mfma_f32_32x32x16_bf16 v[80:95], a[120:123], v[164:167], v[80:95]
    v_add_u32 v196, 19584, v196
    v_add_u32 v197, 19584, v197
    s_waitcnt vmcnt(17)
    v_mul_f32 v148, v24, v157
    v_mul_f32 v149, v25, v157
    v_mul_f32 v150, v26, v157
    v_mfma_f32_32x32x16_bf16 v[96:111], a[120:123], v[168:171], v[96:111]
    ds_read_b128 v[184:187], v198 offset:0
    ds_read_b128 v[188:191], v196 offset:0
    buffer_load_dwordx4 a[248:251], v58, s[16:19], s97 offen offset:2048 sc1
    v_mul_f32 v151, v27, v157
    v_mul_f32_e64 v116, v8, v153
    s_waitcnt lgkmcnt(2)
    v_mfma_f32_16x16x32_bf16 v[112:115], a[124:127], v[172:175], v[112:115]
    ds_read_b128 v[192:195], v198 offset:32
    v_mfma_f32_32x32x16_bf16 v[80:95], a[124:127], v[176:179], v[80:95]
    ds_read_b128 v[160:163], v197 offset:0
    v_mul_f32 v117, v9, v153
    v_mul_f32 v118, v10, v153
    v_mul_f32 v119, v11, v153
    v_mul_f32 v120, v12, v153
    v_mfma_f32_32x32x16_bf16 v[96:111], a[124:127], v[180:183], v[96:111]
    buffer_load_dwordx4 a[252:255], v58, s[16:19], s97 offen offset:3072 sc1
    v_mul_f32 v121, v13, v153
    v_mul_f32 v122, v14, v153
    v_mul_f32 v123, v15, v153
    s_waitcnt lgkmcnt(2)
    v_mfma_f32_16x16x32_bf16 v[112:115], a[128:131], v[184:187], v[112:115]
    ds_read_b128 v[164:167], v198 offset:64
    v_mfma_f32_32x32x16_bf16 v[80:95], a[128:131], v[188:191], v[80:95]
    ds_read_b128 v[168:171], v196 offset:64
    v_mul_f32 v124, v16, v153
    v_mul_f32 v125, v17, v153
    v_mul_f32 v126, v18, v153
    s_waitcnt lgkmcnt(2)
    v_mfma_f32_16x16x32_bf16 v[112:115], a[132:135], v[192:195], v[112:115]
    ds_read_b128 v[172:175], v198 offset:96
    v_mfma_f32_32x32x16_bf16 v[80:95], a[132:135], v[160:163], v[80:95]
    ds_read_b128 v[176:179], v197 offset:64
    s_add_u32 s97, s97, 4096
    buffer_load_dwordx4 v[52:55], v58, s[16:19], s97 offen offset:0 sc1
    v_mul_f32 v127, v19, v153
    v_mul_f32_e64 v128, v20, v153
    s_waitcnt lgkmcnt(2)
    v_mfma_f32_16x16x32_bf16 v[112:115], a[136:139], v[164:167], v[112:115]
    ds_read_b128 v[180:183], v198 offset:128
    v_mfma_f32_32x32x16_bf16 v[80:95], a[136:139], v[168:171], v[80:95]
    ds_read_b128 v[184:187], v196 offset:128
    v_mul_f32 v129, v21, v153
    v_mul_f32 v130, v22, v153
    v_mul_f32 v131, v23, v153
    s_waitcnt lgkmcnt(2)
    v_mfma_f32_16x16x32_bf16 v[112:115], a[140:143], v[172:175], v[112:115]
    ds_read_b128 v[188:191], v198 offset:160
    v_mfma_f32_32x32x16_bf16 v[80:95], a[140:143], v[176:179], v[80:95]
    ds_read_b128 v[192:195], v197 offset:128
    s_mov_b32 s96, 4194304
    buffer_load_dwordx4 v[216:219], v56, s[16:19], s96 offen offset:0 sc1
    v_mul_f32 v132, v8, v155
    v_mul_f32_e64 v133, v9, v155
    s_waitcnt lgkmcnt(2)
    v_mfma_f32_16x16x32_bf16 v[112:115], a[144:147], v[180:183], v[112:115]
    ds_read_b128 v[160:163], v198 offset:192
    v_mfma_f32_32x32x16_bf16 v[80:95], a[144:147], v[184:187], v[80:95]
    ds_read_b128 v[164:167], v196 offset:192
    v_mul_f32 v134, v10, v155
    v_mul_f32 v135, v11, v155
    v_mul_f32 v136, v12, v155
    s_waitcnt lgkmcnt(2)
    v_mfma_f32_16x16x32_bf16 v[112:115], a[148:151], v[188:191], v[112:115]
    ds_read_b128 v[168:171], v198 offset:224
    v_mfma_f32_32x32x16_bf16 v[80:95], a[148:151], v[192:195], v[80:95]
    ds_read_b128 v[172:175], v197 offset:192
    buffer_load_dwordx4 v[220:223], v56, s[16:19], s96 offen offset:256 sc1
    v_mul_f32 v137, v13, v155
    v_mul_f32_e64 v138, v14, v155
    s_waitcnt lgkmcnt(2)
    v_mfma_f32_16x16x32_bf16 v[112:115], a[152:155], v[160:163], v[112:115]
    ds_read_b128 v[176:179], v196 offset:8704
    v_mfma_f32_32x32x16_bf16 v[80:95], a[152:155], v[164:167], v[80:95]
    ds_read_b128 v[180:183], v197 offset:8704
    v_mul_f32 v139, v15, v155
    v_mul_f32 v140, v16, v155
    v_mul_f32 v141, v17, v155
    s_waitcnt lgkmcnt(2)
    v_mfma_f32_16x16x32_bf16 v[112:115], a[156:159], v[168:171], v[112:115]
    ds_read_b128 v[184:187], v196 offset:8768
    v_mfma_f32_32x32x16_bf16 v[80:95], a[156:159], v[172:175], v[80:95]
    ds_read_b128 v[188:191], v197 offset:8768
    s_mov_b32 s96, 4227072
    buffer_load_dwordx4 v[224:227], v56, s[16:19], s96 offen offset:0 sc1
    v_mul_f32 v142, v18, v155
    v_mul_f32 v143, v19, v155
    v_mul_f32 v144, v20, v155
    v_mul_f32 v145, v21, v155
    v_mul_f32 v146, v22, v155
    v_mul_f32_e64 v147, v23, v155
    s_waitcnt lgkmcnt(2)
    v_mfma_f32_32x32x16_bf16 v[96:111], a[128:131], v[176:179], v[96:111]
    ds_read_b128 v[192:195], v196 offset:8832
    v_mfma_f32_32x32x16_bf16 v[96:111], a[132:135], v[180:183], v[96:111]
    ds_read_b128 v[160:163], v197 offset:8832
    buffer_load_dwordx4 v[228:231], v56, s[16:19], s96 offen offset:256 sc1
    v_fma_f32 v112, v112, v156, v148
    v_fma_f32 v113, v113, v156, v149
    s_waitcnt lgkmcnt(2)
    v_mfma_f32_32x32x16_bf16 v[96:111], a[136:139], v[184:187], v[96:111]
    ds_read_b128 v[164:167], v196 offset:8896
    v_fma_f32 v114, v114, v156, v150
    v_fma_f32 v115, v115, v156, v151
    v_cvt_pk_bf16_f32 v112, v112, v113
    v_cvt_pk_bf16_f32 v113, v114, v115
    v_mfma_f32_32x32x16_bf16 v[96:111], a[140:143], v[188:191], v[96:111]
    ds_read_b128 v[168:171], v197 offset:8896
    s_mov_b32 s96, 4259840
    buffer_load_dwordx4 v[232:235], v56, s[16:19], s96 offen offset:0 sc1
    v_fma_f32 v80, v80, v152, v116
    v_fma_f32 v81, v81, v152, v117
    s_waitcnt lgkmcnt(2)
    v_mfma_f32_32x32x16_bf16 v[96:111], a[144:147], v[192:195], v[96:111]
    v_fma_f32 v82, v82, v152, v118
    v_fma_f32 v83, v83, v152, v119
    v_cvt_pk_bf16_f32 v80, v80, v81
    v_cvt_pk_bf16_f32 v81, v82, v83
    ds_write_b64 v40, v[112:113] offset:0
    v_mfma_f32_32x32x16_bf16 v[96:111], a[148:151], v[160:163], v[96:111]
    ds_write_b64 v38, v[80:81] offset:0
    v_fma_f32 v84, v84, v152, v120
    v_fma_f32 v85, v85, v152, v121
    v_fma_f32 v86, v86, v152, v122
    s_waitcnt lgkmcnt(2)
    v_mfma_f32_32x32x16_bf16 v[96:111], a[152:155], v[164:167], v[96:111]
    v_fma_f32 v87, v87, v152, v123
    v_cvt_pk_bf16_f32 v84, v84, v85
    v_cvt_pk_bf16_f32 v85, v86, v87
    v_fma_f32 v88, v88, v152, v124
    v_fma_f32 v89, v89, v152, v125
    v_mfma_f32_32x32x16_bf16 v[96:111], a[156:159], v[168:171], v[96:111]
    buffer_load_dwordx4 v[236:239], v56, s[16:19], s96 offen offset:256 sc1
    v_fma_f32 v90, v90, v152, v126
    v_fma_f32 v91, v91, v152, v127
    v_cvt_pk_bf16_f32 v88, v88, v89
    v_cvt_pk_bf16_f32 v89, v90, v91
    ds_write_b64 v38, v[84:85] offset:6400
    ds_write_b64 v38, v[88:89] offset:12800
    v_fma_f32 v92, v92, v152, v128
    v_fma_f32 v93, v93, v152, v129
    v_fma_f32 v94, v94, v152, v130
    v_fma_f32 v95, v95, v152, v131
    v_cvt_pk_bf16_f32 v92, v92, v93
    v_cvt_pk_bf16_f32 v93, v94, v95
    ds_write_b64 v39, v[92:93] offset:0
    v_pk_fma_f32 v[96:97], v[96:97], v[154:155], v[132:133] op_sel_hi:[1,0,1]
    v_pk_fma_f32 v[98:99], v[98:99], v[154:155], v[134:135] op_sel_hi:[1,0,1]
    v_cvt_pk_bf16_f32 v96, v96, v97
    v_cvt_pk_bf16_f32 v97, v98, v99
    v_pk_fma_f32 v[100:101], v[100:101], v[154:155], v[136:137] op_sel_hi:[1,0,1]
    v_pk_fma_f32 v[102:103], v[102:103], v[154:155], v[138:139] op_sel_hi:[1,0,1]
    v_cvt_pk_bf16_f32 v100, v100, v101
    v_cvt_pk_bf16_f32 v101, v102, v103
    ds_write_b64 v38, v[96:97] offset:1600
    ds_write_b64 v38, v[100:101] offset:8000
    v_pk_fma_f32 v[104:105], v[104:105], v[154:155], v[140:141] op_sel_hi:[1,0,1]
    v_pk_fma_f32 v[106:107], v[106:107], v[154:155], v[142:143] op_sel_hi:[1,0,1]
    v_cvt_pk_bf16_f32 v104, v104, v105
    v_cvt_pk_bf16_f32 v105, v106, v107
    v_pk_fma_f32 v[108:109], v[108:109], v[154:155], v[144:145] op_sel_hi:[1,0,1]
    v_pk_fma_f32 v[110:111], v[110:111], v[154:155], v[146:147] op_sel_hi:[1,0,1]
    v_cvt_pk_bf16_f32 v108, v108, v109
    v_cvt_pk_bf16_f32 v109, v110, v111
    ds_write_b64 v38, v[104:105] offset:14400
    ds_write_b64 v39, v[108:109] offset:1600
    s_waitcnt lgkmcnt(0)
    s_barrier
    v_mov_b32 v94, 0
    v_mov_b32 v95, 0
    v_mov_b32 v98, 0
    v_mov_b32_e64 v99, 0
    s_mov_b64 exec, 0xffff
    ds_read_b64 v[94:95], v42 offset:320
    ds_read_b64 v[98:99], v42 offset:640
    s_mov_b64 exec, -1
    s_nop 0
    ds_read_b64 v[92:93], v41 offset:320
    ds_read_b64 v[96:97], v41 offset:640
    ds_read_b64 v[84:85], v41 offset:6720
    ds_read_b64 v[86:87], v42 offset:6720
    ds_read_b64 v[80:81], v41 offset:6400
    ds_read_b64 v[82:83], v42 offset:6400
    ds_read_b64 v[88:89], v41 offset:7040
    ds_read_b64 v[90:91], v42 offset:7040
    ds_read_b64_tr_b16 v[106:107], v44 offset:0
    ds_read_b64_tr_b16 v[100:101], v43 offset:0
    ds_read_b64_tr_b16 v[108:109], v44 offset:320
    ds_read_b64_tr_b16 v[102:103], v43 offset:320
    s_mov_b32 s96, 4292608
    buffer_load_dwordx4 v[240:243], v56, s[16:19], s96 offen offset:0 sc1
    ds_read_b64_tr_b16 v[110:111], v44 offset:640
    ds_read_b64_tr_b16 v[104:105], v43 offset:640
    s_mov_b32 s82, 0x3ea52b5c
    s_lshl_b32 s25, s98, 4
    s_add_u32 s25, s25, 4194304
    s_lshl_b32 s26, s98, 3
    s_add_u32 s26, s26, 4194304
    s_waitcnt lgkmcnt(10)
    v_mfma_f32_16x16x32_bf16 v[116:119], v[84:87], v[92:95], v[28:31]
    buffer_load_dwordx4 v[244:247], v56, s[16:19], s96 offen offset:256 sc1
    v_mfma_f32_16x16x32_bf16 v[120:123], v[84:87], v[96:99], v[32:35]
    s_waitcnt lgkmcnt(8)
    v_mfma_f32_16x16x32_bf16 v[112:115], v[80:83], v[92:95], v[32:35]
    s_waitcnt lgkmcnt(6)
    v_mfma_f32_16x16x32_bf16 v[124:127], v[88:91], v[96:99], v[28:31]
    s_nop 5
    v_max_f32 v112, v112, v116
    v_max_f32 v113, v113, v117
    v_max_f32 v114, v114, v118
    v_max_f32 v115, v115, v119
    v_max3_f32 v156, v112, v113, v114
    s_mov_b32 s96, 4194304
    buffer_load_dwordx2 v[248:249], v57, s[16:19], s96 offen offset:0 sc1
    v_max_f32 v156, v156, v115
    v_max_f32 v120, v120, v124
    v_max_f32 v121, v121, v125
    v_max_f32 v122, v122, v126
    v_max_f32 v123, v123, v127
    v_max3_f32 v157, v120, v121, v122
    v_max_f32 v157, v157, v123
    s_nop 1
    v_permlane16_swap_b32 v156, v157
    buffer_load_dwordx2 v[252:253], v57, s[16:19], s96 offen offset:128 sc1
    v_max_f32 v156, v156, v157
    v_mov_b32 v157, v156
    s_nop 1
    v_permlane32_swap_b32 v156, v157
    v_max_f32 v156, v156, v157
    v_mul_f32 v156, s82, v156
    v_mov_b32 v157, v156
    s_nop 1
    v_permlane16_swap_b32_e64 v156, v157
    v_fma_f32 v112, v112, s82, -v156
    s_mov_b32 s96, 4210688
    buffer_load_dwordx2 v[250:251], v57, s[16:19], s96 offen offset:0 sc1
    v_fma_f32 v113, v113, s82, -v156
    v_fma_f32 v114, v114, s82, -v156
    v_fma_f32 v115, v115, s82, -v156
    v_exp_f32 v112, v112
    v_exp_f32 v113, v113
    v_exp_f32 v114, v114
    v_exp_f32 v115, v115
    v_cvt_pk_bf16_f32 v116, v112, v113
    buffer_load_dwordx2 v[254:255], v57, s[16:19], s96 offen offset:128 sc1
    v_cvt_pk_bf16_f32 v117, v114, v115
    v_bfi_b32 v128, v36, 0, v116
    v_and_b32 v130, v36, v116
    v_bfi_b32 v129, v37, 0, v117
    v_and_b32 v131, v37, v117
    s_waitcnt lgkmcnt(3)
    s_nop 0
    v_mfma_f32_16x16x32_bf16 v[144:147], v[106:109], v[128:131], 0
    s_waitcnt lgkmcnt(2)
    v_mfma_f32_16x16x32_bf16 v[136:139], v[100:103], v[128:131], 0
    v_fma_f32 v120, v120, s82, -v157
    s_mov_b32 s96, 0
    s_mov_b32 s97, 5120
    buffer_load_dwordx2 v[208:209], v60, s[4:7], s96 offen
    v_fma_f32 v121, v121, s82, -v157
    v_fma_f32 v122, v122, s82, -v157
    v_fma_f32 v123, v123, s82, -v157
    v_exp_f32 v120, v120
    v_exp_f32 v121, v121
    v_exp_f32 v122, v122
    v_exp_f32 v123, v123
    v_cvt_pk_bf16_f32 v124, v120, v121
    buffer_load_dwordx2 v[210:211], v60, s[4:7], s97 offen
    v_cvt_pk_bf16_f32 v125, v122, v123
    v_bfi_b32 v132, v36, 0, v124
    v_and_b32 v134, v36, v124
    v_bfi_b32 v133, v37, 0, v125
    v_and_b32 v135, v37, v125
    s_waitcnt lgkmcnt(1)
    s_nop 0
    v_mfma_f32_16x16x32_bf16 v[148:151], v[108:111], v[132:135], 0
    s_waitcnt lgkmcnt(0)
    v_mfma_f32_16x16x32_bf16 v[140:143], v[102:105], v[132:135], 0
    v_mov_b32 v158, v144
    v_lshrrev_b32_e64 v212, 5, v1
    v_mul_u32_u24 v212, 5104, v212
    v_bfe_u32 v213, v1, 4, 1
    v_lshlrev_b32 v213, 2, v213
    v_sub_u32 v212, v212, v213
    v_add_u32 v212, v212, v60
    s_mul_i32 s97, s24, 24
    s_sub_u32 s97, 128, s97
    buffer_load_dword v212, v212, s[4:7], s97 offen
    v_permlane16_swap_b32 v144, v158
    v_rcp_f32_e64 v158, v158
    s_nop 0
    v_pk_mul_f32 v[136:137], v[136:137], v[158:159] op_sel_hi:[1,0]
    v_pk_mul_f32 v[138:139], v[138:139], v[158:159] op_sel_hi:[1,0]
    v_pk_mul_f32 v[144:145], v[144:145], v[158:159] op_sel_hi:[1,0]
    v_pk_mul_f32 v[146:147], v[146:147], v[158:159] op_sel_hi:[1,0]
    v_cvt_pk_bf16_f32 v112, v136, v137
    v_cvt_pk_bf16_f32 v116, v144, v145
    v_cvt_pk_bf16_f32 v113, v138, v139
    v_cvt_pk_bf16_f32 v117, v146, v147
    v_mov_b32 v160, v148
    s_nop 1
    v_permlane16_swap_b32 v148, v160
    v_rcp_f32_e64 v160, v160
    s_nop 0
    v_pk_mul_f32 v[140:141], v[140:141], v[160:161] op_sel_hi:[1,0]
    v_pk_mul_f32 v[142:143], v[142:143], v[160:161] op_sel_hi:[1,0]
    v_pk_mul_f32 v[148:149], v[148:149], v[160:161] op_sel_hi:[1,0]
    v_pk_mul_f32 v[150:151], v[150:151], v[160:161] op_sel_hi:[1,0]
    v_cvt_pk_bf16_f32 v114, v140, v141
    v_cvt_pk_bf16_f32 v118, v148, v149
    v_cvt_pk_bf16_f32 v115, v142, v143
    v_cvt_pk_bf16_f32 v119, v150, v151
    v_permlane16_swap_b32 v112, v114
    v_permlane16_swap_b32 v113, v115
    v_permlane16_swap_b32 v116, v118
    v_permlane16_swap_b32 v117, v119
    buffer_store_dwordx4 v[112:115], v45, s[16:19], s25 offen sc1
    s_mov_b64 exec, s[80:81]
    buffer_store_dwordx2 v[116:117], v46, s[16:19], s26 offen sc1
    s_mov_b64 exec, -1
oe_20:
    s_waitcnt vmcnt(16)
    v_mfma_f32_16x16x32_bf16 v[112:115], a[176:179], v[216:219], 0
    v_mov_b32 v136, 0
    v_mov_b32 v137, 0
    s_waitcnt vmcnt(15)
    v_mfma_f32_16x16x32_bf16 v[116:119], a[176:179], v[220:223], 0
    v_mov_b32 v138, 0
    v_mov_b32 v139, 0
    s_waitcnt vmcnt(14)
    v_mfma_f32_16x16x32_bf16 v[112:115], a[196:199], v[224:227], v[112:115]
    v_mov_b32 v140, 0
    v_mov_b32 v141, 0
    s_waitcnt vmcnt(13)
    v_mfma_f32_16x16x32_bf16 v[116:119], a[196:199], v[228:231], v[116:119]
    s_mov_b32 s25, 6815744
    s_add_u32 s26, s36, 6815744
    s_waitcnt vmcnt(12)
    v_mfma_f32_16x16x32_bf16 v[112:115], a[216:219], v[232:235], v[112:115]
    s_add_u32 s27, s35, 3473408
    s_mov_b32 s28, 0x99999999
    s_waitcnt vmcnt(11)
    v_mfma_f32_16x16x32_bf16 v[116:119], a[216:219], v[236:239], v[116:119]
    s_mov_b32 s29, 0x99999999
    s_waitcnt vmcnt(10)
    v_mfma_f32_16x16x32_bf16 v[112:115], a[236:239], v[240:243], v[112:115]
    s_waitcnt vmcnt(9)
    v_mfma_f32_16x16x32_bf16 v[116:119], a[236:239], v[244:247], v[116:119]
    s_waitcnt vmcnt(6)
    v_mfma_f32_16x16x32_bf16 v[112:115], v[52:55], v[248:251], v[112:115]
    s_waitcnt vmcnt(5)
    v_mfma_f32_16x16x32_bf16 v[116:119], v[52:55], v[252:255], v[116:119]
    v_mfma_f32_16x16x32_bf16 v[88:91], a[164:167], v[216:219], 0
    v_mfma_f32_16x16x32_bf16 v[92:95], a[164:167], v[220:223], 0
    v_mfma_f32_16x16x32_bf16 v[88:91], a[184:187], v[224:227], v[88:91]
    v_mfma_f32_16x16x32_bf16 v[92:95], a[184:187], v[228:231], v[92:95]
    v_mfma_f32_16x16x32_bf16 v[88:91], a[204:207], v[232:235], v[88:91]
    v_mfma_f32_16x16x32_bf16 v[92:95], a[204:207], v[236:239], v[92:95]
    s_nop 1
    v_cmp_u_f32 vcc, v112, v116
    s_nop 0
    s_cbranch_vccnz rd_21
rc_22:
    v_mfma_f32_16x16x32_bf16 v[88:91], a[224:227], v[240:243], v[88:91]
    ds_write_b128 v203, v[112:115] offset:24576
    v_mfma_f32_16x16x32_bf16 v[92:95], a[224:227], v[244:247], v[92:95]
    v_mfma_f32_16x16x32_bf16 v[88:91], a[244:247], v[248:251], v[88:91]
    ds_write_b128 v203, v[116:119] offset:25600
    v_mfma_f32_16x16x32_bf16 v[92:95], a[244:247], v[252:255], v[92:95]
    v_mfma_f32_16x16x32_bf16 v[96:99], a[168:171], v[216:219], 0
    s_waitcnt vmcnt(4)
    v_lshlrev_b32 v120, 16, v208
    v_and_b32 v121, 0xffff0000, v208
    v_mfma_f32_16x16x32_bf16 v[100:103], a[168:171], v[220:223], 0
    v_lshlrev_b32_e64 v122, 16, v209
    v_and_b32 v123, 0xffff0000, v209
    v_mfma_f32_16x16x32_bf16 v[96:99], a[188:191], v[224:227], v[96:99]
    s_waitcnt vmcnt(3)
    v_lshlrev_b32 v124, 16, v210
    v_and_b32 v125, 0xffff0000, v210
    v_mfma_f32_16x16x32_bf16 v[100:103], a[188:191], v[228:231], v[100:103]
    v_lshlrev_b32_e64 v126, 16, v211
    v_and_b32 v127, 0xffff0000, v211
    v_mfma_f32_16x16x32_bf16 v[96:99], a[208:211], v[232:235], v[96:99]
    s_waitcnt vmcnt(2)
    v_lshlrev_b32 v128, 16, v212
    v_and_b32 v129, 0xffff0000, v212
    v_mfma_f32_16x16x32_bf16 v[100:103], a[208:211], v[236:239], v[100:103]
    v_mfma_f32_16x16x32_bf16 v[96:99], a[228:231], v[240:243], v[96:99]
    ds_write_b128 v200, v[88:91] offset:0
    v_mfma_f32_16x16x32_bf16 v[100:103], a[228:231], v[244:247], v[100:103]
    v_mfma_f32_16x16x32_bf16 v[96:99], a[248:251], v[248:251], v[96:99]
    ds_write_b128 v200, v[92:95] offset:1024
    v_mfma_f32_16x16x32_bf16 v[100:103], a[248:251], v[252:255], v[100:103]
    v_mfma_f32_16x16x32_bf16 v[104:107], a[172:175], v[216:219], 0
    v_mfma_f32_16x16x32_bf16 v[108:111], a[172:175], v[220:223], 0
    v_mfma_f32_16x16x32_bf16 v[104:107], a[192:195], v[224:227], v[104:107]
    v_mfma_f32_16x16x32_bf16 v[108:111], a[192:195], v[228:231], v[108:111]
    v_mfma_f32_16x16x32_bf16 v[104:107], a[212:215], v[232:235], v[104:107]
    v_mfma_f32_16x16x32_bf16 v[108:111], a[212:215], v[236:239], v[108:111]
    v_mfma_f32_16x16x32_bf16 v[104:107], a[232:235], v[240:243], v[104:107]
    ds_write_b128 v201, v[96:99] offset:2048
    v_mfma_f32_16x16x32_bf16 v[108:111], a[232:235], v[244:247], v[108:111]
    v_mfma_f32_16x16x32_bf16 v[104:107], a[252:255], v[248:251], v[104:107]
    ds_write_b128 v201, v[100:103] offset:3072
    v_mfma_f32_16x16x32_bf16 v[108:111], a[252:255], v[252:255], v[108:111]
    v_mfma_f32_16x16x32_bf16 v[80:83], a[160:163], v[216:219], v[120:123]
    v_mfma_f32_16x16x32_bf16 v[84:87], a[160:163], v[220:223], v[124:127]
    v_mfma_f32_16x16x32_bf16 v[80:83], a[180:183], v[224:227], v[80:83]
    v_mfma_f32_16x16x32_bf16 v[84:87], a[180:183], v[228:231], v[84:87]
    v_mfma_f32_16x16x32_bf16 v[80:83], a[200:203], v[232:235], v[80:83]
    s_nop 0
    ds_write_b128 v202, v[104:107] offset:4096
    v_mfma_f32_16x16x32_bf16 v[84:87], a[200:203], v[236:239], v[84:87]
    ds_write_b128 v202, v[108:111] offset:5120
    v_mfma_f32_16x16x32_bf16 v[80:83], a[220:223], v[240:243], v[80:83]
    v_mfma_f32_16x16x32_bf16 v[84:87], a[220:223], v[244:247], v[84:87]
    v_mfma_f32_16x16x32_bf16 v[80:83], a[240:243], v[248:251], v[80:83]
    v_mfma_f32_16x16x32_bf16 v[84:87], a[240:243], v[252:255], v[84:87]
    s_waitcnt lgkmcnt(0)
    s_barrier
    s_nop 0
    ds_read_b128 v[88:91], v204 offset:0
    ds_read_b128 v[92:95], v204 offset:1024
    ds_read_b128 v[96:99], v204 offset:2048
    ds_read_b128 v[100:103], v204 offset:3072
    ds_read_b128 v[104:107], v204 offset:4096
    ds_read_b128 v[108:111], v204 offset:5120
    ds_read_b64 v[112:113], v205 offset:24576
    ds_read_b64 v[114:115], v205 offset:26624
    ds_read_b64 v[116:117], v205 offset:28672
    ds_read_b64 v[118:119], v205 offset:30720
    s_waitcnt lgkmcnt(9)
    v_pk_add_f32 v[80:81], v[80:81], v[88:89]
    v_pk_add_f32 v[82:83], v[82:83], v[90:91]
    s_waitcnt lgkmcnt(8)
    v_pk_add_f32 v[84:85], v[84:85], v[92:93]
    v_pk_add_f32 v[86:87], v[86:87], v[94:95]
    s_waitcnt lgkmcnt(7)
    v_pk_add_f32 v[80:81], v[80:81], v[96:97]
    v_pk_add_f32 v[82:83], v[82:83], v[98:99]
    s_waitcnt lgkmcnt(6)
    v_pk_add_f32 v[84:85], v[84:85], v[100:101]
    v_pk_add_f32 v[86:87], v[86:87], v[102:103]
    s_waitcnt lgkmcnt(5)
    v_pk_add_f32 v[80:81], v[80:81], v[104:105]
    v_pk_add_f32 v[82:83], v[82:83], v[106:107]
    s_waitcnt lgkmcnt(4)
    v_pk_add_f32 v[84:85], v[84:85], v[108:109]
    v_pk_add_f32 v[86:87], v[86:87], v[110:111]
    v_cvt_pk_bf16_f32 v132, v80, v81
    v_cvt_pk_bf16_f32 v133, v82, v83
    v_cvt_pk_bf16_f32 v134, v84, v85
    v_cvt_pk_bf16_f32 v135, v86, v87
    s_waitcnt lgkmcnt(3)
    v_pk_add_f32 v[128:129], v[128:129], v[112:113]
    s_waitcnt lgkmcnt(2)
    v_pk_add_f32 v[128:129], v[128:129], v[114:115]
    s_waitcnt lgkmcnt(1)
    v_pk_add_f32 v[128:129], v[128:129], v[116:117]
    s_waitcnt lgkmcnt(0)
    v_pk_add_f32 v[128:129], v[128:129], v[118:119]
    v_cvt_pk_bf16_f32 v130, v128, v129
    buffer_store_dwordx4 v[132:135], v59, s[16:19], s25 offen sc1
    buffer_store_dword v130, v61, s[16:19], s26 offen sc1
    v_dot2c_f32_bf16 v136, v132, v215
    v_dot2c_f32_bf16 v137, v132, v132
    v_dot2c_f32_bf16 v136, v133, v215
    v_dot2c_f32_bf16 v137, v133, v133
    v_dot2c_f32_bf16 v138, v134, v215
    v_dot2c_f32_bf16 v139, v134, v134
    v_dot2c_f32_bf16 v138, v135, v215
    v_dot2c_f32_bf16 v139, v135, v135
    v_dot2c_f32_bf16 v140, v130, v215
    v_dot2c_f32_bf16 v141, v130, v130
    v_permlane32_swap_b32 v136, v138
    v_permlane32_swap_b32 v137, v139
    v_pk_add_f32 v[136:137], v[136:137], v[138:139]
    v_pk_add_f32 v[136:137], v[136:137], v[140:141]
    s_nop 1
    v_permlane16_swap_b32 v136, v137
    v_add_f32_e64 v136, v136, v137
    ds_write_b32 v206, v136 offset:32768
    s_mov_b32 s96, 4198400
    buffer_load_dwordx4 v[216:219], v56, s[16:19], s96 offen offset:0 sc1
    buffer_load_dwordx4 v[220:223], v56, s[16:19], s96 offen offset:256 sc1
    s_mov_b32 s96, 4231168
    buffer_load_dwordx4 v[224:227], v56, s[16:19], s96 offen offset:0 sc1
    buffer_load_dwordx4 v[228:231], v56, s[16:19], s96 offen offset:256 sc1
    s_mov_b32 s96, 4263936
    buffer_load_dwordx4 v[232:235], v56, s[16:19], s96 offen offset:0 sc1
    buffer_load_dwordx4 v[236:239], v56, s[16:19], s96 offen offset:256 sc1
    s_waitcnt lgkmcnt(0)
    s_barrier
    ds_read2st64_b32 v[136:137], v207 offset0:0 offset1:1
    ds_read2st64_b32 v[138:139], v207 offset0:2 offset1:3
    ds_read_b64_tr_b16 v[144:145], v65 offset:32
    ds_read_b64_tr_b16 v[146:147], v65 offset:0
    ds_read_b64_tr_b16 v[148:149], v65 offset:160
    ds_read_b64_tr_b16 v[150:151], v65 offset:128
    ds_read_b64_tr_b16 v[152:153], v65 offset:288
    ds_read_b64_tr_b16 v[154:155], v65 offset:256
    ds_read_b64_tr_b16 v[156:157], v65 offset:416
    ds_read_b64_tr_b16 v[158:159], v65 offset:384
    ds_read_b64_tr_b16 v[160:161], v65 offset:544
    ds_read_b64_tr_b16 v[162:163], v65 offset:512
    ds_read_b64_tr_b16 v[164:165], v65 offset:672
    ds_read_b64_tr_b16 v[166:167], v65 offset:640
    ds_read_b64_tr_b16 v[168:169], v65 offset:800
    ds_read_b64_tr_b16 v[170:171], v65 offset:768
    ds_read_b64_tr_b16 v[172:173], v65 offset:928
    ds_read_b64_tr_b16 v[174:175], v65 offset:896
    s_waitcnt lgkmcnt(15)
    v_pk_add_f32 v[136:137], v[136:137], v[138:139]
    v_add_f32 v136, v136, v137
    v_cndmask_b32 v136, v136, 1.0, s[28:29]
    s_mov_b64 exec, s[80:81]
    buffer_atomic_add_f32 v136, v214, s[16:19], s27 offen
    s_mov_b64 exec, -1
    s_mov_b32 s96, 4296704
    buffer_load_dwordx4 v[240:243], v56, s[16:19], s96 offen offset:0 sc1
    buffer_load_dwordx4 v[244:247], v56, s[16:19], s96 offen offset:256 sc1
    s_mov_b32 s96, 4196352
    buffer_load_dwordx2 v[248:249], v57, s[16:19], s96 offen offset:0 sc1
    buffer_load_dwordx2 v[252:253], v57, s[16:19], s96 offen offset:128 sc1
    s_mov_b32 s96, 4212736
    buffer_load_dwordx2 v[250:251], v57, s[16:19], s96 offen offset:0 sc1
    buffer_load_dwordx2 v[254:255], v57, s[16:19], s96 offen offset:128 sc1
    s_mov_b32 s96, 1310720
    s_mov_b32 s97, 1315840
    buffer_load_dwordx2 v[208:209], v60, s[4:7], s96 offen
    buffer_load_dwordx2 v[210:211], v60, s[4:7], s97 offen
    v_lshrrev_b32_e64 v212, 5, v1
    v_mul_u32_u24 v212, 5104, v212
    v_bfe_u32 v213, v1, 4, 1
    v_lshlrev_b32 v213, 2, v213
    v_sub_u32 v212, v212, v213
    v_add_u32 v212, v212, v60
    s_mul_i32 s97, s24, 24
    s_sub_u32 s97, 1310848, s97
    buffer_load_dword v212, v212, s[4:7], s97 offen
    v_lshrrev_b32 v176, 4, v0
    v_mul_u32_u24 v176, 1216, v176
    v_and_b32 v177, 15, v0
    v_lshl_add_u32 v176, v177, 3, v176
    v_add_u32 v176, 64, v176
    v_mov_b32 v178, 0
    v_mov_b32 v179, 0
    ds_write_b64 v176, v[178:179]
    v_mov_b32 v70, 0
    v_mov_b32 v71, 0
    v_mov_b32 v72, 0
    s_lshl_b32 s25, s24, 17
    v_lshrrev_b32 v176, 5, v1
    v_lshl_add_u32 v176, v176, 14, s25
    v_bfe_u32 v177, v1, 4, 1
    v_lshl_add_u32 v176, v177, 13, v176
    v_and_b32_e64 v177, 15, v1
    v_lshl_add_u32 v73, v177, 4, v176
    v_bfe_u32 v176, v1, 2, 3
    v_lshl_add_u32 v176, v176, 14, s25
    v_bfe_u32 v177, v1, 1, 1
    v_lshl_add_u32 v176, v177, 13, v176
    v_and_b32 v177, 1, v1
    v_lshl_add_u32 v77, v177, 4, v176
    v_lshrrev_b32 v177, 5, v1
    v_and_b32 v176, 31, v1
    v_lshlrev_b32 v176, 3, v176
    v_lshl_add_u32 v78, v177, 10, v176
    v_and_b32 v176, 7, v1
    v_lshlrev_b32 v176, 3, v176
    v_lshl_add_u32 v178, v177, 7, v176
    v_add_u32 v74, 31744, v73
    v_add_u32 v75, 63488, v73
    v_add_u32 v76, 95232, v73
    v_add_u32 v178, 53760, v178
    v_and_b32 v176, 31, v1
    v_cmp_eq_u32 vcc, 0, v176
    v_cmp_eq_u32 s[82:83], 24, v176
    s_nop 0
    s_or_b64 vcc, vcc, s[82:83]
    v_mov_b32 v176, 155648
    v_mov_b32 v177, 157696
    v_cndmask_b32 v176, v176, v177, vcc
    v_cndmask_b32 v79, v176, v178, s[78:79]
oe_23:
    s_waitcnt vmcnt(15)
    v_mfma_f32_16x16x32_bf16 v[112:115], a[176:179], v[216:219], 0
    v_mov_b32 v136, 0
    v_mov_b32 v137, 0
    s_waitcnt vmcnt(14)
    v_mfma_f32_16x16x32_bf16 v[116:119], a[176:179], v[220:223], 0
    v_mov_b32 v138, 0
    v_mov_b32 v139, 0
    s_waitcnt vmcnt(13)
    v_mfma_f32_16x16x32_bf16 v[112:115], a[196:199], v[224:227], v[112:115]
    v_mov_b32 v140, 0
    v_mov_b32_e64 v141, 0
    s_waitcnt vmcnt(12)
    v_mfma_f32_16x16x32_bf16 v[116:119], a[196:199], v[228:231], v[116:119]
    s_mov_b32 s25, 6817792
    s_add_u32 s26, s36, 6817792
    s_waitcnt vmcnt(11)
    v_mfma_f32_16x16x32_bf16 v[112:115], a[216:219], v[232:235], v[112:115]
    s_add_u32 s27, s35, 3477504
    s_mov_b32 s28, 0x99999999
    s_waitcnt vmcnt(10)
    v_mfma_f32_16x16x32_bf16 v[116:119], a[216:219], v[236:239], v[116:119]
    s_mov_b32 s29, 0x99999999
    s_waitcnt vmcnt(8)
    v_mfma_f32_16x16x32_bf16 v[112:115], a[236:239], v[240:243], v[112:115]
    s_waitcnt vmcnt(7)
    v_mfma_f32_16x16x32_bf16 v[116:119], a[236:239], v[244:247], v[116:119]
    s_waitcnt vmcnt(4)
    v_mfma_f32_16x16x32_bf16 v[112:115], v[52:55], v[248:251], v[112:115]
    s_waitcnt vmcnt(3)
    v_mfma_f32_16x16x32_bf16 v[116:119], v[52:55], v[252:255], v[116:119]
    v_mfma_f32_16x16x32_bf16 v[88:91], a[164:167], v[216:219], 0
    v_mfma_f32_16x16x32_bf16 v[92:95], a[164:167], v[220:223], 0
    v_mfma_f32_16x16x32_bf16 v[88:91], a[184:187], v[224:227], v[88:91]
    v_mfma_f32_16x16x32_bf16 v[92:95], a[184:187], v[228:231], v[92:95]
    v_mfma_f32_16x16x32_bf16 v[88:91], a[204:207], v[232:235], v[88:91]
    v_mfma_f32_16x16x32_bf16 v[92:95], a[204:207], v[236:239], v[92:95]
    s_nop 1
    v_cmp_u_f32 vcc, v112, v116
    s_nop 0
    s_cbranch_vccnz rd_24
rc_25:
    v_mfma_f32_16x16x32_bf16 v[88:91], a[224:227], v[240:243], v[88:91]
    ds_write_b128 v203, v[112:115] offset:24576
    v_mfma_f32_16x16x32_bf16 v[92:95], a[224:227], v[244:247], v[92:95]
    v_mfma_f32_16x16x32_bf16 v[88:91], a[244:247], v[248:251], v[88:91]
    ds_write_b128 v203, v[116:119] offset:25600
    v_mfma_f32_16x16x32_bf16 v[92:95], a[244:247], v[252:255], v[92:95]
    v_mfma_f32_16x16x32_bf16 v[96:99], a[168:171], v[216:219], 0
    s_waitcnt vmcnt(2)
    v_lshlrev_b32 v120, 16, v208
    v_and_b32 v121, 0xffff0000, v208
    v_mfma_f32_16x16x32_bf16 v[100:103], a[168:171], v[220:223], 0
    v_lshlrev_b32_e64 v122, 16, v209
    v_and_b32 v123, 0xffff0000, v209
    v_mfma_f32_16x16x32_bf16 v[96:99], a[188:191], v[224:227], v[96:99]
    s_waitcnt vmcnt(1)
    v_lshlrev_b32 v124, 16, v210
    v_and_b32 v125, 0xffff0000, v210
    v_mfma_f32_16x16x32_bf16 v[100:103], a[188:191], v[228:231], v[100:103]
    v_lshlrev_b32_e64 v126, 16, v211
    v_and_b32 v127, 0xffff0000, v211
    v_mfma_f32_16x16x32_bf16 v[96:99], a[208:211], v[232:235], v[96:99]
    s_waitcnt vmcnt(0)
    v_lshlrev_b32 v128, 16, v212
    v_and_b32 v129, 0xffff0000, v212
    v_mfma_f32_16x16x32_bf16 v[100:103], a[208:211], v[236:239], v[100:103]
    v_mfma_f32_16x16x32_bf16 v[96:99], a[228:231], v[240:243], v[96:99]
    ds_write_b128 v200, v[88:91] offset:0
    v_mfma_f32_16x16x32_bf16 v[100:103], a[228:231], v[244:247], v[100:103]
    v_mfma_f32_16x16x32_bf16 v[96:99], a[248:251], v[248:251], v[96:99]
    ds_write_b128 v200, v[92:95] offset:1024
    v_mfma_f32_16x16x32_bf16 v[100:103], a[248:251], v[252:255], v[100:103]
    v_mfma_f32_16x16x32_bf16 v[104:107], a[172:175], v[216:219], 0
    v_mfma_f32_16x16x32_bf16 v[108:111], a[172:175], v[220:223], 0
    v_mfma_f32_16x16x32_bf16 v[104:107], a[192:195], v[224:227], v[104:107]
    v_mfma_f32_16x16x32_bf16 v[108:111], a[192:195], v[228:231], v[108:111]
    v_mfma_f32_16x16x32_bf16 v[104:107], a[212:215], v[232:235], v[104:107]
    v_mfma_f32_16x16x32_bf16 v[108:111], a[212:215], v[236:239], v[108:111]
    v_mfma_f32_16x16x32_bf16 v[104:107], a[232:235], v[240:243], v[104:107]
    ds_write_b128 v201, v[96:99] offset:2048
    v_mfma_f32_16x16x32_bf16 v[108:111], a[232:235], v[244:247], v[108:111]
    v_mfma_f32_16x16x32_bf16 v[104:107], a[252:255], v[248:251], v[104:107]
    ds_write_b128 v201, v[100:103] offset:3072
    v_mfma_f32_16x16x32_bf16 v[108:111], a[252:255], v[252:255], v[108:111]
    v_mfma_f32_16x16x32_bf16 v[80:83], a[160:163], v[216:219], v[120:123]
    v_mfma_f32_16x16x32_bf16 v[84:87], a[160:163], v[220:223], v[124:127]
    v_mfma_f32_16x16x32_bf16 v[80:83], a[180:183], v[224:227], v[80:83]
    v_mfma_f32_16x16x32_bf16 v[84:87], a[180:183], v[228:231], v[84:87]
    v_mfma_f32_16x16x32_bf16 v[80:83], a[200:203], v[232:235], v[80:83]
    s_nop 0
    ds_write_b128 v202, v[104:107] offset:4096
    v_mfma_f32_16x16x32_bf16 v[84:87], a[200:203], v[236:239], v[84:87]
    ds_write_b128 v202, v[108:111] offset:5120
    v_mfma_f32_16x16x32_bf16 v[80:83], a[220:223], v[240:243], v[80:83]
    v_mfma_f32_16x16x32_bf16 v[84:87], a[220:223], v[244:247], v[84:87]
    v_mfma_f32_16x16x32_bf16 v[80:83], a[240:243], v[248:251], v[80:83]
    v_mfma_f32_16x16x32_bf16 v[84:87], a[240:243], v[252:255], v[84:87]
    s_waitcnt lgkmcnt(0)
    s_barrier
    s_nop 0
    ds_read_b128 v[88:91], v204 offset:0
    ds_read_b128 v[92:95], v204 offset:1024
    ds_read_b128 v[96:99], v204 offset:2048
    ds_read_b128 v[100:103], v204 offset:3072
    ds_read_b128 v[104:107], v204 offset:4096
    ds_read_b128 v[108:111], v204 offset:5120
    ds_read_b64 v[112:113], v205 offset:24576
    ds_read_b64 v[114:115], v205 offset:26624
    ds_read_b64 v[116:117], v205 offset:28672
    ds_read_b64 v[118:119], v205 offset:30720
    s_waitcnt lgkmcnt(9)
    v_pk_add_f32 v[80:81], v[80:81], v[88:89]
    v_pk_add_f32 v[82:83], v[82:83], v[90:91]
    s_waitcnt lgkmcnt(8)
    v_pk_add_f32 v[84:85], v[84:85], v[92:93]
    v_pk_add_f32 v[86:87], v[86:87], v[94:95]
    s_waitcnt lgkmcnt(7)
    v_pk_add_f32 v[80:81], v[80:81], v[96:97]
    v_pk_add_f32 v[82:83], v[82:83], v[98:99]
    s_waitcnt lgkmcnt(6)
    v_pk_add_f32 v[84:85], v[84:85], v[100:101]
    v_pk_add_f32 v[86:87], v[86:87], v[102:103]
    s_waitcnt lgkmcnt(5)
    v_pk_add_f32 v[80:81], v[80:81], v[104:105]
    v_pk_add_f32 v[82:83], v[82:83], v[106:107]
    s_waitcnt lgkmcnt(4)
    v_pk_add_f32 v[84:85], v[84:85], v[108:109]
    v_pk_add_f32 v[86:87], v[86:87], v[110:111]
    v_cvt_pk_bf16_f32 v132, v80, v81
    v_cvt_pk_bf16_f32 v133, v82, v83
    v_cvt_pk_bf16_f32 v134, v84, v85
    v_cvt_pk_bf16_f32 v135, v86, v87
    s_waitcnt lgkmcnt(3)
    v_pk_add_f32 v[128:129], v[128:129], v[112:113]
    s_waitcnt lgkmcnt(2)
    v_pk_add_f32 v[128:129], v[128:129], v[114:115]
    s_waitcnt lgkmcnt(1)
    v_pk_add_f32 v[128:129], v[128:129], v[116:117]
    s_waitcnt lgkmcnt(0)
    v_pk_add_f32 v[128:129], v[128:129], v[118:119]
    v_cvt_pk_bf16_f32 v130, v128, v129
    buffer_store_dwordx4 v[132:135], v59, s[16:19], s25 offen sc1
    buffer_store_dword v130, v61, s[16:19], s26 offen sc1
    v_dot2c_f32_bf16 v136, v132, v215
    v_dot2c_f32_bf16 v137, v132, v132
    v_dot2c_f32_bf16 v136, v133, v215
    v_dot2c_f32_bf16 v137, v133, v133
    v_dot2c_f32_bf16 v138, v134, v215
    v_dot2c_f32_bf16 v139, v134, v134
    v_dot2c_f32_bf16 v138, v135, v215
    v_dot2c_f32_bf16 v139, v135, v135
    v_dot2c_f32_bf16 v140, v130, v215
    v_dot2c_f32_bf16 v141, v130, v130
    v_permlane32_swap_b32 v136, v138
    v_permlane32_swap_b32 v137, v139
    v_pk_add_f32 v[136:137], v[136:137], v[138:139]
    v_pk_add_f32 v[136:137], v[136:137], v[140:141]
    s_nop 1
    v_permlane16_swap_b32 v136, v137
    v_add_f32 v136, v136, v137
    ds_write_b32 v206, v136 offset:32768
    s_lshl_b32 s96, s75, 14
    s_add_u32 s96, s96, 6815744
    s_lshl_b32 s97, s24, 12
    s_nop 0
    s_add_u32 s97, s97, 3473408
    buffer_load_dwordx4 v[176:179], v62, s[16:19], s96 offen offset:0 sc1
    buffer_load_dwordx4 v[180:183], v62, s[16:19], s96 offen offset:1024 sc1
    buffer_load_dwordx4 v[184:187], v62, s[16:19], s97 offen offset:0 sc1
    buffer_load_dwordx4 v[188:191], v62, s[16:19], s97 offen offset:1024 sc1
    buffer_load_dwordx4 v[192:195], v62, s[16:19], s97 offen offset:2048 sc1
    buffer_load_dwordx4 v[196:199], v62, s[16:19], s97 offen offset:3072 sc1
    s_waitcnt lgkmcnt(0)
    s_barrier
    ds_read2st64_b32 v[136:137], v207 offset0:0 offset1:1
    ds_read2st64_b32 v[138:139], v207 offset0:2 offset1:3
    s_waitcnt lgkmcnt(0)
    v_pk_add_f32 v[136:137], v[136:137], v[138:139]
    v_add_f32 v136, v136, v137
    v_cndmask_b32 v136, v136, 1.0, s[28:29]
    s_mov_b64 exec, s[80:81]
    buffer_atomic_add_f32 v136, v214, s[16:19], s27 offen
    s_mov_b64 exec, -1
    s_cmp_ge_u32 s2, 160
    s_cbranch_scc1 nc_26
    s_waitcnt vmcnt(1)
ce_28:
    v_max3_u32 v208, v176, v177, v178
    v_max3_u32 v208, v208, v179, v180
    v_max3_u32 v208, v208, v181, v182
    v_max_u32_e64 v208, v208, v183
    v_cmp_eq_u32 s[82:83], -1, v208
    v_min3_f32 v209, v184, v187, v188
    v_min3_f32 v209, v209, v191, v192
    v_min3_f32 v209, v209, v195, v196
    v_min_f32 v209, v209, v199
    v_cmp_neq_f32 vcc, 0x41000000, v209
    s_nop 0
    s_or_b64 vcc, vcc, s[82:83]
    s_cbranch_vccnz rd_29
rc_30:
    v_mul_f32 v208, 0x3acccccd, v185
    v_mul_f32 v209, 0x3acccccd, v189
    v_mul_f32 v186, 0x3acccccd, v186
    v_mul_f32 v190, 0x3acccccd, v190
    v_fma_f32 v186, -v208, v208, v186
    v_fma_f32 v190, -v209, v209, v190
    v_max_f32 v186, 0, v186
    v_max_f32 v190, 0, v190
    v_add_f32 v186, 0x3727c5ac, v186
    v_add_f32 v190, 0x3727c5ac, v190
    v_rsq_f32 v185, v186
    v_rsq_f32 v189, v190
    v_mul_f32 v186, -v208, v185
    v_mul_f32 v190, -v209, v189
    v_lshlrev_b32 v80, 16, v176
    v_and_b32 v82, 0xffff0000, v176
    v_lshlrev_b32 v84, 16, v177
    v_and_b32 v86, 0xffff0000, v177
    v_lshlrev_b32 v81, 16, v178
    v_and_b32 v83, 0xffff0000, v178
    v_lshlrev_b32 v85, 16, v179
    v_and_b32 v87, 0xffff0000, v179
    v_fma_f32 v208, v80, v185, v186
    v_fma_f32 v209, v81, v189, v190
    v_cvt_pk_bf16_f32 v176, v208, v209
    v_fma_f32 v208, v82, v185, v186
    v_fma_f32 v209, v83, v189, v190
    v_cvt_pk_bf16_f32 v177, v208, v209
    v_fma_f32 v208, v84, v185, v186
    v_fma_f32 v209, v85, v189, v190
    v_cvt_pk_bf16_f32 v178, v208, v209
    v_fma_f32 v208, v86, v185, v186
    v_fma_f32 v209, v87, v189, v190
    v_cvt_pk_bf16_f32 v179, v208, v209
    ds_write_b32 v63, v176 offset:0
    ds_write_b32 v63, v177 offset:4864
    ds_write_b32 v63, v178 offset:9728
    ds_write_b32 v63, v179 offset:14592
    v_mul_f32 v208, 0x3acccccd, v193
    v_mul_f32 v209, 0x3acccccd, v197
    v_mul_f32 v194, 0x3acccccd, v194
    v_mul_f32 v198, 0x3acccccd, v198
    v_fma_f32 v194, -v208, v208, v194
    v_fma_f32 v198, -v209, v209, v198
    v_max_f32 v194, 0, v194
    v_max_f32 v198, 0, v198
    v_add_f32 v194, 0x3727c5ac, v194
    v_add_f32 v198, 0x3727c5ac, v198
    v_rsq_f32 v193, v194
    v_rsq_f32 v197, v198
    v_mul_f32 v194, -v208, v193
    v_mul_f32 v198, -v209, v197
    v_lshlrev_b32 v88, 16, v180
    v_and_b32 v90, 0xffff0000, v180
    v_lshlrev_b32 v92, 16, v181
    v_and_b32 v94, 0xffff0000, v181
    v_lshlrev_b32 v89, 16, v182
    v_and_b32 v91, 0xffff0000, v182
    v_lshlrev_b32 v93, 16, v183
    v_and_b32 v95, 0xffff0000, v183
    v_fma_f32 v208, v88, v193, v194
    v_fma_f32 v209, v89, v197, v198
    v_cvt_pk_bf16_f32 v180, v208, v209
    v_fma_f32 v208, v90, v193, v194
    v_fma_f32 v209, v91, v197, v198
    v_cvt_pk_bf16_f32 v181, v208, v209
    v_fma_f32 v208, v92, v193, v194
    v_fma_f32 v209, v93, v197, v198
    v_cvt_pk_bf16_f32 v182, v208, v209
    v_fma_f32 v208, v94, v193, v194
    v_fma_f32 v209, v95, v197, v198
    v_cvt_pk_bf16_f32 v183, v208, v209
    ds_write_b32 v63, v180 offset:256
    ds_write_b32 v63, v181 offset:5120
    ds_write_b32 v63, v182 offset:9984
    ds_write_b32 v63, v183 offset:14848
    s_waitcnt lgkmcnt(0)
    s_barrier
    ds_read_b128 v[212:215], v64 offset:96
    ds_read_b128 v[216:219], v64 offset:64
    ds_read_b128 v[220:223], v64 offset:32
    ds_read_b128 v[224:227], v64 offset:0
    s_waitcnt lgkmcnt(3)
    v_mfma_f32_32x32x16_bf16 v[96:111], v[212:215], v[144:147], 0
    ds_read_b128 v[228:231], v64 offset:224
    ds_read_b64_tr_b16 v[176:177], v65 offset:1056
    ds_read_b64_tr_b16 v[178:179], v65 offset:1024
    ds_read_b64_tr_b16 v[180:181], v65 offset:1184
    ds_read_b64_tr_b16 v[182:183], v65 offset:1152
    s_waitcnt lgkmcnt(7)
    v_mfma_f32_32x32x16_bf16 v[96:111], v[216:219], v[148:151], v[96:111]
    ds_read_b128 v[232:235], v64 offset:192
    ds_read_b64_tr_b16 v[184:185], v65 offset:1312
    ds_read_b64_tr_b16 v[186:187], v65 offset:1280
    ds_read_b64_tr_b16 v[188:189], v65 offset:1440
    ds_read_b64_tr_b16 v[190:191], v65 offset:1408
    s_waitcnt lgkmcnt(11)
    v_mfma_f32_32x32x16_bf16 v[96:111], v[220:223], v[152:155], v[96:111]
    ds_read_b128 v[236:239], v64 offset:160
    ds_read_b64_tr_b16 v[192:193], v65 offset:1568
    ds_read_b64_tr_b16 v[194:195], v65 offset:1536
    ds_read_b64_tr_b16 v[196:197], v65 offset:1696
    ds_read_b64_tr_b16 v[198:199], v65 offset:1664
    s_waitcnt lgkmcnt(15)
    v_mfma_f32_32x32x16_bf16 v[96:111], v[224:227], v[156:159], v[96:111]
    ds_read_b128 v[240:243], v64 offset:128
    ds_read_b64_tr_b16 v[200:201], v65 offset:1824
    ds_read_b64_tr_b16 v[202:203], v65 offset:1792
    ds_read_b64_tr_b16 v[204:205], v65 offset:1952
    ds_read_b64_tr_b16 v[206:207], v65 offset:1920
    s_waitcnt lgkmcnt(15)
    v_mfma_f32_32x32x16_bf16 v[112:127], v[228:231], v[144:147], 0
    v_mov_b32 v248, -1
    v_mov_b32 v249, -1
    v_mov_b32 v250, -1
    v_mov_b32 v251, -1
    s_lshl_b32 s88, s75, 14
    s_add_u32 s88, s88, 9437184
    buffer_store_dwordx4 v[248:251], v62, s[16:19], s88 offen offset:0 sc1
    s_waitcnt lgkmcnt(14)
    v_mfma_f32_32x32x16_bf16 v[112:127], v[232:235], v[148:151], v[112:127]
    v_cndmask_b32 v208, v99, v72, s[76:77]
    v_cndmask_b32 v209, v103, v99, s[76:77]
    v_cndmask_b32 v210, v107, v103, s[76:77]
    v_cndmask_b32 v211, v111, v107, s[76:77]
    v_mov_b32_e64 v72, v111
    s_waitcnt lgkmcnt(9)
    v_mfma_f32_32x32x16_bf16 v[112:127], v[236:239], v[152:155], v[112:127]
    v_add_f32_dpp v98, v208, v98 wave_ror:1 row_mask:0xf bank_mask:0xf
    v_add_f32_dpp v102, v209, v102 wave_ror:1 row_mask:0xf bank_mask:0xf
    v_add_f32_dpp v106, v210, v106 wave_ror:1 row_mask:0xf bank_mask:0xf
    v_add_f32_dpp v110, v211, v110 wave_ror:1 row_mask:0xf bank_mask:0xf
    v_cndmask_b32 v208, v98, v71, s[76:77]
    s_waitcnt lgkmcnt(4)
    v_mfma_f32_32x32x16_bf16 v[112:127], v[240:243], v[156:159], v[112:127]
    v_cndmask_b32 v209, v102, v98, s[76:77]
    v_cndmask_b32 v210, v106, v102, s[76:77]
    v_cndmask_b32 v211, v110, v106, s[76:77]
    v_mov_b32 v71, v110
    v_add_f32_dpp v97, v208, v97 wave_ror:1 row_mask:0xf bank_mask:0xf
    v_add_f32_dpp v101, v209, v101 wave_ror:1 row_mask:0xf bank_mask:0xf
    v_mfma_f32_32x32x16_bf16 v[112:127], v[212:215], v[160:163], v[112:127]
    ds_read_b128 v[244:247], v64 offset:352
    v_add_f32_dpp v105, v210, v105 wave_ror:1 row_mask:0xf bank_mask:0xf
    v_add_f32_dpp v109, v211, v109 wave_ror:1 row_mask:0xf bank_mask:0xf
    v_cndmask_b32 v208, v97, v70, s[76:77]
    v_cndmask_b32 v209, v101, v97, s[76:77]
    v_cndmask_b32 v210, v105, v101, s[76:77]
    v_mfma_f32_32x32x16_bf16 v[112:127], v[216:219], v[164:167], v[112:127]
    ds_read_b128 v[216:219], v64 offset:320
    v_cndmask_b32 v211, v109, v105, s[76:77]
    v_mov_b32_e64 v70, v109
    v_add_f32_dpp v96, v208, v96 wave_ror:1 row_mask:0xf bank_mask:0xf
    v_add_f32_dpp v100, v209, v100 wave_ror:1 row_mask:0xf bank_mask:0xf
    v_add_f32_dpp v104, v210, v104 wave_ror:1 row_mask:0xf bank_mask:0xf
    v_mfma_f32_32x32x16_bf16 v[112:127], v[220:223], v[168:171], v[112:127]
    ds_read_b128 v[220:223], v64 offset:288
    buffer_store_dwordx4 v[248:251], v62, s[16:19], s88 offen offset:1024 sc1
    v_add_f32_dpp v108, v211, v108 wave_ror:1 row_mask:0xf bank_mask:0xf
    v_mfma_f32_32x32x16_bf16 v[112:127], v[224:227], v[172:175], v[112:127]
    ds_read_b128 v[224:227], v64 offset:256
    ds_write_b32 v66, v96 offset:0
    ds_write_b32 v66, v100 offset:64
    s_waitcnt lgkmcnt(5)
    v_mfma_f32_32x32x16_bf16 v[128:143], v[244:247], v[144:147], 0
    ds_write_b32 v66, v104 offset:128
    ds_write_b32 v66, v108 offset:192
    s_nop 0
    s_waitcnt lgkmcnt(6)
    v_mfma_f32_32x32x16_bf16 v[128:143], v[216:219], v[148:151], v[128:143]
    s_nop 3
    v_cndmask_b32 v208, v115, v72, s[76:77]
    s_waitcnt lgkmcnt(5)
    v_mfma_f32_32x32x16_bf16 v[128:143], v[220:223], v[152:155], v[128:143]
    v_cndmask_b32 v209, v119, v115, s[76:77]
    v_cndmask_b32 v210, v123, v119, s[76:77]
    v_cndmask_b32 v211, v127, v123, s[76:77]
    v_mov_b32 v72, v127
    v_add_f32_dpp v114, v208, v114 wave_ror:1 row_mask:0xf bank_mask:0xf
    s_waitcnt lgkmcnt(4)
    v_mfma_f32_32x32x16_bf16 v[128:143], v[224:227], v[156:159], v[128:143]
    v_add_f32_dpp v118, v209, v118 wave_ror:1 row_mask:0xf bank_mask:0xf
    v_add_f32_dpp v122, v210, v122 wave_ror:1 row_mask:0xf bank_mask:0xf
    v_add_f32_dpp v126, v211, v126 wave_ror:1 row_mask:0xf bank_mask:0xf
    v_cndmask_b32 v208, v114, v71, s[76:77]
    v_cndmask_b32 v209, v118, v114, s[76:77]
    v_cndmask_b32 v210, v122, v118, s[76:77]
    v_mfma_f32_32x32x16_bf16 v[128:143], v[228:231], v[160:163], v[128:143]
    buffer_store_dwordx4 v[248:251], v62, s[16:19], s88 offen offset:2048 sc1
    v_cndmask_b32 v211, v126, v122, s[76:77]
    v_mov_b32 v71, v126
    v_add_f32_dpp v113, v208, v113 wave_ror:1 row_mask:0xf bank_mask:0xf
    v_add_f32_dpp v117, v209, v117 wave_ror:1 row_mask:0xf bank_mask:0xf
    v_add_f32_dpp v121, v210, v121 wave_ror:1 row_mask:0xf bank_mask:0xf
    v_mfma_f32_32x32x16_bf16 v[128:143], v[232:235], v[164:167], v[128:143]
    ds_read_b128 v[232:235], v64 offset:64
    v_add_f32_dpp v125, v211, v125 wave_ror:1 row_mask:0xf bank_mask:0xf
    v_cndmask_b32 v208, v113, v70, s[76:77]
    v_cndmask_b32 v209, v117, v113, s[76:77]
    v_cndmask_b32 v210, v121, v117, s[76:77]
    v_cndmask_b32 v211, v125, v121, s[76:77]
    v_mfma_f32_32x32x16_bf16 v[128:143], v[236:239], v[168:171], v[128:143]
    ds_read_b128 v[236:239], v64 offset:32
    v_mov_b32_e64 v70, v125
    v_add_f32_dpp v112, v208, v112 wave_ror:1 row_mask:0xf bank_mask:0xf
    v_add_f32_dpp v116, v209, v116 wave_ror:1 row_mask:0xf bank_mask:0xf
    v_add_f32_dpp v120, v210, v120 wave_ror:1 row_mask:0xf bank_mask:0xf
    v_add_f32_dpp v124, v211, v124 wave_ror:1 row_mask:0xf bank_mask:0xf
    v_mfma_f32_32x32x16_bf16 v[128:143], v[240:243], v[172:175], v[128:143]
    ds_read_b128 v[240:243], v64 offset:0
    ds_write_b32 v66, v112 offset:256
    ds_write_b32 v66, v116 offset:320
    v_mfma_f32_32x32x16_bf16 v[128:143], v[212:215], v[176:179], v[128:143]
    ds_read_b128 v[212:215], v64 offset:480
    ds_write_b32 v66, v120 offset:384
    ds_write_b32 v66, v124 offset:448
    s_waitcnt lgkmcnt(7)
    v_mfma_f32_32x32x16_bf16 v[128:143], v[232:235], v[180:183], v[128:143]
    ds_read_b128 v[232:235], v64 offset:448
    s_waitcnt lgkmcnt(7)
    v_mfma_f32_32x32x16_bf16 v[128:143], v[236:239], v[184:187], v[128:143]
    ds_read_b128 v[236:239], v64 offset:416
    buffer_store_dwordx4 v[248:251], v62, s[16:19], s88 offen offset:3072 sc1
    s_waitcnt lgkmcnt(7)
    v_mfma_f32_32x32x16_bf16 v[128:143], v[240:243], v[188:191], v[128:143]
    ds_read_b128 v[240:243], v64 offset:384
    s_nop 3
    s_waitcnt lgkmcnt(5)
    v_mfma_f32_32x32x16_bf16 v[112:127], v[212:215], v[144:147], 0
    s_nop 4
    s_waitcnt lgkmcnt(2)
    v_mfma_f32_32x32x16_bf16 v[112:127], v[232:235], v[148:151], v[112:127]
    v_cndmask_b32 v208, v131, v72, s[76:77]
    v_cndmask_b32 v209, v135, v131, s[76:77]
    v_cndmask_b32 v210, v139, v135, s[76:77]
    v_cndmask_b32 v211, v143, v139, s[76:77]
    v_mov_b32_e64 v72, v143
    s_waitcnt lgkmcnt(1)
    v_mfma_f32_32x32x16_bf16 v[112:127], v[236:239], v[152:155], v[112:127]
    v_add_f32_dpp v130, v208, v130 wave_ror:1 row_mask:0xf bank_mask:0xf
    v_add_f32_dpp v134, v209, v134 wave_ror:1 row_mask:0xf bank_mask:0xf
    v_add_f32_dpp v138, v210, v138 wave_ror:1 row_mask:0xf bank_mask:0xf
    v_add_f32_dpp v142, v211, v142 wave_ror:1 row_mask:0xf bank_mask:0xf
    v_cndmask_b32 v208, v130, v71, s[76:77]
    s_waitcnt lgkmcnt(0)
    v_mfma_f32_32x32x16_bf16 v[112:127], v[240:243], v[156:159], v[112:127]
    v_cndmask_b32 v209, v134, v130, s[76:77]
    v_cndmask_b32 v210, v138, v134, s[76:77]
    v_cndmask_b32 v211, v142, v138, s[76:77]
    v_mov_b32 v71, v142
    v_add_f32_dpp v129, v208, v129 wave_ror:1 row_mask:0xf bank_mask:0xf
    v_add_f32_dpp v133, v209, v133 wave_ror:1 row_mask:0xf bank_mask:0xf
    v_mfma_f32_32x32x16_bf16 v[112:127], v[244:247], v[160:163], v[112:127]
    v_add_f32_dpp v137, v210, v137 wave_ror:1 row_mask:0xf bank_mask:0xf
    v_add_f32_dpp v141, v211, v141 wave_ror:1 row_mask:0xf bank_mask:0xf
    v_cndmask_b32 v208, v129, v70, s[76:77]
    v_cndmask_b32 v209, v133, v129, s[76:77]
    v_cndmask_b32 v210, v137, v133, s[76:77]
    v_cndmask_b32 v211, v141, v137, s[76:77]
    v_mfma_f32_32x32x16_bf16 v[112:127], v[216:219], v[164:167], v[112:127]
    ds_read_b128 v[240:243], v64 offset:192
    v_mov_b32_e64 v70, v141
    v_add_f32_dpp v128, v208, v128 wave_ror:1 row_mask:0xf bank_mask:0xf
    v_add_f32_dpp v132, v209, v132 wave_ror:1 row_mask:0xf bank_mask:0xf
    v_add_f32_dpp v136, v210, v136 wave_ror:1 row_mask:0xf bank_mask:0xf
    v_add_f32_dpp v140, v211, v140 wave_ror:1 row_mask:0xf bank_mask:0xf
    v_mfma_f32_32x32x16_bf16 v[112:127], v[220:223], v[168:171], v[112:127]
    ds_read_b128 v[220:223], v64 offset:160
    ds_write_b32 v66, v128 offset:512
    ds_write_b32 v66, v132 offset:576
    v_mfma_f32_32x32x16_bf16 v[112:127], v[224:227], v[172:175], v[112:127]
    ds_read_b128 v[224:227], v64 offset:128
    ds_write_b32 v66, v136 offset:640
    ds_write_b32 v66, v140 offset:704
    v_mfma_f32_32x32x16_bf16 v[112:127], v[228:231], v[176:179], v[112:127]
    ds_read_b128 v[236:239], v64 offset:96
    s_waitcnt lgkmcnt(7)
    v_mfma_f32_32x32x16_bf16 v[112:127], v[240:243], v[180:183], v[112:127]
    ds_read_b128 v[240:243], v64 offset:64
    s_waitcnt lgkmcnt(7)
    v_mfma_f32_32x32x16_bf16 v[112:127], v[220:223], v[184:187], v[112:127]
    ds_read_b128 v[220:223], v64 offset:32
    s_waitcnt lgkmcnt(5)
    v_mfma_f32_32x32x16_bf16 v[112:127], v[224:227], v[188:191], v[112:127]
    ds_read_b128 v[224:227], v64 offset:0
    s_waitcnt lgkmcnt(3)
    v_mfma_f32_32x32x16_bf16 v[112:127], v[236:239], v[192:195], v[112:127]
    ds_read_b64_tr_b16 v[216:217], v65 offset:544
    ds_read_b64_tr_b16 v[218:219], v65 offset:512
    s_waitcnt lgkmcnt(4)
    v_mfma_f32_32x32x16_bf16 v[112:127], v[240:243], v[196:199], v[112:127]
    ds_read_b64_tr_b16 v[240:241], v65 offset:1056
    ds_read_b64_tr_b16 v[242:243], v65 offset:1024
    s_waitcnt lgkmcnt(5)
    v_mfma_f32_32x32x16_bf16 v[112:127], v[220:223], v[200:203], v[112:127]
    s_waitcnt lgkmcnt(4)
    v_mfma_f32_32x32x16_bf16 v[112:127], v[224:227], v[204:207], v[112:127]
    ds_read_b64_tr_b16 v[224:225], v65 offset:1568
    ds_read_b64_tr_b16 v[226:227], v65 offset:1536
    s_lshl_b32 s96, s75, 14
    s_add_u32 s96, s96, 6815744
    s_lshl_b32 s97, s24, 12
    s_add_u32 s97, s97, 3477504
    buffer_load_dwordx4 v[248:251], v62, s[16:19], s96 offen offset:2048 sc1
    s_waitcnt lgkmcnt(4)
    v_mfma_f32_32x32x16_bf16 v[144:159], v[212:215], v[216:219], 0
    s_nop 3
    v_cndmask_b32 v208, v115, v72, s[76:77]
    s_waitcnt lgkmcnt(2)
    v_mfma_f32_32x32x16_bf16 v[144:159], v[244:247], v[240:243], v[144:159]
    buffer_load_dwordx4 v[252:255], v62, s[16:19], s96 offen offset:3072 sc1
    v_cndmask_b32 v209, v119, v115, s[76:77]
    v_cndmask_b32 v210, v123, v119, s[76:77]
    v_cndmask_b32 v211, v127, v123, s[76:77]
    v_mov_b32_e64 v72, v127
    v_add_f32_dpp v114, v208, v114 wave_ror:1 row_mask:0xf bank_mask:0xf
    v_mfma_f32_32x32x16_bf16 v[160:175], v[212:215], v[240:243], 0
    ds_read_b64_tr_b16 v[216:217], v65 offset:2080
    ds_read_b64_tr_b16 v[218:219], v65 offset:2048
    v_add_f32_dpp v118, v209, v118 wave_ror:1 row_mask:0xf bank_mask:0xf
    v_add_f32_dpp v122, v210, v122 wave_ror:1 row_mask:0xf bank_mask:0xf
    v_add_f32_dpp v126, v211, v126 wave_ror:1 row_mask:0xf bank_mask:0xf
    s_waitcnt lgkmcnt(2)
    v_mfma_f32_32x32x16_bf16 v[144:159], v[228:231], v[224:227], v[144:159]
    buffer_load_dwordx4 v[96:99], v62, s[16:19], s97 offen offset:0 sc1
    v_cndmask_b32 v208, v114, v71, s[76:77]
    v_cndmask_b32 v209, v118, v114, s[76:77]
    v_cndmask_b32 v210, v122, v118, s[76:77]
    v_cndmask_b32 v211, v126, v122, s[76:77]
    v_mov_b32 v71, v126
    v_mfma_f32_32x32x16_bf16 v[160:175], v[244:247], v[224:227], v[160:175]
    v_add_f32_dpp v113, v208, v113 wave_ror:1 row_mask:0xf bank_mask:0xf
    v_add_f32_dpp v117, v209, v117 wave_ror:1 row_mask:0xf bank_mask:0xf
    v_add_f32_dpp v121, v210, v121 wave_ror:1 row_mask:0xf bank_mask:0xf
    v_add_f32_dpp v125, v211, v125 wave_ror:1 row_mask:0xf bank_mask:0xf
    v_cndmask_b32 v208, v113, v70, s[76:77]
    v_cndmask_b32 v209, v117, v113, s[76:77]
    v_mfma_f32_32x32x16_bf16 v[176:191], v[212:215], v[224:227], 0
    buffer_load_dwordx4 v[100:103], v62, s[16:19], s97 offen offset:1024 sc1
    v_cndmask_b32 v210, v121, v117, s[76:77]
    v_cndmask_b32 v211, v125, v121, s[76:77]
    v_mov_b32 v70, v125
    v_add_f32_dpp v112, v208, v112 wave_ror:1 row_mask:0xf bank_mask:0xf
    s_waitcnt lgkmcnt(0)
    v_mfma_f32_32x32x16_bf16 v[144:159], v[236:239], v[216:219], v[144:159]
    ds_read_b64_tr_b16 v[240:241], v65 offset:2592
    ds_read_b64_tr_b16 v[242:243], v65 offset:2560
    v_add_f32_dpp v116, v209, v116 wave_ror:1 row_mask:0xf bank_mask:0xf
    v_add_f32_dpp v120, v210, v120 wave_ror:1 row_mask:0xf bank_mask:0xf
    v_add_f32_dpp v124, v211, v124 wave_ror:1 row_mask:0xf bank_mask:0xf
    v_mfma_f32_32x32x16_bf16 v[160:175], v[228:231], v[216:219], v[160:175]
    buffer_load_dwordx4 v[104:107], v62, s[16:19], s97 offen offset:2048 sc1
    ds_write_b32 v66, v112 offset:768
    ds_write_b32 v66, v116 offset:832
    v_mfma_f32_32x32x16_bf16 v[176:191], v[244:247], v[216:219], v[176:191]
    ds_write_b32 v66, v120 offset:896
    ds_write_b32 v66, v124 offset:960
    v_mfma_f32_32x32x16_bf16 v[192:207], v[212:215], v[216:219], 0
    ds_read_b64_tr_b16 v[212:213], v65 offset:3104
    ds_read_b64_tr_b16 v[214:215], v65 offset:3072
    buffer_load_dwordx4 v[108:111], v62, s[16:19], s97 offen offset:3072 sc1
    s_waitcnt lgkmcnt(6)
    v_mfma_f32_32x32x16_bf16 v[160:175], v[236:239], v[240:243], v[160:175]
    v_mfma_f32_32x32x16_bf16 v[176:191], v[228:231], v[240:243], v[176:191]
    ds_read_b64_tr_b16 v[224:225], v65 offset:3616
    ds_read_b64_tr_b16 v[226:227], v65 offset:3584
    s_waitcnt vmcnt(6) lgkmcnt(4)
    s_barrier
    v_mfma_f32_32x32x16_bf16 v[192:207], v[244:247], v[240:243], v[192:207]
    ds_read_b64_tr_b16 v[244:245], v65 offset:672
    ds_read_b64_tr_b16 v[246:247], v65 offset:640
    ds_read_b64 v[112:113], v67 offset:0
    ds_read_b64 v[114:115], v67 offset:4224
    ds_read_b64 v[116:117], v67 offset:8448
    s_waitcnt lgkmcnt(7)
    v_mfma_f32_32x32x16_bf16 v[176:191], v[236:239], v[212:215], v[176:191]
    ds_read_b128 v[216:219], v64 offset:320
    ds_read_b64_tr_b16 v[240:241], v65 offset:1184
    ds_read_b64_tr_b16 v[242:243], v65 offset:1152
    ds_read_b64 v[118:119], v67 offset:12672
    ds_read_b64 v[120:121], v67 offset:512
    ds_read_b64 v[122:123], v67 offset:4736
    v_mfma_f32_32x32x16_bf16 v[192:207], v[228:231], v[212:215], v[192:207]
    ds_read_b64 v[124:125], v67 offset:8960
    ds_read_b64 v[126:127], v67 offset:13184
    s_lshl_b32 s25, s75, 14
    s_add_u32 s25, s25, 9437184
    s_waitcnt lgkmcnt(13)
    v_mfma_f32_32x32x16_bf16 v[192:207], v[236:239], v[224:227], v[192:207]
    ds_read_b128 v[228:231], v64 offset:192
    ds_read_b64_tr_b16 v[236:237], v65 offset:1696
    ds_read_b64_tr_b16 v[238:239], v65 offset:1664
    s_waitcnt lgkmcnt(14)
    v_mfma_f32_32x32x16_bf16 v[144:159], v[232:235], v[244:247], v[144:159]
    v_mov_b32 v5, 1
    s_add_u32 s82, s86, 24576
    buffer_atomic_add v5, v6, s[16:19], s82 offen offset:0 sc0 sc1
    s_waitcnt lgkmcnt(8)
    v_mfma_f32_32x32x16_bf16 v[144:159], v[216:219], v[240:243], v[144:159]
    v_mfma_f32_32x32x16_bf16 v[160:175], v[232:235], v[240:243], v[160:175]
    ds_read_b128 v[212:215], v64 offset:64
    ds_read_b64_tr_b16 v[224:225], v65 offset:2208
    ds_read_b64_tr_b16 v[226:227], v65 offset:2176
    s_waitcnt lgkmcnt(3)
    v_mfma_f32_32x32x16_bf16 v[144:159], v[228:231], v[236:239], v[144:159]
    v_mfma_f32_32x32x16_bf16 v[160:175], v[216:219], v[236:239], v[160:175]
    v_add_f32 v112, v112, v80
    v_add_f32 v113, v113, v81
    v_add_f32 v114, v114, v82
    v_add_f32 v115, v115, v83
    v_add_f32 v116, v116, v84
    v_mfma_f32_32x32x16_bf16 v[176:191], v[232:235], v[236:239], v[176:191]
    v_add_f32 v117, v117, v85
    v_add_f32 v118, v118, v86
    v_add_f32 v119, v119, v87
    v_cvt_pk_bf16_f32 v128, v112, v114
    v_cvt_pk_bf16_f32 v129, v116, v118
    s_waitcnt lgkmcnt(0)
    v_mfma_f32_32x32x16_bf16 v[144:159], v[212:215], v[224:227], v[144:159]
    ds_read_b64_tr_b16 v[244:245], v65 offset:2720
    ds_read_b64_tr_b16 v[246:247], v65 offset:2688
    v_cvt_pk_bf16_f32 v130, v113, v115
    v_cvt_pk_bf16_f32 v131, v117, v119
    v_mfma_f32_32x32x16_bf16 v[160:175], v[228:231], v[224:227], v[160:175]
    buffer_store_dwordx4 v[128:131], v62, s[16:19], s25 offen offset:0 sc1
    v_add_f32 v120, v120, v88
    v_add_f32 v121, v121, v89
    v_add_f32 v122, v122, v90
    v_add_f32 v123, v123, v91
    v_add_f32 v124, v124, v92
    v_mfma_f32_32x32x16_bf16 v[176:191], v[216:219], v[224:227], v[176:191]
    v_add_f32 v125, v125, v93
    v_add_f32 v126, v126, v94
    v_add_f32_e64 v127, v127, v95
    v_cvt_pk_bf16_f32 v132, v120, v122
    v_cvt_pk_bf16_f32 v133, v124, v126
    v_cvt_pk_bf16_f32 v134, v121, v123
    v_mfma_f32_32x32x16_bf16 v[192:207], v[232:235], v[224:227], v[192:207]
    ds_read_b64_tr_b16 v[232:233], v65 offset:3232
    ds_read_b64_tr_b16 v[234:235], v65 offset:3200
    v_cvt_pk_bf16_f32 v135, v125, v127
    s_waitcnt lgkmcnt(2)
    v_mfma_f32_32x32x16_bf16 v[160:175], v[212:215], v[244:247], v[160:175]
    buffer_store_dwordx4 v[132:135], v62, s[16:19], s25 offen offset:1024 sc1
    ds_read_b64_tr_b16 v[112:113], v65 offset:32
    ds_read_b64_tr_b16 v[114:115], v65 offset:0
    ds_read_b64_tr_b16 v[116:117], v65 offset:160
    ds_read_b64_tr_b16 v[118:119], v65 offset:128
    ds_read_b64_tr_b16 v[120:121], v65 offset:288
    v_mfma_f32_32x32x16_bf16 v[176:191], v[228:231], v[244:247], v[176:191]
    ds_read_b64_tr_b16 v[240:241], v65 offset:3744
    ds_read_b64_tr_b16 v[242:243], v65 offset:3712
    ds_read_b64_tr_b16 v[122:123], v65 offset:256
    ds_read_b64_tr_b16 v[124:125], v65 offset:416
    ds_read_b64_tr_b16 v[126:127], v65 offset:384
    ds_read_b64_tr_b16 v[128:129], v65 offset:544
    v_mfma_f32_32x32x16_bf16 v[192:207], v[216:219], v[244:247], v[192:207]
    ds_read_b128 v[216:219], v64 offset:416
    ds_read_b64_tr_b16 v[236:237], v65 offset:800
    ds_read_b64_tr_b16 v[238:239], v65 offset:768
    ds_read_b64_tr_b16 v[130:131], v65 offset:512
    ds_read_b64_tr_b16 v[132:133], v65 offset:672
    s_waitcnt lgkmcnt(15)
    v_mfma_f32_32x32x16_bf16 v[176:191], v[212:215], v[232:235], v[176:191]
    ds_read_b128 v[224:227], v64 offset:288
    ds_read_b64_tr_b16 v[244:245], v65 offset:1312
    ds_read_b64_tr_b16 v[246:247], v65 offset:1280
    ds_read_b64_tr_b16 v[134:135], v65 offset:640
    ds_read_b64_tr_b16 v[136:137], v65 offset:800
    ds_read_b64_tr_b16 v[138:139], v65 offset:768
    v_mfma_f32_32x32x16_bf16 v[192:207], v[228:231], v[232:235], v[192:207]
    ds_read_b64_tr_b16 v[140:141], v65 offset:928
    ds_read_b64_tr_b16 v[142:143], v65 offset:896
    s_waitcnt lgkmcnt(15)
    v_mfma_f32_32x32x16_bf16 v[192:207], v[212:215], v[240:243], v[192:207]
    ds_read_b128 v[228:231], v64 offset:160
    ds_read_b64_tr_b16 v[212:213], v65 offset:1824
    ds_read_b64_tr_b16 v[214:215], v65 offset:1792
    s_waitcnt vmcnt(3)
ce_31:
    v_max3_u32 v208, v248, v249, v250
    v_max3_u32 v208, v208, v251, v252
    v_max3_u32 v208, v208, v253, v254
    v_max_u32_e64 v208, v208, v255
    v_cmp_eq_u32 s[82:83], -1, v208
    v_min3_f32 v209, v96, v99, v100
    v_min3_f32 v209, v209, v103, v104
    v_min3_f32 v209, v209, v107, v108
    v_min_f32 v209, v209, v111
    v_cmp_neq_f32 vcc, 0x41000000, v209
    s_nop 0
    s_or_b64 vcc, vcc, s[82:83]
    s_cbranch_vccnz rd_32
rc_33:
    s_waitcnt lgkmcnt(13)
    v_mfma_f32_32x32x16_bf16 v[144:159], v[216:219], v[236:239], v[144:159]
    v_mul_f32 v208, 0x3acccccd, v97
    v_mul_f32 v209, 0x3acccccd, v101
    v_mul_f32 v98, 0x3acccccd, v98
    v_mul_f32 v102, 0x3acccccd, v102
    v_fma_f32 v98, -v208, v208, v98
    s_waitcnt lgkmcnt(8)
    v_mfma_f32_32x32x16_bf16 v[144:159], v[224:227], v[244:247], v[144:159]
    v_fma_f32 v102, -v209, v209, v102
    v_max_f32 v98, 0, v98
    v_max_f32 v102, 0, v102
    v_add_f32 v98, 0x3727c5ac, v98
    v_add_f32 v102, 0x3727c5ac, v102
    v_mfma_f32_32x32x16_bf16 v[160:175], v[216:219], v[244:247], v[160:175]
    ds_read_b64_tr_b16 v[232:233], v65 offset:2336
    ds_read_b64_tr_b16 v[234:235], v65 offset:2304
    v_rsq_f32 v97, v98
    s_waitcnt lgkmcnt(2)
    v_mfma_f32_32x32x16_bf16 v[144:159], v[228:231], v[212:215], v[144:159]
    v_rsq_f32_e64 v101, v102
    v_mul_f32 v98, -v208, v97
    v_mul_f32 v102, -v209, v101
    v_lshlrev_b32_e64 v80, 16, v248
    v_and_b32 v82, 0xffff0000, v248
    v_mfma_f32_32x32x16_bf16 v[160:175], v[224:227], v[212:215], v[160:175]
    v_lshlrev_b32 v84, 16, v249
    v_and_b32 v86, 0xffff0000, v249
    v_lshlrev_b32 v81, 16, v250
    v_and_b32 v83, 0xffff0000, v250
    v_lshlrev_b32_e64 v85, 16, v251
    v_and_b32 v87, 0xffff0000, v251
    v_mfma_f32_32x32x16_bf16 v[176:191], v[216:219], v[212:215], v[176:191]
    v_fma_f32 v208, v80, v97, v98
    v_fma_f32 v209, v81, v101, v102
    v_cvt_pk_bf16_f32 v248, v208, v209
    v_fma_f32 v208, v82, v97, v98
    v_fma_f32 v209, v83, v101, v102
    s_waitcnt lgkmcnt(0)
    v_mfma_f32_32x32x16_bf16 v[144:159], v[220:223], v[232:235], v[144:159]
    ds_read_b64_tr_b16 v[240:241], v65 offset:2848
    ds_read_b64_tr_b16 v[242:243], v65 offset:2816
    v_cvt_pk_bf16_f32 v249, v208, v209
    v_fma_f32 v208, v84, v97, v98
    v_fma_f32 v209, v85, v101, v102
    v_cvt_pk_bf16_f32 v250, v208, v209
    v_mfma_f32_32x32x16_bf16 v[160:175], v[228:231], v[232:235], v[160:175]
    v_fma_f32 v208, v86, v97, v98
    v_fma_f32 v209, v87, v101, v102
    v_cvt_pk_bf16_f32 v251, v208, v209
    v_mfma_f32_32x32x16_bf16 v[176:191], v[224:227], v[232:235], v[176:191]
    ds_write_b32 v63, v248 offset:512
    ds_write_b32 v63, v249 offset:5376
    ds_write_b32 v63, v250 offset:10240
    v_mfma_f32_32x32x16_bf16 v[192:207], v[216:219], v[232:235], v[192:207]
    ds_read_b64_tr_b16 v[216:217], v65 offset:3360
    ds_read_b64_tr_b16 v[218:219], v65 offset:3328
    ds_write_b32 v63, v251 offset:15104
    v_mul_f32 v208, 0x3acccccd, v105
    s_waitcnt lgkmcnt(6)
    v_mfma_f32_32x32x16_bf16 v[160:175], v[220:223], v[240:243], v[160:175]
    v_mul_f32 v209, 0x3acccccd, v109
    v_mul_f32 v106, 0x3acccccd, v106
    v_mul_f32 v110, 0x3acccccd, v110
    v_fma_f32 v106, -v208, v208, v106
    v_fma_f32 v110, -v209, v209, v110
    v_max_f32_e64 v106, 0, v106
    v_mfma_f32_32x32x16_bf16 v[176:191], v[228:231], v[240:243], v[176:191]
    ds_read_b64_tr_b16 v[236:237], v65 offset:3872
    ds_read_b64_tr_b16 v[238:239], v65 offset:3840
    v_max_f32_e64 v110, 0, v110
    v_add_f32 v106, 0x3727c5ac, v106
    v_add_f32 v110, 0x3727c5ac, v110
    v_mfma_f32_32x32x16_bf16 v[192:207], v[224:227], v[240:243], v[192:207]
    ds_read_b128 v[224:227], v64 offset:384
    ds_read_b64_tr_b16 v[244:245], v65 offset:928
    ds_read_b64_tr_b16 v[246:247], v65 offset:896
    v_rsq_f32 v105, v106
    s_waitcnt lgkmcnt(6)
    v_mfma_f32_32x32x16_bf16 v[176:191], v[220:223], v[216:219], v[176:191]
    ds_read_b128 v[212:215], v64 offset:256
    ds_read_b64_tr_b16 v[232:233], v65 offset:1440
    ds_read_b64_tr_b16 v[234:235], v65 offset:1408
    v_rsq_f32_e64 v109, v110
    v_mul_f32 v106, -v208, v105
    v_mfma_f32_32x32x16_bf16 v[192:207], v[228:231], v[216:219], v[192:207]
    v_mul_f32 v110, -v209, v109
    v_lshlrev_b32 v88, 16, v252
    v_and_b32 v90, 0xffff0000, v252
    v_lshlrev_b32 v92, 16, v253
    v_and_b32 v94, 0xffff0000, v253
    s_waitcnt lgkmcnt(6)
    v_mfma_f32_32x32x16_bf16 v[192:207], v[220:223], v[236:239], v[192:207]
    ds_read_b128 v[220:223], v64 offset:128
    ds_read_b64_tr_b16 v[228:229], v65 offset:1952
    ds_read_b64_tr_b16 v[230:231], v65 offset:1920
    v_lshlrev_b32 v89, 16, v254
    v_and_b32 v91, 0xffff0000, v254
    s_waitcnt lgkmcnt(6)
    v_mfma_f32_32x32x16_bf16 v[144:159], v[224:227], v[244:247], v[144:159]
    v_lshlrev_b32 v93, 16, v255
    v_and_b32 v95, 0xffff0000, v255
    v_fma_f32 v208, v88, v105, v106
    v_fma_f32 v209, v89, v109, v110
    v_cvt_pk_bf16_f32 v252, v208, v209
    s_waitcnt lgkmcnt(3)
    v_mfma_f32_32x32x16_bf16 v[144:159], v[212:215], v[232:235], v[144:159]
    v_fma_f32 v208, v90, v105, v106
    v_fma_f32 v209, v91, v109, v110
    v_cvt_pk_bf16_f32 v253, v208, v209
    v_fma_f32 v208, v92, v105, v106
    v_fma_f32 v209, v93, v109, v110
    v_cvt_pk_bf16_f32 v254, v208, v209
    v_mfma_f32_32x32x16_bf16 v[160:175], v[224:227], v[232:235], v[160:175]
    ds_read_b128 v[240:243], v64 offset:0
    ds_read_b64_tr_b16 v[216:217], v65 offset:2464
    ds_read_b64_tr_b16 v[218:219], v65 offset:2432
    v_fma_f32 v208, v94, v105, v106
    v_fma_f32 v209, v95, v109, v110
    s_waitcnt lgkmcnt(3)
    v_mfma_f32_32x32x16_bf16 v[144:159], v[220:223], v[228:231], v[144:159]
    v_cvt_pk_bf16_f32 v255, v208, v209
    ds_write_b32 v63, v252 offset:768
    v_mfma_f32_32x32x16_bf16 v[160:175], v[212:215], v[228:231], v[160:175]
    ds_write_b32 v63, v253 offset:5632
    ds_write_b32 v63, v254 offset:10496
    ds_write_b32 v63, v255 offset:15360
    v_mfma_f32_32x32x16_bf16 v[176:191], v[224:227], v[228:231], v[176:191]
    s_waitcnt vmcnt(2)
    v_cmp_eq_u32 vcc, 19, v5
    s_nop 0
    s_cbranch_vccnz gl_34
gc_35:
    s_lshl_b32 s25, s72, 5
    s_add_u32 s25, s25, 0
    s_sub_u32 s26, s25, 4
    s_waitcnt lgkmcnt(4)
    v_mfma_f32_32x32x16_bf16 v[144:159], v[240:243], v[216:219], v[144:159]
    ds_read_b64_tr_b16 v[236:237], v65 offset:2976
    ds_read_b64_tr_b16 v[238:239], v65 offset:2944
    s_max_i32 s26, s26, 0
    s_lshl_b32 s27, s71, 12
    s_add_u32 s27, s27, 9437184
    s_lshl_b32 s99, s25, 3
    v_mfma_f32_32x32x16_bf16 v[160:175], v[220:223], v[216:219], v[160:175]
    s_lshl_b32 s100, s26, 3
    s_lshl_b32 s92, s24, 12
    s_lshl_b32 s93, s24, 9
    s_add_u32 s99, s99, s27
    s_add_u32 s100, s100, s27
    v_mfma_f32_32x32x16_bf16 v[176:191], v[212:215], v[216:219], v[176:191]
    v_mfma_f32_32x32x16_bf16 v[192:207], v[224:227], v[216:219], v[192:207]
    ds_read_b64_tr_b16 v[224:225], v65 offset:3488
    ds_read_b64_tr_b16 v[226:227], v65 offset:3456
    s_waitcnt lgkmcnt(2)
    v_mfma_f32_32x32x16_bf16 v[160:175], v[240:243], v[236:239], v[160:175]
    v_mfma_f32_32x32x16_bf16 v[176:191], v[220:223], v[236:239], v[176:191]
    ds_read_b64_tr_b16 v[244:245], v65 offset:4000
    ds_read_b64_tr_b16 v[246:247], v65 offset:3968
    v_mfma_f32_32x32x16_bf16 v[192:207], v[212:215], v[236:239], v[192:207]
    s_waitcnt lgkmcnt(2)
    v_mfma_f32_32x32x16_bf16 v[176:191], v[240:243], v[224:227], v[176:191]
    v_mfma_f32_32x32x16_bf16 v[192:207], v[220:223], v[224:227], v[192:207]
    s_waitcnt lgkmcnt(0)
    v_mfma_f32_32x32x16_bf16 v[192:207], v[240:243], v[244:247], v[192:207]
    s_waitcnt lgkmcnt(0)
    s_barrier
    ds_read_b128 v[212:215], v64 offset:608
    ds_read_b128 v[216:219], v64 offset:576
    ds_read_b128 v[220:223], v64 offset:544
    ds_read_b128 v[224:227], v64 offset:512
    s_waitcnt lgkmcnt(3)
    v_mfma_f32_32x32x16_bf16 v[144:159], v[212:215], v[112:115], v[144:159]
    ds_read_b128 v[228:231], v64 offset:736
    s_waitcnt lgkmcnt(3)
    v_mfma_f32_32x32x16_bf16 v[144:159], v[216:219], v[116:119], v[144:159]
    ds_read_b128 v[232:235], v64 offset:704
    s_waitcnt lgkmcnt(3)
    v_mfma_f32_32x32x16_bf16 v[144:159], v[220:223], v[120:123], v[144:159]
    ds_read_b128 v[236:239], v64 offset:672
    s_waitcnt lgkmcnt(3)
    v_mfma_f32_32x32x16_bf16 v[144:159], v[224:227], v[124:127], v[144:159]
    ds_read_b128 v[240:243], v64 offset:640
    s_nop 3
    s_waitcnt lgkmcnt(3)
    v_mfma_f32_32x32x16_bf16 v[160:175], v[228:231], v[112:115], v[160:175]
    s_nop 4
    s_waitcnt lgkmcnt(2)
    v_mfma_f32_32x32x16_bf16 v[160:175], v[232:235], v[116:119], v[160:175]
    v_cndmask_b32 v208, v147, v72, s[76:77]
    v_cndmask_b32 v209, v151, v147, s[76:77]
    v_cndmask_b32 v210, v155, v151, s[76:77]
    v_cndmask_b32 v211, v159, v155, s[76:77]
    v_mov_b32_e64 v72, v159
    s_waitcnt lgkmcnt(1)
    v_mfma_f32_32x32x16_bf16 v[160:175], v[236:239], v[120:123], v[160:175]
    v_add_f32_dpp v146, v208, v146 wave_ror:1 row_mask:0xf bank_mask:0xf
    v_add_f32_dpp v150, v209, v150 wave_ror:1 row_mask:0xf bank_mask:0xf
    v_add_f32_dpp v154, v210, v154 wave_ror:1 row_mask:0xf bank_mask:0xf
    v_add_f32_dpp v158, v211, v158 wave_ror:1 row_mask:0xf bank_mask:0xf
    v_cndmask_b32 v208, v146, v71, s[76:77]
    s_waitcnt lgkmcnt(0)
    v_mfma_f32_32x32x16_bf16 v[160:175], v[240:243], v[124:127], v[160:175]
    v_cndmask_b32 v209, v150, v146, s[76:77]
    v_cndmask_b32 v210, v154, v150, s[76:77]
    v_cndmask_b32 v211, v158, v154, s[76:77]
    v_mov_b32 v71, v158
    v_add_f32_dpp v145, v208, v145 wave_ror:1 row_mask:0xf bank_mask:0xf
    v_add_f32_dpp v149, v209, v149 wave_ror:1 row_mask:0xf bank_mask:0xf
    v_mfma_f32_32x32x16_bf16 v[160:175], v[212:215], v[128:131], v[160:175]
    ds_read_b128 v[244:247], v64 offset:864
    v_add_f32_dpp v153, v210, v153 wave_ror:1 row_mask:0xf bank_mask:0xf
    v_add_f32_dpp v157, v211, v157 wave_ror:1 row_mask:0xf bank_mask:0xf
    v_cndmask_b32 v208, v145, v70, s[76:77]
    v_cndmask_b32 v209, v149, v145, s[76:77]
    v_cndmask_b32 v210, v153, v149, s[76:77]
    v_mfma_f32_32x32x16_bf16 v[160:175], v[216:219], v[132:135], v[160:175]
    ds_read_b128 v[248:251], v64 offset:832
    v_cndmask_b32 v211, v157, v153, s[76:77]
    v_mov_b32_e64 v70, v157
    v_add_f32_dpp v144, v208, v144 wave_ror:1 row_mask:0xf bank_mask:0xf
    v_add_f32_dpp v148, v209, v148 wave_ror:1 row_mask:0xf bank_mask:0xf
    v_add_f32_dpp v152, v210, v152 wave_ror:1 row_mask:0xf bank_mask:0xf
    v_mfma_f32_32x32x16_bf16 v[160:175], v[220:223], v[136:139], v[160:175]
    ds_read_b128 v[252:255], v64 offset:800
    v_add_f32_dpp v156, v211, v156 wave_ror:1 row_mask:0xf bank_mask:0xf
    ds_write_b32 v66, v144 offset:0
    v_mfma_f32_32x32x16_bf16 v[160:175], v[224:227], v[140:143], v[160:175]
    ds_read_b128 v[224:227], v64 offset:768
    ds_write_b32 v66, v148 offset:64
    ds_write_b32 v66, v152 offset:128
    s_waitcnt lgkmcnt(6)
    v_mfma_f32_32x32x16_bf16 v[176:191], v[244:247], v[112:115], v[176:191]
    ds_write_b32 v66, v156 offset:192
    s_nop 2
    s_waitcnt lgkmcnt(6)
    v_mfma_f32_32x32x16_bf16 v[176:191], v[248:251], v[116:119], v[176:191]
    s_nop 2
    v_cndmask_b32 v208, v163, v72, s[76:77]
    v_cndmask_b32 v209, v167, v163, s[76:77]
    s_waitcnt lgkmcnt(5)
    v_mfma_f32_32x32x16_bf16 v[176:191], v[252:255], v[120:123], v[176:191]
    v_cndmask_b32 v210, v171, v167, s[76:77]
    v_cndmask_b32 v211, v175, v171, s[76:77]
    v_mov_b32 v72, v175
    v_add_f32_dpp v162, v208, v162 wave_ror:1 row_mask:0xf bank_mask:0xf
    v_add_f32_dpp v166, v209, v166 wave_ror:1 row_mask:0xf bank_mask:0xf
    s_waitcnt lgkmcnt(3)
    v_mfma_f32_32x32x16_bf16 v[176:191], v[224:227], v[124:127], v[176:191]
    v_add_f32_dpp v170, v210, v170 wave_ror:1 row_mask:0xf bank_mask:0xf
    v_add_f32_dpp v174, v211, v174 wave_ror:1 row_mask:0xf bank_mask:0xf
    v_cndmask_b32 v208, v162, v71, s[76:77]
    v_cndmask_b32 v209, v166, v162, s[76:77]
    v_cndmask_b32 v210, v170, v166, s[76:77]
    v_cndmask_b32 v211, v174, v170, s[76:77]
    v_mfma_f32_32x32x16_bf16 v[176:191], v[228:231], v[128:131], v[176:191]
    ds_read_b64_tr_b16 v[228:229], v65 offset:1056
    ds_read_b64_tr_b16 v[230:231], v65 offset:1024
    v_mov_b32 v71, v174
    v_add_f32_dpp v161, v208, v161 wave_ror:1 row_mask:0xf bank_mask:0xf
    v_add_f32_dpp v165, v209, v165 wave_ror:1 row_mask:0xf bank_mask:0xf
    v_add_f32_dpp v169, v210, v169 wave_ror:1 row_mask:0xf bank_mask:0xf
    v_mfma_f32_32x32x16_bf16 v[176:191], v[232:235], v[132:135], v[176:191]
    ds_read_b64_tr_b16 v[232:233], v65 offset:1184
    ds_read_b64_tr_b16 v[234:235], v65 offset:1152
    v_add_f32_dpp v173, v211, v173 wave_ror:1 row_mask:0xf bank_mask:0xf
    v_cndmask_b32 v208, v161, v70, s[76:77]
    v_cndmask_b32 v209, v165, v161, s[76:77]
    v_cndmask_b32 v210, v169, v165, s[76:77]
    v_mfma_f32_32x32x16_bf16 v[176:191], v[236:239], v[136:139], v[176:191]
    ds_read_b64_tr_b16 v[236:237], v65 offset:1312
    ds_read_b64_tr_b16 v[238:239], v65 offset:1280
    v_cndmask_b32 v211, v173, v169, s[76:77]
    v_mov_b32_e64 v70, v173
    v_add_f32_dpp v160, v208, v160 wave_ror:1 row_mask:0xf bank_mask:0xf
    v_add_f32_dpp v164, v209, v164 wave_ror:1 row_mask:0xf bank_mask:0xf
    v_mfma_f32_32x32x16_bf16 v[176:191], v[240:243], v[140:143], v[176:191]
    ds_read_b128 v[240:243], v64 offset:512
    ds_read_b64_tr_b16 v[224:225], v65 offset:1440
    ds_read_b64_tr_b16 v[226:227], v65 offset:1408
    v_add_f32_dpp v168, v210, v168 wave_ror:1 row_mask:0xf bank_mask:0xf
    v_add_f32_dpp v172, v211, v172 wave_ror:1 row_mask:0xf bank_mask:0xf
    s_waitcnt lgkmcnt(7)
    v_mfma_f32_32x32x16_bf16 v[176:191], v[212:215], v[228:231], v[176:191]
    ds_read_b128 v[212:215], v64 offset:992
    ds_write_b32 v66, v160 offset:256
    ds_write_b32 v66, v164 offset:320
    s_waitcnt lgkmcnt(8)
    v_mfma_f32_32x32x16_bf16 v[176:191], v[216:219], v[232:235], v[176:191]
    ds_read_b128 v[216:219], v64 offset:960
    ds_write_b32 v66, v168 offset:384
    ds_write_b32 v66, v172 offset:448
    s_waitcnt lgkmcnt(9)
    v_mfma_f32_32x32x16_bf16 v[176:191], v[220:223], v[236:239], v[176:191]
    ds_read_b128 v[220:223], v64 offset:928
    s_waitcnt lgkmcnt(7)
    v_mfma_f32_32x32x16_bf16 v[176:191], v[240:243], v[224:227], v[176:191]
    ds_read_b128 v[240:243], v64 offset:896
    s_waitcnt lgkmcnt(2)
    s_barrier
    v_mfma_f32_32x32x16_bf16 v[192:207], v[212:215], v[112:115], v[192:207]
    ds_read_b64 v[144:145], v67 offset:0
    ds_read_b64 v[146:147], v67 offset:4224
    ds_read_b64 v[148:149], v67 offset:8448
    ds_read_b64 v[150:151], v67 offset:12672
    s_lshl_b32 s25, s75, 14
    v_mfma_f32_32x32x16_bf16 v[192:207], v[216:219], v[116:119], v[192:207]
    buffer_load_dword v7, v4, s[16:19], s89 offen offset:0 sc1
    s_add_u32 s25, s25, 9437184
    s_nop 0
    v_cndmask_b32 v208, v179, v72, s[76:77]
    v_cndmask_b32 v209, v183, v179, s[76:77]
    s_waitcnt lgkmcnt(5)
    v_mfma_f32_32x32x16_bf16 v[192:207], v[220:223], v[120:123], v[192:207]
    v_cndmask_b32 v210, v187, v183, s[76:77]
    v_cndmask_b32 v211, v191, v187, s[76:77]
    v_mov_b32 v72, v191
    v_add_f32_dpp v178, v208, v178 wave_ror:1 row_mask:0xf bank_mask:0xf
    v_add_f32_dpp v182, v209, v182 wave_ror:1 row_mask:0xf bank_mask:0xf
    s_waitcnt lgkmcnt(4)
    v_mfma_f32_32x32x16_bf16 v[192:207], v[240:243], v[124:127], v[192:207]
    ds_read_b128 v[212:215], v64 offset:768
    v_add_f32_dpp v186, v210, v186 wave_ror:1 row_mask:0xf bank_mask:0xf
    v_add_f32_dpp v190, v211, v190 wave_ror:1 row_mask:0xf bank_mask:0xf
    v_cndmask_b32 v208, v178, v71, s[76:77]
    v_cndmask_b32 v209, v182, v178, s[76:77]
    v_cndmask_b32 v210, v186, v182, s[76:77]
    v_mfma_f32_32x32x16_bf16 v[192:207], v[244:247], v[128:131], v[192:207]
    ds_read_b128 v[244:247], v64 offset:736
    v_cndmask_b32 v211, v190, v186, s[76:77]
    v_mov_b32 v71, v190
    v_add_f32_dpp v177, v208, v177 wave_ror:1 row_mask:0xf bank_mask:0xf
    v_add_f32_dpp v181, v209, v181 wave_ror:1 row_mask:0xf bank_mask:0xf
    v_add_f32_dpp v185, v210, v185 wave_ror:1 row_mask:0xf bank_mask:0xf
    v_mfma_f32_32x32x16_bf16 v[192:207], v[248:251], v[132:135], v[192:207]
    ds_read_b128 v[248:251], v64 offset:704
    v_add_f32_dpp v189, v211, v189 wave_ror:1 row_mask:0xf bank_mask:0xf
    v_cndmask_b32 v208, v177, v70, s[76:77]
    v_cndmask_b32 v209, v181, v177, s[76:77]
    v_cndmask_b32 v210, v185, v181, s[76:77]
    v_cndmask_b32 v211, v189, v185, s[76:77]
    v_mfma_f32_32x32x16_bf16 v[192:207], v[252:255], v[136:139], v[192:207]
    ds_read_b128 v[252:255], v64 offset:672
    v_mov_b32_e64 v70, v189
    v_add_f32_dpp v176, v208, v176 wave_ror:1 row_mask:0xf bank_mask:0xf
    v_add_f32_dpp v180, v209, v180 wave_ror:1 row_mask:0xf bank_mask:0xf
    v_add_f32_dpp v184, v210, v184 wave_ror:1 row_mask:0xf bank_mask:0xf
    s_waitcnt lgkmcnt(3)
    v_mfma_f32_32x32x16_bf16 v[192:207], v[212:215], v[140:143], v[192:207]
    ds_read_b128 v[216:219], v64 offset:640
    v_add_f32_dpp v188, v211, v188 wave_ror:1 row_mask:0xf bank_mask:0xf
    s_waitcnt lgkmcnt(3)
    v_mfma_f32_32x32x16_bf16 v[192:207], v[244:247], v[228:231], v[192:207]
    ds_read_b128 v[228:231], v64 offset:608
    ds_read_b64_tr_b16 v[220:221], v65 offset:1568
    ds_read_b64_tr_b16 v[222:223], v65 offset:1536
    ds_write_b32 v66, v176 offset:512
    s_waitcnt lgkmcnt(6)
    v_mfma_f32_32x32x16_bf16 v[192:207], v[248:251], v[232:235], v[192:207]
    ds_read_b128 v[232:235], v64 offset:576
    ds_read_b64_tr_b16 v[240:241], v65 offset:1696
    ds_read_b64_tr_b16 v[242:243], v65 offset:1664
    ds_write_b32 v66, v180 offset:576
    s_waitcnt lgkmcnt(9)
    v_mfma_f32_32x32x16_bf16 v[192:207], v[252:255], v[236:239], v[192:207]
    ds_read_b128 v[236:239], v64 offset:544
    ds_read_b64_tr_b16 v[212:213], v65 offset:1824
    ds_read_b64_tr_b16 v[214:215], v65 offset:1792
    ds_write_b32 v66, v184 offset:640
    s_waitcnt lgkmcnt(12)
    v_mfma_f32_32x32x16_bf16 v[192:207], v[216:219], v[224:227], v[192:207]
    ds_read_b128 v[224:227], v64 offset:512
    ds_read_b64_tr_b16 v[244:245], v65 offset:1952
    ds_read_b64_tr_b16 v[246:247], v65 offset:1920
    ds_write_b32 v66, v188 offset:704
    s_waitcnt lgkmcnt(13)
    v_mfma_f32_32x32x16_bf16 v[192:207], v[228:231], v[220:223], v[192:207]
    v_add_f32 v144, v144, v80
    v_add_f32 v145, v145, v81
    v_add_f32 v146, v146, v82
    v_add_f32 v147, v147, v83
    s_waitcnt lgkmcnt(9)
    v_mfma_f32_32x32x16_bf16 v[192:207], v[232:235], v[240:243], v[192:207]
    v_add_f32 v148, v148, v84
    v_add_f32 v149, v149, v85
    v_add_f32 v150, v150, v86
    v_add_f32 v151, v151, v87
    v_cvt_pk_bf16_f32 v160, v144, v146
    s_waitcnt lgkmcnt(5)
    v_mfma_f32_32x32x16_bf16 v[192:207], v[236:239], v[212:215], v[192:207]
    v_cvt_pk_bf16_f32 v161, v148, v150
    v_cvt_pk_bf16_f32 v162, v145, v147
    v_cvt_pk_bf16_f32 v163, v149, v151
    s_waitcnt lgkmcnt(1)
    v_mfma_f32_32x32x16_bf16 v[192:207], v[224:227], v[244:247], v[192:207]
    buffer_store_dwordx4 v[160:163], v62, s[16:19], s25 offen offset:2048 sc1
    s_nop 10
    v_cndmask_b32 v208, v195, v72, s[76:77]
    v_cndmask_b32 v209, v199, v195, s[76:77]
    v_cndmask_b32 v210, v203, v199, s[76:77]
    v_cndmask_b32 v211, v207, v203, s[76:77]
    v_mov_b32_e64 v72, v207
    v_add_f32_dpp v194, v208, v194 wave_ror:1 row_mask:0xf bank_mask:0xf
    v_add_f32_dpp v198, v209, v198 wave_ror:1 row_mask:0xf bank_mask:0xf
    v_add_f32_dpp v202, v210, v202 wave_ror:1 row_mask:0xf bank_mask:0xf
    v_add_f32_dpp v206, v211, v206 wave_ror:1 row_mask:0xf bank_mask:0xf
    v_cndmask_b32 v208, v194, v71, s[76:77]
    v_cndmask_b32 v209, v198, v194, s[76:77]
    v_cndmask_b32 v210, v202, v198, s[76:77]
    v_cndmask_b32 v211, v206, v202, s[76:77]
    v_mov_b32_e64 v71, v206
    v_add_f32_dpp v193, v208, v193 wave_ror:1 row_mask:0xf bank_mask:0xf
    v_add_f32_dpp v197, v209, v197 wave_ror:1 row_mask:0xf bank_mask:0xf
    v_add_f32_dpp v201, v210, v201 wave_ror:1 row_mask:0xf bank_mask:0xf
    v_add_f32_dpp v205, v211, v205 wave_ror:1 row_mask:0xf bank_mask:0xf
    v_cndmask_b32 v208, v193, v70, s[76:77]
    v_cndmask_b32 v209, v197, v193, s[76:77]
    v_cndmask_b32 v210, v201, v197, s[76:77]
    v_cndmask_b32 v211, v205, v201, s[76:77]
    v_mov_b32_e64 v70, v205
    v_add_f32_dpp v192, v208, v192 wave_ror:1 row_mask:0xf bank_mask:0xf
    v_add_f32_dpp v196, v209, v196 wave_ror:1 row_mask:0xf bank_mask:0xf
    v_add_f32_dpp v200, v210, v200 wave_ror:1 row_mask:0xf bank_mask:0xf
    v_add_f32_dpp v204, v211, v204 wave_ror:1 row_mask:0xf bank_mask:0xf
    ds_write_b32 v66, v192 offset:768
    ds_write_b32 v66, v196 offset:832
    ds_write_b32 v66, v200 offset:896
    ds_write_b32 v66, v204 offset:960
    s_waitcnt lgkmcnt(0)
    s_waitcnt vmcnt(1)
    v_cmp_gt_u32_e64 vcc, 1, v7
    s_nop 0
    s_and_b64 vcc, vcc, s[50:51]
    s_cbranch_scc1 ps_36
pc_38:
    s_barrier
    ds_read_b64 v[152:153], v67 offset:512
    ds_read_b64 v[154:155], v67 offset:4736
    ds_read_b64 v[156:157], v67 offset:8960
    ds_read_b64 v[158:159], v67 offset:13184
    s_add_u32 m0, s92, 36352
    s_nop 0
    s_nop 0
    buffer_load_dwordx4 v73, s[16:19], s99 offen offset:0 sc1 lds
    buffer_load_dwordx4 v74, s[16:19], s99 offen offset:1024 sc1 lds
    buffer_load_dwordx4 v75, s[16:19], s99 offen offset:2048 sc1 lds
    buffer_load_dwordx4 v76, s[16:19], s99 offen offset:3072 sc1 lds
    s_add_u32 m0, s93, 53760
    s_add_u32 s99, s99, 524288
    s_mov_b64 exec, s[80:81]
    buffer_load_dwordx4 v77, s[16:19], s100 offen sc1 lds
    s_mov_b64 exec, -1
    s_add_u32 s100, s100, 524288
    s_lshl_b32 s25, s75, 14
    s_add_u32 s25, s25, 9437184
    s_waitcnt lgkmcnt(0)
    v_add_f32 v152, v152, v88
    v_add_f32 v153, v153, v89
    v_add_f32 v154, v154, v90
    v_add_f32 v155, v155, v91
    v_add_f32 v156, v156, v92
    v_add_f32 v157, v157, v93
    v_add_f32 v158, v158, v94
    v_add_f32 v159, v159, v95
    v_cvt_pk_bf16_f32 v164, v152, v154
    v_cvt_pk_bf16_f32 v165, v156, v158
    v_cvt_pk_bf16_f32 v166, v153, v155
    v_cvt_pk_bf16_f32 v167, v157, v159
    buffer_store_dwordx4 v[164:167], v62, s[16:19], s25 offen offset:3072 sc1
    v_mov_b32_e64 v5, 1
    s_add_u32 s82, s86, 24576
    buffer_atomic_add v5, v6, s[16:19], s82 offen offset:4 sc0 sc1
    s_add_u32 m0, s92, 55936
    s_nop 0
    s_nop 0
    buffer_load_dwordx4 v73, s[16:19], s99 offen offset:0 sc1 lds
    buffer_load_dwordx4 v74, s[16:19], s99 offen offset:1024 sc1 lds
    buffer_load_dwordx4 v75, s[16:19], s99 offen offset:2048 sc1 lds
    buffer_load_dwordx4 v76, s[16:19], s99 offen offset:3072 sc1 lds
    s_add_u32 m0, s93, 73344
    s_add_u32 s99, s99, 524288
    s_mov_b64 exec, s[80:81]
    buffer_load_dwordx4 v77, s[16:19], s100 offen sc1 lds
    s_mov_b64 exec, -1
    s_add_u32 s100, s100, 524288
    s_branch ec_27
nc_26:
    v_lshlrev_b32 v2, 3, v4
    v_mov_b32_e64 v5, 1
    v_cndmask_b32 v2, v4, v2, s[50:51]
    buffer_atomic_add v5, v2, s[16:19], s86 offen offset:8 sc1
    buffer_load_dword v7, v4, s[16:19], s87 offen offset:8 sc1
    s_waitcnt vmcnt(0)
    v_cmp_gt_u32 vcc, 12, v7
    s_nop 0
    s_and_b64 vcc, vcc, s[50:51]
    s_cbranch_scc1 ps_39
pc_41:
    v_mov_b32 v100, -1
    v_mov_b32 v101, -1
    v_mov_b32 v102, -1
    v_mov_b32 v103, -1
    v_lshlrev_b32 v104, 4, v0
    s_sub_u32 s88, s2, 160
    s_mul_i32 s88, s88, 57344
    s_min_u32 s88, s88, 5185536
    s_add_u32 s88, s88, 12058624
    buffer_store_dwordx4 v[100:103], v104, s[16:19], s88 offen sc1
    s_add_u32 s88, s88, 4096
    buffer_store_dwordx4 v[100:103], v104, s[16:19], s88 offen sc1
    s_add_u32 s88, s88, 4096
    buffer_store_dwordx4 v[100:103], v104, s[16:19], s88 offen sc1
    s_add_u32 s88, s88, 4096
    buffer_store_dwordx4 v[100:103], v104, s[16:19], s88 offen sc1
    s_add_u32 s88, s88, 4096
    buffer_store_dwordx4 v[100:103], v104, s[16:19], s88 offen sc1
    s_add_u32 s88, s88, 4096
    buffer_store_dwordx4 v[100:103], v104, s[16:19], s88 offen sc1
    s_add_u32 s88, s88, 4096
    buffer_store_dwordx4 v[100:103], v104, s[16:19], s88 offen sc1
    s_add_u32 s88, s88, 4096
    buffer_store_dwordx4 v[100:103], v104, s[16:19], s88 offen sc1
    s_add_u32 s88, s88, 4096
    buffer_store_dwordx4 v[100:103], v104, s[16:19], s88 offen sc1
    s_add_u32 s88, s88, 4096
    buffer_store_dwordx4 v[100:103], v104, s[16:19], s88 offen sc1
    s_add_u32 s88, s88, 4096
    buffer_store_dwordx4 v[100:103], v104, s[16:19], s88 offen sc1
    s_add_u32 s88, s88, 4096
    buffer_store_dwordx4 v[100:103], v104, s[16:19], s88 offen sc1
    s_add_u32 s88, s88, 4096
    buffer_store_dwordx4 v[100:103], v104, s[16:19], s88 offen sc1
    s_add_u32 s88, s88, 4096
    buffer_store_dwordx4 v[100:103], v104, s[16:19], s88 offen sc1
    s_waitcnt vmcnt(0)
    s_barrier
    v_mov_b32_e64 v5, 1
    s_add_u32 s82, s86, 8192
    buffer_atomic_add v5, v6, s[16:19], s82 offen offset:12 sc0 sc1
    s_waitcnt vmcnt(0)
    v_cmp_eq_u32 vcc, 11, v5
    s_nop 0
    s_cbranch_vccnz gl_42
gc_43:
    buffer_load_dword v7, v4, s[16:19], s89 offen offset:0 sc1
    s_waitcnt vmcnt(0)
    v_cmp_gt_u32 vcc, 1, v7
    s_nop 0
    s_and_b64 vcc, vcc, s[50:51]
    s_cbranch_scc1 ps_44
pc_46:
    s_barrier
    s_sub_u32 s3, s2, 160
    s_and_b32 s3, s3, 63
    s_add_u32 s3, s3, 0
    s_and_b32 s25, s3, 3
    s_lshl_b32 s25, s25, 12
    s_lshr_b32 s26, s3, 2
    s_lshl_b32 s26, s26, 7
    s_add_u32 s3, s25, s26
    v_lshrrev_b32 v236, 3, v0
    v_and_b32 v237, 7, v0
    v_lshlrev_b32 v237, 4, v237
    v_lshl_add_u32 v236, v236, 14, v237
    s_sub_u32 s25, s2, 160
    s_cmp_lt_u32 s25, 64
    s_cselect_b32 s25, 0, 1073741824
    v_add_u32_e64 v236, s25, v236
    s_add_u32 s26, s3, 9437184
    buffer_load_dwordx4 v[216:219], v236, s[16:19], s26 offen sc1
    s_add_u32 s26, s26, 524288
    buffer_load_dwordx4 v[220:223], v236, s[16:19], s26 offen sc1
    s_add_u32 s26, s26, 524288
    buffer_load_dwordx4 v[224:227], v236, s[16:19], s26 offen sc1
    s_add_u32 s26, s26, 524288
    buffer_load_dwordx4 v[228:231], v236, s[16:19], s26 offen sc1
    s_add_u32 s26, s26, 524288
    buffer_load_dwordx4 v[232:235], v236, s[16:19], s26 offen sc1
    s_lshl_b32 s25, s72, 5
    s_add_u32 s25, s25, 0
    s_sub_u32 s26, s25, 4
    s_max_i32 s26, s26, 0
    s_lshl_b32 s27, s71, 12
    s_add_u32 s27, s27, 9437184
    s_lshl_b32 s99, s25, 3
    s_lshl_b32 s100, s26, 3
    s_lshl_b32 s92, s24, 12
    s_lshl_b32 s93, s24, 9
    s_add_u32 s99, s99, s27
    s_add_u32 s100, s100, s27
    s_add_u32 m0, s92, 36352
    s_nop 0
    buffer_load_dwordx4 v73, s[16:19], s99 offen offset:0 sc1 lds
    buffer_load_dwordx4 v74, s[16:19], s99 offen offset:1024 sc1 lds
    buffer_load_dwordx4 v75, s[16:19], s99 offen offset:2048 sc1 lds
    buffer_load_dwordx4 v76, s[16:19], s99 offen offset:3072 sc1 lds
    s_add_u32 m0, s93, 53760
    s_add_u32 s99, s99, 524288
    s_mov_b64 exec, s[80:81]
    buffer_load_dwordx4 v77, s[16:19], s100 offen sc1 lds
    s_mov_b64 exec, -1
    s_add_u32 s100, s100, 524288
    s_add_u32 m0, s92, 55936
    s_nop 0
    s_nop 0
    buffer_load_dwordx4 v73, s[16:19], s99 offen offset:0 sc1 lds
    buffer_load_dwordx4 v74, s[16:19], s99 offen offset:1024 sc1 lds
    buffer_load_dwordx4 v75, s[16:19], s99 offen offset:2048 sc1 lds
    buffer_load_dwordx4 v76, s[16:19], s99 offen offset:3072 sc1 lds
    s_add_u32 m0, s93, 73344
    s_add_u32 s99, s99, 524288
    s_mov_b64 exec, s[80:81]
    buffer_load_dwordx4 v77, s[16:19], s100 offen sc1 lds
    s_mov_b64 exec, -1
    s_add_u32 s100, s100, 524288
    s_sub_u32 s85, s2, 160
    s_cmp_ge_u32 s85, 64
    s_cbranch_scc1 s2_47
    v_mov_b32 v238, 0x3f803f80
    s_lshl_b32 s25, s24, 7
    s_add_u32 s25, s25, 134272
    v_lshrrev_b32 v239, 4, v1
    v_lshl_add_u32 v237, v239, 2, v237
    v_add_u32 v237, s25, v237
se_48:
    v_mov_b32 v240, 0
    v_mov_b32 v241, 0
    v_mov_b32 v242, 0
    v_mov_b32 v243, 0
    s_waitcnt vmcnt(14)
    v_dot2c_f32_bf16 v240, v216, v238
    v_dot2c_f32_bf16 v241, v216, v216
    v_dot2c_f32_bf16 v240, v217, v238
    v_dot2c_f32_bf16 v241, v217, v217
    v_dot2c_f32_bf16 v242, v218, v238
    v_dot2c_f32_bf16 v243, v218, v218
    v_dot2c_f32_bf16 v242, v219, v238
    v_dot2c_f32_bf16 v243, v219, v219
    s_waitcnt vmcnt(13)
    v_dot2c_f32_bf16 v240, v220, v238
    v_dot2c_f32_bf16 v241, v220, v220
    v_dot2c_f32_bf16 v240, v221, v238
    v_dot2c_f32_bf16 v241, v221, v221
    v_dot2c_f32_bf16 v242, v222, v238
    v_dot2c_f32_bf16 v243, v222, v222
    v_dot2c_f32_bf16 v242, v223, v238
    v_dot2c_f32_bf16 v243, v223, v223
    s_waitcnt vmcnt(12)
    v_dot2c_f32_bf16 v240, v224, v238
    v_dot2c_f32_bf16 v241, v224, v224
    v_dot2c_f32_bf16 v240, v225, v238
    v_dot2c_f32_bf16 v241, v225, v225
    v_dot2c_f32_bf16 v242, v226, v238
    v_dot2c_f32_bf16 v243, v226, v226
    v_dot2c_f32_bf16 v242, v227, v238
    v_dot2c_f32_bf16 v243, v227, v227
    s_waitcnt vmcnt(11)
    v_dot2c_f32_bf16 v240, v228, v238
    v_dot2c_f32_bf16 v241, v228, v228
    v_dot2c_f32_bf16 v240, v229, v238
    v_dot2c_f32_bf16 v241, v229, v229
    v_dot2c_f32_bf16 v242, v230, v238
    v_dot2c_f32_bf16 v243, v230, v230
    v_dot2c_f32_bf16 v242, v231, v238
    v_dot2c_f32_bf16 v243, v231, v231
    s_waitcnt vmcnt(10)
    v_dot2c_f32_bf16 v240, v232, v238
    v_dot2c_f32_bf16 v241, v232, v232
    v_dot2c_f32_bf16 v240, v233, v238
    v_dot2c_f32_bf16 v241, v233, v233
    v_dot2c_f32_bf16 v242, v234, v238
    v_dot2c_f32_bf16 v243, v234, v234
    v_dot2c_f32_bf16 v242, v235, v238
    v_dot2c_f32_bf16 v243, v235, v235
    s_nop 2
    v_cmp_u_f32 vcc, v241, v243
    s_nop 0
    s_cbranch_vccnz rd_49
rc_50:
    v_permlane32_swap_b32 v240, v242
    v_permlane32_swap_b32 v241, v243
    v_pk_add_f32 v[240:241], v[240:241], v[242:243]
    s_nop 1
    v_permlane16_swap_b32 v240, v241
    v_add_f32 v240, v240, v241
    s_nop 1
    v_add_f32_dpp v240, v240, v240 row_ror:8 row_mask:0xf bank_mask:0xf
    ds_write_b32 v237, v240
    v_and_b32 v236, 15, v0
    v_lshlrev_b32 v236, 3, v236
    v_add_u32 v237, 134272, v236
    v_mov_b32 v239, 1073741824
    v_cmp_gt_u32 vcc, 16, v0
    s_nop 1
    v_cndmask_b32 v236, v239, v236, vcc
    s_add_u32 s25, s3, 3457024
    s_waitcnt lgkmcnt(0)
    s_barrier
    ds_read_b64 v[216:217], v237 offset:0
    ds_read_b64 v[218:219], v237 offset:128
    ds_read_b64 v[220:221], v237 offset:256
    ds_read_b64 v[222:223], v237 offset:384
    s_waitcnt lgkmcnt(2)
    v_pk_add_f32 v[216:217], v[216:217], v[218:219]
    s_waitcnt lgkmcnt(0)
    v_pk_add_f32 v[220:221], v[220:221], v[222:223]
    v_pk_add_f32 v[216:217], v[216:217], v[220:221]
    v_mul_f32 v239, 0x3acccccd, v216
    v_mul_f32 v217, 0x3acccccd, v217
    v_fma_f32 v217, -v239, v239, v217
    v_max_f32 v217, 0, v217
    v_add_f32 v217, 0x3727c5ac, v217
    v_rsq_f32_e64 v216, v217
    s_nop 0
    v_mul_f32 v217, -v239, v216
    buffer_store_dwordx2 v[216:217], v236, s[16:19], s25 offen sc1
s2_47:
ec_27:
ge_51:
    v_add_u32 v196, 36352, v78
    v_mov_b32_e64 v198, v79
    s_waitcnt vmcnt(5)
    s_barrier
    ds_read_b64 v[160:161], v198 offset:0
    ds_read_b64 v[162:163], v198 offset:64
    ds_read_b64 v[164:165], v196 offset:0
    ds_read_b64 v[166:167], v196 offset:512
    ds_read_b64 v[168:169], v196 offset:256
    ds_read_b64 v[170:171], v196 offset:768
    ds_read_b64 v[172:173], v198 offset:256
    ds_read_b64 v[174:175], v198 offset:320
    ds_read_b64 v[176:177], v196 offset:2048
    ds_read_b64 v[178:179], v196 offset:2560
    ds_read_b64 v[180:181], v196 offset:2304
    ds_read_b64 v[182:183], v196 offset:2816
    s_waitcnt lgkmcnt(6)
    v_mfma_f32_16x16x32_bf16 v[112:115], a[0:3], v[160:163], 0
    ds_read_b64 v[184:185], v198 offset:512
    v_mfma_f32_32x32x16_bf16 v[80:95], a[0:3], v[164:167], 0
    ds_read_b64 v[186:187], v198 offset:576
    ds_read_b64 v[188:189], v196 offset:4096
    ds_read_b64 v[190:191], v196 offset:4608
    v_mov_b32 v208, 0
    v_mov_b32_e64 v209, 0
    v_mfma_f32_32x32x16_bf16 v[96:111], a[0:3], v[168:171], 0
    ds_read_b64 v[192:193], v196 offset:4352
    ds_read_b64 v[194:195], v196 offset:4864
    s_add_u32 m0, s92, 75520
    s_nop 0
    buffer_load_dwordx4 v73, s[16:19], s99 offen offset:0 sc1 lds
    s_waitcnt lgkmcnt(6)
    v_mfma_f32_16x16x32_bf16 v[112:115], a[4:7], v[172:175], v[112:115]
    ds_read_b64 v[160:161], v198 offset:768
    v_mfma_f32_32x32x16_bf16 v[80:95], a[4:7], v[176:179], v[80:95]
    ds_read_b64 v[162:163], v198 offset:832
    ds_read_b64 v[164:165], v196 offset:6144
    ds_read_b64 v[166:167], v196 offset:6656
    v_lshrrev_b32_e64 v210, 5, v0
    v_mul_u32_u24 v210, 1600, v210
    v_mfma_f32_32x32x16_bf16 v[96:111], a[4:7], v[180:183], v[96:111]
    ds_read_b64 v[168:169], v196 offset:6400
    ds_read_b64 v[170:171], v196 offset:6912
    buffer_load_dwordx4 v74, s[16:19], s99 offen offset:1024 sc1 lds
    v_and_b32 v211, 31, v0
    s_waitcnt lgkmcnt(6)
    v_mfma_f32_16x16x32_bf16 v[112:115], a[8:11], v[184:187], v[112:115]
    ds_read_b64 v[172:173], v198 offset:1024
    v_mfma_f32_32x32x16_bf16 v[80:95], a[8:11], v[188:191], v[80:95]
    ds_read_b64 v[174:175], v198 offset:1088
    ds_read_b64 v[176:177], v196 offset:8192
    ds_read_b64 v[178:179], v196 offset:8704
    v_min_u32_e64 v211, 19, v211
    v_lshl_add_u32 v210, v211, 3, v210
    v_mfma_f32_32x32x16_bf16 v[96:111], a[8:11], v[192:195], v[96:111]
    ds_read_b64 v[180:181], v196 offset:8448
    ds_read_b64 v[182:183], v196 offset:8960
    buffer_load_dwordx4 v75, s[16:19], s99 offen offset:2048 sc1 lds
    v_add_u32 v210, 6400, v210
    s_waitcnt lgkmcnt(6)
    v_mfma_f32_16x16x32_bf16 v[112:115], a[12:15], v[160:163], v[112:115]
    ds_read_b64 v[184:185], v198 offset:1280
    v_mfma_f32_32x32x16_bf16 v[80:95], a[12:15], v[164:167], v[80:95]
    ds_read_b64 v[186:187], v198 offset:1344
    ds_read_b64 v[188:189], v196 offset:10240
    ds_read_b64 v[190:191], v196 offset:10752
    ds_write_b64 v210, v[208:209]
    v_mfma_f32_32x32x16_bf16 v[96:111], a[12:15], v[168:171], v[96:111]
    ds_read_b64 v[192:193], v196 offset:10496
    ds_read_b64 v[194:195], v196 offset:11008
    buffer_load_dwordx4 v76, s[16:19], s99 offen offset:3072 sc1 lds
    s_waitcnt lgkmcnt(7)
    v_mfma_f32_16x16x32_bf16 v[112:115], a[16:19], v[172:175], v[112:115]
    ds_read_b64 v[160:161], v198 offset:1536
    v_mfma_f32_32x32x16_bf16 v[80:95], a[16:19], v[176:179], v[80:95]
    ds_read_b64 v[162:163], v198 offset:1600
    ds_read_b64 v[164:165], v196 offset:12288
    ds_read_b64 v[166:167], v196 offset:12800
    v_mfma_f32_32x32x16_bf16 v[96:111], a[16:19], v[180:183], v[96:111]
    ds_read_b64 v[168:169], v196 offset:12544
    ds_read_b64 v[170:171], v196 offset:13056
    s_add_u32 m0, s93, 92928
    s_add_u32 s99, s99, 524288
    s_mov_b64 exec, s[80:81]
    buffer_load_dwordx4 v77, s[16:19], s100 offen sc1 lds
    s_mov_b64 exec, -1
    s_add_u32 s100, s100, 524288
    s_waitcnt lgkmcnt(6)
    v_mfma_f32_16x16x32_bf16 v[112:115], a[20:23], v[184:187], v[112:115]
    ds_read_b64 v[172:173], v198 offset:1792
    v_mfma_f32_32x32x16_bf16 v[80:95], a[20:23], v[188:191], v[80:95]
    ds_read_b64 v[174:175], v198 offset:1856
    ds_read_b64 v[176:177], v196 offset:14336
    ds_read_b64 v[178:179], v196 offset:14848
    v_mfma_f32_32x32x16_bf16 v[96:111], a[20:23], v[192:195], v[96:111]
    ds_read_b64 v[180:181], v196 offset:14592
    ds_read_b64 v[182:183], v196 offset:15104
    buffer_load_dword v7, v4, s[16:19], s87 offen offset:12 sc1
    v_cmp_eq_u32 vcc, 19, v5
    s_nop 0
    s_cbranch_vccnz gl_52
gc_53:
    s_waitcnt vmcnt(6)
    s_barrier
    s_waitcnt lgkmcnt(6)
    v_mfma_f32_16x16x32_bf16 v[112:115], a[24:27], v[160:163], v[112:115]
    v_add_u32 v198, v49, v198
    v_mfma_f32_32x32x16_bf16 v[80:95], a[24:27], v[164:167], v[80:95]
    v_add_u32 v196, 19584, v196
    ds_read_b64 v[184:185], v198 offset:0
    ds_read_b64 v[186:187], v198 offset:64
    ds_read_b64 v[188:189], v196 offset:0
    v_mfma_f32_32x32x16_bf16 v[96:111], a[24:27], v[168:171], v[96:111]
    ds_read_b64 v[190:191], v196 offset:512
    ds_read_b64 v[192:193], v196 offset:256
    ds_read_b64 v[194:195], v196 offset:768
    s_add_u32 m0, s92, 95104
    s_nop 0
    buffer_load_dwordx4 v73, s[16:19], s99 offen offset:0 sc1 lds
    s_waitcnt lgkmcnt(6)
    v_mfma_f32_16x16x32_bf16 v[112:115], a[28:31], v[172:175], v[112:115]
    ds_read_b64 v[160:161], v198 offset:256
    v_mfma_f32_32x32x16_bf16 v[80:95], a[28:31], v[176:179], v[80:95]
    ds_read_b64 v[162:163], v198 offset:320
    ds_read_b64 v[164:165], v196 offset:2048
    ds_read_b64 v[166:167], v196 offset:2560
    v_mfma_f32_32x32x16_bf16 v[96:111], a[28:31], v[180:183], v[96:111]
    ds_read_b64 v[168:169], v196 offset:2304
    ds_read_b64 v[170:171], v196 offset:2816
    buffer_load_dwordx4 v74, s[16:19], s99 offen offset:1024 sc1 lds
    s_waitcnt lgkmcnt(6)
    v_mfma_f32_16x16x32_bf16 v[112:115], a[32:35], v[184:187], v[112:115]
    ds_read_b64 v[172:173], v198 offset:512
    v_mfma_f32_32x32x16_bf16 v[80:95], a[32:35], v[188:191], v[80:95]
    ds_read_b64 v[174:175], v198 offset:576
    ds_read_b64 v[176:177], v196 offset:4096
    ds_read_b64 v[178:179], v196 offset:4608
    v_mfma_f32_32x32x16_bf16 v[96:111], a[32:35], v[192:195], v[96:111]
    ds_read_b64 v[180:181], v196 offset:4352
    ds_read_b64 v[182:183], v196 offset:4864
    buffer_load_dwordx4 v75, s[16:19], s99 offen offset:2048 sc1 lds
    s_waitcnt lgkmcnt(6)
    v_mfma_f32_16x16x32_bf16 v[112:115], a[36:39], v[160:163], v[112:115]
    ds_read_b64 v[184:185], v198 offset:768
    v_mfma_f32_32x32x16_bf16 v[80:95], a[36:39], v[164:167], v[80:95]
    ds_read_b64 v[186:187], v198 offset:832
    ds_read_b64 v[188:189], v196 offset:6144
    ds_read_b64 v[190:191], v196 offset:6656
    v_mfma_f32_32x32x16_bf16 v[96:111], a[36:39], v[168:171], v[96:111]
    ds_read_b64 v[192:193], v196 offset:6400
    ds_read_b64 v[194:195], v196 offset:6912
    buffer_load_dwordx4 v76, s[16:19], s99 offen offset:3072 sc1 lds
    s_waitcnt lgkmcnt(6)
    v_mfma_f32_16x16x32_bf16 v[112:115], a[40:43], v[172:175], v[112:115]
    ds_read_b64 v[160:161], v198 offset:1024
    v_mfma_f32_32x32x16_bf16 v[80:95], a[40:43], v[176:179], v[80:95]
    ds_read_b64 v[162:163], v198 offset:1088
    ds_read_b64 v[164:165], v196 offset:8192
    ds_read_b64 v[166:167], v196 offset:8704
    v_mfma_f32_32x32x16_bf16 v[96:111], a[40:43], v[180:183], v[96:111]
    ds_read_b64 v[168:169], v196 offset:8448
    ds_read_b64 v[170:171], v196 offset:8960
    s_add_u32 m0, s93, 112512
    s_add_u32 s99, s99, 524288
    s_mov_b64 exec, s[80:81]
    buffer_load_dwordx4 v77, s[16:19], s100 offen sc1 lds
    s_mov_b64 exec, -1
    s_add_u32 s100, s100, 524288
    s_waitcnt lgkmcnt(6)
    v_mfma_f32_16x16x32_bf16 v[112:115], a[44:47], v[184:187], v[112:115]
    ds_read_b64 v[172:173], v198 offset:1280
    v_mfma_f32_32x32x16_bf16 v[80:95], a[44:47], v[188:191], v[80:95]
    ds_read_b64 v[174:175], v198 offset:1344
    ds_read_b64 v[176:177], v196 offset:10240
    ds_read_b64 v[178:179], v196 offset:10752
    v_mfma_f32_32x32x16_bf16 v[96:111], a[44:47], v[192:195], v[96:111]
    ds_read_b64 v[180:181], v196 offset:10496
    ds_read_b64 v[182:183], v196 offset:11008
    s_add_u32 m0, s92, 114688
    s_nop 0
    buffer_load_dwordx4 v73, s[16:19], s99 offen offset:0 sc1 lds
    s_waitcnt lgkmcnt(6)
    v_mfma_f32_16x16x32_bf16 v[112:115], a[48:51], v[160:163], v[112:115]
    ds_read_b64 v[184:185], v198 offset:1536
    v_mfma_f32_32x32x16_bf16 v[80:95], a[48:51], v[164:167], v[80:95]
    ds_read_b64 v[186:187], v198 offset:1600
    ds_read_b64 v[188:189], v196 offset:12288
    ds_read_b64 v[190:191], v196 offset:12800
    v_mfma_f32_32x32x16_bf16 v[96:111], a[48:51], v[168:171], v[96:111]
    ds_read_b64 v[192:193], v196 offset:12544
    ds_read_b64 v[194:195], v196 offset:13056
    buffer_load_dwordx4 v74, s[16:19], s99 offen offset:1024 sc1 lds
    s_waitcnt lgkmcnt(6)
    v_mfma_f32_16x16x32_bf16 v[112:115], a[52:55], v[172:175], v[112:115]
    ds_read_b64 v[160:161], v198 offset:1792
    v_mfma_f32_32x32x16_bf16 v[80:95], a[52:55], v[176:179], v[80:95]
    ds_read_b64 v[162:163], v198 offset:1856
    ds_read_b64 v[164:165], v196 offset:14336
    ds_read_b64 v[166:167], v196 offset:14848
    v_mfma_f32_32x32x16_bf16 v[96:111], a[52:55], v[180:183], v[96:111]
    ds_read_b64 v[168:169], v196 offset:14592
    ds_read_b64 v[170:171], v196 offset:15104
    buffer_load_dwordx4 v75, s[16:19], s99 offen offset:2048 sc1 lds
    s_waitcnt vmcnt(8)
    v_cmp_gt_u32 vcc, 1, v7
    s_nop 0
    s_and_b64 vcc, vcc, s[50:51]
    s_cbranch_scc1 ps_54
pc_56:
    s_barrier
    s_waitcnt lgkmcnt(6)
    v_mfma_f32_16x16x32_bf16 v[112:115], a[56:59], v[184:187], v[112:115]
    v_add_u32_e64 v198, v49, v198
    v_mfma_f32_32x32x16_bf16 v[80:95], a[56:59], v[188:191], v[80:95]
    v_add_u32 v196, 19584, v196
    ds_read_b64 v[172:173], v198 offset:0
    ds_read_b64 v[174:175], v198 offset:64
    ds_read_b64 v[176:177], v196 offset:0
    v_mfma_f32_32x32x16_bf16 v[96:111], a[56:59], v[192:195], v[96:111]
    ds_read_b64 v[178:179], v196 offset:512
    ds_read_b64 v[180:181], v196 offset:256
    ds_read_b64 v[182:183], v196 offset:768
    buffer_load_dwordx4 v76, s[16:19], s99 offen offset:3072 sc1 lds
    s_waitcnt lgkmcnt(6)
    v_mfma_f32_16x16x32_bf16 v[112:115], a[60:63], v[160:163], v[112:115]
    ds_read_b64 v[184:185], v198 offset:256
    v_mfma_f32_32x32x16_bf16 v[80:95], a[60:63], v[164:167], v[80:95]
    ds_read_b64 v[186:187], v198 offset:320
    ds_read_b64 v[188:189], v196 offset:2048
    ds_read_b64 v[190:191], v196 offset:2560
    v_mfma_f32_32x32x16_bf16 v[96:111], a[60:63], v[168:171], v[96:111]
    ds_read_b64 v[192:193], v196 offset:2304
    ds_read_b64 v[194:195], v196 offset:2816
    s_add_u32 m0, s93, 132096
    s_add_u32 s99, s99, 524288
    s_mov_b64 exec, s[80:81]
    buffer_load_dwordx4 v77, s[16:19], s100 offen sc1 lds
    s_mov_b64 exec, -1
    s_add_u32 s100, s100, 524288
    s_waitcnt lgkmcnt(6)
    v_mfma_f32_16x16x32_bf16 v[112:115], a[64:67], v[172:175], v[112:115]
    ds_read_b64 v[160:161], v198 offset:512
    v_mfma_f32_32x32x16_bf16 v[80:95], a[64:67], v[176:179], v[80:95]
    ds_read_b64 v[162:163], v198 offset:576
    ds_read_b64 v[164:165], v196 offset:4096
    ds_read_b64 v[166:167], v196 offset:4608
    v_mfma_f32_32x32x16_bf16 v[96:111], a[64:67], v[180:183], v[96:111]
    ds_read_b64 v[168:169], v196 offset:4352
    ds_read_b64 v[170:171], v196 offset:4864
    s_lshl_b32 s25, s72, 5
    s_add_u32 s25, s25, 256
    s_sub_u32 s26, s25, 4
    s_max_i32 s26, s26, 0
    s_lshl_b32 s27, s71, 12
    s_add_u32 s27, s27, 9437184
    s_lshl_b32 s99, s25, 3
    s_lshl_b32 s100, s26, 3
    s_lshl_b32 s92, s24, 12
    s_lshl_b32 s93, s24, 9
    s_add_u32 s99, s99, s27
    s_add_u32 s100, s100, s27
    s_waitcnt lgkmcnt(6)
    v_mfma_f32_16x16x32_bf16 v[112:115], a[68:71], v[184:187], v[112:115]
    ds_read_b64 v[172:173], v198 offset:768
    v_mfma_f32_32x32x16_bf16 v[80:95], a[68:71], v[188:191], v[80:95]
    ds_read_b64 v[174:175], v198 offset:832
    ds_read_b64 v[176:177], v196 offset:6144
    ds_read_b64 v[178:179], v196 offset:6656
    v_mfma_f32_32x32x16_bf16 v[96:111], a[68:71], v[192:195], v[96:111]
    ds_read_b64 v[180:181], v196 offset:6400
    ds_read_b64 v[182:183], v196 offset:6912
    s_waitcnt lgkmcnt(6)
    v_mfma_f32_16x16x32_bf16 v[112:115], a[72:75], v[160:163], v[112:115]
    ds_read_b64 v[184:185], v198 offset:1024
    v_mfma_f32_32x32x16_bf16 v[80:95], a[72:75], v[164:167], v[80:95]
    ds_read_b64 v[186:187], v198 offset:1088
    ds_read_b64 v[188:189], v196 offset:8192
    ds_read_b64 v[190:191], v196 offset:8704
    v_mfma_f32_32x32x16_bf16 v[96:111], a[72:75], v[168:171], v[96:111]
    ds_read_b64 v[192:193], v196 offset:8448
    ds_read_b64 v[194:195], v196 offset:8960
    s_waitcnt lgkmcnt(6)
    v_mfma_f32_16x16x32_bf16 v[112:115], a[76:79], v[172:175], v[112:115]
    ds_read_b64 v[160:161], v198 offset:1280
    v_mfma_f32_32x32x16_bf16 v[80:95], a[76:79], v[176:179], v[80:95]
    ds_read_b64 v[162:163], v198 offset:1344
    ds_read_b64 v[164:165], v196 offset:10240
    ds_read_b64 v[166:167], v196 offset:10752
    v_mfma_f32_32x32x16_bf16 v[96:111], a[76:79], v[180:183], v[96:111]
    ds_read_b64 v[168:169], v196 offset:10496
    ds_read_b64 v[170:171], v196 offset:11008
    s_waitcnt lgkmcnt(6)
    v_mfma_f32_16x16x32_bf16 v[112:115], a[80:83], v[184:187], v[112:115]
    ds_read_b64 v[172:173], v198 offset:1536
    v_mfma_f32_32x32x16_bf16 v[80:95], a[80:83], v[188:191], v[80:95]
    ds_read_b64 v[174:175], v198 offset:1600
    ds_read_b64 v[176:177], v196 offset:12288
    ds_read_b64 v[178:179], v196 offset:12800
    v_mfma_f32_32x32x16_bf16 v[96:111], a[80:83], v[192:195], v[96:111]
    ds_read_b64 v[180:181], v196 offset:12544
    ds_read_b64 v[182:183], v196 offset:13056
    s_lshl_b32 s98, s72, 5
    s_add_u32 s98, s98, 0
    s_sub_u32 s95, s98, 4
    s_max_i32 s95, s95, 0
    s_lshl_b32 s94, s98, 3
    s_lshl_b32 s95, s95, 3
    s_add_u32 s94, s94, 3457024
    s_add_u32 s95, s95, 3457024
    s_add_u32 s96, s94, 8192
    buffer_load_dwordx2 v[152:153], v47, s[16:19], s94 offen sc1
    s_waitcnt lgkmcnt(6)
    v_mfma_f32_16x16x32_bf16 v[112:115], a[84:87], v[160:163], v[112:115]
    ds_read_b64 v[184:185], v198 offset:1792
    v_mfma_f32_32x32x16_bf16 v[80:95], a[84:87], v[164:167], v[80:95]
    ds_read_b64 v[186:187], v198 offset:1856
    ds_read_b64 v[188:189], v196 offset:14336
    ds_read_b64 v[190:191], v196 offset:14848
    v_mfma_f32_32x32x16_bf16 v[96:111], a[84:87], v[168:171], v[96:111]
    ds_read_b64 v[192:193], v196 offset:14592
    ds_read_b64 v[194:195], v196 offset:15104
    buffer_load_dwordx2 v[154:155], v47, s[16:19], s96 offen sc1
    s_waitcnt vmcnt(7)
    s_barrier
    s_waitcnt lgkmcnt(6)
    v_mfma_f32_16x16x32_bf16 v[112:115], a[88:91], v[172:175], v[112:115]
    v_add_u32_e64 v198, v49, v198
    v_mfma_f32_32x32x16_bf16 v[80:95], a[88:91], v[176:179], v[80:95]
    v_add_u32 v196, 19584, v196
    ds_read_b64 v[160:161], v198 offset:0
    ds_read_b64 v[162:163], v198 offset:64
    ds_read_b64 v[164:165], v196 offset:0
    v_mfma_f32_32x32x16_bf16 v[96:111], a[88:91], v[180:183], v[96:111]
    ds_read_b64 v[166:167], v196 offset:512
    ds_read_b64 v[168:169], v196 offset:256
    ds_read_b64 v[170:171], v196 offset:768
    buffer_load_dwordx2 v[156:157], v48, s[16:19], s95 offen sc1
    s_waitcnt lgkmcnt(6)
    v_mfma_f32_16x16x32_bf16 v[112:115], a[92:95], v[184:187], v[112:115]
    ds_read_b64 v[172:173], v198 offset:256
    v_mfma_f32_32x32x16_bf16 v[80:95], a[92:95], v[188:191], v[80:95]
    ds_read_b64 v[174:175], v198 offset:320
    ds_read_b64 v[176:177], v196 offset:2048
    ds_read_b64 v[178:179], v196 offset:2560
    v_mfma_f32_32x32x16_bf16 v[96:111], a[92:95], v[192:195], v[96:111]
    ds_read_b64 v[180:181], v196 offset:2304
    ds_read_b64 v[182:183], v196 offset:2816
    buffer_load_dword v7, v4, s[16:19], s89 offen offset:4 sc1
    s_waitcnt lgkmcnt(6)
    v_mfma_f32_16x16x32_bf16 v[112:115], a[96:99], v[160:163], v[112:115]
    ds_read_b64 v[184:185], v198 offset:512
    v_mfma_f32_32x32x16_bf16 v[80:95], a[96:99], v[164:167], v[80:95]
    ds_read_b64 v[186:187], v198 offset:576
    ds_read_b64 v[188:189], v196 offset:4096
    ds_read_b64 v[190:191], v196 offset:4608
    v_mfma_f32_32x32x16_bf16 v[96:111], a[96:99], v[168:171], v[96:111]
    ds_read_b64 v[192:193], v196 offset:4352
    ds_read_b64 v[194:195], v196 offset:4864
    s_waitcnt lgkmcnt(6)
    v_mfma_f32_16x16x32_bf16 v[112:115], a[100:103], v[172:175], v[112:115]
    ds_read_b64 v[160:161], v198 offset:768
    v_mfma_f32_32x32x16_bf16 v[80:95], a[100:103], v[176:179], v[80:95]
    ds_read_b64 v[162:163], v198 offset:832
    ds_read_b64 v[164:165], v196 offset:6144
    ds_read_b64 v[166:167], v196 offset:6656
    v_mfma_f32_32x32x16_bf16 v[96:111], a[100:103], v[180:183], v[96:111]
    ds_read_b64 v[168:169], v196 offset:6400
    ds_read_b64 v[170:171], v196 offset:6912
    s_waitcnt lgkmcnt(6)
    v_mfma_f32_16x16x32_bf16 v[112:115], a[104:107], v[184:187], v[112:115]
    ds_read_b64 v[172:173], v198 offset:1024
    v_mfma_f32_32x32x16_bf16 v[80:95], a[104:107], v[188:191], v[80:95]
    ds_read_b64 v[174:175], v198 offset:1088
    ds_read_b64 v[176:177], v196 offset:8192
    ds_read_b64 v[178:179], v196 offset:8704
    v_mfma_f32_32x32x16_bf16 v[96:111], a[104:107], v[192:195], v[96:111]
    ds_read_b64 v[180:181], v196 offset:8448
    ds_read_b64 v[182:183], v196 offset:8960
    s_waitcnt lgkmcnt(6)
    v_mfma_f32_16x16x32_bf16 v[112:115], a[108:111], v[160:163], v[112:115]
    ds_read_b64 v[184:185], v198 offset:1280
    v_mfma_f32_32x32x16_bf16 v[80:95], a[108:111], v[164:167], v[80:95]
    ds_read_b64 v[186:187], v198 offset:1344
    ds_read_b64 v[188:189], v196 offset:10240
    ds_read_b64 v[190:191], v196 offset:10752
    v_mfma_f32_32x32x16_bf16 v[96:111], a[108:111], v[168:171], v[96:111]
    ds_read_b64 v[192:193], v196 offset:10496
    ds_read_b64 v[194:195], v196 offset:11008
    s_waitcnt lgkmcnt(6)
    v_mfma_f32_16x16x32_bf16 v[112:115], a[112:115], v[172:175], v[112:115]
    ds_read_b64 v[160:161], v198 offset:1536
    v_mfma_f32_32x32x16_bf16 v[80:95], a[112:115], v[176:179], v[80:95]
    ds_read_b64 v[162:163], v198 offset:1600
    ds_read_b64 v[164:165], v196 offset:12288
    ds_read_b64 v[166:167], v196 offset:12800
    v_mfma_f32_32x32x16_bf16 v[96:111], a[112:115], v[180:183], v[96:111]
    ds_read_b64 v[168:169], v196 offset:12544
    ds_read_b64 v[170:171], v196 offset:13056
    s_waitcnt lgkmcnt(6)
    v_mfma_f32_16x16x32_bf16 v[112:115], a[116:119], v[184:187], v[112:115]
    ds_read_b64 v[172:173], v198 offset:1792
    v_mfma_f32_32x32x16_bf16 v[80:95], a[116:119], v[188:191], v[80:95]
    ds_read_b64 v[174:175], v198 offset:1856
    ds_read_b64 v[176:177], v196 offset:14336
    ds_read_b64 v[178:179], v196 offset:14848
    v_mfma_f32_32x32x16_bf16 v[96:111], a[116:119], v[192:195], v[96:111]
    ds_read_b64 v[180:181], v196 offset:14592
    ds_read_b64 v[182:183], v196 offset:15104
sl_57:
    s_waitcnt vmcnt(2)
    v_max3_u32 v2, v152, v153, v154
    s_waitcnt vmcnt(1)
    v_max3_u32 v2, v2, v155, v156
    v_max_u32 v2, v2, v157
    v_cmp_eq_u32 vcc, -1, v2
    s_nop 0
    s_cbranch_vccnz rd_58
rc_59:
    s_waitcnt vmcnt(0)
    v_cmp_gt_u32 vcc, 1, v7
    s_nop 0
    s_and_b64 vcc, vcc, s[50:51]
    s_cbranch_scc1 ps_60
pc_62:
    s_barrier
    s_waitcnt lgkmcnt(6)
    v_mfma_f32_16x16x32_bf16 v[112:115], a[120:123], v[160:163], v[112:115]
    v_add_u32_e64 v198, v49, v198
    v_mfma_f32_32x32x16_bf16 v[80:95], a[120:123], v[164:167], v[80:95]
    v_add_u32 v196, 19584, v196
    ds_read_b64 v[184:185], v198 offset:0
    ds_read_b64 v[186:187], v198 offset:64
    v_mul_f32 v148, v24, v157
    v_mul_f32 v149, v25, v157
    v_mfma_f32_32x32x16_bf16 v[96:111], a[120:123], v[168:171], v[96:111]
    ds_read_b64 v[188:189], v196 offset:0
    ds_read_b64 v[190:191], v196 offset:512
    s_sub_u32 s3, s2, 160
    s_and_b32 s3, s3, 63
    s_add_u32 s3, s3, 64
    s_and_b32 s25, s3, 3
    s_lshl_b32 s25, s25, 12
    s_lshr_b32 s26, s3, 2
    s_lshl_b32 s26, s26, 7
    s_add_u32 s3, s25, s26
    v_lshrrev_b32 v236, 3, v0
    v_and_b32 v237, 7, v0
    v_lshlrev_b32 v237, 4, v237
    v_lshl_add_u32 v236, v236, 14, v237
    s_sub_u32 s25, s2, 160
    s_cmp_lt_u32 s25, 64
    s_cselect_b32 s25, 0, 1073741824
    v_add_u32_e64 v236, s25, v236
    s_add_u32 s26, s3, 9437184
    buffer_load_dwordx4 v[216:219], v236, s[16:19], s26 offen sc1
    v_mul_f32 v150, v26, v157
    v_mul_f32_e64 v151, v27, v157
    s_waitcnt lgkmcnt(4)
    v_mfma_f32_16x16x32_bf16 v[112:115], a[124:127], v[172:175], v[112:115]
    ds_read_b64 v[192:193], v198 offset:256
    v_mfma_f32_32x32x16_bf16 v[80:95], a[124:127], v[176:179], v[80:95]
    ds_read_b64 v[194:195], v198 offset:320
    ds_read_b64 v[160:161], v196 offset:2048
    v_mul_f32 v116, v8, v153
    v_mul_f32 v117, v9, v153
    v_mul_f32_e64 v118, v10, v153
    v_mfma_f32_32x32x16_bf16 v[96:111], a[124:127], v[180:183], v[96:111]
    ds_read_b64 v[162:163], v196 offset:2560
    s_add_u32 s26, s26, 524288
    buffer_load_dwordx4 v[220:223], v236, s[16:19], s26 offen sc1
    v_mul_f32 v119, v11, v153
    v_mul_f32_e64 v120, v12, v153
    s_waitcnt lgkmcnt(4)
    v_mfma_f32_16x16x32_bf16 v[112:115], a[128:131], v[184:187], v[112:115]
    ds_read_b64 v[164:165], v198 offset:512
    v_mfma_f32_32x32x16_bf16 v[80:95], a[128:131], v[188:191], v[80:95]
    ds_read_b64 v[166:167], v198 offset:576
    ds_read_b64 v[168:169], v196 offset:4096
    ds_read_b64 v[170:171], v196 offset:4608
    v_mul_f32 v121, v13, v153
    v_mul_f32_e64 v122, v14, v153
    s_waitcnt lgkmcnt(4)
    v_mfma_f32_16x16x32_bf16 v[112:115], a[132:135], v[192:195], v[112:115]
    ds_read_b64 v[172:173], v198 offset:768
    v_mfma_f32_32x32x16_bf16 v[80:95], a[132:135], v[160:163], v[80:95]
    ds_read_b64 v[174:175], v198 offset:832
    ds_read_b64 v[176:177], v196 offset:6144
    ds_read_b64 v[178:179], v196 offset:6656
    s_add_u32 s26, s26, 524288
    buffer_load_dwordx4 v[224:227], v236, s[16:19], s26 offen sc1
    v_mul_f32 v123, v15, v153
    v_mul_f32_e64 v124, v16, v153
    s_waitcnt lgkmcnt(4)
    v_mfma_f32_16x16x32_bf16 v[112:115], a[136:139], v[164:167], v[112:115]
    ds_read_b64 v[180:181], v198 offset:1024
    v_mfma_f32_32x32x16_bf16 v[80:95], a[136:139], v[168:171], v[80:95]
    ds_read_b64 v[182:183], v198 offset:1088
    ds_read_b64 v[184:185], v196 offset:8192
    ds_read_b64 v[186:187], v196 offset:8704
    v_mul_f32 v125, v17, v153
    v_mul_f32_e64 v126, v18, v153
    s_waitcnt lgkmcnt(4)
    v_mfma_f32_16x16x32_bf16 v[112:115], a[140:143], v[172:175], v[112:115]
    ds_read_b64 v[188:189], v198 offset:1280
    v_mfma_f32_32x32x16_bf16 v[80:95], a[140:143], v[176:179], v[80:95]
    ds_read_b64 v[190:191], v198 offset:1344
    ds_read_b64 v[192:193], v196 offset:10240
    ds_read_b64 v[194:195], v196 offset:10752
    s_add_u32 s26, s26, 524288
    buffer_load_dwordx4 v[228:231], v236, s[16:19], s26 offen sc1
    v_mul_f32 v127, v19, v153
    v_mul_f32_e64 v128, v20, v153
    s_waitcnt lgkmcnt(4)
    v_mfma_f32_16x16x32_bf16 v[112:115], a[144:147], v[180:183], v[112:115]
    ds_read_b64 v[160:161], v198 offset:1536
    v_mfma_f32_32x32x16_bf16 v[80:95], a[144:147], v[184:187], v[80:95]
    ds_read_b64 v[162:163], v198 offset:1600
    ds_read_b64 v[164:165], v196 offset:12288
    ds_read_b64 v[166:167], v196 offset:12800
    v_mul_f32 v129, v21, v153
    v_mul_f32_e64 v130, v22, v153
    s_waitcnt lgkmcnt(4)
    v_mfma_f32_16x16x32_bf16 v[112:115], a[148:151], v[188:191], v[112:115]
    ds_read_b64 v[168:169], v198 offset:1792
    v_mfma_f32_32x32x16_bf16 v[80:95], a[148:151], v[192:195], v[80:95]
    ds_read_b64 v[170:171], v198 offset:1856
    ds_read_b64 v[172:173], v196 offset:14336
    ds_read_b64 v[174:175], v196 offset:14848
    s_add_u32 s26, s26, 524288
    buffer_load_dwordx4 v[232:235], v236, s[16:19], s26 offen sc1
    v_mul_f32 v131, v23, v153
    v_mul_f32_e64 v132, v8, v155
    s_waitcnt lgkmcnt(4)
    v_mfma_f32_16x16x32_bf16 v[112:115], a[152:155], v[160:163], v[112:115]
    ds_read_b64 v[176:177], v196 offset:256
    v_mfma_f32_32x32x16_bf16 v[80:95], a[152:155], v[164:167], v[80:95]
    ds_read_b64 v[178:179], v196 offset:768
    ds_read_b64 v[180:181], v196 offset:2304
    ds_read_b64 v[182:183], v196 offset:2816
    v_mul_f32 v133, v9, v155
    v_mul_f32_e64 v134, v10, v155
    s_waitcnt lgkmcnt(4)
    v_mfma_f32_16x16x32_bf16 v[112:115], a[156:159], v[168:171], v[112:115]
    ds_read_b64 v[184:185], v196 offset:4352
    v_mfma_f32_32x32x16_bf16 v[80:95], a[156:159], v[172:175], v[80:95]
    ds_read_b64 v[186:187], v196 offset:4864
    ds_read_b64 v[188:189], v196 offset:6400
    ds_read_b64 v[190:191], v196 offset:6912
    s_add_u32 m0, s92, 36352
    s_nop 0
    buffer_load_dwordx4 v73, s[16:19], s99 offen offset:0 sc1 lds
    v_mul_f32 v135, v11, v155
    v_mul_f32 v136, v12, v155
    v_mul_f32 v137, v13, v155
    v_mul_f32 v138, v14, v155
    v_mul_f32 v139, v15, v155
    v_mul_f32 v140, v16, v155
    v_mul_f32 v141, v17, v155
    v_mul_f32 v142, v18, v155
    v_mul_f32 v143, v19, v155
    v_mul_f32 v144, v20, v155
    v_mul_f32 v145, v21, v155
    v_mul_f32 v146, v22, v155
    v_mul_f32_e64 v147, v23, v155
    s_waitcnt lgkmcnt(4)
    v_mfma_f32_32x32x16_bf16 v[96:111], a[128:131], v[176:179], v[96:111]
    ds_read_b64 v[192:193], v196 offset:8448
    ds_read_b64 v[194:195], v196 offset:8960
    v_mfma_f32_32x32x16_bf16 v[96:111], a[132:135], v[180:183], v[96:111]
    ds_read_b64 v[160:161], v196 offset:10496
    ds_read_b64 v[162:163], v196 offset:11008
    buffer_load_dwordx4 v74, s[16:19], s99 offen offset:1024 sc1 lds
    v_fma_f32 v112, v112, v156, v148
    v_fma_f32 v113, v113, v156, v149
    s_waitcnt lgkmcnt(4)
    v_mfma_f32_32x32x16_bf16 v[96:111], a[136:139], v[184:187], v[96:111]
    ds_read_b64 v[164:165], v196 offset:12544
    ds_read_b64 v[166:167], v196 offset:13056
    v_fma_f32 v114, v114, v156, v150
    v_fma_f32 v115, v115, v156, v151
    v_cvt_pk_bf16_f32 v112, v112, v113
    v_mfma_f32_32x32x16_bf16 v[96:111], a[140:143], v[188:191], v[96:111]
    ds_read_b64 v[168:169], v196 offset:14592
    ds_read_b64 v[170:171], v196 offset:15104
    buffer_load_dwordx4 v75, s[16:19], s99 offen offset:2048 sc1 lds
    v_cvt_pk_bf16_f32 v113, v114, v115
    v_fma_f32 v80, v80, v152, v116
    s_waitcnt lgkmcnt(4)
    v_mfma_f32_32x32x16_bf16 v[96:111], a[144:147], v[192:195], v[96:111]
    v_fma_f32 v81, v81, v152, v117
    v_fma_f32 v82, v82, v152, v118
    v_fma_f32 v83, v83, v152, v119
    v_cvt_pk_bf16_f32 v80, v80, v81
    v_cvt_pk_bf16_f32 v81, v82, v83
    v_mfma_f32_32x32x16_bf16 v[96:111], a[148:151], v[160:163], v[96:111]
    ds_write_b64 v40, v[112:113] offset:0
    ds_write_b64 v38, v[80:81] offset:0
    v_fma_f32 v84, v84, v152, v120
    v_fma_f32 v85, v85, v152, v121
    s_waitcnt lgkmcnt(2)
    v_mfma_f32_32x32x16_bf16 v[96:111], a[152:155], v[164:167], v[96:111]
    v_fma_f32 v86, v86, v152, v122
    v_fma_f32 v87, v87, v152, v123
    v_cvt_pk_bf16_f32 v84, v84, v85
    v_cvt_pk_bf16_f32 v85, v86, v87
    v_fma_f32 v88, v88, v152, v124
    v_mfma_f32_32x32x16_bf16 v[96:111], a[156:159], v[168:171], v[96:111]
    buffer_load_dwordx4 v76, s[16:19], s99 offen offset:3072 sc1 lds
    v_fma_f32 v89, v89, v152, v125
    v_fma_f32 v90, v90, v152, v126
    v_fma_f32 v91, v91, v152, v127
    v_cvt_pk_bf16_f32 v88, v88, v89
    v_cvt_pk_bf16_f32 v89, v90, v91
    ds_write_b64 v38, v[84:85] offset:6400
    ds_write_b64 v38, v[88:89] offset:12800
    v_fma_f32 v92, v92, v152, v128
    v_fma_f32 v93, v93, v152, v129
    v_fma_f32 v94, v94, v152, v130
    v_fma_f32 v95, v95, v152, v131
    v_cvt_pk_bf16_f32 v92, v92, v93
    v_cvt_pk_bf16_f32 v93, v94, v95
    ds_write_b64 v39, v[92:93] offset:0
    v_pk_fma_f32 v[96:97], v[96:97], v[154:155], v[132:133] op_sel_hi:[1,0,1]
    v_pk_fma_f32 v[98:99], v[98:99], v[154:155], v[134:135] op_sel_hi:[1,0,1]
    v_cvt_pk_bf16_f32 v96, v96, v97
    v_cvt_pk_bf16_f32 v97, v98, v99
    v_pk_fma_f32 v[100:101], v[100:101], v[154:155], v[136:137] op_sel_hi:[1,0,1]
    v_pk_fma_f32 v[102:103], v[102:103], v[154:155], v[138:139] op_sel_hi:[1,0,1]
    v_cvt_pk_bf16_f32 v100, v100, v101
    v_cvt_pk_bf16_f32 v101, v102, v103
    ds_write_b64 v38, v[96:97] offset:1600
    ds_write_b64 v38, v[100:101] offset:8000
    v_pk_fma_f32 v[104:105], v[104:105], v[154:155], v[140:141] op_sel_hi:[1,0,1]
    v_pk_fma_f32 v[106:107], v[106:107], v[154:155], v[142:143] op_sel_hi:[1,0,1]
    v_cvt_pk_bf16_f32 v104, v104, v105
    v_cvt_pk_bf16_f32 v105, v106, v107
    v_pk_fma_f32 v[108:109], v[108:109], v[154:155], v[144:145] op_sel_hi:[1,0,1]
    v_pk_fma_f32 v[110:111], v[110:111], v[154:155], v[146:147] op_sel_hi:[1,0,1]
    v_cvt_pk_bf16_f32 v108, v108, v109
    v_cvt_pk_bf16_f32 v109, v110, v111
    ds_write_b64 v38, v[104:105] offset:14400
    ds_write_b64 v39, v[108:109] offset:1600
    v_cmp_u_f32 vcc, v82, v114
    v_cmp_u_f32 s[82:83], v98, v98
    s_lshl_b32 s25, s24, 2
    s_add_u32 s25, s25, 160256
    s_or_b64 vcc, vcc, s[82:83]
    s_cselect_b32 s26, 1, 0
    v_mov_b32 v196, s25
    v_mov_b32 v197, s26
    ds_write_b32 v196, v197
    s_waitcnt lgkmcnt(0)
    s_barrier
    s_sub_u32 s85, s2, 160
    s_cmp_ge_u32 s85, 64
    s_cbranch_scc1 s2_63
    v_mov_b32 v238, 0x3f803f80
    s_lshl_b32 s25, s24, 7
    s_add_u32 s25, s25, 134272
    v_lshrrev_b32 v239, 4, v1
    v_lshl_add_u32 v237, v239, 2, v237
    v_add_u32 v237, s25, v237
se_64:
    v_mov_b32 v240, 0
    v_mov_b32 v241, 0
    v_mov_b32 v242, 0
    v_mov_b32 v243, 0
    s_waitcnt vmcnt(8)
    v_dot2c_f32_bf16 v240, v216, v238
    v_dot2c_f32_bf16 v241, v216, v216
    v_dot2c_f32_bf16 v240, v217, v238
    v_dot2c_f32_bf16 v241, v217, v217
    v_dot2c_f32_bf16 v242, v218, v238
    v_dot2c_f32_bf16 v243, v218, v218
    v_dot2c_f32_bf16 v242, v219, v238
    v_dot2c_f32_bf16 v243, v219, v219
    s_waitcnt vmcnt(7)
    v_dot2c_f32_bf16 v240, v220, v238
    v_dot2c_f32_bf16 v241, v220, v220
    v_dot2c_f32_bf16 v240, v221, v238
    v_dot2c_f32_bf16 v241, v221, v221
    v_dot2c_f32_bf16 v242, v222, v238
    v_dot2c_f32_bf16 v243, v222, v222
    v_dot2c_f32_bf16 v242, v223, v238
    v_dot2c_f32_bf16 v243, v223, v223
    s_waitcnt vmcnt(6)
    v_dot2c_f32_bf16 v240, v224, v238
    v_dot2c_f32_bf16 v241, v224, v224
    v_dot2c_f32_bf16 v240, v225, v238
    v_dot2c_f32_bf16 v241, v225, v225
    v_dot2c_f32_bf16 v242, v226, v238
    v_dot2c_f32_bf16 v243, v226, v226
    v_dot2c_f32_bf16 v242, v227, v238
    v_dot2c_f32_bf16 v243, v227, v227
    s_waitcnt vmcnt(5)
    v_dot2c_f32_bf16 v240, v228, v238
    v_dot2c_f32_bf16 v241, v228, v228
    v_dot2c_f32_bf16 v240, v229, v238
    v_dot2c_f32_bf16 v241, v229, v229
    v_dot2c_f32_bf16 v242, v230, v238
    v_dot2c_f32_bf16 v243, v230, v230
    v_dot2c_f32_bf16 v242, v231, v238
    v_dot2c_f32_bf16 v243, v231, v231
    s_waitcnt vmcnt(4)
    v_dot2c_f32_bf16 v240, v232, v238
    v_dot2c_f32_bf16 v241, v232, v232
    v_dot2c_f32_bf16 v240, v233, v238
    v_dot2c_f32_bf16 v241, v233, v233
    v_dot2c_f32_bf16 v242, v234, v238
    v_dot2c_f32_bf16 v243, v234, v234
    v_dot2c_f32_bf16 v242, v235, v238
    v_dot2c_f32_bf16 v243, v235, v235
    s_nop 2
    v_cmp_u_f32 vcc, v241, v243
    s_nop 0
    s_cbranch_vccnz rd_65
rc_66:
    v_permlane32_swap_b32 v240, v242
    v_permlane32_swap_b32 v241, v243
    v_pk_add_f32 v[240:241], v[240:241], v[242:243]
    s_nop 1
    v_permlane16_swap_b32 v240, v241
    v_add_f32_e64 v240, v240, v241
    s_nop 1
    v_add_f32_dpp v240, v240, v240 row_ror:8 row_mask:0xf bank_mask:0xf
    ds_write_b32 v237, v240
    v_and_b32 v236, 15, v0
    v_lshlrev_b32 v236, 3, v236
    v_add_u32 v237, 134272, v236
    v_mov_b32 v239, 1073741824
    v_cmp_gt_u32 vcc, 16, v0
    s_nop 1
    v_cndmask_b32 v236, v239, v236, vcc
    s_add_u32 s25, s3, 3457024
    s_waitcnt lgkmcnt(0)
    s_barrier
    ds_read_b64 v[216:217], v237 offset:0
    ds_read_b64 v[218:219], v237 offset:128
    ds_read_b64 v[220:221], v237 offset:256
    ds_read_b64 v[222:223], v237 offset:384
    s_waitcnt lgkmcnt(2)
    v_pk_add_f32 v[216:217], v[216:217], v[218:219]
    s_waitcnt lgkmcnt(0)
    v_pk_add_f32 v[220:221], v[220:221], v[222:223]
    v_pk_add_f32 v[216:217], v[216:217], v[220:221]
    v_mul_f32 v239, 0x3acccccd, v216
    v_mul_f32 v217, 0x3acccccd, v217
    v_fma_f32 v217, -v239, v239, v217
    v_max_f32 v217, 0, v217
    v_add_f32 v217, 0x3727c5ac, v217
    v_rsq_f32_e64 v216, v217
    s_nop 0
    v_mul_f32 v217, -v239, v216
    buffer_store_dwordx2 v[216:217], v236, s[16:19], s25 offen sc1
s2_63:
    v_mov_b32 v158, 160256
    ds_read_b128 v[128:131], v158
    v_mov_b32 v94, 0
    v_mov_b32 v95, 0
    v_mov_b32 v98, 0
    v_mov_b32 v99, 0
    s_mov_b64 exec, 0xffff
    ds_read_b64 v[94:95], v42 offset:320
    ds_read_b64 v[98:99], v42 offset:640
    s_mov_b64 exec, -1
    s_nop 0
    ds_read_b64 v[92:93], v41 offset:320
    ds_read_b64 v[96:97], v41 offset:640
    ds_read_b64 v[84:85], v41 offset:6720
    ds_read_b64 v[86:87], v42 offset:6720
    ds_read_b64 v[80:81], v41 offset:6400
    ds_read_b64 v[82:83], v42 offset:6400
    ds_read_b64 v[88:89], v41 offset:7040
    ds_read_b64 v[90:91], v42 offset:7040
    ds_read_b64_tr_b16 v[106:107], v44 offset:0
    ds_read_b64_tr_b16 v[100:101], v43 offset:0
    s_add_u32 m0, s93, 53760
    s_add_u32 s99, s99, 524288
    s_mov_b64 exec, s[80:81]
    buffer_load_dwordx4 v77, s[16:19], s100 offen sc1 lds
    s_mov_b64 exec, -1
    s_add_u32 s100, s100, 524288
    ds_read_b64_tr_b16 v[108:109], v44 offset:320
    ds_read_b64_tr_b16 v[102:103], v43 offset:320
    ds_read_b64_tr_b16 v[110:111], v44 offset:640
    ds_read_b64_tr_b16 v[104:105], v43 offset:640
    v_mov_b32 v156, 0xf149f2ca
    v_cndmask_b32 v152, v32, v156, s[90:91]
    v_cndmask_b32 v153, v33, v156, s[90:91]
    v_cndmask_b32 v154, v34, v156, s[90:91]
    s_add_u32 m0, s92, 55936
    s_nop 0
    buffer_load_dwordx4 v73, s[16:19], s99 offen offset:0 sc1 lds
    v_cndmask_b32 v155, v35, v156, s[90:91]
    s_mov_b32 s82, 0x3ea52b5c
    s_lshl_b32 s25, s98, 4
    s_add_u32 s25, s25, 12058624
    s_lshl_b32 s26, s98, 3
    s_add_u32 s26, s26, 12058624
    s_waitcnt lgkmcnt(15)
    v_or3_b32 v128, v128, v129, v130
    v_or_b32 v128, v128, v131
    buffer_load_dwordx4 v74, s[16:19], s99 offen offset:1024 sc1 lds
    v_cmp_ne_u32_e64 vcc, 0, v128
    s_nop 0
    s_cbranch_vccnz rd_67
rc_68:
    s_waitcnt lgkmcnt(10)
    v_mfma_f32_16x16x32_bf16 v[116:119], v[84:87], v[92:95], v[28:31]
    v_mfma_f32_16x16x32_bf16 v[120:123], v[84:87], v[96:99], v[32:35]
    s_waitcnt lgkmcnt(8)
    v_mfma_f32_16x16x32_bf16 v[112:115], v[80:83], v[92:95], v[152:155]
    s_waitcnt lgkmcnt(6)
    v_mfma_f32_16x16x32_bf16 v[124:127], v[88:91], v[96:99], v[28:31]
    s_nop 5
    v_max_f32 v112, v112, v116
    v_max_f32 v113, v113, v117
    v_max_f32 v114, v114, v118
    buffer_load_dwordx4 v75, s[16:19], s99 offen offset:2048 sc1 lds
    v_max_f32 v115, v115, v119
    v_max3_f32 v156, v112, v113, v114
    v_max_f32 v156, v156, v115
    v_max_f32 v120, v120, v124
    v_max_f32 v121, v121, v125
    v_max_f32 v122, v122, v126
    v_max_f32 v123, v123, v127
    v_max3_f32 v157, v120, v121, v122
    buffer_load_dwordx4 v76, s[16:19], s99 offen offset:3072 sc1 lds
    v_max_f32 v157, v157, v123
    s_nop 1
    v_permlane16_swap_b32 v156, v157
    v_max_f32 v156, v156, v157
    v_mov_b32 v157, v156
    s_nop 1
    v_permlane32_swap_b32 v156, v157
    v_max_f32 v156, v156, v157
    v_mul_f32 v156, s82, v156
    v_mov_b32 v157, v156
    s_add_u32 m0, s93, 73344
    s_add_u32 s99, s99, 524288
    s_mov_b64 exec, s[80:81]
    buffer_load_dwordx4 v77, s[16:19], s100 offen sc1 lds
    s_mov_b64 exec, -1
    s_add_u32 s100, s100, 524288
    v_permlane16_swap_b32_e64 v156, v157
    v_fma_f32 v112, v112, s82, -v156
    v_fma_f32 v113, v113, s82, -v156
    v_fma_f32 v114, v114, s82, -v156
    v_fma_f32 v115, v115, s82, -v156
    v_exp_f32 v112, v112
    v_exp_f32 v113, v113
    v_exp_f32 v114, v114
    s_add_u32 m0, s92, 75520
    s_nop 0
    buffer_load_dwordx4 v73, s[16:19], s99 offen offset:0 sc1 lds
    v_exp_f32_e64 v115, v115
    v_cvt_pk_bf16_f32 v116, v112, v113
    v_cvt_pk_bf16_f32 v117, v114, v115
    v_bfi_b32 v128, v36, 0, v116
    v_and_b32 v130, v36, v116
    v_bfi_b32 v129, v37, 0, v117
    v_and_b32 v131, v37, v117
    s_waitcnt lgkmcnt(3)
    s_nop 0
    v_mfma_f32_16x16x32_bf16 v[144:147], v[106:109], v[128:131], 0
    buffer_load_dwordx4 v74, s[16:19], s99 offen offset:1024 sc1 lds
    s_waitcnt lgkmcnt(2)
    v_mfma_f32_16x16x32_bf16 v[136:139], v[100:103], v[128:131], 0
    v_fma_f32 v120, v120, s82, -v157
    v_fma_f32 v121, v121, s82, -v157
    v_fma_f32 v122, v122, s82, -v157
    v_fma_f32 v123, v123, s82, -v157
    v_exp_f32 v120, v120
    v_exp_f32 v121, v121
    v_exp_f32 v122, v122
    buffer_load_dwordx4 v75, s[16:19], s99 offen offset:2048 sc1 lds
    v_exp_f32_e64 v123, v123
    v_cvt_pk_bf16_f32 v124, v120, v121
    v_cvt_pk_bf16_f32 v125, v122, v123
    v_bfi_b32 v132, v36, 0, v124
    v_and_b32 v134, v36, v124
    v_bfi_b32 v133, v37, 0, v125
    v_and_b32 v135, v37, v125
    s_waitcnt lgkmcnt(1)
    s_nop 0
    v_mfma_f32_16x16x32_bf16 v[148:151], v[108:111], v[132:135], 0
    buffer_load_dwordx4 v76, s[16:19], s99 offen offset:3072 sc1 lds
    s_waitcnt lgkmcnt(0)
    v_mfma_f32_16x16x32_bf16 v[140:143], v[102:105], v[132:135], 0
    v_mov_b32 v158, v144
    s_nop 1
    v_permlane16_swap_b32 v144, v158
    v_rcp_f32 v158, v158
    s_nop 0
    v_pk_mul_f32 v[136:137], v[136:137], v[158:159] op_sel_hi:[1,0]
    v_pk_mul_f32 v[138:139], v[138:139], v[158:159] op_sel_hi:[1,0]
    v_pk_mul_f32 v[144:145], v[144:145], v[158:159] op_sel_hi:[1,0]
    v_pk_mul_f32 v[146:147], v[146:147], v[158:159] op_sel_hi:[1,0]
    s_add_u32 m0, s93, 92928
    s_add_u32 s99, s99, 524288
    s_mov_b64 exec, s[80:81]
    buffer_load_dwordx4 v77, s[16:19], s100 offen sc1 lds
    s_mov_b64 exec, -1
    s_add_u32 s100, s100, 524288
    v_cvt_pk_bf16_f32 v112, v136, v137
    v_cvt_pk_bf16_f32 v116, v144, v145
    v_cvt_pk_bf16_f32 v113, v138, v139
    v_cvt_pk_bf16_f32 v117, v146, v147
    v_mov_b32 v160, v148
    s_nop 1
    v_permlane16_swap_b32 v148, v160
    v_rcp_f32_e64 v160, v160
    s_nop 0
    v_pk_mul_f32 v[140:141], v[140:141], v[160:161] op_sel_hi:[1,0]
    v_pk_mul_f32 v[142:143], v[142:143], v[160:161] op_sel_hi:[1,0]
    v_pk_mul_f32 v[148:149], v[148:149], v[160:161] op_sel_hi:[1,0]
    v_pk_mul_f32 v[150:151], v[150:151], v[160:161] op_sel_hi:[1,0]
    v_cvt_pk_bf16_f32 v114, v140, v141
    v_cvt_pk_bf16_f32 v118, v148, v149
    v_cvt_pk_bf16_f32 v115, v142, v143
    v_cvt_pk_bf16_f32 v119, v150, v151
    v_permlane16_swap_b32 v112, v114
    v_permlane16_swap_b32 v113, v115
    v_permlane16_swap_b32 v116, v118
    v_permlane16_swap_b32 v117, v119
    buffer_store_dwordx4 v[112:115], v45, s[16:19], s25 offen sc1
    s_mov_b64 exec, s[80:81]
    buffer_store_dwordx2 v[116:117], v46, s[16:19], s26 offen sc1
    s_mov_b64 exec, -1
ge_69:
    v_add_u32 v196, 36352, v78
    v_mov_b32_e64 v198, v79
    s_waitcnt vmcnt(12)
    s_barrier
    ds_read_b64 v[160:161], v198 offset:0
    ds_read_b64 v[162:163], v198 offset:64
    ds_read_b64 v[164:165], v196 offset:0
    ds_read_b64 v[166:167], v196 offset:512
    ds_read_b64 v[168:169], v196 offset:256
    ds_read_b64 v[170:171], v196 offset:768
    ds_read_b64 v[172:173], v198 offset:256
    ds_read_b64 v[174:175], v198 offset:320
    ds_read_b64 v[176:177], v196 offset:2048
    ds_read_b64 v[178:179], v196 offset:2560
    ds_read_b64 v[180:181], v196 offset:2304
    ds_read_b64 v[182:183], v196 offset:2816
    s_waitcnt lgkmcnt(6)
    v_mfma_f32_16x16x32_bf16 v[112:115], a[0:3], v[160:163], 0
    ds_read_b64 v[184:185], v198 offset:512
    v_mfma_f32_32x32x16_bf16 v[80:95], a[0:3], v[164:167], 0
    ds_read_b64 v[186:187], v198 offset:576
    ds_read_b64 v[188:189], v196 offset:4096
    ds_read_b64 v[190:191], v196 offset:4608
    v_mfma_f32_32x32x16_bf16 v[96:111], a[0:3], v[168:171], 0
    ds_read_b64 v[192:193], v196 offset:4352
    ds_read_b64 v[194:195], v196 offset:4864
    s_add_u32 m0, s92, 95104
    s_nop 0
    buffer_load_dwordx4 v73, s[16:19], s99 offen offset:0 sc1 lds
    s_waitcnt lgkmcnt(6)
    v_mfma_f32_16x16x32_bf16 v[112:115], a[4:7], v[172:175], v[112:115]
    ds_read_b64 v[160:161], v198 offset:768
    v_mfma_f32_32x32x16_bf16 v[80:95], a[4:7], v[176:179], v[80:95]
    ds_read_b64 v[162:163], v198 offset:832
    ds_read_b64 v[164:165], v196 offset:6144
    ds_read_b64 v[166:167], v196 offset:6656
    v_mfma_f32_32x32x16_bf16 v[96:111], a[4:7], v[180:183], v[96:111]
    ds_read_b64 v[168:169], v196 offset:6400
    ds_read_b64 v[170:171], v196 offset:6912
    buffer_load_dwordx4 v74, s[16:19], s99 offen offset:1024 sc1 lds
    s_waitcnt lgkmcnt(6)
    v_mfma_f32_16x16x32_bf16 v[112:115], a[8:11], v[184:187], v[112:115]
    ds_read_b64 v[172:173], v198 offset:1024
    v_mfma_f32_32x32x16_bf16 v[80:95], a[8:11], v[188:191], v[80:95]
    ds_read_b64 v[174:175], v198 offset:1088
    ds_read_b64 v[176:177], v196 offset:8192
    ds_read_b64 v[178:179], v196 offset:8704
    v_mfma_f32_32x32x16_bf16 v[96:111], a[8:11], v[192:195], v[96:111]
    ds_read_b64 v[180:181], v196 offset:8448
    ds_read_b64 v[182:183], v196 offset:8960
    buffer_load_dwordx4 v75, s[16:19], s99 offen offset:2048 sc1 lds
    s_waitcnt lgkmcnt(6)
    v_mfma_f32_16x16x32_bf16 v[112:115], a[12:15], v[160:163], v[112:115]
    ds_read_b64 v[184:185], v198 offset:1280
    v_mfma_f32_32x32x16_bf16 v[80:95], a[12:15], v[164:167], v[80:95]
    ds_read_b64 v[186:187], v198 offset:1344
    ds_read_b64 v[188:189], v196 offset:10240
    ds_read_b64 v[190:191], v196 offset:10752
    v_mfma_f32_32x32x16_bf16 v[96:111], a[12:15], v[168:171], v[96:111]
    ds_read_b64 v[192:193], v196 offset:10496
    ds_read_b64 v[194:195], v196 offset:11008
    buffer_load_dwordx4 v76, s[16:19], s99 offen offset:3072 sc1 lds
    s_waitcnt lgkmcnt(6)
    v_mfma_f32_16x16x32_bf16 v[112:115], a[16:19], v[172:175], v[112:115]
    ds_read_b64 v[160:161], v198 offset:1536
    v_mfma_f32_32x32x16_bf16 v[80:95], a[16:19], v[176:179], v[80:95]
    ds_read_b64 v[162:163], v198 offset:1600
    ds_read_b64 v[164:165], v196 offset:12288
    ds_read_b64 v[166:167], v196 offset:12800
    v_mfma_f32_32x32x16_bf16 v[96:111], a[16:19], v[180:183], v[96:111]
    ds_read_b64 v[168:169], v196 offset:12544
    ds_read_b64 v[170:171], v196 offset:13056
    s_add_u32 m0, s93, 112512
    s_add_u32 s99, s99, 524288
    s_mov_b64 exec, s[80:81]
    buffer_load_dwordx4 v77, s[16:19], s100 offen sc1 lds
    s_mov_b64 exec, -1
    s_add_u32 s100, s100, 524288
    s_waitcnt lgkmcnt(6)
    v_mfma_f32_16x16x32_bf16 v[112:115], a[20:23], v[184:187], v[112:115]
    ds_read_b64 v[172:173], v198 offset:1792
    v_mfma_f32_32x32x16_bf16 v[80:95], a[20:23], v[188:191], v[80:95]
    ds_read_b64 v[174:175], v198 offset:1856
    ds_read_b64 v[176:177], v196 offset:14336
    ds_read_b64 v[178:179], v196 offset:14848
    v_mfma_f32_32x32x16_bf16 v[96:111], a[20:23], v[192:195], v[96:111]
    ds_read_b64 v[180:181], v196 offset:14592
    ds_read_b64 v[182:183], v196 offset:15104
    s_add_u32 m0, s92, 114688
    s_nop 0
    buffer_load_dwordx4 v73, s[16:19], s99 offen offset:0 sc1 lds
    s_waitcnt vmcnt(13)
    s_barrier
    s_waitcnt lgkmcnt(6)
    v_mfma_f32_16x16x32_bf16 v[112:115], a[24:27], v[160:163], v[112:115]
    v_add_u32 v198, v49, v198
    v_mfma_f32_32x32x16_bf16 v[80:95], a[24:27], v[164:167], v[80:95]
    v_add_u32 v196, 19584, v196
    ds_read_b64 v[184:185], v198 offset:0
    ds_read_b64 v[186:187], v198 offset:64
    ds_read_b64 v[188:189], v196 offset:0
    v_mfma_f32_32x32x16_bf16 v[96:111], a[24:27], v[168:171], v[96:111]
    ds_read_b64 v[190:191], v196 offset:512
    ds_read_b64 v[192:193], v196 offset:256
    ds_read_b64 v[194:195], v196 offset:768
    buffer_load_dwordx4 v74, s[16:19], s99 offen offset:1024 sc1 lds
    s_waitcnt lgkmcnt(6)
    v_mfma_f32_16x16x32_bf16 v[112:115], a[28:31], v[172:175], v[112:115]
    ds_read_b64 v[160:161], v198 offset:256
    v_mfma_f32_32x32x16_bf16 v[80:95], a[28:31], v[176:179], v[80:95]
    ds_read_b64 v[162:163], v198 offset:320
    ds_read_b64 v[164:165], v196 offset:2048
    ds_read_b64 v[166:167], v196 offset:2560
    v_mfma_f32_32x32x16_bf16 v[96:111], a[28:31], v[180:183], v[96:111]
    ds_read_b64 v[168:169], v196 offset:2304
    ds_read_b64 v[170:171], v196 offset:2816
    buffer_load_dwordx4 v75, s[16:19], s99 offen offset:2048 sc1 lds
    s_waitcnt lgkmcnt(6)
    v_mfma_f32_16x16x32_bf16 v[112:115], a[32:35], v[184:187], v[112:115]
    ds_read_b64 v[172:173], v198 offset:512
    v_mfma_f32_32x32x16_bf16 v[80:95], a[32:35], v[188:191], v[80:95]
    ds_read_b64 v[174:175], v198 offset:576
    ds_read_b64 v[176:177], v196 offset:4096
    ds_read_b64 v[178:179], v196 offset:4608
    v_mfma_f32_32x32x16_bf16 v[96:111], a[32:35], v[192:195], v[96:111]
    ds_read_b64 v[180:181], v196 offset:4352
    ds_read_b64 v[182:183], v196 offset:4864
    buffer_load_dwordx4 v76, s[16:19], s99 offen offset:3072 sc1 lds
    s_waitcnt lgkmcnt(6)
    v_mfma_f32_16x16x32_bf16 v[112:115], a[36:39], v[160:163], v[112:115]
    ds_read_b64 v[184:185], v198 offset:768
    v_mfma_f32_32x32x16_bf16 v[80:95], a[36:39], v[164:167], v[80:95]
    ds_read_b64 v[186:187], v198 offset:832
    ds_read_b64 v[188:189], v196 offset:6144
    ds_read_b64 v[190:191], v196 offset:6656
    v_mfma_f32_32x32x16_bf16 v[96:111], a[36:39], v[168:171], v[96:111]
    ds_read_b64 v[192:193], v196 offset:6400
    ds_read_b64 v[194:195], v196 offset:6912
    s_add_u32 m0, s93, 132096
    s_add_u32 s99, s99, 524288
    s_mov_b64 exec, s[80:81]
    buffer_load_dwordx4 v77, s[16:19], s100 offen sc1 lds
    s_mov_b64 exec, -1
    s_add_u32 s100, s100, 524288
    s_waitcnt lgkmcnt(6)
    v_mfma_f32_16x16x32_bf16 v[112:115], a[40:43], v[172:175], v[112:115]
    ds_read_b64 v[160:161], v198 offset:1024
    v_mfma_f32_32x32x16_bf16 v[80:95], a[40:43], v[176:179], v[80:95]
    ds_read_b64 v[162:163], v198 offset:1088
    ds_read_b64 v[164:165], v196 offset:8192
    ds_read_b64 v[166:167], v196 offset:8704
    v_add_u32 v199, 36352, v58
    s_lshl_b32 s32, s24, 11
    v_mfma_f32_32x32x16_bf16 v[96:111], a[40:43], v[180:183], v[96:111]
    ds_read_b64 v[168:169], v196 offset:8448
    ds_read_b64 v[170:171], v196 offset:8960
    v_add_u32 v203, s32, v199
    s_add_u32 s32, s24, 1
    s_waitcnt lgkmcnt(6)
    v_mfma_f32_16x16x32_bf16 v[112:115], a[44:47], v[184:187], v[112:115]
    ds_read_b64 v[172:173], v198 offset:1280
    v_mfma_f32_32x32x16_bf16 v[80:95], a[44:47], v[188:191], v[80:95]
    ds_read_b64 v[174:175], v198 offset:1344
    ds_read_b64 v[176:177], v196 offset:10240
    ds_read_b64 v[178:179], v196 offset:10752
    s_and_b32 s32, s32, 3
    s_mul_i32 s32, s32, 6144
    v_mfma_f32_32x32x16_bf16 v[96:111], a[44:47], v[192:195], v[96:111]
    ds_read_b64 v[180:181], v196 offset:10496
    ds_read_b64 v[182:183], v196 offset:11008
    v_add_u32 v200, s32, v199
    s_add_u32 s32, s24, 2
    s_waitcnt lgkmcnt(6)
    v_mfma_f32_16x16x32_bf16 v[112:115], a[48:51], v[160:163], v[112:115]
    ds_read_b64 v[184:185], v198 offset:1536
    v_mfma_f32_32x32x16_bf16 v[80:95], a[48:51], v[164:167], v[80:95]
    ds_read_b64 v[186:187], v198 offset:1600
    ds_read_b64 v[188:189], v196 offset:12288
    ds_read_b64 v[190:191], v196 offset:12800
    s_and_b32 s32, s32, 3
    s_mul_i32 s32, s32, 6144
    v_mfma_f32_32x32x16_bf16 v[96:111], a[48:51], v[168:171], v[96:111]
    ds_read_b64 v[192:193], v196 offset:12544
    ds_read_b64 v[194:195], v196 offset:13056
    v_add_u32 v201, s32, v199
    s_add_u32 s32, s24, 3
    s_waitcnt lgkmcnt(6)
    v_mfma_f32_16x16x32_bf16 v[112:115], a[52:55], v[172:175], v[112:115]
    ds_read_b64 v[160:161], v198 offset:1792
    v_mfma_f32_32x32x16_bf16 v[80:95], a[52:55], v[176:179], v[80:95]
    ds_read_b64 v[162:163], v198 offset:1856
    ds_read_b64 v[164:165], v196 offset:14336
    ds_read_b64 v[166:167], v196 offset:14848
    s_and_b32 s32, s32, 3
    s_mul_i32 s32, s32, 6144
    v_mfma_f32_32x32x16_bf16 v[96:111], a[52:55], v[180:183], v[96:111]
    ds_read_b64 v[168:169], v196 offset:14592
    ds_read_b64 v[170:171], v196 offset:15104
    v_add_u32 v202, s32, v199
    s_mul_i32 s32, s24, 6144
    s_waitcnt vmcnt(12)
    s_barrier
    s_waitcnt lgkmcnt(6)
    v_mfma_f32_16x16x32_bf16 v[112:115], a[56:59], v[184:187], v[112:115]
    v_add_u32 v198, v49, v198
    v_mfma_f32_32x32x16_bf16 v[80:95], a[56:59], v[188:191], v[80:95]
    v_add_u32 v196, 19584, v196
    ds_read_b64 v[172:173], v198 offset:0
    ds_read_b64 v[174:175], v198 offset:64
    ds_read_b64 v[176:177], v196 offset:0
    v_add_u32_e64 v204, s32, v199
    v_mfma_f32_32x32x16_bf16 v[96:111], a[56:59], v[192:195], v[96:111]
    ds_read_b64 v[178:179], v196 offset:512
    ds_read_b64 v[180:181], v196 offset:256
    ds_read_b64 v[182:183], v196 offset:768
    s_lshl_b32 s32, s24, 8
    s_waitcnt lgkmcnt(6)
    v_mfma_f32_16x16x32_bf16 v[112:115], a[60:63], v[160:163], v[112:115]
    ds_read_b64 v[184:185], v198 offset:256
    v_mfma_f32_32x32x16_bf16 v[80:95], a[60:63], v[164:167], v[80:95]
    ds_read_b64 v[186:187], v198 offset:320
    ds_read_b64 v[188:189], v196 offset:2048
    ds_read_b64 v[190:191], v196 offset:2560
    s_add_u32 s32, s32, 36352
    v_and_b32_e64 v214, 15, v1
    v_mfma_f32_32x32x16_bf16 v[96:111], a[60:63], v[168:171], v[96:111]
    ds_read_b64 v[192:193], v196 offset:2304
    ds_read_b64 v[194:195], v196 offset:2816
    v_lshl_add_u32 v206, v214, 4, s32
    v_lshrrev_b32 v215, 5, v1
    s_waitcnt lgkmcnt(6)
    v_mfma_f32_16x16x32_bf16 v[112:115], a[64:67], v[172:175], v[112:115]
    ds_read_b64 v[160:161], v198 offset:512
    v_mfma_f32_32x32x16_bf16 v[80:95], a[64:67], v[176:179], v[80:95]
    ds_read_b64 v[162:163], v198 offset:576
    ds_read_b64 v[164:165], v196 offset:4096
    ds_read_b64 v[166:167], v196 offset:4608
    v_lshl_add_u32 v205, v215, 10, v206
    v_bfe_u32 v215, v1, 4, 1
    v_mfma_f32_32x32x16_bf16 v[96:111], a[64:67], v[180:183], v[96:111]
    ds_read_b64 v[168:169], v196 offset:4352
    ds_read_b64 v[170:171], v196 offset:4864
    v_lshl_add_u32 v205, v215, 3, v205
    v_lshlrev_b32 v214, 2, v214
    s_waitcnt lgkmcnt(6)
    v_mfma_f32_16x16x32_bf16 v[112:115], a[68:71], v[184:187], v[112:115]
    ds_read_b64 v[172:173], v198 offset:768
    v_mfma_f32_32x32x16_bf16 v[80:95], a[68:71], v[188:191], v[80:95]
    ds_read_b64 v[174:175], v198 offset:832
    ds_read_b64 v[176:177], v196 offset:6144
    ds_read_b64 v[178:179], v196 offset:6656
    v_lshl_add_u32 v214, v215, 10, v214
    s_lshl_b32 s32, s24, 6
    v_mfma_f32_32x32x16_bf16 v[96:111], a[68:71], v[192:195], v[96:111]
    ds_read_b64 v[180:181], v196 offset:6400
    ds_read_b64 v[182:183], v196 offset:6912
    v_lshl_add_u32 v207, v215, 3, s32
    v_and_b32_e64 v215, 12, v1
    s_waitcnt lgkmcnt(6)
    v_mfma_f32_16x16x32_bf16 v[112:115], a[72:75], v[160:163], v[112:115]
    ds_read_b64 v[184:185], v198 offset:1024
    v_mfma_f32_32x32x16_bf16 v[80:95], a[72:75], v[164:167], v[80:95]
    ds_read_b64 v[186:187], v198 offset:1088
    ds_read_b64 v[188:189], v196 offset:8192
    ds_read_b64 v[190:191], v196 offset:8704
    v_lshl_add_u32 v207, v215, 2, v207
    v_and_b32_e64 v215, 2, v1
    v_mfma_f32_32x32x16_bf16 v[96:111], a[72:75], v[168:171], v[96:111]
    ds_read_b64 v[192:193], v196 offset:8448
    ds_read_b64 v[194:195], v196 offset:8960
    s_lshl_b32 s98, s72, 5
    s_add_u32 s98, s98, 256
    s_sub_u32 s95, s98, 4
    s_max_i32 s95, s95, 0
    s_lshl_b32 s94, s98, 3
    s_lshl_b32 s95, s95, 3
    s_add_u32 s94, s94, 3457024
    s_add_u32 s95, s95, 3457024
    s_add_u32 s96, s94, 8192
    buffer_load_dwordx2 v[152:153], v47, s[16:19], s94 offen sc1
    s_waitcnt lgkmcnt(6)
    v_mfma_f32_16x16x32_bf16 v[112:115], a[76:79], v[172:175], v[112:115]
    ds_read_b64 v[160:161], v198 offset:1280
    v_mfma_f32_32x32x16_bf16 v[80:95], a[76:79], v[176:179], v[80:95]
    ds_read_b64 v[162:163], v198 offset:1344
    ds_read_b64 v[164:165], v196 offset:10240
    ds_read_b64 v[166:167], v196 offset:10752
    v_lshl_add_u32 v207, v215, 1, v207
    v_add_u32 v207, 69120, v207
    v_mfma_f32_32x32x16_bf16 v[96:111], a[76:79], v[180:183], v[96:111]
    ds_read_b64 v[168:169], v196 offset:10496
    ds_read_b64 v[170:171], v196 offset:11008
    buffer_load_dwordx2 v[154:155], v47, s[16:19], s96 offen sc1
    v_lshrrev_b32 v215, 4, v1
    s_waitcnt lgkmcnt(6)
    v_mfma_f32_16x16x32_bf16 v[112:115], a[80:83], v[184:187], v[112:115]
    ds_read_b64 v[172:173], v198 offset:1536
    v_mfma_f32_32x32x16_bf16 v[80:95], a[80:83], v[188:191], v[80:95]
    ds_read_b64 v[174:175], v198 offset:1600
    ds_read_b64 v[176:177], v196 offset:12288
    ds_read_b64 v[178:179], v196 offset:12800
    v_lshl_add_u32 v206, v215, 2, v206
    v_mov_b32 v215, 0x3f803f80
    v_mfma_f32_32x32x16_bf16 v[96:111], a[80:83], v[192:195], v[96:111]
    ds_read_b64 v[180:181], v196 offset:12544
    ds_read_b64 v[182:183], v196 offset:13056
    buffer_load_dwordx2 v[156:157], v48, s[16:19], s95 offen sc1
    s_waitcnt lgkmcnt(6)
    v_mfma_f32_16x16x32_bf16 v[112:115], a[84:87], v[160:163], v[112:115]
    ds_read_b64 v[184:185], v198 offset:1792
    v_mfma_f32_32x32x16_bf16 v[80:95], a[84:87], v[164:167], v[80:95]
    ds_read_b64 v[186:187], v198 offset:1856
    ds_read_b64 v[188:189], v196 offset:14336
    ds_read_b64 v[190:191], v196 offset:14848
    v_mfma_f32_32x32x16_bf16 v[96:111], a[84:87], v[168:171], v[96:111]
    ds_read_b64 v[192:193], v196 offset:14592
    ds_read_b64 v[194:195], v196 offset:15104
    s_waitcnt vmcnt(8)
    s_barrier
    s_waitcnt lgkmcnt(6)
    v_mfma_f32_16x16x32_bf16 v[112:115], a[88:91], v[172:175], v[112:115]
    v_add_u32_e64 v198, v49, v198
    v_mfma_f32_32x32x16_bf16 v[80:95], a[88:91], v[176:179], v[80:95]
    v_add_u32 v196, 19584, v196
    ds_read_b64 v[160:161], v198 offset:0
    ds_read_b64 v[162:163], v198 offset:64
    ds_read_b64 v[164:165], v196 offset:0
    v_mfma_f32_32x32x16_bf16 v[96:111], a[88:91], v[180:183], v[96:111]
    ds_read_b64 v[166:167], v196 offset:512
    ds_read_b64 v[168:169], v196 offset:256
    ds_read_b64 v[170:171], v196 offset:768
    s_waitcnt lgkmcnt(6)
    v_mfma_f32_16x16x32_bf16 v[112:115], a[92:95], v[184:187], v[112:115]
    ds_read_b64 v[172:173], v198 offset:256
    v_mfma_f32_32x32x16_bf16 v[80:95], a[92:95], v[188:191], v[80:95]
    ds_read_b64 v[174:175], v198 offset:320
    ds_read_b64 v[176:177], v196 offset:2048
    ds_read_b64 v[178:179], v196 offset:2560
    v_mfma_f32_32x32x16_bf16 v[96:111], a[92:95], v[192:195], v[96:111]
    ds_read_b64 v[180:181], v196 offset:2304
    ds_read_b64 v[182:183], v196 offset:2816
    s_waitcnt lgkmcnt(6)
    v_mfma_f32_16x16x32_bf16 v[112:115], a[96:99], v[160:163], v[112:115]
    ds_read_b64 v[184:185], v198 offset:512
    v_mfma_f32_32x32x16_bf16 v[80:95], a[96:99], v[164:167], v[80:95]
    ds_read_b64 v[186:187], v198 offset:576
    ds_read_b64 v[188:189], v196 offset:4096
    ds_read_b64 v[190:191], v196 offset:4608
    v_mfma_f32_32x32x16_bf16 v[96:111], a[96:99], v[168:171], v[96:111]
    ds_read_b64 v[192:193], v196 offset:4352
    ds_read_b64 v[194:195], v196 offset:4864
    s_waitcnt lgkmcnt(6)
    v_mfma_f32_16x16x32_bf16 v[112:115], a[100:103], v[172:175], v[112:115]
    ds_read_b64 v[160:161], v198 offset:768
    v_mfma_f32_32x32x16_bf16 v[80:95], a[100:103], v[176:179], v[80:95]
    ds_read_b64 v[162:163], v198 offset:832
    ds_read_b64 v[164:165], v196 offset:6144
    ds_read_b64 v[166:167], v196 offset:6656
    v_mfma_f32_32x32x16_bf16 v[96:111], a[100:103], v[180:183], v[96:111]
    ds_read_b64 v[168:169], v196 offset:6400
    ds_read_b64 v[170:171], v196 offset:6912
    s_waitcnt lgkmcnt(6)
    v_mfma_f32_16x16x32_bf16 v[112:115], a[104:107], v[184:187], v[112:115]
    ds_read_b64 v[172:173], v198 offset:1024
    v_mfma_f32_32x32x16_bf16 v[80:95], a[104:107], v[188:191], v[80:95]
    ds_read_b64 v[174:175], v198 offset:1088
    ds_read_b64 v[176:177], v196 offset:8192
    ds_read_b64 v[178:179], v196 offset:8704
    v_mfma_f32_32x32x16_bf16 v[96:111], a[104:107], v[192:195], v[96:111]
    ds_read_b64 v[180:181], v196 offset:8448
    ds_read_b64 v[182:183], v196 offset:8960
    s_waitcnt lgkmcnt(6)
    v_mfma_f32_16x16x32_bf16 v[112:115], a[108:111], v[160:163], v[112:115]
    ds_read_b64 v[184:185], v198 offset:1280
    v_mfma_f32_32x32x16_bf16 v[80:95], a[108:111], v[164:167], v[80:95]
    ds_read_b64 v[186:187], v198 offset:1344
    ds_read_b64 v[188:189], v196 offset:10240
    ds_read_b64 v[190:191], v196 offset:10752
    v_mfma_f32_32x32x16_bf16 v[96:111], a[108:111], v[168:171], v[96:111]
    ds_read_b64 v[192:193], v196 offset:10496
    ds_read_b64 v[194:195], v196 offset:11008
    s_waitcnt lgkmcnt(6)
    v_mfma_f32_16x16x32_bf16 v[112:115], a[112:115], v[172:175], v[112:115]
    ds_read_b64 v[160:161], v198 offset:1536
    v_mfma_f32_32x32x16_bf16 v[80:95], a[112:115], v[176:179], v[80:95]
    ds_read_b64 v[162:163], v198 offset:1600
    ds_read_b64 v[164:165], v196 offset:12288
    ds_read_b64 v[166:167], v196 offset:12800
    v_mfma_f32_32x32x16_bf16 v[96:111], a[112:115], v[180:183], v[96:111]
    ds_read_b64 v[168:169], v196 offset:12544
    ds_read_b64 v[170:171], v196 offset:13056
    s_waitcnt lgkmcnt(6)
    v_mfma_f32_16x16x32_bf16 v[112:115], a[116:119], v[184:187], v[112:115]
    ds_read_b64 v[172:173], v198 offset:1792
    v_mfma_f32_32x32x16_bf16 v[80:95], a[116:119], v[188:191], v[80:95]
    ds_read_b64 v[174:175], v198 offset:1856
    ds_read_b64 v[176:177], v196 offset:14336
    ds_read_b64 v[178:179], v196 offset:14848
    v_mfma_f32_32x32x16_bf16 v[96:111], a[116:119], v[192:195], v[96:111]
    ds_read_b64 v[180:181], v196 offset:14592
    ds_read_b64 v[182:183], v196 offset:15104
sl_70:
    s_waitcnt vmcnt(1)
    v_max3_u32 v2, v152, v153, v154
    s_waitcnt vmcnt(0)
    v_max3_u32 v2, v2, v155, v156
    v_max_u32 v2, v2, v157
    v_cmp_eq_u32 vcc, -1, v2
    s_nop 0
    s_cbranch_vccnz rd_71
rc_72:
    s_barrier
    s_waitcnt lgkmcnt(6)
    v_mfma_f32_16x16x32_bf16 v[112:115], a[120:123], v[160:163], v[112:115]
    v_add_u32 v198, v49, v198
    v_mfma_f32_32x32x16_bf16 v[80:95], a[120:123], v[164:167], v[80:95]
    v_add_u32 v196, 19584, v196
    ds_read_b64 v[184:185], v198 offset:0
    ds_read_b64 v[186:187], v198 offset:64
    v_mul_f32 v148, v24, v157
    v_mul_f32 v149, v25, v157
    v_mfma_f32_32x32x16_bf16 v[96:111], a[120:123], v[168:171], v[96:111]
    ds_read_b64 v[188:189], v196 offset:0
    ds_read_b64 v[190:191], v196 offset:512
    s_mov_b32 s96, 12058624
    buffer_load_dwordx4 v[216:219], v56, s[16:19], s96 offen offset:0 sc1
    v_mul_f32 v150, v26, v157
    v_mul_f32_e64 v151, v27, v157
    s_waitcnt lgkmcnt(4)
    v_mfma_f32_16x16x32_bf16 v[112:115], a[124:127], v[172:175], v[112:115]
    ds_read_b64 v[192:193], v198 offset:256
    v_mfma_f32_32x32x16_bf16 v[80:95], a[124:127], v[176:179], v[80:95]
    ds_read_b64 v[194:195], v198 offset:320
    ds_read_b64 v[160:161], v196 offset:2048
    v_mul_f32 v116, v8, v153
    v_mul_f32 v117, v9, v153
    v_mul_f32_e64 v118, v10, v153
    v_mfma_f32_32x32x16_bf16 v[96:111], a[124:127], v[180:183], v[96:111]
    ds_read_b64 v[162:163], v196 offset:2560
    buffer_load_dwordx4 v[220:223], v56, s[16:19], s96 offen offset:256 sc1
    v_mul_f32 v119, v11, v153
    v_mul_f32_e64 v120, v12, v153
    s_waitcnt lgkmcnt(4)
    v_mfma_f32_16x16x32_bf16 v[112:115], a[128:131], v[184:187], v[112:115]
    ds_read_b64 v[164:165], v198 offset:512
    v_mfma_f32_32x32x16_bf16 v[80:95], a[128:131], v[188:191], v[80:95]
    ds_read_b64 v[166:167], v198 offset:576
    ds_read_b64 v[168:169], v196 offset:4096
    ds_read_b64 v[170:171], v196 offset:4608
    v_mul_f32 v121, v13, v153
    v_mul_f32_e64 v122, v14, v153
    s_waitcnt lgkmcnt(4)
    v_mfma_f32_16x16x32_bf16 v[112:115], a[132:135], v[192:195], v[112:115]
    ds_read_b64 v[172:173], v198 offset:768
    v_mfma_f32_32x32x16_bf16 v[80:95], a[132:135], v[160:163], v[80:95]
    ds_read_b64 v[174:175], v198 offset:832
    ds_read_b64 v[176:177], v196 offset:6144
    ds_read_b64 v[178:179], v196 offset:6656
    s_mov_b32 s96, 12091392
    buffer_load_dwordx4 v[224:227], v56, s[16:19], s96 offen offset:0 sc1
    v_mul_f32 v123, v15, v153
    v_mul_f32_e64 v124, v16, v153
    s_waitcnt lgkmcnt(4)
    v_mfma_f32_16x16x32_bf16 v[112:115], a[136:139], v[164:167], v[112:115]
    ds_read_b64 v[180:181], v198 offset:1024
    v_mfma_f32_32x32x16_bf16 v[80:95], a[136:139], v[168:171], v[80:95]
    ds_read_b64 v[182:183], v198 offset:1088
    ds_read_b64 v[184:185], v196 offset:8192
    ds_read_b64 v[186:187], v196 offset:8704
    v_mul_f32 v125, v17, v153
    v_mul_f32_e64 v126, v18, v153
    s_waitcnt lgkmcnt(4)
    v_mfma_f32_16x16x32_bf16 v[112:115], a[140:143], v[172:175], v[112:115]
    ds_read_b64 v[188:189], v198 offset:1280
    v_mfma_f32_32x32x16_bf16 v[80:95], a[140:143], v[176:179], v[80:95]
    ds_read_b64 v[190:191], v198 offset:1344
    ds_read_b64 v[192:193], v196 offset:10240
    ds_read_b64 v[194:195], v196 offset:10752
    buffer_load_dwordx4 v[228:231], v56, s[16:19], s96 offen offset:256 sc1
    v_mul_f32 v127, v19, v153
    v_mul_f32_e64 v128, v20, v153
    s_waitcnt lgkmcnt(4)
    v_mfma_f32_16x16x32_bf16 v[112:115], a[144:147], v[180:183], v[112:115]
    ds_read_b64 v[160:161], v198 offset:1536
    v_mfma_f32_32x32x16_bf16 v[80:95], a[144:147], v[184:187], v[80:95]
    ds_read_b64 v[162:163], v198 offset:1600
    ds_read_b64 v[164:165], v196 offset:12288
    ds_read_b64 v[166:167], v196 offset:12800
    v_mul_f32 v129, v21, v153
    v_mul_f32_e64 v130, v22, v153
    s_waitcnt lgkmcnt(4)
    v_mfma_f32_16x16x32_bf16 v[112:115], a[148:151], v[188:191], v[112:115]
    ds_read_b64 v[168:169], v198 offset:1792
    v_mfma_f32_32x32x16_bf16 v[80:95], a[148:151], v[192:195], v[80:95]
    ds_read_b64 v[170:171], v198 offset:1856
    ds_read_b64 v[172:173], v196 offset:14336
    ds_read_b64 v[174:175], v196 offset:14848
    s_mov_b32 s96, 12124160
    buffer_load_dwordx4 v[232:235], v56, s[16:19], s96 offen offset:0 sc1
    v_mul_f32 v131, v23, v153
    v_mul_f32_e64 v132, v8, v155
    s_waitcnt lgkmcnt(4)
    v_mfma_f32_16x16x32_bf16 v[112:115], a[152:155], v[160:163], v[112:115]
    ds_read_b64 v[176:177], v196 offset:256
    v_mfma_f32_32x32x16_bf16 v[80:95], a[152:155], v[164:167], v[80:95]
    ds_read_b64 v[178:179], v196 offset:768
    ds_read_b64 v[180:181], v196 offset:2304
    ds_read_b64 v[182:183], v196 offset:2816
    v_mul_f32 v133, v9, v155
    v_mul_f32_e64 v134, v10, v155
    s_waitcnt lgkmcnt(4)
    v_mfma_f32_16x16x32_bf16 v[112:115], a[156:159], v[168:171], v[112:115]
    ds_read_b64 v[184:185], v196 offset:4352
    v_mfma_f32_32x32x16_bf16 v[80:95], a[156:159], v[172:175], v[80:95]
    ds_read_b64 v[186:187], v196 offset:4864
    ds_read_b64 v[188:189], v196 offset:6400
    ds_read_b64 v[190:191], v196 offset:6912
    buffer_load_dwordx4 v[236:239], v56, s[16:19], s96 offen offset:256 sc1
    v_mul_f32 v135, v11, v155
    v_mul_f32 v136, v12, v155
    v_mul_f32 v137, v13, v155
    v_mul_f32 v138, v14, v155
    v_mul_f32 v139, v15, v155
    v_mul_f32 v140, v16, v155
    v_mul_f32 v141, v17, v155
    v_mul_f32 v142, v18, v155
    v_mul_f32 v143, v19, v155
    v_mul_f32 v144, v20, v155
    v_mul_f32 v145, v21, v155
    v_mul_f32 v146, v22, v155
    v_mul_f32 v147, v23, v155
    s_waitcnt lgkmcnt(4)
    v_mfma_f32_32x32x16_bf16 v[96:111], a[128:131], v[176:179], v[96:111]
    ds_read_b64 v[192:193], v196 offset:8448
    ds_read_b64 v[194:195], v196 offset:8960
    v_mfma_f32_32x32x16_bf16 v[96:111], a[132:135], v[180:183], v[96:111]
    ds_read_b64 v[160:161], v196 offset:10496
    ds_read_b64 v[162:163], v196 offset:11008
    s_mov_b32 s96, 12156928
    buffer_load_dwordx4 v[240:243], v56, s[16:19], s96 offen offset:0 sc1
    v_fma_f32 v112, v112, v156, v148
    v_fma_f32 v113, v113, v156, v149
    s_waitcnt lgkmcnt(4)
    v_mfma_f32_32x32x16_bf16 v[96:111], a[136:139], v[184:187], v[96:111]
    ds_read_b64 v[164:165], v196 offset:12544
    ds_read_b64 v[166:167], v196 offset:13056
    v_fma_f32 v114, v114, v156, v150
    v_fma_f32 v115, v115, v156, v151
    v_cvt_pk_bf16_f32 v112, v112, v113
    v_mfma_f32_32x32x16_bf16 v[96:111], a[140:143], v[188:191], v[96:111]
    ds_read_b64 v[168:169], v196 offset:14592
    ds_read_b64 v[170:171], v196 offset:15104
    buffer_load_dwordx4 v[244:247], v56, s[16:19], s96 offen offset:256 sc1
    v_cvt_pk_bf16_f32 v113, v114, v115
    v_fma_f32 v80, v80, v152, v116
    s_waitcnt lgkmcnt(4)
    v_mfma_f32_32x32x16_bf16 v[96:111], a[144:147], v[192:195], v[96:111]
    v_fma_f32 v81, v81, v152, v117
    v_fma_f32 v82, v82, v152, v118
    v_fma_f32 v83, v83, v152, v119
    v_cvt_pk_bf16_f32 v80, v80, v81
    v_cvt_pk_bf16_f32 v81, v82, v83
    v_mfma_f32_32x32x16_bf16 v[96:111], a[148:151], v[160:163], v[96:111]
    ds_write_b64 v40, v[112:113] offset:0
    ds_write_b64 v38, v[80:81] offset:0
    v_fma_f32 v84, v84, v152, v120
    v_fma_f32 v85, v85, v152, v121
    s_waitcnt lgkmcnt(2)
    v_mfma_f32_32x32x16_bf16 v[96:111], a[152:155], v[164:167], v[96:111]
    v_fma_f32 v86, v86, v152, v122
    v_fma_f32 v87, v87, v152, v123
    v_cvt_pk_bf16_f32 v84, v84, v85
    v_cvt_pk_bf16_f32 v85, v86, v87
    v_fma_f32 v88, v88, v152, v124
    v_mfma_f32_32x32x16_bf16 v[96:111], a[156:159], v[168:171], v[96:111]
    s_mov_b32 s96, 12058624
    buffer_load_dwordx2 v[248:249], v57, s[16:19], s96 offen offset:0 sc1
    v_fma_f32 v89, v89, v152, v125
    v_fma_f32 v90, v90, v152, v126
    v_fma_f32 v91, v91, v152, v127
    v_cvt_pk_bf16_f32 v88, v88, v89
    v_cvt_pk_bf16_f32 v89, v90, v91
    ds_write_b64 v38, v[84:85] offset:6400
    ds_write_b64 v38, v[88:89] offset:12800
    v_fma_f32 v92, v92, v152, v128
    v_fma_f32 v93, v93, v152, v129
    v_fma_f32 v94, v94, v152, v130
    v_fma_f32 v95, v95, v152, v131
    v_cvt_pk_bf16_f32 v92, v92, v93
    v_cvt_pk_bf16_f32 v93, v94, v95
    ds_write_b64 v39, v[92:93] offset:0
    v_pk_fma_f32 v[96:97], v[96:97], v[154:155], v[132:133] op_sel_hi:[1,0,1]
    v_pk_fma_f32 v[98:99], v[98:99], v[154:155], v[134:135] op_sel_hi:[1,0,1]
    v_cvt_pk_bf16_f32 v96, v96, v97
    v_cvt_pk_bf16_f32 v97, v98, v99
    v_pk_fma_f32 v[100:101], v[100:101], v[154:155], v[136:137] op_sel_hi:[1,0,1]
    v_pk_fma_f32 v[102:103], v[102:103], v[154:155], v[138:139] op_sel_hi:[1,0,1]
    v_cvt_pk_bf16_f32 v100, v100, v101
    v_cvt_pk_bf16_f32 v101, v102, v103
    ds_write_b64 v38, v[96:97] offset:1600
    ds_write_b64 v38, v[100:101] offset:8000
    v_pk_fma_f32 v[104:105], v[104:105], v[154:155], v[140:141] op_sel_hi:[1,0,1]
    v_pk_fma_f32 v[106:107], v[106:107], v[154:155], v[142:143] op_sel_hi:[1,0,1]
    v_cvt_pk_bf16_f32 v104, v104, v105
    v_cvt_pk_bf16_f32 v105, v106, v107
    v_pk_fma_f32 v[108:109], v[108:109], v[154:155], v[144:145] op_sel_hi:[1,0,1]
    v_pk_fma_f32 v[110:111], v[110:111], v[154:155], v[146:147] op_sel_hi:[1,0,1]
    v_cvt_pk_bf16_f32 v108, v108, v109
    v_cvt_pk_bf16_f32 v109, v110, v111
    ds_write_b64 v38, v[104:105] offset:14400
    ds_write_b64 v39, v[108:109] offset:1600
    v_cmp_u_f32 vcc, v82, v114
    v_cmp_u_f32 s[82:83], v98, v98
    s_lshl_b32 s25, s24, 2
    s_add_u32 s25, s25, 160256
    s_or_b64 vcc, vcc, s[82:83]
    s_cselect_b32 s26, 1, 0
    v_mov_b32 v196, s25
    v_mov_b32 v197, s26
    ds_write_b32 v196, v197
    s_waitcnt lgkmcnt(0)
    s_barrier
    v_mov_b32 v158, 160256
    ds_read_b128 v[128:131], v158
    v_mov_b32 v94, 0
    v_mov_b32 v95, 0
    v_mov_b32 v98, 0
    v_mov_b32_e64 v99, 0
    s_mov_b64 exec, 0xffff
    ds_read_b64 v[94:95], v42 offset:320
    ds_read_b64 v[98:99], v42 offset:640
    s_mov_b64 exec, -1
    s_nop 0
    ds_read_b64 v[92:93], v41 offset:320
    ds_read_b64 v[96:97], v41 offset:640
    ds_read_b64 v[84:85], v41 offset:6720
    ds_read_b64 v[86:87], v42 offset:6720
    ds_read_b64 v[80:81], v41 offset:6400
    ds_read_b64 v[82:83], v42 offset:6400
    ds_read_b64 v[88:89], v41 offset:7040
    ds_read_b64 v[90:91], v42 offset:7040
    ds_read_b64_tr_b16 v[106:107], v44 offset:0
    ds_read_b64_tr_b16 v[100:101], v43 offset:0
    buffer_load_dwordx2 v[252:253], v57, s[16:19], s96 offen offset:128 sc1
    ds_read_b64_tr_b16 v[108:109], v44 offset:320
    ds_read_b64_tr_b16 v[102:103], v43 offset:320
    ds_read_b64_tr_b16 v[110:111], v44 offset:640
    ds_read_b64_tr_b16 v[104:105], v43 offset:640
    s_mov_b32 s82, 0x3ea52b5c
    s_lshl_b32 s25, s98, 4
    s_add_u32 s25, s25, 12058624
    s_lshl_b32 s26, s98, 3
    s_mov_b32 s96, 12075008
    buffer_load_dwordx2 v[250:251], v57, s[16:19], s96 offen offset:0 sc1
    s_add_u32 s26, s26, 12058624
    s_waitcnt lgkmcnt(15)
    v_or3_b32 v128, v128, v129, v130
    v_or_b32 v128, v128, v131
    v_cmp_ne_u32 vcc, 0, v128
    s_nop 0
    s_cbranch_vccnz rd_73
rc_74:
    s_waitcnt lgkmcnt(10)
    v_mfma_f32_16x16x32_bf16 v[116:119], v[84:87], v[92:95], v[28:31]
    v_mfma_f32_16x16x32_bf16 v[120:123], v[84:87], v[96:99], v[32:35]
    s_waitcnt lgkmcnt(8)
    v_mfma_f32_16x16x32_bf16 v[112:115], v[80:83], v[92:95], v[32:35]
    s_waitcnt lgkmcnt(6)
    v_mfma_f32_16x16x32_bf16 v[124:127], v[88:91], v[96:99], v[28:31]
    buffer_load_dwordx2 v[254:255], v57, s[16:19], s96 offen offset:128 sc1
    s_nop 4
    v_max_f32 v112, v112, v116
    v_max_f32 v113, v113, v117
    v_max_f32 v114, v114, v118
    v_max_f32 v115, v115, v119
    v_max3_f32 v156, v112, v113, v114
    v_max_f32 v156, v156, v115
    v_max_f32 v120, v120, v124
    v_max_f32 v121, v121, v125
    s_mov_b32 s96, 9437184
    buffer_load_dwordx4 v[208:211], v59, s[16:19], s96 offen sc1
    v_max_f32 v122, v122, v126
    v_max_f32 v123, v123, v127
    v_max3_f32 v157, v120, v121, v122
    v_max_f32 v157, v157, v123
    s_nop 1
    v_permlane16_swap_b32 v156, v157
    v_max_f32 v156, v156, v157
    v_mov_b32 v157, v156
    s_nop 1
    v_permlane32_swap_b32_e64 v156, v157
    s_add_u32 s97, s36, 9437184
    buffer_load_dword v212, v61, s[16:19], s97 offen sc1
    v_max_f32 v156, v156, v157
    v_mul_f32 v156, s82, v156
    v_mov_b32 v157, v156
    s_nop 1
    v_permlane16_swap_b32_e64 v156, v157
    v_fma_f32 v112, v112, s82, -v156
    v_fma_f32 v113, v113, s82, -v156
    v_fma_f32 v114, v114, s82, -v156
    v_fma_f32 v115, v115, s82, -v156
    v_exp_f32 v112, v112
    v_exp_f32 v113, v113
    v_exp_f32 v114, v114
    v_exp_f32 v115, v115
    v_cvt_pk_bf16_f32 v116, v112, v113
    v_cvt_pk_bf16_f32 v117, v114, v115
    v_bfi_b32 v128, v36, 0, v116
    v_and_b32 v130, v36, v116
    v_bfi_b32 v129, v37, 0, v117
    v_and_b32 v131, v37, v117
    s_waitcnt lgkmcnt(3)
    s_nop 0
    v_mfma_f32_16x16x32_bf16 v[144:147], v[106:109], v[128:131], 0
    s_waitcnt lgkmcnt(2)
    v_mfma_f32_16x16x32_bf16 v[136:139], v[100:103], v[128:131], 0
    v_fma_f32 v120, v120, s82, -v157
    v_fma_f32 v121, v121, s82, -v157
    v_fma_f32 v122, v122, s82, -v157
    v_fma_f32 v123, v123, s82, -v157
    v_exp_f32 v120, v120
    v_exp_f32 v121, v121
    v_exp_f32 v122, v122
    v_exp_f32_e64 v123, v123
    v_cvt_pk_bf16_f32 v124, v120, v121
    v_cvt_pk_bf16_f32 v125, v122, v123
    v_bfi_b32 v132, v36, 0, v124
    v_and_b32 v134, v36, v124
    v_bfi_b32 v133, v37, 0, v125
    v_and_b32 v135, v37, v125
    s_waitcnt lgkmcnt(1)
    s_nop 0
    v_mfma_f32_16x16x32_bf16 v[148:151], v[108:111], v[132:135], 0
    s_waitcnt lgkmcnt(0)
    v_mfma_f32_16x16x32_bf16 v[140:143], v[102:105], v[132:135], 0
    v_mov_b32 v158, v144
    s_nop 1
    v_permlane16_swap_b32 v144, v158
    v_rcp_f32 v158, v158
    s_nop 0
    v_pk_mul_f32 v[136:137], v[136:137], v[158:159] op_sel_hi:[1,0]
    v_pk_mul_f32 v[138:139], v[138:139], v[158:159] op_sel_hi:[1,0]
    v_pk_mul_f32 v[144:145], v[144:145], v[158:159] op_sel_hi:[1,0]
    v_pk_mul_f32 v[146:147], v[146:147], v[158:159] op_sel_hi:[1,0]
    v_cvt_pk_bf16_f32 v112, v136, v137
    v_cvt_pk_bf16_f32 v116, v144, v145
    v_cvt_pk_bf16_f32 v113, v138, v139
    v_cvt_pk_bf16_f32 v117, v146, v147
    v_mov_b32 v160, v148
    s_nop 1
    v_permlane16_swap_b32 v148, v160
    v_rcp_f32_e64 v160, v160
    s_nop 0
    v_pk_mul_f32 v[140:141], v[140:141], v[160:161] op_sel_hi:[1,0]
    v_pk_mul_f32 v[142:143], v[142:143], v[160:161] op_sel_hi:[1,0]
    v_pk_mul_f32 v[148:149], v[148:149], v[160:161] op_sel_hi:[1,0]
    v_pk_mul_f32 v[150:151], v[150:151], v[160:161] op_sel_hi:[1,0]
    v_cvt_pk_bf16_f32 v114, v140, v141
    v_cvt_pk_bf16_f32 v118, v148, v149
    v_cvt_pk_bf16_f32 v115, v142, v143
    v_cvt_pk_bf16_f32 v119, v150, v151
    v_permlane16_swap_b32 v112, v114
    v_permlane16_swap_b32 v113, v115
    v_permlane16_swap_b32 v116, v118
    v_permlane16_swap_b32 v117, v119
    buffer_store_dwordx4 v[112:115], v45, s[16:19], s25 offen sc1
    s_mov_b64 exec, s[80:81]
    buffer_store_dwordx2 v[116:117], v46, s[16:19], s26 offen sc1
    s_mov_b64 exec, -1
oe_75:
    s_waitcnt vmcnt(15)
    v_mfma_f32_16x16x32_bf16 v[112:115], a[176:179], v[216:219], 0
    v_mov_b32 v136, 0
    v_mov_b32 v137, 0
    s_waitcnt vmcnt(14)
    v_mfma_f32_16x16x32_bf16 v[116:119], a[176:179], v[220:223], 0
    v_mov_b32 v138, 0
    v_mov_b32 v139, 0
    s_waitcnt vmcnt(13)
    v_mfma_f32_16x16x32_bf16 v[112:115], a[196:199], v[224:227], v[112:115]
    v_mov_b32 v140, 0
    v_mov_b32 v141, 0
    s_waitcnt vmcnt(12)
    v_mfma_f32_16x16x32_bf16 v[116:119], a[196:199], v[228:231], v[116:119]
    s_mov_b32 s25, 14680064
    s_add_u32 s26, s36, 14680064
    s_waitcnt vmcnt(11)
    v_mfma_f32_16x16x32_bf16 v[112:115], a[216:219], v[232:235], v[112:115]
    s_add_u32 s27, s35, 3506176
    s_mov_b32 s28, 0x99999999
    s_waitcnt vmcnt(10)
    v_mfma_f32_16x16x32_bf16 v[116:119], a[216:219], v[236:239], v[116:119]
    s_mov_b32 s29, 0x99999999
    s_waitcnt vmcnt(9)
    v_mfma_f32_16x16x32_bf16 v[112:115], a[236:239], v[240:243], v[112:115]
    s_waitcnt vmcnt(8)
    v_mfma_f32_16x16x32_bf16 v[116:119], a[236:239], v[244:247], v[116:119]
    s_waitcnt vmcnt(5)
    v_mfma_f32_16x16x32_bf16 v[112:115], v[52:55], v[248:251], v[112:115]
    s_waitcnt vmcnt(4)
    v_mfma_f32_16x16x32_bf16 v[116:119], v[52:55], v[252:255], v[116:119]
    v_mfma_f32_16x16x32_bf16 v[88:91], a[164:167], v[216:219], 0
    v_mfma_f32_16x16x32_bf16 v[92:95], a[164:167], v[220:223], 0
    v_mfma_f32_16x16x32_bf16 v[88:91], a[184:187], v[224:227], v[88:91]
    s_waitcnt vmcnt(3)
    v_max3_u32 v132, v208, v209, v210
    s_waitcnt vmcnt(2)
    v_max3_u32 v132, v132, v211, v212
    v_mfma_f32_16x16x32_bf16 v[92:95], a[184:187], v[228:231], v[92:95]
    v_cmp_eq_u32 s[82:83], -1, v132
    v_mfma_f32_16x16x32_bf16 v[88:91], a[204:207], v[232:235], v[88:91]
    v_mfma_f32_16x16x32_bf16 v[92:95], a[204:207], v[236:239], v[92:95]
    v_cmp_u_f32 vcc, v112, v116
    s_nop 0
    s_or_b64 vcc, vcc, s[82:83]
    s_cbranch_vccnz rd_76
rc_77:
    v_mfma_f32_16x16x32_bf16 v[88:91], a[224:227], v[240:243], v[88:91]
    ds_write_b128 v203, v[112:115] offset:24576
    v_mfma_f32_16x16x32_bf16 v[92:95], a[224:227], v[244:247], v[92:95]
    v_mfma_f32_16x16x32_bf16 v[88:91], a[244:247], v[248:251], v[88:91]
    ds_write_b128 v203, v[116:119] offset:25600
    v_mfma_f32_16x16x32_bf16 v[92:95], a[244:247], v[252:255], v[92:95]
    v_mfma_f32_16x16x32_bf16 v[96:99], a[168:171], v[216:219], 0
    v_lshlrev_b32_e64 v120, 16, v208
    v_and_b32 v121, 0xffff0000, v208
    v_mfma_f32_16x16x32_bf16 v[100:103], a[168:171], v[220:223], 0
    v_lshlrev_b32_e64 v122, 16, v209
    v_and_b32 v123, 0xffff0000, v209
    v_mfma_f32_16x16x32_bf16 v[96:99], a[188:191], v[224:227], v[96:99]
    v_lshlrev_b32_e64 v124, 16, v210
    v_and_b32 v125, 0xffff0000, v210
    v_mfma_f32_16x16x32_bf16 v[100:103], a[188:191], v[228:231], v[100:103]
    v_lshlrev_b32_e64 v126, 16, v211
    v_and_b32 v127, 0xffff0000, v211
    v_mfma_f32_16x16x32_bf16 v[96:99], a[208:211], v[232:235], v[96:99]
    v_lshlrev_b32_e64 v128, 16, v212
    v_and_b32 v129, 0xffff0000, v212
    v_mfma_f32_16x16x32_bf16 v[100:103], a[208:211], v[236:239], v[100:103]
    v_mfma_f32_16x16x32_bf16 v[96:99], a[228:231], v[240:243], v[96:99]
    ds_write_b128 v200, v[88:91] offset:0
    v_mfma_f32_16x16x32_bf16 v[100:103], a[228:231], v[244:247], v[100:103]
    v_mfma_f32_16x16x32_bf16 v[96:99], a[248:251], v[248:251], v[96:99]
    ds_write_b128 v200, v[92:95] offset:1024
    v_mfma_f32_16x16x32_bf16 v[100:103], a[248:251], v[252:255], v[100:103]
    v_mfma_f32_16x16x32_bf16 v[104:107], a[172:175], v[216:219], 0
    v_mfma_f32_16x16x32_bf16 v[108:111], a[172:175], v[220:223], 0
    v_mfma_f32_16x16x32_bf16 v[104:107], a[192:195], v[224:227], v[104:107]
    v_mfma_f32_16x16x32_bf16 v[108:111], a[192:195], v[228:231], v[108:111]
    v_mfma_f32_16x16x32_bf16 v[104:107], a[212:215], v[232:235], v[104:107]
    v_mfma_f32_16x16x32_bf16 v[108:111], a[212:215], v[236:239], v[108:111]
    v_mfma_f32_16x16x32_bf16 v[104:107], a[232:235], v[240:243], v[104:107]
    ds_write_b128 v201, v[96:99] offset:2048
    v_mfma_f32_16x16x32_bf16 v[108:111], a[232:235], v[244:247], v[108:111]
    v_mfma_f32_16x16x32_bf16 v[104:107], a[252:255], v[248:251], v[104:107]
    ds_write_b128 v201, v[100:103] offset:3072
    v_mfma_f32_16x16x32_bf16 v[108:111], a[252:255], v[252:255], v[108:111]
    v_mfma_f32_16x16x32_bf16 v[80:83], a[160:163], v[216:219], v[120:123]
    v_mfma_f32_16x16x32_bf16 v[84:87], a[160:163], v[220:223], v[124:127]
    v_mfma_f32_16x16x32_bf16 v[80:83], a[180:183], v[224:227], v[80:83]
    v_mfma_f32_16x16x32_bf16 v[84:87], a[180:183], v[228:231], v[84:87]
    v_mfma_f32_16x16x32_bf16 v[80:83], a[200:203], v[232:235], v[80:83]
    s_nop 0
    ds_write_b128 v202, v[104:107] offset:4096
    v_mfma_f32_16x16x32_bf16 v[84:87], a[200:203], v[236:239], v[84:87]
    ds_write_b128 v202, v[108:111] offset:5120
    v_mfma_f32_16x16x32_bf16 v[80:83], a[220:223], v[240:243], v[80:83]
    v_mfma_f32_16x16x32_bf16 v[84:87], a[220:223], v[244:247], v[84:87]
    v_mfma_f32_16x16x32_bf16 v[80:83], a[240:243], v[248:251], v[80:83]
    v_mfma_f32_16x16x32_bf16 v[84:87], a[240:243], v[252:255], v[84:87]
    s_waitcnt lgkmcnt(0)
    s_barrier
    s_nop 0
    ds_read_b128 v[88:91], v204 offset:0
    ds_read_b128 v[92:95], v204 offset:1024
    ds_read_b128 v[96:99], v204 offset:2048
    ds_read_b128 v[100:103], v204 offset:3072
    ds_read_b128 v[104:107], v204 offset:4096
    ds_read_b128 v[108:111], v204 offset:5120
    ds_read_b64 v[112:113], v205 offset:24576
    ds_read_b64 v[114:115], v205 offset:26624
    ds_read_b64 v[116:117], v205 offset:28672
    ds_read_b64 v[118:119], v205 offset:30720
    s_mov_b32 s96, 12062720
    buffer_load_dwordx4 v[216:219], v56, s[16:19], s96 offen offset:0 sc1
    buffer_load_dwordx4 v[220:223], v56, s[16:19], s96 offen offset:256 sc1
    s_mov_b32 s96, 12095488
    buffer_load_dwordx4 v[224:227], v56, s[16:19], s96 offen offset:0 sc1
    buffer_load_dwordx4 v[228:231], v56, s[16:19], s96 offen offset:256 sc1
    s_mov_b32 s96, 12128256
    buffer_load_dwordx4 v[232:235], v56, s[16:19], s96 offen offset:0 sc1
    buffer_load_dwordx4 v[236:239], v56, s[16:19], s96 offen offset:256 sc1
    s_waitcnt lgkmcnt(9)
    v_pk_add_f32 v[80:81], v[80:81], v[88:89]
    v_pk_add_f32 v[82:83], v[82:83], v[90:91]
    s_waitcnt lgkmcnt(8)
    v_pk_add_f32 v[84:85], v[84:85], v[92:93]
    v_pk_add_f32 v[86:87], v[86:87], v[94:95]
    s_waitcnt lgkmcnt(7)
    v_pk_add_f32 v[80:81], v[80:81], v[96:97]
    v_pk_add_f32 v[82:83], v[82:83], v[98:99]
    s_waitcnt lgkmcnt(6)
    v_pk_add_f32 v[84:85], v[84:85], v[100:101]
    v_pk_add_f32 v[86:87], v[86:87], v[102:103]
    s_waitcnt lgkmcnt(5)
    v_pk_add_f32 v[80:81], v[80:81], v[104:105]
    v_pk_add_f32 v[82:83], v[82:83], v[106:107]
    s_waitcnt lgkmcnt(4)
    v_pk_add_f32 v[84:85], v[84:85], v[108:109]
    v_pk_add_f32 v[86:87], v[86:87], v[110:111]
    v_cvt_pk_bf16_f32 v132, v80, v81
    v_cvt_pk_bf16_f32 v133, v82, v83
    v_cvt_pk_bf16_f32 v134, v84, v85
    v_cvt_pk_bf16_f32 v135, v86, v87
    s_waitcnt lgkmcnt(3)
    v_pk_add_f32 v[128:129], v[128:129], v[112:113]
    s_waitcnt lgkmcnt(2)
    v_pk_add_f32 v[128:129], v[128:129], v[114:115]
    s_waitcnt lgkmcnt(1)
    v_pk_add_f32 v[128:129], v[128:129], v[116:117]
    s_waitcnt lgkmcnt(0)
    v_pk_add_f32 v[128:129], v[128:129], v[118:119]
    v_cvt_pk_bf16_f32 v130, v128, v129
    buffer_store_dwordx4 v[132:135], v59, s[16:19], s25 offen sc1
    buffer_store_dword v130, v61, s[16:19], s26 offen sc1
    v_dot2c_f32_bf16 v136, v132, v215
    v_dot2c_f32_bf16 v137, v132, v132
    v_dot2c_f32_bf16 v136, v133, v215
    v_dot2c_f32_bf16 v137, v133, v133
    v_dot2c_f32_bf16 v138, v134, v215
    v_dot2c_f32_bf16 v139, v134, v134
    v_dot2c_f32_bf16 v138, v135, v215
    v_dot2c_f32_bf16 v139, v135, v135
    v_dot2c_f32_bf16 v140, v130, v215
    v_dot2c_f32_bf16 v141, v130, v130
    v_permlane32_swap_b32 v136, v138
    v_permlane32_swap_b32 v137, v139
    v_pk_add_f32 v[136:137], v[136:137], v[138:139]
    v_pk_add_f32 v[136:137], v[136:137], v[140:141]
    s_nop 1
    v_permlane16_swap_b32 v136, v137
    v_add_f32_e64 v136, v136, v137
    ds_write_b32 v206, v136 offset:32768
    s_mov_b32 s96, 12161024
    buffer_load_dwordx4 v[240:243], v56, s[16:19], s96 offen offset:0 sc1
    buffer_load_dwordx4 v[244:247], v56, s[16:19], s96 offen offset:256 sc1
    s_mov_b32 s96, 12060672
    buffer_load_dwordx2 v[248:249], v57, s[16:19], s96 offen offset:0 sc1
    buffer_load_dwordx2 v[252:253], v57, s[16:19], s96 offen offset:128 sc1
    s_mov_b32 s96, 12077056
    buffer_load_dwordx2 v[250:251], v57, s[16:19], s96 offen offset:0 sc1
    buffer_load_dwordx2 v[254:255], v57, s[16:19], s96 offen offset:128 sc1
    s_mov_b32 s96, 9439232
    buffer_load_dwordx4 v[208:211], v59, s[16:19], s96 offen sc1
    s_add_u32 s97, s36, 9439232
    buffer_load_dword v212, v61, s[16:19], s97 offen sc1
    s_waitcnt lgkmcnt(0)
    s_barrier
    ds_read2st64_b32 v[136:137], v207 offset0:0 offset1:1
    ds_read2st64_b32 v[138:139], v207 offset0:2 offset1:3
    ds_read_b64_tr_b16 v[144:145], v65 offset:32
    ds_read_b64_tr_b16 v[146:147], v65 offset:0
    ds_read_b64_tr_b16 v[148:149], v65 offset:160
    ds_read_b64_tr_b16 v[150:151], v65 offset:128
    ds_read_b64_tr_b16 v[152:153], v65 offset:288
    ds_read_b64_tr_b16 v[154:155], v65 offset:256
    ds_read_b64_tr_b16 v[156:157], v65 offset:416
    ds_read_b64_tr_b16 v[158:159], v65 offset:384
    ds_read_b64_tr_b16 v[160:161], v65 offset:544
    ds_read_b64_tr_b16 v[162:163], v65 offset:512
    ds_read_b64_tr_b16 v[164:165], v65 offset:672
    ds_read_b64_tr_b16 v[166:167], v65 offset:640
    ds_read_b64_tr_b16 v[168:169], v65 offset:800
    ds_read_b64_tr_b16 v[170:171], v65 offset:768
    ds_read_b64_tr_b16 v[172:173], v65 offset:928
    ds_read_b64_tr_b16 v[174:175], v65 offset:896
    s_waitcnt lgkmcnt(15)
    v_pk_add_f32 v[136:137], v[136:137], v[138:139]
    v_add_f32 v136, v136, v137
    v_cndmask_b32 v136, v136, 1.0, s[28:29]
    s_mov_b64 exec, s[80:81]
    buffer_atomic_add_f32 v136, v214, s[16:19], s27 offen
    s_mov_b64 exec, -1
    v_lshrrev_b32 v176, 4, v0
    v_mul_u32_u24 v176, 1216, v176
    v_and_b32 v177, 15, v0
    v_lshl_add_u32 v176, v177, 3, v176
    v_add_u32 v176, 64, v176
    v_mov_b32 v178, 0
    v_mov_b32 v179, 0
    ds_write_b64 v176, v[178:179]
    v_mov_b32 v70, 0
    v_mov_b32 v71, 0
    v_mov_b32 v72, 0
oe_78:
    s_waitcnt vmcnt(16)
    v_mfma_f32_16x16x32_bf16 v[112:115], a[176:179], v[216:219], 0
    v_mov_b32 v136, 0
    v_mov_b32 v137, 0
    s_waitcnt vmcnt(15)
    v_mfma_f32_16x16x32_bf16 v[116:119], a[176:179], v[220:223], 0
    v_mov_b32 v138, 0
    v_mov_b32 v139, 0
    s_waitcnt vmcnt(14)
    v_mfma_f32_16x16x32_bf16 v[112:115], a[196:199], v[224:227], v[112:115]
    v_mov_b32 v140, 0
    v_mov_b32 v141, 0
    s_waitcnt vmcnt(13)
    v_mfma_f32_16x16x32_bf16 v[116:119], a[196:199], v[228:231], v[116:119]
    s_mov_b32 s25, 14682112
    s_add_u32 s26, s36, 14682112
    s_waitcnt vmcnt(12)
    v_mfma_f32_16x16x32_bf16 v[112:115], a[216:219], v[232:235], v[112:115]
    s_add_u32 s27, s35, 3510272
    s_mov_b32 s28, 0x99999999
    s_waitcnt vmcnt(11)
    v_mfma_f32_16x16x32_bf16 v[116:119], a[216:219], v[236:239], v[116:119]
    s_mov_b32 s29, 0x99999999
    s_waitcnt vmcnt(8)
    v_mfma_f32_16x16x32_bf16 v[112:115], a[236:239], v[240:243], v[112:115]
    s_waitcnt vmcnt(7)
    v_mfma_f32_16x16x32_bf16 v[116:119], a[236:239], v[244:247], v[116:119]
    s_waitcnt vmcnt(4)
    v_mfma_f32_16x16x32_bf16 v[112:115], v[52:55], v[248:251], v[112:115]
    s_waitcnt vmcnt(3)
    v_mfma_f32_16x16x32_bf16 v[116:119], v[52:55], v[252:255], v[116:119]
    v_mfma_f32_16x16x32_bf16 v[88:91], a[164:167], v[216:219], 0
    v_mfma_f32_16x16x32_bf16 v[92:95], a[164:167], v[220:223], 0
    v_mfma_f32_16x16x32_bf16 v[88:91], a[184:187], v[224:227], v[88:91]
    s_waitcnt vmcnt(2)
    v_max3_u32 v132, v208, v209, v210
    s_waitcnt vmcnt(1)
    v_max3_u32 v132, v132, v211, v212
    v_mfma_f32_16x16x32_bf16 v[92:95], a[184:187], v[228:231], v[92:95]
    v_cmp_eq_u32 s[82:83], -1, v132
    v_mfma_f32_16x16x32_bf16 v[88:91], a[204:207], v[232:235], v[88:91]
    v_mfma_f32_16x16x32_bf16 v[92:95], a[204:207], v[236:239], v[92:95]
    v_cmp_u_f32 vcc, v112, v116
    s_nop 0
    s_or_b64 vcc, vcc, s[82:83]
    s_cbranch_vccnz rd_79
rc_80:
    v_mfma_f32_16x16x32_bf16 v[88:91], a[224:227], v[240:243], v[88:91]
    ds_write_b128 v203, v[112:115] offset:24576
    v_mfma_f32_16x16x32_bf16 v[92:95], a[224:227], v[244:247], v[92:95]
    v_mfma_f32_16x16x32_bf16 v[88:91], a[244:247], v[248:251], v[88:91]
    ds_write_b128 v203, v[116:119] offset:25600
    v_mfma_f32_16x16x32_bf16 v[92:95], a[244:247], v[252:255], v[92:95]
    v_mfma_f32_16x16x32_bf16 v[96:99], a[168:171], v[216:219], 0
    v_lshlrev_b32_e64 v120, 16, v208
    v_and_b32 v121, 0xffff0000, v208
    v_mfma_f32_16x16x32_bf16 v[100:103], a[168:171], v[220:223], 0
    v_lshlrev_b32_e64 v122, 16, v209
    v_and_b32 v123, 0xffff0000, v209
    v_mfma_f32_16x16x32_bf16 v[96:99], a[188:191], v[224:227], v[96:99]
    v_lshlrev_b32_e64 v124, 16, v210
    v_and_b32 v125, 0xffff0000, v210
    v_mfma_f32_16x16x32_bf16 v[100:103], a[188:191], v[228:231], v[100:103]
    v_lshlrev_b32_e64 v126, 16, v211
    v_and_b32 v127, 0xffff0000, v211
    v_mfma_f32_16x16x32_bf16 v[96:99], a[208:211], v[232:235], v[96:99]
    v_lshlrev_b32_e64 v128, 16, v212
    v_and_b32 v129, 0xffff0000, v212
    v_mfma_f32_16x16x32_bf16 v[100:103], a[208:211], v[236:239], v[100:103]
    v_mfma_f32_16x16x32_bf16 v[96:99], a[228:231], v[240:243], v[96:99]
    ds_write_b128 v200, v[88:91] offset:0
    v_mfma_f32_16x16x32_bf16 v[100:103], a[228:231], v[244:247], v[100:103]
    v_mfma_f32_16x16x32_bf16 v[96:99], a[248:251], v[248:251], v[96:99]
    ds_write_b128 v200, v[92:95] offset:1024
    v_mfma_f32_16x16x32_bf16 v[100:103], a[248:251], v[252:255], v[100:103]
    v_mfma_f32_16x16x32_bf16 v[104:107], a[172:175], v[216:219], 0
    v_mfma_f32_16x16x32_bf16 v[108:111], a[172:175], v[220:223], 0
    v_mfma_f32_16x16x32_bf16 v[104:107], a[192:195], v[224:227], v[104:107]
    v_mfma_f32_16x16x32_bf16 v[108:111], a[192:195], v[228:231], v[108:111]
    v_mfma_f32_16x16x32_bf16 v[104:107], a[212:215], v[232:235], v[104:107]
    v_mfma_f32_16x16x32_bf16 v[108:111], a[212:215], v[236:239], v[108:111]
    v_mfma_f32_16x16x32_bf16 v[104:107], a[232:235], v[240:243], v[104:107]
    ds_write_b128 v201, v[96:99] offset:2048
    v_mfma_f32_16x16x32_bf16 v[108:111], a[232:235], v[244:247], v[108:111]
    v_mfma_f32_16x16x32_bf16 v[104:107], a[252:255], v[248:251], v[104:107]
    ds_write_b128 v201, v[100:103] offset:3072
    v_mfma_f32_16x16x32_bf16 v[108:111], a[252:255], v[252:255], v[108:111]
    v_mfma_f32_16x16x32_bf16 v[80:83], a[160:163], v[216:219], v[120:123]
    v_mfma_f32_16x16x32_bf16 v[84:87], a[160:163], v[220:223], v[124:127]
    v_mfma_f32_16x16x32_bf16 v[80:83], a[180:183], v[224:227], v[80:83]
    v_mfma_f32_16x16x32_bf16 v[84:87], a[180:183], v[228:231], v[84:87]
    v_mfma_f32_16x16x32_bf16 v[80:83], a[200:203], v[232:235], v[80:83]
    s_nop 0
    ds_write_b128 v202, v[104:107] offset:4096
    v_mfma_f32_16x16x32_bf16 v[84:87], a[200:203], v[236:239], v[84:87]
    ds_write_b128 v202, v[108:111] offset:5120
    v_mfma_f32_16x16x32_bf16 v[80:83], a[220:223], v[240:243], v[80:83]
    v_mfma_f32_16x16x32_bf16 v[84:87], a[220:223], v[244:247], v[84:87]
    v_mfma_f32_16x16x32_bf16 v[80:83], a[240:243], v[248:251], v[80:83]
    v_mfma_f32_16x16x32_bf16 v[84:87], a[240:243], v[252:255], v[84:87]
    s_waitcnt lgkmcnt(0)
    s_barrier
    s_nop 0
    ds_read_b128 v[88:91], v204 offset:0
    ds_read_b128 v[92:95], v204 offset:1024
    ds_read_b128 v[96:99], v204 offset:2048
    ds_read_b128 v[100:103], v204 offset:3072
    ds_read_b128 v[104:107], v204 offset:4096
    ds_read_b128 v[108:111], v204 offset:5120
    ds_read_b64 v[112:113], v205 offset:24576
    ds_read_b64 v[114:115], v205 offset:26624
    ds_read_b64 v[116:117], v205 offset:28672
    ds_read_b64 v[118:119], v205 offset:30720
    s_lshl_b32 s96, s75, 14
    s_add_u32 s96, s96, 14680064
    s_lshl_b32 s97, s24, 12
    s_add_u32 s97, s97, 3506176
    buffer_load_dwordx4 v[176:179], v62, s[16:19], s96 offen offset:0 sc1
    buffer_load_dwordx4 v[180:183], v62, s[16:19], s96 offen offset:1024 sc1
    buffer_load_dwordx4 v[184:187], v62, s[16:19], s97 offen offset:0 sc1
    buffer_load_dwordx4 v[188:191], v62, s[16:19], s97 offen offset:1024 sc1
    buffer_load_dwordx4 v[192:195], v62, s[16:19], s97 offen offset:2048 sc1
    buffer_load_dwordx4 v[196:199], v62, s[16:19], s97 offen offset:3072 sc1
    s_waitcnt lgkmcnt(9)
    v_pk_add_f32 v[80:81], v[80:81], v[88:89]
    v_pk_add_f32 v[82:83], v[82:83], v[90:91]
    s_waitcnt lgkmcnt(8)
    v_pk_add_f32 v[84:85], v[84:85], v[92:93]
    v_pk_add_f32 v[86:87], v[86:87], v[94:95]
    s_waitcnt lgkmcnt(7)
    v_pk_add_f32 v[80:81], v[80:81], v[96:97]
    v_pk_add_f32 v[82:83], v[82:83], v[98:99]
    s_waitcnt lgkmcnt(6)
    v_pk_add_f32 v[84:85], v[84:85], v[100:101]
    v_pk_add_f32 v[86:87], v[86:87], v[102:103]
    s_waitcnt lgkmcnt(5)
    v_pk_add_f32 v[80:81], v[80:81], v[104:105]
    v_pk_add_f32 v[82:83], v[82:83], v[106:107]
    s_waitcnt lgkmcnt(4)
    v_pk_add_f32 v[84:85], v[84:85], v[108:109]
    v_pk_add_f32 v[86:87], v[86:87], v[110:111]
    v_cvt_pk_bf16_f32 v132, v80, v81
    v_cvt_pk_bf16_f32 v133, v82, v83
    v_cvt_pk_bf16_f32 v134, v84, v85
    v_cvt_pk_bf16_f32 v135, v86, v87
    s_waitcnt lgkmcnt(3)
    v_pk_add_f32 v[128:129], v[128:129], v[112:113]
    s_waitcnt lgkmcnt(2)
    v_pk_add_f32 v[128:129], v[128:129], v[114:115]
    s_waitcnt lgkmcnt(1)
    v_pk_add_f32 v[128:129], v[128:129], v[116:117]
    s_waitcnt lgkmcnt(0)
    v_pk_add_f32 v[128:129], v[128:129], v[118:119]
    v_cvt_pk_bf16_f32 v130, v128, v129
    buffer_store_dwordx4 v[132:135], v59, s[16:19], s25 offen sc1
    buffer_store_dword v130, v61, s[16:19], s26 offen sc1
    v_dot2c_f32_bf16 v136, v132, v215
    v_dot2c_f32_bf16 v137, v132, v132
    v_dot2c_f32_bf16 v136, v133, v215
    v_dot2c_f32_bf16 v137, v133, v133
    v_dot2c_f32_bf16 v138, v134, v215
    v_dot2c_f32_bf16 v139, v134, v134
    v_dot2c_f32_bf16 v138, v135, v215
    v_dot2c_f32_bf16 v139, v135, v135
    v_dot2c_f32_bf16 v140, v130, v215
    v_dot2c_f32_bf16 v141, v130, v130
    v_permlane32_swap_b32 v136, v138
    v_permlane32_swap_b32 v137, v139
    v_pk_add_f32 v[136:137], v[136:137], v[138:139]
    v_pk_add_f32 v[136:137], v[136:137], v[140:141]
    s_nop 1
    v_permlane16_swap_b32 v136, v137
    v_add_f32 v136, v136, v137
    ds_write_b32 v206, v136 offset:32768
    s_waitcnt lgkmcnt(0)
    s_barrier
    ds_read2st64_b32 v[136:137], v207 offset0:0 offset1:1
    ds_read2st64_b32 v[138:139], v207 offset0:2 offset1:3
    s_waitcnt lgkmcnt(0)
    v_pk_add_f32 v[136:137], v[136:137], v[138:139]
    v_add_f32 v136, v136, v137
    v_cndmask_b32 v136, v136, 1.0, s[28:29]
    s_mov_b64 exec, s[80:81]
    buffer_atomic_add_f32 v136, v214, s[16:19], s27 offen
    s_mov_b64 exec, -1
    s_cmp_ge_u32 s2, 160
    s_cbranch_scc1 nc_81
    s_waitcnt vmcnt(3)
ce_83:
    v_max3_u32 v208, v176, v177, v178
    v_max3_u32 v208, v208, v179, v180
    v_max3_u32 v208, v208, v181, v182
    v_max_u32 v208, v208, v183
    v_cmp_eq_u32 s[82:83], -1, v208
    v_min3_f32 v209, v184, v187, v188
    v_min3_f32 v209, v209, v191, v192
    v_min3_f32 v209, v209, v195, v196
    v_min_f32 v209, v209, v199
    v_cmp_neq_f32 vcc, 0x41000000, v209
    s_nop 0
    s_or_b64 vcc, vcc, s[82:83]
    s_cbranch_vccnz rd_84
rc_85:
    v_mul_f32 v208, 0x3acccccd, v185
    v_mul_f32 v209, 0x3acccccd, v189
    v_mul_f32 v186, 0x3acccccd, v186
    v_mul_f32 v190, 0x3acccccd, v190
    v_fma_f32 v186, -v208, v208, v186
    v_fma_f32 v190, -v209, v209, v190
    v_max_f32 v186, 0, v186
    v_max_f32 v190, 0, v190
    v_add_f32 v186, 0x3727c5ac, v186
    v_add_f32 v190, 0x3727c5ac, v190
    v_rsq_f32 v185, v186
    v_rsq_f32 v189, v190
    v_mul_f32 v186, -v208, v185
    v_mul_f32 v190, -v209, v189
    v_lshlrev_b32 v80, 16, v176
    v_and_b32 v82, 0xffff0000, v176
    v_lshlrev_b32 v84, 16, v177
    v_and_b32 v86, 0xffff0000, v177
    v_lshlrev_b32 v81, 16, v178
    v_and_b32 v83, 0xffff0000, v178
    v_lshlrev_b32 v85, 16, v179
    v_and_b32 v87, 0xffff0000, v179
    v_fma_f32 v208, v80, v185, v186
    v_fma_f32 v209, v81, v189, v190
    v_cvt_pk_bf16_f32 v176, v208, v209
    v_fma_f32 v208, v82, v185, v186
    v_fma_f32 v209, v83, v189, v190
    v_cvt_pk_bf16_f32 v177, v208, v209
    v_fma_f32 v208, v84, v185, v186
    v_fma_f32 v209, v85, v189, v190
    v_cvt_pk_bf16_f32 v178, v208, v209
    v_fma_f32 v208, v86, v185, v186
    v_fma_f32 v209, v87, v189, v190
    v_cvt_pk_bf16_f32 v179, v208, v209
    ds_write_b32 v63, v176 offset:0
    ds_write_b32 v63, v177 offset:4864
    ds_write_b32 v63, v178 offset:9728
    ds_write_b32 v63, v179 offset:14592
    v_mul_f32 v208, 0x3acccccd, v193
    v_mul_f32 v209, 0x3acccccd, v197
    v_mul_f32 v194, 0x3acccccd, v194
    v_mul_f32 v198, 0x3acccccd, v198
    v_fma_f32 v194, -v208, v208, v194
    v_fma_f32 v198, -v209, v209, v198
    v_max_f32 v194, 0, v194
    v_max_f32 v198, 0, v198
    v_add_f32 v194, 0x3727c5ac, v194
    v_add_f32 v198, 0x3727c5ac, v198
    v_rsq_f32 v193, v194
    v_rsq_f32 v197, v198
    v_mul_f32 v194, -v208, v193
    v_mul_f32 v198, -v209, v197
    v_lshlrev_b32 v88, 16, v180
    v_and_b32 v90, 0xffff0000, v180
    v_lshlrev_b32 v92, 16, v181
    v_and_b32 v94, 0xffff0000, v181
    v_lshlrev_b32 v89, 16, v182
    v_and_b32 v91, 0xffff0000, v182
    v_lshlrev_b32 v93, 16, v183
    v_and_b32 v95, 0xffff0000, v183
    v_fma_f32 v208, v88, v193, v194
    v_fma_f32 v209, v89, v197, v198
    v_cvt_pk_bf16_f32 v180, v208, v209
    v_fma_f32 v208, v90, v193, v194
    v_fma_f32 v209, v91, v197, v198
    v_cvt_pk_bf16_f32 v181, v208, v209
    v_fma_f32 v208, v92, v193, v194
    v_fma_f32 v209, v93, v197, v198
    v_cvt_pk_bf16_f32 v182, v208, v209
    v_fma_f32 v208, v94, v193, v194
    v_fma_f32 v209, v95, v197, v198
    v_cvt_pk_bf16_f32 v183, v208, v209
    ds_write_b32 v63, v180 offset:256
    ds_write_b32 v63, v181 offset:5120
    ds_write_b32 v63, v182 offset:9984
    ds_write_b32 v63, v183 offset:14848
    s_waitcnt lgkmcnt(0)
    s_barrier
    ds_read_b128 v[212:215], v64 offset:96
    ds_read_b128 v[216:219], v64 offset:64
    ds_read_b128 v[220:223], v64 offset:32
    ds_read_b128 v[224:227], v64 offset:0
    s_waitcnt lgkmcnt(3)
    v_mfma_f32_32x32x16_bf16 v[96:111], v[212:215], v[144:147], 0
    ds_read_b128 v[228:231], v64 offset:224
    ds_read_b64_tr_b16 v[176:177], v65 offset:1056
    ds_read_b64_tr_b16 v[178:179], v65 offset:1024
    ds_read_b64_tr_b16 v[180:181], v65 offset:1184
    ds_read_b64_tr_b16 v[182:183], v65 offset:1152
    s_waitcnt lgkmcnt(7)
    v_mfma_f32_32x32x16_bf16 v[96:111], v[216:219], v[148:151], v[96:111]
    ds_read_b128 v[232:235], v64 offset:192
    ds_read_b64_tr_b16 v[184:185], v65 offset:1312
    ds_read_b64_tr_b16 v[186:187], v65 offset:1280
    ds_read_b64_tr_b16 v[188:189], v65 offset:1440
    ds_read_b64_tr_b16 v[190:191], v65 offset:1408
    s_waitcnt lgkmcnt(11)
    v_mfma_f32_32x32x16_bf16 v[96:111], v[220:223], v[152:155], v[96:111]
    ds_read_b128 v[236:239], v64 offset:160
    ds_read_b64_tr_b16 v[192:193], v65 offset:1568
    ds_read_b64_tr_b16 v[194:195], v65 offset:1536
    ds_read_b64_tr_b16 v[196:197], v65 offset:1696
    ds_read_b64_tr_b16 v[198:199], v65 offset:1664
    s_waitcnt lgkmcnt(15)
    v_mfma_f32_32x32x16_bf16 v[96:111], v[224:227], v[156:159], v[96:111]
    ds_read_b128 v[240:243], v64 offset:128
    ds_read_b64_tr_b16 v[200:201], v65 offset:1824
    ds_read_b64_tr_b16 v[202:203], v65 offset:1792
    ds_read_b64_tr_b16 v[204:205], v65 offset:1952
    ds_read_b64_tr_b16 v[206:207], v65 offset:1920
    s_waitcnt lgkmcnt(15)
    v_mfma_f32_32x32x16_bf16 v[112:127], v[228:231], v[144:147], 0
    s_nop 4
    s_waitcnt lgkmcnt(14)
    v_mfma_f32_32x32x16_bf16 v[112:127], v[232:235], v[148:151], v[112:127]
    v_cndmask_b32 v208, v99, v72, s[76:77]
    v_cndmask_b32 v209, v103, v99, s[76:77]
    v_cndmask_b32 v210, v107, v103, s[76:77]
    v_cndmask_b32 v211, v111, v107, s[76:77]
    v_mov_b32_e64 v72, v111
    s_waitcnt lgkmcnt(9)
    v_mfma_f32_32x32x16_bf16 v[112:127], v[236:239], v[152:155], v[112:127]
    v_add_f32_dpp v98, v208, v98 wave_ror:1 row_mask:0xf bank_mask:0xf
    v_add_f32_dpp v102, v209, v102 wave_ror:1 row_mask:0xf bank_mask:0xf
    v_add_f32_dpp v106, v210, v106 wave_ror:1 row_mask:0xf bank_mask:0xf
    v_add_f32_dpp v110, v211, v110 wave_ror:1 row_mask:0xf bank_mask:0xf
    v_cndmask_b32 v208, v98, v71, s[76:77]
    s_waitcnt lgkmcnt(4)
    v_mfma_f32_32x32x16_bf16 v[112:127], v[240:243], v[156:159], v[112:127]
    v_cndmask_b32 v209, v102, v98, s[76:77]
    v_cndmask_b32 v210, v106, v102, s[76:77]
    v_cndmask_b32 v211, v110, v106, s[76:77]
    v_mov_b32 v71, v110
    v_add_f32_dpp v97, v208, v97 wave_ror:1 row_mask:0xf bank_mask:0xf
    v_add_f32_dpp v101, v209, v101 wave_ror:1 row_mask:0xf bank_mask:0xf
    v_mfma_f32_32x32x16_bf16 v[112:127], v[212:215], v[160:163], v[112:127]
    ds_read_b128 v[244:247], v64 offset:352
    v_add_f32_dpp v105, v210, v105 wave_ror:1 row_mask:0xf bank_mask:0xf
    v_add_f32_dpp v109, v211, v109 wave_ror:1 row_mask:0xf bank_mask:0xf
    v_cndmask_b32 v208, v97, v70, s[76:77]
    v_cndmask_b32 v209, v101, v97, s[76:77]
    v_cndmask_b32 v210, v105, v101, s[76:77]
    v_mfma_f32_32x32x16_bf16 v[112:127], v[216:219], v[164:167], v[112:127]
    ds_read_b128 v[216:219], v64 offset:320
    v_cndmask_b32 v211, v109, v105, s[76:77]
    v_mov_b32_e64 v70, v109
    v_add_f32_dpp v96, v208, v96 wave_ror:1 row_mask:0xf bank_mask:0xf
    v_add_f32_dpp v100, v209, v100 wave_ror:1 row_mask:0xf bank_mask:0xf
    v_add_f32_dpp v104, v210, v104 wave_ror:1 row_mask:0xf bank_mask:0xf
    v_mfma_f32_32x32x16_bf16 v[112:127], v[220:223], v[168:171], v[112:127]
    ds_read_b128 v[220:223], v64 offset:288
    v_add_f32_dpp v108, v211, v108 wave_ror:1 row_mask:0xf bank_mask:0xf
    ds_write_b32 v66, v96 offset:0
    v_mfma_f32_32x32x16_bf16 v[112:127], v[224:227], v[172:175], v[112:127]
    ds_read_b128 v[224:227], v64 offset:256
    ds_write_b32 v66, v100 offset:64
    ds_write_b32 v66, v104 offset:128
    s_waitcnt lgkmcnt(6)
    v_mfma_f32_32x32x16_bf16 v[128:143], v[244:247], v[144:147], 0
    ds_write_b32 v66, v108 offset:192
    s_nop 2
    s_waitcnt lgkmcnt(6)
    v_mfma_f32_32x32x16_bf16 v[128:143], v[216:219], v[148:151], v[128:143]
    s_nop 2
    v_cndmask_b32 v208, v115, v72, s[76:77]
    v_cndmask_b32 v209, v119, v115, s[76:77]
    s_waitcnt lgkmcnt(5)
    v_mfma_f32_32x32x16_bf16 v[128:143], v[220:223], v[152:155], v[128:143]
    v_cndmask_b32 v210, v123, v119, s[76:77]
    v_cndmask_b32 v211, v127, v123, s[76:77]
    v_mov_b32 v72, v127
    v_add_f32_dpp v114, v208, v114 wave_ror:1 row_mask:0xf bank_mask:0xf
    v_add_f32_dpp v118, v209, v118 wave_ror:1 row_mask:0xf bank_mask:0xf
    s_waitcnt lgkmcnt(3)
    v_mfma_f32_32x32x16_bf16 v[128:143], v[224:227], v[156:159], v[128:143]
    v_add_f32_dpp v122, v210, v122 wave_ror:1 row_mask:0xf bank_mask:0xf
    v_add_f32_dpp v126, v211, v126 wave_ror:1 row_mask:0xf bank_mask:0xf
    v_cndmask_b32 v208, v114, v71, s[76:77]
    v_cndmask_b32 v209, v118, v114, s[76:77]
    v_cndmask_b32 v210, v122, v118, s[76:77]
    v_cndmask_b32 v211, v126, v122, s[76:77]
    v_mfma_f32_32x32x16_bf16 v[128:143], v[228:231], v[160:163], v[128:143]
    v_mov_b32 v71, v126
    v_add_f32_dpp v113, v208, v113 wave_ror:1 row_mask:0xf bank_mask:0xf
    v_add_f32_dpp v117, v209, v117 wave_ror:1 row_mask:0xf bank_mask:0xf
    v_add_f32_dpp v121, v210, v121 wave_ror:1 row_mask:0xf bank_mask:0xf
    v_add_f32_dpp v125, v211, v125 wave_ror:1 row_mask:0xf bank_mask:0xf
    v_cndmask_b32 v208, v113, v70, s[76:77]
    v_mfma_f32_32x32x16_bf16 v[128:143], v[232:235], v[164:167], v[128:143]
    ds_read_b128 v[232:235], v64 offset:64
    v_cndmask_b32 v209, v117, v113, s[76:77]
    v_cndmask_b32 v210, v121, v117, s[76:77]
    v_cndmask_b32 v211, v125, v121, s[76:77]
    v_mov_b32_e64 v70, v125
    v_add_f32_dpp v112, v208, v112 wave_ror:1 row_mask:0xf bank_mask:0xf
    v_mfma_f32_32x32x16_bf16 v[128:143], v[236:239], v[168:171], v[128:143]
    ds_read_b128 v[236:239], v64 offset:32
    v_add_f32_dpp v116, v209, v116 wave_ror:1 row_mask:0xf bank_mask:0xf
    v_add_f32_dpp v120, v210, v120 wave_ror:1 row_mask:0xf bank_mask:0xf
    v_add_f32_dpp v124, v211, v124 wave_ror:1 row_mask:0xf bank_mask:0xf
    v_mfma_f32_32x32x16_bf16 v[128:143], v[240:243], v[172:175], v[128:143]
    ds_read_b128 v[240:243], v64 offset:0
    ds_write_b32 v66, v112 offset:256
    ds_write_b32 v66, v116 offset:320
    v_mfma_f32_32x32x16_bf16 v[128:143], v[212:215], v[176:179], v[128:143]
    ds_read_b128 v[212:215], v64 offset:480
    ds_write_b32 v66, v120 offset:384
    ds_write_b32 v66, v124 offset:448
    s_waitcnt lgkmcnt(7)
    v_mfma_f32_32x32x16_bf16 v[128:143], v[232:235], v[180:183], v[128:143]
    ds_read_b128 v[232:235], v64 offset:448
    s_waitcnt lgkmcnt(7)
    v_mfma_f32_32x32x16_bf16 v[128:143], v[236:239], v[184:187], v[128:143]
    ds_read_b128 v[236:239], v64 offset:416
    s_waitcnt lgkmcnt(7)
    v_mfma_f32_32x32x16_bf16 v[128:143], v[240:243], v[188:191], v[128:143]
    ds_read_b128 v[240:243], v64 offset:384
    s_nop 3
    s_waitcnt lgkmcnt(5)
    v_mfma_f32_32x32x16_bf16 v[112:127], v[212:215], v[144:147], 0
    s_nop 4
    s_waitcnt lgkmcnt(2)
    v_mfma_f32_32x32x16_bf16 v[112:127], v[232:235], v[148:151], v[112:127]
    v_cndmask_b32 v208, v131, v72, s[76:77]
    v_cndmask_b32 v209, v135, v131, s[76:77]
    v_cndmask_b32 v210, v139, v135, s[76:77]
    v_cndmask_b32 v211, v143, v139, s[76:77]
    v_mov_b32_e64 v72, v143
    s_waitcnt lgkmcnt(1)
    v_mfma_f32_32x32x16_bf16 v[112:127], v[236:239], v[152:155], v[112:127]
    v_add_f32_dpp v130, v208, v130 wave_ror:1 row_mask:0xf bank_mask:0xf
    v_add_f32_dpp v134, v209, v134 wave_ror:1 row_mask:0xf bank_mask:0xf
    v_add_f32_dpp v138, v210, v138 wave_ror:1 row_mask:0xf bank_mask:0xf
    v_add_f32_dpp v142, v211, v142 wave_ror:1 row_mask:0xf bank_mask:0xf
    v_cndmask_b32 v208, v130, v71, s[76:77]
    s_waitcnt lgkmcnt(0)
    v_mfma_f32_32x32x16_bf16 v[112:127], v[240:243], v[156:159], v[112:127]
    v_cndmask_b32 v209, v134, v130, s[76:77]
    v_cndmask_b32 v210, v138, v134, s[76:77]
    v_cndmask_b32 v211, v142, v138, s[76:77]
    v_mov_b32 v71, v142
    v_add_f32_dpp v129, v208, v129 wave_ror:1 row_mask:0xf bank_mask:0xf
    v_add_f32_dpp v133, v209, v133 wave_ror:1 row_mask:0xf bank_mask:0xf
    v_mfma_f32_32x32x16_bf16 v[112:127], v[244:247], v[160:163], v[112:127]
    v_add_f32_dpp v137, v210, v137 wave_ror:1 row_mask:0xf bank_mask:0xf
    v_add_f32_dpp v141, v211, v141 wave_ror:1 row_mask:0xf bank_mask:0xf
    v_cndmask_b32 v208, v129, v70, s[76:77]
    v_cndmask_b32 v209, v133, v129, s[76:77]
    v_cndmask_b32 v210, v137, v133, s[76:77]
    v_cndmask_b32 v211, v141, v137, s[76:77]
    v_mfma_f32_32x32x16_bf16 v[112:127], v[216:219], v[164:167], v[112:127]
    ds_read_b128 v[240:243], v64 offset:192
    v_mov_b32_e64 v70, v141
    v_add_f32_dpp v128, v208, v128 wave_ror:1 row_mask:0xf bank_mask:0xf
    v_add_f32_dpp v132, v209, v132 wave_ror:1 row_mask:0xf bank_mask:0xf
    v_add_f32_dpp v136, v210, v136 wave_ror:1 row_mask:0xf bank_mask:0xf
    v_add_f32_dpp v140, v211, v140 wave_ror:1 row_mask:0xf bank_mask:0xf
    v_mfma_f32_32x32x16_bf16 v[112:127], v[220:223], v[168:171], v[112:127]
    ds_read_b128 v[220:223], v64 offset:160
    ds_write_b32 v66, v128 offset:512
    ds_write_b32 v66, v132 offset:576
    v_mfma_f32_32x32x16_bf16 v[112:127], v[224:227], v[172:175], v[112:127]
    ds_read_b128 v[224:227], v64 offset:128
    ds_write_b32 v66, v136 offset:640
    ds_write_b32 v66, v140 offset:704
    v_mfma_f32_32x32x16_bf16 v[112:127], v[228:231], v[176:179], v[112:127]
    ds_read_b128 v[236:239], v64 offset:96
    s_waitcnt lgkmcnt(7)
    v_mfma_f32_32x32x16_bf16 v[112:127], v[240:243], v[180:183], v[112:127]
    ds_read_b128 v[240:243], v64 offset:64
    s_waitcnt lgkmcnt(7)
    v_mfma_f32_32x32x16_bf16 v[112:127], v[220:223], v[184:187], v[112:127]
    ds_read_b128 v[220:223], v64 offset:32
    s_waitcnt lgkmcnt(5)
    v_mfma_f32_32x32x16_bf16 v[112:127], v[224:227], v[188:191], v[112:127]
    ds_read_b128 v[224:227], v64 offset:0
    s_waitcnt lgkmcnt(3)
    v_mfma_f32_32x32x16_bf16 v[112:127], v[236:239], v[192:195], v[112:127]
    ds_read_b64_tr_b16 v[216:217], v65 offset:544
    ds_read_b64_tr_b16 v[218:219], v65 offset:512
    s_waitcnt lgkmcnt(4)
    v_mfma_f32_32x32x16_bf16 v[112:127], v[240:243], v[196:199], v[112:127]
    ds_read_b64_tr_b16 v[240:241], v65 offset:1056
    ds_read_b64_tr_b16 v[242:243], v65 offset:1024
    s_waitcnt lgkmcnt(5)
    v_mfma_f32_32x32x16_bf16 v[112:127], v[220:223], v[200:203], v[112:127]
    s_waitcnt lgkmcnt(4)
    v_mfma_f32_32x32x16_bf16 v[112:127], v[224:227], v[204:207], v[112:127]
    ds_read_b64_tr_b16 v[224:225], v65 offset:1568
    ds_read_b64_tr_b16 v[226:227], v65 offset:1536
    s_lshl_b32 s96, s75, 14
    s_add_u32 s96, s96, 14680064
    s_lshl_b32 s97, s24, 12
    s_add_u32 s97, s97, 3510272
    buffer_load_dwordx4 v[248:251], v62, s[16:19], s96 offen offset:2048 sc1
    s_waitcnt lgkmcnt(4)
    v_mfma_f32_32x32x16_bf16 v[144:159], v[212:215], v[216:219], 0
    s_nop 3
    v_cndmask_b32 v208, v115, v72, s[76:77]
    s_waitcnt lgkmcnt(2)
    v_mfma_f32_32x32x16_bf16 v[144:159], v[244:247], v[240:243], v[144:159]
    buffer_load_dwordx4 v[252:255], v62, s[16:19], s96 offen offset:3072 sc1
    v_cndmask_b32 v209, v119, v115, s[76:77]
    v_cndmask_b32 v210, v123, v119, s[76:77]
    v_cndmask_b32 v211, v127, v123, s[76:77]
    v_mov_b32_e64 v72, v127
    v_add_f32_dpp v114, v208, v114 wave_ror:1 row_mask:0xf bank_mask:0xf
    v_mfma_f32_32x32x16_bf16 v[160:175], v[212:215], v[240:243], 0
    ds_read_b64_tr_b16 v[216:217], v65 offset:2080
    ds_read_b64_tr_b16 v[218:219], v65 offset:2048
    v_add_f32_dpp v118, v209, v118 wave_ror:1 row_mask:0xf bank_mask:0xf
    v_add_f32_dpp v122, v210, v122 wave_ror:1 row_mask:0xf bank_mask:0xf
    v_add_f32_dpp v126, v211, v126 wave_ror:1 row_mask:0xf bank_mask:0xf
    s_waitcnt lgkmcnt(2)
    v_mfma_f32_32x32x16_bf16 v[144:159], v[228:231], v[224:227], v[144:159]
    buffer_load_dwordx4 v[96:99], v62, s[16:19], s97 offen offset:0 sc1
    v_cndmask_b32 v208, v114, v71, s[76:77]
    v_cndmask_b32 v209, v118, v114, s[76:77]
    v_cndmask_b32 v210, v122, v118, s[76:77]
    v_cndmask_b32 v211, v126, v122, s[76:77]
    v_mov_b32 v71, v126
    v_mfma_f32_32x32x16_bf16 v[160:175], v[244:247], v[224:227], v[160:175]
    v_add_f32_dpp v113, v208, v113 wave_ror:1 row_mask:0xf bank_mask:0xf
    v_add_f32_dpp v117, v209, v117 wave_ror:1 row_mask:0xf bank_mask:0xf
    v_add_f32_dpp v121, v210, v121 wave_ror:1 row_mask:0xf bank_mask:0xf
    v_add_f32_dpp v125, v211, v125 wave_ror:1 row_mask:0xf bank_mask:0xf
    v_cndmask_b32 v208, v113, v70, s[76:77]
    v_cndmask_b32 v209, v117, v113, s[76:77]
    v_mfma_f32_32x32x16_bf16 v[176:191], v[212:215], v[224:227], 0
    buffer_load_dwordx4 v[100:103], v62, s[16:19], s97 offen offset:1024 sc1
    v_cndmask_b32 v210, v121, v117, s[76:77]
    v_cndmask_b32 v211, v125, v121, s[76:77]
    v_mov_b32 v70, v125
    v_add_f32_dpp v112, v208, v112 wave_ror:1 row_mask:0xf bank_mask:0xf
    s_waitcnt lgkmcnt(0)
    v_mfma_f32_32x32x16_bf16 v[144:159], v[236:239], v[216:219], v[144:159]
    ds_read_b64_tr_b16 v[240:241], v65 offset:2592
    ds_read_b64_tr_b16 v[242:243], v65 offset:2560
    v_add_f32_dpp v116, v209, v116 wave_ror:1 row_mask:0xf bank_mask:0xf
    v_add_f32_dpp v120, v210, v120 wave_ror:1 row_mask:0xf bank_mask:0xf
    v_add_f32_dpp v124, v211, v124 wave_ror:1 row_mask:0xf bank_mask:0xf
    v_mfma_f32_32x32x16_bf16 v[160:175], v[228:231], v[216:219], v[160:175]
    buffer_load_dwordx4 v[104:107], v62, s[16:19], s97 offen offset:2048 sc1
    ds_write_b32 v66, v112 offset:768
    ds_write_b32 v66, v116 offset:832
    v_mfma_f32_32x32x16_bf16 v[176:191], v[244:247], v[216:219], v[176:191]
    ds_write_b32 v66, v120 offset:896
    ds_write_b32 v66, v124 offset:960
    v_mfma_f32_32x32x16_bf16 v[192:207], v[212:215], v[216:219], 0
    ds_read_b64_tr_b16 v[212:213], v65 offset:3104
    ds_read_b64_tr_b16 v[214:215], v65 offset:3072
    buffer_load_dwordx4 v[108:111], v62, s[16:19], s97 offen offset:3072 sc1
    s_waitcnt lgkmcnt(6)
    v_mfma_f32_32x32x16_bf16 v[160:175], v[236:239], v[240:243], v[160:175]
    v_mfma_f32_32x32x16_bf16 v[176:191], v[228:231], v[240:243], v[176:191]
    ds_read_b64_tr_b16 v[224:225], v65 offset:3616
    ds_read_b64_tr_b16 v[226:227], v65 offset:3584
    s_waitcnt lgkmcnt(4)
    s_barrier
    v_mfma_f32_32x32x16_bf16 v[192:207], v[244:247], v[240:243], v[192:207]
    ds_read_b64_tr_b16 v[244:245], v65 offset:672
    ds_read_b64_tr_b16 v[246:247], v65 offset:640
    ds_read_b64 v[112:113], v67 offset:0
    ds_read_b64 v[114:115], v67 offset:4224
    ds_read_b64 v[116:117], v67 offset:8448
    s_waitcnt lgkmcnt(7)
    v_mfma_f32_32x32x16_bf16 v[176:191], v[236:239], v[212:215], v[176:191]
    ds_read_b128 v[216:219], v64 offset:320
    ds_read_b64_tr_b16 v[240:241], v65 offset:1184
    ds_read_b64_tr_b16 v[242:243], v65 offset:1152
    ds_read_b64 v[118:119], v67 offset:12672
    ds_read_b64 v[120:121], v67 offset:512
    ds_read_b64 v[122:123], v67 offset:4736
    v_mfma_f32_32x32x16_bf16 v[192:207], v[228:231], v[212:215], v[192:207]
    ds_read_b64 v[124:125], v67 offset:8960
    ds_read_b64 v[126:127], v67 offset:13184
    s_waitcnt lgkmcnt(13)
    v_mfma_f32_32x32x16_bf16 v[192:207], v[236:239], v[224:227], v[192:207]
    ds_read_b128 v[228:231], v64 offset:192
    ds_read_b64_tr_b16 v[236:237], v65 offset:1696
    ds_read_b64_tr_b16 v[238:239], v65 offset:1664
    s_waitcnt lgkmcnt(14)
    v_mfma_f32_32x32x16_bf16 v[144:159], v[232:235], v[244:247], v[144:159]
    s_waitcnt lgkmcnt(8)
    v_mfma_f32_32x32x16_bf16 v[144:159], v[216:219], v[240:243], v[144:159]
    v_mfma_f32_32x32x16_bf16 v[160:175], v[232:235], v[240:243], v[160:175]
    ds_read_b128 v[212:215], v64 offset:64
    ds_read_b64_tr_b16 v[224:225], v65 offset:2208
    ds_read_b64_tr_b16 v[226:227], v65 offset:2176
    s_waitcnt lgkmcnt(6)
    v_add_f32 v112, v112, v80
    s_waitcnt lgkmcnt(3)
    v_mfma_f32_32x32x16_bf16 v[144:159], v[228:231], v[236:239], v[144:159]
    v_add_f32 v113, v113, v81
    v_add_f32 v114, v114, v82
    v_add_f32 v115, v115, v83
    v_add_f32 v116, v116, v84
    v_add_f32 v117, v117, v85
    v_add_f32 v118, v118, v86
    v_mfma_f32_32x32x16_bf16 v[160:175], v[216:219], v[236:239], v[160:175]
    v_add_f32_e64 v119, v119, v87
    v_cvt_pk_bf16_f32 v128, v112, v114
    v_cvt_pk_bf16_f32 v129, v116, v118
    v_cvt_pk_bf16_f32 v130, v113, v115
    v_cvt_pk_bf16_f32 v131, v117, v119
    s_mov_b32 s25, 0
    v_mfma_f32_32x32x16_bf16 v[176:191], v[232:235], v[236:239], v[176:191]
    buffer_store_dwordx2 v[128:129], v68, s[20:23], s25 offen
    s_mov_b32 s25, 5120
    buffer_store_dwordx2 v[130:131], v68, s[20:23], s25 offen
    v_add_f32 v120, v120, v88
    v_add_f32 v121, v121, v89
    s_waitcnt lgkmcnt(0)
    v_mfma_f32_32x32x16_bf16 v[144:159], v[212:215], v[224:227], v[144:159]
    ds_read_b64_tr_b16 v[244:245], v65 offset:2720
    ds_read_b64_tr_b16 v[246:247], v65 offset:2688
    v_add_f32 v122, v122, v90
    v_add_f32 v123, v123, v91
    v_add_f32 v124, v124, v92
    v_add_f32 v125, v125, v93
    v_mfma_f32_32x32x16_bf16 v[160:175], v[228:231], v[224:227], v[160:175]
    v_add_f32 v126, v126, v94
    v_add_f32 v127, v127, v95
    v_cvt_pk_bf16_f32 v132, v120, v122
    v_cvt_pk_bf16_f32 v133, v124, v126
    v_cvt_pk_bf16_f32 v134, v121, v123
    v_cvt_pk_bf16_f32 v135, v125, v127
    v_mfma_f32_32x32x16_bf16 v[176:191], v[216:219], v[224:227], v[176:191]
    s_mov_b32 s25, 655360
    buffer_store_dwordx2 v[132:133], v68, s[20:23], s25 offen
    s_mov_b32 s25, 660480
    buffer_store_dwordx2 v[134:135], v68, s[20:23], s25 offen
    ds_read_b64_tr_b16 v[112:113], v65 offset:32
    ds_read_b64_tr_b16 v[114:115], v65 offset:0
    v_mfma_f32_32x32x16_bf16 v[192:207], v[232:235], v[224:227], v[192:207]
    ds_read_b64_tr_b16 v[232:233], v65 offset:3232
    ds_read_b64_tr_b16 v[234:235], v65 offset:3200
    ds_read_b64_tr_b16 v[116:117], v65 offset:160
    ds_read_b64_tr_b16 v[118:119], v65 offset:128
    ds_read_b64_tr_b16 v[120:121], v65 offset:288
    s_waitcnt lgkmcnt(7)
    v_mfma_f32_32x32x16_bf16 v[160:175], v[212:215], v[244:247], v[160:175]
    ds_read_b64_tr_b16 v[122:123], v65 offset:256
    ds_read_b64_tr_b16 v[124:125], v65 offset:416
    ds_read_b64_tr_b16 v[126:127], v65 offset:384
    ds_read_b64_tr_b16 v[128:129], v65 offset:544
    ds_read_b64_tr_b16 v[130:131], v65 offset:512
    ds_read_b64_tr_b16 v[132:133], v65 offset:672
    v_mfma_f32_32x32x16_bf16 v[176:191], v[228:231], v[244:247], v[176:191]
    ds_read_b64_tr_b16 v[240:241], v65 offset:3744
    ds_read_b64_tr_b16 v[242:243], v65 offset:3712
    ds_read_b64_tr_b16 v[134:135], v65 offset:640
    ds_read_b64_tr_b16 v[136:137], v65 offset:800
    ds_read_b64_tr_b16 v[138:139], v65 offset:768
    ds_read_b64_tr_b16 v[140:141], v65 offset:928
    v_mfma_f32_32x32x16_bf16 v[192:207], v[216:219], v[244:247], v[192:207]
    ds_read_b128 v[216:219], v64 offset:416
    ds_read_b64_tr_b16 v[236:237], v65 offset:800
    ds_read_b64_tr_b16 v[238:239], v65 offset:768
    ds_read_b64_tr_b16 v[142:143], v65 offset:896
    s_waitcnt lgkmcnt(15)
    v_mfma_f32_32x32x16_bf16 v[176:191], v[212:215], v[232:235], v[176:191]
    ds_read_b128 v[224:227], v64 offset:288
    ds_read_b64_tr_b16 v[244:245], v65 offset:1312
    ds_read_b64_tr_b16 v[246:247], v65 offset:1280
    s_waitcnt vmcnt(4)
ce_86:
    v_max3_u32 v208, v248, v249, v250
    v_max3_u32 v208, v208, v251, v252
    v_max3_u32 v208, v208, v253, v254
    v_max_u32 v208, v208, v255
    v_cmp_eq_u32 s[82:83], -1, v208
    v_min3_f32 v209, v96, v99, v100
    v_min3_f32 v209, v209, v103, v104
    v_min3_f32 v209, v209, v107, v108
    v_min_f32 v209, v209, v111
    v_cmp_neq_f32 vcc, 0x41000000, v209
    s_nop 0
    s_or_b64 vcc, vcc, s[82:83]
    s_cbranch_vccnz rd_87
rc_88:
    v_mfma_f32_32x32x16_bf16 v[192:207], v[228:231], v[232:235], v[192:207]
    v_mul_f32 v208, 0x3acccccd, v97
    v_mul_f32 v209, 0x3acccccd, v101
    v_mul_f32 v98, 0x3acccccd, v98
    v_mul_f32 v102, 0x3acccccd, v102
    v_fma_f32 v98, -v208, v208, v98
    s_waitcnt lgkmcnt(11)
    v_mfma_f32_32x32x16_bf16 v[192:207], v[212:215], v[240:243], v[192:207]
    ds_read_b128 v[228:231], v64 offset:160
    ds_read_b64_tr_b16 v[212:213], v65 offset:1824
    ds_read_b64_tr_b16 v[214:215], v65 offset:1792
    v_fma_f32 v102, -v209, v209, v102
    v_max_f32 v98, 0, v98
    s_waitcnt lgkmcnt(7)
    v_mfma_f32_32x32x16_bf16 v[144:159], v[216:219], v[236:239], v[144:159]
    v_max_f32 v102, 0, v102
    v_add_f32 v98, 0x3727c5ac, v98
    v_add_f32 v102, 0x3727c5ac, v102
    v_rsq_f32 v97, v98
    s_waitcnt lgkmcnt(3)
    v_mfma_f32_32x32x16_bf16 v[144:159], v[224:227], v[244:247], v[144:159]
    v_rsq_f32_e64 v101, v102
    v_mul_f32 v98, -v208, v97
    v_mul_f32 v102, -v209, v101
    v_lshlrev_b32_e64 v80, 16, v248
    v_and_b32 v82, 0xffff0000, v248
    v_mfma_f32_32x32x16_bf16 v[160:175], v[216:219], v[244:247], v[160:175]
    ds_read_b64_tr_b16 v[232:233], v65 offset:2336
    ds_read_b64_tr_b16 v[234:235], v65 offset:2304
    v_lshlrev_b32 v84, 16, v249
    v_and_b32 v86, 0xffff0000, v249
    v_lshlrev_b32_e64 v81, 16, v250
    s_waitcnt lgkmcnt(2)
    v_mfma_f32_32x32x16_bf16 v[144:159], v[228:231], v[212:215], v[144:159]
    v_and_b32 v83, 0xffff0000, v250
    v_lshlrev_b32_e64 v85, 16, v251
    v_and_b32 v87, 0xffff0000, v251
    v_fma_f32 v208, v80, v97, v98
    v_fma_f32 v209, v81, v101, v102
    v_cvt_pk_bf16_f32 v248, v208, v209
    v_mfma_f32_32x32x16_bf16 v[160:175], v[224:227], v[212:215], v[160:175]
    v_fma_f32 v208, v82, v97, v98
    v_fma_f32 v209, v83, v101, v102
    v_cvt_pk_bf16_f32 v249, v208, v209
    v_fma_f32 v208, v84, v97, v98
    v_fma_f32 v209, v85, v101, v102
    v_cvt_pk_bf16_f32 v250, v208, v209
    v_mfma_f32_32x32x16_bf16 v[176:191], v[216:219], v[212:215], v[176:191]
    v_fma_f32 v208, v86, v97, v98
    v_fma_f32 v209, v87, v101, v102
    v_cvt_pk_bf16_f32 v251, v208, v209
    s_waitcnt lgkmcnt(0)
    v_mfma_f32_32x32x16_bf16 v[144:159], v[220:223], v[232:235], v[144:159]
    ds_read_b64_tr_b16 v[240:241], v65 offset:2848
    ds_read_b64_tr_b16 v[242:243], v65 offset:2816
    ds_write_b32 v63, v248 offset:512
    ds_write_b32 v63, v249 offset:5376
    v_mfma_f32_32x32x16_bf16 v[160:175], v[228:231], v[232:235], v[160:175]
    ds_write_b32 v63, v250 offset:10240
    ds_write_b32 v63, v251 offset:15104
    v_mul_f32 v208, 0x3acccccd, v105
    v_mul_f32 v209, 0x3acccccd, v109
    v_mfma_f32_32x32x16_bf16 v[176:191], v[224:227], v[232:235], v[176:191]
    v_mul_f32 v106, 0x3acccccd, v106
    v_mul_f32 v110, 0x3acccccd, v110
    v_fma_f32 v106, -v208, v208, v106
    v_fma_f32 v110, -v209, v209, v110
    v_max_f32 v106, 0, v106
    v_max_f32_e64 v110, 0, v110
    v_mfma_f32_32x32x16_bf16 v[192:207], v[216:219], v[232:235], v[192:207]
    ds_read_b64_tr_b16 v[216:217], v65 offset:3360
    ds_read_b64_tr_b16 v[218:219], v65 offset:3328
    v_add_f32 v106, 0x3727c5ac, v106
    v_add_f32 v110, 0x3727c5ac, v110
    s_waitcnt lgkmcnt(6)
    v_mfma_f32_32x32x16_bf16 v[160:175], v[220:223], v[240:243], v[160:175]
    v_rsq_f32 v105, v106
    v_rsq_f32_e64 v109, v110
    v_mul_f32 v106, -v208, v105
    v_mul_f32 v110, -v209, v109
    v_mfma_f32_32x32x16_bf16 v[176:191], v[228:231], v[240:243], v[176:191]
    ds_read_b64_tr_b16 v[236:237], v65 offset:3872
    ds_read_b64_tr_b16 v[238:239], v65 offset:3840
    v_lshlrev_b32 v88, 16, v252
    v_and_b32 v90, 0xffff0000, v252
    v_lshlrev_b32 v92, 16, v253
    v_and_b32 v94, 0xffff0000, v253
    v_mfma_f32_32x32x16_bf16 v[192:207], v[224:227], v[240:243], v[192:207]
    ds_read_b128 v[224:227], v64 offset:384
    ds_read_b64_tr_b16 v[244:245], v65 offset:928
    ds_read_b64_tr_b16 v[246:247], v65 offset:896
    v_lshlrev_b32 v89, 16, v254
    v_and_b32 v91, 0xffff0000, v254
    s_waitcnt lgkmcnt(5)
    v_mfma_f32_32x32x16_bf16 v[176:191], v[220:223], v[216:219], v[176:191]
    ds_read_b128 v[212:215], v64 offset:256
    ds_read_b64_tr_b16 v[232:233], v65 offset:1440
    ds_read_b64_tr_b16 v[234:235], v65 offset:1408
    v_lshlrev_b32_e64 v93, 16, v255
    v_and_b32 v95, 0xffff0000, v255
    v_fma_f32 v208, v88, v105, v106
    v_mfma_f32_32x32x16_bf16 v[192:207], v[228:231], v[216:219], v[192:207]
    v_fma_f32 v209, v89, v109, v110
    v_cvt_pk_bf16_f32 v252, v208, v209
    v_fma_f32 v208, v90, v105, v106
    v_fma_f32 v209, v91, v109, v110
    v_cvt_pk_bf16_f32 v253, v208, v209
    s_waitcnt lgkmcnt(6)
    v_mfma_f32_32x32x16_bf16 v[192:207], v[220:223], v[236:239], v[192:207]
    ds_read_b128 v[220:223], v64 offset:128
    ds_read_b64_tr_b16 v[228:229], v65 offset:1952
    ds_read_b64_tr_b16 v[230:231], v65 offset:1920
    v_fma_f32 v208, v92, v105, v106
    v_fma_f32 v209, v93, v109, v110
    s_waitcnt lgkmcnt(6)
    v_mfma_f32_32x32x16_bf16 v[144:159], v[224:227], v[244:247], v[144:159]
    v_cvt_pk_bf16_f32 v254, v208, v209
    v_fma_f32 v208, v94, v105, v106
    v_fma_f32 v209, v95, v109, v110
    v_cvt_pk_bf16_f32 v255, v208, v209
    s_waitcnt lgkmcnt(3)
    v_mfma_f32_32x32x16_bf16 v[144:159], v[212:215], v[232:235], v[144:159]
    ds_write_b32 v63, v252 offset:768
    ds_write_b32 v63, v253 offset:5632
    ds_write_b32 v63, v254 offset:10496
    v_mfma_f32_32x32x16_bf16 v[160:175], v[224:227], v[232:235], v[160:175]
    ds_read_b128 v[240:243], v64 offset:0
    ds_read_b64_tr_b16 v[216:217], v65 offset:2464
    ds_read_b64_tr_b16 v[218:219], v65 offset:2432
    ds_write_b32 v63, v255 offset:15360
    s_waitcnt lgkmcnt(7)
    v_mfma_f32_32x32x16_bf16 v[144:159], v[220:223], v[228:231], v[144:159]
    v_mfma_f32_32x32x16_bf16 v[160:175], v[212:215], v[228:231], v[160:175]
    v_mfma_f32_32x32x16_bf16 v[176:191], v[224:227], v[228:231], v[176:191]
    s_waitcnt lgkmcnt(1)
    v_mfma_f32_32x32x16_bf16 v[144:159], v[240:243], v[216:219], v[144:159]
    ds_read_b64_tr_b16 v[236:237], v65 offset:2976
    ds_read_b64_tr_b16 v[238:239], v65 offset:2944
    v_mfma_f32_32x32x16_bf16 v[160:175], v[220:223], v[216:219], v[160:175]
    v_mfma_f32_32x32x16_bf16 v[176:191], v[212:215], v[216:219], v[176:191]
    v_mfma_f32_32x32x16_bf16 v[192:207], v[224:227], v[216:219], v[192:207]
    ds_read_b64_tr_b16 v[224:225], v65 offset:3488
    ds_read_b64_tr_b16 v[226:227], v65 offset:3456
    s_waitcnt lgkmcnt(2)
    v_mfma_f32_32x32x16_bf16 v[160:175], v[240:243], v[236:239], v[160:175]
    v_mfma_f32_32x32x16_bf16 v[176:191], v[220:223], v[236:239], v[176:191]
    ds_read_b64_tr_b16 v[244:245], v65 offset:4000
    ds_read_b64_tr_b16 v[246:247], v65 offset:3968
    v_mfma_f32_32x32x16_bf16 v[192:207], v[212:215], v[236:239], v[192:207]
    s_waitcnt lgkmcnt(2)
    v_mfma_f32_32x32x16_bf16 v[176:191], v[240:243], v[224:227], v[176:191]
    v_mfma_f32_32x32x16_bf16 v[192:207], v[220:223], v[224:227], v[192:207]
    s_waitcnt lgkmcnt(0)
    v_mfma_f32_32x32x16_bf16 v[192:207], v[240:243], v[244:247], v[192:207]
    s_waitcnt lgkmcnt(0)
    s_barrier
    ds_read_b128 v[212:215], v64 offset:608
    ds_read_b128 v[216:219], v64 offset:576
    ds_read_b128 v[220:223], v64 offset:544
    ds_read_b128 v[224:227], v64 offset:512
    s_waitcnt lgkmcnt(3)
    v_mfma_f32_32x32x16_bf16 v[144:159], v[212:215], v[112:115], v[144:159]
    ds_read_b128 v[228:231], v64 offset:736
    s_waitcnt lgkmcnt(3)
    v_mfma_f32_32x32x16_bf16 v[144:159], v[216:219], v[116:119], v[144:159]
    ds_read_b128 v[232:235], v64 offset:704
    s_waitcnt lgkmcnt(3)
    v_mfma_f32_32x32x16_bf16 v[144:159], v[220:223], v[120:123], v[144:159]
    ds_read_b128 v[236:239], v64 offset:672
    s_waitcnt lgkmcnt(3)
    v_mfma_f32_32x32x16_bf16 v[144:159], v[224:227], v[124:127], v[144:159]
    ds_read_b128 v[240:243], v64 offset:640
    s_nop 3
    s_waitcnt lgkmcnt(3)
    v_mfma_f32_32x32x16_bf16 v[160:175], v[228:231], v[112:115], v[160:175]
    s_nop 4
    s_waitcnt lgkmcnt(2)
    v_mfma_f32_32x32x16_bf16 v[160:175], v[232:235], v[116:119], v[160:175]
    v_cndmask_b32 v208, v147, v72, s[76:77]
    v_cndmask_b32 v209, v151, v147, s[76:77]
    v_cndmask_b32 v210, v155, v151, s[76:77]
    v_cndmask_b32 v211, v159, v155, s[76:77]
    v_mov_b32 v72, v159
    s_waitcnt lgkmcnt(1)
    v_mfma_f32_32x32x16_bf16 v[160:175], v[236:239], v[120:123], v[160:175]
    v_add_f32_dpp v146, v208, v146 wave_ror:1 row_mask:0xf bank_mask:0xf
    v_add_f32_dpp v150, v209, v150 wave_ror:1 row_mask:0xf bank_mask:0xf
    v_add_f32_dpp v154, v210, v154 wave_ror:1 row_mask:0xf bank_mask:0xf
    v_add_f32_dpp v158, v211, v158 wave_ror:1 row_mask:0xf bank_mask:0xf
    v_cndmask_b32 v208, v146, v71, s[76:77]
    s_waitcnt lgkmcnt(0)
    v_mfma_f32_32x32x16_bf16 v[160:175], v[240:243], v[124:127], v[160:175]
    v_cndmask_b32 v209, v150, v146, s[76:77]
    v_cndmask_b32 v210, v154, v150, s[76:77]
    v_cndmask_b32 v211, v158, v154, s[76:77]
    v_mov_b32 v71, v158
    v_add_f32_dpp v145, v208, v145 wave_ror:1 row_mask:0xf bank_mask:0xf
    v_add_f32_dpp v149, v209, v149 wave_ror:1 row_mask:0xf bank_mask:0xf
    v_mfma_f32_32x32x16_bf16 v[160:175], v[212:215], v[128:131], v[160:175]
    ds_read_b128 v[244:247], v64 offset:864
    v_add_f32_dpp v153, v210, v153 wave_ror:1 row_mask:0xf bank_mask:0xf
    v_add_f32_dpp v157, v211, v157 wave_ror:1 row_mask:0xf bank_mask:0xf
    v_cndmask_b32 v208, v145, v70, s[76:77]
    v_cndmask_b32 v209, v149, v145, s[76:77]
    v_cndmask_b32 v210, v153, v149, s[76:77]
    v_mfma_f32_32x32x16_bf16 v[160:175], v[216:219], v[132:135], v[160:175]
    ds_read_b128 v[248:251], v64 offset:832
    v_cndmask_b32 v211, v157, v153, s[76:77]
    v_mov_b32_e64 v70, v157
    v_add_f32_dpp v144, v208, v144 wave_ror:1 row_mask:0xf bank_mask:0xf
    v_add_f32_dpp v148, v209, v148 wave_ror:1 row_mask:0xf bank_mask:0xf
    v_add_f32_dpp v152, v210, v152 wave_ror:1 row_mask:0xf bank_mask:0xf
    v_mfma_f32_32x32x16_bf16 v[160:175], v[220:223], v[136:139], v[160:175]
    ds_read_b128 v[252:255], v64 offset:800
    v_add_f32_dpp v156, v211, v156 wave_ror:1 row_mask:0xf bank_mask:0xf
    ds_write_b32 v66, v144 offset:0
    v_mfma_f32_32x32x16_bf16 v[160:175], v[224:227], v[140:143], v[160:175]
    ds_read_b128 v[224:227], v64 offset:768
    ds_write_b32 v66, v148 offset:64
    ds_write_b32 v66, v152 offset:128
    s_waitcnt lgkmcnt(6)
    v_mfma_f32_32x32x16_bf16 v[176:191], v[244:247], v[112:115], v[176:191]
    ds_write_b32 v66, v156 offset:192
    s_nop 2
    s_waitcnt lgkmcnt(6)
    v_mfma_f32_32x32x16_bf16 v[176:191], v[248:251], v[116:119], v[176:191]
    s_nop 2
    v_cndmask_b32 v208, v163, v72, s[76:77]
    v_cndmask_b32 v209, v167, v163, s[76:77]
    s_waitcnt lgkmcnt(5)
    v_mfma_f32_32x32x16_bf16 v[176:191], v[252:255], v[120:123], v[176:191]
    v_cndmask_b32 v210, v171, v167, s[76:77]
    v_cndmask_b32 v211, v175, v171, s[76:77]
    v_mov_b32 v72, v175
    v_add_f32_dpp v162, v208, v162 wave_ror:1 row_mask:0xf bank_mask:0xf
    v_add_f32_dpp v166, v209, v166 wave_ror:1 row_mask:0xf bank_mask:0xf
    s_waitcnt lgkmcnt(3)
    v_mfma_f32_32x32x16_bf16 v[176:191], v[224:227], v[124:127], v[176:191]
    v_add_f32_dpp v170, v210, v170 wave_ror:1 row_mask:0xf bank_mask:0xf
    v_add_f32_dpp v174, v211, v174 wave_ror:1 row_mask:0xf bank_mask:0xf
    v_cndmask_b32 v208, v162, v71, s[76:77]
    v_cndmask_b32 v209, v166, v162, s[76:77]
    v_cndmask_b32 v210, v170, v166, s[76:77]
    v_cndmask_b32 v211, v174, v170, s[76:77]
    v_mfma_f32_32x32x16_bf16 v[176:191], v[228:231], v[128:131], v[176:191]
    ds_read_b64_tr_b16 v[228:229], v65 offset:1056
    ds_read_b64_tr_b16 v[230:231], v65 offset:1024
    v_mov_b32 v71, v174
    v_add_f32_dpp v161, v208, v161 wave_ror:1 row_mask:0xf bank_mask:0xf
    v_add_f32_dpp v165, v209, v165 wave_ror:1 row_mask:0xf bank_mask:0xf
    v_add_f32_dpp v169, v210, v169 wave_ror:1 row_mask:0xf bank_mask:0xf
    v_mfma_f32_32x32x16_bf16 v[176:191], v[232:235], v[132:135], v[176:191]
    ds_read_b64_tr_b16 v[232:233], v65 offset:1184
    ds_read_b64_tr_b16 v[234:235], v65 offset:1152
    v_add_f32_dpp v173, v211, v173 wave_ror:1 row_mask:0xf bank_mask:0xf
    v_cndmask_b32 v208, v161, v70, s[76:77]
    v_cndmask_b32 v209, v165, v161, s[76:77]
    v_cndmask_b32 v210, v169, v165, s[76:77]
    v_mfma_f32_32x32x16_bf16 v[176:191], v[236:239], v[136:139], v[176:191]
    ds_read_b64_tr_b16 v[236:237], v65 offset:1312
    ds_read_b64_tr_b16 v[238:239], v65 offset:1280
    v_cndmask_b32 v211, v173, v169, s[76:77]
    v_mov_b32_e64 v70, v173
    v_add_f32_dpp v160, v208, v160 wave_ror:1 row_mask:0xf bank_mask:0xf
    v_add_f32_dpp v164, v209, v164 wave_ror:1 row_mask:0xf bank_mask:0xf
    v_mfma_f32_32x32x16_bf16 v[176:191], v[240:243], v[140:143], v[176:191]
    ds_read_b128 v[240:243], v64 offset:512
    ds_read_b64_tr_b16 v[224:225], v65 offset:1440
    ds_read_b64_tr_b16 v[226:227], v65 offset:1408
    v_add_f32_dpp v168, v210, v168 wave_ror:1 row_mask:0xf bank_mask:0xf
    v_add_f32_dpp v172, v211, v172 wave_ror:1 row_mask:0xf bank_mask:0xf
    s_waitcnt lgkmcnt(7)
    v_mfma_f32_32x32x16_bf16 v[176:191], v[212:215], v[228:231], v[176:191]
    ds_read_b128 v[212:215], v64 offset:992
    ds_write_b32 v66, v160 offset:256
    ds_write_b32 v66, v164 offset:320
    s_waitcnt lgkmcnt(8)
    v_mfma_f32_32x32x16_bf16 v[176:191], v[216:219], v[232:235], v[176:191]
    ds_read_b128 v[216:219], v64 offset:960
    ds_write_b32 v66, v168 offset:384
    ds_write_b32 v66, v172 offset:448
    s_waitcnt lgkmcnt(9)
    v_mfma_f32_32x32x16_bf16 v[176:191], v[220:223], v[236:239], v[176:191]
    ds_read_b128 v[220:223], v64 offset:928
    s_waitcnt lgkmcnt(7)
    v_mfma_f32_32x32x16_bf16 v[176:191], v[240:243], v[224:227], v[176:191]
    ds_read_b128 v[240:243], v64 offset:896
    s_waitcnt lgkmcnt(2)
    s_barrier
    v_mfma_f32_32x32x16_bf16 v[192:207], v[212:215], v[112:115], v[192:207]
    ds_read_b64 v[144:145], v67 offset:0
    ds_read_b64 v[146:147], v67 offset:4224
    ds_read_b64 v[148:149], v67 offset:8448
    ds_read_b64 v[150:151], v67 offset:12672
    s_nop 0
    v_mfma_f32_32x32x16_bf16 v[192:207], v[216:219], v[116:119], v[192:207]
    s_nop 2
    v_cndmask_b32 v208, v179, v72, s[76:77]
    v_cndmask_b32 v209, v183, v179, s[76:77]
    s_waitcnt lgkmcnt(5)
    v_mfma_f32_32x32x16_bf16 v[192:207], v[220:223], v[120:123], v[192:207]
    v_cndmask_b32 v210, v187, v183, s[76:77]
    v_cndmask_b32 v211, v191, v187, s[76:77]
    v_mov_b32 v72, v191
    v_add_f32_dpp v178, v208, v178 wave_ror:1 row_mask:0xf bank_mask:0xf
    v_add_f32_dpp v182, v209, v182 wave_ror:1 row_mask:0xf bank_mask:0xf
    s_waitcnt lgkmcnt(4)
    v_mfma_f32_32x32x16_bf16 v[192:207], v[240:243], v[124:127], v[192:207]
    ds_read_b128 v[212:215], v64 offset:768
    v_add_f32_dpp v186, v210, v186 wave_ror:1 row_mask:0xf bank_mask:0xf
    v_add_f32_dpp v190, v211, v190 wave_ror:1 row_mask:0xf bank_mask:0xf
    v_cndmask_b32 v208, v178, v71, s[76:77]
    v_cndmask_b32 v209, v182, v178, s[76:77]
    v_cndmask_b32 v210, v186, v182, s[76:77]
    v_mfma_f32_32x32x16_bf16 v[192:207], v[244:247], v[128:131], v[192:207]
    ds_read_b128 v[244:247], v64 offset:736
    v_cndmask_b32 v211, v190, v186, s[76:77]
    v_mov_b32 v71, v190
    v_add_f32_dpp v177, v208, v177 wave_ror:1 row_mask:0xf bank_mask:0xf
    v_add_f32_dpp v181, v209, v181 wave_ror:1 row_mask:0xf bank_mask:0xf
    v_add_f32_dpp v185, v210, v185 wave_ror:1 row_mask:0xf bank_mask:0xf
    v_mfma_f32_32x32x16_bf16 v[192:207], v[248:251], v[132:135], v[192:207]
    ds_read_b128 v[248:251], v64 offset:704
    v_add_f32_dpp v189, v211, v189 wave_ror:1 row_mask:0xf bank_mask:0xf
    v_cndmask_b32 v208, v177, v70, s[76:77]
    v_cndmask_b32 v209, v181, v177, s[76:77]
    v_cndmask_b32 v210, v185, v181, s[76:77]
    v_cndmask_b32 v211, v189, v185, s[76:77]
    v_mfma_f32_32x32x16_bf16 v[192:207], v[252:255], v[136:139], v[192:207]
    ds_read_b128 v[252:255], v64 offset:672
    v_mov_b32_e64 v70, v189
    v_add_f32_dpp v176, v208, v176 wave_ror:1 row_mask:0xf bank_mask:0xf
    v_add_f32_dpp v180, v209, v180 wave_ror:1 row_mask:0xf bank_mask:0xf
    v_add_f32_dpp v184, v210, v184 wave_ror:1 row_mask:0xf bank_mask:0xf
    s_waitcnt lgkmcnt(3)
    v_mfma_f32_32x32x16_bf16 v[192:207], v[212:215], v[140:143], v[192:207]
    ds_read_b128 v[216:219], v64 offset:640
    v_add_f32_dpp v188, v211, v188 wave_ror:1 row_mask:0xf bank_mask:0xf
    s_waitcnt lgkmcnt(3)
    v_mfma_f32_32x32x16_bf16 v[192:207], v[244:247], v[228:231], v[192:207]
    ds_read_b128 v[228:231], v64 offset:608
    ds_read_b64_tr_b16 v[220:221], v65 offset:1568
    ds_read_b64_tr_b16 v[222:223], v65 offset:1536
    ds_write_b32 v66, v176 offset:512
    s_waitcnt lgkmcnt(6)
    v_mfma_f32_32x32x16_bf16 v[192:207], v[248:251], v[232:235], v[192:207]
    ds_read_b128 v[232:235], v64 offset:576
    ds_read_b64_tr_b16 v[240:241], v65 offset:1696
    ds_read_b64_tr_b16 v[242:243], v65 offset:1664
    ds_write_b32 v66, v180 offset:576
    s_waitcnt lgkmcnt(9)
    v_mfma_f32_32x32x16_bf16 v[192:207], v[252:255], v[236:239], v[192:207]
    ds_read_b128 v[236:239], v64 offset:544
    ds_read_b64_tr_b16 v[212:213], v65 offset:1824
    ds_read_b64_tr_b16 v[214:215], v65 offset:1792
    ds_write_b32 v66, v184 offset:640
    s_waitcnt lgkmcnt(12)
    v_mfma_f32_32x32x16_bf16 v[192:207], v[216:219], v[224:227], v[192:207]
    ds_read_b128 v[224:227], v64 offset:512
    ds_read_b64_tr_b16 v[244:245], v65 offset:1952
    ds_read_b64_tr_b16 v[246:247], v65 offset:1920
    ds_write_b32 v66, v188 offset:704
    s_waitcnt lgkmcnt(13)
    v_mfma_f32_32x32x16_bf16 v[192:207], v[228:231], v[220:223], v[192:207]
    v_add_f32 v144, v144, v80
    v_add_f32 v145, v145, v81
    v_add_f32 v146, v146, v82
    v_add_f32 v147, v147, v83
    s_waitcnt lgkmcnt(9)
    v_mfma_f32_32x32x16_bf16 v[192:207], v[232:235], v[240:243], v[192:207]
    v_add_f32 v148, v148, v84
    v_add_f32 v149, v149, v85
    v_add_f32 v150, v150, v86
    v_add_f32 v151, v151, v87
    v_cvt_pk_bf16_f32 v160, v144, v146
    s_waitcnt lgkmcnt(5)
    v_mfma_f32_32x32x16_bf16 v[192:207], v[236:239], v[212:215], v[192:207]
    v_cvt_pk_bf16_f32 v161, v148, v150
    v_cvt_pk_bf16_f32 v162, v145, v147
    v_cvt_pk_bf16_f32 v163, v149, v151
    s_mov_b32 s25, 1310720
    s_waitcnt lgkmcnt(1)
    v_mfma_f32_32x32x16_bf16 v[192:207], v[224:227], v[244:247], v[192:207]
    buffer_store_dwordx2 v[160:161], v68, s[20:23], s25 offen
    s_mov_b32 s25, 1315840
    buffer_store_dwordx2 v[162:163], v68, s[20:23], s25 offen
    s_nop 8
    v_cndmask_b32 v208, v195, v72, s[76:77]
    v_cndmask_b32 v209, v199, v195, s[76:77]
    v_cndmask_b32 v210, v203, v199, s[76:77]
    v_cndmask_b32 v211, v207, v203, s[76:77]
    v_mov_b32_e64 v72, v207
    v_add_f32_dpp v194, v208, v194 wave_ror:1 row_mask:0xf bank_mask:0xf
    v_add_f32_dpp v198, v209, v198 wave_ror:1 row_mask:0xf bank_mask:0xf
    v_add_f32_dpp v202, v210, v202 wave_ror:1 row_mask:0xf bank_mask:0xf
    v_add_f32_dpp v206, v211, v206 wave_ror:1 row_mask:0xf bank_mask:0xf
    v_cndmask_b32 v208, v194, v71, s[76:77]
    v_cndmask_b32 v209, v198, v194, s[76:77]
    v_cndmask_b32 v210, v202, v198, s[76:77]
    v_cndmask_b32 v211, v206, v202, s[76:77]
    v_mov_b32_e64 v71, v206
    v_add_f32_dpp v193, v208, v193 wave_ror:1 row_mask:0xf bank_mask:0xf
    v_add_f32_dpp v197, v209, v197 wave_ror:1 row_mask:0xf bank_mask:0xf
    v_add_f32_dpp v201, v210, v201 wave_ror:1 row_mask:0xf bank_mask:0xf
    v_add_f32_dpp v205, v211, v205 wave_ror:1 row_mask:0xf bank_mask:0xf
    v_cndmask_b32 v208, v193, v70, s[76:77]
    v_cndmask_b32 v209, v197, v193, s[76:77]
    v_cndmask_b32 v210, v201, v197, s[76:77]
    v_cndmask_b32 v211, v205, v201, s[76:77]
    v_mov_b32_e64 v70, v205
    v_add_f32_dpp v192, v208, v192 wave_ror:1 row_mask:0xf bank_mask:0xf
    v_add_f32_dpp v196, v209, v196 wave_ror:1 row_mask:0xf bank_mask:0xf
    v_add_f32_dpp v200, v210, v200 wave_ror:1 row_mask:0xf bank_mask:0xf
    v_add_f32_dpp v204, v211, v204 wave_ror:1 row_mask:0xf bank_mask:0xf
    ds_write_b32 v66, v192 offset:768
    ds_write_b32 v66, v196 offset:832
    ds_write_b32 v66, v200 offset:896
    ds_write_b32 v66, v204 offset:960
    s_waitcnt lgkmcnt(0)
    s_barrier
    ds_read_b64 v[152:153], v67 offset:512
    ds_read_b64 v[154:155], v67 offset:4736
    ds_read_b64 v[156:157], v67 offset:8960
    ds_read_b64 v[158:159], v67 offset:13184
    s_waitcnt lgkmcnt(0)
    v_add_f32 v152, v152, v88
    v_add_f32 v153, v153, v89
    v_add_f32 v154, v154, v90
    v_add_f32 v155, v155, v91
    v_add_f32 v156, v156, v92
    v_add_f32 v157, v157, v93
    v_add_f32 v158, v158, v94
    v_add_f32_e64 v159, v159, v95
    v_cvt_pk_bf16_f32 v164, v152, v154
    v_cvt_pk_bf16_f32 v165, v156, v158
    v_cvt_pk_bf16_f32 v166, v153, v155
    v_cvt_pk_bf16_f32 v167, v157, v159
    s_mov_b32 s25, 1966080
    buffer_store_dwordx2 v[164:165], v68, s[20:23], s25 offen
    s_mov_b32 s25, 1971200
    buffer_store_dwordx2 v[166:167], v68, s[20:23], s25 offen
    s_branch ec_82
nc_81:
ec_82:
L_end:
    s_endpgm
ps_4:
    s_mov_b32 s84, 1048576
pl_5:
    global_load_dword v7, v5, s[66:67] sc1
    s_waitcnt vmcnt(0)
    s_sub_u32 s84, s84, 1
    s_cbranch_scc1 pc_6
    v_cmp_gt_u32_e64 vcc, 1, v7
    s_nop 0
    s_and_b64 vcc, vcc, s[50:51]
    s_and_b64 vcc, vcc, 1
    s_cbranch_scc1 pl_5
    s_branch pc_6
ps_7:
    s_mov_b32 s84, 1048576
pl_8:
    buffer_load_dword v7, v4, s[16:19], s87 offen offset:0 sc1
    s_waitcnt vmcnt(0)
    s_sub_u32 s84, s84, 1
    s_cbranch_scc1 pc_9
    v_cmp_gt_u32 vcc, 32, v7
    s_nop 0
    s_and_b64 vcc, vcc, s[50:51]
    s_cbranch_scc1 pl_8
    s_branch pc_9
ps_11:
    s_mov_b32 s84, 1048576
pl_12:
    global_load_dword v7, v5, s[66:67] sc1
    s_waitcnt vmcnt(0)
    s_sub_u32 s84, s84, 1
    s_cbranch_scc1 pc_13
    v_cmp_gt_u32_e64 vcc, 1, v7
    s_nop 0
    s_and_b64 vcc, vcc, s[50:51]
    s_and_b64 vcc, vcc, 1
    s_cbranch_scc1 pl_12
    s_branch pc_13
ps_14:
    s_mov_b32 s84, 1048576
pl_15:
    buffer_load_dword v7, v4, s[16:19], s87 offen offset:0 sc1
    s_waitcnt vmcnt(0)
    s_sub_u32 s84, s84, 1
    s_cbranch_scc1 pc_16
    v_cmp_gt_u32 vcc, 32, v7
    s_nop 0
    s_and_b64 vcc, vcc, s[50:51]
    s_cbranch_scc1 pl_15
    s_branch pc_16
ps_17:
    s_mov_b32 s84, 1048576
pl_18:
    buffer_load_dword v7, v4, s[16:19], s89 offen offset:8 sc1
    s_waitcnt vmcnt(0)
    s_sub_u32 s84, s84, 1
    s_cbranch_scc1 pc_19
    v_cmp_gt_u32_e64 vcc, 32, v7
    s_nop 0
    s_and_b64 vcc, vcc, s[50:51]
    s_cbranch_scc1 pl_18
    s_branch pc_19
rd_21:
    s_cmp_eq_u32 s38, 0
    s_cbranch_scc1 rc_22
    s_sub_u32 s38, s38, 1
    s_nop 7
    s_nop 7
    s_sleep 4
    s_mov_b64 exec, vcc
    s_mov_b32 s96, 4194304
    buffer_load_dwordx4 v[216:219], v56, s[16:19], s96 offen offset:0 sc1
    buffer_load_dwordx4 v[220:223], v56, s[16:19], s96 offen offset:256 sc1
    s_mov_b32 s96, 4227072
    buffer_load_dwordx4 v[224:227], v56, s[16:19], s96 offen offset:0 sc1
    buffer_load_dwordx4 v[228:231], v56, s[16:19], s96 offen offset:256 sc1
    s_mov_b32 s96, 4259840
    buffer_load_dwordx4 v[232:235], v56, s[16:19], s96 offen offset:0 sc1
    buffer_load_dwordx4 v[236:239], v56, s[16:19], s96 offen offset:256 sc1
    s_mov_b32 s96, 4292608
    buffer_load_dwordx4 v[240:243], v56, s[16:19], s96 offen offset:0 sc1
    buffer_load_dwordx4 v[244:247], v56, s[16:19], s96 offen offset:256 sc1
    s_mov_b32 s96, 4194304
    buffer_load_dwordx2 v[248:249], v57, s[16:19], s96 offen offset:0 sc1
    buffer_load_dwordx2 v[252:253], v57, s[16:19], s96 offen offset:128 sc1
    s_mov_b32 s96, 4210688
    buffer_load_dwordx2 v[250:251], v57, s[16:19], s96 offen offset:0 sc1
    buffer_load_dwordx2 v[254:255], v57, s[16:19], s96 offen offset:128 sc1
    s_mov_b32 s96, 0
    s_mov_b32 s97, 5120
    s_waitcnt vmcnt(16)
    buffer_load_dwordx2 v[208:209], v60, s[4:7], s96 offen
    s_waitcnt vmcnt(16)
    buffer_load_dwordx2 v[210:211], v60, s[4:7], s97 offen
    s_waitcnt vmcnt(16)
    v_lshrrev_b32_e64 v212, 5, v1
    v_mul_u32_u24 v212, 5104, v212
    v_bfe_u32 v213, v1, 4, 1
    v_lshlrev_b32 v213, 2, v213
    v_sub_u32 v212, v212, v213
    v_add_u32 v212, v212, v60
    s_mul_i32 s97, s24, 24
    s_sub_u32 s97, 128, s97
    buffer_load_dword v212, v212, s[4:7], s97 offen
    s_mov_b64 exec, -1
    s_waitcnt vmcnt(0) lgkmcnt(0)
    s_branch oe_20
rd_24:
    s_cmp_eq_u32 s38, 0
    s_cbranch_scc1 rc_25
    s_sub_u32 s38, s38, 1
    s_nop 7
    s_nop 7
    s_sleep 4
    s_mov_b64 exec, vcc
    s_mov_b32 s96, 4198400
    buffer_load_dwordx4 v[216:219], v56, s[16:19], s96 offen offset:0 sc1
    buffer_load_dwordx4 v[220:223], v56, s[16:19], s96 offen offset:256 sc1
    s_mov_b32 s96, 4231168
    buffer_load_dwordx4 v[224:227], v56, s[16:19], s96 offen offset:0 sc1
    buffer_load_dwordx4 v[228:231], v56, s[16:19], s96 offen offset:256 sc1
    s_mov_b32 s96, 4263936
    buffer_load_dwordx4 v[232:235], v56, s[16:19], s96 offen offset:0 sc1
    buffer_load_dwordx4 v[236:239], v56, s[16:19], s96 offen offset:256 sc1
    s_mov_b32 s96, 4296704
    buffer_load_dwordx4 v[240:243], v56, s[16:19], s96 offen offset:0 sc1
    buffer_load_dwordx4 v[244:247], v56, s[16:19], s96 offen offset:256 sc1
    s_mov_b32 s96, 4196352
    buffer_load_dwordx2 v[248:249], v57, s[16:19], s96 offen offset:0 sc1
    buffer_load_dwordx2 v[252:253], v57, s[16:19], s96 offen offset:128 sc1
    s_mov_b32 s96, 4212736
    buffer_load_dwordx2 v[250:251], v57, s[16:19], s96 offen offset:0 sc1
    buffer_load_dwordx2 v[254:255], v57, s[16:19], s96 offen offset:128 sc1
    s_mov_b32 s96, 1310720
    s_mov_b32 s97, 1315840
    s_waitcnt vmcnt(14)
    buffer_load_dwordx2 v[208:209], v60, s[4:7], s96 offen
    s_waitcnt vmcnt(14)
    buffer_load_dwordx2 v[210:211], v60, s[4:7], s97 offen
    s_waitcnt vmcnt(14)
    v_lshrrev_b32 v212, 5, v1
    v_mul_u32_u24 v212, 5104, v212
    v_bfe_u32 v213, v1, 4, 1
    v_lshlrev_b32 v213, 2, v213
    v_sub_u32 v212, v212, v213
    v_add_u32 v212, v212, v60
    s_mul_i32 s97, s24, 24
    s_sub_u32 s97, 1310848, s97
    buffer_load_dword v212, v212, s[4:7], s97 offen
    s_mov_b64 exec, -1
    s_waitcnt vmcnt(0) lgkmcnt(0)
    s_branch oe_23
rd_29:
    s_cmp_eq_u32 s38, 0
    s_cbranch_scc1 rc_30
    s_sub_u32 s38, s38, 1
    s_nop 7
    s_nop 7
    s_sleep 4
    s_mov_b64 exec, vcc
    s_lshl_b32 s96, s75, 14
    s_add_u32 s96, s96, 6815744
    s_lshl_b32 s97, s24, 12
    s_add_u32 s97, s97, 3473408
    buffer_load_dwordx4 v[176:179], v62, s[16:19], s96 offen offset:0 sc1
    buffer_load_dwordx4 v[180:183], v62, s[16:19], s96 offen offset:1024 sc1
    buffer_load_dwordx4 v[184:187], v62, s[16:19], s97 offen offset:0 sc1
    buffer_load_dwordx4 v[188:191], v62, s[16:19], s97 offen offset:1024 sc1
    buffer_load_dwordx4 v[192:195], v62, s[16:19], s97 offen offset:2048 sc1
    buffer_load_dwordx4 v[196:199], v62, s[16:19], s97 offen offset:3072 sc1
    s_mov_b64 exec, -1
    s_waitcnt vmcnt(0) lgkmcnt(0)
    s_branch ce_28
rd_32:
    s_cmp_eq_u32 s38, 0
    s_cbranch_scc1 rc_33
    s_sub_u32 s38, s38, 1
    s_nop 7
    s_nop 7
    s_sleep 4
    s_mov_b64 exec, vcc
    s_lshl_b32 s96, s75, 14
    s_add_u32 s96, s96, 6815744
    s_lshl_b32 s97, s24, 12
    s_add_u32 s97, s97, 3477504
    buffer_load_dwordx4 v[248:251], v62, s[16:19], s96 offen offset:2048 sc1
    buffer_load_dwordx4 v[252:255], v62, s[16:19], s96 offen offset:3072 sc1
    buffer_load_dwordx4 v[96:99], v62, s[16:19], s97 offen offset:0 sc1
    buffer_load_dwordx4 v[100:103], v62, s[16:19], s97 offen offset:1024 sc1
    buffer_load_dwordx4 v[104:107], v62, s[16:19], s97 offen offset:2048 sc1
    buffer_load_dwordx4 v[108:111], v62, s[16:19], s97 offen offset:3072 sc1
    s_mov_b64 exec, -1
    s_waitcnt vmcnt(0) lgkmcnt(0)
    s_branch ce_31
gl_34:
    s_add_u32 s82, s86, 16384
    v_lshlrev_b32 v2, 10, v1
    v_mov_b32_e64 v5, 1
    s_mov_b64 exec, 255
    buffer_store_dword v5, v2, s[16:19], s82 offen offset:0 sc1
    s_mov_b64 exec, -1
    s_branch gc_35
ps_36:
    s_mov_b32 s84, 1048576
pl_37:
    buffer_load_dword v7, v4, s[16:19], s89 offen offset:0 sc1
    s_waitcnt vmcnt(0)
    s_sub_u32 s84, s84, 1
    s_cbranch_scc1 pc_38
    v_cmp_gt_u32 vcc, 1, v7
    s_nop 0
    s_and_b64 vcc, vcc, s[50:51]
    s_cbranch_scc1 pl_37
    s_branch pc_38
ps_39:
    s_mov_b32 s84, 1048576
pl_40:
    buffer_load_dword v7, v4, s[16:19], s87 offen offset:8 sc1
    s_waitcnt vmcnt(0)
    s_sub_u32 s84, s84, 1
    s_cbranch_scc1 pc_41
    v_cmp_gt_u32 vcc, 12, v7
    s_nop 0
    s_and_b64 vcc, vcc, s[50:51]
    s_cbranch_scc1 pl_40
    s_branch pc_41
gl_42:
    s_add_u32 s82, s86, 0
    v_lshlrev_b32 v2, 10, v1
    v_mov_b32_e64 v5, 1
    s_mov_b64 exec, 255
    buffer_store_dword v5, v2, s[16:19], s82 offen offset:12 sc1
    s_mov_b64 exec, -1
    s_branch gc_43
ps_44:
    s_mov_b32 s84, 1048576
pl_45:
    buffer_load_dword v7, v4, s[16:19], s89 offen offset:0 sc1
    s_waitcnt vmcnt(0)
    s_sub_u32 s84, s84, 1
    s_cbranch_scc1 pc_46
    v_cmp_gt_u32_e64 vcc, 1, v7
    s_nop 0
    s_and_b64 vcc, vcc, s[50:51]
    s_cbranch_scc1 pl_45
    s_branch pc_46
rd_49:
    s_cmp_eq_u32 s38, 0
    s_cbranch_scc1 rc_50
    s_sub_u32 s38, s38, 1
    s_nop 7
    s_nop 7
    s_sleep 4
    s_mov_b64 exec, vcc
    s_add_u32 s26, s3, 9437184
    buffer_load_dwordx4 v[216:219], v236, s[16:19], s26 offen sc1
    s_add_u32 s26, s26, 524288
    buffer_load_dwordx4 v[220:223], v236, s[16:19], s26 offen sc1
    s_add_u32 s26, s26, 524288
    buffer_load_dwordx4 v[224:227], v236, s[16:19], s26 offen sc1
    s_add_u32 s26, s26, 524288
    buffer_load_dwordx4 v[228:231], v236, s[16:19], s26 offen sc1
    s_add_u32 s26, s26, 524288
    buffer_load_dwordx4 v[232:235], v236, s[16:19], s26 offen sc1
    s_mov_b64 exec, -1
    s_waitcnt vmcnt(0) lgkmcnt(0)
    s_branch se_48
gl_52:
    s_add_u32 s82, s86, 16384
    v_lshlrev_b32 v2, 10, v1
    v_mov_b32_e64 v5, 1
    s_mov_b64 exec, 255
    buffer_store_dword v5, v2, s[16:19], s82 offen offset:4 sc1
    s_mov_b64 exec, -1
    s_branch gc_53
ps_54:
    s_mov_b32 s84, 1048576
pl_55:
    buffer_load_dword v7, v4, s[16:19], s87 offen offset:12 sc1
    s_waitcnt vmcnt(0)
    s_sub_u32 s84, s84, 1
    s_cbranch_scc1 pc_56
    v_cmp_gt_u32_e64 vcc, 1, v7
    s_nop 0
    s_and_b64 vcc, vcc, s[50:51]
    s_cbranch_scc1 pl_55
    s_branch pc_56
rd_58:
    s_cmp_eq_u32 s38, 0
    s_cbranch_scc1 rc_59
    s_sub_u32 s38, s38, 1
    s_nop 7
    s_nop 7
    s_sleep 4
    s_mov_b64 exec, vcc
    s_lshl_b32 s98, s72, 5
    s_add_u32 s98, s98, 0
    s_sub_u32 s95, s98, 4
    s_max_i32 s95, s95, 0
    s_lshl_b32 s94, s98, 3
    s_lshl_b32 s95, s95, 3
    s_add_u32 s94, s94, 3457024
    s_add_u32 s95, s95, 3457024
    s_add_u32 s96, s94, 8192
    buffer_load_dwordx2 v[152:153], v47, s[16:19], s94 offen sc1
    buffer_load_dwordx2 v[154:155], v47, s[16:19], s96 offen sc1
    buffer_load_dwordx2 v[156:157], v48, s[16:19], s95 offen sc1
    s_mov_b64 exec, -1
    s_waitcnt vmcnt(0) lgkmcnt(0)
    s_branch sl_57
ps_60:
    s_mov_b32 s84, 1048576
pl_61:
    buffer_load_dword v7, v4, s[16:19], s89 offen offset:4 sc1
    s_waitcnt vmcnt(0)
    s_sub_u32 s84, s84, 1
    s_cbranch_scc1 pc_62
    v_cmp_gt_u32 vcc, 1, v7
    s_nop 0
    s_and_b64 vcc, vcc, s[50:51]
    s_cbranch_scc1 pl_61
    s_branch pc_62
rd_65:
    s_cmp_eq_u32 s38, 0
    s_cbranch_scc1 rc_66
    s_sub_u32 s38, s38, 1
    s_nop 7
    s_nop 7
    s_sleep 4
    s_mov_b64 exec, vcc
    s_add_u32 s26, s3, 9437184
    buffer_load_dwordx4 v[216:219], v236, s[16:19], s26 offen sc1
    s_add_u32 s26, s26, 524288
    buffer_load_dwordx4 v[220:223], v236, s[16:19], s26 offen sc1
    s_add_u32 s26, s26, 524288
    buffer_load_dwordx4 v[224:227], v236, s[16:19], s26 offen sc1
    s_add_u32 s26, s26, 524288
    buffer_load_dwordx4 v[228:231], v236, s[16:19], s26 offen sc1
    s_add_u32 s26, s26, 524288
    buffer_load_dwordx4 v[232:235], v236, s[16:19], s26 offen sc1
    s_mov_b64 exec, -1
    s_waitcnt vmcnt(0) lgkmcnt(0)
    s_branch se_64
rd_67:
    s_cmp_eq_u32 s39, 0
    s_cbranch_scc1 rc_68
    s_sub_u32 s39, s39, 1
    s_nop 7
    s_nop 7
    s_waitcnt vmcnt(0) lgkmcnt(0)
    s_barrier
    s_lshl_b32 s25, s72, 5
    s_add_u32 s25, s25, 0
    s_sub_u32 s26, s25, 4
    s_max_i32 s26, s26, 0
    s_lshl_b32 s27, s71, 12
    s_add_u32 s27, s27, 9437184
    s_lshl_b32 s99, s25, 3
    s_lshl_b32 s100, s26, 3
    s_lshl_b32 s92, s24, 12
    s_lshl_b32 s93, s24, 9
    s_add_u32 s99, s99, s27
    s_add_u32 s100, s100, s27
    s_add_u32 m0, s92, 36352
    s_nop 0
    buffer_load_dwordx4 v73, s[16:19], s99 offen offset:0 sc1 lds
    buffer_load_dwordx4 v74, s[16:19], s99 offen offset:1024 sc1 lds
    buffer_load_dwordx4 v75, s[16:19], s99 offen offset:2048 sc1 lds
    buffer_load_dwordx4 v76, s[16:19], s99 offen offset:3072 sc1 lds
    s_add_u32 m0, s93, 53760
    s_add_u32 s99, s99, 524288
    s_mov_b64 exec, s[80:81]
    buffer_load_dwordx4 v77, s[16:19], s100 offen sc1 lds
    s_mov_b64 exec, -1
    s_add_u32 s100, s100, 524288
    s_add_u32 m0, s92, 55936
    s_nop 0
    s_nop 0
    buffer_load_dwordx4 v73, s[16:19], s99 offen offset:0 sc1 lds
    buffer_load_dwordx4 v74, s[16:19], s99 offen offset:1024 sc1 lds
    buffer_load_dwordx4 v75, s[16:19], s99 offen offset:2048 sc1 lds
    buffer_load_dwordx4 v76, s[16:19], s99 offen offset:3072 sc1 lds
    s_add_u32 m0, s93, 73344
    s_add_u32 s99, s99, 524288
    s_mov_b64 exec, s[80:81]
    buffer_load_dwordx4 v77, s[16:19], s100 offen sc1 lds
    s_mov_b64 exec, -1
    s_add_u32 s100, s100, 524288
    s_mov_b64 exec, -1
    s_waitcnt vmcnt(0) lgkmcnt(0)
    s_branch ge_51
rd_71:
    s_cmp_eq_u32 s38, 0
    s_cbranch_scc1 rc_72
    s_sub_u32 s38, s38, 1
    s_nop 7
    s_nop 7
    s_sleep 4
    s_mov_b64 exec, vcc
    s_lshl_b32 s98, s72, 5
    s_add_u32 s98, s98, 256
    s_sub_u32 s95, s98, 4
    s_max_i32 s95, s95, 0
    s_lshl_b32 s94, s98, 3
    s_lshl_b32 s95, s95, 3
    s_nop 0
    s_add_u32 s94, s94, 3457024
    s_add_u32 s95, s95, 3457024
    s_add_u32 s96, s94, 8192
    buffer_load_dwordx2 v[152:153], v47, s[16:19], s94 offen sc1
    buffer_load_dwordx2 v[154:155], v47, s[16:19], s96 offen sc1
    buffer_load_dwordx2 v[156:157], v48, s[16:19], s95 offen sc1
    s_mov_b64 exec, -1
    s_waitcnt vmcnt(0) lgkmcnt(0)
    s_branch sl_70
rd_73:
    s_cmp_eq_u32 s39, 0
    s_cbranch_scc1 rc_74
    s_sub_u32 s39, s39, 1
    s_nop 7
    s_nop 7
    s_waitcnt vmcnt(0) lgkmcnt(0)
    s_barrier
    s_lshl_b32 s25, s72, 5
    s_add_u32 s25, s25, 256
    s_sub_u32 s26, s25, 4
    s_max_i32 s26, s26, 0
    s_lshl_b32 s27, s71, 12
    s_add_u32 s27, s27, 9437184
    s_lshl_b32 s99, s25, 3
    s_lshl_b32 s100, s26, 3
    s_lshl_b32 s92, s24, 12
    s_lshl_b32 s93, s24, 9
    s_add_u32 s99, s99, s27
    s_add_u32 s100, s100, s27
    s_add_u32 m0, s92, 36352
    s_nop 0
    s_nop 0
    buffer_load_dwordx4 v73, s[16:19], s99 offen offset:0 sc1 lds
    buffer_load_dwordx4 v74, s[16:19], s99 offen offset:1024 sc1 lds
    buffer_load_dwordx4 v75, s[16:19], s99 offen offset:2048 sc1 lds
    buffer_load_dwordx4 v76, s[16:19], s99 offen offset:3072 sc1 lds
    s_add_u32 m0, s93, 53760
    s_add_u32 s99, s99, 524288
    s_mov_b64 exec, s[80:81]
    buffer_load_dwordx4 v77, s[16:19], s100 offen sc1 lds
    s_mov_b64 exec, -1
    s_add_u32 s100, s100, 524288
    s_add_u32 m0, s92, 55936
    s_nop 0
    s_nop 0
    buffer_load_dwordx4 v73, s[16:19], s99 offen offset:0 sc1 lds
    buffer_load_dwordx4 v74, s[16:19], s99 offen offset:1024 sc1 lds
    buffer_load_dwordx4 v75, s[16:19], s99 offen offset:2048 sc1 lds
    buffer_load_dwordx4 v76, s[16:19], s99 offen offset:3072 sc1 lds
    s_add_u32 m0, s93, 73344
    s_add_u32 s99, s99, 524288
    s_mov_b64 exec, s[80:81]
    buffer_load_dwordx4 v77, s[16:19], s100 offen sc1 lds
    s_mov_b64 exec, -1
    s_add_u32 s100, s100, 524288
    s_add_u32 m0, s92, 75520
    s_nop 0
    s_nop 0
    buffer_load_dwordx4 v73, s[16:19], s99 offen offset:0 sc1 lds
    buffer_load_dwordx4 v74, s[16:19], s99 offen offset:1024 sc1 lds
    buffer_load_dwordx4 v75, s[16:19], s99 offen offset:2048 sc1 lds
    buffer_load_dwordx4 v76, s[16:19], s99 offen offset:3072 sc1 lds
    s_add_u32 m0, s93, 92928
    s_add_u32 s99, s99, 524288
    s_mov_b64 exec, s[80:81]
    buffer_load_dwordx4 v77, s[16:19], s100 offen sc1 lds
    s_mov_b64 exec, -1
    s_add_u32 s100, s100, 524288
    s_mov_b64 exec, -1
    s_waitcnt vmcnt(0) lgkmcnt(0)
    s_branch ge_69
rd_76:
    s_cmp_eq_u32 s38, 0
    s_cbranch_scc1 rc_77
    s_sub_u32 s38, s38, 1
    s_nop 7
    s_nop 7
    s_sleep 4
    s_mov_b64 exec, vcc
    s_mov_b32 s96, 12058624
    buffer_load_dwordx4 v[216:219], v56, s[16:19], s96 offen offset:0 sc1
    buffer_load_dwordx4 v[220:223], v56, s[16:19], s96 offen offset:256 sc1
    s_mov_b32 s96, 12091392
    buffer_load_dwordx4 v[224:227], v56, s[16:19], s96 offen offset:0 sc1
    buffer_load_dwordx4 v[228:231], v56, s[16:19], s96 offen offset:256 sc1
    s_mov_b32 s96, 12124160
    buffer_load_dwordx4 v[232:235], v56, s[16:19], s96 offen offset:0 sc1
    buffer_load_dwordx4 v[236:239], v56, s[16:19], s96 offen offset:256 sc1
    s_mov_b32 s96, 12156928
    buffer_load_dwordx4 v[240:243], v56, s[16:19], s96 offen offset:0 sc1
    buffer_load_dwordx4 v[244:247], v56, s[16:19], s96 offen offset:256 sc1
    s_mov_b32 s96, 12058624
    buffer_load_dwordx2 v[248:249], v57, s[16:19], s96 offen offset:0 sc1
    buffer_load_dwordx2 v[252:253], v57, s[16:19], s96 offen offset:128 sc1
    s_mov_b32 s96, 12075008
    buffer_load_dwordx2 v[250:251], v57, s[16:19], s96 offen offset:0 sc1
    buffer_load_dwordx2 v[254:255], v57, s[16:19], s96 offen offset:128 sc1
    s_mov_b32 s96, 9437184
    buffer_load_dwordx4 v[208:211], v59, s[16:19], s96 offen sc1
    s_add_u32 s97, s36, 9437184
    buffer_load_dword v212, v61, s[16:19], s97 offen sc1
    s_mov_b64 exec, -1
    s_waitcnt vmcnt(0) lgkmcnt(0)
    s_branch oe_75
rd_79:
    s_cmp_eq_u32 s38, 0
    s_cbranch_scc1 rc_80
    s_sub_u32 s38, s38, 1
    s_nop 7
    s_nop 7
    s_sleep 4
    s_mov_b64 exec, vcc
    s_mov_b32 s96, 12062720
    buffer_load_dwordx4 v[216:219], v56, s[16:19], s96 offen offset:0 sc1
    buffer_load_dwordx4 v[220:223], v56, s[16:19], s96 offen offset:256 sc1
    s_mov_b32 s96, 12095488
    buffer_load_dwordx4 v[224:227], v56, s[16:19], s96 offen offset:0 sc1
    buffer_load_dwordx4 v[228:231], v56, s[16:19], s96 offen offset:256 sc1
    s_mov_b32 s96, 12128256
    buffer_load_dwordx4 v[232:235], v56, s[16:19], s96 offen offset:0 sc1
    buffer_load_dwordx4 v[236:239], v56, s[16:19], s96 offen offset:256 sc1
    s_mov_b32 s96, 12161024
    buffer_load_dwordx4 v[240:243], v56, s[16:19], s96 offen offset:0 sc1
    buffer_load_dwordx4 v[244:247], v56, s[16:19], s96 offen offset:256 sc1
    s_mov_b32 s96, 12060672
    buffer_load_dwordx2 v[248:249], v57, s[16:19], s96 offen offset:0 sc1
    buffer_load_dwordx2 v[252:253], v57, s[16:19], s96 offen offset:128 sc1
    s_mov_b32 s96, 12077056
    buffer_load_dwordx2 v[250:251], v57, s[16:19], s96 offen offset:0 sc1
    buffer_load_dwordx2 v[254:255], v57, s[16:19], s96 offen offset:128 sc1
    s_mov_b32 s96, 9439232
    buffer_load_dwordx4 v[208:211], v59, s[16:19], s96 offen sc1
    s_add_u32 s97, s36, 9439232
    buffer_load_dword v212, v61, s[16:19], s97 offen sc1
    s_mov_b64 exec, -1
    s_waitcnt vmcnt(0) lgkmcnt(0)
    s_branch oe_78
rd_84:
    s_cmp_eq_u32 s38, 0
    s_cbranch_scc1 rc_85
    s_sub_u32 s38, s38, 1
    s_nop 7
    s_nop 7
    s_sleep 4
    s_mov_b64 exec, vcc
    s_lshl_b32 s96, s75, 14
    s_add_u32 s96, s96, 14680064
    s_lshl_b32 s97, s24, 12
    s_add_u32 s97, s97, 3506176
    buffer_load_dwordx4 v[176:179], v62, s[16:19], s96 offen offset:0 sc1
    buffer_load_dwordx4 v[180:183], v62, s[16:19], s96 offen offset:1024 sc1
    buffer_load_dwordx4 v[184:187], v62, s[16:19], s97 offen offset:0 sc1
    buffer_load_dwordx4 v[188:191], v62, s[16:19], s97 offen offset:1024 sc1
    buffer_load_dwordx4 v[192:195], v62, s[16:19], s97 offen offset:2048 sc1
    buffer_load_dwordx4 v[196:199], v62, s[16:19], s97 offen offset:3072 sc1
    s_mov_b64 exec, -1
    s_waitcnt vmcnt(0) lgkmcnt(0)
    s_branch ce_83
rd_87:
    s_cmp_eq_u32 s38, 0
    s_cbranch_scc1 rc_88
    s_sub_u32 s38, s38, 1
    s_nop 7
    s_nop 7
    s_sleep 4
    s_mov_b64 exec, vcc
    s_lshl_b32 s96, s75, 14
    s_add_u32 s96, s96, 14680064
    s_lshl_b32 s97, s24, 12
    s_add_u32 s97, s97, 3510272
    buffer_load_dwordx4 v[248:251], v62, s[16:19], s96 offen offset:2048 sc1
    buffer_load_dwordx4 v[252:255], v62, s[16:19], s96 offen offset:3072 sc1
    buffer_load_dwordx4 v[96:99], v62, s[16:19], s97 offen offset:0 sc1
    buffer_load_dwordx4 v[100:103], v62, s[16:19], s97 offen offset:1024 sc1
    buffer_load_dwordx4 v[104:107], v62, s[16:19], s97 offen offset:2048 sc1
    buffer_load_dwordx4 v[108:111], v62, s[16:19], s97 offen offset:3072 sc1
    s_mov_b64 exec, -1
    s_waitcnt vmcnt(0) lgkmcnt(0)
    s_branch ce_86
L_last:
    s_endpgm
.section .rodata,"a"
.p2align 6
.amdhsa_kernel interleave_layers__sliding_local_dilated__ssm_conv_s4d__prompt_kernel
  .amdhsa_next_free_vgpr 512
  .amdhsa_next_free_sgpr 102
  .amdhsa_accum_offset 256
  .amdhsa_group_segment_fixed_size 0
  .amdhsa_kernarg_size 104
  .amdhsa_user_sgpr_count 2
  .amdhsa_user_sgpr_kernarg_segment_ptr 1
  .amdhsa_system_sgpr_workgroup_id_x 1
.end_amdhsa_kernel
```

```asm
; @launch grid=(256,1,1) block=(256,1,1) lds=163840
.amdgcn_target "amdgcn-amd-amdhsa--gfx950"
.text
.globl interleave_layers__sliding_local_dilated__ssm_conv_s4d__prompt_kernel
.p2align 8
.type interleave_layers__sliding_local_dilated__ssm_conv_s4d__prompt_kernel,@function
interleave_layers__sliding_local_dilated__ssm_conv_s4d__prompt_kernel:
    s_getpc_b64 s[42:43]
L_start:
    s_cmp_ge_u32 s2, 256
    s_cbranch_scc1 L_end
    s_load_dwordx16 s[44:59], s[0:1], 0
    s_load_dwordx8 s[60:67], s[0:1], 64
    s_load_dwordx2 s[68:69], s[0:1], 96
    v_and_b32 v1, 63, v0
    v_lshrrev_b32 v2, 6, v0
    s_nop 0
    v_readfirstlane_b32 s24, v2
    s_bfe_u32 s82, s2, 0x40003
    s_lshl_b32 s82, s82, 13
    v_lshrrev_b32 v159, 2, v0
    v_lshl_add_u32 v159, v159, 7, s82
    v_min_u32 v159, L_last-L_start, v159
    global_load_dword v159, v159, s[42:43]
    s_and_b32 s25, s2, 7
    s_lshr_b32 s26, s2, 3
    s_and_b32 s27, s26, 3
    s_lshr_b32 s28, s26, 4
    s_lshl_b32 s28, s28, 2
    s_add_u32 s3, s27, s28
    s_lshl_b32 s27, s3, 2
    s_lshr_b32 s70, 0x75206431, s27
    s_and_b32 s70, s70, 7
    s_and_b32 s27, s25, 1
    s_lshl_b32 s27, s27, 3
    s_add_u32 s70, s70, s27
    s_bfe_u32 s71, s26, 0x10002
    s_bfe_u32 s28, s26, 0x10003
    s_and_b32 s72, s25, 6
    s_add_u32 s72, s72, s28
    s_and_b32 s73, s26, 7
    s_lshr_b32 s28, s26, 3
    s_lshl_b32 s74, s25, 2
    s_add_u32 s74, s74, s28
    s_mul_i32 s75, s25, 20
    s_add_u32 s75, s75, s26
    s_min_u32 s27, s2, 239
    s_mul_i32 s25, s27, 10923
    s_lshr_b32 s25, s25, 16
    s_mul_i32 s26, s25, 6
    s_sub_u32 s26, s27, s26
    s_mul_i32 s27, s25, 61440
    s_mul_i32 s28, s26, 640
    s_add_u32 s27, s27, s28
    s_lshl_b32 s28, s24, 10
    v_add_u32 v85, 0, v0
    v_mul_u32_u24 v84, 1639, v85
    v_lshrrev_b32 v84, 16, v84
    v_mul_u32_u24 v84, 3200, v84
    v_lshl_add_u32 v85, v85, 4, v84
    v_add_u32 v86, 256, v0
    v_mul_u32_u24 v84, 1639, v86
    v_lshrrev_b32_e64 v84, 16, v84
    v_mul_u32_u24 v84, 3200, v84
    v_lshl_add_u32 v86, v86, 4, v84
    v_add_u32 v87, 512, v0
    v_min_u32 v87, 639, v87
    v_mul_u32_u24 v84, 1639, v87
    v_lshrrev_b32_e64 v84, 16, v84
    v_mul_u32_u24 v84, 3200, v84
    v_lshl_add_u32 v87, v87, 4, v84
    s_mov_b32 s76, 0
    s_mov_b32 s77, 0x80000000
    s_mov_b32 s80, -1
    s_mov_b32 s81, 0
    s_nop 0
    s_mov_b32 s78, 0xfe0000fe
    s_mov_b32 s79, 0xfe0000fe
    s_mov_b32 s6, 2621440
    s_mov_b32 s7, 0x20000
    s_mov_b32 s10, 2457600
    s_mov_b32 s11, 0x20000
    s_mov_b32 s14, 819200
    s_mov_b32 s15, 0x20000
    s_mov_b32 s18, 22061056
    s_mov_b32 s19, 0x20000
    s_mov_b32 s22, 2621440
    s_mov_b32 s23, 0x20000
    s_waitcnt lgkmcnt(0)
    s_mov_b32 s4, s44
    s_and_b32 s5, s45, 0xffff
    s_mov_b32 s8, s46
    s_and_b32 s9, s47, 0xffff
    s_mov_b32 s12, s48
    s_and_b32 s13, s49, 0xffff
    s_mov_b32 s16, s68
    s_and_b32 s17, s69, 0xffff
    s_mov_b32 s20, s64
    s_and_b32 s21, s65, 0xffff
    s_cmp_lg_u32 s2, 255
    s_cbranch_scc1 fz_1
    v_mov_b32 v120, 0
    v_mov_b32 v121, 0
    v_mov_b32 v122, 0
    v_mov_b32 v123, 0
    v_lshlrev_b32 v124, 4, v0
    s_mov_b32 s88, 3538944
    buffer_store_dwordx4 v[120:123], v124, s[16:19], s88 offen sc1
    s_mov_b32 s88, 3543040
    buffer_store_dwordx4 v[120:123], v124, s[16:19], s88 offen sc1
    s_mov_b32 s88, 3547136
    buffer_store_dwordx4 v[120:123], v124, s[16:19], s88 offen sc1
    s_mov_b32 s88, 3555328
    buffer_store_dwordx4 v[120:123], v124, s[16:19], s88 offen sc1
    s_mov_b32 s88, 3559424
    buffer_store_dwordx4 v[120:123], v124, s[16:19], s88 offen sc1
    s_mov_b32 s88, 3563520
    buffer_store_dwordx4 v[120:123], v124, s[16:19], s88 offen sc1
fz_1:
    s_min_u32 s96, s75, 159
    s_lshl_b32 s96, s96, 2
    s_add_u32 s96, s96, s24
    s_mul_i32 s97, s96, 384
    s_lshl_b32 s96, s96, 1
    v_lshl_add_u32 v2, v1, 2, s97
    v_mov_b32 v241, s96
    global_load_dword v232, v2, s[52:53]
    global_load_dword v233, v2, s[54:55]
    global_load_dword v234, v2, s[56:57]
    global_load_dword v235, v2, s[58:59]
    global_load_ushort v240, v241, s[60:61]
    s_add_u32 m0, s28, 134272
    s_nop 0
    buffer_load_dwordx4 v85, s[8:11], s27 offen lds
    s_add_u32 m0, s28, 138368
    s_nop 0
    buffer_load_dwordx4 v86, s[8:11], s27 offen lds
    s_add_u32 m0, s28, 142464
    s_nop 0
    buffer_load_dwordx4 v87, s[8:11], s27 offen lds
    s_lshr_b32 s29, s26, 1
    s_and_b32 s30, s26, 1
    s_lshl_b32 s30, s30, 3
    s_lshl_b32 s31, s25, 10
    s_add_u32 s31, s31, 0
    s_cmp_ge_u32 s2, 240
    s_cselect_b32 s31, 1073741824, s31
    v_bfe_u32 v93, v0, 2, 2
    v_bfe_u32 v92, v0, 1, 1
    v_lshl_add_u32 v92, v92, 3, v93
    v_mul_u32_u24 v92, 640, v92
    v_and_b32 v93, 1, v0
    v_mul_u32_u24 v93, 40, v93
    v_add_u32 v91, v92, v93
    v_add_u32 v91, 134272, v91
    v_lshrrev_b32 v88, 4, v0
    v_add_u32 v88, 0, v88
    v_cmp_gt_u32 vcc, 40, v88
    v_min_u32 v88, 39, v88
    v_mul_u32_u24 v89, 13108, v88
    v_lshrrev_b32 v89, 16, v89
    v_mul_u32_u24 v90, 5, v89
    v_sub_u32_e64 v90, v88, v90
    v_mul_u32_u24 v92, 80, v89
    v_lshl_add_u32 v92, v90, 3, v92
    v_add_u32 v111, v92, v91
    v_add_u32 v89, s30, v89
    v_cmp_eq_u32 s[82:83], 4, v90
    v_mov_b32 v92, s29
    s_nop 0
    v_cndmask_b32 v93, v90, v92, s[82:83]
    v_cndmask_b32 v92, v92, 3, s[82:83]
    v_lshl_add_u32 v89, v89, 2, v93
    v_mul_u32_u24 v89, 40960, v89
    v_lshl_add_u32 v89, v92, 8, v89
    v_and_b32 v92, 15, v0
    v_lshl_add_u32 v89, v92, 4, v89
    v_mov_b32 v92, 1073741824
    v_cndmask_b32 v89, v92, v89, vcc
    v_add_u32 v108, s31, v89
    v_lshrrev_b32 v88, 4, v0
    v_add_u32 v88, 16, v88
    v_cmp_gt_u32 vcc, 40, v88
    v_min_u32 v88, 39, v88
    v_mul_u32_u24 v89, 13108, v88
    v_lshrrev_b32 v89, 16, v89
    v_mul_u32_u24 v90, 5, v89
    v_sub_u32_e64 v90, v88, v90
    v_mul_u32_u24 v92, 80, v89
    v_lshl_add_u32 v92, v90, 3, v92
    v_add_u32 v112, v92, v91
    v_add_u32 v89, s30, v89
    v_cmp_eq_u32 s[82:83], 4, v90
    v_mov_b32 v92, s29
    s_nop 0
    v_cndmask_b32 v93, v90, v92, s[82:83]
    v_cndmask_b32 v92, v92, 3, s[82:83]
    v_lshl_add_u32 v89, v89, 2, v93
    v_mul_u32_u24 v89, 40960, v89
    v_lshl_add_u32 v89, v92, 8, v89
    v_and_b32 v92, 15, v0
    v_lshl_add_u32 v89, v92, 4, v89
    v_mov_b32 v92, 1073741824
    v_cndmask_b32 v89, v92, v89, vcc
    v_add_u32 v109, s31, v89
    v_lshrrev_b32 v88, 4, v0
    v_add_u32 v88, 32, v88
    v_cmp_gt_u32 vcc, 40, v88
    v_min_u32 v88, 39, v88
    v_mul_u32_u24 v89, 13108, v88
    v_lshrrev_b32 v89, 16, v89
    v_mul_u32_u24 v90, 5, v89
    v_sub_u32_e64 v90, v88, v90
    v_mul_u32_u24 v92, 80, v89
    v_lshl_add_u32 v92, v90, 3, v92
    v_add_u32 v113, v92, v91
    v_add_u32 v89, s30, v89
    v_cmp_eq_u32 s[82:83], 4, v90
    v_mov_b32 v92, s29
    s_nop 0
    v_cndmask_b32 v93, v90, v92, s[82:83]
    v_cndmask_b32 v92, v92, 3, s[82:83]
    v_lshl_add_u32 v89, v89, 2, v93
    v_mul_u32_u24 v89, 40960, v89
    v_lshl_add_u32 v89, v92, 8, v89
    v_and_b32 v92, 15, v0
    v_lshl_add_u32 v89, v92, 4, v89
    v_mov_b32 v92, 1073741824
    v_cndmask_b32 v89, v92, v89, vcc
    v_add_u32 v110, s31, v89
    s_mul_i32 s25, s3, 18
    s_lshl_b32 s26, s72, 7
    s_add_u32 s25, s25, s26
    s_add_u32 s25, s25, s71
    s_add_u32 s25, s25, -16
    s_max_i32 s25, s25, 0
    s_mul_i32 s25, s25, 1280
    v_lshrrev_b32_e64 v204, 1, v0
    v_min_u32 v204, 89, v204
    v_mul_u32_u24 v205, 6554, v204
    v_lshrrev_b32_e64 v205, 16, v205
    v_mul_u32_u24 v205, 1280, v205
    v_lshl_add_u32 v204, v204, 7, v205
    buffer_load_dword v204, v204, s[4:7], s25 offen
    s_and_b32 s25, s2, 7
    s_lshl_b32 s86, s25, 7
    s_add_u32 s86, s86, 3538944
    s_lshl_b32 s87, s25, 10
    s_add_u32 s87, s87, 3538944
    s_add_u32 s89, s87, 16384
    v_cmp_gt_u32 s[50:51], 8, v0
    v_cmp_eq_u32 vcc, 0, v0
    v_lshlrev_b32 v4, 7, v1
    v_mov_b32 v6, 1073741824
    v_cndmask_b32 v4, v6, v4, s[50:51]
    v_cndmask_b32 v6, v6, 0, vcc
    v_mov_b32 v5, 0
    v_mov_b32 v140, 0
    v_mov_b32_e64 v141, 0
    v_mov_b32 v142, 0x3f803f80
    v_mov_b32 v143, 0x3f803f80
    v_lshlrev_b32_e64 v144, 3, v0
    v_add_u32 v144, 155648, v144
    ds_write_b64 v144, v[140:141]
    ds_write_b64 v144, v[142:143] offset:2048
    v_and_b32 v50, 31, v1
    v_lshrrev_b32 v51, 5, v1
    v_mul_u32_u24 v52, 40, v50
    v_mul_u32_u24 v53, 3200, v51
    v_add_u32 v53, v52, v53
    s_lshl_b32 s25, s24, 3
    s_add_u32 s25, s25, 320
    v_add_u32 v38, s25, v53
    s_mul_i32 s25, s24, 6400
    s_add_u32 s25, s25, 352
    v_add_u32 v39, s25, v53
    s_lshl_b32 s31, s71, 12
    v_lshl_add_u32 v47, v50, 3, s31
    v_bfe_u32 v52, v1, 2, 1
    v_and_b32 v53, 3, v1
    v_lshlrev_b32 v54, 13, v52
    v_lshl_add_u32 v54, v53, 3, v54
    v_add_u32_e64 v48, s31, v54
    v_bfe_u32 v54, v1, 4, 1
    v_lshl_add_u32 v52, v54, 1, v52
    v_mul_u32_u24 v52, 40, v52
    v_add_u32 v52, v52, v53
    v_mul_u32_u24_e64 v52, 40, v52
    v_bfe_u32 v53, v1, 3, 1
    v_cmp_eq_u32 s[82:83], v53, v54
    v_lshl_add_u32 v53, v53, 1, v51
    v_cmp_eq_u32 vcc, 3, v53
    v_mov_b32 v54, s24
    s_nop 0
    v_cndmask_b32 v53, v53, v54, vcc
    v_cndmask_b32 v54, v54, 4, vcc
    v_mul_u32_u24 v53, 6400, v53
    v_lshl_add_u32 v52, v54, 3, v52
    v_add_u32_e64 v52, v52, v53
    v_add_u32 v40, 160, v52
    v_mov_b32 v52, 19584
    v_cndmask_b32 v49, 0, v52, s[78:79]
    v_and_b32 v50, 15, v1
    v_lshrrev_b32 v51, 4, v1
    s_and_b32 s25, s24, 1
    s_and_b32 s26, s24, 2
    s_mul_i32 s27, s25, 3200
    s_mul_i32 s28, s26, 320
    s_add_u32 s27, s27, s28
    s_add_u32 s27, s27, 0
    v_and_b32 v52, 1, v1
    v_mul_u32_u24 v52, 1600, v52
    v_lshrrev_b32 v53, 1, v50
    v_mul_u32_u24_e64 v54, 40, v53
    v_add3_u32 v52, v52, v54, s27
    v_lshl_add_u32 v41, v51, 3, v52
    v_add_u32_e64 v42, 32, v52
    v_bfe_u32 v52, v1, 2, 1
    v_mul_u32_u24 v52, 1600, v52
    v_lshrrev_b32 v54, 3, v1
    v_mul_u32_u24 v54, 40, v54
    v_add3_u32 v52, v52, v54, s27
    v_add_u32 v52, 12800, v52
    v_and_b32 v54, 3, v1
    v_lshl_add_u32 v43, v54, 3, v52
    v_add_u32 v52, 32, v52
    v_cmp_eq_u32 vcc, 0, v54
    v_mov_b32 v54, 157696
    s_nop 0
    v_cndmask_b32 v44, v54, v52, vcc
    v_and_b32 v52, 1, v51
    v_add_u32 v52, s26, v52
    v_lshrrev_b32 v54, 2, v50
    v_lshl_add_u32 v52, v52, 2, v54
    v_and_b32 v53, 1, v53
    v_lshl_add_u32 v52, v53, 4, v52
    v_and_b32 v53, 1, v50
    v_lshl_add_u32 v52, v53, 10, v52
    s_lshl_b32 s30, s70, 1
    s_add_u32 s30, s30, s25
    s_lshl_b32 s29, s30, 3
    s_add_u32 s29, s29, s71
    s_lshl_b32 s29, s29, 13
    v_lshrrev_b32 v53, 1, v51
    v_lshlrev_b32 v53, 15, v53
    v_lshl_add_u32 v53, v52, 4, v53
    v_add_u32_e64 v45, s29, v53
    s_lshl_b32 s29, s30, 2
    s_add_u32 s29, s29, s71
    s_lshl_b32 s29, s29, 12
    s_add_u32 s29, s29, 2097152
    v_lshl_add_u32 v46, v52, 3, s29
    s_or_b32 s29, s26, s72
    s_cmp_eq_u32 s29, 0
    s_cselect_b64 s[90:91], -1, 0
    v_lshlrev_b32 v52, 2, v51
    v_sub_u32 v52, v50, v52
    v_mov_b32 v55, 0xf149f2ca
    v_subrev_u32 v53, 0, v52
    v_cmp_lt_u32 vcc, 7, v53
    s_nop 1
    v_cndmask_b32 v28, 0, v55, vcc
    v_cmp_lt_i32 vcc, -9, v53
    s_nop 1
    v_cndmask_b32 v32, 0, v55, vcc
    v_cmp_le_i32 vcc, 0, v53
    v_mov_b32 v54, 0xffff
    s_nop 0
    v_cndmask_b32 v54, 0, v54, vcc
    v_mov_b32 v36, v54
    v_subrev_u32 v53, 1, v52
    v_cmp_lt_u32 vcc, 7, v53
    s_nop 1
    v_cndmask_b32 v29, 0, v55, vcc
    v_cmp_lt_i32 vcc, -9, v53
    s_nop 1
    v_cndmask_b32 v33, 0, v55, vcc
    v_cmp_le_i32 vcc, 0, v53
    v_mov_b32 v54, 0xffff0000
    s_nop 0
    v_cndmask_b32 v54, 0, v54, vcc
    v_or_b32 v36, v36, v54
    v_subrev_u32 v53, 2, v52
    v_cmp_lt_u32 vcc, 7, v53
    s_nop 1
    v_cndmask_b32 v30, 0, v55, vcc
    v_cmp_lt_i32 vcc, -9, v53
    s_nop 1
    v_cndmask_b32 v34, 0, v55, vcc
    v_cmp_le_i32 vcc, 0, v53
    v_mov_b32 v54, 0xffff
    s_nop 0
    v_cndmask_b32 v54, 0, v54, vcc
    v_mov_b32 v37, v54
    v_subrev_u32 v53, 3, v52
    v_cmp_lt_u32 vcc, 7, v53
    s_nop 1
    v_cndmask_b32 v31, 0, v55, vcc
    v_cmp_lt_i32 vcc, -9, v53
    s_nop 1
    v_cndmask_b32 v35, 0, v55, vcc
    v_cmp_le_i32 vcc, 0, v53
    v_mov_b32 v54, 0xffff0000
    s_nop 0
    v_cndmask_b32 v54, 0, v54, vcc
    v_or_b32 v37, v37, v54
    v_and_b32 v62, 15, v1
    v_lshrrev_b32 v63, 4, v1
    s_and_b32 s25, s74, 3
    s_lshr_b32 s26, s74, 2
    s_lshl_b32 s27, s24, 6
    s_add_u32 s27, s27, s25
    s_lshl_b32 s27, s27, 13
    s_lshl_b32 s28, s26, 9
    s_add_u32 s27, s27, s28
    v_lshl_add_u32 v64, v63, 17, s27
    v_lshl_add_u32 v56, v62, 4, v64
    s_lshl_b32 s27, s24, 5
    s_add_u32 s27, s27, s25
    s_lshl_b32 s27, s27, 12
    s_lshl_b32 s28, s26, 8
    s_add_u32 s27, s27, s28
    s_add_u32 s27, s27, 2097152
    v_lshl_add_u32 v64, v63, 15, s27
    v_lshl_add_u32 v57, v62, 3, v64
    v_lshlrev_b32 v58, 4, v1
    s_lshl_b32 s29, s25, 12
    s_add_u32 s29, s29, s28
    v_lshl_add_u32 v64, v62, 4, s29
    v_lshl_add_u32 v61, v63, 2, v64
    s_mul_i32 s30, s73, 20
    s_lshl_b32 s31, s24, 2
    s_add_u32 s30, s30, s31
    s_lshl_b32 s31, s30, 14
    v_lshl_add_u32 v64, v63, 14, v64
    v_add_u32 v59, s31, v64
    s_lshl_b32 s31, s26, 7
    s_add_u32 s31, s31, s25
    s_mul_i32 s31, s31, 1280
    s_lshl_b32 s30, s30, 3
    s_add_u32 s31, s31, s30
    v_mul_u32_u24 v64, 10240, v62
    v_lshl_add_u32 v64, v63, 3, v64
    v_add_u32_e64 v60, s31, v64
    s_lshl_b32 s25, s24, 12
    v_lshl_add_u32 v62, v1, 4, s25
    s_mul_i32 s25, s24, 1216
    s_add_u32 s25, s25, 192
    v_lshl_add_u32 v63, v1, 2, s25
    s_mul_i32 s25, s24, 4864
    s_add_u32 s25, s25, 80
    v_and_b32_e64 v70, 3, v1
    v_mul_u32_u24 v70, 1216, v70
    v_bfe_u32 v71, v1, 2, 3
    v_lshl_add_u32 v70, v71, 4, v70
    v_lshrrev_b32 v71, 5, v1
    v_lshl_add_u32 v70, v71, 4, v70
    v_add_u32 v64, s25, v70
    s_mul_i32 s25, s24, 4160
    s_add_u32 s25, s25, 134368
    v_lshlrev_b32 v71, 6, v71
    v_sub_u32 v71, s25, v71
    v_bfe_u32 v70, v1, 4, 1
    v_lshl_add_u32 v71, v70, 5, v71
    v_and_b32_e64 v70, 3, v1
    v_lshl_add_u32 v71, v70, 3, v71
    v_bfe_u32 v70, v1, 2, 2
    v_lshlrev_b32 v70, 3, v70
    v_sub_u32 v65, v71, v70
    s_mul_i32 s25, s24, 4224
    s_add_u32 s25, s25, 19456
    v_and_b32 v70, 3, v1
    v_mul_u32_u24 v70, 1056, v70
    v_and_b32 v71, 60, v1
    v_add3_u32 v66, v70, v71, s25
    s_mul_i32 s25, s24, 1056
    s_add_u32 s25, s25, 19456
    v_lshl_add_u32 v67, v1, 3, s25
    s_mul_i32 s25, s24, 1280
    s_lshl_b32 s26, s75, 3
    s_add_u32 s25, s25, s26
    v_mul_u32_u24 v70, 10240, v1
    v_add_u32 v68, s25, v70
    s_and_b32 s25, s24, 1
    s_lshl_b32 s25, s25, 6
    s_and_b32 s26, s24, 2
    s_add_u32 s25, s25, s26
    s_mul_i32 s25, s25, 1280
    v_lshrrev_b32 v140, 4, v1
    v_and_b32 v141, 15, v1
    v_xor_b32 v141, v140, v141
    v_lshlrev_b32_e64 v141, 4, v141
    v_mul_u32_u24 v142, 5120, v140
    v_add3_u32 v73, v141, v142, s25
    s_and_b32 s25, s24, 1
    s_lshl_b32 s25, s25, 3
    s_add_u32 s25, s25, s26
    s_mul_i32 s25, s25, 1280
    v_add3_u32 v77, v141, v142, s25
    v_lshrrev_b32 v141, 5, v1
    v_and_b32 v140, 3, v1
    v_xor_b32 v142, v140, v141
    v_lshlrev_b32_e64 v142, 4, v142
    v_lshl_add_u32 v142, v140, 8, v142
    v_bfe_u32 v140, v1, 2, 3
    v_mul_u32_u24 v140, 1088, v140
    v_add_u32 v78, v140, v142
    v_and_b32 v140, 1, v1
    v_xor_b32 v142, v140, v141
    v_lshlrev_b32 v142, 4, v142
    v_lshl_add_u32 v142, v140, 8, v142
    v_bfe_u32 v140, v1, 1, 2
    v_mul_u32_u24 v140, 544, v140
    v_add_u32_e64 v142, v140, v142
    v_add_u32 v74, 19392, v73
    v_add_u32 v75, 38784, v73
    v_add_u32 v76, 58176, v73
    v_add_u32 v142, 53760, v142
    v_and_b32 v140, 31, v1
    v_cmp_eq_u32 vcc, 0, v140
    v_cmp_eq_u32 s[82:83], 24, v140
    s_nop 0
    s_or_b64 vcc, vcc, s[82:83]
    v_mov_b32 v140, 155648
    v_mov_b32 v141, 157696
    v_cndmask_b32_e64 v140, v140, v141, vcc
    v_cndmask_b32 v79, v140, v142, s[78:79]
    v_bfe_u32 v201, v1, 3, 2
    v_and_b32 v202, s24, v201
    v_cmp_eq_u32 vcc, 3, v202
    v_lshrrev_b32 v202, 5, v1
    v_lshl_add_u32 v201, v201, 1, v202
    v_and_b32 v202, 7, v1
    v_lshl_add_u32 v201, v201, 3, v202
    v_lshlrev_b32 v200, 4, v201
    v_mov_b32 v201, 1073741824
    v_cndmask_b32 v200, v200, v201, vcc
    s_lshl_b32 s101, s70, 2
    s_add_u32 s101, s101, s24
    s_mul_i32 s101, s101, 40960
    s_add_u32 s101, s101, 0
    s_lshl_b32 s25, s72, 5
    s_add_u32 s25, s25, 0
    s_sub_u32 s26, s25, 4
    s_max_i32 s26, s26, 0
    s_mul_i32 s27, s71, 1280
    s_mul_i32 s99, s25, 5120
    s_mul_i32 s100, s26, 5120
    s_mul_i32 s92, s24, 4352
    s_mul_i32 s93, s24, 544
    s_add_u32 s99, s99, s27
    s_add_u32 s100, s100, s27
    s_mov_b32 s38, 0x10000
    s_mov_b32 s39, 0x1000
    s_cmp_ge_u32 s2, 160
    s_cbranch_scc1 nc_2
    s_mul_i32 s37, s24, 8704
    s_add_u32 s25, s37, 0
    s_add_u32 s37, s37, 0
    s_mov_b32 m0, s37
    v_and_b32 v199, 31, v1
    v_mul_u32_u24 v199, 272, v199
    v_lshrrev_b32 v215, 5, v1
    v_lshl_add_u32 v199, v215, 4, v199
    v_add_u32 v252, s25, v199
    s_waitcnt vmcnt(4)
    v_lshlrev_b32 v253, 16, v240
    v_mul_f32 v253, 0x3fb8aa3b, v253
    v_exp_f32 v253, v253
    s_nop 0
    v_cvt_pk_bf16_f32 v253, v253, v253
    v_lshlrev_b32 v253, 16, v253
    v_lshlrev_b32 v199, 16, v232
    v_mul_f32 v199, 0x3fb8aa3b, v199
    v_exp_f32 v199, v199
    v_lshlrev_b32 v255, 16, v233
    v_mul_f32 v255, v255, v253
    v_mul_f32 v255, 0x3e22f983, v255
    v_cvt_pk_bf16_f32 v199, v199, v199
    v_lshlrev_b32 v199, 16, v199
    v_mul_f32_e64 v254, v199, v253
    v_mul_f32 v254, 0xbfb8aa3b, v254
    v_mul_f32 v182, 0x41000000, v254
    v_mul_f32 v185, 0x41000000, v255
    v_mul_f32 v184, 0x43800000, v254
    v_mul_f32 v189, 0x43800000, v255
    v_fract_f32 v185, v185
    v_fract_f32 v188, v255
    v_fract_f32 v189, v189
    v_exp_f32 v182, v182
    v_exp_f32 v183, v254
    v_exp_f32 v184, v184
    v_cos_f32 v186, v185
    v_sin_f32 v187, v185
    v_cos_f32 v180, v188
    v_sin_f32 v181, v188
    v_cos_f32 v190, v189
    v_sin_f32 v191, v189
    v_lshlrev_b32 v192, 16, v234
    v_lshlrev_b32 v193, 16, v235
    v_add_f32 v199, v253, v253
    v_mul_f32 v192, v192, v199
    v_mul_f32 v193, v193, v199
    v_mul_f32 v186, v186, v182
    v_mul_f32 v187, v187, v182
    v_mul_f32 v180, v180, v183
    v_mul_f32 v181, v181, v183
    v_mul_f32 v190, v190, v184
    v_mul_f32_e64 v191, v191, v184
    v_mov_b32 v242, 0x3f80
    v_cvt_pk_bf16_f32 v243, v186, v187
    v_pk_mul_f32 v[194:195], v[186:187], v[186:187] op_sel:[0,0] op_sel_hi:[0,1]
    v_pk_fma_f32 v[172:173], v[186:187], v[186:187], v[194:195] op_sel:[1,1,0] op_sel_hi:[1,0,1] neg_lo:[0,1,0]
    v_cvt_pk_bf16_f32 v244, v172, v173
    v_pk_mul_f32 v[194:195], v[172:173], v[186:187] op_sel:[0,0] op_sel_hi:[0,1]
    v_pk_fma_f32 v[174:175], v[172:173], v[186:187], v[194:195] op_sel:[1,1,0] op_sel_hi:[1,0,1] neg_lo:[0,1,0]
    v_cvt_pk_bf16_f32 v245, v174, v175
    v_pk_mul_f32 v[194:195], v[174:175], v[186:187] op_sel:[0,0] op_sel_hi:[0,1]
    v_pk_fma_f32 v[172:173], v[174:175], v[186:187], v[194:195] op_sel:[1,1,0] op_sel_hi:[1,0,1] neg_lo:[0,1,0]
    v_cvt_pk_bf16_f32 v246, v172, v173
    v_pk_mul_f32 v[194:195], v[172:173], v[186:187] op_sel:[0,0] op_sel_hi:[0,1]
    v_pk_fma_f32 v[174:175], v[172:173], v[186:187], v[194:195] op_sel:[1,1,0] op_sel_hi:[1,0,1] neg_lo:[0,1,0]
    v_cvt_pk_bf16_f32 v247, v174, v175
    v_pk_mul_f32 v[194:195], v[174:175], v[186:187] op_sel:[0,0] op_sel_hi:[0,1]
    v_pk_fma_f32 v[172:173], v[174:175], v[186:187], v[194:195] op_sel:[1,1,0] op_sel_hi:[1,0,1] neg_lo:[0,1,0]
    v_cvt_pk_bf16_f32 v248, v172, v173
    v_pk_mul_f32 v[194:195], v[172:173], v[186:187] op_sel:[0,0] op_sel_hi:[0,1]
    v_pk_fma_f32 v[174:175], v[172:173], v[186:187], v[194:195] op_sel:[1,1,0] op_sel_hi:[1,0,1] neg_lo:[0,1,0]
    v_cvt_pk_bf16_f32 v249, v174, v175
    v_pk_mul_f32 v[194:195], v[174:175], v[186:187] op_sel:[0,0] op_sel_hi:[0,1]
    v_pk_fma_f32 v[172:173], v[174:175], v[186:187], v[194:195] op_sel:[1,1,0] op_sel_hi:[1,0,1] neg_lo:[0,1,0]
    v_cvt_pk_bf16_f32 v250, v172, v173
    v_pk_mul_f32 v[194:195], v[172:173], v[186:187] op_sel:[0,0] op_sel_hi:[0,1]
    v_pk_fma_f32 v[174:175], v[172:173], v[186:187], v[194:195] op_sel:[1,1,0] op_sel_hi:[1,0,1] neg_lo:[0,1,0]
    v_cvt_pk_bf16_f32 v251, v174, v175
    ds_write_addtid_b32 v242 offset:0
    ds_write_addtid_b32 v243 offset:272
    ds_write_addtid_b32 v244 offset:544
    ds_write_addtid_b32 v245 offset:816
    ds_write_addtid_b32 v246 offset:1088
    ds_write_addtid_b32 v247 offset:1360
    ds_write_addtid_b32 v248 offset:1632
    ds_write_addtid_b32 v249 offset:1904
    ds_write_addtid_b32 v250 offset:2176
    ds_write_addtid_b32 v251 offset:2448
    v_pk_mul_f32 v[194:195], v[174:175], v[186:187] op_sel:[0,0] op_sel_hi:[0,1]
    v_pk_fma_f32 v[172:173], v[174:175], v[186:187], v[194:195] op_sel:[1,1,0] op_sel_hi:[1,0,1] neg_lo:[0,1,0]
    v_cvt_pk_bf16_f32 v242, v172, v173
    v_pk_mul_f32 v[194:195], v[172:173], v[186:187] op_sel:[0,0] op_sel_hi:[0,1]
    v_pk_fma_f32 v[174:175], v[172:173], v[186:187], v[194:195] op_sel:[1,1,0] op_sel_hi:[1,0,1] neg_lo:[0,1,0]
    v_cvt_pk_bf16_f32 v243, v174, v175
    v_pk_mul_f32 v[194:195], v[174:175], v[186:187] op_sel:[0,0] op_sel_hi:[0,1]
    v_pk_fma_f32 v[172:173], v[174:175], v[186:187], v[194:195] op_sel:[1,1,0] op_sel_hi:[1,0,1] neg_lo:[0,1,0]
    v_cvt_pk_bf16_f32 v244, v172, v173
    v_pk_mul_f32 v[194:195], v[172:173], v[186:187] op_sel:[0,0] op_sel_hi:[0,1]
    v_pk_fma_f32 v[174:175], v[172:173], v[186:187], v[194:195] op_sel:[1,1,0] op_sel_hi:[1,0,1] neg_lo:[0,1,0]
    v_cvt_pk_bf16_f32 v245, v174, v175
    v_pk_mul_f32 v[194:195], v[174:175], v[186:187] op_sel:[0,0] op_sel_hi:[0,1]
    v_pk_fma_f32 v[172:173], v[174:175], v[186:187], v[194:195] op_sel:[1,1,0] op_sel_hi:[1,0,1] neg_lo:[0,1,0]
    v_cvt_pk_bf16_f32 v246, v172, v173
    v_pk_mul_f32 v[194:195], v[172:173], v[186:187] op_sel:[0,0] op_sel_hi:[0,1]
    v_pk_fma_f32 v[174:175], v[172:173], v[186:187], v[194:195] op_sel:[1,1,0] op_sel_hi:[1,0,1] neg_lo:[0,1,0]
    v_cvt_pk_bf16_f32 v247, v174, v175
    v_pk_mul_f32 v[194:195], v[174:175], v[186:187] op_sel:[0,0] op_sel_hi:[0,1]
    v_pk_fma_f32 v[172:173], v[174:175], v[186:187], v[194:195] op_sel:[1,1,0] op_sel_hi:[1,0,1] neg_lo:[0,1,0]
    v_cvt_pk_bf16_f32 v248, v172, v173
    v_pk_mul_f32 v[194:195], v[172:173], v[186:187] op_sel:[0,0] op_sel_hi:[0,1]
    v_pk_fma_f32 v[174:175], v[172:173], v[186:187], v[194:195] op_sel:[1,1,0] op_sel_hi:[1,0,1] neg_lo:[0,1,0]
    v_cvt_pk_bf16_f32 v249, v174, v175
    v_pk_mul_f32 v[194:195], v[174:175], v[186:187] op_sel:[0,0] op_sel_hi:[0,1]
    v_pk_fma_f32 v[172:173], v[174:175], v[186:187], v[194:195] op_sel:[1,1,0] op_sel_hi:[1,0,1] neg_lo:[0,1,0]
    v_cvt_pk_bf16_f32 v250, v172, v173
    v_pk_mul_f32 v[194:195], v[172:173], v[186:187] op_sel:[0,0] op_sel_hi:[0,1]
    v_pk_fma_f32 v[174:175], v[172:173], v[186:187], v[194:195] op_sel:[1,1,0] op_sel_hi:[1,0,1] neg_lo:[0,1,0]
    v_cvt_pk_bf16_f32 v251, v174, v175
    ds_write_addtid_b32 v242 offset:2720
    ds_write_addtid_b32 v243 offset:2992
    ds_write_addtid_b32 v244 offset:3264
    s_waitcnt vmcnt(1)
    s_barrier
    ds_read_b64_tr_b16 v[96:97], v111
    ds_read_b64_tr_b16 v[98:99], v111 offset:2560
    ds_read_b64_tr_b16 v[100:101], v112
    ds_read_b64_tr_b16 v[102:103], v112 offset:2560
    ds_read_b64_tr_b16 v[104:105], v113
    ds_read_b64_tr_b16 v[106:107], v113 offset:2560
    s_waitcnt lgkmcnt(4)
    buffer_store_dwordx4 v[96:99], v108, s[16:19], 0 offen sc1
    s_waitcnt lgkmcnt(2)
    buffer_store_dwordx4 v[100:103], v109, s[16:19], 0 offen sc1
    s_waitcnt lgkmcnt(0)
    s_nop 0
    buffer_store_dwordx4 v[104:107], v110, s[16:19], 0 offen sc1
    global_load_dword v7, v5, s[66:67] sc1
    ds_write_addtid_b32 v245 offset:3536
    ds_write_addtid_b32 v246 offset:3808
    ds_write_addtid_b32 v247 offset:4080
    ds_write_addtid_b32 v248 offset:4352
    ds_write_addtid_b32 v249 offset:4624
    ds_write_addtid_b32 v250 offset:4896
    ds_write_addtid_b32 v251 offset:5168
    v_pk_mul_f32 v[194:195], v[174:175], v[186:187] op_sel:[0,0] op_sel_hi:[0,1]
    v_pk_fma_f32 v[172:173], v[174:175], v[186:187], v[194:195] op_sel:[1,1,0] op_sel_hi:[1,0,1] neg_lo:[0,1,0]
    v_cvt_pk_bf16_f32 v242, v172, v173
    v_pk_mul_f32 v[194:195], v[172:173], v[186:187] op_sel:[0,0] op_sel_hi:[0,1]
    v_pk_fma_f32 v[174:175], v[172:173], v[186:187], v[194:195] op_sel:[1,1,0] op_sel_hi:[1,0,1] neg_lo:[0,1,0]
    v_cvt_pk_bf16_f32 v243, v174, v175
    v_pk_mul_f32 v[194:195], v[174:175], v[186:187] op_sel:[0,0] op_sel_hi:[0,1]
    v_pk_fma_f32 v[172:173], v[174:175], v[186:187], v[194:195] op_sel:[1,1,0] op_sel_hi:[1,0,1] neg_lo:[0,1,0]
    v_cvt_pk_bf16_f32 v244, v172, v173
    v_pk_mul_f32 v[194:195], v[172:173], v[186:187] op_sel:[0,0] op_sel_hi:[0,1]
    v_pk_fma_f32 v[174:175], v[172:173], v[186:187], v[194:195] op_sel:[1,1,0] op_sel_hi:[1,0,1] neg_lo:[0,1,0]
    v_cvt_pk_bf16_f32 v245, v174, v175
    v_pk_mul_f32 v[194:195], v[174:175], v[186:187] op_sel:[0,0] op_sel_hi:[0,1]
    v_pk_fma_f32 v[172:173], v[174:175], v[186:187], v[194:195] op_sel:[1,1,0] op_sel_hi:[1,0,1] neg_lo:[0,1,0]
    v_cvt_pk_bf16_f32 v246, v172, v173
    v_pk_mul_f32 v[194:195], v[172:173], v[186:187] op_sel:[0,0] op_sel_hi:[0,1]
    v_pk_fma_f32 v[174:175], v[172:173], v[186:187], v[194:195] op_sel:[1,1,0] op_sel_hi:[1,0,1] neg_lo:[0,1,0]
    v_cvt_pk_bf16_f32 v247, v174, v175
    v_pk_mul_f32 v[194:195], v[174:175], v[186:187] op_sel:[0,0] op_sel_hi:[0,1]
    v_pk_fma_f32 v[172:173], v[174:175], v[186:187], v[194:195] op_sel:[1,1,0] op_sel_hi:[1,0,1] neg_lo:[0,1,0]
    v_cvt_pk_bf16_f32 v248, v172, v173
    v_pk_mul_f32 v[194:195], v[172:173], v[186:187] op_sel:[0,0] op_sel_hi:[0,1]
    v_pk_fma_f32 v[174:175], v[172:173], v[186:187], v[194:195] op_sel:[1,1,0] op_sel_hi:[1,0,1] neg_lo:[0,1,0]
    v_cvt_pk_bf16_f32 v249, v174, v175
    v_pk_mul_f32 v[194:195], v[174:175], v[186:187] op_sel:[0,0] op_sel_hi:[0,1]
    v_pk_fma_f32 v[172:173], v[174:175], v[186:187], v[194:195] op_sel:[1,1,0] op_sel_hi:[1,0,1] neg_lo:[0,1,0]
    v_cvt_pk_bf16_f32 v250, v172, v173
    v_pk_mul_f32 v[194:195], v[172:173], v[186:187] op_sel:[0,0] op_sel_hi:[0,1]
    v_pk_fma_f32 v[174:175], v[172:173], v[186:187], v[194:195] op_sel:[1,1,0] op_sel_hi:[1,0,1] neg_lo:[0,1,0]
    s_min_u32 s96, s75, 159
    s_lshl_b32 s96, s96, 2
    s_add_u32 s96, s96, s24
    s_mul_i32 s97, s96, 384
    s_lshl_b32 s96, s96, 1
    v_lshl_add_u32 v2, v1, 1, s97
    v_mov_b32 v241, s96
    global_load_ushort v236, v2, s[52:53] offset:256
    global_load_ushort v237, v2, s[54:55] offset:256
    global_load_ushort v238, v2, s[56:57] offset:256
    global_load_ushort v239, v2, s[58:59] offset:256
    global_load_ushort v241, v241, s[62:63]
    v_cvt_pk_bf16_f32 v251, v174, v175
    ds_write_addtid_b32 v242 offset:5440
    ds_write_addtid_b32 v243 offset:5712
    ds_write_addtid_b32 v244 offset:5984
    ds_write_addtid_b32 v245 offset:6256
    ds_write_addtid_b32 v246 offset:6528
    ds_write_addtid_b32 v247 offset:6800
    ds_write_addtid_b32 v248 offset:7072
    ds_write_addtid_b32 v249 offset:7344
    ds_write_addtid_b32 v250 offset:7616
    ds_write_addtid_b32 v251 offset:7888
    v_pk_mul_f32 v[194:195], v[174:175], v[186:187] op_sel:[0,0] op_sel_hi:[0,1]
    v_pk_fma_f32 v[172:173], v[174:175], v[186:187], v[194:195] op_sel:[1,1,0] op_sel_hi:[1,0,1] neg_lo:[0,1,0]
    v_cvt_pk_bf16_f32 v242, v172, v173
    v_pk_mul_f32 v[194:195], v[172:173], v[186:187] op_sel:[0,0] op_sel_hi:[0,1]
    v_pk_fma_f32 v[174:175], v[172:173], v[186:187], v[194:195] op_sel:[1,1,0] op_sel_hi:[1,0,1] neg_lo:[0,1,0]
    v_cvt_pk_bf16_f32 v243, v174, v175
    ds_write_addtid_b32 v242 offset:8160
    ds_write_addtid_b32 v243 offset:8432
    ds_read_b128 a[160:163], v252 offset:0
    ds_read_b128 a[164:167], v252 offset:32
    ds_read_b128 a[168:171], v252 offset:64
    ds_read_b128 a[172:175], v252 offset:96
    ds_read_b128 a[176:179], v252 offset:128
    ds_read_b128 a[180:183], v252 offset:160
    ds_read_b128 a[184:187], v252 offset:192
    ds_read_b128 a[188:191], v252 offset:224
    v_pk_mul_f32 v[194:195], v[180:181], v[180:181] op_sel:[0,0] op_sel_hi:[0,1]
    v_pk_fma_f32 v[182:183], v[180:181], v[180:181], v[194:195] op_sel:[1,1,0] op_sel_hi:[1,0,1] neg_lo:[0,1,0]
    v_pk_mul_f32 v[194:195], v[182:183], v[182:183] op_sel:[0,0] op_sel_hi:[0,1]
    v_pk_fma_f32 v[184:185], v[182:183], v[182:183], v[194:195] op_sel:[1,1,0] op_sel_hi:[1,0,1] neg_lo:[0,1,0]
    v_cvt_pk_bf16_f32 v242, v192, -v193
    v_pk_mul_f32 v[194:195], v[192:193], v[180:181] op_sel:[0,0] op_sel_hi:[0,1]
    v_pk_fma_f32 v[174:175], v[192:193], v[180:181], v[194:195] op_sel:[1,1,0] op_sel_hi:[1,0,1] neg_lo:[0,1,0]
    v_cvt_pk_bf16_f32 v243, v174, -v175
    v_pk_mul_f32 v[194:195], v[174:175], v[180:181] op_sel:[0,0] op_sel_hi:[0,1]
    v_lshrrev_b32 v132, 5, v0
    v_and_b32 v133, 31, v0
    v_mul_u32_u24 v132, 1280, v132
    v_lshl_add_u32 v134, v133, 4, v132
    v_mov_b32 v135, 1073741824
    v_cmp_gt_u32 vcc, 16, v133
    s_mul_i32 s96, s2, 10240
    buffer_load_dwordx4 v[120:123], v134, s[4:7], s96 offen
    v_cndmask_b32_e64 v135, v135, v134, vcc
    buffer_load_dwordx4 v[124:127], v134, s[4:7], s96 offen offset:512
    buffer_load_dwordx4 v[128:131], v135, s[4:7], s96 offen offset:1024
    v_pk_fma_f32 v[172:173], v[174:175], v[180:181], v[194:195] op_sel:[1,1,0] op_sel_hi:[1,0,1] neg_lo:[0,1,0]
    v_cvt_pk_bf16_f32 v244, v172, -v173
    v_pk_mul_f32 v[194:195], v[172:173], v[180:181] op_sel:[0,0] op_sel_hi:[0,1]
    v_pk_fma_f32 v[174:175], v[172:173], v[180:181], v[194:195] op_sel:[1,1,0] op_sel_hi:[1,0,1] neg_lo:[0,1,0]
    v_cvt_pk_bf16_f32 v245, v174, -v175
    v_pk_mul_f32 v[194:195], v[174:175], v[180:181] op_sel:[0,0] op_sel_hi:[0,1]
    v_pk_fma_f32 v[172:173], v[174:175], v[180:181], v[194:195] op_sel:[1,1,0] op_sel_hi:[1,0,1] neg_lo:[0,1,0]
    v_cvt_pk_bf16_f32 v246, v172, -v173
    v_pk_mul_f32 v[194:195], v[172:173], v[180:181] op_sel:[0,0] op_sel_hi:[0,1]
    v_pk_fma_f32 v[174:175], v[172:173], v[180:181], v[194:195] op_sel:[1,1,0] op_sel_hi:[1,0,1] neg_lo:[0,1,0]
    v_cvt_pk_bf16_f32 v247, v174, -v175
    v_pk_mul_f32 v[194:195], v[174:175], v[180:181] op_sel:[0,0] op_sel_hi:[0,1]
    v_pk_fma_f32 v[172:173], v[174:175], v[180:181], v[194:195] op_sel:[1,1,0] op_sel_hi:[1,0,1] neg_lo:[0,1,0]
    v_cvt_pk_bf16_f32 v248, v172, -v173
    v_pk_mul_f32 v[194:195], v[172:173], v[180:181] op_sel:[0,0] op_sel_hi:[0,1]
    v_pk_fma_f32 v[174:175], v[172:173], v[180:181], v[194:195] op_sel:[1,1,0] op_sel_hi:[1,0,1] neg_lo:[0,1,0]
    v_cvt_pk_bf16_f32 v249, v174, -v175
    v_pk_mul_f32 v[194:195], v[192:193], v[190:191] op_sel:[0,0] op_sel_hi:[0,1]
    v_pk_fma_f32 v[176:177], v[192:193], v[190:191], v[194:195] op_sel:[1,1,0] op_sel_hi:[1,0,1] neg_lo:[0,1,0]
    v_cvt_pk_bf16_f32 v250, v176, -v177
    v_pk_mul_f32 v[194:195], v[176:177], v[182:183] op_sel:[0,0] op_sel_hi:[0,1]
    v_pk_fma_f32 v[174:175], v[176:177], v[182:183], v[194:195] op_sel:[1,1,0] op_sel_hi:[1,0,1] neg_lo:[0,1,0]
    v_cvt_pk_bf16_f32 v251, v174, -v175
    ds_write_addtid_b32 v242 offset:0
    ds_write_addtid_b32 v243 offset:272
    ds_write_addtid_b32 v244 offset:544
    ds_write_addtid_b32 v245 offset:816
    ds_write_addtid_b32 v246 offset:1088
    ds_write_addtid_b32 v247 offset:1360
    ds_write_addtid_b32 v248 offset:1632
    ds_write_addtid_b32 v249 offset:1904
    ds_write_addtid_b32 v250 offset:2176
    ds_write_addtid_b32 v251 offset:2448
    v_pk_mul_f32 v[194:195], v[174:175], v[182:183] op_sel:[0,0] op_sel_hi:[0,1]
    v_pk_fma_f32 v[172:173], v[174:175], v[182:183], v[194:195] op_sel:[1,1,0] op_sel_hi:[1,0,1] neg_lo:[0,1,0]
    v_cvt_pk_bf16_f32 v242, v172, -v173
    v_mov_b32 v140, 1073741824
    v_lshlrev_b32 v141, 2, v0
    v_cmp_gt_u32 vcc, 64, v0
    s_nop 1
    v_cndmask_b32 v141, v140, v141, vcc
    v_mov_b32_e64 v140, 0
    s_lshl_b32 s97, s2, 8
    s_add_u32 s97, s97, 3473408
    buffer_store_dword v140, v141, s[16:19], s97 offen sc1
    v_pk_mul_f32 v[194:195], v[172:173], v[182:183] op_sel:[0,0] op_sel_hi:[0,1]
    v_pk_fma_f32 v[174:175], v[172:173], v[182:183], v[194:195] op_sel:[1,1,0] op_sel_hi:[1,0,1] neg_lo:[0,1,0]
    v_cvt_pk_bf16_f32 v243, v174, -v175
    v_pk_mul_f32 v[194:195], v[174:175], v[182:183] op_sel:[0,0] op_sel_hi:[0,1]
    v_pk_fma_f32 v[172:173], v[174:175], v[182:183], v[194:195] op_sel:[1,1,0] op_sel_hi:[1,0,1] neg_lo:[0,1,0]
    v_cvt_pk_bf16_f32 v244, v172, -v173
    v_pk_mul_f32 v[194:195], v[176:177], v[190:191] op_sel:[0,0] op_sel_hi:[0,1]
    v_pk_fma_f32 v[178:179], v[176:177], v[190:191], v[194:195] op_sel:[1,1,0] op_sel_hi:[1,0,1] neg_lo:[0,1,0]
    v_cvt_pk_bf16_f32 v245, v178, -v179
    v_pk_mul_f32 v[194:195], v[178:179], v[184:185] op_sel:[0,0] op_sel_hi:[0,1]
    v_pk_fma_f32 v[174:175], v[178:179], v[184:185], v[194:195] op_sel:[1,1,0] op_sel_hi:[1,0,1] neg_lo:[0,1,0]
    v_cvt_pk_bf16_f32 v246, v174, -v175
    v_pk_mul_f32 v[194:195], v[174:175], v[184:185] op_sel:[0,0] op_sel_hi:[0,1]
    v_pk_fma_f32 v[172:173], v[174:175], v[184:185], v[194:195] op_sel:[1,1,0] op_sel_hi:[1,0,1] neg_lo:[0,1,0]
    v_cvt_pk_bf16_f32 v247, v172, -v173
    v_pk_mul_f32 v[194:195], v[178:179], v[190:191] op_sel:[0,0] op_sel_hi:[0,1]
    v_pk_fma_f32 v[176:177], v[178:179], v[190:191], v[194:195] op_sel:[1,1,0] op_sel_hi:[1,0,1] neg_lo:[0,1,0]
    v_cvt_pk_bf16_f32 v248, v176, -v177
    v_pk_mul_f32 v[194:195], v[176:177], v[184:185] op_sel:[0,0] op_sel_hi:[0,1]
    v_pk_fma_f32 v[174:175], v[176:177], v[184:185], v[194:195] op_sel:[1,1,0] op_sel_hi:[1,0,1] neg_lo:[0,1,0]
    v_cvt_pk_bf16_f32 v249, v174, -v175
    v_pk_mul_f32 v[194:195], v[174:175], v[184:185] op_sel:[0,0] op_sel_hi:[0,1]
    v_pk_fma_f32 v[172:173], v[174:175], v[184:185], v[194:195] op_sel:[1,1,0] op_sel_hi:[1,0,1] neg_lo:[0,1,0]
    v_cvt_pk_bf16_f32 v250, v172, -v173
    v_pk_mul_f32 v[194:195], v[176:177], v[190:191] op_sel:[0,0] op_sel_hi:[0,1]
    v_pk_fma_f32 v[178:179], v[176:177], v[190:191], v[194:195] op_sel:[1,1,0] op_sel_hi:[1,0,1] neg_lo:[0,1,0]
    v_cvt_pk_bf16_f32 v251, v178, -v179
    ds_write_addtid_b32 v242 offset:2720
    ds_write_addtid_b32 v242 offset:3264
    ds_write_addtid_b32 v243 offset:3536
    ds_write_addtid_b32 v244 offset:3808
    ds_write_addtid_b32 v245 offset:4352
    ds_write_addtid_b32 v246 offset:4624
    ds_write_addtid_b32 v247 offset:4896
    ds_write_addtid_b32 v248 offset:5440
    ds_write_addtid_b32 v249 offset:5712
    v_mov_b32 v142, 1073741824
    v_lshlrev_b32 v143, 2, v0
    v_cmp_gt_u32 vcc, 16, v0
    s_nop 1
    v_cndmask_b32 v143, v142, v143, vcc
    v_mov_b32_e64 v142, -1
    s_lshl_b32 s97, s2, 6
    s_add_u32 s97, s97, 3457024
    buffer_store_dword v142, v143, s[16:19], s97 offen sc1
    ds_write_addtid_b32 v250 offset:5984
    ds_write_addtid_b32 v251 offset:6528
    v_pk_mul_f32 v[194:195], v[178:179], v[186:187] op_sel:[0,0] op_sel_hi:[0,1]
    v_pk_fma_f32 v[174:175], v[178:179], v[186:187], v[194:195] op_sel:[1,1,0] op_sel_hi:[1,0,1] neg_lo:[0,1,0]
    v_cvt_pk_bf16_f32 v242, v174, -v175
    v_pk_mul_f32 v[194:195], v[178:179], v[190:191] op_sel:[0,0] op_sel_hi:[0,1]
    v_pk_fma_f32 v[176:177], v[178:179], v[190:191], v[194:195] op_sel:[1,1,0] op_sel_hi:[1,0,1] neg_lo:[0,1,0]
    v_cvt_pk_bf16_f32 v243, v176, -v177
    v_pk_mul_f32 v[194:195], v[176:177], v[186:187] op_sel:[0,0] op_sel_hi:[0,1]
    v_pk_fma_f32 v[174:175], v[176:177], v[186:187], v[194:195] op_sel:[1,1,0] op_sel_hi:[1,0,1] neg_lo:[0,1,0]
    v_cvt_pk_bf16_f32 v244, v174, -v175
    v_pk_mul_f32 v[194:195], v[176:177], v[190:191] op_sel:[0,0] op_sel_hi:[0,1]
    v_pk_fma_f32 v[178:179], v[176:177], v[190:191], v[194:195] op_sel:[1,1,0] op_sel_hi:[1,0,1] neg_lo:[0,1,0]
    v_cvt_pk_bf16_f32 v245, v178, -v179
    v_pk_mul_f32 v[194:195], v[178:179], v[186:187] op_sel:[0,0] op_sel_hi:[0,1]
    v_pk_fma_f32 v[174:175], v[178:179], v[186:187], v[194:195] op_sel:[1,1,0] op_sel_hi:[1,0,1] neg_lo:[0,1,0]
    v_cvt_pk_bf16_f32 v246, v174, -v175
    v_pk_mul_f32 v[194:195], v[178:179], v[190:191] op_sel:[0,0] op_sel_hi:[0,1]
    v_pk_fma_f32 v[176:177], v[178:179], v[190:191], v[194:195] op_sel:[1,1,0] op_sel_hi:[1,0,1] neg_lo:[0,1,0]
    v_cvt_pk_bf16_f32 v247, v176, -v177
    v_pk_mul_f32 v[194:195], v[176:177], v[186:187] op_sel:[0,0] op_sel_hi:[0,1]
    v_pk_fma_f32 v[174:175], v[176:177], v[186:187], v[194:195] op_sel:[1,1,0] op_sel_hi:[1,0,1] neg_lo:[0,1,0]
    v_cvt_pk_bf16_f32 v248, v174, -v175
    ds_write_addtid_b32 v242 offset:6800
    ds_write_addtid_b32 v243 offset:7072
    ds_write_addtid_b32 v244 offset:7344
    ds_write_addtid_b32 v245 offset:7616
    ds_write_addtid_b32 v246 offset:7888
    ds_write_addtid_b32 v247 offset:8160
    ds_write_addtid_b32 v248 offset:8432
    ds_read_b128 a[192:195], v252 offset:0
    ds_read_b128 a[196:199], v252 offset:32
    ds_read_b128 a[200:203], v252 offset:64
    ds_read_b128 a[204:207], v252 offset:96
    ds_read_b128 a[208:211], v252 offset:128
    ds_read_b128 a[212:215], v252 offset:160
    s_waitcnt vmcnt(11)
    s_waitcnt vmcnt(10)
    v_cmp_gt_u32 vcc, 1, v7
    s_nop 0
    s_and_b64 vcc, vcc, s[50:51]
    s_and_b64 vcc, vcc, 1
    s_cbranch_scc1 ps_4
pc_6:
    s_barrier
    v_lshlrev_b32 v2, 3, v4
    v_mov_b32 v5, 1
    v_cndmask_b32 v2, v4, v2, s[50:51]
    buffer_atomic_add v5, v2, s[16:19], s86 offen offset:0 sc1
    ds_read_b128 a[216:219], v252 offset:192
    ds_read_b128 a[220:223], v252 offset:224
    v_and_b32 v199, 0xffff0000, v232
    v_mul_f32 v199, 0x3fb8aa3b, v199
    v_exp_f32 v199, v199
    v_and_b32 v255, 0xffff0000, v233
    v_mul_f32 v255, v255, v253
    v_mul_f32 v255, 0x3e22f983, v255
    v_cvt_pk_bf16_f32 v199, v199, v199
    v_lshlrev_b32 v199, 16, v199
    v_mul_f32 v254, v199, v253
    v_mul_f32 v254, 0xbfb8aa3b, v254
    s_waitcnt lgkmcnt(7)
    v_mfma_f32_32x32x16_bf16 v[216:231], a[192:195], a[160:163], 0
    v_mul_f32 v182, 0x41000000, v254
    v_mul_f32 v185, 0x41000000, v255
    v_mul_f32 v184, 0x43800000, v254
    v_mul_f32 v189, 0x43800000, v255
    s_waitcnt lgkmcnt(6)
    v_mfma_f32_32x32x16_bf16 v[216:231], a[196:199], a[164:167], v[216:231]
    v_fract_f32 v185, v185
    v_fract_f32 v188, v255
    v_fract_f32 v189, v189
    v_exp_f32 v182, v182
    s_waitcnt lgkmcnt(5)
    v_mfma_f32_32x32x16_bf16 v[216:231], a[200:203], a[168:171], v[216:231]
    v_exp_f32 v183, v254
    v_exp_f32 v184, v184
    v_cos_f32 v186, v185
    v_mov_b32 v144, -1
    v_mov_b32 v145, -1
    v_mov_b32 v146, -1
    v_mov_b32 v147, -1
    v_lshlrev_b32_e64 v148, 4, v0
    s_sub_u32 s88, s2, 0
    s_mul_i32 s88, s88, 20480
    s_min_u32 s88, s88, 5222400
    s_add_u32 s88, s88, 4194304
    buffer_store_dwordx4 v[144:147], v148, s[16:19], s88 offen sc1
    v_sin_f32 v187, v185
    s_waitcnt lgkmcnt(4)
    v_mfma_f32_32x32x16_bf16 v[216:231], a[204:207], a[172:175], v[216:231]
    v_cos_f32 v180, v188
    v_sin_f32 v181, v188
    v_cos_f32 v190, v189
    v_sin_f32_e64 v191, v189
    s_waitcnt lgkmcnt(3)
    v_mfma_f32_32x32x16_bf16 v[216:231], a[208:211], a[176:179], v[216:231]
    v_and_b32 v192, 0xffff0000, v234
    v_and_b32 v193, 0xffff0000, v235
    v_add_f32 v199, v253, v253
    v_mul_f32 v192, v192, v199
    s_waitcnt lgkmcnt(2)
    v_mfma_f32_32x32x16_bf16 v[216:231], a[212:215], a[180:183], v[216:231]
    v_mul_f32 v193, v193, v199
    v_mul_f32 v186, v186, v182
    v_mul_f32 v187, v187, v182
    v_mul_f32 v180, v180, v183
    s_waitcnt lgkmcnt(1)
    v_mfma_f32_32x32x16_bf16 v[216:231], a[216:219], a[184:187], v[216:231]
    v_mul_f32 v181, v181, v183
    v_mul_f32 v190, v190, v184
    v_mul_f32 v191, v191, v184
    s_waitcnt lgkmcnt(0)
    v_mfma_f32_32x32x16_bf16 v[216:231], a[220:223], a[188:191], v[216:231]
    v_mov_b32 v242, 0x3f80
    v_cvt_pk_bf16_f32 v243, v186, v187
    v_pk_mul_f32 v[194:195], v[186:187], v[186:187] op_sel:[0,0] op_sel_hi:[0,1]
    v_pk_fma_f32 v[172:173], v[186:187], v[186:187], v[194:195] op_sel:[1,1,0] op_sel_hi:[1,0,1] neg_lo:[0,1,0]
    v_cvt_pk_bf16_f32 v244, v172, v173
    s_add_u32 s88, s88, 4096
    buffer_store_dwordx4 v[144:147], v148, s[16:19], s88 offen sc1
    v_pk_mul_f32 v[194:195], v[172:173], v[186:187] op_sel:[0,0] op_sel_hi:[0,1]
    v_pk_fma_f32 v[174:175], v[172:173], v[186:187], v[194:195] op_sel:[1,1,0] op_sel_hi:[1,0,1] neg_lo:[0,1,0]
    v_cvt_pk_bf16_f32 v245, v174, v175
    v_pk_mul_f32 v[194:195], v[174:175], v[186:187] op_sel:[0,0] op_sel_hi:[0,1]
    v_pk_fma_f32 v[172:173], v[174:175], v[186:187], v[194:195] op_sel:[1,1,0] op_sel_hi:[1,0,1] neg_lo:[0,1,0]
    v_cvt_pk_bf16_f32 v246, v172, v173
    v_pk_mul_f32 v[194:195], v[172:173], v[186:187] op_sel:[0,0] op_sel_hi:[0,1]
    v_pk_fma_f32 v[174:175], v[172:173], v[186:187], v[194:195] op_sel:[1,1,0] op_sel_hi:[1,0,1] neg_lo:[0,1,0]
    v_cvt_pk_bf16_f32 v247, v174, v175
    v_pk_mul_f32 v[194:195], v[174:175], v[186:187] op_sel:[0,0] op_sel_hi:[0,1]
    v_pk_fma_f32 v[172:173], v[174:175], v[186:187], v[194:195] op_sel:[1,1,0] op_sel_hi:[1,0,1] neg_lo:[0,1,0]
    v_cvt_pk_bf16_f32 v248, v172, v173
    v_pk_mul_f32 v[194:195], v[172:173], v[186:187] op_sel:[0,0] op_sel_hi:[0,1]
    v_pk_fma_f32 v[174:175], v[172:173], v[186:187], v[194:195] op_sel:[1,1,0] op_sel_hi:[1,0,1] neg_lo:[0,1,0]
    v_cvt_pk_bf16_f32 v249, v174, v175
    v_pk_mul_f32 v[194:195], v[174:175], v[186:187] op_sel:[0,0] op_sel_hi:[0,1]
    v_pk_fma_f32 v[172:173], v[174:175], v[186:187], v[194:195] op_sel:[1,1,0] op_sel_hi:[1,0,1] neg_lo:[0,1,0]
    v_cvt_pk_bf16_f32 v250, v172, v173
    v_pk_mul_f32 v[194:195], v[172:173], v[186:187] op_sel:[0,0] op_sel_hi:[0,1]
    v_pk_fma_f32 v[174:175], v[172:173], v[186:187], v[194:195] op_sel:[1,1,0] op_sel_hi:[1,0,1] neg_lo:[0,1,0]
    v_cvt_pk_bf16_f32 v251, v174, v175
    ds_write_addtid_b32 v242 offset:0
    ds_write_addtid_b32 v243 offset:272
    ds_write_addtid_b32 v244 offset:544
    ds_write_addtid_b32 v245 offset:816
    ds_write_addtid_b32 v246 offset:1088
    s_add_u32 s88, s88, 4096
    buffer_store_dwordx4 v[144:147], v148, s[16:19], s88 offen sc1
    ds_write_addtid_b32 v247 offset:1360
    ds_write_addtid_b32 v248 offset:1632
    ds_write_addtid_b32 v249 offset:1904
    ds_write_addtid_b32 v250 offset:2176
    ds_write_addtid_b32 v251 offset:2448
    v_pk_mul_f32 v[194:195], v[174:175], v[186:187] op_sel:[0,0] op_sel_hi:[0,1]
    v_pk_fma_f32 v[172:173], v[174:175], v[186:187], v[194:195] op_sel:[1,1,0] op_sel_hi:[1,0,1] neg_lo:[0,1,0]
    v_cvt_pk_bf16_f32 v242, v172, v173
    v_pk_mul_f32 v[194:195], v[172:173], v[186:187] op_sel:[0,0] op_sel_hi:[0,1]
    v_pk_fma_f32 v[174:175], v[172:173], v[186:187], v[194:195] op_sel:[1,1,0] op_sel_hi:[1,0,1] neg_lo:[0,1,0]
    v_cvt_pk_bf16_f32 v243, v174, v175
    v_pk_mul_f32 v[194:195], v[174:175], v[186:187] op_sel:[0,0] op_sel_hi:[0,1]
    v_pk_fma_f32 v[172:173], v[174:175], v[186:187], v[194:195] op_sel:[1,1,0] op_sel_hi:[1,0,1] neg_lo:[0,1,0]
    v_cvt_pk_bf16_f32 v244, v172, v173
    v_pk_mul_f32 v[194:195], v[172:173], v[186:187] op_sel:[0,0] op_sel_hi:[0,1]
    v_pk_fma_f32 v[174:175], v[172:173], v[186:187], v[194:195] op_sel:[1,1,0] op_sel_hi:[1,0,1] neg_lo:[0,1,0]
    v_cvt_pk_bf16_f32 v245, v174, v175
    v_pk_mul_f32 v[194:195], v[174:175], v[186:187] op_sel:[0,0] op_sel_hi:[0,1]
    v_pk_fma_f32 v[172:173], v[174:175], v[186:187], v[194:195] op_sel:[1,1,0] op_sel_hi:[1,0,1] neg_lo:[0,1,0]
    v_cvt_pk_bf16_f32 v246, v172, v173
    v_pk_mul_f32 v[194:195], v[172:173], v[186:187] op_sel:[0,0] op_sel_hi:[0,1]
    v_pk_fma_f32 v[174:175], v[172:173], v[186:187], v[194:195] op_sel:[1,1,0] op_sel_hi:[1,0,1] neg_lo:[0,1,0]
    v_cvt_pk_bf16_f32 v247, v174, v175
    v_pk_mul_f32 v[194:195], v[174:175], v[186:187] op_sel:[0,0] op_sel_hi:[0,1]
    v_pk_fma_f32 v[172:173], v[174:175], v[186:187], v[194:195] op_sel:[1,1,0] op_sel_hi:[1,0,1] neg_lo:[0,1,0]
    v_cvt_pk_bf16_f32 v248, v172, v173
    s_add_u32 s88, s88, 4096
    buffer_store_dwordx4 v[144:147], v148, s[16:19], s88 offen sc1
    v_pk_mul_f32 v[194:195], v[172:173], v[186:187] op_sel:[0,0] op_sel_hi:[0,1]
    v_pk_fma_f32 v[174:175], v[172:173], v[186:187], v[194:195] op_sel:[1,1,0] op_sel_hi:[1,0,1] neg_lo:[0,1,0]
    v_cvt_pk_bf16_f32 v249, v174, v175
    v_pk_mul_f32 v[194:195], v[174:175], v[186:187] op_sel:[0,0] op_sel_hi:[0,1]
    v_pk_fma_f32 v[172:173], v[174:175], v[186:187], v[194:195] op_sel:[1,1,0] op_sel_hi:[1,0,1] neg_lo:[0,1,0]
    v_cvt_pk_bf16_f32 v250, v172, v173
    v_pk_mul_f32 v[194:195], v[172:173], v[186:187] op_sel:[0,0] op_sel_hi:[0,1]
    v_pk_fma_f32 v[174:175], v[172:173], v[186:187], v[194:195] op_sel:[1,1,0] op_sel_hi:[1,0,1] neg_lo:[0,1,0]
    v_cvt_pk_bf16_f32 v251, v174, v175
    ds_write_addtid_b32 v242 offset:2720
    ds_write_addtid_b32 v243 offset:2992
    ds_write_addtid_b32 v244 offset:3264
    ds_write_addtid_b32 v245 offset:3536
    ds_write_addtid_b32 v246 offset:3808
    ds_write_addtid_b32 v247 offset:4080
    ds_write_addtid_b32 v248 offset:4352
    ds_write_addtid_b32 v249 offset:4624
    ds_write_addtid_b32 v250 offset:4896
    ds_write_addtid_b32 v251 offset:5168
    v_pk_mul_f32 v[194:195], v[174:175], v[186:187] op_sel:[0,0] op_sel_hi:[0,1]
    v_pk_fma_f32 v[172:173], v[174:175], v[186:187], v[194:195] op_sel:[1,1,0] op_sel_hi:[1,0,1] neg_lo:[0,1,0]
    v_cvt_pk_bf16_f32 v242, v172, v173
    v_pk_mul_f32 v[194:195], v[172:173], v[186:187] op_sel:[0,0] op_sel_hi:[0,1]
    v_pk_fma_f32 v[174:175], v[172:173], v[186:187], v[194:195] op_sel:[1,1,0] op_sel_hi:[1,0,1] neg_lo:[0,1,0]
    v_cvt_pk_bf16_f32 v243, v174, v175
    v_pk_mul_f32 v[194:195], v[174:175], v[186:187] op_sel:[0,0] op_sel_hi:[0,1]
    s_add_u32 s88, s88, 4096
    buffer_store_dwordx4 v[144:147], v148, s[16:19], s88 offen sc1
    v_pk_fma_f32 v[172:173], v[174:175], v[186:187], v[194:195] op_sel:[1,1,0] op_sel_hi:[1,0,1] neg_lo:[0,1,0]
    v_cvt_pk_bf16_f32 v244, v172, v173
    v_pk_mul_f32 v[194:195], v[172:173], v[186:187] op_sel:[0,0] op_sel_hi:[0,1]
    v_pk_fma_f32 v[174:175], v[172:173], v[186:187], v[194:195] op_sel:[1,1,0] op_sel_hi:[1,0,1] neg_lo:[0,1,0]
    v_cvt_pk_bf16_f32 v245, v174, v175
    v_pk_mul_f32 v[194:195], v[174:175], v[186:187] op_sel:[0,0] op_sel_hi:[0,1]
    v_pk_fma_f32 v[172:173], v[174:175], v[186:187], v[194:195] op_sel:[1,1,0] op_sel_hi:[1,0,1] neg_lo:[0,1,0]
    v_cvt_pk_bf16_f32 v246, v172, v173
    v_pk_mul_f32 v[194:195], v[172:173], v[186:187] op_sel:[0,0] op_sel_hi:[0,1]
    v_pk_fma_f32 v[174:175], v[172:173], v[186:187], v[194:195] op_sel:[1,1,0] op_sel_hi:[1,0,1] neg_lo:[0,1,0]
    v_cvt_pk_bf16_f32 v247, v174, v175
    v_pk_mul_f32 v[194:195], v[174:175], v[186:187] op_sel:[0,0] op_sel_hi:[0,1]
    v_pk_fma_f32 v[172:173], v[174:175], v[186:187], v[194:195] op_sel:[1,1,0] op_sel_hi:[1,0,1] neg_lo:[0,1,0]
    v_cvt_pk_bf16_f32 v248, v172, v173
    v_pk_mul_f32 v[194:195], v[172:173], v[186:187] op_sel:[0,0] op_sel_hi:[0,1]
    v_pk_fma_f32 v[174:175], v[172:173], v[186:187], v[194:195] op_sel:[1,1,0] op_sel_hi:[1,0,1] neg_lo:[0,1,0]
    v_cvt_pk_bf16_f32 v249, v174, v175
    v_pk_mul_f32 v[194:195], v[174:175], v[186:187] op_sel:[0,0] op_sel_hi:[0,1]
    v_pk_fma_f32 v[172:173], v[174:175], v[186:187], v[194:195] op_sel:[1,1,0] op_sel_hi:[1,0,1] neg_lo:[0,1,0]
    v_cvt_pk_bf16_f32 v250, v172, v173
    v_pk_mul_f32 v[194:195], v[172:173], v[186:187] op_sel:[0,0] op_sel_hi:[0,1]
    v_pk_fma_f32 v[174:175], v[172:173], v[186:187], v[194:195] op_sel:[1,1,0] op_sel_hi:[1,0,1] neg_lo:[0,1,0]
    v_cvt_pk_bf16_f32 v251, v174, v175
    ds_write_addtid_b32 v242 offset:5440
    ds_write_addtid_b32 v243 offset:5712
    ds_write_addtid_b32 v244 offset:5984
    ds_write_addtid_b32 v245 offset:6256
    ds_write_addtid_b32 v246 offset:6528
    ds_write_addtid_b32 v247 offset:6800
    ds_write_addtid_b32 v248 offset:7072
    v_mov_b32 v134, 0x3f803f80
    v_mov_b32 v132, 0
    v_mov_b32 v133, 0
    s_waitcnt vmcnt(10)
    v_dot2c_f32_bf16 v132, v120, v134
    v_dot2c_f32_bf16 v133, v120, v120
    v_dot2c_f32_bf16 v132, v121, v134
    v_dot2c_f32_bf16 v133, v121, v121
    v_dot2c_f32_bf16 v132, v122, v134
    v_dot2c_f32_bf16 v133, v122, v122
    v_dot2c_f32_bf16 v132, v123, v134
    v_dot2c_f32_bf16 v133, v123, v123
    s_waitcnt vmcnt(9)
    v_dot2c_f32_bf16 v132, v124, v134
    v_dot2c_f32_bf16 v133, v124, v124
    v_dot2c_f32_bf16 v132, v125, v134
    v_dot2c_f32_bf16 v133, v125, v125
    v_dot2c_f32_bf16 v132, v126, v134
    v_dot2c_f32_bf16 v133, v126, v126
    v_dot2c_f32_bf16 v132, v127, v134
    v_dot2c_f32_bf16 v133, v127, v127
    s_waitcnt vmcnt(8)
    v_dot2c_f32_bf16 v132, v128, v134
    v_dot2c_f32_bf16 v133, v128, v128
    v_dot2c_f32_bf16 v132, v129, v134
    v_dot2c_f32_bf16 v133, v129, v129
    v_dot2c_f32_bf16 v132, v130, v134
    v_dot2c_f32_bf16 v133, v130, v130
    v_dot2c_f32_bf16 v132, v131, v134
    v_dot2c_f32_bf16 v133, v131, v131
    v_lshrrev_b32 v135, 5, v0
    v_and_b32 v121, 3, v135
    v_lshrrev_b32 v135, 2, v135
    v_add_f32_dpp v132, v132, v132 row_shr:1 row_mask:0xf bank_mask:0xf bound_ctrl:0
    v_add_f32_dpp v133, v133, v133 row_shr:1 row_mask:0xf bank_mask:0xf bound_ctrl:0
    v_lshlrev_b32_e64 v135, 3, v135
    v_add_f32_dpp v132, v132, v132 row_shr:2 row_mask:0xf bank_mask:0xf bound_ctrl:0
    v_add_f32_dpp v133, v133, v133 row_shr:2 row_mask:0xf bank_mask:0xf bound_ctrl:0
    v_lshl_add_u32 v135, v121, 12, v135
    v_add_f32_dpp v132, v132, v132 row_shr:4 row_mask:0xf bank_mask:0xf bound_ctrl:0
    v_add_f32_dpp v133, v133, v133 row_shr:4 row_mask:0xf bank_mask:0xf bound_ctrl:0
    v_and_b32_e64 v121, 31, v0
    v_add_f32_dpp v132, v132, v132 row_shr:8 row_mask:0xf bank_mask:0xf bound_ctrl:0
    v_add_f32_dpp v133, v133, v133 row_shr:8 row_mask:0xf bank_mask:0xf bound_ctrl:0
    v_cmp_eq_u32_e64 vcc, 31, v121
    v_add_f32_dpp v132, v132, v132 row_bcast:15 row_mask:0xa bank_mask:0xf
    v_add_f32_dpp v133, v133, v133 row_bcast:15 row_mask:0xa bank_mask:0xf
    v_mov_b32 v121, 1073741824
    v_cndmask_b32_e64 v120, v121, v135, vcc
    s_lshl_b32 s96, s2, 4
    s_add_u32 s96, s96, 3440640
    v_mul_f32 v135, 0x3acccccd, v132
    v_mul_f32 v133, 0x3acccccd, v133
    v_fma_f32 v133, -v135, v135, v133
    v_max_f32 v133, 0, v133
    v_add_f32 v133, 0x3727c5ac, v133
    v_rsq_f32_e64 v132, v133
    s_nop 0
    v_mul_f32 v133, -v135, v132
    buffer_store_dwordx2 v[132:133], v120, s[16:19], s96 offen sc1
    ds_write_addtid_b32 v249 offset:7344
    ds_write_addtid_b32 v250 offset:7616
    ds_write_addtid_b32 v251 offset:7888
    v_pk_mul_f32 v[194:195], v[174:175], v[186:187] op_sel:[0,0] op_sel_hi:[0,1]
    v_pk_fma_f32 v[172:173], v[174:175], v[186:187], v[194:195] op_sel:[1,1,0] op_sel_hi:[1,0,1] neg_lo:[0,1,0]
    v_cvt_pk_bf16_f32 v242, v172, v173
    v_pk_mul_f32 v[194:195], v[172:173], v[186:187] op_sel:[0,0] op_sel_hi:[0,1]
    v_pk_fma_f32 v[174:175], v[172:173], v[186:187], v[194:195] op_sel:[1,1,0] op_sel_hi:[1,0,1] neg_lo:[0,1,0]
    v_cvt_pk_bf16_f32 v243, v174, v175
    ds_write_addtid_b32 v242 offset:8160
    ds_write_addtid_b32 v243 offset:8432
    ds_read_b128 a[160:163], v252 offset:0
    ds_read_b128 a[164:167], v252 offset:32
    ds_read_b128 a[168:171], v252 offset:64
    ds_read_b128 a[172:175], v252 offset:96
    ds_read_b128 a[176:179], v252 offset:128
    ds_read_b128 a[180:183], v252 offset:160
    ds_read_b128 a[184:187], v252 offset:192
    ds_read_b128 a[188:191], v252 offset:224
    v_pk_mul_f32 v[194:195], v[180:181], v[180:181] op_sel:[0,0] op_sel_hi:[0,1]
    v_pk_fma_f32 v[182:183], v[180:181], v[180:181], v[194:195] op_sel:[1,1,0] op_sel_hi:[1,0,1] neg_lo:[0,1,0]
    v_pk_mul_f32 v[194:195], v[182:183], v[182:183] op_sel:[0,0] op_sel_hi:[0,1]
    v_pk_fma_f32 v[184:185], v[182:183], v[182:183], v[194:195] op_sel:[1,1,0] op_sel_hi:[1,0,1] neg_lo:[0,1,0]
    v_cvt_pk_bf16_f32 v242, v192, -v193
    v_pk_mul_f32 v[194:195], v[192:193], v[180:181] op_sel:[0,0] op_sel_hi:[0,1]
    v_pk_fma_f32 v[174:175], v[192:193], v[180:181], v[194:195] op_sel:[1,1,0] op_sel_hi:[1,0,1] neg_lo:[0,1,0]
    v_cvt_pk_bf16_f32 v243, v174, -v175
    v_pk_mul_f32 v[194:195], v[174:175], v[180:181] op_sel:[0,0] op_sel_hi:[0,1]
    v_pk_fma_f32 v[172:173], v[174:175], v[180:181], v[194:195] op_sel:[1,1,0] op_sel_hi:[1,0,1] neg_lo:[0,1,0]
    v_cvt_pk_bf16_f32 v244, v172, -v173
    v_pk_mul_f32 v[194:195], v[172:173], v[180:181] op_sel:[0,0] op_sel_hi:[0,1]
    v_pk_fma_f32 v[174:175], v[172:173], v[180:181], v[194:195] op_sel:[1,1,0] op_sel_hi:[1,0,1] neg_lo:[0,1,0]
    v_cvt_pk_bf16_f32 v245, v174, -v175
    v_pk_mul_f32 v[194:195], v[174:175], v[180:181] op_sel:[0,0] op_sel_hi:[0,1]
    v_pk_fma_f32 v[172:173], v[174:175], v[180:181], v[194:195] op_sel:[1,1,0] op_sel_hi:[1,0,1] neg_lo:[0,1,0]
    v_cvt_pk_bf16_f32 v246, v172, -v173
    v_pk_mul_f32 v[194:195], v[172:173], v[180:181] op_sel:[0,0] op_sel_hi:[0,1]
    v_pk_fma_f32 v[174:175], v[172:173], v[180:181], v[194:195] op_sel:[1,1,0] op_sel_hi:[1,0,1] neg_lo:[0,1,0]
    v_cvt_pk_bf16_f32 v247, v174, -v175
    v_pk_mul_f32 v[194:195], v[174:175], v[180:181] op_sel:[0,0] op_sel_hi:[0,1]
    v_pk_fma_f32 v[172:173], v[174:175], v[180:181], v[194:195] op_sel:[1,1,0] op_sel_hi:[1,0,1] neg_lo:[0,1,0]
    v_cvt_pk_bf16_f32 v248, v172, -v173
    v_pk_mul_f32 v[194:195], v[172:173], v[180:181] op_sel:[0,0] op_sel_hi:[0,1]
    v_pk_fma_f32 v[174:175], v[172:173], v[180:181], v[194:195] op_sel:[1,1,0] op_sel_hi:[1,0,1] neg_lo:[0,1,0]
    v_cvt_pk_bf16_f32 v249, v174, -v175
    v_pk_mul_f32 v[194:195], v[192:193], v[190:191] op_sel:[0,0] op_sel_hi:[0,1]
    v_pk_fma_f32 v[176:177], v[192:193], v[190:191], v[194:195] op_sel:[1,1,0] op_sel_hi:[1,0,1] neg_lo:[0,1,0]
    v_cvt_pk_bf16_f32 v250, v176, -v177
    v_pk_mul_f32 v[194:195], v[176:177], v[182:183] op_sel:[0,0] op_sel_hi:[0,1]
    v_pk_fma_f32 v[174:175], v[176:177], v[182:183], v[194:195] op_sel:[1,1,0] op_sel_hi:[1,0,1] neg_lo:[0,1,0]
    v_cvt_pk_bf16_f32 v251, v174, -v175
    ds_write_addtid_b32 v242 offset:0
    ds_write_addtid_b32 v243 offset:272
    ds_write_addtid_b32 v244 offset:544
    ds_write_addtid_b32 v245 offset:816
    ds_write_addtid_b32 v246 offset:1088
    ds_write_addtid_b32 v247 offset:1360
    ds_write_addtid_b32 v248 offset:1632
    ds_write_addtid_b32 v249 offset:1904
    ds_write_addtid_b32 v250 offset:2176
    buffer_load_dword v7, v4, s[16:19], s87 offen offset:0 sc1
    ds_write_addtid_b32 v251 offset:2448
    v_pk_mul_f32 v[194:195], v[174:175], v[182:183] op_sel:[0,0] op_sel_hi:[0,1]
    v_pk_fma_f32 v[172:173], v[174:175], v[182:183], v[194:195] op_sel:[1,1,0] op_sel_hi:[1,0,1] neg_lo:[0,1,0]
    v_cvt_pk_bf16_f32 v242, v172, -v173
    v_pk_mul_f32 v[194:195], v[172:173], v[182:183] op_sel:[0,0] op_sel_hi:[0,1]
    v_pk_fma_f32 v[174:175], v[172:173], v[182:183], v[194:195] op_sel:[1,1,0] op_sel_hi:[1,0,1] neg_lo:[0,1,0]
    v_cvt_pk_bf16_f32 v243, v174, -v175
    v_pk_mul_f32 v[194:195], v[174:175], v[182:183] op_sel:[0,0] op_sel_hi:[0,1]
    v_pk_fma_f32 v[172:173], v[174:175], v[182:183], v[194:195] op_sel:[1,1,0] op_sel_hi:[1,0,1] neg_lo:[0,1,0]
    v_cvt_pk_bf16_f32 v244, v172, -v173
    v_pk_mul_f32 v[194:195], v[176:177], v[190:191] op_sel:[0,0] op_sel_hi:[0,1]
    v_pk_fma_f32 v[178:179], v[176:177], v[190:191], v[194:195] op_sel:[1,1,0] op_sel_hi:[1,0,1] neg_lo:[0,1,0]
    v_cvt_pk_bf16_f32 v245, v178, -v179
    v_pk_mul_f32 v[194:195], v[178:179], v[184:185] op_sel:[0,0] op_sel_hi:[0,1]
    v_pk_fma_f32 v[174:175], v[178:179], v[184:185], v[194:195] op_sel:[1,1,0] op_sel_hi:[1,0,1] neg_lo:[0,1,0]
    v_cvt_pk_bf16_f32 v246, v174, -v175
    v_pk_mul_f32 v[194:195], v[174:175], v[184:185] op_sel:[0,0] op_sel_hi:[0,1]
    v_pk_fma_f32 v[172:173], v[174:175], v[184:185], v[194:195] op_sel:[1,1,0] op_sel_hi:[1,0,1] neg_lo:[0,1,0]
    v_cvt_pk_bf16_f32 v247, v172, -v173
    v_pk_mul_f32 v[194:195], v[178:179], v[190:191] op_sel:[0,0] op_sel_hi:[0,1]
    v_pk_fma_f32 v[176:177], v[178:179], v[190:191], v[194:195] op_sel:[1,1,0] op_sel_hi:[1,0,1] neg_lo:[0,1,0]
    v_cvt_pk_bf16_f32 v248, v176, -v177
    v_pk_mul_f32 v[194:195], v[176:177], v[184:185] op_sel:[0,0] op_sel_hi:[0,1]
    v_pk_fma_f32 v[174:175], v[176:177], v[184:185], v[194:195] op_sel:[1,1,0] op_sel_hi:[1,0,1] neg_lo:[0,1,0]
    v_cvt_pk_bf16_f32 v249, v174, -v175
    v_pk_mul_f32 v[194:195], v[174:175], v[184:185] op_sel:[0,0] op_sel_hi:[0,1]
    v_pk_fma_f32 v[172:173], v[174:175], v[184:185], v[194:195] op_sel:[1,1,0] op_sel_hi:[1,0,1] neg_lo:[0,1,0]
    v_cvt_pk_bf16_f32 v250, v172, -v173
    v_pk_mul_f32 v[194:195], v[176:177], v[190:191] op_sel:[0,0] op_sel_hi:[0,1]
    v_pk_fma_f32 v[178:179], v[176:177], v[190:191], v[194:195] op_sel:[1,1,0] op_sel_hi:[1,0,1] neg_lo:[0,1,0]
    v_cvt_pk_bf16_f32 v251, v178, -v179
    ds_write_addtid_b32 v242 offset:2720
    ds_write_addtid_b32 v242 offset:3264
    ds_write_addtid_b32 v243 offset:3536
    ds_write_addtid_b32 v244 offset:3808
    ds_write_addtid_b32 v245 offset:4352
    ds_write_addtid_b32 v246 offset:4624
    ds_write_addtid_b32 v247 offset:4896
    ds_write_addtid_b32 v248 offset:5440
    ds_write_addtid_b32 v249 offset:5712
    ds_write_addtid_b32 v250 offset:5984
    ds_write_addtid_b32 v251 offset:6528
    v_pk_mul_f32 v[194:195], v[178:179], v[186:187] op_sel:[0,0] op_sel_hi:[0,1]
    v_pk_fma_f32 v[174:175], v[178:179], v[186:187], v[194:195] op_sel:[1,1,0] op_sel_hi:[1,0,1] neg_lo:[0,1,0]
    v_cvt_pk_bf16_f32 v242, v174, -v175
    v_pk_mul_f32 v[194:195], v[178:179], v[190:191] op_sel:[0,0] op_sel_hi:[0,1]
    v_pk_fma_f32 v[176:177], v[178:179], v[190:191], v[194:195] op_sel:[1,1,0] op_sel_hi:[1,0,1] neg_lo:[0,1,0]
    v_cvt_pk_bf16_f32 v243, v176, -v177
    v_pk_mul_f32 v[194:195], v[176:177], v[186:187] op_sel:[0,0] op_sel_hi:[0,1]
    v_pk_fma_f32 v[174:175], v[176:177], v[186:187], v[194:195] op_sel:[1,1,0] op_sel_hi:[1,0,1] neg_lo:[0,1,0]
    v_cvt_pk_bf16_f32 v244, v174, -v175
    v_pk_mul_f32 v[194:195], v[176:177], v[190:191] op_sel:[0,0] op_sel_hi:[0,1]
    v_pk_fma_f32 v[178:179], v[176:177], v[190:191], v[194:195] op_sel:[1,1,0] op_sel_hi:[1,0,1] neg_lo:[0,1,0]
    v_cvt_pk_bf16_f32 v245, v178, -v179
    v_pk_mul_f32 v[194:195], v[178:179], v[186:187] op_sel:[0,0] op_sel_hi:[0,1]
    v_pk_fma_f32 v[174:175], v[178:179], v[186:187], v[194:195] op_sel:[1,1,0] op_sel_hi:[1,0,1] neg_lo:[0,1,0]
    v_cvt_pk_bf16_f32 v246, v174, -v175
    v_pk_mul_f32 v[194:195], v[178:179], v[190:191] op_sel:[0,0] op_sel_hi:[0,1]
    v_pk_fma_f32 v[176:177], v[178:179], v[190:191], v[194:195] op_sel:[1,1,0] op_sel_hi:[1,0,1] neg_lo:[0,1,0]
    v_cvt_pk_bf16_f32 v247, v176, -v177
    v_pk_mul_f32 v[194:195], v[176:177], v[186:187] op_sel:[0,0] op_sel_hi:[0,1]
    v_pk_fma_f32 v[174:175], v[176:177], v[186:187], v[194:195] op_sel:[1,1,0] op_sel_hi:[1,0,1] neg_lo:[0,1,0]
    v_cvt_pk_bf16_f32 v248, v174, -v175
    ds_write_addtid_b32 v242 offset:6800
    ds_write_addtid_b32 v243 offset:7072
    ds_write_addtid_b32 v244 offset:7344
    ds_write_addtid_b32 v245 offset:7616
    ds_write_addtid_b32 v246 offset:7888
    ds_write_addtid_b32 v247 offset:8160
    ds_write_addtid_b32 v248 offset:8432
    ds_read_b128 a[192:195], v252 offset:0
    ds_read_b128 a[196:199], v252 offset:32
    ds_read_b128 a[200:203], v252 offset:64
    ds_read_b128 a[204:207], v252 offset:96
    ds_read_b128 a[208:211], v252 offset:128
    ds_read_b128 a[212:215], v252 offset:160
    ds_read_b128 a[216:219], v252 offset:192
    ds_read_b128 a[220:223], v252 offset:224
    s_add_u32 m0, s92, 36352
    s_nop 0
    buffer_load_dwordx4 v73, s[4:7], s99 offen offset:0  lds
    v_lshlrev_b32 v199, 16, v236
    v_mul_f32 v199, 0x3fb8aa3b, v199
    v_exp_f32 v199, v199
    v_lshlrev_b32 v255, 16, v237
    v_mul_f32 v255, v255, v253
    v_mul_f32 v255, 0x3e22f983, v255
    v_cvt_pk_bf16_f32 v199, v199, v199
    v_lshlrev_b32 v199, 16, v199
    v_mul_f32 v254, v199, v253
    v_mul_f32 v254, 0xbfb8aa3b, v254
    s_waitcnt lgkmcnt(7)
    v_mfma_f32_32x32x16_bf16 v[216:231], a[192:195], a[160:163], v[216:231]
    s_add_u32 m0, s92, 36352
    s_nop 0
    buffer_load_dwordx4 v74, s[4:7], s99 offen offset:1088  lds
    v_mul_f32 v182, 0x41000000, v254
    v_mul_f32 v185, 0x41000000, v255
    v_mul_f32 v184, 0x43800000, v254
    v_mul_f32 v189, 0x43800000, v255
    s_waitcnt lgkmcnt(6)
    v_mfma_f32_32x32x16_bf16 v[216:231], a[196:199], a[164:167], v[216:231]
    s_add_u32 m0, s92, 36352
    s_nop 0
    buffer_load_dwordx4 v75, s[4:7], s99 offen offset:2176  lds
    v_fract_f32 v185, v185
    v_fract_f32 v188, v255
    v_fract_f32 v189, v189
    v_exp_f32_e64 v182, v182
    s_waitcnt lgkmcnt(5)
    v_mfma_f32_32x32x16_bf16 v[216:231], a[200:203], a[168:171], v[216:231]
    s_add_u32 m0, s92, 36352
    s_nop 0
    buffer_load_dwordx4 v76, s[4:7], s99 offen offset:3264  lds
    v_exp_f32 v183, v254
    v_exp_f32 v184, v184
    v_cos_f32 v186, v185
    v_sin_f32 v187, v185
    s_waitcnt lgkmcnt(4)
    v_mfma_f32_32x32x16_bf16 v[216:231], a[204:207], a[172:175], v[216:231]
    s_add_u32 m0, s93, 53760
    s_add_u32 s99, s99, 256
    s_mov_b64 exec, s[80:81]
    buffer_load_dwordx4 v77, s[4:7], s100 offen  lds
    s_mov_b64 exec, -1
    s_add_u32 s100, s100, 256
    v_cos_f32 v180, v188
    v_sin_f32 v181, v188
    v_cos_f32 v190, v189
    v_sin_f32_e64 v191, v189
    s_waitcnt lgkmcnt(3)
    v_mfma_f32_32x32x16_bf16 v[216:231], a[208:211], a[176:179], v[216:231]
    s_add_u32 m0, s92, 55936
    s_nop 0
    buffer_load_dwordx4 v73, s[4:7], s99 offen offset:0  lds
    v_lshlrev_b32 v192, 16, v238
    v_lshlrev_b32 v193, 16, v239
    v_add_f32 v199, v253, v253
    v_mul_f32 v192, v192, v199
    s_waitcnt lgkmcnt(2)
    v_mfma_f32_32x32x16_bf16 v[216:231], a[212:215], a[180:183], v[216:231]
    s_add_u32 m0, s92, 55936
    s_nop 0
    buffer_load_dwordx4 v74, s[4:7], s99 offen offset:1088  lds
    v_mul_f32 v193, v193, v199
    v_mul_f32 v186, v186, v182
    v_mul_f32 v187, v187, v182
    v_mul_f32 v180, v180, v183
    s_waitcnt lgkmcnt(1)
    v_mfma_f32_32x32x16_bf16 v[216:231], a[216:219], a[184:187], v[216:231]
    s_add_u32 m0, s92, 55936
    s_nop 0
    buffer_load_dwordx4 v75, s[4:7], s99 offen offset:2176  lds
    v_mul_f32 v181, v181, v183
    v_mul_f32 v190, v190, v184
    v_mul_f32_e64 v191, v191, v184
    s_waitcnt lgkmcnt(0)
    v_mfma_f32_32x32x16_bf16 v[216:231], a[220:223], a[188:191], v[216:231]
    s_add_u32 m0, s92, 55936
    s_nop 0
    buffer_load_dwordx4 v76, s[4:7], s99 offen offset:3264  lds
    s_add_u32 m0, s93, 73344
    s_add_u32 s99, s99, 256
    s_mov_b64 exec, s[80:81]
    buffer_load_dwordx4 v77, s[4:7], s100 offen  lds
    s_mov_b64 exec, -1
    s_add_u32 s100, s100, 256
    s_add_u32 m0, s92, 75520
    s_nop 0
    buffer_load_dwordx4 v73, s[4:7], s99 offen offset:0  lds
    s_add_u32 m0, s92, 75520
    s_nop 0
    buffer_load_dwordx4 v74, s[4:7], s99 offen offset:1088  lds
    s_mov_b32 m0, s37
    v_mov_b32 v242, 0x3f80
    v_cvt_pk_bf16_f32 v243, v186, v187
    v_pk_mul_f32 v[194:195], v[186:187], v[186:187] op_sel:[0,0] op_sel_hi:[0,1]
    v_pk_fma_f32 v[172:173], v[186:187], v[186:187], v[194:195] op_sel:[1,1,0] op_sel_hi:[1,0,1] neg_lo:[0,1,0]
    v_cvt_pk_bf16_f32 v244, v172, v173
    v_pk_mul_f32 v[194:195], v[172:173], v[186:187] op_sel:[0,0] op_sel_hi:[0,1]
    v_pk_fma_f32 v[174:175], v[172:173], v[186:187], v[194:195] op_sel:[1,1,0] op_sel_hi:[1,0,1] neg_lo:[0,1,0]
    v_cvt_pk_bf16_f32 v245, v174, v175
    v_pk_mul_f32 v[194:195], v[174:175], v[186:187] op_sel:[0,0] op_sel_hi:[0,1]
    v_pk_fma_f32 v[172:173], v[174:175], v[186:187], v[194:195] op_sel:[1,1,0] op_sel_hi:[1,0,1] neg_lo:[0,1,0]
    v_cvt_pk_bf16_f32 v246, v172, v173
    v_pk_mul_f32 v[194:195], v[172:173], v[186:187] op_sel:[0,0] op_sel_hi:[0,1]
    v_pk_fma_f32 v[174:175], v[172:173], v[186:187], v[194:195] op_sel:[1,1,0] op_sel_hi:[1,0,1] neg_lo:[0,1,0]
    v_cvt_pk_bf16_f32 v247, v174, v175
    v_pk_mul_f32 v[194:195], v[174:175], v[186:187] op_sel:[0,0] op_sel_hi:[0,1]
    v_pk_fma_f32 v[172:173], v[174:175], v[186:187], v[194:195] op_sel:[1,1,0] op_sel_hi:[1,0,1] neg_lo:[0,1,0]
    v_cvt_pk_bf16_f32 v248, v172, v173
    v_pk_mul_f32 v[194:195], v[172:173], v[186:187] op_sel:[0,0] op_sel_hi:[0,1]
    v_pk_fma_f32 v[174:175], v[172:173], v[186:187], v[194:195] op_sel:[1,1,0] op_sel_hi:[1,0,1] neg_lo:[0,1,0]
    v_cvt_pk_bf16_f32 v249, v174, v175
    v_pk_mul_f32 v[194:195], v[174:175], v[186:187] op_sel:[0,0] op_sel_hi:[0,1]
    v_pk_fma_f32 v[172:173], v[174:175], v[186:187], v[194:195] op_sel:[1,1,0] op_sel_hi:[1,0,1] neg_lo:[0,1,0]
    v_cvt_pk_bf16_f32 v250, v172, v173
    v_pk_mul_f32 v[194:195], v[172:173], v[186:187] op_sel:[0,0] op_sel_hi:[0,1]
    s_waitcnt vmcnt(12)
    v_cmp_gt_u32 vcc, 32, v7
    s_nop 0
    s_and_b64 vcc, vcc, s[50:51]
    s_cbranch_scc1 ps_7
pc_9:
    s_barrier
    v_pk_fma_f32 v[174:175], v[172:173], v[186:187], v[194:195] op_sel:[1,1,0] op_sel_hi:[1,0,1] neg_lo:[0,1,0]
    v_cvt_pk_bf16_f32 v251, v174, v175
    ds_write_addtid_b32 v242 offset:0
    ds_write_addtid_b32 v243 offset:272
    ds_write_addtid_b32 v244 offset:544
    ds_write_addtid_b32 v245 offset:816
    ds_write_addtid_b32 v246 offset:1088
    ds_write_addtid_b32 v247 offset:1360
    ds_write_addtid_b32 v248 offset:1632
    ds_write_addtid_b32 v249 offset:1904
    ds_write_addtid_b32 v250 offset:2176
    ds_write_addtid_b32 v251 offset:2448
    v_pk_mul_f32 v[194:195], v[174:175], v[186:187] op_sel:[0,0] op_sel_hi:[0,1]
    v_pk_fma_f32 v[172:173], v[174:175], v[186:187], v[194:195] op_sel:[1,1,0] op_sel_hi:[1,0,1] neg_lo:[0,1,0]
    v_cvt_pk_bf16_f32 v242, v172, v173
    v_pk_mul_f32 v[194:195], v[172:173], v[186:187] op_sel:[0,0] op_sel_hi:[0,1]
    v_pk_fma_f32 v[174:175], v[172:173], v[186:187], v[194:195] op_sel:[1,1,0] op_sel_hi:[1,0,1] neg_lo:[0,1,0]
    v_cvt_pk_bf16_f32 v243, v174, v175
    buffer_load_dwordx4 a[0:3], v200, s[16:19], s101 offen offset:0 sc1
    v_pk_mul_f32 v[194:195], v[174:175], v[186:187] op_sel:[0,0] op_sel_hi:[0,1]
    v_pk_fma_f32 v[172:173], v[174:175], v[186:187], v[194:195] op_sel:[1,1,0] op_sel_hi:[1,0,1] neg_lo:[0,1,0]
    v_cvt_pk_bf16_f32 v244, v172, v173
    v_pk_mul_f32 v[194:195], v[172:173], v[186:187] op_sel:[0,0] op_sel_hi:[0,1]
    v_pk_fma_f32 v[174:175], v[172:173], v[186:187], v[194:195] op_sel:[1,1,0] op_sel_hi:[1,0,1] neg_lo:[0,1,0]
    v_cvt_pk_bf16_f32 v245, v174, v175
    v_pk_mul_f32 v[194:195], v[174:175], v[186:187] op_sel:[0,0] op_sel_hi:[0,1]
    v_pk_fma_f32 v[172:173], v[174:175], v[186:187], v[194:195] op_sel:[1,1,0] op_sel_hi:[1,0,1] neg_lo:[0,1,0]
    v_cvt_pk_bf16_f32 v246, v172, v173
    v_pk_mul_f32 v[194:195], v[172:173], v[186:187] op_sel:[0,0] op_sel_hi:[0,1]
    v_pk_fma_f32 v[174:175], v[172:173], v[186:187], v[194:195] op_sel:[1,1,0] op_sel_hi:[1,0,1] neg_lo:[0,1,0]
    v_cvt_pk_bf16_f32 v247, v174, v175
    v_pk_mul_f32 v[194:195], v[174:175], v[186:187] op_sel:[0,0] op_sel_hi:[0,1]
    v_pk_fma_f32 v[172:173], v[174:175], v[186:187], v[194:195] op_sel:[1,1,0] op_sel_hi:[1,0,1] neg_lo:[0,1,0]
    v_cvt_pk_bf16_f32 v248, v172, v173
    v_pk_mul_f32 v[194:195], v[172:173], v[186:187] op_sel:[0,0] op_sel_hi:[0,1]
    v_pk_fma_f32 v[174:175], v[172:173], v[186:187], v[194:195] op_sel:[1,1,0] op_sel_hi:[1,0,1] neg_lo:[0,1,0]
    v_cvt_pk_bf16_f32 v249, v174, v175
    buffer_load_dwordx4 a[4:7], v200, s[16:19], s101 offen offset:1024 sc1
    v_pk_mul_f32 v[194:195], v[174:175], v[186:187] op_sel:[0,0] op_sel_hi:[0,1]
    v_pk_fma_f32 v[172:173], v[174:175], v[186:187], v[194:195] op_sel:[1,1,0] op_sel_hi:[1,0,1] neg_lo:[0,1,0]
    v_cvt_pk_bf16_f32 v250, v172, v173
    v_pk_mul_f32 v[194:195], v[172:173], v[186:187] op_sel:[0,0] op_sel_hi:[0,1]
    v_pk_fma_f32 v[174:175], v[172:173], v[186:187], v[194:195] op_sel:[1,1,0] op_sel_hi:[1,0,1] neg_lo:[0,1,0]
    v_cvt_pk_bf16_f32 v251, v174, v175
    ds_write_addtid_b32 v242 offset:2720
    ds_write_addtid_b32 v243 offset:2992
    ds_write_addtid_b32 v244 offset:3264
    ds_write_addtid_b32 v245 offset:3536
    ds_write_addtid_b32 v246 offset:3808
    ds_write_addtid_b32 v247 offset:4080
    ds_write_addtid_b32 v248 offset:4352
    ds_write_addtid_b32 v249 offset:4624
    ds_write_addtid_b32 v250 offset:4896
    ds_write_addtid_b32 v251 offset:5168
    v_pk_mul_f32 v[194:195], v[174:175], v[186:187] op_sel:[0,0] op_sel_hi:[0,1]
    v_pk_fma_f32 v[172:173], v[174:175], v[186:187], v[194:195] op_sel:[1,1,0] op_sel_hi:[1,0,1] neg_lo:[0,1,0]
    buffer_load_dwordx4 a[8:11], v200, s[16:19], s101 offen offset:2048 sc1
    v_cvt_pk_bf16_f32 v242, v172, v173
    v_pk_mul_f32 v[194:195], v[172:173], v[186:187] op_sel:[0,0] op_sel_hi:[0,1]
    v_pk_fma_f32 v[174:175], v[172:173], v[186:187], v[194:195] op_sel:[1,1,0] op_sel_hi:[1,0,1] neg_lo:[0,1,0]
    v_cvt_pk_bf16_f32 v243, v174, v175
    v_pk_mul_f32 v[194:195], v[174:175], v[186:187] op_sel:[0,0] op_sel_hi:[0,1]
    v_pk_fma_f32 v[172:173], v[174:175], v[186:187], v[194:195] op_sel:[1,1,0] op_sel_hi:[1,0,1] neg_lo:[0,1,0]
    v_cvt_pk_bf16_f32 v244, v172, v173
    v_pk_mul_f32 v[194:195], v[172:173], v[186:187] op_sel:[0,0] op_sel_hi:[0,1]
    v_pk_fma_f32 v[174:175], v[172:173], v[186:187], v[194:195] op_sel:[1,1,0] op_sel_hi:[1,0,1] neg_lo:[0,1,0]
    v_cvt_pk_bf16_f32 v245, v174, v175
    v_pk_mul_f32 v[194:195], v[174:175], v[186:187] op_sel:[0,0] op_sel_hi:[0,1]
    v_pk_fma_f32 v[172:173], v[174:175], v[186:187], v[194:195] op_sel:[1,1,0] op_sel_hi:[1,0,1] neg_lo:[0,1,0]
    v_cvt_pk_bf16_f32 v246, v172, v173
    v_pk_mul_f32 v[194:195], v[172:173], v[186:187] op_sel:[0,0] op_sel_hi:[0,1]
    v_pk_fma_f32 v[174:175], v[172:173], v[186:187], v[194:195] op_sel:[1,1,0] op_sel_hi:[1,0,1] neg_lo:[0,1,0]
    v_cvt_pk_bf16_f32 v247, v174, v175
    v_pk_mul_f32 v[194:195], v[174:175], v[186:187] op_sel:[0,0] op_sel_hi:[0,1]
    v_pk_fma_f32 v[172:173], v[174:175], v[186:187], v[194:195] op_sel:[1,1,0] op_sel_hi:[1,0,1] neg_lo:[0,1,0]
    buffer_load_dwordx4 a[12:15], v200, s[16:19], s101 offen offset:3072 sc1
    v_cvt_pk_bf16_f32 v248, v172, v173
    v_pk_mul_f32 v[194:195], v[172:173], v[186:187] op_sel:[0,0] op_sel_hi:[0,1]
    v_pk_fma_f32 v[174:175], v[172:173], v[186:187], v[194:195] op_sel:[1,1,0] op_sel_hi:[1,0,1] neg_lo:[0,1,0]
    v_cvt_pk_bf16_f32 v249, v174, v175
    v_pk_mul_f32 v[194:195], v[174:175], v[186:187] op_sel:[0,0] op_sel_hi:[0,1]
    v_pk_fma_f32 v[172:173], v[174:175], v[186:187], v[194:195] op_sel:[1,1,0] op_sel_hi:[1,0,1] neg_lo:[0,1,0]
    v_cvt_pk_bf16_f32 v250, v172, v173
    v_pk_mul_f32 v[194:195], v[172:173], v[186:187] op_sel:[0,0] op_sel_hi:[0,1]
    v_pk_fma_f32 v[174:175], v[172:173], v[186:187], v[194:195] op_sel:[1,1,0] op_sel_hi:[1,0,1] neg_lo:[0,1,0]
    v_cvt_pk_bf16_f32 v251, v174, v175
    ds_write_addtid_b32 v242 offset:5440
    ds_write_addtid_b32 v243 offset:5712
    ds_write_addtid_b32 v244 offset:5984
    ds_write_addtid_b32 v245 offset:6256
    ds_write_addtid_b32 v246 offset:6528
    ds_write_addtid_b32 v247 offset:6800
    ds_write_addtid_b32 v248 offset:7072
    ds_write_addtid_b32 v249 offset:7344
    s_add_u32 s101, s101, 4096
    buffer_load_dwordx4 a[16:19], v200, s[16:19], s101 offen offset:0 sc1
    ds_write_addtid_b32 v250 offset:7616
    ds_write_addtid_b32 v251 offset:7888
    v_pk_mul_f32 v[194:195], v[174:175], v[186:187] op_sel:[0,0] op_sel_hi:[0,1]
    v_pk_fma_f32 v[172:173], v[174:175], v[186:187], v[194:195] op_sel:[1,1,0] op_sel_hi:[1,0,1] neg_lo:[0,1,0]
    v_cvt_pk_bf16_f32 v242, v172, v173
    v_pk_mul_f32 v[194:195], v[172:173], v[186:187] op_sel:[0,0] op_sel_hi:[0,1]
    v_pk_fma_f32 v[174:175], v[172:173], v[186:187], v[194:195] op_sel:[1,1,0] op_sel_hi:[1,0,1] neg_lo:[0,1,0]
    v_cvt_pk_bf16_f32 v243, v174, v175
    ds_write_addtid_b32 v242 offset:8160
    ds_write_addtid_b32 v243 offset:8432
    ds_read_b128 a[160:163], v252 offset:0
    ds_read_b128 a[164:167], v252 offset:32
    ds_read_b128 a[168:171], v252 offset:64
    ds_read_b128 a[172:175], v252 offset:96
    ds_read_b128 a[176:179], v252 offset:128
    ds_read_b128 a[180:183], v252 offset:160
    ds_read_b128 a[184:187], v252 offset:192
    ds_read_b128 a[188:191], v252 offset:224
    buffer_load_dwordx4 a[20:23], v200, s[16:19], s101 offen offset:1024 sc1
    v_pk_mul_f32 v[194:195], v[180:181], v[180:181] op_sel:[0,0] op_sel_hi:[0,1]
    v_pk_fma_f32 v[182:183], v[180:181], v[180:181], v[194:195] op_sel:[1,1,0] op_sel_hi:[1,0,1] neg_lo:[0,1,0]
    v_pk_mul_f32 v[194:195], v[182:183], v[182:183] op_sel:[0,0] op_sel_hi:[0,1]
    v_pk_fma_f32 v[184:185], v[182:183], v[182:183], v[194:195] op_sel:[1,1,0] op_sel_hi:[1,0,1] neg_lo:[0,1,0]
    v_cvt_pk_bf16_f32 v242, v192, -v193
    v_pk_mul_f32 v[194:195], v[192:193], v[180:181] op_sel:[0,0] op_sel_hi:[0,1]
    v_pk_fma_f32 v[174:175], v[192:193], v[180:181], v[194:195] op_sel:[1,1,0] op_sel_hi:[1,0,1] neg_lo:[0,1,0]
    v_cvt_pk_bf16_f32 v243, v174, -v175
    v_pk_mul_f32 v[194:195], v[174:175], v[180:181] op_sel:[0,0] op_sel_hi:[0,1]
    v_pk_fma_f32 v[172:173], v[174:175], v[180:181], v[194:195] op_sel:[1,1,0] op_sel_hi:[1,0,1] neg_lo:[0,1,0]
    v_cvt_pk_bf16_f32 v244, v172, -v173
    v_pk_mul_f32 v[194:195], v[172:173], v[180:181] op_sel:[0,0] op_sel_hi:[0,1]
    v_pk_fma_f32 v[174:175], v[172:173], v[180:181], v[194:195] op_sel:[1,1,0] op_sel_hi:[1,0,1] neg_lo:[0,1,0]
    v_cvt_pk_bf16_f32 v245, v174, -v175
    v_pk_mul_f32 v[194:195], v[174:175], v[180:181] op_sel:[0,0] op_sel_hi:[0,1]
    v_pk_fma_f32 v[172:173], v[174:175], v[180:181], v[194:195] op_sel:[1,1,0] op_sel_hi:[1,0,1] neg_lo:[0,1,0]
    v_cvt_pk_bf16_f32 v246, v172, -v173
    v_pk_mul_f32 v[194:195], v[172:173], v[180:181] op_sel:[0,0] op_sel_hi:[0,1]
    buffer_load_dwordx4 a[24:27], v200, s[16:19], s101 offen offset:2048 sc1
    v_pk_fma_f32 v[174:175], v[172:173], v[180:181], v[194:195] op_sel:[1,1,0] op_sel_hi:[1,0,1] neg_lo:[0,1,0]
    v_cvt_pk_bf16_f32 v247, v174, -v175
    v_pk_mul_f32 v[194:195], v[174:175], v[180:181] op_sel:[0,0] op_sel_hi:[0,1]
    v_pk_fma_f32 v[172:173], v[174:175], v[180:181], v[194:195] op_sel:[1,1,0] op_sel_hi:[1,0,1] neg_lo:[0,1,0]
    v_cvt_pk_bf16_f32 v248, v172, -v173
    v_pk_mul_f32 v[194:195], v[172:173], v[180:181] op_sel:[0,0] op_sel_hi:[0,1]
    v_pk_fma_f32 v[174:175], v[172:173], v[180:181], v[194:195] op_sel:[1,1,0] op_sel_hi:[1,0,1] neg_lo:[0,1,0]
    v_cvt_pk_bf16_f32 v249, v174, -v175
    v_pk_mul_f32 v[194:195], v[192:193], v[190:191] op_sel:[0,0] op_sel_hi:[0,1]
    v_pk_fma_f32 v[176:177], v[192:193], v[190:191], v[194:195] op_sel:[1,1,0] op_sel_hi:[1,0,1] neg_lo:[0,1,0]
    v_cvt_pk_bf16_f32 v250, v176, -v177
    v_pk_mul_f32 v[194:195], v[176:177], v[182:183] op_sel:[0,0] op_sel_hi:[0,1]
    v_pk_fma_f32 v[174:175], v[176:177], v[182:183], v[194:195] op_sel:[1,1,0] op_sel_hi:[1,0,1] neg_lo:[0,1,0]
    v_cvt_pk_bf16_f32 v251, v174, -v175
    ds_write_addtid_b32 v242 offset:0
    ds_write_addtid_b32 v243 offset:272
    ds_write_addtid_b32 v244 offset:544
    ds_write_addtid_b32 v245 offset:816
    buffer_load_dwordx4 a[28:31], v200, s[16:19], s101 offen offset:3072 sc1
    ds_write_addtid_b32 v246 offset:1088
    ds_write_addtid_b32 v247 offset:1360
    ds_write_addtid_b32 v248 offset:1632
    ds_write_addtid_b32 v249 offset:1904
    ds_write_addtid_b32 v250 offset:2176
    ds_write_addtid_b32 v251 offset:2448
    v_pk_mul_f32 v[194:195], v[174:175], v[182:183] op_sel:[0,0] op_sel_hi:[0,1]
    v_pk_fma_f32 v[172:173], v[174:175], v[182:183], v[194:195] op_sel:[1,1,0] op_sel_hi:[1,0,1] neg_lo:[0,1,0]
    v_cvt_pk_bf16_f32 v242, v172, -v173
    v_pk_mul_f32 v[194:195], v[172:173], v[182:183] op_sel:[0,0] op_sel_hi:[0,1]
    v_pk_fma_f32 v[174:175], v[172:173], v[182:183], v[194:195] op_sel:[1,1,0] op_sel_hi:[1,0,1] neg_lo:[0,1,0]
    v_cvt_pk_bf16_f32 v243, v174, -v175
    v_pk_mul_f32 v[194:195], v[174:175], v[182:183] op_sel:[0,0] op_sel_hi:[0,1]
    v_pk_fma_f32 v[172:173], v[174:175], v[182:183], v[194:195] op_sel:[1,1,0] op_sel_hi:[1,0,1] neg_lo:[0,1,0]
    v_cvt_pk_bf16_f32 v244, v172, -v173
    v_pk_mul_f32 v[194:195], v[176:177], v[190:191] op_sel:[0,0] op_sel_hi:[0,1]
    v_pk_fma_f32 v[178:179], v[176:177], v[190:191], v[194:195] op_sel:[1,1,0] op_sel_hi:[1,0,1] neg_lo:[0,1,0]
    v_cvt_pk_bf16_f32 v245, v178, -v179
    s_add_u32 s101, s101, 4096
    buffer_load_dwordx4 a[32:35], v200, s[16:19], s101 offen offset:0 sc1
    v_pk_mul_f32 v[194:195], v[178:179], v[184:185] op_sel:[0,0] op_sel_hi:[0,1]
    v_pk_fma_f32 v[174:175], v[178:179], v[184:185], v[194:195] op_sel:[1,1,0] op_sel_hi:[1,0,1] neg_lo:[0,1,0]
    v_cvt_pk_bf16_f32 v246, v174, -v175
    v_pk_mul_f32 v[194:195], v[174:175], v[184:185] op_sel:[0,0] op_sel_hi:[0,1]
    v_pk_fma_f32 v[172:173], v[174:175], v[184:185], v[194:195] op_sel:[1,1,0] op_sel_hi:[1,0,1] neg_lo:[0,1,0]
    v_cvt_pk_bf16_f32 v247, v172, -v173
    v_pk_mul_f32 v[194:195], v[178:179], v[190:191] op_sel:[0,0] op_sel_hi:[0,1]
    v_pk_fma_f32 v[176:177], v[178:179], v[190:191], v[194:195] op_sel:[1,1,0] op_sel_hi:[1,0,1] neg_lo:[0,1,0]
    v_cvt_pk_bf16_f32 v248, v176, -v177
    v_pk_mul_f32 v[194:195], v[176:177], v[184:185] op_sel:[0,0] op_sel_hi:[0,1]
    v_pk_fma_f32 v[174:175], v[176:177], v[184:185], v[194:195] op_sel:[1,1,0] op_sel_hi:[1,0,1] neg_lo:[0,1,0]
    v_cvt_pk_bf16_f32 v249, v174, -v175
    v_pk_mul_f32 v[194:195], v[174:175], v[184:185] op_sel:[0,0] op_sel_hi:[0,1]
    v_pk_fma_f32 v[172:173], v[174:175], v[184:185], v[194:195] op_sel:[1,1,0] op_sel_hi:[1,0,1] neg_lo:[0,1,0]
    v_cvt_pk_bf16_f32 v250, v172, -v173
    v_pk_mul_f32 v[194:195], v[176:177], v[190:191] op_sel:[0,0] op_sel_hi:[0,1]
    v_pk_fma_f32 v[178:179], v[176:177], v[190:191], v[194:195] op_sel:[1,1,0] op_sel_hi:[1,0,1] neg_lo:[0,1,0]
    v_cvt_pk_bf16_f32 v251, v178, -v179
    buffer_load_dwordx4 a[36:39], v200, s[16:19], s101 offen offset:1024 sc1
    ds_write_addtid_b32 v242 offset:2720
    ds_write_addtid_b32 v242 offset:3264
    ds_write_addtid_b32 v243 offset:3536
    ds_write_addtid_b32 v244 offset:3808
    ds_write_addtid_b32 v245 offset:4352
    ds_write_addtid_b32 v246 offset:4624
    ds_write_addtid_b32 v247 offset:4896
    ds_write_addtid_b32 v248 offset:5440
    ds_write_addtid_b32 v249 offset:5712
    ds_write_addtid_b32 v250 offset:5984
    ds_write_addtid_b32 v251 offset:6528
    v_pk_mul_f32 v[194:195], v[178:179], v[186:187] op_sel:[0,0] op_sel_hi:[0,1]
    v_pk_fma_f32 v[174:175], v[178:179], v[186:187], v[194:195] op_sel:[1,1,0] op_sel_hi:[1,0,1] neg_lo:[0,1,0]
    v_cvt_pk_bf16_f32 v242, v174, -v175
    v_pk_mul_f32 v[194:195], v[178:179], v[190:191] op_sel:[0,0] op_sel_hi:[0,1]
    v_pk_fma_f32 v[176:177], v[178:179], v[190:191], v[194:195] op_sel:[1,1,0] op_sel_hi:[1,0,1] neg_lo:[0,1,0]
    v_cvt_pk_bf16_f32 v243, v176, -v177
    v_pk_mul_f32 v[194:195], v[176:177], v[186:187] op_sel:[0,0] op_sel_hi:[0,1]
    buffer_load_dwordx4 a[40:43], v200, s[16:19], s101 offen offset:2048 sc1
    v_pk_fma_f32 v[174:175], v[176:177], v[186:187], v[194:195] op_sel:[1,1,0] op_sel_hi:[1,0,1] neg_lo:[0,1,0]
    v_cvt_pk_bf16_f32 v244, v174, -v175
    v_pk_mul_f32 v[194:195], v[176:177], v[190:191] op_sel:[0,0] op_sel_hi:[0,1]
    v_pk_fma_f32 v[178:179], v[176:177], v[190:191], v[194:195] op_sel:[1,1,0] op_sel_hi:[1,0,1] neg_lo:[0,1,0]
    v_cvt_pk_bf16_f32 v245, v178, -v179
    v_pk_mul_f32 v[194:195], v[178:179], v[186:187] op_sel:[0,0] op_sel_hi:[0,1]
    v_pk_fma_f32 v[174:175], v[178:179], v[186:187], v[194:195] op_sel:[1,1,0] op_sel_hi:[1,0,1] neg_lo:[0,1,0]
    v_cvt_pk_bf16_f32 v246, v174, -v175
    v_pk_mul_f32 v[194:195], v[178:179], v[190:191] op_sel:[0,0] op_sel_hi:[0,1]
    v_pk_fma_f32 v[176:177], v[178:179], v[190:191], v[194:195] op_sel:[1,1,0] op_sel_hi:[1,0,1] neg_lo:[0,1,0]
    v_cvt_pk_bf16_f32 v247, v176, -v177
    v_pk_mul_f32 v[194:195], v[176:177], v[186:187] op_sel:[0,0] op_sel_hi:[0,1]
    v_pk_fma_f32 v[174:175], v[176:177], v[186:187], v[194:195] op_sel:[1,1,0] op_sel_hi:[1,0,1] neg_lo:[0,1,0]
    v_cvt_pk_bf16_f32 v248, v174, -v175
    ds_write_addtid_b32 v242 offset:6800
    ds_write_addtid_b32 v243 offset:7072
    ds_write_addtid_b32 v244 offset:7344
    ds_write_addtid_b32 v245 offset:7616
    buffer_load_dwordx4 a[44:47], v200, s[16:19], s101 offen offset:3072 sc1
    ds_write_addtid_b32 v246 offset:7888
    ds_write_addtid_b32 v247 offset:8160
    ds_write_addtid_b32 v248 offset:8432
    ds_read_b128 a[192:195], v252 offset:0
    ds_read_b128 a[196:199], v252 offset:32
    ds_read_b128 a[200:203], v252 offset:64
    ds_read_b128 a[204:207], v252 offset:96
    ds_read_b128 a[208:211], v252 offset:128
    ds_read_b128 a[212:215], v252 offset:160
    ds_read_b128 a[216:219], v252 offset:192
    ds_read_b128 a[220:223], v252 offset:224
    s_add_u32 m0, s92, 75520
    s_nop 0
    buffer_load_dwordx4 v75, s[4:7], s99 offen offset:2176  lds
    s_waitcnt lgkmcnt(7)
    v_mfma_f32_32x32x16_bf16 v[216:231], a[192:195], a[160:163], v[216:231]
    s_add_u32 m0, s92, 75520
    s_nop 0
    buffer_load_dwordx4 v76, s[4:7], s99 offen offset:3264  lds
    s_waitcnt lgkmcnt(6)
    v_mfma_f32_32x32x16_bf16 v[216:231], a[196:199], a[164:167], v[216:231]
    s_add_u32 m0, s93, 92928
    s_add_u32 s101, s101, 4096
    buffer_load_dwordx4 a[48:51], v200, s[16:19], s101 offen offset:0 sc1
    s_add_u32 s99, s99, 256
    s_mov_b64 exec, s[80:81]
    buffer_load_dwordx4 v77, s[4:7], s100 offen  lds
    s_mov_b64 exec, -1
    s_add_u32 s100, s100, 256
    s_waitcnt lgkmcnt(5)
    v_mfma_f32_32x32x16_bf16 v[216:231], a[200:203], a[168:171], v[216:231]
    s_add_u32 m0, s92, 95104
    s_nop 0
    buffer_load_dwordx4 v73, s[4:7], s99 offen offset:0  lds
    s_waitcnt lgkmcnt(4)
    v_mfma_f32_32x32x16_bf16 v[216:231], a[204:207], a[172:175], v[216:231]
    s_add_u32 m0, s92, 95104
    s_nop 0
    buffer_load_dwordx4 v74, s[4:7], s99 offen offset:1088  lds
    s_waitcnt lgkmcnt(3)
    v_mfma_f32_32x32x16_bf16 v[216:231], a[208:211], a[176:179], v[216:231]
    s_add_u32 m0, s92, 95104
    s_nop 0
    buffer_load_dwordx4 v75, s[4:7], s99 offen offset:2176  lds
    s_waitcnt lgkmcnt(2)
    v_mfma_f32_32x32x16_bf16 v[216:231], a[212:215], a[180:183], v[216:231]
    s_add_u32 m0, s92, 95104
    s_nop 0
    buffer_load_dwordx4 v76, s[4:7], s99 offen offset:3264  lds
    s_waitcnt lgkmcnt(1)
    v_mfma_f32_32x32x16_bf16 v[216:231], a[216:219], a[184:187], v[216:231]
    buffer_load_dwordx4 a[52:55], v200, s[16:19], s101 offen offset:1024 sc1
    s_add_u32 m0, s93, 112512
    s_add_u32 s99, s99, 256
    s_mov_b64 exec, s[80:81]
    buffer_load_dwordx4 v77, s[4:7], s100 offen  lds
    s_mov_b64 exec, -1
    s_add_u32 s100, s100, 256
    s_waitcnt lgkmcnt(0)
    v_mfma_f32_32x32x16_bf16 v[216:231], a[220:223], a[188:191], v[216:231]
    s_add_u32 m0, s92, 114688
    s_nop 0
    buffer_load_dwordx4 v73, s[4:7], s99 offen offset:0  lds
    s_add_u32 m0, s92, 114688
    s_nop 0
    buffer_load_dwordx4 v74, s[4:7], s99 offen offset:1088  lds
    s_add_u32 m0, s92, 114688
    s_nop 0
    buffer_load_dwordx4 v75, s[4:7], s99 offen offset:2176  lds
    s_add_u32 m0, s92, 114688
    s_nop 0
    buffer_load_dwordx4 v76, s[4:7], s99 offen offset:3264  lds
    s_add_u32 m0, s93, 132096
    s_add_u32 s99, s99, 256
    s_mov_b64 exec, s[80:81]
    buffer_load_dwordx4 v77, s[4:7], s100 offen  lds
    s_mov_b64 exec, -1
    s_add_u32 s100, s100, 256
    s_mov_b32 m0, s37
    s_branch ec_3
nc_2:
    s_cmp_lg_u32 s2, 255
    s_cbranch_scc1 fr_10
    v_mov_b32 v2, 1
    s_waitcnt vmcnt(9)
    s_barrier
    s_mov_b64 exec, 1
    global_store_dword v5, v2, s[66:67] sc1
    s_mov_b64 exec, -1
fr_10:
    s_sub_u32 s33, s2, 160
    s_min_u32 s33, s33, 159
    s_mul_i32 s29, s33, 3277
    s_lshr_b32 s29, s29, 16
    s_mul_i32 s30, s29, 20
    s_sub_u32 s30, s33, s30
    s_mul_i32 s31, s30, 13108
    s_lshr_b32 s31, s31, 16
    s_mul_i32 s32, s31, 5
    s_sub_u32 s32, s30, s32
    s_lshl_b32 s28, s24, 10
    s_lshr_b32 s34, s32, 1
    s_mul_i32 s34, s34, 20
    s_and_b32 s35, s32, 1
    s_lshl_b32 s35, s35, 3
    s_add_u32 s34, s34, s35
    s_cmp_eq_u32 s32, 4
    s_cselect_b32 s34, 16, s34
    s_cselect_b32 s35, 20, 4
    s_mul_i32 s36, s31, 160
    s_add_u32 s34, s34, s36
    s_mul_i32 s34, s34, 1280
    s_mul_i32 s36, s29, 160
    s_add_u32 s34, s34, s36
    v_add_u32 v162, 0, v0
    v_mul_u32_u24 v160, 6554, v162
    v_lshrrev_b32 v160, 16, v160
    v_mul_u32_u24 v161, 10, v160
    v_sub_u32 v161, v162, v161
    v_lshrrev_b32 v163, 3, v160
    v_mul_u32_u24 v163, 40, v163
    v_bfe_u32 v164, v160, 2, 1
    v_mul_u32_u24 v164, s35, v164
    v_and_b32_e64 v160, 3, v160
    v_add3_u32 v160, v160, v163, v164
    v_mul_u32_u24 v160, 1280, v160
    v_lshl_add_u32 v162, v161, 4, v160
    s_add_u32 m0, s28, 0
    s_nop 0
    buffer_load_dwordx4 v162, s[12:15], s34 offen lds
    v_add_u32 v162, 256, v0
    v_min_u32 v162, 319, v162
    v_mul_u32_u24 v160, 6554, v162
    v_lshrrev_b32 v160, 16, v160
    v_mul_u32_u24 v161, 10, v160
    v_sub_u32 v161, v162, v161
    v_lshrrev_b32 v163, 3, v160
    v_mul_u32_u24 v163, 40, v163
    v_bfe_u32 v164, v160, 2, 1
    v_mul_u32_u24 v164, s35, v164
    v_and_b32_e64 v160, 3, v160
    v_add3_u32 v160, v160, v163, v164
    v_mul_u32_u24 v160, 1280, v160
    v_lshl_add_u32 v162, v161, 4, v160
    s_add_u32 m0, s28, 4096
    s_nop 0
    buffer_load_dwordx4 v162, s[12:15], s34 offen lds
    v_bfe_u32 v163, v0, 4, 2
    v_bfe_u32 v164, v0, 2, 2
    v_lshl_add_u32 v163, v163, 3, v164
    v_mul_u32_u24 v163, 160, v163
    v_and_b32 v164, 3, v0
    v_lshl_add_u32 v165, v164, 3, v163
    v_add_u32 v165, 0, v165
    s_lshl_b32 s36, s24, 5
    v_add_u32_e64 v166, s36, v165
    s_mul_i32 s33, s33, 5120
    s_add_u32 s33, s33, 2621440
    v_lshl_add_u32 v167, v1, 4, s33
    v_add_u32 v164, 4096, v167
    v_mov_b32 v163, 1073741824
    v_cmp_gt_u32 vcc, 64, v0
    s_sub_u32 s36, s24, s31
    s_and_b32 s36, s36, 3
    s_lshl_b32 s36, s36, 10
    v_cndmask_b32 v168, v163, v164, vcc
    v_add_u32 v167, s36, v167
    s_sub_u32 s33, s2, 64
    s_min_u32 s33, s33, 159
    s_mul_i32 s29, s33, 3277
    s_lshr_b32 s29, s29, 16
    s_mul_i32 s30, s29, 20
    s_sub_u32 s30, s33, s30
    s_mul_i32 s31, s30, 13108
    s_lshr_b32 s31, s31, 16
    s_mul_i32 s32, s31, 5
    s_sub_u32 s32, s30, s32
    s_lshl_b32 s28, s24, 10
    s_lshr_b32 s34, s32, 1
    s_mul_i32 s34, s34, 20
    s_and_b32 s35, s32, 1
    s_lshl_b32 s35, s35, 3
    s_add_u32 s34, s34, s35
    s_cmp_eq_u32 s32, 4
    s_cselect_b32 s34, 16, s34
    s_cselect_b32 s35, 20, 4
    s_mul_i32 s36, s31, 160
    s_add_u32 s34, s34, s36
    s_mul_i32 s34, s34, 1280
    s_mul_i32 s36, s29, 160
    s_add_u32 s34, s34, s36
    v_add_u32 v182, 0, v0
    v_mul_u32_u24 v180, 6554, v182
    v_lshrrev_b32 v180, 16, v180
    v_mul_u32_u24 v181, 10, v180
    v_sub_u32 v181, v182, v181
    v_lshrrev_b32 v183, 3, v180
    v_mul_u32_u24 v183, 40, v183
    v_bfe_u32 v184, v180, 2, 1
    v_mul_u32_u24 v184, s35, v184
    v_and_b32_e64 v180, 3, v180
    v_add3_u32 v180, v180, v183, v184
    v_mul_u32_u24 v180, 1280, v180
    v_lshl_add_u32 v182, v181, 4, v180
    s_add_u32 m0, s28, 8192
    s_nop 0
    buffer_load_dwordx4 v182, s[12:15], s34 offen lds
    v_add_u32 v182, 256, v0
    v_min_u32 v182, 319, v182
    v_mul_u32_u24 v180, 6554, v182
    v_lshrrev_b32 v180, 16, v180
    v_mul_u32_u24 v181, 10, v180
    v_sub_u32 v181, v182, v181
    v_lshrrev_b32 v183, 3, v180
    v_mul_u32_u24 v183, 40, v183
    v_bfe_u32 v184, v180, 2, 1
    v_mul_u32_u24 v184, s35, v184
    v_and_b32 v180, 3, v180
    v_add3_u32 v180, v180, v183, v184
    v_mul_u32_u24 v180, 1280, v180
    v_lshl_add_u32 v182, v181, 4, v180
    s_add_u32 m0, s28, 12288
    s_nop 0
    buffer_load_dwordx4 v182, s[12:15], s34 offen lds
    v_bfe_u32 v183, v0, 4, 2
    v_bfe_u32 v184, v0, 2, 2
    v_lshl_add_u32 v183, v183, 3, v184
    v_mul_u32_u24 v183, 160, v183
    v_and_b32 v184, 3, v0
    v_lshl_add_u32 v185, v184, 3, v183
    v_add_u32 v185, 8192, v185
    s_lshl_b32 s36, s24, 5
    v_add_u32 v186, s36, v185
    s_mul_i32 s33, s33, 5120
    s_add_u32 s33, s33, 2621440
    v_lshl_add_u32 v187, v1, 4, s33
    v_add_u32 v184, 4096, v187
    v_mov_b32 v183, 1073741824
    v_cmp_gt_u32 vcc, 64, v0
    s_sub_u32 s36, s24, s31
    s_and_b32 s36, s36, 3
    s_lshl_b32 s36, s36, 10
    v_cndmask_b32 v188, v183, v184, vcc
    v_add_u32 v187, s36, v187
    v_mov_b32 v216, 0
    v_mov_b32 v217, 0
    v_mov_b32 v218, 0
    v_mov_b32 v219, 0
    v_mov_b32 v220, 0
    v_mov_b32 v221, 0
    v_mov_b32 v222, 0
    v_mov_b32 v223, 0
    v_mov_b32 v224, 0
    v_mov_b32 v225, 0
    v_mov_b32 v226, 0
    v_mov_b32 v227, 0
    v_mov_b32 v228, 0
    v_mov_b32 v229, 0
    v_mov_b32 v230, 0
    v_mov_b32_e64 v231, 0
    s_waitcnt vmcnt(5)
    s_barrier
    ds_read_b64_tr_b16 v[96:97], v111
    ds_read_b64_tr_b16 v[98:99], v111 offset:2560
    ds_read_b64_tr_b16 v[100:101], v112
    ds_read_b64_tr_b16 v[102:103], v112 offset:2560
    ds_read_b64_tr_b16 v[104:105], v113
    ds_read_b64_tr_b16 v[106:107], v113 offset:2560
    s_waitcnt lgkmcnt(4)
    buffer_store_dwordx4 v[96:99], v108, s[16:19], 0 offen sc1
    s_waitcnt lgkmcnt(2)
    buffer_store_dwordx4 v[100:103], v109, s[16:19], 0 offen sc1
    s_waitcnt lgkmcnt(0)
    buffer_store_dwordx4 v[104:107], v110, s[16:19], 0 offen sc1
    global_load_dword v7, v5, s[66:67] sc1
    v_lshrrev_b32 v132, 5, v0
    v_and_b32_e64 v133, 31, v0
    v_mul_u32_u24 v132, 1280, v132
    v_lshl_add_u32 v134, v133, 4, v132
    v_mov_b32 v135, 1073741824
    v_cmp_gt_u32 vcc, 16, v133
    s_mul_i32 s96, s2, 10240
    buffer_load_dwordx4 v[120:123], v134, s[4:7], s96 offen
    v_cndmask_b32_e64 v135, v135, v134, vcc
    buffer_load_dwordx4 v[124:127], v134, s[4:7], s96 offen offset:512
    buffer_load_dwordx4 v[128:131], v135, s[4:7], s96 offen offset:1024
    s_waitcnt vmcnt(4)
    s_waitcnt vmcnt(3)
    v_cmp_gt_u32 vcc, 1, v7
    s_nop 0
    s_and_b64 vcc, vcc, s[50:51]
    s_and_b64 vcc, vcc, 1
    s_cbranch_scc1 ps_11
pc_13:
    s_barrier
    v_lshlrev_b32 v2, 3, v4
    v_mov_b32 v5, 1
    v_cndmask_b32 v2, v4, v2, s[50:51]
    buffer_atomic_add v5, v2, s[16:19], s86 offen offset:0 sc1
    ds_read_b64_tr_b16 v[172:173], v166
    ds_read_b64_tr_b16 v[174:175], v166 offset:640
    ds_read_b64_tr_b16 v[176:177], v165 offset:128
    ds_read_b64_tr_b16 v[178:179], v165 offset:768
    s_waitcnt lgkmcnt(2)
    buffer_store_dwordx4 v[172:175], v167, s[16:19], 0 offen sc1
    s_waitcnt lgkmcnt(0)
    buffer_store_dwordx4 v[176:179], v168, s[16:19], 0 offen sc1
    ds_read_b64_tr_b16 v[192:193], v186
    ds_read_b64_tr_b16 v[194:195], v186 offset:640
    ds_read_b64_tr_b16 v[196:197], v185 offset:128
    ds_read_b64_tr_b16 v[198:199], v185 offset:768
    s_waitcnt lgkmcnt(2)
    buffer_store_dwordx4 v[192:195], v187, s[16:19], 0 offen sc1
    s_waitcnt lgkmcnt(0)
    buffer_store_dwordx4 v[196:199], v188, s[16:19], 0 offen sc1
    v_mov_b32 v134, 0x3f803f80
    v_mov_b32 v132, 0
    v_mov_b32 v133, 0
    s_waitcnt vmcnt(7)
    v_dot2c_f32_bf16 v132, v120, v134
    v_dot2c_f32_bf16 v133, v120, v120
    v_dot2c_f32_bf16 v132, v121, v134
    v_dot2c_f32_bf16 v133, v121, v121
    v_dot2c_f32_bf16 v132, v122, v134
    v_dot2c_f32_bf16 v133, v122, v122
    v_dot2c_f32_bf16 v132, v123, v134
    v_dot2c_f32_bf16 v133, v123, v123
    s_waitcnt vmcnt(6)
    v_dot2c_f32_bf16 v132, v124, v134
    v_dot2c_f32_bf16 v133, v124, v124
    v_dot2c_f32_bf16 v132, v125, v134
    v_dot2c_f32_bf16 v133, v125, v125
    v_dot2c_f32_bf16 v132, v126, v134
    v_dot2c_f32_bf16 v133, v126, v126
    v_dot2c_f32_bf16 v132, v127, v134
    v_dot2c_f32_bf16 v133, v127, v127
    s_waitcnt vmcnt(5)
    v_dot2c_f32_bf16 v132, v128, v134
    v_dot2c_f32_bf16 v133, v128, v128
    v_dot2c_f32_bf16 v132, v129, v134
    v_dot2c_f32_bf16 v133, v129, v129
    v_dot2c_f32_bf16 v132, v130, v134
    v_dot2c_f32_bf16 v133, v130, v130
    v_dot2c_f32_bf16 v132, v131, v134
    v_dot2c_f32_bf16 v133, v131, v131
    v_lshrrev_b32 v135, 5, v0
    v_and_b32 v121, 3, v135
    v_lshrrev_b32 v135, 2, v135
    v_add_f32_dpp v132, v132, v132 row_shr:1 row_mask:0xf bank_mask:0xf bound_ctrl:0
    v_add_f32_dpp v133, v133, v133 row_shr:1 row_mask:0xf bank_mask:0xf bound_ctrl:0
    v_lshlrev_b32_e64 v135, 3, v135
    v_add_f32_dpp v132, v132, v132 row_shr:2 row_mask:0xf bank_mask:0xf bound_ctrl:0
    v_add_f32_dpp v133, v133, v133 row_shr:2 row_mask:0xf bank_mask:0xf bound_ctrl:0
    v_lshl_add_u32 v135, v121, 12, v135
    v_add_f32_dpp v132, v132, v132 row_shr:4 row_mask:0xf bank_mask:0xf bound_ctrl:0
    v_add_f32_dpp v133, v133, v133 row_shr:4 row_mask:0xf bank_mask:0xf bound_ctrl:0
    v_and_b32_e64 v121, 31, v0
    v_add_f32_dpp v132, v132, v132 row_shr:8 row_mask:0xf bank_mask:0xf bound_ctrl:0
    v_add_f32_dpp v133, v133, v133 row_shr:8 row_mask:0xf bank_mask:0xf bound_ctrl:0
    v_cmp_eq_u32_e64 vcc, 31, v121
    v_add_f32_dpp v132, v132, v132 row_bcast:15 row_mask:0xa bank_mask:0xf
    v_add_f32_dpp v133, v133, v133 row_bcast:15 row_mask:0xa bank_mask:0xf
    v_mov_b32 v121, 1073741824
    v_cndmask_b32_e64 v120, v121, v135, vcc
    s_lshl_b32 s96, s2, 4
    s_add_u32 s96, s96, 3440640
    v_mul_f32 v135, 0x3acccccd, v132
    v_mul_f32 v133, 0x3acccccd, v133
    v_fma_f32 v133, -v135, v135, v133
    v_max_f32 v133, 0, v133
    v_add_f32 v133, 0x3727c5ac, v133
    v_rsq_f32_e64 v132, v133
    s_nop 0
    v_mul_f32 v133, -v135, v132
    buffer_store_dwordx2 v[132:133], v120, s[16:19], s96 offen sc1
    s_add_u32 m0, s92, 36352
    s_nop 0
    s_nop 0
    buffer_load_dwordx4 v73, s[4:7], s99 offen offset:0  lds
    buffer_load_dwordx4 v74, s[4:7], s99 offen offset:1088  lds
    buffer_load_dwordx4 v75, s[4:7], s99 offen offset:2176  lds
    buffer_load_dwordx4 v76, s[4:7], s99 offen offset:3264  lds
    s_add_u32 m0, s93, 53760
    s_add_u32 s99, s99, 256
    s_mov_b64 exec, s[80:81]
    buffer_load_dwordx4 v77, s[4:7], s100 offen  lds
    s_mov_b64 exec, -1
    s_add_u32 s100, s100, 256
    s_add_u32 m0, s92, 55936
    s_nop 0
    s_nop 0
    buffer_load_dwordx4 v73, s[4:7], s99 offen offset:0  lds
    buffer_load_dwordx4 v74, s[4:7], s99 offen offset:1088  lds
    buffer_load_dwordx4 v75, s[4:7], s99 offen offset:2176  lds
    buffer_load_dwordx4 v76, s[4:7], s99 offen offset:3264  lds
    s_add_u32 m0, s93, 73344
    s_add_u32 s99, s99, 256
    s_mov_b64 exec, s[80:81]
    buffer_load_dwordx4 v77, s[4:7], s100 offen  lds
    s_mov_b64 exec, -1
    s_add_u32 s100, s100, 256
    v_mov_b32 v140, 1073741824
    v_lshlrev_b32 v141, 2, v0
    v_cmp_gt_u32 vcc, 64, v0
    s_nop 1
    v_cndmask_b32 v141, v140, v141, vcc
    v_mov_b32_e64 v140, 0
    s_lshl_b32 s97, s2, 8
    s_add_u32 s97, s97, 3473408
    buffer_store_dword v140, v141, s[16:19], s97 offen sc1
    v_mov_b32 v142, 1073741824
    v_lshlrev_b32 v143, 2, v0
    v_cmp_gt_u32 vcc, 16, v0
    s_nop 1
    v_cndmask_b32 v143, v142, v143, vcc
    v_mov_b32_e64 v142, -1
    s_lshl_b32 s97, s2, 6
    s_add_u32 s97, s97, 3457024
    buffer_store_dword v142, v143, s[16:19], s97 offen sc1
    v_mov_b32 v144, -1
    v_mov_b32 v145, -1
    v_mov_b32 v146, -1
    v_mov_b32 v147, -1
    v_lshlrev_b32 v148, 4, v0
    s_sub_u32 s88, s2, 0
    s_mul_i32 s88, s88, 20480
    s_min_u32 s88, s88, 5222400
    s_add_u32 s88, s88, 4194304
    buffer_store_dwordx4 v[144:147], v148, s[16:19], s88 offen sc1
    s_add_u32 s88, s88, 4096
    buffer_store_dwordx4 v[144:147], v148, s[16:19], s88 offen sc1
    s_add_u32 s88, s88, 4096
    buffer_store_dwordx4 v[144:147], v148, s[16:19], s88 offen sc1
    s_add_u32 s88, s88, 4096
    buffer_store_dwordx4 v[144:147], v148, s[16:19], s88 offen sc1
    s_add_u32 s88, s88, 4096
    buffer_store_dwordx4 v[144:147], v148, s[16:19], s88 offen sc1
    s_add_u32 m0, s92, 75520
    s_nop 0
    s_nop 0
    buffer_load_dwordx4 v73, s[4:7], s99 offen offset:0  lds
    buffer_load_dwordx4 v74, s[4:7], s99 offen offset:1088  lds
    buffer_load_dwordx4 v75, s[4:7], s99 offen offset:2176  lds
    buffer_load_dwordx4 v76, s[4:7], s99 offen offset:3264  lds
    s_add_u32 m0, s93, 92928
    s_add_u32 s99, s99, 256
    s_mov_b64 exec, s[80:81]
    buffer_load_dwordx4 v77, s[4:7], s100 offen  lds
    s_mov_b64 exec, -1
    s_add_u32 s100, s100, 256
    s_add_u32 m0, s92, 95104
    s_nop 0
    s_nop 0
    buffer_load_dwordx4 v73, s[4:7], s99 offen offset:0  lds
    buffer_load_dwordx4 v74, s[4:7], s99 offen offset:1088  lds
    buffer_load_dwordx4 v75, s[4:7], s99 offen offset:2176  lds
    buffer_load_dwordx4 v76, s[4:7], s99 offen offset:3264  lds
    s_add_u32 m0, s93, 112512
    s_add_u32 s99, s99, 256
    s_mov_b64 exec, s[80:81]
    buffer_load_dwordx4 v77, s[4:7], s100 offen  lds
    s_mov_b64 exec, -1
    s_add_u32 s100, s100, 256
    s_add_u32 m0, s92, 114688
    s_nop 0
    s_nop 0
    buffer_load_dwordx4 v73, s[4:7], s99 offen offset:0  lds
    buffer_load_dwordx4 v74, s[4:7], s99 offen offset:1088  lds
    buffer_load_dwordx4 v75, s[4:7], s99 offen offset:2176  lds
    buffer_load_dwordx4 v76, s[4:7], s99 offen offset:3264  lds
    s_add_u32 m0, s93, 132096
    s_add_u32 s99, s99, 256
    s_mov_b64 exec, s[80:81]
    buffer_load_dwordx4 v77, s[4:7], s100 offen  lds
    s_mov_b64 exec, -1
    s_add_u32 s100, s100, 256
    s_waitcnt vmcnt(15)
    buffer_load_dword v7, v4, s[16:19], s87 offen offset:0 sc1
    s_waitcnt vmcnt(0)
    v_cmp_gt_u32_e64 vcc, 32, v7
    s_nop 0
    s_and_b64 vcc, vcc, s[50:51]
    s_cbranch_scc1 ps_14
pc_16:
    s_barrier
    buffer_load_dwordx4 a[0:3], v200, s[16:19], s101 offen offset:0 sc1
    buffer_load_dwordx4 a[4:7], v200, s[16:19], s101 offen offset:1024 sc1
    buffer_load_dwordx4 a[8:11], v200, s[16:19], s101 offen offset:2048 sc1
    buffer_load_dwordx4 a[12:15], v200, s[16:19], s101 offen offset:3072 sc1
    s_add_u32 s101, s101, 4096
    buffer_load_dwordx4 a[16:19], v200, s[16:19], s101 offen offset:0 sc1
    buffer_load_dwordx4 a[20:23], v200, s[16:19], s101 offen offset:1024 sc1
    buffer_load_dwordx4 a[24:27], v200, s[16:19], s101 offen offset:2048 sc1
    buffer_load_dwordx4 a[28:31], v200, s[16:19], s101 offen offset:3072 sc1
    s_add_u32 s101, s101, 4096
    buffer_load_dwordx4 a[32:35], v200, s[16:19], s101 offen offset:0 sc1
    buffer_load_dwordx4 a[36:39], v200, s[16:19], s101 offen offset:1024 sc1
    buffer_load_dwordx4 a[40:43], v200, s[16:19], s101 offen offset:2048 sc1
    buffer_load_dwordx4 a[44:47], v200, s[16:19], s101 offen offset:3072 sc1
    s_add_u32 s101, s101, 4096
    buffer_load_dwordx4 a[48:51], v200, s[16:19], s101 offen offset:0 sc1
    buffer_load_dwordx4 a[52:55], v200, s[16:19], s101 offen offset:1024 sc1
ec_3:
    v_add_u32 v196, 36352, v78
    v_mov_b32 v198, v79
    v_xor_b32 v197, 32, v196
    s_waitcnt vmcnt(34)
    s_barrier
    s_add_u32 s82, s86, 16384
    v_lshlrev_b32 v2, 3, v4
    v_mov_b32 v5, 1
    v_cndmask_b32 v2, v4, v2, s[50:51]
    buffer_atomic_add v5, v2, s[16:19], s82 offen offset:8 sc1
    ds_read_b128 v[160:163], v198 offset:0
    ds_read_b128 v[164:167], v196 offset:0
    ds_read_b128 v[168:171], v196 offset:8704
    ds_read_b128 v[172:175], v198 offset:32
    ds_read_b128 v[176:179], v197 offset:0
    ds_read_b128 v[180:183], v197 offset:8704
    s_waitcnt lgkmcnt(3)
    s_waitcnt vmcnt(14)
    v_mfma_f32_16x16x32_bf16 v[112:115], a[0:3], v[160:163], 0
    ds_read_b128 v[184:187], v198 offset:64
    v_mfma_f32_32x32x16_bf16 v[80:95], a[0:3], v[164:167], 0
    ds_read_b128 v[188:191], v196 offset:64
    v_mov_b32 v208, 0
    v_mov_b32 v209, 0
    v_lshrrev_b32_e64 v210, 5, v0
    v_mul_u32_u24 v210, 1600, v210
    v_mfma_f32_32x32x16_bf16 v[96:111], a[0:3], v[168:171], 0
    ds_read_b128 v[192:195], v196 offset:8768
    buffer_load_dwordx4 a[56:59], v200, s[16:19], s101 offen offset:2048 sc1
    v_and_b32 v211, 31, v0
    v_min_u32 v211, 19, v211
    s_waitcnt lgkmcnt(3)
    s_waitcnt vmcnt(14)
    v_mfma_f32_16x16x32_bf16 v[112:115], a[4:7], v[172:175], v[112:115]
    ds_read_b128 v[160:163], v198 offset:96
    v_mfma_f32_32x32x16_bf16 v[80:95], a[4:7], v[176:179], v[80:95]
    ds_read_b128 v[164:167], v197 offset:64
    v_lshl_add_u32 v210, v211, 3, v210
    v_add_u32 v210, 6400, v210
    ds_write_b64 v210, v[208:209]
    s_mul_i32 s33, s24, 4160
    v_mfma_f32_32x32x16_bf16 v[96:111], a[4:7], v[180:183], v[96:111]
    ds_read_b128 v[168:171], v197 offset:8768
    buffer_load_dwordx4 a[60:63], v200, s[16:19], s101 offen offset:3072 sc1
    s_add_u32 s33, s33, 134272
    v_and_b32_e64 v250, 31, v1
    s_waitcnt lgkmcnt(4)
    s_waitcnt vmcnt(14)
    v_mfma_f32_16x16x32_bf16 v[112:115], a[8:11], v[184:187], v[112:115]
    ds_read_b128 v[172:175], v198 offset:128
    v_mfma_f32_32x32x16_bf16 v[80:95], a[8:11], v[188:191], v[80:95]
    ds_read_b128 v[176:179], v196 offset:128
    v_lshl_add_u32 v250, v250, 4, s33
    v_lshrrev_b32_e64 v253, 5, v1
    v_lshl_add_u32 v251, v253, 3, v250
    v_lshl_add_u32 v252, v253, 9, v250
    v_mfma_f32_32x32x16_bf16 v[96:111], a[8:11], v[192:195], v[96:111]
    ds_read_b128 v[180:183], v196 offset:8832
    s_add_u32 s101, s101, 4096
    buffer_load_dwordx4 a[64:67], v200, s[16:19], s101 offen offset:0 sc1
    v_lshl_add_u32 v250, v253, 10, v250
    s_waitcnt lgkmcnt(3)
    s_waitcnt vmcnt(14)
    v_mfma_f32_16x16x32_bf16 v[112:115], a[12:15], v[160:163], v[112:115]
    ds_read_b128 v[184:187], v198 offset:160
    v_mfma_f32_32x32x16_bf16 v[80:95], a[12:15], v[164:167], v[80:95]
    ds_read_b128 v[188:191], v197 offset:128
    v_cmp_eq_u32 vcc, 0, v1
    v_lshlrev_b32 v254, 16, v241
    v_min_u32 v253, 15, v1
    v_cndmask_b32 v254, 0, v254, vcc
    v_mfma_f32_32x32x16_bf16 v[96:111], a[12:15], v[168:171], v[96:111]
    ds_read_b128 v[192:195], v197 offset:8832
    buffer_load_dwordx4 a[68:71], v200, s[16:19], s101 offen offset:1024 sc1
    v_lshl_add_u32 v253, v253, 2, s33
    v_add_f32_e64 v216, v216, v254
    s_waitcnt lgkmcnt(3)
    s_waitcnt vmcnt(14)
    v_mfma_f32_16x16x32_bf16 v[112:115], a[16:19], v[172:175], v[112:115]
    ds_read_b128 v[160:163], v198 offset:192
    v_mfma_f32_32x32x16_bf16 v[80:95], a[16:19], v[176:179], v[80:95]
    ds_read_b128 v[164:167], v196 offset:192
    v_and_b32 v254, 1, v1
    v_cmp_eq_u32 vcc, 1, v254
    v_mov_b32_e64 v254, 0
    v_cvt_pk_bf16_f32 v242, v216, v217
    v_mfma_f32_32x32x16_bf16 v[96:111], a[16:19], v[180:183], v[96:111]
    ds_read_b128 v[168:171], v196 offset:8896
    buffer_load_dwordx4 a[72:75], v200, s[16:19], s101 offen offset:2048 sc1
    v_cvt_pk_bf16_f32 v243, v218, v219
    v_cvt_pk_bf16_f32 v244, v220, v220
    s_waitcnt lgkmcnt(3)
    s_waitcnt vmcnt(14)
    v_mfma_f32_16x16x32_bf16 v[112:115], a[20:23], v[184:187], v[112:115]
    ds_read_b128 v[172:175], v198 offset:224
    v_mfma_f32_32x32x16_bf16 v[80:95], a[20:23], v[188:191], v[80:95]
    ds_read_b128 v[176:179], v197 offset:192
    v_cvt_pk_bf16_f32 v245, v221, v222
    v_cvt_pk_bf16_f32 v246, v224, v224
    v_cvt_pk_bf16_f32 v247, v224, v225
    v_cvt_pk_bf16_f32 v248, v225, v225
    v_mfma_f32_32x32x16_bf16 v[96:111], a[20:23], v[192:195], v[96:111]
    ds_read_b128 v[180:183], v197 offset:8896
    buffer_load_dwordx4 a[76:79], v200, s[16:19], s101 offen offset:3072 sc1
    v_cvt_pk_bf16_f32 v249, v226, v226
    ds_write_b32 v253, v254
    s_barrier
    s_waitcnt lgkmcnt(4)
    s_waitcnt vmcnt(14)
    v_mfma_f32_16x16x32_bf16 v[112:115], a[24:27], v[160:163], v[112:115]
    v_add_u32 v198, v49, v198
    v_mfma_f32_32x32x16_bf16 v[80:95], a[24:27], v[164:167], v[80:95]
    v_add_u32 v196, 19584, v196
    v_add_u32 v197, 19584, v197
    ds_read_b128 v[184:187], v198 offset:0
    ds_write_b64 v251, v[242:243] offset:64
    ds_write_b64 v251, v[244:245] offset:576
    v_mfma_f32_32x32x16_bf16 v[96:111], a[24:27], v[168:171], v[96:111]
    ds_read_b128 v[188:191], v196 offset:0
    ds_read_b128 v[192:195], v196 offset:8704
    s_add_u32 s101, s101, 4096
    buffer_load_dwordx4 a[80:83], v200, s[16:19], s101 offen offset:0 sc1
    s_waitcnt lgkmcnt(6)
    s_waitcnt vmcnt(14)
    v_mfma_f32_16x16x32_bf16 v[112:115], a[28:31], v[172:175], v[112:115]
    ds_read_b128 v[160:163], v198 offset:32
    v_mfma_f32_32x32x16_bf16 v[80:95], a[28:31], v[176:179], v[80:95]
    ds_read_b128 v[164:167], v197 offset:0
    ds_write_b128 v252, v[246:249] offset:1088
    v_cndmask_b32 v255, v228, v229, vcc
    v_cvt_pk_bf16_f32 v216, v228, v228
    v_mov_b32 v217, v216
    v_mfma_f32_32x32x16_bf16 v[96:111], a[28:31], v[180:183], v[96:111]
    ds_read_b128 v[168:171], v197 offset:8704
    buffer_load_dwordx4 a[84:87], v200, s[16:19], s101 offen offset:1024 sc1
    v_cvt_pk_bf16_f32 v218, v255, v229
    v_cvt_pk_bf16_f32 v219, v229, v229
    s_waitcnt lgkmcnt(4)
    s_waitcnt vmcnt(14)
    v_mfma_f32_16x16x32_bf16 v[112:115], a[32:35], v[184:187], v[112:115]
    ds_read_b128 v[172:175], v198 offset:64
    v_mfma_f32_32x32x16_bf16 v[80:95], a[32:35], v[188:191], v[80:95]
    ds_read_b128 v[176:179], v196 offset:64
    ds_write_b128 v250, v[216:219] offset:2112
    v_cndmask_b32 v255, v230, v231, vcc
    v_cvt_pk_bf16_f32 v220, v230, v230
    v_mov_b32 v221, v220
    v_mfma_f32_32x32x16_bf16 v[96:111], a[32:35], v[192:195], v[96:111]
    ds_read_b128 v[180:183], v196 offset:8768
    buffer_load_dwordx4 a[88:91], v200, s[16:19], s101 offen offset:2048 sc1
    v_cvt_pk_bf16_f32 v222, v255, v231
    v_cvt_pk_bf16_f32 v223, v231, v231
    s_waitcnt lgkmcnt(4)
    s_waitcnt vmcnt(14)
    v_mfma_f32_16x16x32_bf16 v[112:115], a[36:39], v[160:163], v[112:115]
    ds_read_b128 v[184:187], v198 offset:96
    v_mfma_f32_32x32x16_bf16 v[80:95], a[36:39], v[164:167], v[80:95]
    ds_read_b128 v[188:191], v197 offset:64
    ds_write_b128 v250, v[220:223] offset:2624
    v_mfma_f32_32x32x16_bf16 v[96:111], a[36:39], v[168:171], v[96:111]
    ds_read_b128 v[192:195], v197 offset:8768
    buffer_load_dwordx4 a[92:95], v200, s[16:19], s101 offen offset:3072 sc1
    s_waitcnt lgkmcnt(4)
    s_waitcnt vmcnt(14)
    v_mfma_f32_16x16x32_bf16 v[112:115], a[40:43], v[172:175], v[112:115]
    ds_read_b128 v[160:163], v198 offset:128
    v_mfma_f32_32x32x16_bf16 v[80:95], a[40:43], v[176:179], v[80:95]
    ds_read_b128 v[164:167], v196 offset:128
    v_mfma_f32_32x32x16_bf16 v[96:111], a[40:43], v[180:183], v[96:111]
    ds_read_b128 v[168:171], v196 offset:8832
    s_add_u32 s101, s101, 4096
    buffer_load_dwordx4 a[96:99], v200, s[16:19], s101 offen offset:0 sc1
    s_waitcnt lgkmcnt(3)
    s_waitcnt vmcnt(14)
    v_mfma_f32_16x16x32_bf16 v[112:115], a[44:47], v[184:187], v[112:115]
    ds_read_b128 v[172:175], v198 offset:160
    v_mfma_f32_32x32x16_bf16 v[80:95], a[44:47], v[188:191], v[80:95]
    ds_read_b128 v[176:179], v197 offset:128
    v_mfma_f32_32x32x16_bf16 v[96:111], a[44:47], v[192:195], v[96:111]
    ds_read_b128 v[180:183], v197 offset:8832
    buffer_load_dwordx4 a[100:103], v200, s[16:19], s101 offen offset:1024 sc1
    s_waitcnt lgkmcnt(3)
    s_waitcnt vmcnt(14)
    v_mfma_f32_16x16x32_bf16 v[112:115], a[48:51], v[160:163], v[112:115]
    ds_read_b128 v[184:187], v198 offset:192
    v_mfma_f32_32x32x16_bf16 v[80:95], a[48:51], v[164:167], v[80:95]
    ds_read_b128 v[188:191], v196 offset:192
    v_mfma_f32_32x32x16_bf16 v[96:111], a[48:51], v[168:171], v[96:111]
    ds_read_b128 v[192:195], v196 offset:8896
    buffer_load_dwordx4 a[104:107], v200, s[16:19], s101 offen offset:2048 sc1
    s_waitcnt lgkmcnt(3)
    s_waitcnt vmcnt(14)
    v_mfma_f32_16x16x32_bf16 v[112:115], a[52:55], v[172:175], v[112:115]
    ds_read_b128 v[160:163], v198 offset:224
    v_mfma_f32_32x32x16_bf16 v[80:95], a[52:55], v[176:179], v[80:95]
    ds_read_b128 v[164:167], v197 offset:192
    v_mfma_f32_32x32x16_bf16 v[96:111], a[52:55], v[180:183], v[96:111]
    ds_read_b128 v[168:171], v197 offset:8896
    buffer_load_dwordx4 a[108:111], v200, s[16:19], s101 offen offset:3072 sc1
    s_barrier
    s_waitcnt lgkmcnt(3)
    s_waitcnt vmcnt(13)
    v_mfma_f32_16x16x32_bf16 v[112:115], a[56:59], v[184:187], v[112:115]
    v_add_u32 v198, v49, v198
    v_mfma_f32_32x32x16_bf16 v[80:95], a[56:59], v[188:191], v[80:95]
    v_add_u32 v196, 19584, v196
    v_add_u32 v197, 19584, v197
    ds_read_b128 v[172:175], v198 offset:0
    v_mfma_f32_32x32x16_bf16 v[96:111], a[56:59], v[192:195], v[96:111]
    ds_read_b128 v[176:179], v196 offset:0
    ds_read_b128 v[180:183], v196 offset:8704
    s_add_u32 s101, s101, 4096
    buffer_load_dwordx4 a[112:115], v200, s[16:19], s101 offen offset:0 sc1
    s_waitcnt lgkmcnt(3)
    s_waitcnt vmcnt(13)
    v_mfma_f32_16x16x32_bf16 v[112:115], a[60:63], v[160:163], v[112:115]
    ds_read_b128 v[184:187], v198 offset:32
    v_mfma_f32_32x32x16_bf16 v[80:95], a[60:63], v[164:167], v[80:95]
    ds_read_b128 v[188:191], v197 offset:0
    v_mfma_f32_32x32x16_bf16 v[96:111], a[60:63], v[168:171], v[96:111]
    ds_read_b128 v[192:195], v197 offset:8704
    buffer_load_dwordx4 a[116:119], v200, s[16:19], s101 offen offset:1024 sc1
    s_waitcnt lgkmcnt(3)
    s_waitcnt vmcnt(13)
    v_mfma_f32_16x16x32_bf16 v[112:115], a[64:67], v[172:175], v[112:115]
    ds_read_b128 v[160:163], v198 offset:64
    v_mfma_f32_32x32x16_bf16 v[80:95], a[64:67], v[176:179], v[80:95]
    ds_read_b128 v[164:167], v196 offset:64
    v_mfma_f32_32x32x16_bf16 v[96:111], a[64:67], v[180:183], v[96:111]
    ds_read_b128 v[168:171], v196 offset:8768
    buffer_load_dwordx4 a[120:123], v200, s[16:19], s101 offen offset:2048 sc1
    s_waitcnt lgkmcnt(3)
    s_waitcnt vmcnt(13)
    v_mfma_f32_16x16x32_bf16 v[112:115], a[68:71], v[184:187], v[112:115]
    ds_read_b128 v[172:175], v198 offset:96
    v_mfma_f32_32x32x16_bf16 v[80:95], a[68:71], v[188:191], v[80:95]
    ds_read_b128 v[176:179], v197 offset:64
    v_mfma_f32_32x32x16_bf16 v[96:111], a[68:71], v[192:195], v[96:111]
    ds_read_b128 v[180:183], v197 offset:8768
    buffer_load_dwordx4 a[124:127], v200, s[16:19], s101 offen offset:3072 sc1
    s_waitcnt lgkmcnt(3)
    s_waitcnt vmcnt(13)
    v_mfma_f32_16x16x32_bf16 v[112:115], a[72:75], v[160:163], v[112:115]
    ds_read_b128 v[184:187], v198 offset:128
    v_mfma_f32_32x32x16_bf16 v[80:95], a[72:75], v[164:167], v[80:95]
    ds_read_b128 v[188:191], v196 offset:128
    v_mfma_f32_32x32x16_bf16 v[96:111], a[72:75], v[168:171], v[96:111]
    ds_read_b128 v[192:195], v196 offset:8832
    s_add_u32 s101, s101, 4096
    buffer_load_dwordx4 a[128:131], v200, s[16:19], s101 offen offset:0 sc1
    s_waitcnt lgkmcnt(3)
    s_waitcnt vmcnt(13)
    v_mfma_f32_16x16x32_bf16 v[112:115], a[76:79], v[172:175], v[112:115]
    ds_read_b128 v[160:163], v198 offset:160
    v_mfma_f32_32x32x16_bf16 v[80:95], a[76:79], v[176:179], v[80:95]
    ds_read_b128 v[164:167], v197 offset:128
    v_mfma_f32_32x32x16_bf16 v[96:111], a[76:79], v[180:183], v[96:111]
    ds_read_b128 v[168:171], v197 offset:8832
    buffer_load_dwordx4 a[132:135], v200, s[16:19], s101 offen offset:1024 sc1
    s_waitcnt lgkmcnt(3)
    s_waitcnt vmcnt(13)
    v_mfma_f32_16x16x32_bf16 v[112:115], a[80:83], v[184:187], v[112:115]
    ds_read_b128 v[172:175], v198 offset:192
    v_mfma_f32_32x32x16_bf16 v[80:95], a[80:83], v[188:191], v[80:95]
    ds_read_b128 v[176:179], v196 offset:192
    v_mfma_f32_32x32x16_bf16 v[96:111], a[80:83], v[192:195], v[96:111]
    ds_read_b128 v[180:183], v196 offset:8896
    buffer_load_dwordx4 a[136:139], v200, s[16:19], s101 offen offset:2048 sc1
    s_waitcnt lgkmcnt(3)
    s_waitcnt vmcnt(13)
    v_mfma_f32_16x16x32_bf16 v[112:115], a[84:87], v[160:163], v[112:115]
    ds_read_b128 v[184:187], v198 offset:224
    v_mfma_f32_32x32x16_bf16 v[80:95], a[84:87], v[164:167], v[80:95]
    ds_read_b128 v[188:191], v197 offset:192
    v_mfma_f32_32x32x16_bf16 v[96:111], a[84:87], v[168:171], v[96:111]
    ds_read_b128 v[192:195], v197 offset:8896
    buffer_load_dwordx4 a[140:143], v200, s[16:19], s101 offen offset:3072 sc1
    s_barrier
    s_waitcnt lgkmcnt(3)
    s_waitcnt vmcnt(13)
    v_mfma_f32_16x16x32_bf16 v[112:115], a[88:91], v[172:175], v[112:115]
    v_add_u32 v198, v49, v198
    v_mfma_f32_32x32x16_bf16 v[80:95], a[88:91], v[176:179], v[80:95]
    v_add_u32 v196, 19584, v196
    v_add_u32 v197, 19584, v197
    ds_read_b128 v[160:163], v198 offset:0
    v_mfma_f32_32x32x16_bf16 v[96:111], a[88:91], v[180:183], v[96:111]
    ds_read_b128 v[164:167], v196 offset:0
    ds_read_b128 v[168:171], v196 offset:8704
    s_add_u32 s101, s101, 4096
    buffer_load_dword v7, v4, s[16:19], s89 offen offset:8 sc1
    s_waitcnt lgkmcnt(3)
    s_waitcnt vmcnt(13)
    v_mfma_f32_16x16x32_bf16 v[112:115], a[92:95], v[184:187], v[112:115]
    ds_read_b128 v[172:175], v198 offset:32
    v_mfma_f32_32x32x16_bf16 v[80:95], a[92:95], v[188:191], v[80:95]
    ds_read_b128 v[176:179], v197 offset:0
    v_mfma_f32_32x32x16_bf16 v[96:111], a[92:95], v[192:195], v[96:111]
    ds_read_b128 v[180:183], v197 offset:8704
    buffer_load_dwordx4 a[144:147], v200, s[16:19], s101 offen offset:0 sc1
    s_waitcnt lgkmcnt(3)
    s_waitcnt vmcnt(13)
    v_mfma_f32_16x16x32_bf16 v[112:115], a[96:99], v[160:163], v[112:115]
    ds_read_b128 v[184:187], v198 offset:64
    v_mfma_f32_32x32x16_bf16 v[80:95], a[96:99], v[164:167], v[80:95]
    ds_read_b128 v[188:191], v196 offset:64
    v_mfma_f32_32x32x16_bf16 v[96:111], a[96:99], v[168:171], v[96:111]
    ds_read_b128 v[192:195], v196 offset:8768
    buffer_load_dwordx4 a[148:151], v200, s[16:19], s101 offen offset:1024 sc1
    s_waitcnt lgkmcnt(3)
    s_waitcnt vmcnt(13)
    v_mfma_f32_16x16x32_bf16 v[112:115], a[100:103], v[172:175], v[112:115]
    ds_read_b128 v[160:163], v198 offset:96
    v_mfma_f32_32x32x16_bf16 v[80:95], a[100:103], v[176:179], v[80:95]
    ds_read_b128 v[164:167], v197 offset:64
    v_mfma_f32_32x32x16_bf16 v[96:111], a[100:103], v[180:183], v[96:111]
    ds_read_b128 v[168:171], v197 offset:8768
    buffer_load_dwordx4 a[152:155], v200, s[16:19], s101 offen offset:2048 sc1
    s_waitcnt lgkmcnt(3)
    s_waitcnt vmcnt(13)
    v_mfma_f32_16x16x32_bf16 v[112:115], a[104:107], v[184:187], v[112:115]
    ds_read_b128 v[172:175], v198 offset:128
    v_mfma_f32_32x32x16_bf16 v[80:95], a[104:107], v[188:191], v[80:95]
    ds_read_b128 v[176:179], v196 offset:128
    v_mfma_f32_32x32x16_bf16 v[96:111], a[104:107], v[192:195], v[96:111]
    ds_read_b128 v[180:183], v196 offset:8832
    buffer_load_dwordx4 a[156:159], v200, s[16:19], s101 offen offset:3072 sc1
    s_waitcnt lgkmcnt(3)
    s_waitcnt vmcnt(13)
    v_mfma_f32_16x16x32_bf16 v[112:115], a[108:111], v[160:163], v[112:115]
    ds_read_b128 v[184:187], v198 offset:160
    v_mfma_f32_32x32x16_bf16 v[80:95], a[108:111], v[164:167], v[80:95]
    ds_read_b128 v[188:191], v197 offset:128
    v_mfma_f32_32x32x16_bf16 v[96:111], a[108:111], v[168:171], v[96:111]
    ds_read_b128 v[192:195], v197 offset:8832
    s_add_u32 s101, s101, 4096
    s_lshl_b32 s25, s72, 5
    s_add_u32 s25, s25, 256
    s_sub_u32 s26, s25, 4
    s_max_i32 s26, s26, 0
    s_mul_i32 s27, s71, 1280
    s_mul_i32 s99, s25, 5120
    s_mul_i32 s100, s26, 5120
    s_mul_i32 s92, s24, 4352
    s_mul_i32 s93, s24, 544
    s_add_u32 s99, s99, s27
    s_add_u32 s100, s100, s27
    s_waitcnt lgkmcnt(3)
    s_waitcnt vmcnt(12)
    v_mfma_f32_16x16x32_bf16 v[112:115], a[112:115], v[172:175], v[112:115]
    ds_read_b128 v[160:163], v198 offset:192
    v_mfma_f32_32x32x16_bf16 v[80:95], a[112:115], v[176:179], v[80:95]
    ds_read_b128 v[164:167], v196 offset:192
    v_mfma_f32_32x32x16_bf16 v[96:111], a[112:115], v[180:183], v[96:111]
    ds_read_b128 v[168:171], v196 offset:8896
    s_waitcnt lgkmcnt(3)
    s_waitcnt vmcnt(11)
    v_mfma_f32_16x16x32_bf16 v[112:115], a[116:119], v[184:187], v[112:115]
    ds_read_b128 v[172:175], v198 offset:224
    v_mfma_f32_32x32x16_bf16 v[80:95], a[116:119], v[188:191], v[80:95]
    ds_read_b128 v[176:179], v197 offset:192
    v_mfma_f32_32x32x16_bf16 v[96:111], a[116:119], v[192:195], v[96:111]
    ds_read_b128 v[180:183], v197 offset:8896
    s_waitcnt vmcnt(4)
    v_cmp_gt_u32 vcc, 32, v7
    s_nop 0
    s_and_b64 vcc, vcc, s[50:51]
    s_cbranch_scc1 ps_17
pc_19:
    s_barrier
    s_waitcnt lgkmcnt(3)
    v_mfma_f32_16x16x32_bf16 v[112:115], a[120:123], v[160:163], v[112:115]
    v_add_u32_e64 v198, v49, v198
    v_mfma_f32_32x32x16_bf16 v[80:95], a[120:123], v[164:167], v[80:95]
    v_add_u32 v196, 19584, v196
    v_add_u32 v197, 19584, v197
    s_lshl_b32 s31, s24, 7
    s_add_u32 s31, s31, 159744
    v_bfe_u32 v132, v1, 3, 1
    v_mfma_f32_32x32x16_bf16 v[96:111], a[120:123], v[168:171], v[96:111]
    ds_read_b128 v[184:187], v198 offset:0
    ds_read_b128 v[188:191], v196 offset:0
    s_lshl_b32 s98, s72, 5
    s_add_u32 s98, s98, 0
    s_sub_u32 s95, s98, 4
    s_max_i32 s95, s95, 0
    s_lshl_b32 s94, s98, 3
    s_lshl_b32 s95, s95, 3
    s_add_u32 s94, s94, 3440640
    s_add_u32 s95, s95, 3440640
    s_add_u32 s96, s94, 8192
    buffer_load_dwordx2 v[152:153], v47, s[16:19], s94 offen sc1
    v_lshrrev_b32 v133, 4, v1
    v_lshl_add_u32 v132, v132, 2, v133
    s_waitcnt lgkmcnt(2)
    v_mfma_f32_16x16x32_bf16 v[112:115], a[124:127], v[172:175], v[112:115]
    ds_read_b128 v[192:195], v198 offset:32
    v_mfma_f32_32x32x16_bf16 v[80:95], a[124:127], v[176:179], v[80:95]
    ds_read_b128 v[160:163], v197 offset:0
    v_lshl_add_u32 v132, v132, 4, s31
    v_lshrrev_b32 v133, 5, v1
    v_lshl_add_u32 v133, v133, 4, s31
    v_mfma_f32_32x32x16_bf16 v[96:111], a[124:127], v[180:183], v[96:111]
    buffer_load_dwordx2 v[154:155], v47, s[16:19], s96 offen sc1
    s_waitcnt lgkmcnt(2)
    v_mfma_f32_16x16x32_bf16 v[112:115], a[128:131], v[184:187], v[112:115]
    ds_read_b128 v[164:167], v198 offset:64
    v_mfma_f32_32x32x16_bf16 v[80:95], a[128:131], v[188:191], v[80:95]
    ds_read_b128 v[168:171], v196 offset:64
    s_waitcnt lgkmcnt(2)
    v_mfma_f32_16x16x32_bf16 v[112:115], a[132:135], v[192:195], v[112:115]
    ds_read_b128 v[172:175], v198 offset:96
    v_mfma_f32_32x32x16_bf16 v[80:95], a[132:135], v[160:163], v[80:95]
    ds_read_b128 v[176:179], v197 offset:64
    buffer_load_dwordx2 v[156:157], v48, s[16:19], s95 offen sc1
    s_waitcnt lgkmcnt(2)
    v_mfma_f32_16x16x32_bf16 v[112:115], a[136:139], v[164:167], v[112:115]
    ds_read_b128 v[180:183], v198 offset:128
    v_mfma_f32_32x32x16_bf16 v[80:95], a[136:139], v[168:171], v[80:95]
    ds_read_b128 v[184:187], v196 offset:128
    s_waitcnt lgkmcnt(2)
    v_mfma_f32_16x16x32_bf16 v[112:115], a[140:143], v[172:175], v[112:115]
    ds_read_b128 v[188:191], v198 offset:160
    v_mfma_f32_32x32x16_bf16 v[80:95], a[140:143], v[176:179], v[80:95]
    ds_read_b128 v[192:195], v197 offset:128
    s_add_u32 m0, s92, 36352
    s_nop 0
    buffer_load_dwordx4 v73, s[4:7], s99 offen offset:0  lds
    s_waitcnt lgkmcnt(2)
    s_waitcnt vmcnt(7)
    v_mfma_f32_16x16x32_bf16 v[112:115], a[144:147], v[180:183], v[112:115]
    ds_read_b128 v[160:163], v198 offset:192
    v_mfma_f32_32x32x16_bf16 v[80:95], a[144:147], v[184:187], v[80:95]
    ds_read_b128 v[164:167], v196 offset:192
    s_waitcnt lgkmcnt(2)
    s_waitcnt vmcnt(6)
    v_mfma_f32_16x16x32_bf16 v[112:115], a[148:151], v[188:191], v[112:115]
    ds_read_b128 v[168:171], v198 offset:224
    v_mfma_f32_32x32x16_bf16 v[80:95], a[148:151], v[192:195], v[80:95]
    ds_read_b128 v[172:175], v197 offset:192
    buffer_load_dwordx4 v74, s[4:7], s99 offen offset:1088  lds
    s_waitcnt lgkmcnt(2)
    s_waitcnt vmcnt(6)
    v_mfma_f32_16x16x32_bf16 v[112:115], a[152:155], v[160:163], v[112:115]
    ds_read_b128 v[176:179], v196 offset:8704
    v_mfma_f32_32x32x16_bf16 v[80:95], a[152:155], v[164:167], v[80:95]
    ds_read_b128 v[180:183], v197 offset:8704
    s_waitcnt lgkmcnt(2)
    s_waitcnt vmcnt(5)
    v_mfma_f32_16x16x32_bf16 v[112:115], a[156:159], v[168:171], v[112:115]
    ds_read_b128 v[184:187], v196 offset:8768
    v_mfma_f32_32x32x16_bf16 v[80:95], a[156:159], v[172:175], v[80:95]
    ds_read_b128 v[188:191], v197 offset:8768
    buffer_load_dwordx4 v75, s[4:7], s99 offen offset:2176  lds
    s_waitcnt lgkmcnt(2)
    v_mfma_f32_32x32x16_bf16 v[96:111], a[128:131], v[176:179], v[96:111]
    ds_read_b128 v[192:195], v196 offset:8832
    v_mfma_f32_32x32x16_bf16 v[96:111], a[132:135], v[180:183], v[96:111]
    ds_read_b128 v[160:163], v197 offset:8832
    buffer_load_dwordx4 v76, s[4:7], s99 offen offset:3264  lds
    s_mov_b32 exec_lo, 0x01010101
    s_mov_b32 exec_hi, 0x01010101
    ds_write_b128 v132, v[112:115]
    s_mov_b64 exec, -1
    s_waitcnt lgkmcnt(3)
    v_mfma_f32_32x32x16_bf16 v[96:111], a[136:139], v[184:187], v[96:111]
    ds_read_b128 v[164:167], v196 offset:8896
    ds_read_b128 v[24:27], v132
    ds_read_b128 v[8:11], v133 offset:0
    ds_read_b128 v[12:15], v133 offset:32
    ds_read_b128 v[16:19], v133 offset:64
    v_mfma_f32_32x32x16_bf16 v[96:111], a[140:143], v[188:191], v[96:111]
    ds_read_b128 v[168:171], v197 offset:8896
    s_add_u32 m0, s93, 53760
    s_add_u32 s99, s99, 256
    s_mov_b64 exec, s[80:81]
    buffer_load_dwordx4 v77, s[4:7], s100 offen  lds
    s_mov_b64 exec, -1
    s_add_u32 s100, s100, 256
    ds_read_b128 v[20:23], v133 offset:96
    s_waitcnt vmcnt(5) lgkmcnt(5)
    v_mul_f32 v148, v24, v157
    v_mfma_f32_32x32x16_bf16 v[96:111], a[144:147], v[192:195], v[96:111]
    v_mul_f32 v149, v25, v157
    v_mul_f32 v150, v26, v157
    v_mul_f32 v151, v27, v157
    s_waitcnt lgkmcnt(4)
    v_mul_f32 v116, v8, v153
    v_mul_f32 v117, v9, v153
    v_mfma_f32_32x32x16_bf16 v[96:111], a[148:151], v[160:163], v[96:111]
    v_mul_f32 v118, v10, v153
    v_mul_f32 v119, v11, v153
    s_waitcnt lgkmcnt(3)
    v_mul_f32 v120, v12, v153
    v_mul_f32 v121, v13, v153
    s_waitcnt lgkmcnt(1)
    v_mfma_f32_32x32x16_bf16 v[96:111], a[152:155], v[164:167], v[96:111]
    v_mul_f32 v122, v14, v153
    v_mul_f32 v123, v15, v153
    v_mul_f32 v124, v16, v153
    v_mul_f32 v125, v17, v153
    v_mul_f32_e64 v126, v18, v153
    v_mfma_f32_32x32x16_bf16 v[96:111], a[156:159], v[168:171], v[96:111]
    s_add_u32 m0, s92, 55936
    s_nop 0
    buffer_load_dwordx4 v73, s[4:7], s99 offen offset:0  lds
    v_mul_f32 v127, v19, v153
    s_waitcnt lgkmcnt(0)
    v_mul_f32 v128, v20, v153
    v_mul_f32 v129, v21, v153
    v_mul_f32 v130, v22, v153
    v_mul_f32_e64 v131, v23, v153
    v_fma_f32 v112, v112, v156, v148
    v_fma_f32 v113, v113, v156, v149
    v_fma_f32 v114, v114, v156, v150
    v_fma_f32 v115, v115, v156, v151
    v_cvt_pk_bf16_f32 v112, v112, v113
    v_cvt_pk_bf16_f32 v113, v114, v115
    v_fma_f32 v80, v80, v152, v116
    v_fma_f32 v81, v81, v152, v117
    v_fma_f32 v82, v82, v152, v118
    v_fma_f32 v83, v83, v152, v119
    v_cvt_pk_bf16_f32 v80, v80, v81
    v_cvt_pk_bf16_f32 v81, v82, v83
    ds_write_b64 v40, v[112:113] offset:0
    ds_write_b64 v38, v[80:81] offset:0
    v_fma_f32 v84, v84, v152, v120
    v_fma_f32 v85, v85, v152, v121
    v_fma_f32 v86, v86, v152, v122
    v_fma_f32 v87, v87, v152, v123
    v_cvt_pk_bf16_f32 v84, v84, v85
    v_cvt_pk_bf16_f32 v85, v86, v87
    v_fma_f32 v88, v88, v152, v124
    v_fma_f32 v89, v89, v152, v125
    v_fma_f32 v90, v90, v152, v126
    v_fma_f32 v91, v91, v152, v127
    v_cvt_pk_bf16_f32 v88, v88, v89
    v_cvt_pk_bf16_f32 v89, v90, v91
    ds_write_b64 v38, v[84:85] offset:6400
    ds_write_b64 v38, v[88:89] offset:12800
    v_fma_f32 v92, v92, v152, v128
    v_fma_f32 v93, v93, v152, v129
    v_fma_f32 v94, v94, v152, v130
    v_fma_f32 v95, v95, v152, v131
    v_cvt_pk_bf16_f32 v92, v92, v93
    v_cvt_pk_bf16_f32 v93, v94, v95
    ds_write_b64 v39, v[92:93] offset:0
    v_mul_f32 v132, v8, v155
    v_mul_f32 v133, v9, v155
    v_mul_f32 v134, v10, v155
    v_mul_f32 v135, v11, v155
    v_mul_f32 v136, v12, v155
    v_mul_f32 v137, v13, v155
    v_mul_f32 v138, v14, v155
    v_mul_f32 v139, v15, v155
    v_mul_f32 v140, v16, v155
    v_mul_f32 v141, v17, v155
    v_mul_f32 v142, v18, v155
    v_mul_f32 v143, v19, v155
    v_mul_f32 v144, v20, v155
    v_mul_f32 v145, v21, v155
    v_mul_f32 v146, v22, v155
    v_mul_f32 v147, v23, v155
    v_pk_fma_f32 v[96:97], v[96:97], v[154:155], v[132:133] op_sel_hi:[1,0,1]
    v_pk_fma_f32 v[98:99], v[98:99], v[154:155], v[134:135] op_sel_hi:[1,0,1]
    v_cvt_pk_bf16_f32 v96, v96, v97
    v_cvt_pk_bf16_f32 v97, v98, v99
    v_pk_fma_f32 v[100:101], v[100:101], v[154:155], v[136:137] op_sel_hi:[1,0,1]
    v_pk_fma_f32 v[102:103], v[102:103], v[154:155], v[138:139] op_sel_hi:[1,0,1]
    v_cvt_pk_bf16_f32 v100, v100, v101
    v_cvt_pk_bf16_f32 v101, v102, v103
    ds_write_b64 v38, v[96:97] offset:1600
    ds_write_b64 v38, v[100:101] offset:8000
    v_pk_fma_f32 v[104:105], v[104:105], v[154:155], v[140:141] op_sel_hi:[1,0,1]
    v_pk_fma_f32 v[106:107], v[106:107], v[154:155], v[142:143] op_sel_hi:[1,0,1]
    v_cvt_pk_bf16_f32 v104, v104, v105
    v_cvt_pk_bf16_f32 v105, v106, v107
    v_pk_fma_f32 v[108:109], v[108:109], v[154:155], v[144:145] op_sel_hi:[1,0,1]
    v_pk_fma_f32 v[110:111], v[110:111], v[154:155], v[146:147] op_sel_hi:[1,0,1]
    v_cvt_pk_bf16_f32 v108, v108, v109
    v_cvt_pk_bf16_f32 v109, v110, v111
    ds_write_b64 v38, v[104:105] offset:14400
    ds_write_b64 v39, v[108:109] offset:1600
    s_waitcnt lgkmcnt(0)
    s_barrier
    v_mov_b32 v94, 0
    v_mov_b32 v95, 0
    v_mov_b32 v98, 0
    v_mov_b32 v99, 0
    s_mov_b64 exec, 0xffff
    ds_read_b64 v[94:95], v42 offset:320
    ds_read_b64 v[98:99], v42 offset:640
    s_mov_b64 exec, -1
    s_nop 0
    ds_read_b64 v[92:93], v41 offset:320
    ds_read_b64 v[96:97], v41 offset:640
    ds_read_b64 v[84:85], v41 offset:6720
    ds_read_b64 v[86:87], v42 offset:6720
    ds_read_b64 v[80:81], v41 offset:6400
    ds_read_b64 v[82:83], v42 offset:6400
    ds_read_b64 v[88:89], v41 offset:7040
    ds_read_b64 v[90:91], v42 offset:7040
    ds_read_b64_tr_b16 v[106:107], v44 offset:0
    ds_read_b64_tr_b16 v[100:101], v43 offset:0
    ds_read_b64_tr_b16 v[108:109], v44 offset:320
    ds_read_b64_tr_b16 v[102:103], v43 offset:320
    buffer_load_dwordx4 v74, s[4:7], s99 offen offset:1088  lds
    ds_read_b64_tr_b16 v[110:111], v44 offset:640
    ds_read_b64_tr_b16 v[104:105], v43 offset:640
    v_mov_b32 v156, 0xf149f2ca
    v_cndmask_b32 v152, v32, v156, s[90:91]
    v_cndmask_b32 v153, v33, v156, s[90:91]
    v_cndmask_b32 v154, v34, v156, s[90:91]
    v_cndmask_b32 v155, v35, v156, s[90:91]
    s_mov_b32 s82, 0x3ea52b5c
    buffer_load_dwordx4 v75, s[4:7], s99 offen offset:2176  lds
    s_lshl_b32 s25, s98, 4
    s_add_u32 s25, s25, 4194304
    s_lshl_b32 s26, s98, 3
    s_add_u32 s26, s26, 4194304
    s_waitcnt lgkmcnt(10)
    v_mfma_f32_16x16x32_bf16 v[116:119], v[84:87], v[92:95], v[28:31]
    v_mfma_f32_16x16x32_bf16 v[120:123], v[84:87], v[96:99], v[32:35]
    s_waitcnt lgkmcnt(8)
    v_mfma_f32_16x16x32_bf16 v[112:115], v[80:83], v[92:95], v[152:155]
    s_waitcnt lgkmcnt(6)
    v_mfma_f32_16x16x32_bf16 v[124:127], v[88:91], v[96:99], v[28:31]
    buffer_load_dwordx4 v76, s[4:7], s99 offen offset:3264  lds
    s_nop 4
    v_max_f32 v112, v112, v116
    v_max_f32 v113, v113, v117
    v_max_f32 v114, v114, v118
    v_max_f32 v115, v115, v119
    v_max3_f32 v156, v112, v113, v114
    v_max_f32 v156, v156, v115
    v_max_f32 v120, v120, v124
    v_max_f32_e64 v121, v121, v125
    s_add_u32 m0, s93, 73344
    s_add_u32 s99, s99, 256
    s_mov_b64 exec, s[80:81]
    buffer_load_dwordx4 v77, s[4:7], s100 offen  lds
    s_mov_b64 exec, -1
    s_add_u32 s100, s100, 256
    v_max_f32 v122, v122, v126
    v_max_f32 v123, v123, v127
    v_max3_f32 v157, v120, v121, v122
    v_max_f32 v157, v157, v123
    s_nop 1
    v_permlane16_swap_b32 v156, v157
    v_max_f32 v156, v156, v157
    v_mov_b32 v157, v156
    s_nop 1
    v_permlane32_swap_b32 v156, v157
    s_add_u32 m0, s92, 75520
    s_nop 0
    buffer_load_dwordx4 v73, s[4:7], s99 offen offset:0  lds
    v_max_f32 v156, v156, v157
    v_mul_f32 v156, s82, v156
    v_mov_b32 v157, v156
    s_nop 1
    v_permlane16_swap_b32_e64 v156, v157
    v_fma_f32 v112, v112, s82, -v156
    v_fma_f32 v113, v113, s82, -v156
    v_fma_f32 v114, v114, s82, -v156
    v_fma_f32 v115, v115, s82, -v156
    buffer_load_dwordx4 v74, s[4:7], s99 offen offset:1088  lds
    v_exp_f32 v112, v112
    v_exp_f32 v113, v113
    v_exp_f32 v114, v114
    v_exp_f32 v115, v115
    v_cvt_pk_bf16_f32 v116, v112, v113
    v_cvt_pk_bf16_f32 v117, v114, v115
    v_bfi_b32 v128, v36, 0, v116
    v_and_b32_e64 v130, v36, v116
    buffer_load_dwordx4 v75, s[4:7], s99 offen offset:2176  lds
    v_bfi_b32 v129, v37, 0, v117
    v_and_b32 v131, v37, v117
    s_waitcnt lgkmcnt(3)
    s_nop 0
    v_mfma_f32_16x16x32_bf16 v[144:147], v[106:109], v[128:131], 0
    s_waitcnt lgkmcnt(2)
    v_mfma_f32_16x16x32_bf16 v[136:139], v[100:103], v[128:131], 0
    v_fma_f32 v120, v120, s82, -v157
    v_fma_f32 v121, v121, s82, -v157
    v_fma_f32 v122, v122, s82, -v157
    v_fma_f32 v123, v123, s82, -v157
    buffer_load_dwordx4 v76, s[4:7], s99 offen offset:3264  lds
    v_exp_f32 v120, v120
    v_exp_f32 v121, v121
    v_exp_f32 v122, v122
    v_exp_f32 v123, v123
    v_cvt_pk_bf16_f32 v124, v120, v121
    v_cvt_pk_bf16_f32 v125, v122, v123
    v_bfi_b32 v132, v36, 0, v124
    v_and_b32_e64 v134, v36, v124
    s_add_u32 m0, s93, 92928
    s_add_u32 s99, s99, 256
    s_mov_b64 exec, s[80:81]
    buffer_load_dwordx4 v77, s[4:7], s100 offen  lds
    s_mov_b64 exec, -1
    s_add_u32 s100, s100, 256
    v_bfi_b32 v133, v37, 0, v125
    v_and_b32 v135, v37, v125
    s_waitcnt lgkmcnt(1)
    s_nop 0
    v_mfma_f32_16x16x32_bf16 v[148:151], v[108:111], v[132:135], 0
    s_waitcnt lgkmcnt(0)
    v_mfma_f32_16x16x32_bf16 v[140:143], v[102:105], v[132:135], 0
    v_mov_b32 v158, v144
    s_nop 1
    v_permlane16_swap_b32 v144, v158
    v_rcp_f32 v158, v158
    s_nop 0
    v_pk_mul_f32 v[136:137], v[136:137], v[158:159] op_sel_hi:[1,0]
    s_lshl_b32 s97, s73, 2
    s_add_u32 s97, s97, s24
    s_nop 0
    s_mul_i32 s97, s97, 25600
    s_add_u32 s97, s97, 2621440
    buffer_load_dwordx4 a[160:163], v58, s[16:19], s97 offen offset:0 sc1
    v_pk_mul_f32 v[138:139], v[138:139], v[158:159] op_sel_hi:[1,0]
    v_pk_mul_f32 v[144:145], v[144:145], v[158:159] op_sel_hi:[1,0]
    v_pk_mul_f32 v[146:147], v[146:147], v[158:159] op_sel_hi:[1,0]
    v_cvt_pk_bf16_f32 v112, v136, v137
    v_cvt_pk_bf16_f32 v116, v144, v145
    v_cvt_pk_bf16_f32 v113, v138, v139
    v_cvt_pk_bf16_f32 v117, v146, v147
    v_mov_b32 v160, v148
    buffer_load_dwordx4 a[164:167], v58, s[16:19], s97 offen offset:1024 sc1
    s_nop 0
    v_permlane16_swap_b32 v148, v160
    v_rcp_f32_e64 v160, v160
    s_nop 0
    v_pk_mul_f32 v[140:141], v[140:141], v[160:161] op_sel_hi:[1,0]
    v_pk_mul_f32 v[142:143], v[142:143], v[160:161] op_sel_hi:[1,0]
    v_pk_mul_f32 v[148:149], v[148:149], v[160:161] op_sel_hi:[1,0]
    v_pk_mul_f32 v[150:151], v[150:151], v[160:161] op_sel_hi:[1,0]
    v_cvt_pk_bf16_f32 v114, v140, v141
    v_cvt_pk_bf16_f32 v118, v148, v149
    buffer_load_dwordx4 a[168:171], v58, s[16:19], s97 offen offset:2048 sc1
    v_cvt_pk_bf16_f32 v115, v142, v143
    v_cvt_pk_bf16_f32 v119, v150, v151
    v_permlane16_swap_b32 v112, v114
    v_permlane16_swap_b32 v113, v115
    v_permlane16_swap_b32 v116, v118
    v_permlane16_swap_b32 v117, v119
    buffer_store_dwordx4 v[112:115], v45, s[16:19], s25 offen sc1
    s_mov_b64 exec, s[80:81]
    buffer_store_dwordx2 v[116:117], v46, s[16:19], s26 offen sc1
    s_mov_b64 exec, -1
    buffer_load_dwordx4 a[172:175], v58, s[16:19], s97 offen offset:3072 sc1
    s_add_u32 s97, s97, 4096
    buffer_load_dwordx4 a[176:179], v58, s[16:19], s97 offen offset:0 sc1
    v_add_u32 v196, 36352, v78
    v_mov_b32 v198, v79
    v_xor_b32 v197, 32, v196
    s_waitcnt vmcnt(17)
    s_barrier
    ds_read_b128 v[160:163], v198 offset:0
    ds_read_b128 v[164:167], v196 offset:0
    ds_read_b128 v[168:171], v196 offset:8704
    ds_read_b128 v[172:175], v198 offset:32
    ds_read_b128 v[176:179], v197 offset:0
    ds_read_b128 v[180:183], v197 offset:8704
    s_waitcnt lgkmcnt(3)
    v_mfma_f32_16x16x32_bf16 v[112:115], a[0:3], v[160:163], 0
    ds_read_b128 v[184:187], v198 offset:64
    v_mfma_f32_32x32x16_bf16 v[80:95], a[0:3], v[164:167], 0
    ds_read_b128 v[188:191], v196 offset:64
    v_mfma_f32_32x32x16_bf16 v[96:111], a[0:3], v[168:171], 0
    ds_read_b128 v[192:195], v196 offset:8768
    s_add_u32 m0, s92, 95104
    s_nop 0
    buffer_load_dwordx4 v73, s[4:7], s99 offen offset:0  lds
    s_waitcnt lgkmcnt(3)
    v_mfma_f32_16x16x32_bf16 v[112:115], a[4:7], v[172:175], v[112:115]
    ds_read_b128 v[160:163], v198 offset:96
    v_mfma_f32_32x32x16_bf16 v[80:95], a[4:7], v[176:179], v[80:95]
    ds_read_b128 v[164:167], v197 offset:64
    v_mfma_f32_32x32x16_bf16 v[96:111], a[4:7], v[180:183], v[96:111]
    ds_read_b128 v[168:171], v197 offset:8768
    buffer_load_dwordx4 v74, s[4:7], s99 offen offset:1088  lds
    s_waitcnt lgkmcnt(3)
    v_mfma_f32_16x16x32_bf16 v[112:115], a[8:11], v[184:187], v[112:115]
    ds_read_b128 v[172:175], v198 offset:128
    v_mfma_f32_32x32x16_bf16 v[80:95], a[8:11], v[188:191], v[80:95]
    ds_read_b128 v[176:179], v196 offset:128
    v_mfma_f32_32x32x16_bf16 v[96:111], a[8:11], v[192:195], v[96:111]
    ds_read_b128 v[180:183], v196 offset:8832
    buffer_load_dwordx4 v75, s[4:7], s99 offen offset:2176  lds
    s_waitcnt lgkmcnt(3)
    v_mfma_f32_16x16x32_bf16 v[112:115], a[12:15], v[160:163], v[112:115]
    ds_read_b128 v[184:187], v198 offset:160
    v_mfma_f32_32x32x16_bf16 v[80:95], a[12:15], v[164:167], v[80:95]
    ds_read_b128 v[188:191], v197 offset:128
    v_mfma_f32_32x32x16_bf16 v[96:111], a[12:15], v[168:171], v[96:111]
    ds_read_b128 v[192:195], v197 offset:8832
    buffer_load_dwordx4 v76, s[4:7], s99 offen offset:3264  lds
    s_waitcnt lgkmcnt(3)
    v_mfma_f32_16x16x32_bf16 v[112:115], a[16:19], v[172:175], v[112:115]
    ds_read_b128 v[160:163], v198 offset:192
    v_mfma_f32_32x32x16_bf16 v[80:95], a[16:19], v[176:179], v[80:95]
    ds_read_b128 v[164:167], v196 offset:192
    v_mfma_f32_32x32x16_bf16 v[96:111], a[16:19], v[180:183], v[96:111]
    ds_read_b128 v[168:171], v196 offset:8896
    s_add_u32 m0, s93, 112512
    s_add_u32 s99, s99, 256
    s_mov_b64 exec, s[80:81]
    buffer_load_dwordx4 v77, s[4:7], s100 offen  lds
    s_mov_b64 exec, -1
    s_add_u32 s100, s100, 256
    s_waitcnt lgkmcnt(3)
    v_mfma_f32_16x16x32_bf16 v[112:115], a[20:23], v[184:187], v[112:115]
    ds_read_b128 v[172:175], v198 offset:224
    v_mfma_f32_32x32x16_bf16 v[80:95], a[20:23], v[188:191], v[80:95]
    ds_read_b128 v[176:179], v197 offset:192
    v_mfma_f32_32x32x16_bf16 v[96:111], a[20:23], v[192:195], v[96:111]
    ds_read_b128 v[180:183], v197 offset:8896
    s_add_u32 m0, s92, 114688
    s_nop 0
    buffer_load_dwordx4 v73, s[4:7], s99 offen offset:0  lds
    s_waitcnt vmcnt(18)
    s_barrier
    s_waitcnt lgkmcnt(3)
    v_mfma_f32_16x16x32_bf16 v[112:115], a[24:27], v[160:163], v[112:115]
    v_add_u32 v198, v49, v198
    v_mfma_f32_32x32x16_bf16 v[80:95], a[24:27], v[164:167], v[80:95]
    v_add_u32 v196, 19584, v196
    v_add_u32 v197, 19584, v197
    ds_read_b128 v[184:187], v198 offset:0
    v_mfma_f32_32x32x16_bf16 v[96:111], a[24:27], v[168:171], v[96:111]
    ds_read_b128 v[188:191], v196 offset:0
    ds_read_b128 v[192:195], v196 offset:8704
    buffer_load_dwordx4 v74, s[4:7], s99 offen offset:1088  lds
    s_waitcnt lgkmcnt(3)
    v_mfma_f32_16x16x32_bf16 v[112:115], a[28:31], v[172:175], v[112:115]
    ds_read_b128 v[160:163], v198 offset:32
    v_mfma_f32_32x32x16_bf16 v[80:95], a[28:31], v[176:179], v[80:95]
    ds_read_b128 v[164:167], v197 offset:0
    v_mfma_f32_32x32x16_bf16 v[96:111], a[28:31], v[180:183], v[96:111]
    ds_read_b128 v[168:171], v197 offset:8704
    buffer_load_dwordx4 v75, s[4:7], s99 offen offset:2176  lds
    s_waitcnt lgkmcnt(3)
    v_mfma_f32_16x16x32_bf16 v[112:115], a[32:35], v[184:187], v[112:115]
    ds_read_b128 v[172:175], v198 offset:64
    v_mfma_f32_32x32x16_bf16 v[80:95], a[32:35], v[188:191], v[80:95]
    ds_read_b128 v[176:179], v196 offset:64
    v_mfma_f32_32x32x16_bf16 v[96:111], a[32:35], v[192:195], v[96:111]
    ds_read_b128 v[180:183], v196 offset:8768
    buffer_load_dwordx4 v76, s[4:7], s99 offen offset:3264  lds
    s_waitcnt lgkmcnt(3)
    v_mfma_f32_16x16x32_bf16 v[112:115], a[36:39], v[160:163], v[112:115]
    ds_read_b128 v[184:187], v198 offset:96
    v_mfma_f32_32x32x16_bf16 v[80:95], a[36:39], v[164:167], v[80:95]
    ds_read_b128 v[188:191], v197 offset:64
    v_mfma_f32_32x32x16_bf16 v[96:111], a[36:39], v[168:171], v[96:111]
    ds_read_b128 v[192:195], v197 offset:8768
    s_add_u32 m0, s93, 132096
    s_add_u32 s99, s99, 256
    s_mov_b64 exec, s[80:81]
    buffer_load_dwordx4 v77, s[4:7], s100 offen  lds
    s_mov_b64 exec, -1
    s_add_u32 s100, s100, 256
    s_waitcnt lgkmcnt(3)
    v_mfma_f32_16x16x32_bf16 v[112:115], a[40:43], v[172:175], v[112:115]
    ds_read_b128 v[160:163], v198 offset:128
    v_mfma_f32_32x32x16_bf16 v[80:95], a[40:43], v[176:179], v[80:95]
    ds_read_b128 v[164:167], v196 offset:128
    s_lshl_b32 s25, s24, 6
    s_and_b32 s35, s74, 3
    s_lshl_b32 s35, s35, 13
    s_add_u32 s35, s35, s25
    v_mfma_f32_32x32x16_bf16 v[96:111], a[40:43], v[180:183], v[96:111]
    ds_read_b128 v[168:171], v196 offset:8832
    s_lshl_b32 s98, s72, 5
    s_add_u32 s98, s98, 256
    s_sub_u32 s95, s98, 4
    s_max_i32 s95, s95, 0
    s_lshl_b32 s94, s98, 3
    s_lshl_b32 s95, s95, 3
    s_add_u32 s94, s94, 3440640
    s_add_u32 s95, s95, 3440640
    s_add_u32 s96, s94, 8192
    buffer_load_dwordx2 v[152:153], v47, s[16:19], s94 offen sc1
    s_waitcnt lgkmcnt(3)
    v_mfma_f32_16x16x32_bf16 v[112:115], a[44:47], v[184:187], v[112:115]
    ds_read_b128 v[172:175], v198 offset:160
    v_mfma_f32_32x32x16_bf16 v[80:95], a[44:47], v[188:191], v[80:95]
    ds_read_b128 v[176:179], v197 offset:128
    s_lshr_b32 s25, s74, 4
    s_lshl_b32 s25, s25, 11
    s_add_u32 s35, s35, s25
    s_and_b32 s25, s74, 12
    v_mfma_f32_32x32x16_bf16 v[96:111], a[44:47], v[192:195], v[96:111]
    ds_read_b128 v[180:183], v197 offset:8832
    buffer_load_dwordx2 v[154:155], v47, s[16:19], s96 offen sc1
    s_lshl_b32 s25, s25, 6
    s_add_u32 s35, s35, s25
    s_waitcnt lgkmcnt(3)
    v_mfma_f32_16x16x32_bf16 v[112:115], a[48:51], v[160:163], v[112:115]
    ds_read_b128 v[184:187], v198 offset:192
    v_mfma_f32_32x32x16_bf16 v[80:95], a[48:51], v[164:167], v[80:95]
    ds_read_b128 v[188:191], v196 offset:192
    s_mul_i32 s36, s73, 20
    s_add_u32 s36, s36, s24
    s_add_u32 s36, s36, 16
    s_lshl_b32 s36, s36, 14
    v_mfma_f32_32x32x16_bf16 v[96:111], a[48:51], v[168:171], v[96:111]
    ds_read_b128 v[192:195], v196 offset:8896
    buffer_load_dwordx2 v[156:157], v48, s[16:19], s95 offen sc1
    v_add_u32 v199, 36352, v58
    s_lshl_b32 s32, s24, 11
    s_waitcnt lgkmcnt(3)
    v_mfma_f32_16x16x32_bf16 v[112:115], a[52:55], v[172:175], v[112:115]
    ds_read_b128 v[160:163], v198 offset:224
    v_mfma_f32_32x32x16_bf16 v[80:95], a[52:55], v[176:179], v[80:95]
    ds_read_b128 v[164:167], v197 offset:192
    v_add_u32 v203, s32, v199
    s_add_u32 s32, s24, 1
    s_and_b32 s32, s32, 3
    s_mul_i32 s32, s32, 6144
    v_mfma_f32_32x32x16_bf16 v[96:111], a[52:55], v[180:183], v[96:111]
    ds_read_b128 v[168:171], v197 offset:8896
    buffer_load_dwordx4 a[180:183], v58, s[16:19], s97 offen offset:1024 sc1
    v_add_u32 v200, s32, v199
    s_add_u32 s32, s24, 2
    s_waitcnt vmcnt(21)
    s_barrier
    s_waitcnt lgkmcnt(3)
    v_mfma_f32_16x16x32_bf16 v[112:115], a[56:59], v[184:187], v[112:115]
    v_add_u32 v198, v49, v198
    v_mfma_f32_32x32x16_bf16 v[80:95], a[56:59], v[188:191], v[80:95]
    v_add_u32 v196, 19584, v196
    v_add_u32 v197, 19584, v197
    ds_read_b128 v[172:175], v198 offset:0
    s_and_b32 s32, s32, 3
    s_mul_i32 s32, s32, 6144
    v_mfma_f32_32x32x16_bf16 v[96:111], a[56:59], v[192:195], v[96:111]
    ds_read_b128 v[176:179], v196 offset:0
    ds_read_b128 v[180:183], v196 offset:8704
    buffer_load_dwordx4 a[184:187], v58, s[16:19], s97 offen offset:2048 sc1
    v_add_u32_e64 v201, s32, v199
    s_waitcnt lgkmcnt(3)
    v_mfma_f32_16x16x32_bf16 v[112:115], a[60:63], v[160:163], v[112:115]
    ds_read_b128 v[184:187], v198 offset:32
    v_mfma_f32_32x32x16_bf16 v[80:95], a[60:63], v[164:167], v[80:95]
    ds_read_b128 v[188:191], v197 offset:0
    s_add_u32 s32, s24, 3
    s_and_b32 s32, s32, 3
    s_mul_i32 s32, s32, 6144
    v_add_u32_e64 v202, s32, v199
    v_mfma_f32_32x32x16_bf16 v[96:111], a[60:63], v[168:171], v[96:111]
    ds_read_b128 v[192:195], v197 offset:8704
    buffer_load_dwordx4 a[188:191], v58, s[16:19], s97 offen offset:3072 sc1
    s_mul_i32 s32, s24, 6144
    v_add_u32 v204, s32, v199
    s_waitcnt lgkmcnt(3)
    v_mfma_f32_16x16x32_bf16 v[112:115], a[64:67], v[172:175], v[112:115]
    ds_read_b128 v[160:163], v198 offset:64
    v_mfma_f32_32x32x16_bf16 v[80:95], a[64:67], v[176:179], v[80:95]
    ds_read_b128 v[164:167], v196 offset:64
    s_lshl_b32 s32, s24, 8
    s_add_u32 s32, s32, 36352
    v_and_b32 v214, 15, v1
    v_lshl_add_u32 v206, v214, 4, s32
    v_mfma_f32_32x32x16_bf16 v[96:111], a[64:67], v[180:183], v[96:111]
    ds_read_b128 v[168:171], v196 offset:8768
    s_add_u32 s97, s97, 4096
    buffer_load_dwordx4 a[192:195], v58, s[16:19], s97 offen offset:0 sc1
    v_lshrrev_b32 v215, 5, v1
    s_waitcnt lgkmcnt(3)
    v_mfma_f32_16x16x32_bf16 v[112:115], a[68:71], v[184:187], v[112:115]
    ds_read_b128 v[172:175], v198 offset:96
    v_mfma_f32_32x32x16_bf16 v[80:95], a[68:71], v[188:191], v[80:95]
    ds_read_b128 v[176:179], v197 offset:64
    v_lshl_add_u32 v205, v215, 10, v206
    v_bfe_u32 v215, v1, 4, 1
    v_lshl_add_u32 v205, v215, 3, v205
    v_lshlrev_b32_e64 v214, 2, v214
    v_mfma_f32_32x32x16_bf16 v[96:111], a[68:71], v[192:195], v[96:111]
    ds_read_b128 v[180:183], v197 offset:8768
    buffer_load_dwordx4 a[196:199], v58, s[16:19], s97 offen offset:1024 sc1
    v_lshl_add_u32 v214, v215, 10, v214
    s_lshl_b32 s32, s24, 6
    s_waitcnt lgkmcnt(3)
    v_mfma_f32_16x16x32_bf16 v[112:115], a[72:75], v[160:163], v[112:115]
    ds_read_b128 v[184:187], v198 offset:128
    v_mfma_f32_32x32x16_bf16 v[80:95], a[72:75], v[164:167], v[80:95]
    ds_read_b128 v[188:191], v196 offset:128
    v_lshl_add_u32 v207, v215, 3, s32
    v_and_b32 v215, 12, v1
    v_lshl_add_u32 v207, v215, 2, v207
    v_and_b32 v215, 2, v1
    v_mfma_f32_32x32x16_bf16 v[96:111], a[72:75], v[168:171], v[96:111]
    ds_read_b128 v[192:195], v196 offset:8832
    buffer_load_dwordx4 a[200:203], v58, s[16:19], s97 offen offset:2048 sc1
    v_lshl_add_u32 v207, v215, 1, v207
    v_add_u32 v207, 69120, v207
    s_waitcnt lgkmcnt(3)
    v_mfma_f32_16x16x32_bf16 v[112:115], a[76:79], v[172:175], v[112:115]
    ds_read_b128 v[160:163], v198 offset:160
    v_mfma_f32_32x32x16_bf16 v[80:95], a[76:79], v[176:179], v[80:95]
    ds_read_b128 v[164:167], v197 offset:128
    v_lshrrev_b32 v215, 4, v1
    v_lshl_add_u32 v206, v215, 2, v206
    v_mov_b32 v215, 0x3f803f80
    v_mfma_f32_32x32x16_bf16 v[96:111], a[76:79], v[180:183], v[96:111]
    ds_read_b128 v[168:171], v197 offset:8832
    buffer_load_dwordx4 a[204:207], v58, s[16:19], s97 offen offset:3072 sc1
    s_waitcnt lgkmcnt(3)
    v_mfma_f32_16x16x32_bf16 v[112:115], a[80:83], v[184:187], v[112:115]
    ds_read_b128 v[172:175], v198 offset:192
    v_mfma_f32_32x32x16_bf16 v[80:95], a[80:83], v[188:191], v[80:95]
    ds_read_b128 v[176:179], v196 offset:192
    v_mfma_f32_32x32x16_bf16 v[96:111], a[80:83], v[192:195], v[96:111]
    ds_read_b128 v[180:183], v196 offset:8896
    s_add_u32 s97, s97, 4096
    buffer_load_dwordx4 a[208:211], v58, s[16:19], s97 offen offset:0 sc1
    s_waitcnt lgkmcnt(3)
    v_mfma_f32_16x16x32_bf16 v[112:115], a[84:87], v[160:163], v[112:115]
    ds_read_b128 v[184:187], v198 offset:224
    v_mfma_f32_32x32x16_bf16 v[80:95], a[84:87], v[164:167], v[80:95]
    ds_read_b128 v[188:191], v197 offset:192
    v_mfma_f32_32x32x16_bf16 v[96:111], a[84:87], v[168:171], v[96:111]
    ds_read_b128 v[192:195], v197 offset:8896
    buffer_load_dwordx4 a[212:215], v58, s[16:19], s97 offen offset:1024 sc1
    s_waitcnt vmcnt(17)
    s_barrier
    s_waitcnt lgkmcnt(3)
    v_mfma_f32_16x16x32_bf16 v[112:115], a[88:91], v[172:175], v[112:115]
    v_add_u32 v198, v49, v198
    v_mfma_f32_32x32x16_bf16 v[80:95], a[88:91], v[176:179], v[80:95]
    v_add_u32 v196, 19584, v196
    v_add_u32 v197, 19584, v197
    ds_read_b128 v[160:163], v198 offset:0
    v_mfma_f32_32x32x16_bf16 v[96:111], a[88:91], v[180:183], v[96:111]
    ds_read_b128 v[164:167], v196 offset:0
    ds_read_b128 v[168:171], v196 offset:8704
    buffer_load_dwordx4 a[216:219], v58, s[16:19], s97 offen offset:2048 sc1
    s_waitcnt lgkmcnt(3)
    v_mfma_f32_16x16x32_bf16 v[112:115], a[92:95], v[184:187], v[112:115]
    ds_read_b128 v[172:175], v198 offset:32
    v_mfma_f32_32x32x16_bf16 v[80:95], a[92:95], v[188:191], v[80:95]
    ds_read_b128 v[176:179], v197 offset:0
    v_mfma_f32_32x32x16_bf16 v[96:111], a[92:95], v[192:195], v[96:111]
    ds_read_b128 v[180:183], v197 offset:8704
    buffer_load_dwordx4 a[220:223], v58, s[16:19], s97 offen offset:3072 sc1
    s_waitcnt lgkmcnt(3)
    v_mfma_f32_16x16x32_bf16 v[112:115], a[96:99], v[160:163], v[112:115]
    ds_read_b128 v[184:187], v198 offset:64
    v_mfma_f32_32x32x16_bf16 v[80:95], a[96:99], v[164:167], v[80:95]
    ds_read_b128 v[188:191], v196 offset:64
    v_mfma_f32_32x32x16_bf16 v[96:111], a[96:99], v[168:171], v[96:111]
    ds_read_b128 v[192:195], v196 offset:8768
    s_add_u32 s97, s97, 4096
    buffer_load_dwordx4 a[224:227], v58, s[16:19], s97 offen offset:0 sc1
    s_waitcnt lgkmcnt(3)
    v_mfma_f32_16x16x32_bf16 v[112:115], a[100:103], v[172:175], v[112:115]
    ds_read_b128 v[160:163], v198 offset:96
    v_mfma_f32_32x32x16_bf16 v[80:95], a[100:103], v[176:179], v[80:95]
    ds_read_b128 v[164:167], v197 offset:64
    v_mfma_f32_32x32x16_bf16 v[96:111], a[100:103], v[180:183], v[96:111]
    ds_read_b128 v[168:171], v197 offset:8768
    buffer_load_dwordx4 a[228:231], v58, s[16:19], s97 offen offset:1024 sc1
    s_waitcnt lgkmcnt(3)
    v_mfma_f32_16x16x32_bf16 v[112:115], a[104:107], v[184:187], v[112:115]
    ds_read_b128 v[172:175], v198 offset:128
    v_mfma_f32_32x32x16_bf16 v[80:95], a[104:107], v[188:191], v[80:95]
    ds_read_b128 v[176:179], v196 offset:128
    v_mfma_f32_32x32x16_bf16 v[96:111], a[104:107], v[192:195], v[96:111]
    ds_read_b128 v[180:183], v196 offset:8832
    buffer_load_dwordx4 a[232:235], v58, s[16:19], s97 offen offset:2048 sc1
    s_waitcnt lgkmcnt(3)
    v_mfma_f32_16x16x32_bf16 v[112:115], a[108:111], v[160:163], v[112:115]
    ds_read_b128 v[184:187], v198 offset:160
    v_mfma_f32_32x32x16_bf16 v[80:95], a[108:111], v[164:167], v[80:95]
    ds_read_b128 v[188:191], v197 offset:128
    v_mfma_f32_32x32x16_bf16 v[96:111], a[108:111], v[168:171], v[96:111]
    ds_read_b128 v[192:195], v197 offset:8832
    buffer_load_dwordx4 a[236:239], v58, s[16:19], s97 offen offset:3072 sc1
    s_waitcnt lgkmcnt(3)
    v_mfma_f32_16x16x32_bf16 v[112:115], a[112:115], v[172:175], v[112:115]
    ds_read_b128 v[160:163], v198 offset:192
    v_mfma_f32_32x32x16_bf16 v[80:95], a[112:115], v[176:179], v[80:95]
    ds_read_b128 v[164:167], v196 offset:192
    v_mfma_f32_32x32x16_bf16 v[96:111], a[112:115], v[180:183], v[96:111]
    ds_read_b128 v[168:171], v196 offset:8896
    s_add_u32 s97, s97, 4096
    buffer_load_dwordx4 a[240:243], v58, s[16:19], s97 offen offset:0 sc1
    s_waitcnt lgkmcnt(3)
    v_mfma_f32_16x16x32_bf16 v[112:115], a[116:119], v[184:187], v[112:115]
    ds_read_b128 v[172:175], v198 offset:224
    v_mfma_f32_32x32x16_bf16 v[80:95], a[116:119], v[188:191], v[80:95]
    ds_read_b128 v[176:179], v197 offset:192
    v_mfma_f32_32x32x16_bf16 v[96:111], a[116:119], v[192:195], v[96:111]
    ds_read_b128 v[180:183], v197 offset:8896
    buffer_load_dwordx4 a[244:247], v58, s[16:19], s97 offen offset:1024 sc1
    s_waitcnt vmcnt(20)
    s_barrier
    s_waitcnt lgkmcnt(3)
    v_mfma_f32_16x16x32_bf16 v[112:115], a[120:123], v[160:163], v[112:115]
    v_add_u32_e64 v198, v49, v198
    v_mfma_f32_32x32x16_bf16 v[80:95], a[120:123], v[164:167], v[80:95]
    v_add_u32 v196, 19584, v196
    v_add_u32 v197, 19584, v197
    s_waitcnt vmcnt(17)
    v_mul_f32 v148, v24, v157
    v_mul_f32 v149, v25, v157
    v_mul_f32 v150, v26, v157
    v_mfma_f32_32x32x16_bf16 v[96:111], a[120:123], v[168:171], v[96:111]
    ds_read_b128 v[184:187], v198 offset:0
    ds_read_b128 v[188:191], v196 offset:0
    buffer_load_dwordx4 a[248:251], v58, s[16:19], s97 offen offset:2048 sc1
    v_mul_f32 v151, v27, v157
    v_mul_f32_e64 v116, v8, v153
    s_waitcnt lgkmcnt(2)
    v_mfma_f32_16x16x32_bf16 v[112:115], a[124:127], v[172:175], v[112:115]
    ds_read_b128 v[192:195], v198 offset:32
    v_mfma_f32_32x32x16_bf16 v[80:95], a[124:127], v[176:179], v[80:95]
    ds_read_b128 v[160:163], v197 offset:0
    v_mul_f32 v117, v9, v153
    v_mul_f32 v118, v10, v153
    v_mul_f32 v119, v11, v153
    v_mul_f32 v120, v12, v153
    v_mfma_f32_32x32x16_bf16 v[96:111], a[124:127], v[180:183], v[96:111]
    buffer_load_dwordx4 a[252:255], v58, s[16:19], s97 offen offset:3072 sc1
    v_mul_f32 v121, v13, v153
    v_mul_f32 v122, v14, v153
    v_mul_f32 v123, v15, v153
    s_waitcnt lgkmcnt(2)
    v_mfma_f32_16x16x32_bf16 v[112:115], a[128:131], v[184:187], v[112:115]
    ds_read_b128 v[164:167], v198 offset:64
    v_mfma_f32_32x32x16_bf16 v[80:95], a[128:131], v[188:191], v[80:95]
    ds_read_b128 v[168:171], v196 offset:64
    v_mul_f32 v124, v16, v153
    v_mul_f32 v125, v17, v153
    v_mul_f32 v126, v18, v153
    s_waitcnt lgkmcnt(2)
    v_mfma_f32_16x16x32_bf16 v[112:115], a[132:135], v[192:195], v[112:115]
    ds_read_b128 v[172:175], v198 offset:96
    v_mfma_f32_32x32x16_bf16 v[80:95], a[132:135], v[160:163], v[80:95]
    ds_read_b128 v[176:179], v197 offset:64
    s_add_u32 s97, s97, 4096
    buffer_load_dwordx4 v[52:55], v58, s[16:19], s97 offen offset:0 sc1
    v_mul_f32 v127, v19, v153
    v_mul_f32_e64 v128, v20, v153
    s_waitcnt lgkmcnt(2)
    v_mfma_f32_16x16x32_bf16 v[112:115], a[136:139], v[164:167], v[112:115]
    ds_read_b128 v[180:183], v198 offset:128
    v_mfma_f32_32x32x16_bf16 v[80:95], a[136:139], v[168:171], v[80:95]
    ds_read_b128 v[184:187], v196 offset:128
    v_mul_f32 v129, v21, v153
    v_mul_f32 v130, v22, v153
    v_mul_f32 v131, v23, v153
    s_waitcnt lgkmcnt(2)
    v_mfma_f32_16x16x32_bf16 v[112:115], a[140:143], v[172:175], v[112:115]
    ds_read_b128 v[188:191], v198 offset:160
    v_mfma_f32_32x32x16_bf16 v[80:95], a[140:143], v[176:179], v[80:95]
    ds_read_b128 v[192:195], v197 offset:128
    s_mov_b32 s96, 4194304
    buffer_load_dwordx4 v[216:219], v56, s[16:19], s96 offen offset:0 sc1
    v_mul_f32 v132, v8, v155
    v_mul_f32_e64 v133, v9, v155
    s_waitcnt lgkmcnt(2)
    v_mfma_f32_16x16x32_bf16 v[112:115], a[144:147], v[180:183], v[112:115]
    ds_read_b128 v[160:163], v198 offset:192
    v_mfma_f32_32x32x16_bf16 v[80:95], a[144:147], v[184:187], v[80:95]
    ds_read_b128 v[164:167], v196 offset:192
    v_mul_f32 v134, v10, v155
    v_mul_f32 v135, v11, v155
    v_mul_f32 v136, v12, v155
    s_waitcnt lgkmcnt(2)
    v_mfma_f32_16x16x32_bf16 v[112:115], a[148:151], v[188:191], v[112:115]
    ds_read_b128 v[168:171], v198 offset:224
    v_mfma_f32_32x32x16_bf16 v[80:95], a[148:151], v[192:195], v[80:95]
    ds_read_b128 v[172:175], v197 offset:192
    buffer_load_dwordx4 v[220:223], v56, s[16:19], s96 offen offset:256 sc1
    v_mul_f32 v137, v13, v155
    v_mul_f32_e64 v138, v14, v155
    s_waitcnt lgkmcnt(2)
    v_mfma_f32_16x16x32_bf16 v[112:115], a[152:155], v[160:163], v[112:115]
    ds_read_b128 v[176:179], v196 offset:8704
    v_mfma_f32_32x32x16_bf16 v[80:95], a[152:155], v[164:167], v[80:95]
    ds_read_b128 v[180:183], v197 offset:8704
    v_mul_f32 v139, v15, v155
    v_mul_f32 v140, v16, v155
    v_mul_f32 v141, v17, v155
    s_waitcnt lgkmcnt(2)
    v_mfma_f32_16x16x32_bf16 v[112:115], a[156:159], v[168:171], v[112:115]
    ds_read_b128 v[184:187], v196 offset:8768
    v_mfma_f32_32x32x16_bf16 v[80:95], a[156:159], v[172:175], v[80:95]
    ds_read_b128 v[188:191], v197 offset:8768
    s_mov_b32 s96, 4227072
    buffer_load_dwordx4 v[224:227], v56, s[16:19], s96 offen offset:0 sc1
    v_mul_f32 v142, v18, v155
    v_mul_f32 v143, v19, v155
    v_mul_f32 v144, v20, v155
    v_mul_f32 v145, v21, v155
    v_mul_f32 v146, v22, v155
    v_mul_f32_e64 v147, v23, v155
    s_waitcnt lgkmcnt(2)
    v_mfma_f32_32x32x16_bf16 v[96:111], a[128:131], v[176:179], v[96:111]
    ds_read_b128 v[192:195], v196 offset:8832
    v_mfma_f32_32x32x16_bf16 v[96:111], a[132:135], v[180:183], v[96:111]
    ds_read_b128 v[160:163], v197 offset:8832
    buffer_load_dwordx4 v[228:231], v56, s[16:19], s96 offen offset:256 sc1
    v_fma_f32 v112, v112, v156, v148
    v_fma_f32 v113, v113, v156, v149
    s_waitcnt lgkmcnt(2)
    v_mfma_f32_32x32x16_bf16 v[96:111], a[136:139], v[184:187], v[96:111]
    ds_read_b128 v[164:167], v196 offset:8896
    v_fma_f32 v114, v114, v156, v150
    v_fma_f32 v115, v115, v156, v151
    v_cvt_pk_bf16_f32 v112, v112, v113
    v_cvt_pk_bf16_f32 v113, v114, v115
    v_mfma_f32_32x32x16_bf16 v[96:111], a[140:143], v[188:191], v[96:111]
    ds_read_b128 v[168:171], v197 offset:8896
    s_mov_b32 s96, 4259840
    buffer_load_dwordx4 v[232:235], v56, s[16:19], s96 offen offset:0 sc1
    v_fma_f32 v80, v80, v152, v116
    v_fma_f32 v81, v81, v152, v117
    s_waitcnt lgkmcnt(2)
    v_mfma_f32_32x32x16_bf16 v[96:111], a[144:147], v[192:195], v[96:111]
    v_fma_f32 v82, v82, v152, v118
    v_fma_f32 v83, v83, v152, v119
    v_cvt_pk_bf16_f32 v80, v80, v81
    v_cvt_pk_bf16_f32 v81, v82, v83
    ds_write_b64 v40, v[112:113] offset:0
    v_mfma_f32_32x32x16_bf16 v[96:111], a[148:151], v[160:163], v[96:111]
    ds_write_b64 v38, v[80:81] offset:0
    v_fma_f32 v84, v84, v152, v120
    v_fma_f32 v85, v85, v152, v121
    v_fma_f32 v86, v86, v152, v122
    s_waitcnt lgkmcnt(2)
    v_mfma_f32_32x32x16_bf16 v[96:111], a[152:155], v[164:167], v[96:111]
    v_fma_f32 v87, v87, v152, v123
    v_cvt_pk_bf16_f32 v84, v84, v85
    v_cvt_pk_bf16_f32 v85, v86, v87
    v_fma_f32 v88, v88, v152, v124
    v_fma_f32 v89, v89, v152, v125
    v_mfma_f32_32x32x16_bf16 v[96:111], a[156:159], v[168:171], v[96:111]
    buffer_load_dwordx4 v[236:239], v56, s[16:19], s96 offen offset:256 sc1
    v_fma_f32 v90, v90, v152, v126
    v_fma_f32 v91, v91, v152, v127
    v_cvt_pk_bf16_f32 v88, v88, v89
    v_cvt_pk_bf16_f32 v89, v90, v91
    ds_write_b64 v38, v[84:85] offset:6400
    ds_write_b64 v38, v[88:89] offset:12800
    v_fma_f32 v92, v92, v152, v128
    v_fma_f32 v93, v93, v152, v129
    v_fma_f32 v94, v94, v152, v130
    v_fma_f32 v95, v95, v152, v131
    v_cvt_pk_bf16_f32 v92, v92, v93
    v_cvt_pk_bf16_f32 v93, v94, v95
    ds_write_b64 v39, v[92:93] offset:0
    v_pk_fma_f32 v[96:97], v[96:97], v[154:155], v[132:133] op_sel_hi:[1,0,1]
    v_pk_fma_f32 v[98:99], v[98:99], v[154:155], v[134:135] op_sel_hi:[1,0,1]
    v_cvt_pk_bf16_f32 v96, v96, v97
    v_cvt_pk_bf16_f32 v97, v98, v99
    v_pk_fma_f32 v[100:101], v[100:101], v[154:155], v[136:137] op_sel_hi:[1,0,1]
    v_pk_fma_f32 v[102:103], v[102:103], v[154:155], v[138:139] op_sel_hi:[1,0,1]
    v_cvt_pk_bf16_f32 v100, v100, v101
    v_cvt_pk_bf16_f32 v101, v102, v103
    ds_write_b64 v38, v[96:97] offset:1600
    ds_write_b64 v38, v[100:101] offset:8000
    v_pk_fma_f32 v[104:105], v[104:105], v[154:155], v[140:141] op_sel_hi:[1,0,1]
    v_pk_fma_f32 v[106:107], v[106:107], v[154:155], v[142:143] op_sel_hi:[1,0,1]
    v_cvt_pk_bf16_f32 v104, v104, v105
    v_cvt_pk_bf16_f32 v105, v106, v107
    v_pk_fma_f32 v[108:109], v[108:109], v[154:155], v[144:145] op_sel_hi:[1,0,1]
    v_pk_fma_f32 v[110:111], v[110:111], v[154:155], v[146:147] op_sel_hi:[1,0,1]
    v_cvt_pk_bf16_f32 v108, v108, v109
    v_cvt_pk_bf16_f32 v109, v110, v111
    ds_write_b64 v38, v[104:105] offset:14400
    ds_write_b64 v39, v[108:109] offset:1600
    s_waitcnt lgkmcnt(0)
    s_barrier
    v_mov_b32 v94, 0
    v_mov_b32 v95, 0
    v_mov_b32 v98, 0
    v_mov_b32_e64 v99, 0
    s_mov_b64 exec, 0xffff
    ds_read_b64 v[94:95], v42 offset:320
    ds_read_b64 v[98:99], v42 offset:640
    s_mov_b64 exec, -1
    s_nop 0
    ds_read_b64 v[92:93], v41 offset:320
    ds_read_b64 v[96:97], v41 offset:640
    ds_read_b64 v[84:85], v41 offset:6720
    ds_read_b64 v[86:87], v42 offset:6720
    ds_read_b64 v[80:81], v41 offset:6400
    ds_read_b64 v[82:83], v42 offset:6400
    ds_read_b64 v[88:89], v41 offset:7040
    ds_read_b64 v[90:91], v42 offset:7040
    ds_read_b64_tr_b16 v[106:107], v44 offset:0
    ds_read_b64_tr_b16 v[100:101], v43 offset:0
    ds_read_b64_tr_b16 v[108:109], v44 offset:320
    ds_read_b64_tr_b16 v[102:103], v43 offset:320
    s_mov_b32 s96, 4292608
    buffer_load_dwordx4 v[240:243], v56, s[16:19], s96 offen offset:0 sc1
    ds_read_b64_tr_b16 v[110:111], v44 offset:640
    ds_read_b64_tr_b16 v[104:105], v43 offset:640
    s_mov_b32 s82, 0x3ea52b5c
    s_lshl_b32 s25, s98, 4
    s_add_u32 s25, s25, 4194304
    s_lshl_b32 s26, s98, 3
    s_add_u32 s26, s26, 4194304
    s_waitcnt lgkmcnt(10)
    v_mfma_f32_16x16x32_bf16 v[116:119], v[84:87], v[92:95], v[28:31]
    buffer_load_dwordx4 v[244:247], v56, s[16:19], s96 offen offset:256 sc1
    v_mfma_f32_16x16x32_bf16 v[120:123], v[84:87], v[96:99], v[32:35]
    s_waitcnt lgkmcnt(8)
    v_mfma_f32_16x16x32_bf16 v[112:115], v[80:83], v[92:95], v[32:35]
    s_waitcnt lgkmcnt(6)
    v_mfma_f32_16x16x32_bf16 v[124:127], v[88:91], v[96:99], v[28:31]
    s_nop 5
    v_max_f32 v112, v112, v116
    v_max_f32 v113, v113, v117
    v_max_f32 v114, v114, v118
    v_max_f32 v115, v115, v119
    v_max3_f32 v156, v112, v113, v114
    s_mov_b32 s96, 4194304
    buffer_load_dwordx2 v[248:249], v57, s[16:19], s96 offen offset:0 sc1
    v_max_f32 v156, v156, v115
    v_max_f32 v120, v120, v124
    v_max_f32 v121, v121, v125
    v_max_f32 v122, v122, v126
    v_max_f32 v123, v123, v127
    v_max3_f32 v157, v120, v121, v122
    v_max_f32 v157, v157, v123
    s_nop 1
    v_permlane16_swap_b32 v156, v157
    buffer_load_dwordx2 v[252:253], v57, s[16:19], s96 offen offset:128 sc1
    v_max_f32 v156, v156, v157
    v_mov_b32 v157, v156
    s_nop 1
    v_permlane32_swap_b32 v156, v157
    v_max_f32 v156, v156, v157
    v_mul_f32 v156, s82, v156
    v_mov_b32 v157, v156
    s_nop 1
    v_permlane16_swap_b32_e64 v156, v157
    v_fma_f32 v112, v112, s82, -v156
    s_mov_b32 s96, 4210688
    buffer_load_dwordx2 v[250:251], v57, s[16:19], s96 offen offset:0 sc1
    v_fma_f32 v113, v113, s82, -v156
    v_fma_f32 v114, v114, s82, -v156
    v_fma_f32 v115, v115, s82, -v156
    v_exp_f32 v112, v112
    v_exp_f32 v113, v113
    v_exp_f32 v114, v114
    v_exp_f32 v115, v115
    v_cvt_pk_bf16_f32 v116, v112, v113
    buffer_load_dwordx2 v[254:255], v57, s[16:19], s96 offen offset:128 sc1
    v_cvt_pk_bf16_f32 v117, v114, v115
    v_bfi_b32 v128, v36, 0, v116
    v_and_b32 v130, v36, v116
    v_bfi_b32 v129, v37, 0, v117
    v_and_b32 v131, v37, v117
    s_waitcnt lgkmcnt(3)
    s_nop 0
    v_mfma_f32_16x16x32_bf16 v[144:147], v[106:109], v[128:131], 0
    s_waitcnt lgkmcnt(2)
    v_mfma_f32_16x16x32_bf16 v[136:139], v[100:103], v[128:131], 0
    v_fma_f32 v120, v120, s82, -v157
    s_mov_b32 s96, 0
    s_mov_b32 s97, 5120
    buffer_load_dwordx2 v[208:209], v60, s[4:7], s96 offen
    v_fma_f32 v121, v121, s82, -v157
    v_fma_f32 v122, v122, s82, -v157
    v_fma_f32 v123, v123, s82, -v157
    v_exp_f32 v120, v120
    v_exp_f32 v121, v121
    v_exp_f32 v122, v122
    v_exp_f32 v123, v123
    v_cvt_pk_bf16_f32 v124, v120, v121
    buffer_load_dwordx2 v[210:211], v60, s[4:7], s97 offen
    v_cvt_pk_bf16_f32 v125, v122, v123
    v_bfi_b32 v132, v36, 0, v124
    v_and_b32 v134, v36, v124
    v_bfi_b32 v133, v37, 0, v125
    v_and_b32 v135, v37, v125
    s_waitcnt lgkmcnt(1)
    s_nop 0
    v_mfma_f32_16x16x32_bf16 v[148:151], v[108:111], v[132:135], 0
    s_waitcnt lgkmcnt(0)
    v_mfma_f32_16x16x32_bf16 v[140:143], v[102:105], v[132:135], 0
    v_mov_b32 v158, v144
    v_lshrrev_b32_e64 v212, 5, v1
    v_mul_u32_u24 v212, 5104, v212
    v_bfe_u32 v213, v1, 4, 1
    v_lshlrev_b32 v213, 2, v213
    v_sub_u32 v212, v212, v213
    v_add_u32 v212, v212, v60
    s_mul_i32 s97, s24, 24
    s_sub_u32 s97, 128, s97
    buffer_load_dword v212, v212, s[4:7], s97 offen
    v_permlane16_swap_b32 v144, v158
    v_rcp_f32_e64 v158, v158
    s_nop 0
    v_pk_mul_f32 v[136:137], v[136:137], v[158:159] op_sel_hi:[1,0]
    v_pk_mul_f32 v[138:139], v[138:139], v[158:159] op_sel_hi:[1,0]
    v_pk_mul_f32 v[144:145], v[144:145], v[158:159] op_sel_hi:[1,0]
    v_pk_mul_f32 v[146:147], v[146:147], v[158:159] op_sel_hi:[1,0]
    v_cvt_pk_bf16_f32 v112, v136, v137
    v_cvt_pk_bf16_f32 v116, v144, v145
    v_cvt_pk_bf16_f32 v113, v138, v139
    v_cvt_pk_bf16_f32 v117, v146, v147
    v_mov_b32 v160, v148
    s_nop 1
    v_permlane16_swap_b32 v148, v160
    v_rcp_f32_e64 v160, v160
    s_nop 0
    v_pk_mul_f32 v[140:141], v[140:141], v[160:161] op_sel_hi:[1,0]
    v_pk_mul_f32 v[142:143], v[142:143], v[160:161] op_sel_hi:[1,0]
    v_pk_mul_f32 v[148:149], v[148:149], v[160:161] op_sel_hi:[1,0]
    v_pk_mul_f32 v[150:151], v[150:151], v[160:161] op_sel_hi:[1,0]
    v_cvt_pk_bf16_f32 v114, v140, v141
    v_cvt_pk_bf16_f32 v118, v148, v149
    v_cvt_pk_bf16_f32 v115, v142, v143
    v_cvt_pk_bf16_f32 v119, v150, v151
    v_permlane16_swap_b32 v112, v114
    v_permlane16_swap_b32 v113, v115
    v_permlane16_swap_b32 v116, v118
    v_permlane16_swap_b32 v117, v119
    buffer_store_dwordx4 v[112:115], v45, s[16:19], s25 offen sc1
    s_mov_b64 exec, s[80:81]
    buffer_store_dwordx2 v[116:117], v46, s[16:19], s26 offen sc1
    s_mov_b64 exec, -1
oe_20:
    s_waitcnt vmcnt(16)
    v_mfma_f32_16x16x32_bf16 v[112:115], a[176:179], v[216:219], 0
    v_mov_b32 v136, 0
    v_mov_b32 v137, 0
    s_waitcnt vmcnt(15)
    v_mfma_f32_16x16x32_bf16 v[116:119], a[176:179], v[220:223], 0
    v_mov_b32 v138, 0
    v_mov_b32 v139, 0
    s_waitcnt vmcnt(14)
    v_mfma_f32_16x16x32_bf16 v[112:115], a[196:199], v[224:227], v[112:115]
    v_mov_b32 v140, 0
    v_mov_b32 v141, 0
    s_waitcnt vmcnt(13)
    v_mfma_f32_16x16x32_bf16 v[116:119], a[196:199], v[228:231], v[116:119]
    s_mov_b32 s25, 6815744
    s_add_u32 s26, s36, 6815744
    s_waitcnt vmcnt(12)
    v_mfma_f32_16x16x32_bf16 v[112:115], a[216:219], v[232:235], v[112:115]
    s_add_u32 s27, s35, 3473408
    s_mov_b32 s28, 0x99999999
    s_waitcnt vmcnt(11)
    v_mfma_f32_16x16x32_bf16 v[116:119], a[216:219], v[236:239], v[116:119]
    s_mov_b32 s29, 0x99999999
    s_waitcnt vmcnt(10)
    v_mfma_f32_16x16x32_bf16 v[112:115], a[236:239], v[240:243], v[112:115]
    s_waitcnt vmcnt(9)
    v_mfma_f32_16x16x32_bf16 v[116:119], a[236:239], v[244:247], v[116:119]
    s_waitcnt vmcnt(6)
    v_mfma_f32_16x16x32_bf16 v[112:115], v[52:55], v[248:251], v[112:115]
    s_waitcnt vmcnt(5)
    v_mfma_f32_16x16x32_bf16 v[116:119], v[52:55], v[252:255], v[116:119]
    v_mfma_f32_16x16x32_bf16 v[88:91], a[164:167], v[216:219], 0
    v_mfma_f32_16x16x32_bf16 v[92:95], a[164:167], v[220:223], 0
    v_mfma_f32_16x16x32_bf16 v[88:91], a[184:187], v[224:227], v[88:91]
    v_mfma_f32_16x16x32_bf16 v[92:95], a[184:187], v[228:231], v[92:95]
    v_mfma_f32_16x16x32_bf16 v[88:91], a[204:207], v[232:235], v[88:91]
    v_mfma_f32_16x16x32_bf16 v[92:95], a[204:207], v[236:239], v[92:95]
    s_nop 1
    v_cmp_u_f32 vcc, v112, v116
    s_nop 0
    s_cbranch_vccnz rd_21
rc_22:
    v_mfma_f32_16x16x32_bf16 v[88:91], a[224:227], v[240:243], v[88:91]
    ds_write_b128 v203, v[112:115] offset:24576
    v_mfma_f32_16x16x32_bf16 v[92:95], a[224:227], v[244:247], v[92:95]
    v_mfma_f32_16x16x32_bf16 v[88:91], a[244:247], v[248:251], v[88:91]
    ds_write_b128 v203, v[116:119] offset:25600
    v_mfma_f32_16x16x32_bf16 v[92:95], a[244:247], v[252:255], v[92:95]
    v_mfma_f32_16x16x32_bf16 v[96:99], a[168:171], v[216:219], 0
    s_waitcnt vmcnt(4)
    v_lshlrev_b32 v120, 16, v208
    v_and_b32 v121, 0xffff0000, v208
    v_mfma_f32_16x16x32_bf16 v[100:103], a[168:171], v[220:223], 0
    v_lshlrev_b32_e64 v122, 16, v209
    v_and_b32 v123, 0xffff0000, v209
    v_mfma_f32_16x16x32_bf16 v[96:99], a[188:191], v[224:227], v[96:99]
    s_waitcnt vmcnt(3)
    v_lshlrev_b32 v124, 16, v210
    v_and_b32 v125, 0xffff0000, v210
    v_mfma_f32_16x16x32_bf16 v[100:103], a[188:191], v[228:231], v[100:103]
    v_lshlrev_b32_e64 v126, 16, v211
    v_and_b32 v127, 0xffff0000, v211
    v_mfma_f32_16x16x32_bf16 v[96:99], a[208:211], v[232:235], v[96:99]
    s_waitcnt vmcnt(2)
    v_lshlrev_b32 v128, 16, v212
    v_and_b32 v129, 0xffff0000, v212
    v_mfma_f32_16x16x32_bf16 v[100:103], a[208:211], v[236:239], v[100:103]
    v_mfma_f32_16x16x32_bf16 v[96:99], a[228:231], v[240:243], v[96:99]
    ds_write_b128 v200, v[88:91] offset:0
    v_mfma_f32_16x16x32_bf16 v[100:103], a[228:231], v[244:247], v[100:103]
    v_mfma_f32_16x16x32_bf16 v[96:99], a[248:251], v[248:251], v[96:99]
    ds_write_b128 v200, v[92:95] offset:1024
    v_mfma_f32_16x16x32_bf16 v[100:103], a[248:251], v[252:255], v[100:103]
    v_mfma_f32_16x16x32_bf16 v[104:107], a[172:175], v[216:219], 0
    v_mfma_f32_16x16x32_bf16 v[108:111], a[172:175], v[220:223], 0
    v_mfma_f32_16x16x32_bf16 v[104:107], a[192:195], v[224:227], v[104:107]
    v_mfma_f32_16x16x32_bf16 v[108:111], a[192:195], v[228:231], v[108:111]
    v_mfma_f32_16x16x32_bf16 v[104:107], a[212:215], v[232:235], v[104:107]
    v_mfma_f32_16x16x32_bf16 v[108:111], a[212:215], v[236:239], v[108:111]
    v_mfma_f32_16x16x32_bf16 v[104:107], a[232:235], v[240:243], v[104:107]
    ds_write_b128 v201, v[96:99] offset:2048
    v_mfma_f32_16x16x32_bf16 v[108:111], a[232:235], v[244:247], v[108:111]
    v_mfma_f32_16x16x32_bf16 v[104:107], a[252:255], v[248:251], v[104:107]
    ds_write_b128 v201, v[100:103] offset:3072
    v_mfma_f32_16x16x32_bf16 v[108:111], a[252:255], v[252:255], v[108:111]
    v_mfma_f32_16x16x32_bf16 v[80:83], a[160:163], v[216:219], v[120:123]
    v_mfma_f32_16x16x32_bf16 v[84:87], a[160:163], v[220:223], v[124:127]
    v_mfma_f32_16x16x32_bf16 v[80:83], a[180:183], v[224:227], v[80:83]
    v_mfma_f32_16x16x32_bf16 v[84:87], a[180:183], v[228:231], v[84:87]
    v_mfma_f32_16x16x32_bf16 v[80:83], a[200:203], v[232:235], v[80:83]
    s_nop 0
    ds_write_b128 v202, v[104:107] offset:4096
    v_mfma_f32_16x16x32_bf16 v[84:87], a[200:203], v[236:239], v[84:87]
    ds_write_b128 v202, v[108:111] offset:5120
    v_mfma_f32_16x16x32_bf16 v[80:83], a[220:223], v[240:243], v[80:83]
    v_mfma_f32_16x16x32_bf16 v[84:87], a[220:223], v[244:247], v[84:87]
    v_mfma_f32_16x16x32_bf16 v[80:83], a[240:243], v[248:251], v[80:83]
    v_mfma_f32_16x16x32_bf16 v[84:87], a[240:243], v[252:255], v[84:87]
    s_waitcnt lgkmcnt(0)
    s_barrier
    s_nop 0
    ds_read_b128 v[88:91], v204 offset:0
    ds_read_b128 v[92:95], v204 offset:1024
    ds_read_b128 v[96:99], v204 offset:2048
    ds_read_b128 v[100:103], v204 offset:3072
    ds_read_b128 v[104:107], v204 offset:4096
    ds_read_b128 v[108:111], v204 offset:5120
    ds_read_b64 v[112:113], v205 offset:24576
    ds_read_b64 v[114:115], v205 offset:26624
    ds_read_b64 v[116:117], v205 offset:28672
    ds_read_b64 v[118:119], v205 offset:30720
    s_waitcnt lgkmcnt(9)
    v_pk_add_f32 v[80:81], v[80:81], v[88:89]
    v_pk_add_f32 v[82:83], v[82:83], v[90:91]
    s_waitcnt lgkmcnt(8)
    v_pk_add_f32 v[84:85], v[84:85], v[92:93]
    v_pk_add_f32 v[86:87], v[86:87], v[94:95]
    s_waitcnt lgkmcnt(7)
    v_pk_add_f32 v[80:81], v[80:81], v[96:97]
    v_pk_add_f32 v[82:83], v[82:83], v[98:99]
    s_waitcnt lgkmcnt(6)
    v_pk_add_f32 v[84:85], v[84:85], v[100:101]
    v_pk_add_f32 v[86:87], v[86:87], v[102:103]
    s_waitcnt lgkmcnt(5)
    v_pk_add_f32 v[80:81], v[80:81], v[104:105]
    v_pk_add_f32 v[82:83], v[82:83], v[106:107]
    s_waitcnt lgkmcnt(4)
    v_pk_add_f32 v[84:85], v[84:85], v[108:109]
    v_pk_add_f32 v[86:87], v[86:87], v[110:111]
    v_cvt_pk_bf16_f32 v132, v80, v81
    v_cvt_pk_bf16_f32 v133, v82, v83
    v_cvt_pk_bf16_f32 v134, v84, v85
    v_cvt_pk_bf16_f32 v135, v86, v87
    s_waitcnt lgkmcnt(3)
    v_pk_add_f32 v[128:129], v[128:129], v[112:113]
    s_waitcnt lgkmcnt(2)
    v_pk_add_f32 v[128:129], v[128:129], v[114:115]
    s_waitcnt lgkmcnt(1)
    v_pk_add_f32 v[128:129], v[128:129], v[116:117]
    s_waitcnt lgkmcnt(0)
    v_pk_add_f32 v[128:129], v[128:129], v[118:119]
    v_cvt_pk_bf16_f32 v130, v128, v129
    buffer_store_dwordx4 v[132:135], v59, s[16:19], s25 offen sc1
    buffer_store_dword v130, v61, s[16:19], s26 offen sc1
    v_dot2c_f32_bf16 v136, v132, v215
    v_dot2c_f32_bf16 v137, v132, v132
    v_dot2c_f32_bf16 v136, v133, v215
    v_dot2c_f32_bf16 v137, v133, v133
    v_dot2c_f32_bf16 v138, v134, v215
    v_dot2c_f32_bf16 v139, v134, v134
    v_dot2c_f32_bf16 v138, v135, v215
    v_dot2c_f32_bf16 v139, v135, v135
    v_dot2c_f32_bf16 v140, v130, v215
    v_dot2c_f32_bf16 v141, v130, v130
    v_permlane32_swap_b32 v136, v138
    v_permlane32_swap_b32 v137, v139
    v_pk_add_f32 v[136:137], v[136:137], v[138:139]
    v_pk_add_f32 v[136:137], v[136:137], v[140:141]
    s_nop 1
    v_permlane16_swap_b32 v136, v137
    v_add_f32_e64 v136, v136, v137
    ds_write_b32 v206, v136 offset:32768
    s_mov_b32 s96, 4198400
    buffer_load_dwordx4 v[216:219], v56, s[16:19], s96 offen offset:0 sc1
    buffer_load_dwordx4 v[220:223], v56, s[16:19], s96 offen offset:256 sc1
    s_mov_b32 s96, 4231168
    buffer_load_dwordx4 v[224:227], v56, s[16:19], s96 offen offset:0 sc1
    buffer_load_dwordx4 v[228:231], v56, s[16:19], s96 offen offset:256 sc1
    s_mov_b32 s96, 4263936
    buffer_load_dwordx4 v[232:235], v56, s[16:19], s96 offen offset:0 sc1
    buffer_load_dwordx4 v[236:239], v56, s[16:19], s96 offen offset:256 sc1
    s_waitcnt lgkmcnt(0)
    s_barrier
    ds_read2st64_b32 v[136:137], v207 offset0:0 offset1:1
    ds_read2st64_b32 v[138:139], v207 offset0:2 offset1:3
    ds_read_b64_tr_b16 v[144:145], v65 offset:32
    ds_read_b64_tr_b16 v[146:147], v65 offset:0
    ds_read_b64_tr_b16 v[148:149], v65 offset:160
    ds_read_b64_tr_b16 v[150:151], v65 offset:128
    ds_read_b64_tr_b16 v[152:153], v65 offset:288
    ds_read_b64_tr_b16 v[154:155], v65 offset:256
    ds_read_b64_tr_b16 v[156:157], v65 offset:416
    ds_read_b64_tr_b16 v[158:159], v65 offset:384
    ds_read_b64_tr_b16 v[160:161], v65 offset:544
    ds_read_b64_tr_b16 v[162:163], v65 offset:512
    ds_read_b64_tr_b16 v[164:165], v65 offset:672
    ds_read_b64_tr_b16 v[166:167], v65 offset:640
    ds_read_b64_tr_b16 v[168:169], v65 offset:800
    ds_read_b64_tr_b16 v[170:171], v65 offset:768
    ds_read_b64_tr_b16 v[172:173], v65 offset:928
    ds_read_b64_tr_b16 v[174:175], v65 offset:896
    s_waitcnt lgkmcnt(15)
    v_pk_add_f32 v[136:137], v[136:137], v[138:139]
    v_add_f32 v136, v136, v137
    v_cndmask_b32 v136, v136, 1.0, s[28:29]
    s_mov_b64 exec, s[80:81]
    buffer_atomic_add_f32 v136, v214, s[16:19], s27 offen
    s_mov_b64 exec, -1
    s_mov_b32 s96, 4296704
    buffer_load_dwordx4 v[240:243], v56, s[16:19], s96 offen offset:0 sc1
    buffer_load_dwordx4 v[244:247], v56, s[16:19], s96 offen offset:256 sc1
    s_mov_b32 s96, 4196352
    buffer_load_dwordx2 v[248:249], v57, s[16:19], s96 offen offset:0 sc1
    buffer_load_dwordx2 v[252:253], v57, s[16:19], s96 offen offset:128 sc1
    s_mov_b32 s96, 4212736
    buffer_load_dwordx2 v[250:251], v57, s[16:19], s96 offen offset:0 sc1
    buffer_load_dwordx2 v[254:255], v57, s[16:19], s96 offen offset:128 sc1
    s_mov_b32 s96, 1310720
    s_mov_b32 s97, 1315840
    buffer_load_dwordx2 v[208:209], v60, s[4:7], s96 offen
    buffer_load_dwordx2 v[210:211], v60, s[4:7], s97 offen
    v_lshrrev_b32_e64 v212, 5, v1
    v_mul_u32_u24 v212, 5104, v212
    v_bfe_u32 v213, v1, 4, 1
    v_lshlrev_b32 v213, 2, v213
    v_sub_u32 v212, v212, v213
    v_add_u32 v212, v212, v60
    s_mul_i32 s97, s24, 24
    s_sub_u32 s97, 1310848, s97
    buffer_load_dword v212, v212, s[4:7], s97 offen
    v_lshrrev_b32 v176, 4, v0
    v_mul_u32_u24 v176, 1216, v176
    v_and_b32 v177, 15, v0
    v_lshl_add_u32 v176, v177, 3, v176
    v_add_u32 v176, 64, v176
    v_mov_b32 v178, 0
    v_mov_b32 v179, 0
    ds_write_b64 v176, v[178:179]
    v_mov_b32 v70, 0
    v_mov_b32 v71, 0
    v_mov_b32 v72, 0
    s_lshl_b32 s25, s24, 17
    v_lshrrev_b32 v176, 5, v1
    v_lshl_add_u32 v176, v176, 14, s25
    v_bfe_u32 v177, v1, 4, 1
    v_lshl_add_u32 v176, v177, 13, v176
    v_and_b32_e64 v177, 15, v1
    v_lshl_add_u32 v73, v177, 4, v176
    v_bfe_u32 v176, v1, 2, 3
    v_lshl_add_u32 v176, v176, 14, s25
    v_bfe_u32 v177, v1, 1, 1
    v_lshl_add_u32 v176, v177, 13, v176
    v_and_b32 v177, 1, v1
    v_lshl_add_u32 v77, v177, 4, v176
    v_lshrrev_b32 v177, 5, v1
    v_and_b32 v176, 31, v1
    v_lshlrev_b32 v176, 3, v176
    v_lshl_add_u32 v78, v177, 10, v176
    v_and_b32 v176, 7, v1
    v_lshlrev_b32 v176, 3, v176
    v_lshl_add_u32 v178, v177, 7, v176
    v_add_u32 v74, 31744, v73
    v_add_u32 v75, 63488, v73
    v_add_u32 v76, 95232, v73
    v_add_u32 v178, 53760, v178
    v_and_b32 v176, 31, v1
    v_cmp_eq_u32 vcc, 0, v176
    v_cmp_eq_u32 s[82:83], 24, v176
    s_nop 0
    s_or_b64 vcc, vcc, s[82:83]
    v_mov_b32 v176, 155648
    v_mov_b32 v177, 157696
    v_cndmask_b32 v176, v176, v177, vcc
    v_cndmask_b32 v79, v176, v178, s[78:79]
oe_23:
    s_waitcnt vmcnt(15)
    v_mfma_f32_16x16x32_bf16 v[112:115], a[176:179], v[216:219], 0
    v_mov_b32 v136, 0
    v_mov_b32 v137, 0
    s_waitcnt vmcnt(14)
    v_mfma_f32_16x16x32_bf16 v[116:119], a[176:179], v[220:223], 0
    v_mov_b32 v138, 0
    v_mov_b32 v139, 0
    s_waitcnt vmcnt(13)
    v_mfma_f32_16x16x32_bf16 v[112:115], a[196:199], v[224:227], v[112:115]
    v_mov_b32 v140, 0
    v_mov_b32_e64 v141, 0
    s_waitcnt vmcnt(12)
    v_mfma_f32_16x16x32_bf16 v[116:119], a[196:199], v[228:231], v[116:119]
    s_mov_b32 s25, 6817792
    s_add_u32 s26, s36, 6817792
    s_waitcnt vmcnt(11)
    v_mfma_f32_16x16x32_bf16 v[112:115], a[216:219], v[232:235], v[112:115]
    s_add_u32 s27, s35, 3477504
    s_mov_b32 s28, 0x99999999
    s_waitcnt vmcnt(10)
    v_mfma_f32_16x16x32_bf16 v[116:119], a[216:219], v[236:239], v[116:119]
    s_mov_b32 s29, 0x99999999
    s_waitcnt vmcnt(8)
    v_mfma_f32_16x16x32_bf16 v[112:115], a[236:239], v[240:243], v[112:115]
    s_waitcnt vmcnt(7)
    v_mfma_f32_16x16x32_bf16 v[116:119], a[236:239], v[244:247], v[116:119]
    s_waitcnt vmcnt(4)
    v_mfma_f32_16x16x32_bf16 v[112:115], v[52:55], v[248:251], v[112:115]
    s_waitcnt vmcnt(3)
    v_mfma_f32_16x16x32_bf16 v[116:119], v[52:55], v[252:255], v[116:119]
    v_mfma_f32_16x16x32_bf16 v[88:91], a[164:167], v[216:219], 0
    v_mfma_f32_16x16x32_bf16 v[92:95], a[164:167], v[220:223], 0
    v_mfma_f32_16x16x32_bf16 v[88:91], a[184:187], v[224:227], v[88:91]
    v_mfma_f32_16x16x32_bf16 v[92:95], a[184:187], v[228:231], v[92:95]
    v_mfma_f32_16x16x32_bf16 v[88:91], a[204:207], v[232:235], v[88:91]
    v_mfma_f32_16x16x32_bf16 v[92:95], a[204:207], v[236:239], v[92:95]
    s_nop 1
    v_cmp_u_f32 vcc, v112, v116
    s_nop 0
    s_cbranch_vccnz rd_24
rc_25:
    v_mfma_f32_16x16x32_bf16 v[88:91], a[224:227], v[240:243], v[88:91]
    ds_write_b128 v203, v[112:115] offset:24576
    v_mfma_f32_16x16x32_bf16 v[92:95], a[224:227], v[244:247], v[92:95]
    v_mfma_f32_16x16x32_bf16 v[88:91], a[244:247], v[248:251], v[88:91]
    ds_write_b128 v203, v[116:119] offset:25600
    v_mfma_f32_16x16x32_bf16 v[92:95], a[244:247], v[252:255], v[92:95]
    v_mfma_f32_16x16x32_bf16 v[96:99], a[168:171], v[216:219], 0
    s_waitcnt vmcnt(2)
    v_lshlrev_b32 v120, 16, v208
    v_and_b32 v121, 0xffff0000, v208
    v_mfma_f32_16x16x32_bf16 v[100:103], a[168:171], v[220:223], 0
    v_lshlrev_b32_e64 v122, 16, v209
    v_and_b32 v123, 0xffff0000, v209
    v_mfma_f32_16x16x32_bf16 v[96:99], a[188:191], v[224:227], v[96:99]
    s_waitcnt vmcnt(1)
    v_lshlrev_b32 v124, 16, v210
    v_and_b32 v125, 0xffff0000, v210
    v_mfma_f32_16x16x32_bf16 v[100:103], a[188:191], v[228:231], v[100:103]
    v_lshlrev_b32_e64 v126, 16, v211
    v_and_b32 v127, 0xffff0000, v211
    v_mfma_f32_16x16x32_bf16 v[96:99], a[208:211], v[232:235], v[96:99]
    s_waitcnt vmcnt(0)
    v_lshlrev_b32 v128, 16, v212
    v_and_b32 v129, 0xffff0000, v212
    v_mfma_f32_16x16x32_bf16 v[100:103], a[208:211], v[236:239], v[100:103]
    v_mfma_f32_16x16x32_bf16 v[96:99], a[228:231], v[240:243], v[96:99]
    ds_write_b128 v200, v[88:91] offset:0
    v_mfma_f32_16x16x32_bf16 v[100:103], a[228:231], v[244:247], v[100:103]
    v_mfma_f32_16x16x32_bf16 v[96:99], a[248:251], v[248:251], v[96:99]
    ds_write_b128 v200, v[92:95] offset:1024
    v_mfma_f32_16x16x32_bf16 v[100:103], a[248:251], v[252:255], v[100:103]
    v_mfma_f32_16x16x32_bf16 v[104:107], a[172:175], v[216:219], 0
    v_mfma_f32_16x16x32_bf16 v[108:111], a[172:175], v[220:223], 0
    v_mfma_f32_16x16x32_bf16 v[104:107], a[192:195], v[224:227], v[104:107]
    v_mfma_f32_16x16x32_bf16 v[108:111], a[192:195], v[228:231], v[108:111]
    v_mfma_f32_16x16x32_bf16 v[104:107], a[212:215], v[232:235], v[104:107]
    v_mfma_f32_16x16x32_bf16 v[108:111], a[212:215], v[236:239], v[108:111]
    v_mfma_f32_16x16x32_bf16 v[104:107], a[232:235], v[240:243], v[104:107]
    ds_write_b128 v201, v[96:99] offset:2048
    v_mfma_f32_16x16x32_bf16 v[108:111], a[232:235], v[244:247], v[108:111]
    v_mfma_f32_16x16x32_bf16 v[104:107], a[252:255], v[248:251], v[104:107]
    ds_write_b128 v201, v[100:103] offset:3072
    v_mfma_f32_16x16x32_bf16 v[108:111], a[252:255], v[252:255], v[108:111]
    v_mfma_f32_16x16x32_bf16 v[80:83], a[160:163], v[216:219], v[120:123]
    v_mfma_f32_16x16x32_bf16 v[84:87], a[160:163], v[220:223], v[124:127]
    v_mfma_f32_16x16x32_bf16 v[80:83], a[180:183], v[224:227], v[80:83]
    v_mfma_f32_16x16x32_bf16 v[84:87], a[180:183], v[228:231], v[84:87]
    v_mfma_f32_16x16x32_bf16 v[80:83], a[200:203], v[232:235], v[80:83]
    s_nop 0
    ds_write_b128 v202, v[104:107] offset:4096
    v_mfma_f32_16x16x32_bf16 v[84:87], a[200:203], v[236:239], v[84:87]
    ds_write_b128 v202, v[108:111] offset:5120
    v_mfma_f32_16x16x32_bf16 v[80:83], a[220:223], v[240:243], v[80:83]
    v_mfma_f32_16x16x32_bf16 v[84:87], a[220:223], v[244:247], v[84:87]
    v_mfma_f32_16x16x32_bf16 v[80:83], a[240:243], v[248:251], v[80:83]
    v_mfma_f32_16x16x32_bf16 v[84:87], a[240:243], v[252:255], v[84:87]
    s_waitcnt lgkmcnt(0)
    s_barrier
    s_nop 0
    ds_read_b128 v[88:91], v204 offset:0
    ds_read_b128 v[92:95], v204 offset:1024
    ds_read_b128 v[96:99], v204 offset:2048
    ds_read_b128 v[100:103], v204 offset:3072
    ds_read_b128 v[104:107], v204 offset:4096
    ds_read_b128 v[108:111], v204 offset:5120
    ds_read_b64 v[112:113], v205 offset:24576
    ds_read_b64 v[114:115], v205 offset:26624
    ds_read_b64 v[116:117], v205 offset:28672
    ds_read_b64 v[118:119], v205 offset:30720
    s_waitcnt lgkmcnt(9)
    v_pk_add_f32 v[80:81], v[80:81], v[88:89]
    v_pk_add_f32 v[82:83], v[82:83], v[90:91]
    s_waitcnt lgkmcnt(8)
    v_pk_add_f32 v[84:85], v[84:85], v[92:93]
    v_pk_add_f32 v[86:87], v[86:87], v[94:95]
    s_waitcnt lgkmcnt(7)
    v_pk_add_f32 v[80:81], v[80:81], v[96:97]
    v_pk_add_f32 v[82:83], v[82:83], v[98:99]
    s_waitcnt lgkmcnt(6)
    v_pk_add_f32 v[84:85], v[84:85], v[100:101]
    v_pk_add_f32 v[86:87], v[86:87], v[102:103]
    s_waitcnt lgkmcnt(5)
    v_pk_add_f32 v[80:81], v[80:81], v[104:105]
    v_pk_add_f32 v[82:83], v[82:83], v[106:107]
    s_waitcnt lgkmcnt(4)
    v_pk_add_f32 v[84:85], v[84:85], v[108:109]
    v_pk_add_f32 v[86:87], v[86:87], v[110:111]
    v_cvt_pk_bf16_f32 v132, v80, v81
    v_cvt_pk_bf16_f32 v133, v82, v83
    v_cvt_pk_bf16_f32 v134, v84, v85
    v_cvt_pk_bf16_f32 v135, v86, v87
    s_waitcnt lgkmcnt(3)
    v_pk_add_f32 v[128:129], v[128:129], v[112:113]
    s_waitcnt lgkmcnt(2)
    v_pk_add_f32 v[128:129], v[128:129], v[114:115]
    s_waitcnt lgkmcnt(1)
    v_pk_add_f32 v[128:129], v[128:129], v[116:117]
    s_waitcnt lgkmcnt(0)
    v_pk_add_f32 v[128:129], v[128:129], v[118:119]
    v_cvt_pk_bf16_f32 v130, v128, v129
    buffer_store_dwordx4 v[132:135], v59, s[16:19], s25 offen sc1
    buffer_store_dword v130, v61, s[16:19], s26 offen sc1
    v_dot2c_f32_bf16 v136, v132, v215
    v_dot2c_f32_bf16 v137, v132, v132
    v_dot2c_f32_bf16 v136, v133, v215
    v_dot2c_f32_bf16 v137, v133, v133
    v_dot2c_f32_bf16 v138, v134, v215
    v_dot2c_f32_bf16 v139, v134, v134
    v_dot2c_f32_bf16 v138, v135, v215
    v_dot2c_f32_bf16 v139, v135, v135
    v_dot2c_f32_bf16 v140, v130, v215
    v_dot2c_f32_bf16 v141, v130, v130
    v_permlane32_swap_b32 v136, v138
    v_permlane32_swap_b32 v137, v139
    v_pk_add_f32 v[136:137], v[136:137], v[138:139]
    v_pk_add_f32 v[136:137], v[136:137], v[140:141]
    s_nop 1
    v_permlane16_swap_b32 v136, v137
    v_add_f32 v136, v136, v137
    ds_write_b32 v206, v136 offset:32768
    s_lshl_b32 s96, s75, 14
    s_add_u32 s96, s96, 6815744
    s_lshl_b32 s97, s24, 12
    s_nop 0
    s_add_u32 s97, s97, 3473408
    buffer_load_dwordx4 v[176:179], v62, s[16:19], s96 offen offset:0 sc1
    buffer_load_dwordx4 v[180:183], v62, s[16:19], s96 offen offset:1024 sc1
    buffer_load_dwordx4 v[184:187], v62, s[16:19], s97 offen offset:0 sc1
    buffer_load_dwordx4 v[188:191], v62, s[16:19], s97 offen offset:1024 sc1
    buffer_load_dwordx4 v[192:195], v62, s[16:19], s97 offen offset:2048 sc1
    buffer_load_dwordx4 v[196:199], v62, s[16:19], s97 offen offset:3072 sc1
    s_waitcnt lgkmcnt(0)
    s_barrier
    ds_read2st64_b32 v[136:137], v207 offset0:0 offset1:1
    ds_read2st64_b32 v[138:139], v207 offset0:2 offset1:3
    s_waitcnt lgkmcnt(0)
    v_pk_add_f32 v[136:137], v[136:137], v[138:139]
    v_add_f32 v136, v136, v137
    v_cndmask_b32 v136, v136, 1.0, s[28:29]
    s_mov_b64 exec, s[80:81]
    buffer_atomic_add_f32 v136, v214, s[16:19], s27 offen
    s_mov_b64 exec, -1
    s_cmp_ge_u32 s2, 160
    s_cbranch_scc1 nc_26
    s_waitcnt vmcnt(1)
ce_28:
    v_max3_u32 v208, v176, v177, v178
    v_max3_u32 v208, v208, v179, v180
    v_max3_u32 v208, v208, v181, v182
    v_max_u32_e64 v208, v208, v183
    v_cmp_eq_u32 s[82:83], -1, v208
    v_min3_f32 v209, v184, v187, v188
    v_min3_f32 v209, v209, v191, v192
    v_min3_f32 v209, v209, v195, v196
    v_min_f32 v209, v209, v199
    v_cmp_neq_f32 vcc, 0x41000000, v209
    s_nop 0
    s_or_b64 vcc, vcc, s[82:83]
    s_cbranch_vccnz rd_29
rc_30:
    v_mul_f32 v208, 0x3acccccd, v185
    v_mul_f32 v209, 0x3acccccd, v189
    v_mul_f32 v186, 0x3acccccd, v186
    v_mul_f32 v190, 0x3acccccd, v190
    v_fma_f32 v186, -v208, v208, v186
    v_fma_f32 v190, -v209, v209, v190
    v_max_f32 v186, 0, v186
    v_max_f32 v190, 0, v190
    v_add_f32 v186, 0x3727c5ac, v186
    v_add_f32 v190, 0x3727c5ac, v190
    v_rsq_f32 v185, v186
    v_rsq_f32 v189, v190
    v_mul_f32 v186, -v208, v185
    v_mul_f32 v190, -v209, v189
    v_lshlrev_b32 v80, 16, v176
    v_and_b32 v82, 0xffff0000, v176
    v_lshlrev_b32 v84, 16, v177
    v_and_b32 v86, 0xffff0000, v177
    v_lshlrev_b32 v81, 16, v178
    v_and_b32 v83, 0xffff0000, v178
    v_lshlrev_b32 v85, 16, v179
    v_and_b32 v87, 0xffff0000, v179
    v_fma_f32 v208, v80, v185, v186
    v_fma_f32 v209, v81, v189, v190
    v_cvt_pk_bf16_f32 v176, v208, v209
    v_fma_f32 v208, v82, v185, v186
    v_fma_f32 v209, v83, v189, v190
    v_cvt_pk_bf16_f32 v177, v208, v209
    v_fma_f32 v208, v84, v185, v186
    v_fma_f32 v209, v85, v189, v190
    v_cvt_pk_bf16_f32 v178, v208, v209
    v_fma_f32 v208, v86, v185, v186
    v_fma_f32 v209, v87, v189, v190
    v_cvt_pk_bf16_f32 v179, v208, v209
    ds_write_b32 v63, v176 offset:0
    ds_write_b32 v63, v177 offset:4864
    ds_write_b32 v63, v178 offset:9728
    ds_write_b32 v63, v179 offset:14592
    v_mul_f32 v208, 0x3acccccd, v193
    v_mul_f32 v209, 0x3acccccd, v197
    v_mul_f32 v194, 0x3acccccd, v194
    v_mul_f32 v198, 0x3acccccd, v198
    v_fma_f32 v194, -v208, v208, v194
    v_fma_f32 v198, -v209, v209, v198
    v_max_f32 v194, 0, v194
    v_max_f32 v198, 0, v198
    v_add_f32 v194, 0x3727c5ac, v194
    v_add_f32 v198, 0x3727c5ac, v198
    v_rsq_f32 v193, v194
    v_rsq_f32 v197, v198
    v_mul_f32 v194, -v208, v193
    v_mul_f32 v198, -v209, v197
    v_lshlrev_b32 v88, 16, v180
    v_and_b32 v90, 0xffff0000, v180
    v_lshlrev_b32 v92, 16, v181
    v_and_b32 v94, 0xffff0000, v181
    v_lshlrev_b32 v89, 16, v182
    v_and_b32 v91, 0xffff0000, v182
    v_lshlrev_b32 v93, 16, v183
    v_and_b32 v95, 0xffff0000, v183
    v_fma_f32 v208, v88, v193, v194
    v_fma_f32 v209, v89, v197, v198
    v_cvt_pk_bf16_f32 v180, v208, v209
    v_fma_f32 v208, v90, v193, v194
    v_fma_f32 v209, v91, v197, v198
    v_cvt_pk_bf16_f32 v181, v208, v209
    v_fma_f32 v208, v92, v193, v194
    v_fma_f32 v209, v93, v197, v198
    v_cvt_pk_bf16_f32 v182, v208, v209
    v_fma_f32 v208, v94, v193, v194
    v_fma_f32 v209, v95, v197, v198
    v_cvt_pk_bf16_f32 v183, v208, v209
    ds_write_b32 v63, v180 offset:256
    ds_write_b32 v63, v181 offset:5120
    ds_write_b32 v63, v182 offset:9984
    ds_write_b32 v63, v183 offset:14848
    s_waitcnt lgkmcnt(0)
    s_barrier
    ds_read_b128 v[212:215], v64 offset:96
    ds_read_b128 v[216:219], v64 offset:64
    ds_read_b128 v[220:223], v64 offset:32
    ds_read_b128 v[224:227], v64 offset:0
    s_waitcnt lgkmcnt(3)
    v_mfma_f32_32x32x16_bf16 v[96:111], v[212:215], v[144:147], 0
    ds_read_b128 v[228:231], v64 offset:224
    ds_read_b64_tr_b16 v[176:177], v65 offset:1056
    ds_read_b64_tr_b16 v[178:179], v65 offset:1024
    ds_read_b64_tr_b16 v[180:181], v65 offset:1184
    ds_read_b64_tr_b16 v[182:183], v65 offset:1152
    s_waitcnt lgkmcnt(7)
    v_mfma_f32_32x32x16_bf16 v[96:111], v[216:219], v[148:151], v[96:111]
    ds_read_b128 v[232:235], v64 offset:192
    ds_read_b64_tr_b16 v[184:185], v65 offset:1312
    ds_read_b64_tr_b16 v[186:187], v65 offset:1280
    ds_read_b64_tr_b16 v[188:189], v65 offset:1440
    ds_read_b64_tr_b16 v[190:191], v65 offset:1408
    s_waitcnt lgkmcnt(11)
    v_mfma_f32_32x32x16_bf16 v[96:111], v[220:223], v[152:155], v[96:111]
    ds_read_b128 v[236:239], v64 offset:160
    ds_read_b64_tr_b16 v[192:193], v65 offset:1568
    ds_read_b64_tr_b16 v[194:195], v65 offset:1536
    ds_read_b64_tr_b16 v[196:197], v65 offset:1696
    ds_read_b64_tr_b16 v[198:199], v65 offset:1664
    s_waitcnt lgkmcnt(15)
    v_mfma_f32_32x32x16_bf16 v[96:111], v[224:227], v[156:159], v[96:111]
    ds_read_b128 v[240:243], v64 offset:128
    ds_read_b64_tr_b16 v[200:201], v65 offset:1824
    ds_read_b64_tr_b16 v[202:203], v65 offset:1792
    ds_read_b64_tr_b16 v[204:205], v65 offset:1952
    ds_read_b64_tr_b16 v[206:207], v65 offset:1920
    s_waitcnt lgkmcnt(15)
    v_mfma_f32_32x32x16_bf16 v[112:127], v[228:231], v[144:147], 0
    v_mov_b32 v248, -1
    v_mov_b32 v249, -1
    v_mov_b32 v250, -1
    v_mov_b32 v251, -1
    s_lshl_b32 s88, s75, 14
    s_add_u32 s88, s88, 9437184
    buffer_store_dwordx4 v[248:251], v62, s[16:19], s88 offen offset:0 sc1
    s_waitcnt lgkmcnt(14)
    v_mfma_f32_32x32x16_bf16 v[112:127], v[232:235], v[148:151], v[112:127]
    v_cndmask_b32 v208, v99, v72, s[76:77]
    v_cndmask_b32 v209, v103, v99, s[76:77]
    v_cndmask_b32 v210, v107, v103, s[76:77]
    v_cndmask_b32 v211, v111, v107, s[76:77]
    v_mov_b32_e64 v72, v111
    s_waitcnt lgkmcnt(9)
    v_mfma_f32_32x32x16_bf16 v[112:127], v[236:239], v[152:155], v[112:127]
    v_add_f32_dpp v98, v208, v98 wave_ror:1 row_mask:0xf bank_mask:0xf
    v_add_f32_dpp v102, v209, v102 wave_ror:1 row_mask:0xf bank_mask:0xf
    v_add_f32_dpp v106, v210, v106 wave_ror:1 row_mask:0xf bank_mask:0xf
    v_add_f32_dpp v110, v211, v110 wave_ror:1 row_mask:0xf bank_mask:0xf
    v_cndmask_b32 v208, v98, v71, s[76:77]
    s_waitcnt lgkmcnt(4)
    v_mfma_f32_32x32x16_bf16 v[112:127], v[240:243], v[156:159], v[112:127]
    v_cndmask_b32 v209, v102, v98, s[76:77]
    v_cndmask_b32 v210, v106, v102, s[76:77]
    v_cndmask_b32 v211, v110, v106, s[76:77]
    v_mov_b32 v71, v110
    v_add_f32_dpp v97, v208, v97 wave_ror:1 row_mask:0xf bank_mask:0xf
    v_add_f32_dpp v101, v209, v101 wave_ror:1 row_mask:0xf bank_mask:0xf
    v_mfma_f32_32x32x16_bf16 v[112:127], v[212:215], v[160:163], v[112:127]
    ds_read_b128 v[244:247], v64 offset:352
    v_add_f32_dpp v105, v210, v105 wave_ror:1 row_mask:0xf bank_mask:0xf
    v_add_f32_dpp v109, v211, v109 wave_ror:1 row_mask:0xf bank_mask:0xf
    v_cndmask_b32 v208, v97, v70, s[76:77]
    v_cndmask_b32 v209, v101, v97, s[76:77]
    v_cndmask_b32 v210, v105, v101, s[76:77]
    v_mfma_f32_32x32x16_bf16 v[112:127], v[216:219], v[164:167], v[112:127]
    ds_read_b128 v[216:219], v64 offset:320
    v_cndmask_b32 v211, v109, v105, s[76:77]
    v_mov_b32_e64 v70, v109
    v_add_f32_dpp v96, v208, v96 wave_ror:1 row_mask:0xf bank_mask:0xf
    v_add_f32_dpp v100, v209, v100 wave_ror:1 row_mask:0xf bank_mask:0xf
    v_add_f32_dpp v104, v210, v104 wave_ror:1 row_mask:0xf bank_mask:0xf
    v_mfma_f32_32x32x16_bf16 v[112:127], v[220:223], v[168:171], v[112:127]
    ds_read_b128 v[220:223], v64 offset:288
    buffer_store_dwordx4 v[248:251], v62, s[16:19], s88 offen offset:1024 sc1
    v_add_f32_dpp v108, v211, v108 wave_ror:1 row_mask:0xf bank_mask:0xf
    v_mfma_f32_32x32x16_bf16 v[112:127], v[224:227], v[172:175], v[112:127]
    ds_read_b128 v[224:227], v64 offset:256
    ds_write_b32 v66, v96 offset:0
    ds_write_b32 v66, v100 offset:64
    s_waitcnt lgkmcnt(5)
    v_mfma_f32_32x32x16_bf16 v[128:143], v[244:247], v[144:147], 0
    ds_write_b32 v66, v104 offset:128
    ds_write_b32 v66, v108 offset:192
    s_nop 0
    s_waitcnt lgkmcnt(6)
    v_mfma_f32_32x32x16_bf16 v[128:143], v[216:219], v[148:151], v[128:143]
    s_nop 3
    v_cndmask_b32 v208, v115, v72, s[76:77]
    s_waitcnt lgkmcnt(5)
    v_mfma_f32_32x32x16_bf16 v[128:143], v[220:223], v[152:155], v[128:143]
    v_cndmask_b32 v209, v119, v115, s[76:77]
    v_cndmask_b32 v210, v123, v119, s[76:77]
    v_cndmask_b32 v211, v127, v123, s[76:77]
    v_mov_b32 v72, v127
    v_add_f32_dpp v114, v208, v114 wave_ror:1 row_mask:0xf bank_mask:0xf
    s_waitcnt lgkmcnt(4)
    v_mfma_f32_32x32x16_bf16 v[128:143], v[224:227], v[156:159], v[128:143]
    v_add_f32_dpp v118, v209, v118 wave_ror:1 row_mask:0xf bank_mask:0xf
    v_add_f32_dpp v122, v210, v122 wave_ror:1 row_mask:0xf bank_mask:0xf
    v_add_f32_dpp v126, v211, v126 wave_ror:1 row_mask:0xf bank_mask:0xf
    v_cndmask_b32 v208, v114, v71, s[76:77]
    v_cndmask_b32 v209, v118, v114, s[76:77]
    v_cndmask_b32 v210, v122, v118, s[76:77]
    v_mfma_f32_32x32x16_bf16 v[128:143], v[228:231], v[160:163], v[128:143]
    buffer_store_dwordx4 v[248:251], v62, s[16:19], s88 offen offset:2048 sc1
    v_cndmask_b32 v211, v126, v122, s[76:77]
    v_mov_b32 v71, v126
    v_add_f32_dpp v113, v208, v113 wave_ror:1 row_mask:0xf bank_mask:0xf
    v_add_f32_dpp v117, v209, v117 wave_ror:1 row_mask:0xf bank_mask:0xf
    v_add_f32_dpp v121, v210, v121 wave_ror:1 row_mask:0xf bank_mask:0xf
    v_mfma_f32_32x32x16_bf16 v[128:143], v[232:235], v[164:167], v[128:143]
    ds_read_b128 v[232:235], v64 offset:64
    v_add_f32_dpp v125, v211, v125 wave_ror:1 row_mask:0xf bank_mask:0xf
    v_cndmask_b32 v208, v113, v70, s[76:77]
    v_cndmask_b32 v209, v117, v113, s[76:77]
    v_cndmask_b32 v210, v121, v117, s[76:77]
    v_cndmask_b32 v211, v125, v121, s[76:77]
    v_mfma_f32_32x32x16_bf16 v[128:143], v[236:239], v[168:171], v[128:143]
    ds_read_b128 v[236:239], v64 offset:32
    v_mov_b32_e64 v70, v125
    v_add_f32_dpp v112, v208, v112 wave_ror:1 row_mask:0xf bank_mask:0xf
    v_add_f32_dpp v116, v209, v116 wave_ror:1 row_mask:0xf bank_mask:0xf
    v_add_f32_dpp v120, v210, v120 wave_ror:1 row_mask:0xf bank_mask:0xf
    v_add_f32_dpp v124, v211, v124 wave_ror:1 row_mask:0xf bank_mask:0xf
    v_mfma_f32_32x32x16_bf16 v[128:143], v[240:243], v[172:175], v[128:143]
    ds_read_b128 v[240:243], v64 offset:0
    ds_write_b32 v66, v112 offset:256
    ds_write_b32 v66, v116 offset:320
    v_mfma_f32_32x32x16_bf16 v[128:143], v[212:215], v[176:179], v[128:143]
    ds_read_b128 v[212:215], v64 offset:480
    ds_write_b32 v66, v120 offset:384
    ds_write_b32 v66, v124 offset:448
    s_waitcnt lgkmcnt(7)
    v_mfma_f32_32x32x16_bf16 v[128:143], v[232:235], v[180:183], v[128:143]
    ds_read_b128 v[232:235], v64 offset:448
    s_waitcnt lgkmcnt(7)
    v_mfma_f32_32x32x16_bf16 v[128:143], v[236:239], v[184:187], v[128:143]
    ds_read_b128 v[236:239], v64 offset:416
    buffer_store_dwordx4 v[248:251], v62, s[16:19], s88 offen offset:3072 sc1
    s_waitcnt lgkmcnt(7)
    v_mfma_f32_32x32x16_bf16 v[128:143], v[240:243], v[188:191], v[128:143]
    ds_read_b128 v[240:243], v64 offset:384
    s_nop 3
    s_waitcnt lgkmcnt(5)
    v_mfma_f32_32x32x16_bf16 v[112:127], v[212:215], v[144:147], 0
    s_nop 4
    s_waitcnt lgkmcnt(2)
    v_mfma_f32_32x32x16_bf16 v[112:127], v[232:235], v[148:151], v[112:127]
    v_cndmask_b32 v208, v131, v72, s[76:77]
    v_cndmask_b32 v209, v135, v131, s[76:77]
    v_cndmask_b32 v210, v139, v135, s[76:77]
    v_cndmask_b32 v211, v143, v139, s[76:77]
    v_mov_b32_e64 v72, v143
    s_waitcnt lgkmcnt(1)
    v_mfma_f32_32x32x16_bf16 v[112:127], v[236:239], v[152:155], v[112:127]
    v_add_f32_dpp v130, v208, v130 wave_ror:1 row_mask:0xf bank_mask:0xf
    v_add_f32_dpp v134, v209, v134 wave_ror:1 row_mask:0xf bank_mask:0xf
    v_add_f32_dpp v138, v210, v138 wave_ror:1 row_mask:0xf bank_mask:0xf
    v_add_f32_dpp v142, v211, v142 wave_ror:1 row_mask:0xf bank_mask:0xf
    v_cndmask_b32 v208, v130, v71, s[76:77]
    s_waitcnt lgkmcnt(0)
    v_mfma_f32_32x32x16_bf16 v[112:127], v[240:243], v[156:159], v[112:127]
    v_cndmask_b32 v209, v134, v130, s[76:77]
    v_cndmask_b32 v210, v138, v134, s[76:77]
    v_cndmask_b32 v211, v142, v138, s[76:77]
    v_mov_b32 v71, v142
    v_add_f32_dpp v129, v208, v129 wave_ror:1 row_mask:0xf bank_mask:0xf
    v_add_f32_dpp v133, v209, v133 wave_ror:1 row_mask:0xf bank_mask:0xf
    v_mfma_f32_32x32x16_bf16 v[112:127], v[244:247], v[160:163], v[112:127]
    v_add_f32_dpp v137, v210, v137 wave_ror:1 row_mask:0xf bank_mask:0xf
    v_add_f32_dpp v141, v211, v141 wave_ror:1 row_mask:0xf bank_mask:0xf
    v_cndmask_b32 v208, v129, v70, s[76:77]
    v_cndmask_b32 v209, v133, v129, s[76:77]
    v_cndmask_b32 v210, v137, v133, s[76:77]
    v_cndmask_b32 v211, v141, v137, s[76:77]
    v_mfma_f32_32x32x16_bf16 v[112:127], v[216:219], v[164:167], v[112:127]
    ds_read_b128 v[240:243], v64 offset:192
    v_mov_b32_e64 v70, v141
    v_add_f32_dpp v128, v208, v128 wave_ror:1 row_mask:0xf bank_mask:0xf
    v_add_f32_dpp v132, v209, v132 wave_ror:1 row_mask:0xf bank_mask:0xf
    v_add_f32_dpp v136, v210, v136 wave_ror:1 row_mask:0xf bank_mask:0xf
    v_add_f32_dpp v140, v211, v140 wave_ror:1 row_mask:0xf bank_mask:0xf
    v_mfma_f32_32x32x16_bf16 v[112:127], v[220:223], v[168:171], v[112:127]
    ds_read_b128 v[220:223], v64 offset:160
    ds_write_b32 v66, v128 offset:512
    ds_write_b32 v66, v132 offset:576
    v_mfma_f32_32x32x16_bf16 v[112:127], v[224:227], v[172:175], v[112:127]
    ds_read_b128 v[224:227], v64 offset:128
    ds_write_b32 v66, v136 offset:640
    ds_write_b32 v66, v140 offset:704
    v_mfma_f32_32x32x16_bf16 v[112:127], v[228:231], v[176:179], v[112:127]
    ds_read_b128 v[236:239], v64 offset:96
    s_waitcnt lgkmcnt(7)
    v_mfma_f32_32x32x16_bf16 v[112:127], v[240:243], v[180:183], v[112:127]
    ds_read_b128 v[240:243], v64 offset:64
    s_waitcnt lgkmcnt(7)
    v_mfma_f32_32x32x16_bf16 v[112:127], v[220:223], v[184:187], v[112:127]
    ds_read_b128 v[220:223], v64 offset:32
    s_waitcnt lgkmcnt(5)
    v_mfma_f32_32x32x16_bf16 v[112:127], v[224:227], v[188:191], v[112:127]
    ds_read_b128 v[224:227], v64 offset:0
    s_waitcnt lgkmcnt(3)
    v_mfma_f32_32x32x16_bf16 v[112:127], v[236:239], v[192:195], v[112:127]
    ds_read_b64_tr_b16 v[216:217], v65 offset:544
    ds_read_b64_tr_b16 v[218:219], v65 offset:512
    s_waitcnt lgkmcnt(4)
    v_mfma_f32_32x32x16_bf16 v[112:127], v[240:243], v[196:199], v[112:127]
    ds_read_b64_tr_b16 v[240:241], v65 offset:1056
    ds_read_b64_tr_b16 v[242:243], v65 offset:1024
    s_waitcnt lgkmcnt(5)
    v_mfma_f32_32x32x16_bf16 v[112:127], v[220:223], v[200:203], v[112:127]
    s_waitcnt lgkmcnt(4)
    v_mfma_f32_32x32x16_bf16 v[112:127], v[224:227], v[204:207], v[112:127]
    ds_read_b64_tr_b16 v[224:225], v65 offset:1568
    ds_read_b64_tr_b16 v[226:227], v65 offset:1536
    s_lshl_b32 s96, s75, 14
    s_add_u32 s96, s96, 6815744
    s_lshl_b32 s97, s24, 12
    s_add_u32 s97, s97, 3477504
    buffer_load_dwordx4 v[248:251], v62, s[16:19], s96 offen offset:2048 sc1
    s_waitcnt lgkmcnt(4)
    v_mfma_f32_32x32x16_bf16 v[144:159], v[212:215], v[216:219], 0
    s_nop 3
    v_cndmask_b32 v208, v115, v72, s[76:77]
    s_waitcnt lgkmcnt(2)
    v_mfma_f32_32x32x16_bf16 v[144:159], v[244:247], v[240:243], v[144:159]
    buffer_load_dwordx4 v[252:255], v62, s[16:19], s96 offen offset:3072 sc1
    v_cndmask_b32 v209, v119, v115, s[76:77]
    v_cndmask_b32 v210, v123, v119, s[76:77]
    v_cndmask_b32 v211, v127, v123, s[76:77]
    v_mov_b32_e64 v72, v127
    v_add_f32_dpp v114, v208, v114 wave_ror:1 row_mask:0xf bank_mask:0xf
    v_mfma_f32_32x32x16_bf16 v[160:175], v[212:215], v[240:243], 0
    ds_read_b64_tr_b16 v[216:217], v65 offset:2080
    ds_read_b64_tr_b16 v[218:219], v65 offset:2048
    v_add_f32_dpp v118, v209, v118 wave_ror:1 row_mask:0xf bank_mask:0xf
    v_add_f32_dpp v122, v210, v122 wave_ror:1 row_mask:0xf bank_mask:0xf
    v_add_f32_dpp v126, v211, v126 wave_ror:1 row_mask:0xf bank_mask:0xf
    s_waitcnt lgkmcnt(2)
    v_mfma_f32_32x32x16_bf16 v[144:159], v[228:231], v[224:227], v[144:159]
    buffer_load_dwordx4 v[96:99], v62, s[16:19], s97 offen offset:0 sc1
    v_cndmask_b32 v208, v114, v71, s[76:77]
    v_cndmask_b32 v209, v118, v114, s[76:77]
    v_cndmask_b32 v210, v122, v118, s[76:77]
    v_cndmask_b32 v211, v126, v122, s[76:77]
    v_mov_b32 v71, v126
    v_mfma_f32_32x32x16_bf16 v[160:175], v[244:247], v[224:227], v[160:175]
    v_add_f32_dpp v113, v208, v113 wave_ror:1 row_mask:0xf bank_mask:0xf
    v_add_f32_dpp v117, v209, v117 wave_ror:1 row_mask:0xf bank_mask:0xf
    v_add_f32_dpp v121, v210, v121 wave_ror:1 row_mask:0xf bank_mask:0xf
    v_add_f32_dpp v125, v211, v125 wave_ror:1 row_mask:0xf bank_mask:0xf
    v_cndmask_b32 v208, v113, v70, s[76:77]
    v_cndmask_b32 v209, v117, v113, s[76:77]
    v_mfma_f32_32x32x16_bf16 v[176:191], v[212:215], v[224:227], 0
    buffer_load_dwordx4 v[100:103], v62, s[16:19], s97 offen offset:1024 sc1
    v_cndmask_b32 v210, v121, v117, s[76:77]
    v_cndmask_b32 v211, v125, v121, s[76:77]
    v_mov_b32 v70, v125
    v_add_f32_dpp v112, v208, v112 wave_ror:1 row_mask:0xf bank_mask:0xf
    s_waitcnt lgkmcnt(0)
    v_mfma_f32_32x32x16_bf16 v[144:159], v[236:239], v[216:219], v[144:159]
    ds_read_b64_tr_b16 v[240:241], v65 offset:2592
    ds_read_b64_tr_b16 v[242:243], v65 offset:2560
    v_add_f32_dpp v116, v209, v116 wave_ror:1 row_mask:0xf bank_mask:0xf
    v_add_f32_dpp v120, v210, v120 wave_ror:1 row_mask:0xf bank_mask:0xf
    v_add_f32_dpp v124, v211, v124 wave_ror:1 row_mask:0xf bank_mask:0xf
    v_mfma_f32_32x32x16_bf16 v[160:175], v[228:231], v[216:219], v[160:175]
    buffer_load_dwordx4 v[104:107], v62, s[16:19], s97 offen offset:2048 sc1
    ds_write_b32 v66, v112 offset:768
    ds_write_b32 v66, v116 offset:832
    v_mfma_f32_32x32x16_bf16 v[176:191], v[244:247], v[216:219], v[176:191]
    ds_write_b32 v66, v120 offset:896
    ds_write_b32 v66, v124 offset:960
    v_mfma_f32_32x32x16_bf16 v[192:207], v[212:215], v[216:219], 0
    ds_read_b64_tr_b16 v[212:213], v65 offset:3104
    ds_read_b64_tr_b16 v[214:215], v65 offset:3072
    buffer_load_dwordx4 v[108:111], v62, s[16:19], s97 offen offset:3072 sc1
    s_waitcnt lgkmcnt(6)
    v_mfma_f32_32x32x16_bf16 v[160:175], v[236:239], v[240:243], v[160:175]
    v_mfma_f32_32x32x16_bf16 v[176:191], v[228:231], v[240:243], v[176:191]
    ds_read_b64_tr_b16 v[224:225], v65 offset:3616
    ds_read_b64_tr_b16 v[226:227], v65 offset:3584
    s_waitcnt vmcnt(6) lgkmcnt(4)
    s_barrier
    v_mfma_f32_32x32x16_bf16 v[192:207], v[244:247], v[240:243], v[192:207]
    ds_read_b64_tr_b16 v[244:245], v65 offset:672
    ds_read_b64_tr_b16 v[246:247], v65 offset:640
    ds_read_b64 v[112:113], v67 offset:0
    ds_read_b64 v[114:115], v67 offset:4224
    ds_read_b64 v[116:117], v67 offset:8448
    s_waitcnt lgkmcnt(7)
    v_mfma_f32_32x32x16_bf16 v[176:191], v[236:239], v[212:215], v[176:191]
    ds_read_b128 v[216:219], v64 offset:320
    ds_read_b64_tr_b16 v[240:241], v65 offset:1184
    ds_read_b64_tr_b16 v[242:243], v65 offset:1152
    ds_read_b64 v[118:119], v67 offset:12672
    ds_read_b64 v[120:121], v67 offset:512
    ds_read_b64 v[122:123], v67 offset:4736
    v_mfma_f32_32x32x16_bf16 v[192:207], v[228:231], v[212:215], v[192:207]
    ds_read_b64 v[124:125], v67 offset:8960
    ds_read_b64 v[126:127], v67 offset:13184
    s_lshl_b32 s25, s75, 14
    s_add_u32 s25, s25, 9437184
    s_waitcnt lgkmcnt(13)
    v_mfma_f32_32x32x16_bf16 v[192:207], v[236:239], v[224:227], v[192:207]
    ds_read_b128 v[228:231], v64 offset:192
    ds_read_b64_tr_b16 v[236:237], v65 offset:1696
    ds_read_b64_tr_b16 v[238:239], v65 offset:1664
    s_waitcnt lgkmcnt(14)
    v_mfma_f32_32x32x16_bf16 v[144:159], v[232:235], v[244:247], v[144:159]
    v_mov_b32 v5, 1
    s_add_u32 s82, s86, 24576
    buffer_atomic_add v5, v6, s[16:19], s82 offen offset:0 sc0 sc1
    s_waitcnt lgkmcnt(8)
    v_mfma_f32_32x32x16_bf16 v[144:159], v[216:219], v[240:243], v[144:159]
    v_mfma_f32_32x32x16_bf16 v[160:175], v[232:235], v[240:243], v[160:175]
    ds_read_b128 v[212:215], v64 offset:64
    ds_read_b64_tr_b16 v[224:225], v65 offset:2208
    ds_read_b64_tr_b16 v[226:227], v65 offset:2176
    s_waitcnt lgkmcnt(3)
    v_mfma_f32_32x32x16_bf16 v[144:159], v[228:231], v[236:239], v[144:159]
    v_mfma_f32_32x32x16_bf16 v[160:175], v[216:219], v[236:239], v[160:175]
    v_add_f32 v112, v112, v80
    v_add_f32 v113, v113, v81
    v_add_f32 v114, v114, v82
    v_add_f32 v115, v115, v83
    v_add_f32 v116, v116, v84
    v_mfma_f32_32x32x16_bf16 v[176:191], v[232:235], v[236:239], v[176:191]
    v_add_f32 v117, v117, v85
    v_add_f32 v118, v118, v86
    v_add_f32 v119, v119, v87
    v_cvt_pk_bf16_f32 v128, v112, v114
    v_cvt_pk_bf16_f32 v129, v116, v118
    s_waitcnt lgkmcnt(0)
    v_mfma_f32_32x32x16_bf16 v[144:159], v[212:215], v[224:227], v[144:159]
    ds_read_b64_tr_b16 v[244:245], v65 offset:2720
    ds_read_b64_tr_b16 v[246:247], v65 offset:2688
    v_cvt_pk_bf16_f32 v130, v113, v115
    v_cvt_pk_bf16_f32 v131, v117, v119
    v_mfma_f32_32x32x16_bf16 v[160:175], v[228:231], v[224:227], v[160:175]
    buffer_store_dwordx4 v[128:131], v62, s[16:19], s25 offen offset:0 sc1
    v_add_f32 v120, v120, v88
    v_add_f32 v121, v121, v89
    v_add_f32 v122, v122, v90
    v_add_f32 v123, v123, v91
    v_add_f32 v124, v124, v92
    v_mfma_f32_32x32x16_bf16 v[176:191], v[216:219], v[224:227], v[176:191]
    v_add_f32 v125, v125, v93
    v_add_f32 v126, v126, v94
    v_add_f32_e64 v127, v127, v95
    v_cvt_pk_bf16_f32 v132, v120, v122
    v_cvt_pk_bf16_f32 v133, v124, v126
    v_cvt_pk_bf16_f32 v134, v121, v123
    v_mfma_f32_32x32x16_bf16 v[192:207], v[232:235], v[224:227], v[192:207]
    ds_read_b64_tr_b16 v[232:233], v65 offset:3232
    ds_read_b64_tr_b16 v[234:235], v65 offset:3200
    v_cvt_pk_bf16_f32 v135, v125, v127
    s_waitcnt lgkmcnt(2)
    v_mfma_f32_32x32x16_bf16 v[160:175], v[212:215], v[244:247], v[160:175]
    buffer_store_dwordx4 v[132:135], v62, s[16:19], s25 offen offset:1024 sc1
    ds_read_b64_tr_b16 v[112:113], v65 offset:32
    ds_read_b64_tr_b16 v[114:115], v65 offset:0
    ds_read_b64_tr_b16 v[116:117], v65 offset:160
    ds_read_b64_tr_b16 v[118:119], v65 offset:128
    ds_read_b64_tr_b16 v[120:121], v65 offset:288
    v_mfma_f32_32x32x16_bf16 v[176:191], v[228:231], v[244:247], v[176:191]
    ds_read_b64_tr_b16 v[240:241], v65 offset:3744
    ds_read_b64_tr_b16 v[242:243], v65 offset:3712
    ds_read_b64_tr_b16 v[122:123], v65 offset:256
    ds_read_b64_tr_b16 v[124:125], v65 offset:416
    ds_read_b64_tr_b16 v[126:127], v65 offset:384
    ds_read_b64_tr_b16 v[128:129], v65 offset:544
    v_mfma_f32_32x32x16_bf16 v[192:207], v[216:219], v[244:247], v[192:207]
    ds_read_b128 v[216:219], v64 offset:416
    ds_read_b64_tr_b16 v[236:237], v65 offset:800
    ds_read_b64_tr_b16 v[238:239], v65 offset:768
    ds_read_b64_tr_b16 v[130:131], v65 offset:512
    ds_read_b64_tr_b16 v[132:133], v65 offset:672
    s_waitcnt lgkmcnt(15)
    v_mfma_f32_32x32x16_bf16 v[176:191], v[212:215], v[232:235], v[176:191]
    ds_read_b128 v[224:227], v64 offset:288
    ds_read_b64_tr_b16 v[244:245], v65 offset:1312
    ds_read_b64_tr_b16 v[246:247], v65 offset:1280
    ds_read_b64_tr_b16 v[134:135], v65 offset:640
    ds_read_b64_tr_b16 v[136:137], v65 offset:800
    ds_read_b64_tr_b16 v[138:139], v65 offset:768
    v_mfma_f32_32x32x16_bf16 v[192:207], v[228:231], v[232:235], v[192:207]
    ds_read_b64_tr_b16 v[140:141], v65 offset:928
    ds_read_b64_tr_b16 v[142:143], v65 offset:896
    s_waitcnt lgkmcnt(15)
    v_mfma_f32_32x32x16_bf16 v[192:207], v[212:215], v[240:243], v[192:207]
    ds_read_b128 v[228:231], v64 offset:160
    ds_read_b64_tr_b16 v[212:213], v65 offset:1824
    ds_read_b64_tr_b16 v[214:215], v65 offset:1792
    s_waitcnt vmcnt(3)
ce_31:
    v_max3_u32 v208, v248, v249, v250
    v_max3_u32 v208, v208, v251, v252
    v_max3_u32 v208, v208, v253, v254
    v_max_u32_e64 v208, v208, v255
    v_cmp_eq_u32 s[82:83], -1, v208
    v_min3_f32 v209, v96, v99, v100
    v_min3_f32 v209, v209, v103, v104
    v_min3_f32 v209, v209, v107, v108
    v_min_f32 v209, v209, v111
    v_cmp_neq_f32 vcc, 0x41000000, v209
    s_nop 0
    s_or_b64 vcc, vcc, s[82:83]
    s_cbranch_vccnz rd_32
rc_33:
    s_waitcnt lgkmcnt(13)
    v_mfma_f32_32x32x16_bf16 v[144:159], v[216:219], v[236:239], v[144:159]
    v_mul_f32 v208, 0x3acccccd, v97
    v_mul_f32 v209, 0x3acccccd, v101
    v_mul_f32 v98, 0x3acccccd, v98
    v_mul_f32 v102, 0x3acccccd, v102
    v_fma_f32 v98, -v208, v208, v98
    s_waitcnt lgkmcnt(8)
    v_mfma_f32_32x32x16_bf16 v[144:159], v[224:227], v[244:247], v[144:159]
    v_fma_f32 v102, -v209, v209, v102
    v_max_f32 v98, 0, v98
    v_max_f32 v102, 0, v102
    v_add_f32 v98, 0x3727c5ac, v98
    v_add_f32 v102, 0x3727c5ac, v102
    v_mfma_f32_32x32x16_bf16 v[160:175], v[216:219], v[244:247], v[160:175]
    ds_read_b64_tr_b16 v[232:233], v65 offset:2336
    ds_read_b64_tr_b16 v[234:235], v65 offset:2304
    v_rsq_f32 v97, v98
    s_waitcnt lgkmcnt(2)
    v_mfma_f32_32x32x16_bf16 v[144:159], v[228:231], v[212:215], v[144:159]
    v_rsq_f32_e64 v101, v102
    v_mul_f32 v98, -v208, v97
    v_mul_f32 v102, -v209, v101
    v_lshlrev_b32_e64 v80, 16, v248
    v_and_b32 v82, 0xffff0000, v248
    v_mfma_f32_32x32x16_bf16 v[160:175], v[224:227], v[212:215], v[160:175]
    v_lshlrev_b32 v84, 16, v249
    v_and_b32 v86, 0xffff0000, v249
    v_lshlrev_b32 v81, 16, v250
    v_and_b32 v83, 0xffff0000, v250
    v_lshlrev_b32_e64 v85, 16, v251
    v_and_b32 v87, 0xffff0000, v251
    v_mfma_f32_32x32x16_bf16 v[176:191], v[216:219], v[212:215], v[176:191]
    v_fma_f32 v208, v80, v97, v98
    v_fma_f32 v209, v81, v101, v102
    v_cvt_pk_bf16_f32 v248, v208, v209
    v_fma_f32 v208, v82, v97, v98
    v_fma_f32 v209, v83, v101, v102
    s_waitcnt lgkmcnt(0)
    v_mfma_f32_32x32x16_bf16 v[144:159], v[220:223], v[232:235], v[144:159]
    ds_read_b64_tr_b16 v[240:241], v65 offset:2848
    ds_read_b64_tr_b16 v[242:243], v65 offset:2816
    v_cvt_pk_bf16_f32 v249, v208, v209
    v_fma_f32 v208, v84, v97, v98
    v_fma_f32 v209, v85, v101, v102
    v_cvt_pk_bf16_f32 v250, v208, v209
    v_mfma_f32_32x32x16_bf16 v[160:175], v[228:231], v[232:235], v[160:175]
    v_fma_f32 v208, v86, v97, v98
    v_fma_f32 v209, v87, v101, v102
    v_cvt_pk_bf16_f32 v251, v208, v209
    v_mfma_f32_32x32x16_bf16 v[176:191], v[224:227], v[232:235], v[176:191]
    ds_write_b32 v63, v248 offset:512
    ds_write_b32 v63, v249 offset:5376
    ds_write_b32 v63, v250 offset:10240
    v_mfma_f32_32x32x16_bf16 v[192:207], v[216:219], v[232:235], v[192:207]
    ds_read_b64_tr_b16 v[216:217], v65 offset:3360
    ds_read_b64_tr_b16 v[218:219], v65 offset:3328
    ds_write_b32 v63, v251 offset:15104
    v_mul_f32 v208, 0x3acccccd, v105
    s_waitcnt lgkmcnt(6)
    v_mfma_f32_32x32x16_bf16 v[160:175], v[220:223], v[240:243], v[160:175]
    v_mul_f32 v209, 0x3acccccd, v109
    v_mul_f32 v106, 0x3acccccd, v106
    v_mul_f32 v110, 0x3acccccd, v110
    v_fma_f32 v106, -v208, v208, v106
    v_fma_f32 v110, -v209, v209, v110
    v_max_f32_e64 v106, 0, v106
    v_mfma_f32_32x32x16_bf16 v[176:191], v[228:231], v[240:243], v[176:191]
    ds_read_b64_tr_b16 v[236:237], v65 offset:3872
    ds_read_b64_tr_b16 v[238:239], v65 offset:3840
    v_max_f32_e64 v110, 0, v110
    v_add_f32 v106, 0x3727c5ac, v106
    v_add_f32 v110, 0x3727c5ac, v110
    v_mfma_f32_32x32x16_bf16 v[192:207], v[224:227], v[240:243], v[192:207]
    ds_read_b128 v[224:227], v64 offset:384
    ds_read_b64_tr_b16 v[244:245], v65 offset:928
    ds_read_b64_tr_b16 v[246:247], v65 offset:896
    v_rsq_f32 v105, v106
    s_waitcnt lgkmcnt(6)
    v_mfma_f32_32x32x16_bf16 v[176:191], v[220:223], v[216:219], v[176:191]
    ds_read_b128 v[212:215], v64 offset:256
    ds_read_b64_tr_b16 v[232:233], v65 offset:1440
    ds_read_b64_tr_b16 v[234:235], v65 offset:1408
    v_rsq_f32_e64 v109, v110
    v_mul_f32 v106, -v208, v105
    v_mfma_f32_32x32x16_bf16 v[192:207], v[228:231], v[216:219], v[192:207]
    v_mul_f32 v110, -v209, v109
    v_lshlrev_b32 v88, 16, v252
    v_and_b32 v90, 0xffff0000, v252
    v_lshlrev_b32 v92, 16, v253
    v_and_b32 v94, 0xffff0000, v253
    s_waitcnt lgkmcnt(6)
    v_mfma_f32_32x32x16_bf16 v[192:207], v[220:223], v[236:239], v[192:207]
    ds_read_b128 v[220:223], v64 offset:128
    ds_read_b64_tr_b16 v[228:229], v65 offset:1952
    ds_read_b64_tr_b16 v[230:231], v65 offset:1920
    v_lshlrev_b32 v89, 16, v254
    v_and_b32 v91, 0xffff0000, v254
    s_waitcnt lgkmcnt(6)
    v_mfma_f32_32x32x16_bf16 v[144:159], v[224:227], v[244:247], v[144:159]
    v_lshlrev_b32 v93, 16, v255
    v_and_b32 v95, 0xffff0000, v255
    v_fma_f32 v208, v88, v105, v106
    v_fma_f32 v209, v89, v109, v110
    v_cvt_pk_bf16_f32 v252, v208, v209
    s_waitcnt lgkmcnt(3)
    v_mfma_f32_32x32x16_bf16 v[144:159], v[212:215], v[232:235], v[144:159]
    v_fma_f32 v208, v90, v105, v106
    v_fma_f32 v209, v91, v109, v110
    v_cvt_pk_bf16_f32 v253, v208, v209
    v_fma_f32 v208, v92, v105, v106
    v_fma_f32 v209, v93, v109, v110
    v_cvt_pk_bf16_f32 v254, v208, v209
    v_mfma_f32_32x32x16_bf16 v[160:175], v[224:227], v[232:235], v[160:175]
    ds_read_b128 v[240:243], v64 offset:0
    ds_read_b64_tr_b16 v[216:217], v65 offset:2464
    ds_read_b64_tr_b16 v[218:219], v65 offset:2432
    v_fma_f32 v208, v94, v105, v106
    v_fma_f32 v209, v95, v109, v110
    s_waitcnt lgkmcnt(3)
    v_mfma_f32_32x32x16_bf16 v[144:159], v[220:223], v[228:231], v[144:159]
    v_cvt_pk_bf16_f32 v255, v208, v209
    ds_write_b32 v63, v252 offset:768
    v_mfma_f32_32x32x16_bf16 v[160:175], v[212:215], v[228:231], v[160:175]
    ds_write_b32 v63, v253 offset:5632
    ds_write_b32 v63, v254 offset:10496
    ds_write_b32 v63, v255 offset:15360
    v_mfma_f32_32x32x16_bf16 v[176:191], v[224:227], v[228:231], v[176:191]
    s_waitcnt vmcnt(2)
    v_cmp_eq_u32 vcc, 19, v5
    s_nop 0
    s_cbranch_vccnz gl_34
gc_35:
    s_lshl_b32 s25, s72, 5
    s_add_u32 s25, s25, 0
    s_sub_u32 s26, s25, 4
    s_waitcnt lgkmcnt(4)
    v_mfma_f32_32x32x16_bf16 v[144:159], v[240:243], v[216:219], v[144:159]
    ds_read_b64_tr_b16 v[236:237], v65 offset:2976
    ds_read_b64_tr_b16 v[238:239], v65 offset:2944
    s_max_i32 s26, s26, 0
    s_lshl_b32 s27, s71, 12
    s_add_u32 s27, s27, 9437184
    s_lshl_b32 s99, s25, 3
    v_mfma_f32_32x32x16_bf16 v[160:175], v[220:223], v[216:219], v[160:175]
    s_lshl_b32 s100, s26, 3
    s_lshl_b32 s92, s24, 12
    s_lshl_b32 s93, s24, 9
    s_add_u32 s99, s99, s27
    s_add_u32 s100, s100, s27
    v_mfma_f32_32x32x16_bf16 v[176:191], v[212:215], v[216:219], v[176:191]
    v_mfma_f32_32x32x16_bf16 v[192:207], v[224:227], v[216:219], v[192:207]
    ds_read_b64_tr_b16 v[224:225], v65 offset:3488
    ds_read_b64_tr_b16 v[226:227], v65 offset:3456
    s_waitcnt lgkmcnt(2)
    v_mfma_f32_32x32x16_bf16 v[160:175], v[240:243], v[236:239], v[160:175]
    v_mfma_f32_32x32x16_bf16 v[176:191], v[220:223], v[236:239], v[176:191]
    ds_read_b64_tr_b16 v[244:245], v65 offset:4000
    ds_read_b64_tr_b16 v[246:247], v65 offset:3968
    v_mfma_f32_32x32x16_bf16 v[192:207], v[212:215], v[236:239], v[192:207]
    s_waitcnt lgkmcnt(2)
    v_mfma_f32_32x32x16_bf16 v[176:191], v[240:243], v[224:227], v[176:191]
    v_mfma_f32_32x32x16_bf16 v[192:207], v[220:223], v[224:227], v[192:207]
    s_waitcnt lgkmcnt(0)
    v_mfma_f32_32x32x16_bf16 v[192:207], v[240:243], v[244:247], v[192:207]
    s_waitcnt lgkmcnt(0)
    s_barrier
    ds_read_b128 v[212:215], v64 offset:608
    ds_read_b128 v[216:219], v64 offset:576
    ds_read_b128 v[220:223], v64 offset:544
    ds_read_b128 v[224:227], v64 offset:512
    s_waitcnt lgkmcnt(3)
    v_mfma_f32_32x32x16_bf16 v[144:159], v[212:215], v[112:115], v[144:159]
    ds_read_b128 v[228:231], v64 offset:736
    s_waitcnt lgkmcnt(3)
    v_mfma_f32_32x32x16_bf16 v[144:159], v[216:219], v[116:119], v[144:159]
    ds_read_b128 v[232:235], v64 offset:704
    s_waitcnt lgkmcnt(3)
    v_mfma_f32_32x32x16_bf16 v[144:159], v[220:223], v[120:123], v[144:159]
    ds_read_b128 v[236:239], v64 offset:672
    s_waitcnt lgkmcnt(3)
    v_mfma_f32_32x32x16_bf16 v[144:159], v[224:227], v[124:127], v[144:159]
    ds_read_b128 v[240:243], v64 offset:640
    s_nop 3
    s_waitcnt lgkmcnt(3)
    v_mfma_f32_32x32x16_bf16 v[160:175], v[228:231], v[112:115], v[160:175]
    s_nop 4
    s_waitcnt lgkmcnt(2)
    v_mfma_f32_32x32x16_bf16 v[160:175], v[232:235], v[116:119], v[160:175]
    v_cndmask_b32 v208, v147, v72, s[76:77]
    v_cndmask_b32 v209, v151, v147, s[76:77]
    v_cndmask_b32 v210, v155, v151, s[76:77]
    v_cndmask_b32 v211, v159, v155, s[76:77]
    v_mov_b32_e64 v72, v159
    s_waitcnt lgkmcnt(1)
    v_mfma_f32_32x32x16_bf16 v[160:175], v[236:239], v[120:123], v[160:175]
    v_add_f32_dpp v146, v208, v146 wave_ror:1 row_mask:0xf bank_mask:0xf
    v_add_f32_dpp v150, v209, v150 wave_ror:1 row_mask:0xf bank_mask:0xf
    v_add_f32_dpp v154, v210, v154 wave_ror:1 row_mask:0xf bank_mask:0xf
    v_add_f32_dpp v158, v211, v158 wave_ror:1 row_mask:0xf bank_mask:0xf
    v_cndmask_b32 v208, v146, v71, s[76:77]
    s_waitcnt lgkmcnt(0)
    v_mfma_f32_32x32x16_bf16 v[160:175], v[240:243], v[124:127], v[160:175]
    v_cndmask_b32 v209, v150, v146, s[76:77]
    v_cndmask_b32 v210, v154, v150, s[76:77]
    v_cndmask_b32 v211, v158, v154, s[76:77]
    v_mov_b32 v71, v158
    v_add_f32_dpp v145, v208, v145 wave_ror:1 row_mask:0xf bank_mask:0xf
    v_add_f32_dpp v149, v209, v149 wave_ror:1 row_mask:0xf bank_mask:0xf
    v_mfma_f32_32x32x16_bf16 v[160:175], v[212:215], v[128:131], v[160:175]
    ds_read_b128 v[244:247], v64 offset:864
    v_add_f32_dpp v153, v210, v153 wave_ror:1 row_mask:0xf bank_mask:0xf
    v_add_f32_dpp v157, v211, v157 wave_ror:1 row_mask:0xf bank_mask:0xf
    v_cndmask_b32 v208, v145, v70, s[76:77]
    v_cndmask_b32 v209, v149, v145, s[76:77]
    v_cndmask_b32 v210, v153, v149, s[76:77]
    v_mfma_f32_32x32x16_bf16 v[160:175], v[216:219], v[132:135], v[160:175]
    ds_read_b128 v[248:251], v64 offset:832
    v_cndmask_b32 v211, v157, v153, s[76:77]
    v_mov_b32_e64 v70, v157
    v_add_f32_dpp v144, v208, v144 wave_ror:1 row_mask:0xf bank_mask:0xf
    v_add_f32_dpp v148, v209, v148 wave_ror:1 row_mask:0xf bank_mask:0xf
    v_add_f32_dpp v152, v210, v152 wave_ror:1 row_mask:0xf bank_mask:0xf
    v_mfma_f32_32x32x16_bf16 v[160:175], v[220:223], v[136:139], v[160:175]
    ds_read_b128 v[252:255], v64 offset:800
    v_add_f32_dpp v156, v211, v156 wave_ror:1 row_mask:0xf bank_mask:0xf
    ds_write_b32 v66, v144 offset:0
    v_mfma_f32_32x32x16_bf16 v[160:175], v[224:227], v[140:143], v[160:175]
    ds_read_b128 v[224:227], v64 offset:768
    ds_write_b32 v66, v148 offset:64
    ds_write_b32 v66, v152 offset:128
    s_waitcnt lgkmcnt(6)
    v_mfma_f32_32x32x16_bf16 v[176:191], v[244:247], v[112:115], v[176:191]
    ds_write_b32 v66, v156 offset:192
    s_nop 2
    s_waitcnt lgkmcnt(6)
    v_mfma_f32_32x32x16_bf16 v[176:191], v[248:251], v[116:119], v[176:191]
    s_nop 2
    v_cndmask_b32 v208, v163, v72, s[76:77]
    v_cndmask_b32 v209, v167, v163, s[76:77]
    s_waitcnt lgkmcnt(5)
    v_mfma_f32_32x32x16_bf16 v[176:191], v[252:255], v[120:123], v[176:191]
    v_cndmask_b32 v210, v171, v167, s[76:77]
    v_cndmask_b32 v211, v175, v171, s[76:77]
    v_mov_b32 v72, v175
    v_add_f32_dpp v162, v208, v162 wave_ror:1 row_mask:0xf bank_mask:0xf
    v_add_f32_dpp v166, v209, v166 wave_ror:1 row_mask:0xf bank_mask:0xf
    s_waitcnt lgkmcnt(3)
    v_mfma_f32_32x32x16_bf16 v[176:191], v[224:227], v[124:127], v[176:191]
    v_add_f32_dpp v170, v210, v170 wave_ror:1 row_mask:0xf bank_mask:0xf
    v_add_f32_dpp v174, v211, v174 wave_ror:1 row_mask:0xf bank_mask:0xf
    v_cndmask_b32 v208, v162, v71, s[76:77]
    v_cndmask_b32 v209, v166, v162, s[76:77]
    v_cndmask_b32 v210, v170, v166, s[76:77]
    v_cndmask_b32 v211, v174, v170, s[76:77]
    v_mfma_f32_32x32x16_bf16 v[176:191], v[228:231], v[128:131], v[176:191]
    ds_read_b64_tr_b16 v[228:229], v65 offset:1056
    ds_read_b64_tr_b16 v[230:231], v65 offset:1024
    v_mov_b32 v71, v174
    v_add_f32_dpp v161, v208, v161 wave_ror:1 row_mask:0xf bank_mask:0xf
    v_add_f32_dpp v165, v209, v165 wave_ror:1 row_mask:0xf bank_mask:0xf
    v_add_f32_dpp v169, v210, v169 wave_ror:1 row_mask:0xf bank_mask:0xf
    v_mfma_f32_32x32x16_bf16 v[176:191], v[232:235], v[132:135], v[176:191]
    ds_read_b64_tr_b16 v[232:233], v65 offset:1184
    ds_read_b64_tr_b16 v[234:235], v65 offset:1152
    v_add_f32_dpp v173, v211, v173 wave_ror:1 row_mask:0xf bank_mask:0xf
    v_cndmask_b32 v208, v161, v70, s[76:77]
    v_cndmask_b32 v209, v165, v161, s[76:77]
    v_cndmask_b32 v210, v169, v165, s[76:77]
    v_mfma_f32_32x32x16_bf16 v[176:191], v[236:239], v[136:139], v[176:191]
    ds_read_b64_tr_b16 v[236:237], v65 offset:1312
    ds_read_b64_tr_b16 v[238:239], v65 offset:1280
    v_cndmask_b32 v211, v173, v169, s[76:77]
    v_mov_b32_e64 v70, v173
    v_add_f32_dpp v160, v208, v160 wave_ror:1 row_mask:0xf bank_mask:0xf
    v_add_f32_dpp v164, v209, v164 wave_ror:1 row_mask:0xf bank_mask:0xf
    v_mfma_f32_32x32x16_bf16 v[176:191], v[240:243], v[140:143], v[176:191]
    ds_read_b128 v[240:243], v64 offset:512
    ds_read_b64_tr_b16 v[224:225], v65 offset:1440
    ds_read_b64_tr_b16 v[226:227], v65 offset:1408
    v_add_f32_dpp v168, v210, v168 wave_ror:1 row_mask:0xf bank_mask:0xf
    v_add_f32_dpp v172, v211, v172 wave_ror:1 row_mask:0xf bank_mask:0xf
    s_waitcnt lgkmcnt(7)
    v_mfma_f32_32x32x16_bf16 v[176:191], v[212:215], v[228:231], v[176:191]
    ds_read_b128 v[212:215], v64 offset:992
    ds_write_b32 v66, v160 offset:256
    ds_write_b32 v66, v164 offset:320
    s_waitcnt lgkmcnt(8)
    v_mfma_f32_32x32x16_bf16 v[176:191], v[216:219], v[232:235], v[176:191]
    ds_read_b128 v[216:219], v64 offset:960
    ds_write_b32 v66, v168 offset:384
    ds_write_b32 v66, v172 offset:448
    s_waitcnt lgkmcnt(9)
    v_mfma_f32_32x32x16_bf16 v[176:191], v[220:223], v[236:239], v[176:191]
    ds_read_b128 v[220:223], v64 offset:928
    s_waitcnt lgkmcnt(7)
    v_mfma_f32_32x32x16_bf16 v[176:191], v[240:243], v[224:227], v[176:191]
    ds_read_b128 v[240:243], v64 offset:896
    s_waitcnt lgkmcnt(2)
    s_barrier
    v_mfma_f32_32x32x16_bf16 v[192:207], v[212:215], v[112:115], v[192:207]
    ds_read_b64 v[144:145], v67 offset:0
    ds_read_b64 v[146:147], v67 offset:4224
    ds_read_b64 v[148:149], v67 offset:8448
    ds_read_b64 v[150:151], v67 offset:12672
    s_lshl_b32 s25, s75, 14
    v_mfma_f32_32x32x16_bf16 v[192:207], v[216:219], v[116:119], v[192:207]
    buffer_load_dword v7, v4, s[16:19], s89 offen offset:0 sc1
    s_add_u32 s25, s25, 9437184
    s_nop 0
    v_cndmask_b32 v208, v179, v72, s[76:77]
    v_cndmask_b32 v209, v183, v179, s[76:77]
    s_waitcnt lgkmcnt(5)
    v_mfma_f32_32x32x16_bf16 v[192:207], v[220:223], v[120:123], v[192:207]
    v_cndmask_b32 v210, v187, v183, s[76:77]
    v_cndmask_b32 v211, v191, v187, s[76:77]
    v_mov_b32 v72, v191
    v_add_f32_dpp v178, v208, v178 wave_ror:1 row_mask:0xf bank_mask:0xf
    v_add_f32_dpp v182, v209, v182 wave_ror:1 row_mask:0xf bank_mask:0xf
    s_waitcnt lgkmcnt(4)
    v_mfma_f32_32x32x16_bf16 v[192:207], v[240:243], v[124:127], v[192:207]
    ds_read_b128 v[212:215], v64 offset:768
    v_add_f32_dpp v186, v210, v186 wave_ror:1 row_mask:0xf bank_mask:0xf
    v_add_f32_dpp v190, v211, v190 wave_ror:1 row_mask:0xf bank_mask:0xf
    v_cndmask_b32 v208, v178, v71, s[76:77]
    v_cndmask_b32 v209, v182, v178, s[76:77]
    v_cndmask_b32 v210, v186, v182, s[76:77]
    v_mfma_f32_32x32x16_bf16 v[192:207], v[244:247], v[128:131], v[192:207]
    ds_read_b128 v[244:247], v64 offset:736
    v_cndmask_b32 v211, v190, v186, s[76:77]
    v_mov_b32 v71, v190
    v_add_f32_dpp v177, v208, v177 wave_ror:1 row_mask:0xf bank_mask:0xf
    v_add_f32_dpp v181, v209, v181 wave_ror:1 row_mask:0xf bank_mask:0xf
    v_add_f32_dpp v185, v210, v185 wave_ror:1 row_mask:0xf bank_mask:0xf
    v_mfma_f32_32x32x16_bf16 v[192:207], v[248:251], v[132:135], v[192:207]
    ds_read_b128 v[248:251], v64 offset:704
    v_add_f32_dpp v189, v211, v189 wave_ror:1 row_mask:0xf bank_mask:0xf
    v_cndmask_b32 v208, v177, v70, s[76:77]
    v_cndmask_b32 v209, v181, v177, s[76:77]
    v_cndmask_b32 v210, v185, v181, s[76:77]
    v_cndmask_b32 v211, v189, v185, s[76:77]
    v_mfma_f32_32x32x16_bf16 v[192:207], v[252:255], v[136:139], v[192:207]
    ds_read_b128 v[252:255], v64 offset:672
    v_mov_b32_e64 v70, v189
    v_add_f32_dpp v176, v208, v176 wave_ror:1 row_mask:0xf bank_mask:0xf
    v_add_f32_dpp v180, v209, v180 wave_ror:1 row_mask:0xf bank_mask:0xf
    v_add_f32_dpp v184, v210, v184 wave_ror:1 row_mask:0xf bank_mask:0xf
    s_waitcnt lgkmcnt(3)
    v_mfma_f32_32x32x16_bf16 v[192:207], v[212:215], v[140:143], v[192:207]
    ds_read_b128 v[216:219], v64 offset:640
    v_add_f32_dpp v188, v211, v188 wave_ror:1 row_mask:0xf bank_mask:0xf
    s_waitcnt lgkmcnt(3)
    v_mfma_f32_32x32x16_bf16 v[192:207], v[244:247], v[228:231], v[192:207]
    ds_read_b128 v[228:231], v64 offset:608
    ds_read_b64_tr_b16 v[220:221], v65 offset:1568
    ds_read_b64_tr_b16 v[222:223], v65 offset:1536
    ds_write_b32 v66, v176 offset:512
    s_waitcnt lgkmcnt(6)
    v_mfma_f32_32x32x16_bf16 v[192:207], v[248:251], v[232:235], v[192:207]
    ds_read_b128 v[232:235], v64 offset:576
    ds_read_b64_tr_b16 v[240:241], v65 offset:1696
    ds_read_b64_tr_b16 v[242:243], v65 offset:1664
    ds_write_b32 v66, v180 offset:576
    s_waitcnt lgkmcnt(9)
    v_mfma_f32_32x32x16_bf16 v[192:207], v[252:255], v[236:239], v[192:207]
    ds_read_b128 v[236:239], v64 offset:544
    ds_read_b64_tr_b16 v[212:213], v65 offset:1824
    ds_read_b64_tr_b16 v[214:215], v65 offset:1792
    ds_write_b32 v66, v184 offset:640
    s_waitcnt lgkmcnt(12)
    v_mfma_f32_32x32x16_bf16 v[192:207], v[216:219], v[224:227], v[192:207]
    ds_read_b128 v[224:227], v64 offset:512
    ds_read_b64_tr_b16 v[244:245], v65 offset:1952
    ds_read_b64_tr_b16 v[246:247], v65 offset:1920
    ds_write_b32 v66, v188 offset:704
    s_waitcnt lgkmcnt(13)
    v_mfma_f32_32x32x16_bf16 v[192:207], v[228:231], v[220:223], v[192:207]
    v_add_f32 v144, v144, v80
    v_add_f32 v145, v145, v81
    v_add_f32 v146, v146, v82
    v_add_f32 v147, v147, v83
    s_waitcnt lgkmcnt(9)
    v_mfma_f32_32x32x16_bf16 v[192:207], v[232:235], v[240:243], v[192:207]
    v_add_f32 v148, v148, v84
    v_add_f32 v149, v149, v85
    v_add_f32 v150, v150, v86
    v_add_f32 v151, v151, v87
    v_cvt_pk_bf16_f32 v160, v144, v146
    s_waitcnt lgkmcnt(5)
    v_mfma_f32_32x32x16_bf16 v[192:207], v[236:239], v[212:215], v[192:207]
    v_cvt_pk_bf16_f32 v161, v148, v150
    v_cvt_pk_bf16_f32 v162, v145, v147
    v_cvt_pk_bf16_f32 v163, v149, v151
    s_waitcnt lgkmcnt(1)
    v_mfma_f32_32x32x16_bf16 v[192:207], v[224:227], v[244:247], v[192:207]
    buffer_store_dwordx4 v[160:163], v62, s[16:19], s25 offen offset:2048 sc1
    s_nop 10
    v_cndmask_b32 v208, v195, v72, s[76:77]
    v_cndmask_b32 v209, v199, v195, s[76:77]
    v_cndmask_b32 v210, v203, v199, s[76:77]
    v_cndmask_b32 v211, v207, v203, s[76:77]
    v_mov_b32_e64 v72, v207
    v_add_f32_dpp v194, v208, v194 wave_ror:1 row_mask:0xf bank_mask:0xf
    v_add_f32_dpp v198, v209, v198 wave_ror:1 row_mask:0xf bank_mask:0xf
    v_add_f32_dpp v202, v210, v202 wave_ror:1 row_mask:0xf bank_mask:0xf
    v_add_f32_dpp v206, v211, v206 wave_ror:1 row_mask:0xf bank_mask:0xf
    v_cndmask_b32 v208, v194, v71, s[76:77]
    v_cndmask_b32 v209, v198, v194, s[76:77]
    v_cndmask_b32 v210, v202, v198, s[76:77]
    v_cndmask_b32 v211, v206, v202, s[76:77]
    v_mov_b32_e64 v71, v206
    v_add_f32_dpp v193, v208, v193 wave_ror:1 row_mask:0xf bank_mask:0xf
    v_add_f32_dpp v197, v209, v197 wave_ror:1 row_mask:0xf bank_mask:0xf
    v_add_f32_dpp v201, v210, v201 wave_ror:1 row_mask:0xf bank_mask:0xf
    v_add_f32_dpp v205, v211, v205 wave_ror:1 row_mask:0xf bank_mask:0xf
    v_cndmask_b32 v208, v193, v70, s[76:77]
    v_cndmask_b32 v209, v197, v193, s[76:77]
    v_cndmask_b32 v210, v201, v197, s[76:77]
    v_cndmask_b32 v211, v205, v201, s[76:77]
    v_mov_b32_e64 v70, v205
    v_add_f32_dpp v192, v208, v192 wave_ror:1 row_mask:0xf bank_mask:0xf
    v_add_f32_dpp v196, v209, v196 wave_ror:1 row_mask:0xf bank_mask:0xf
    v_add_f32_dpp v200, v210, v200 wave_ror:1 row_mask:0xf bank_mask:0xf
    v_add_f32_dpp v204, v211, v204 wave_ror:1 row_mask:0xf bank_mask:0xf
    ds_write_b32 v66, v192 offset:768
    ds_write_b32 v66, v196 offset:832
    ds_write_b32 v66, v200 offset:896
    ds_write_b32 v66, v204 offset:960
    s_waitcnt lgkmcnt(0)
    s_waitcnt vmcnt(1)
    v_cmp_gt_u32_e64 vcc, 1, v7
    s_nop 0
    s_and_b64 vcc, vcc, s[50:51]
    s_cbranch_scc1 ps_36
pc_38:
    s_barrier
    ds_read_b64 v[152:153], v67 offset:512
    ds_read_b64 v[154:155], v67 offset:4736
    ds_read_b64 v[156:157], v67 offset:8960
    ds_read_b64 v[158:159], v67 offset:13184
    s_add_u32 m0, s92, 36352
    s_nop 0
    s_nop 0
    buffer_load_dwordx4 v73, s[16:19], s99 offen offset:0 sc1 lds
    buffer_load_dwordx4 v74, s[16:19], s99 offen offset:1024 sc1 lds
    buffer_load_dwordx4 v75, s[16:19], s99 offen offset:2048 sc1 lds
    buffer_load_dwordx4 v76, s[16:19], s99 offen offset:3072 sc1 lds
    s_add_u32 m0, s93, 53760
    s_add_u32 s99, s99, 524288
    s_mov_b64 exec, s[80:81]
    buffer_load_dwordx4 v77, s[16:19], s100 offen sc1 lds
    s_mov_b64 exec, -1
    s_add_u32 s100, s100, 524288
    s_lshl_b32 s25, s75, 14
    s_add_u32 s25, s25, 9437184
    s_waitcnt lgkmcnt(0)
    v_add_f32 v152, v152, v88
    v_add_f32 v153, v153, v89
    v_add_f32 v154, v154, v90
    v_add_f32 v155, v155, v91
    v_add_f32 v156, v156, v92
    v_add_f32 v157, v157, v93
    v_add_f32 v158, v158, v94
    v_add_f32 v159, v159, v95
    v_cvt_pk_bf16_f32 v164, v152, v154
    v_cvt_pk_bf16_f32 v165, v156, v158
    v_cvt_pk_bf16_f32 v166, v153, v155
    v_cvt_pk_bf16_f32 v167, v157, v159
    buffer_store_dwordx4 v[164:167], v62, s[16:19], s25 offen offset:3072 sc1
    v_mov_b32_e64 v5, 1
    s_add_u32 s82, s86, 24576
    buffer_atomic_add v5, v6, s[16:19], s82 offen offset:4 sc0 sc1
    s_add_u32 m0, s92, 55936
    s_nop 0
    s_nop 0
    buffer_load_dwordx4 v73, s[16:19], s99 offen offset:0 sc1 lds
    buffer_load_dwordx4 v74, s[16:19], s99 offen offset:1024 sc1 lds
    buffer_load_dwordx4 v75, s[16:19], s99 offen offset:2048 sc1 lds
    buffer_load_dwordx4 v76, s[16:19], s99 offen offset:3072 sc1 lds
    s_add_u32 m0, s93, 73344
    s_add_u32 s99, s99, 524288
    s_mov_b64 exec, s[80:81]
    buffer_load_dwordx4 v77, s[16:19], s100 offen sc1 lds
    s_mov_b64 exec, -1
    s_add_u32 s100, s100, 524288
    s_branch ec_27
nc_26:
    v_lshlrev_b32 v2, 3, v4
    v_mov_b32_e64 v5, 1
    v_cndmask_b32 v2, v4, v2, s[50:51]
    buffer_atomic_add v5, v2, s[16:19], s86 offen offset:8 sc1
    buffer_load_dword v7, v4, s[16:19], s87 offen offset:8 sc1
    s_waitcnt vmcnt(0)
    v_cmp_gt_u32 vcc, 12, v7
    s_nop 0
    s_and_b64 vcc, vcc, s[50:51]
    s_cbranch_scc1 ps_39
pc_41:
    v_mov_b32 v100, -1
    v_mov_b32 v101, -1
    v_mov_b32 v102, -1
    v_mov_b32 v103, -1
    v_lshlrev_b32 v104, 4, v0
    s_sub_u32 s88, s2, 160
    s_mul_i32 s88, s88, 57344
    s_min_u32 s88, s88, 5185536
    s_add_u32 s88, s88, 12058624
    buffer_store_dwordx4 v[100:103], v104, s[16:19], s88 offen sc1
    s_add_u32 s88, s88, 4096
    buffer_store_dwordx4 v[100:103], v104, s[16:19], s88 offen sc1
    s_add_u32 s88, s88, 4096
    buffer_store_dwordx4 v[100:103], v104, s[16:19], s88 offen sc1
    s_add_u32 s88, s88, 4096
    buffer_store_dwordx4 v[100:103], v104, s[16:19], s88 offen sc1
    s_add_u32 s88, s88, 4096
    buffer_store_dwordx4 v[100:103], v104, s[16:19], s88 offen sc1
    s_add_u32 s88, s88, 4096
    buffer_store_dwordx4 v[100:103], v104, s[16:19], s88 offen sc1
    s_add_u32 s88, s88, 4096
    buffer_store_dwordx4 v[100:103], v104, s[16:19], s88 offen sc1
    s_add_u32 s88, s88, 4096
    buffer_store_dwordx4 v[100:103], v104, s[16:19], s88 offen sc1
    s_add_u32 s88, s88, 4096
    buffer_store_dwordx4 v[100:103], v104, s[16:19], s88 offen sc1
    s_add_u32 s88, s88, 4096
    buffer_store_dwordx4 v[100:103], v104, s[16:19], s88 offen sc1
    s_add_u32 s88, s88, 4096
    buffer_store_dwordx4 v[100:103], v104, s[16:19], s88 offen sc1
    s_add_u32 s88, s88, 4096
    buffer_store_dwordx4 v[100:103], v104, s[16:19], s88 offen sc1
    s_add_u32 s88, s88, 4096
    buffer_store_dwordx4 v[100:103], v104, s[16:19], s88 offen sc1
    s_add_u32 s88, s88, 4096
    buffer_store_dwordx4 v[100:103], v104, s[16:19], s88 offen sc1
    s_waitcnt vmcnt(0)
    s_barrier
    v_mov_b32_e64 v5, 1
    s_add_u32 s82, s86, 8192
    buffer_atomic_add v5, v6, s[16:19], s82 offen offset:12 sc0 sc1
    s_waitcnt vmcnt(0)
    v_cmp_eq_u32 vcc, 11, v5
    s_nop 0
    s_cbranch_vccnz gl_42
gc_43:
    buffer_load_dword v7, v4, s[16:19], s89 offen offset:0 sc1
    s_waitcnt vmcnt(0)
    v_cmp_gt_u32 vcc, 1, v7
    s_nop 0
    s_and_b64 vcc, vcc, s[50:51]
    s_cbranch_scc1 ps_44
pc_46:
    s_barrier
    s_sub_u32 s3, s2, 160
    s_and_b32 s3, s3, 63
    s_add_u32 s3, s3, 0
    s_and_b32 s25, s3, 3
    s_lshl_b32 s25, s25, 12
    s_lshr_b32 s26, s3, 2
    s_lshl_b32 s26, s26, 7
    s_add_u32 s3, s25, s26
    v_lshrrev_b32 v236, 3, v0
    v_and_b32 v237, 7, v0
    v_lshlrev_b32 v237, 4, v237
    v_lshl_add_u32 v236, v236, 14, v237
    s_sub_u32 s25, s2, 160
    s_cmp_lt_u32 s25, 64
    s_cselect_b32 s25, 0, 1073741824
    v_add_u32_e64 v236, s25, v236
    s_add_u32 s26, s3, 9437184
    buffer_load_dwordx4 v[216:219], v236, s[16:19], s26 offen sc1
    s_add_u32 s26, s26, 524288
    buffer_load_dwordx4 v[220:223], v236, s[16:19], s26 offen sc1
    s_add_u32 s26, s26, 524288
    buffer_load_dwordx4 v[224:227], v236, s[16:19], s26 offen sc1
    s_add_u32 s26, s26, 524288
    buffer_load_dwordx4 v[228:231], v236, s[16:19], s26 offen sc1
    s_add_u32 s26, s26, 524288
    buffer_load_dwordx4 v[232:235], v236, s[16:19], s26 offen sc1
    s_lshl_b32 s25, s72, 5
    s_add_u32 s25, s25, 0
    s_sub_u32 s26, s25, 4
    s_max_i32 s26, s26, 0
    s_lshl_b32 s27, s71, 12
    s_add_u32 s27, s27, 9437184
    s_lshl_b32 s99, s25, 3
    s_lshl_b32 s100, s26, 3
    s_lshl_b32 s92, s24, 12
    s_lshl_b32 s93, s24, 9
    s_add_u32 s99, s99, s27
    s_add_u32 s100, s100, s27
    s_add_u32 m0, s92, 36352
    s_nop 0
    buffer_load_dwordx4 v73, s[16:19], s99 offen offset:0 sc1 lds
    buffer_load_dwordx4 v74, s[16:19], s99 offen offset:1024 sc1 lds
    buffer_load_dwordx4 v75, s[16:19], s99 offen offset:2048 sc1 lds
    buffer_load_dwordx4 v76, s[16:19], s99 offen offset:3072 sc1 lds
    s_add_u32 m0, s93, 53760
    s_add_u32 s99, s99, 524288
    s_mov_b64 exec, s[80:81]
    buffer_load_dwordx4 v77, s[16:19], s100 offen sc1 lds
    s_mov_b64 exec, -1
    s_add_u32 s100, s100, 524288
    s_add_u32 m0, s92, 55936
    s_nop 0
    s_nop 0
    buffer_load_dwordx4 v73, s[16:19], s99 offen offset:0 sc1 lds
    buffer_load_dwordx4 v74, s[16:19], s99 offen offset:1024 sc1 lds
    buffer_load_dwordx4 v75, s[16:19], s99 offen offset:2048 sc1 lds
    buffer_load_dwordx4 v76, s[16:19], s99 offen offset:3072 sc1 lds
    s_add_u32 m0, s93, 73344
    s_add_u32 s99, s99, 524288
    s_mov_b64 exec, s[80:81]
    buffer_load_dwordx4 v77, s[16:19], s100 offen sc1 lds
    s_mov_b64 exec, -1
    s_add_u32 s100, s100, 524288
    s_sub_u32 s85, s2, 160
    s_cmp_ge_u32 s85, 64
    s_cbranch_scc1 s2_47
    v_mov_b32 v238, 0x3f803f80
    s_lshl_b32 s25, s24, 7
    s_add_u32 s25, s25, 134272
    v_lshrrev_b32 v239, 4, v1
    v_lshl_add_u32 v237, v239, 2, v237
    v_add_u32 v237, s25, v237
se_48:
    v_mov_b32 v240, 0
    v_mov_b32 v241, 0
    v_mov_b32 v242, 0
    v_mov_b32 v243, 0
    s_waitcnt vmcnt(14)
    v_dot2c_f32_bf16 v240, v216, v238
    v_dot2c_f32_bf16 v241, v216, v216
    v_dot2c_f32_bf16 v240, v217, v238
    v_dot2c_f32_bf16 v241, v217, v217
    v_dot2c_f32_bf16 v242, v218, v238
    v_dot2c_f32_bf16 v243, v218, v218
    v_dot2c_f32_bf16 v242, v219, v238
    v_dot2c_f32_bf16 v243, v219, v219
    s_waitcnt vmcnt(13)
    v_dot2c_f32_bf16 v240, v220, v238
    v_dot2c_f32_bf16 v241, v220, v220
    v_dot2c_f32_bf16 v240, v221, v238
    v_dot2c_f32_bf16 v241, v221, v221
    v_dot2c_f32_bf16 v242, v222, v238
    v_dot2c_f32_bf16 v243, v222, v222
    v_dot2c_f32_bf16 v242, v223, v238
    v_dot2c_f32_bf16 v243, v223, v223
    s_waitcnt vmcnt(12)
    v_dot2c_f32_bf16 v240, v224, v238
    v_dot2c_f32_bf16 v241, v224, v224
    v_dot2c_f32_bf16 v240, v225, v238
    v_dot2c_f32_bf16 v241, v225, v225
    v_dot2c_f32_bf16 v242, v226, v238
    v_dot2c_f32_bf16 v243, v226, v226
    v_dot2c_f32_bf16 v242, v227, v238
    v_dot2c_f32_bf16 v243, v227, v227
    s_waitcnt vmcnt(11)
    v_dot2c_f32_bf16 v240, v228, v238
    v_dot2c_f32_bf16 v241, v228, v228
    v_dot2c_f32_bf16 v240, v229, v238
    v_dot2c_f32_bf16 v241, v229, v229
    v_dot2c_f32_bf16 v242, v230, v238
    v_dot2c_f32_bf16 v243, v230, v230
    v_dot2c_f32_bf16 v242, v231, v238
    v_dot2c_f32_bf16 v243, v231, v231
    s_waitcnt vmcnt(10)
    v_dot2c_f32_bf16 v240, v232, v238
    v_dot2c_f32_bf16 v241, v232, v232
    v_dot2c_f32_bf16 v240, v233, v238
    v_dot2c_f32_bf16 v241, v233, v233
    v_dot2c_f32_bf16 v242, v234, v238
    v_dot2c_f32_bf16 v243, v234, v234
    v_dot2c_f32_bf16 v242, v235, v238
    v_dot2c_f32_bf16 v243, v235, v235
    s_nop 2
    v_cmp_u_f32 vcc, v241, v243
    s_nop 0
    s_cbranch_vccnz rd_49
rc_50:
    v_permlane32_swap_b32 v240, v242
    v_permlane32_swap_b32 v241, v243
    v_pk_add_f32 v[240:241], v[240:241], v[242:243]
    s_nop 1
    v_permlane16_swap_b32 v240, v241
    v_add_f32 v240, v240, v241
    s_nop 1
    v_add_f32_dpp v240, v240, v240 row_ror:8 row_mask:0xf bank_mask:0xf
    ds_write_b32 v237, v240
    v_and_b32 v236, 15, v0
    v_lshlrev_b32 v236, 3, v236
    v_add_u32 v237, 134272, v236
    v_mov_b32 v239, 1073741824
    v_cmp_gt_u32 vcc, 16, v0
    s_nop 1
    v_cndmask_b32 v236, v239, v236, vcc
    s_add_u32 s25, s3, 3457024
    s_waitcnt lgkmcnt(0)
    s_barrier
    ds_read_b64 v[216:217], v237 offset:0
    ds_read_b64 v[218:219], v237 offset:128
    ds_read_b64 v[220:221], v237 offset:256
    ds_read_b64 v[222:223], v237 offset:384
    s_waitcnt lgkmcnt(2)
    v_pk_add_f32 v[216:217], v[216:217], v[218:219]
    s_waitcnt lgkmcnt(0)
    v_pk_add_f32 v[220:221], v[220:221], v[222:223]
    v_pk_add_f32 v[216:217], v[216:217], v[220:221]
    v_mul_f32 v239, 0x3acccccd, v216
    v_mul_f32 v217, 0x3acccccd, v217
    v_fma_f32 v217, -v239, v239, v217
    v_max_f32 v217, 0, v217
    v_add_f32 v217, 0x3727c5ac, v217
    v_rsq_f32_e64 v216, v217
    s_nop 0
    v_mul_f32 v217, -v239, v216
    buffer_store_dwordx2 v[216:217], v236, s[16:19], s25 offen sc1
s2_47:
ec_27:
ge_51:
    v_add_u32 v196, 36352, v78
    v_mov_b32_e64 v198, v79
    s_waitcnt vmcnt(5)
    s_barrier
    ds_read_b64 v[160:161], v198 offset:0
    ds_read_b64 v[162:163], v198 offset:64
    ds_read_b64 v[164:165], v196 offset:0
    ds_read_b64 v[166:167], v196 offset:512
    ds_read_b64 v[168:169], v196 offset:256
    ds_read_b64 v[170:171], v196 offset:768
    ds_read_b64 v[172:173], v198 offset:256
    ds_read_b64 v[174:175], v198 offset:320
    ds_read_b64 v[176:177], v196 offset:2048
    ds_read_b64 v[178:179], v196 offset:2560
    ds_read_b64 v[180:181], v196 offset:2304
    ds_read_b64 v[182:183], v196 offset:2816
    s_waitcnt lgkmcnt(6)
    v_mfma_f32_16x16x32_bf16 v[112:115], a[0:3], v[160:163], 0
    ds_read_b64 v[184:185], v198 offset:512
    v_mfma_f32_32x32x16_bf16 v[80:95], a[0:3], v[164:167], 0
    ds_read_b64 v[186:187], v198 offset:576
    ds_read_b64 v[188:189], v196 offset:4096
    ds_read_b64 v[190:191], v196 offset:4608
    v_mov_b32 v208, 0
    v_mov_b32_e64 v209, 0
    v_mfma_f32_32x32x16_bf16 v[96:111], a[0:3], v[168:171], 0
    ds_read_b64 v[192:193], v196 offset:4352
    ds_read_b64 v[194:195], v196 offset:4864
    s_add_u32 m0, s92, 75520
    s_nop 0
    buffer_load_dwordx4 v73, s[16:19], s99 offen offset:0 sc1 lds
    s_waitcnt lgkmcnt(6)
    v_mfma_f32_16x16x32_bf16 v[112:115], a[4:7], v[172:175], v[112:115]
    ds_read_b64 v[160:161], v198 offset:768
    v_mfma_f32_32x32x16_bf16 v[80:95], a[4:7], v[176:179], v[80:95]
    ds_read_b64 v[162:163], v198 offset:832
    ds_read_b64 v[164:165], v196 offset:6144
    ds_read_b64 v[166:167], v196 offset:6656
    v_lshrrev_b32_e64 v210, 5, v0
    v_mul_u32_u24 v210, 1600, v210
    v_mfma_f32_32x32x16_bf16 v[96:111], a[4:7], v[180:183], v[96:111]
    ds_read_b64 v[168:169], v196 offset:6400
    ds_read_b64 v[170:171], v196 offset:6912
    buffer_load_dwordx4 v74, s[16:19], s99 offen offset:1024 sc1 lds
    v_and_b32 v211, 31, v0
    s_waitcnt lgkmcnt(6)
    v_mfma_f32_16x16x32_bf16 v[112:115], a[8:11], v[184:187], v[112:115]
    ds_read_b64 v[172:173], v198 offset:1024
    v_mfma_f32_32x32x16_bf16 v[80:95], a[8:11], v[188:191], v[80:95]
    ds_read_b64 v[174:175], v198 offset:1088
    ds_read_b64 v[176:177], v196 offset:8192
    ds_read_b64 v[178:179], v196 offset:8704
    v_min_u32_e64 v211, 19, v211
    v_lshl_add_u32 v210, v211, 3, v210
    v_mfma_f32_32x32x16_bf16 v[96:111], a[8:11], v[192:195], v[96:111]
    ds_read_b64 v[180:181], v196 offset:8448
    ds_read_b64 v[182:183], v196 offset:8960
    buffer_load_dwordx4 v75, s[16:19], s99 offen offset:2048 sc1 lds
    v_add_u32 v210, 6400, v210
    s_waitcnt lgkmcnt(6)
    v_mfma_f32_16x16x32_bf16 v[112:115], a[12:15], v[160:163], v[112:115]
    ds_read_b64 v[184:185], v198 offset:1280
    v_mfma_f32_32x32x16_bf16 v[80:95], a[12:15], v[164:167], v[80:95]
    ds_read_b64 v[186:187], v198 offset:1344
    ds_read_b64 v[188:189], v196 offset:10240
    ds_read_b64 v[190:191], v196 offset:10752
    ds_write_b64 v210, v[208:209]
    v_mfma_f32_32x32x16_bf16 v[96:111], a[12:15], v[168:171], v[96:111]
    ds_read_b64 v[192:193], v196 offset:10496
    ds_read_b64 v[194:195], v196 offset:11008
    buffer_load_dwordx4 v76, s[16:19], s99 offen offset:3072 sc1 lds
    s_waitcnt lgkmcnt(7)
    v_mfma_f32_16x16x32_bf16 v[112:115], a[16:19], v[172:175], v[112:115]
    ds_read_b64 v[160:161], v198 offset:1536
    v_mfma_f32_32x32x16_bf16 v[80:95], a[16:19], v[176:179], v[80:95]
    ds_read_b64 v[162:163], v198 offset:1600
    ds_read_b64 v[164:165], v196 offset:12288
    ds_read_b64 v[166:167], v196 offset:12800
    v_mfma_f32_32x32x16_bf16 v[96:111], a[16:19], v[180:183], v[96:111]
    ds_read_b64 v[168:169], v196 offset:12544
    ds_read_b64 v[170:171], v196 offset:13056
    s_add_u32 m0, s93, 92928
    s_add_u32 s99, s99, 524288
    s_mov_b64 exec, s[80:81]
    buffer_load_dwordx4 v77, s[16:19], s100 offen sc1 lds
    s_mov_b64 exec, -1
    s_add_u32 s100, s100, 524288
    s_waitcnt lgkmcnt(6)
    v_mfma_f32_16x16x32_bf16 v[112:115], a[20:23], v[184:187], v[112:115]
    ds_read_b64 v[172:173], v198 offset:1792
    v_mfma_f32_32x32x16_bf16 v[80:95], a[20:23], v[188:191], v[80:95]
    ds_read_b64 v[174:175], v198 offset:1856
    ds_read_b64 v[176:177], v196 offset:14336
    ds_read_b64 v[178:179], v196 offset:14848
    v_mfma_f32_32x32x16_bf16 v[96:111], a[20:23], v[192:195], v[96:111]
    ds_read_b64 v[180:181], v196 offset:14592
    ds_read_b64 v[182:183], v196 offset:15104
    buffer_load_dword v7, v4, s[16:19], s87 offen offset:12 sc1
    v_cmp_eq_u32 vcc, 19, v5
    s_nop 0
    s_cbranch_vccnz gl_52
gc_53:
    s_waitcnt vmcnt(6)
    s_barrier
    s_waitcnt lgkmcnt(6)
    v_mfma_f32_16x16x32_bf16 v[112:115], a[24:27], v[160:163], v[112:115]
    v_add_u32 v198, v49, v198
    v_mfma_f32_32x32x16_bf16 v[80:95], a[24:27], v[164:167], v[80:95]
    v_add_u32 v196, 19584, v196
    ds_read_b64 v[184:185], v198 offset:0
    ds_read_b64 v[186:187], v198 offset:64
    ds_read_b64 v[188:189], v196 offset:0
    v_mfma_f32_32x32x16_bf16 v[96:111], a[24:27], v[168:171], v[96:111]
    ds_read_b64 v[190:191], v196 offset:512
    ds_read_b64 v[192:193], v196 offset:256
    ds_read_b64 v[194:195], v196 offset:768
    s_add_u32 m0, s92, 95104
    s_nop 0
    buffer_load_dwordx4 v73, s[16:19], s99 offen offset:0 sc1 lds
    s_waitcnt lgkmcnt(6)
    v_mfma_f32_16x16x32_bf16 v[112:115], a[28:31], v[172:175], v[112:115]
    ds_read_b64 v[160:161], v198 offset:256
    v_mfma_f32_32x32x16_bf16 v[80:95], a[28:31], v[176:179], v[80:95]
    ds_read_b64 v[162:163], v198 offset:320
    ds_read_b64 v[164:165], v196 offset:2048
    ds_read_b64 v[166:167], v196 offset:2560
    v_mfma_f32_32x32x16_bf16 v[96:111], a[28:31], v[180:183], v[96:111]
    ds_read_b64 v[168:169], v196 offset:2304
    ds_read_b64 v[170:171], v196 offset:2816
    buffer_load_dwordx4 v74, s[16:19], s99 offen offset:1024 sc1 lds
    s_waitcnt lgkmcnt(6)
    v_mfma_f32_16x16x32_bf16 v[112:115], a[32:35], v[184:187], v[112:115]
    ds_read_b64 v[172:173], v198 offset:512
    v_mfma_f32_32x32x16_bf16 v[80:95], a[32:35], v[188:191], v[80:95]
    ds_read_b64 v[174:175], v198 offset:576
    ds_read_b64 v[176:177], v196 offset:4096
    ds_read_b64 v[178:179], v196 offset:4608
    v_mfma_f32_32x32x16_bf16 v[96:111], a[32:35], v[192:195], v[96:111]
    ds_read_b64 v[180:181], v196 offset:4352
    ds_read_b64 v[182:183], v196 offset:4864
    buffer_load_dwordx4 v75, s[16:19], s99 offen offset:2048 sc1 lds
    s_waitcnt lgkmcnt(6)
    v_mfma_f32_16x16x32_bf16 v[112:115], a[36:39], v[160:163], v[112:115]
    ds_read_b64 v[184:185], v198 offset:768
    v_mfma_f32_32x32x16_bf16 v[80:95], a[36:39], v[164:167], v[80:95]
    ds_read_b64 v[186:187], v198 offset:832
    ds_read_b64 v[188:189], v196 offset:6144
    ds_read_b64 v[190:191], v196 offset:6656
    v_mfma_f32_32x32x16_bf16 v[96:111], a[36:39], v[168:171], v[96:111]
    ds_read_b64 v[192:193], v196 offset:6400
    ds_read_b64 v[194:195], v196 offset:6912
    buffer_load_dwordx4 v76, s[16:19], s99 offen offset:3072 sc1 lds
    s_waitcnt lgkmcnt(6)
    v_mfma_f32_16x16x32_bf16 v[112:115], a[40:43], v[172:175], v[112:115]
    ds_read_b64 v[160:161], v198 offset:1024
    v_mfma_f32_32x32x16_bf16 v[80:95], a[40:43], v[176:179], v[80:95]
    ds_read_b64 v[162:163], v198 offset:1088
    ds_read_b64 v[164:165], v196 offset:8192
    ds_read_b64 v[166:167], v196 offset:8704
    v_mfma_f32_32x32x16_bf16 v[96:111], a[40:43], v[180:183], v[96:111]
    ds_read_b64 v[168:169], v196 offset:8448
    ds_read_b64 v[170:171], v196 offset:8960
    s_add_u32 m0, s93, 112512
    s_add_u32 s99, s99, 524288
    s_mov_b64 exec, s[80:81]
    buffer_load_dwordx4 v77, s[16:19], s100 offen sc1 lds
    s_mov_b64 exec, -1
    s_add_u32 s100, s100, 524288
    s_waitcnt lgkmcnt(6)
    v_mfma_f32_16x16x32_bf16 v[112:115], a[44:47], v[184:187], v[112:115]
    ds_read_b64 v[172:173], v198 offset:1280
    v_mfma_f32_32x32x16_bf16 v[80:95], a[44:47], v[188:191], v[80:95]
    ds_read_b64 v[174:175], v198 offset:1344
    ds_read_b64 v[176:177], v196 offset:10240
    ds_read_b64 v[178:179], v196 offset:10752
    v_mfma_f32_32x32x16_bf16 v[96:111], a[44:47], v[192:195], v[96:111]
    ds_read_b64 v[180:181], v196 offset:10496
    ds_read_b64 v[182:183], v196 offset:11008
    s_add_u32 m0, s92, 114688
    s_nop 0
    buffer_load_dwordx4 v73, s[16:19], s99 offen offset:0 sc1 lds
    s_waitcnt lgkmcnt(6)
    v_mfma_f32_16x16x32_bf16 v[112:115], a[48:51], v[160:163], v[112:115]
    ds_read_b64 v[184:185], v198 offset:1536
    v_mfma_f32_32x32x16_bf16 v[80:95], a[48:51], v[164:167], v[80:95]
    ds_read_b64 v[186:187], v198 offset:1600
    ds_read_b64 v[188:189], v196 offset:12288
    ds_read_b64 v[190:191], v196 offset:12800
    v_mfma_f32_32x32x16_bf16 v[96:111], a[48:51], v[168:171], v[96:111]
    ds_read_b64 v[192:193], v196 offset:12544
    ds_read_b64 v[194:195], v196 offset:13056
    buffer_load_dwordx4 v74, s[16:19], s99 offen offset:1024 sc1 lds
    s_waitcnt lgkmcnt(6)
    v_mfma_f32_16x16x32_bf16 v[112:115], a[52:55], v[172:175], v[112:115]
    ds_read_b64 v[160:161], v198 offset:1792
    v_mfma_f32_32x32x16_bf16 v[80:95], a[52:55], v[176:179], v[80:95]
    ds_read_b64 v[162:163], v198 offset:1856
    ds_read_b64 v[164:165], v196 offset:14336
    ds_read_b64 v[166:167], v196 offset:14848
    v_mfma_f32_32x32x16_bf16 v[96:111], a[52:55], v[180:183], v[96:111]
    ds_read_b64 v[168:169], v196 offset:14592
    ds_read_b64 v[170:171], v196 offset:15104
    buffer_load_dwordx4 v75, s[16:19], s99 offen offset:2048 sc1 lds
    s_waitcnt vmcnt(8)
    v_cmp_gt_u32 vcc, 1, v7
    s_nop 0
    s_and_b64 vcc, vcc, s[50:51]
    s_cbranch_scc1 ps_54
pc_56:
    s_barrier
    s_waitcnt lgkmcnt(6)
    v_mfma_f32_16x16x32_bf16 v[112:115], a[56:59], v[184:187], v[112:115]
    v_add_u32_e64 v198, v49, v198
    v_mfma_f32_32x32x16_bf16 v[80:95], a[56:59], v[188:191], v[80:95]
    v_add_u32 v196, 19584, v196
    ds_read_b64 v[172:173], v198 offset:0
    ds_read_b64 v[174:175], v198 offset:64
    ds_read_b64 v[176:177], v196 offset:0
    v_mfma_f32_32x32x16_bf16 v[96:111], a[56:59], v[192:195], v[96:111]
    ds_read_b64 v[178:179], v196 offset:512
    ds_read_b64 v[180:181], v196 offset:256
    ds_read_b64 v[182:183], v196 offset:768
    buffer_load_dwordx4 v76, s[16:19], s99 offen offset:3072 sc1 lds
    s_waitcnt lgkmcnt(6)
    v_mfma_f32_16x16x32_bf16 v[112:115], a[60:63], v[160:163], v[112:115]
    ds_read_b64 v[184:185], v198 offset:256
    v_mfma_f32_32x32x16_bf16 v[80:95], a[60:63], v[164:167], v[80:95]
    ds_read_b64 v[186:187], v198 offset:320
    ds_read_b64 v[188:189], v196 offset:2048
    ds_read_b64 v[190:191], v196 offset:2560
    v_mfma_f32_32x32x16_bf16 v[96:111], a[60:63], v[168:171], v[96:111]
    ds_read_b64 v[192:193], v196 offset:2304
    ds_read_b64 v[194:195], v196 offset:2816
    s_add_u32 m0, s93, 132096
    s_add_u32 s99, s99, 524288
    s_mov_b64 exec, s[80:81]
    buffer_load_dwordx4 v77, s[16:19], s100 offen sc1 lds
    s_mov_b64 exec, -1
    s_add_u32 s100, s100, 524288
    s_waitcnt lgkmcnt(6)
    v_mfma_f32_16x16x32_bf16 v[112:115], a[64:67], v[172:175], v[112:115]
    ds_read_b64 v[160:161], v198 offset:512
    v_mfma_f32_32x32x16_bf16 v[80:95], a[64:67], v[176:179], v[80:95]
    ds_read_b64 v[162:163], v198 offset:576
    ds_read_b64 v[164:165], v196 offset:4096
    ds_read_b64 v[166:167], v196 offset:4608
    v_mfma_f32_32x32x16_bf16 v[96:111], a[64:67], v[180:183], v[96:111]
    ds_read_b64 v[168:169], v196 offset:4352
    ds_read_b64 v[170:171], v196 offset:4864
    s_lshl_b32 s25, s72, 5
    s_add_u32 s25, s25, 256
    s_sub_u32 s26, s25, 4
    s_max_i32 s26, s26, 0
    s_lshl_b32 s27, s71, 12
    s_add_u32 s27, s27, 9437184
    s_lshl_b32 s99, s25, 3
    s_lshl_b32 s100, s26, 3
    s_lshl_b32 s92, s24, 12
    s_lshl_b32 s93, s24, 9
    s_add_u32 s99, s99, s27
    s_add_u32 s100, s100, s27
    s_waitcnt lgkmcnt(6)
    v_mfma_f32_16x16x32_bf16 v[112:115], a[68:71], v[184:187], v[112:115]
    ds_read_b64 v[172:173], v198 offset:768
    v_mfma_f32_32x32x16_bf16 v[80:95], a[68:71], v[188:191], v[80:95]
    ds_read_b64 v[174:175], v198 offset:832
    ds_read_b64 v[176:177], v196 offset:6144
    ds_read_b64 v[178:179], v196 offset:6656
    v_mfma_f32_32x32x16_bf16 v[96:111], a[68:71], v[192:195], v[96:111]
    ds_read_b64 v[180:181], v196 offset:6400
    ds_read_b64 v[182:183], v196 offset:6912
    s_waitcnt lgkmcnt(6)
    v_mfma_f32_16x16x32_bf16 v[112:115], a[72:75], v[160:163], v[112:115]
    ds_read_b64 v[184:185], v198 offset:1024
    v_mfma_f32_32x32x16_bf16 v[80:95], a[72:75], v[164:167], v[80:95]
    ds_read_b64 v[186:187], v198 offset:1088
    ds_read_b64 v[188:189], v196 offset:8192
    ds_read_b64 v[190:191], v196 offset:8704
    v_mfma_f32_32x32x16_bf16 v[96:111], a[72:75], v[168:171], v[96:111]
    ds_read_b64 v[192:193], v196 offset:8448
    ds_read_b64 v[194:195], v196 offset:8960
    s_waitcnt lgkmcnt(6)
    v_mfma_f32_16x16x32_bf16 v[112:115], a[76:79], v[172:175], v[112:115]
    ds_read_b64 v[160:161], v198 offset:1280
    v_mfma_f32_32x32x16_bf16 v[80:95], a[76:79], v[176:179], v[80:95]
    ds_read_b64 v[162:163], v198 offset:1344
    ds_read_b64 v[164:165], v196 offset:10240
    ds_read_b64 v[166:167], v196 offset:10752
    v_mfma_f32_32x32x16_bf16 v[96:111], a[76:79], v[180:183], v[96:111]
    ds_read_b64 v[168:169], v196 offset:10496
    ds_read_b64 v[170:171], v196 offset:11008
    s_waitcnt lgkmcnt(6)
    v_mfma_f32_16x16x32_bf16 v[112:115], a[80:83], v[184:187], v[112:115]
    ds_read_b64 v[172:173], v198 offset:1536
    v_mfma_f32_32x32x16_bf16 v[80:95], a[80:83], v[188:191], v[80:95]
    ds_read_b64 v[174:175], v198 offset:1600
    ds_read_b64 v[176:177], v196 offset:12288
    ds_read_b64 v[178:179], v196 offset:12800
    v_mfma_f32_32x32x16_bf16 v[96:111], a[80:83], v[192:195], v[96:111]
    ds_read_b64 v[180:181], v196 offset:12544
    ds_read_b64 v[182:183], v196 offset:13056
    s_lshl_b32 s98, s72, 5
    s_add_u32 s98, s98, 0
    s_sub_u32 s95, s98, 4
    s_max_i32 s95, s95, 0
    s_lshl_b32 s94, s98, 3
    s_lshl_b32 s95, s95, 3
    s_add_u32 s94, s94, 3457024
    s_add_u32 s95, s95, 3457024
    s_add_u32 s96, s94, 8192
    buffer_load_dwordx2 v[152:153], v47, s[16:19], s94 offen sc1
    s_waitcnt lgkmcnt(6)
    v_mfma_f32_16x16x32_bf16 v[112:115], a[84:87], v[160:163], v[112:115]
    ds_read_b64 v[184:185], v198 offset:1792
    v_mfma_f32_32x32x16_bf16 v[80:95], a[84:87], v[164:167], v[80:95]
    ds_read_b64 v[186:187], v198 offset:1856
    ds_read_b64 v[188:189], v196 offset:14336
    ds_read_b64 v[190:191], v196 offset:14848
    v_mfma_f32_32x32x16_bf16 v[96:111], a[84:87], v[168:171], v[96:111]
    ds_read_b64 v[192:193], v196 offset:14592
    ds_read_b64 v[194:195], v196 offset:15104
    buffer_load_dwordx2 v[154:155], v47, s[16:19], s96 offen sc1
    s_waitcnt vmcnt(7)
    s_barrier
    s_waitcnt lgkmcnt(6)
    v_mfma_f32_16x16x32_bf16 v[112:115], a[88:91], v[172:175], v[112:115]
    v_add_u32_e64 v198, v49, v198
    v_mfma_f32_32x32x16_bf16 v[80:95], a[88:91], v[176:179], v[80:95]
    v_add_u32 v196, 19584, v196
    ds_read_b64 v[160:161], v198 offset:0
    ds_read_b64 v[162:163], v198 offset:64
    ds_read_b64 v[164:165], v196 offset:0
    v_mfma_f32_32x32x16_bf16 v[96:111], a[88:91], v[180:183], v[96:111]
    ds_read_b64 v[166:167], v196 offset:512
    ds_read_b64 v[168:169], v196 offset:256
    ds_read_b64 v[170:171], v196 offset:768
    buffer_load_dwordx2 v[156:157], v48, s[16:19], s95 offen sc1
    s_waitcnt lgkmcnt(6)
    v_mfma_f32_16x16x32_bf16 v[112:115], a[92:95], v[184:187], v[112:115]
    ds_read_b64 v[172:173], v198 offset:256
    v_mfma_f32_32x32x16_bf16 v[80:95], a[92:95], v[188:191], v[80:95]
    ds_read_b64 v[174:175], v198 offset:320
    ds_read_b64 v[176:177], v196 offset:2048
    ds_read_b64 v[178:179], v196 offset:2560
    v_mfma_f32_32x32x16_bf16 v[96:111], a[92:95], v[192:195], v[96:111]
    ds_read_b64 v[180:181], v196 offset:2304
    ds_read_b64 v[182:183], v196 offset:2816
    buffer_load_dword v7, v4, s[16:19], s89 offen offset:4 sc1
    s_waitcnt lgkmcnt(6)
    v_mfma_f32_16x16x32_bf16 v[112:115], a[96:99], v[160:163], v[112:115]
    ds_read_b64 v[184:185], v198 offset:512
    v_mfma_f32_32x32x16_bf16 v[80:95], a[96:99], v[164:167], v[80:95]
    ds_read_b64 v[186:187], v198 offset:576
    ds_read_b64 v[188:189], v196 offset:4096
    ds_read_b64 v[190:191], v196 offset:4608
    v_mfma_f32_32x32x16_bf16 v[96:111], a[96:99], v[168:171], v[96:111]
    ds_read_b64 v[192:193], v196 offset:4352
    ds_read_b64 v[194:195], v196 offset:4864
    s_waitcnt lgkmcnt(6)
    v_mfma_f32_16x16x32_bf16 v[112:115], a[100:103], v[172:175], v[112:115]
    ds_read_b64 v[160:161], v198 offset:768
    v_mfma_f32_32x32x16_bf16 v[80:95], a[100:103], v[176:179], v[80:95]
    ds_read_b64 v[162:163], v198 offset:832
    ds_read_b64 v[164:165], v196 offset:6144
    ds_read_b64 v[166:167], v196 offset:6656
    v_mfma_f32_32x32x16_bf16 v[96:111], a[100:103], v[180:183], v[96:111]
    ds_read_b64 v[168:169], v196 offset:6400
    ds_read_b64 v[170:171], v196 offset:6912
    s_waitcnt lgkmcnt(6)
    v_mfma_f32_16x16x32_bf16 v[112:115], a[104:107], v[184:187], v[112:115]
    ds_read_b64 v[172:173], v198 offset:1024
    v_mfma_f32_32x32x16_bf16 v[80:95], a[104:107], v[188:191], v[80:95]
    ds_read_b64 v[174:175], v198 offset:1088
    ds_read_b64 v[176:177], v196 offset:8192
    ds_read_b64 v[178:179], v196 offset:8704
    v_mfma_f32_32x32x16_bf16 v[96:111], a[104:107], v[192:195], v[96:111]
    ds_read_b64 v[180:181], v196 offset:8448
    ds_read_b64 v[182:183], v196 offset:8960
    s_waitcnt lgkmcnt(6)
    v_mfma_f32_16x16x32_bf16 v[112:115], a[108:111], v[160:163], v[112:115]
    ds_read_b64 v[184:185], v198 offset:1280
    v_mfma_f32_32x32x16_bf16 v[80:95], a[108:111], v[164:167], v[80:95]
    ds_read_b64 v[186:187], v198 offset:1344
    ds_read_b64 v[188:189], v196 offset:10240
    ds_read_b64 v[190:191], v196 offset:10752
    v_mfma_f32_32x32x16_bf16 v[96:111], a[108:111], v[168:171], v[96:111]
    ds_read_b64 v[192:193], v196 offset:10496
    ds_read_b64 v[194:195], v196 offset:11008
    s_waitcnt lgkmcnt(6)
    v_mfma_f32_16x16x32_bf16 v[112:115], a[112:115], v[172:175], v[112:115]
    ds_read_b64 v[160:161], v198 offset:1536
    v_mfma_f32_32x32x16_bf16 v[80:95], a[112:115], v[176:179], v[80:95]
    ds_read_b64 v[162:163], v198 offset:1600
    ds_read_b64 v[164:165], v196 offset:12288
    ds_read_b64 v[166:167], v196 offset:12800
    v_mfma_f32_32x32x16_bf16 v[96:111], a[112:115], v[180:183], v[96:111]
    ds_read_b64 v[168:169], v196 offset:12544
    ds_read_b64 v[170:171], v196 offset:13056
    s_waitcnt lgkmcnt(6)
    v_mfma_f32_16x16x32_bf16 v[112:115], a[116:119], v[184:187], v[112:115]
    ds_read_b64 v[172:173], v198 offset:1792
    v_mfma_f32_32x32x16_bf16 v[80:95], a[116:119], v[188:191], v[80:95]
    ds_read_b64 v[174:175], v198 offset:1856
    ds_read_b64 v[176:177], v196 offset:14336
    ds_read_b64 v[178:179], v196 offset:14848
    v_mfma_f32_32x32x16_bf16 v[96:111], a[116:119], v[192:195], v[96:111]
    ds_read_b64 v[180:181], v196 offset:14592
    ds_read_b64 v[182:183], v196 offset:15104
sl_57:
    s_waitcnt vmcnt(2)
    v_max3_u32 v2, v152, v153, v154
    s_waitcnt vmcnt(1)
    v_max3_u32 v2, v2, v155, v156
    v_max_u32 v2, v2, v157
    v_cmp_eq_u32 vcc, -1, v2
    s_nop 0
    s_cbranch_vccnz rd_58
rc_59:
    s_waitcnt vmcnt(0)
    v_cmp_gt_u32 vcc, 1, v7
    s_nop 0
    s_and_b64 vcc, vcc, s[50:51]
    s_cbranch_scc1 ps_60
pc_62:
    s_barrier
    s_waitcnt lgkmcnt(6)
    v_mfma_f32_16x16x32_bf16 v[112:115], a[120:123], v[160:163], v[112:115]
    v_add_u32_e64 v198, v49, v198
    v_mfma_f32_32x32x16_bf16 v[80:95], a[120:123], v[164:167], v[80:95]
    v_add_u32 v196, 19584, v196
    ds_read_b64 v[184:185], v198 offset:0
    ds_read_b64 v[186:187], v198 offset:64
    v_mul_f32 v148, v24, v157
    v_mul_f32 v149, v25, v157
    v_mfma_f32_32x32x16_bf16 v[96:111], a[120:123], v[168:171], v[96:111]
    ds_read_b64 v[188:189], v196 offset:0
    ds_read_b64 v[190:191], v196 offset:512
    s_sub_u32 s3, s2, 160
    s_and_b32 s3, s3, 63
    s_add_u32 s3, s3, 64
    s_and_b32 s25, s3, 3
    s_lshl_b32 s25, s25, 12
    s_lshr_b32 s26, s3, 2
    s_lshl_b32 s26, s26, 7
    s_add_u32 s3, s25, s26
    v_lshrrev_b32 v236, 3, v0
    v_and_b32 v237, 7, v0
    v_lshlrev_b32 v237, 4, v237
    v_lshl_add_u32 v236, v236, 14, v237
    s_sub_u32 s25, s2, 160
    s_cmp_lt_u32 s25, 64
    s_cselect_b32 s25, 0, 1073741824
    v_add_u32_e64 v236, s25, v236
    s_add_u32 s26, s3, 9437184
    buffer_load_dwordx4 v[216:219], v236, s[16:19], s26 offen sc1
    v_mul_f32 v150, v26, v157
    v_mul_f32_e64 v151, v27, v157
    s_waitcnt lgkmcnt(4)
    v_mfma_f32_16x16x32_bf16 v[112:115], a[124:127], v[172:175], v[112:115]
    ds_read_b64 v[192:193], v198 offset:256
    v_mfma_f32_32x32x16_bf16 v[80:95], a[124:127], v[176:179], v[80:95]
    ds_read_b64 v[194:195], v198 offset:320
    ds_read_b64 v[160:161], v196 offset:2048
    v_mul_f32 v116, v8, v153
    v_mul_f32 v117, v9, v153
    v_mul_f32_e64 v118, v10, v153
    v_mfma_f32_32x32x16_bf16 v[96:111], a[124:127], v[180:183], v[96:111]
    ds_read_b64 v[162:163], v196 offset:2560
    s_add_u32 s26, s26, 524288
    buffer_load_dwordx4 v[220:223], v236, s[16:19], s26 offen sc1
    v_mul_f32 v119, v11, v153
    v_mul_f32_e64 v120, v12, v153
    s_waitcnt lgkmcnt(4)
    v_mfma_f32_16x16x32_bf16 v[112:115], a[128:131], v[184:187], v[112:115]
    ds_read_b64 v[164:165], v198 offset:512
    v_mfma_f32_32x32x16_bf16 v[80:95], a[128:131], v[188:191], v[80:95]
    ds_read_b64 v[166:167], v198 offset:576
    ds_read_b64 v[168:169], v196 offset:4096
    ds_read_b64 v[170:171], v196 offset:4608
    v_mul_f32 v121, v13, v153
    v_mul_f32_e64 v122, v14, v153
    s_waitcnt lgkmcnt(4)
    v_mfma_f32_16x16x32_bf16 v[112:115], a[132:135], v[192:195], v[112:115]
    ds_read_b64 v[172:173], v198 offset:768
    v_mfma_f32_32x32x16_bf16 v[80:95], a[132:135], v[160:163], v[80:95]
    ds_read_b64 v[174:175], v198 offset:832
    ds_read_b64 v[176:177], v196 offset:6144
    ds_read_b64 v[178:179], v196 offset:6656
    s_add_u32 s26, s26, 524288
    buffer_load_dwordx4 v[224:227], v236, s[16:19], s26 offen sc1
    v_mul_f32 v123, v15, v153
    v_mul_f32_e64 v124, v16, v153
    s_waitcnt lgkmcnt(4)
    v_mfma_f32_16x16x32_bf16 v[112:115], a[136:139], v[164:167], v[112:115]
    ds_read_b64 v[180:181], v198 offset:1024
    v_mfma_f32_32x32x16_bf16 v[80:95], a[136:139], v[168:171], v[80:95]
    ds_read_b64 v[182:183], v198 offset:1088
    ds_read_b64 v[184:185], v196 offset:8192
    ds_read_b64 v[186:187], v196 offset:8704
    v_mul_f32 v125, v17, v153
    v_mul_f32_e64 v126, v18, v153
    s_waitcnt lgkmcnt(4)
    v_mfma_f32_16x16x32_bf16 v[112:115], a[140:143], v[172:175], v[112:115]
    ds_read_b64 v[188:189], v198 offset:1280
    v_mfma_f32_32x32x16_bf16 v[80:95], a[140:143], v[176:179], v[80:95]
    ds_read_b64 v[190:191], v198 offset:1344
    ds_read_b64 v[192:193], v196 offset:10240
    ds_read_b64 v[194:195], v196 offset:10752
    s_add_u32 s26, s26, 524288
    buffer_load_dwordx4 v[228:231], v236, s[16:19], s26 offen sc1
    v_mul_f32 v127, v19, v153
    v_mul_f32_e64 v128, v20, v153
    s_waitcnt lgkmcnt(4)
    v_mfma_f32_16x16x32_bf16 v[112:115], a[144:147], v[180:183], v[112:115]
    ds_read_b64 v[160:161], v198 offset:1536
    v_mfma_f32_32x32x16_bf16 v[80:95], a[144:147], v[184:187], v[80:95]
    ds_read_b64 v[162:163], v198 offset:1600
    ds_read_b64 v[164:165], v196 offset:12288
    ds_read_b64 v[166:167], v196 offset:12800
    v_mul_f32 v129, v21, v153
    v_mul_f32_e64 v130, v22, v153
    s_waitcnt lgkmcnt(4)
    v_mfma_f32_16x16x32_bf16 v[112:115], a[148:151], v[188:191], v[112:115]
    ds_read_b64 v[168:169], v198 offset:1792
    v_mfma_f32_32x32x16_bf16 v[80:95], a[148:151], v[192:195], v[80:95]
    ds_read_b64 v[170:171], v198 offset:1856
    ds_read_b64 v[172:173], v196 offset:14336
    ds_read_b64 v[174:175], v196 offset:14848
    s_add_u32 s26, s26, 524288
    buffer_load_dwordx4 v[232:235], v236, s[16:19], s26 offen sc1
    v_mul_f32 v131, v23, v153
    v_mul_f32_e64 v132, v8, v155
    s_waitcnt lgkmcnt(4)
    v_mfma_f32_16x16x32_bf16 v[112:115], a[152:155], v[160:163], v[112:115]
    ds_read_b64 v[176:177], v196 offset:256
    v_mfma_f32_32x32x16_bf16 v[80:95], a[152:155], v[164:167], v[80:95]
    ds_read_b64 v[178:179], v196 offset:768
    ds_read_b64 v[180:181], v196 offset:2304
    ds_read_b64 v[182:183], v196 offset:2816
    v_mul_f32 v133, v9, v155
    v_mul_f32_e64 v134, v10, v155
    s_waitcnt lgkmcnt(4)
    v_mfma_f32_16x16x32_bf16 v[112:115], a[156:159], v[168:171], v[112:115]
    ds_read_b64 v[184:185], v196 offset:4352
    v_mfma_f32_32x32x16_bf16 v[80:95], a[156:159], v[172:175], v[80:95]
    ds_read_b64 v[186:187], v196 offset:4864
    ds_read_b64 v[188:189], v196 offset:6400
    ds_read_b64 v[190:191], v196 offset:6912
    s_add_u32 m0, s92, 36352
    s_nop 0
    buffer_load_dwordx4 v73, s[16:19], s99 offen offset:0 sc1 lds
    v_mul_f32 v135, v11, v155
    v_mul_f32 v136, v12, v155
    v_mul_f32 v137, v13, v155
    v_mul_f32 v138, v14, v155
    v_mul_f32 v139, v15, v155
    v_mul_f32 v140, v16, v155
    v_mul_f32 v141, v17, v155
    v_mul_f32 v142, v18, v155
    v_mul_f32 v143, v19, v155
    v_mul_f32 v144, v20, v155
    v_mul_f32 v145, v21, v155
    v_mul_f32 v146, v22, v155
    v_mul_f32_e64 v147, v23, v155
    s_waitcnt lgkmcnt(4)
    v_mfma_f32_32x32x16_bf16 v[96:111], a[128:131], v[176:179], v[96:111]
    ds_read_b64 v[192:193], v196 offset:8448
    ds_read_b64 v[194:195], v196 offset:8960
    v_mfma_f32_32x32x16_bf16 v[96:111], a[132:135], v[180:183], v[96:111]
    ds_read_b64 v[160:161], v196 offset:10496
    ds_read_b64 v[162:163], v196 offset:11008
    buffer_load_dwordx4 v74, s[16:19], s99 offen offset:1024 sc1 lds
    v_fma_f32 v112, v112, v156, v148
    v_fma_f32 v113, v113, v156, v149
    s_waitcnt lgkmcnt(4)
    v_mfma_f32_32x32x16_bf16 v[96:111], a[136:139], v[184:187], v[96:111]
    ds_read_b64 v[164:165], v196 offset:12544
    ds_read_b64 v[166:167], v196 offset:13056
    v_fma_f32 v114, v114, v156, v150
    v_fma_f32 v115, v115, v156, v151
    v_cvt_pk_bf16_f32 v112, v112, v113
    v_mfma_f32_32x32x16_bf16 v[96:111], a[140:143], v[188:191], v[96:111]
    ds_read_b64 v[168:169], v196 offset:14592
    ds_read_b64 v[170:171], v196 offset:15104
    buffer_load_dwordx4 v75, s[16:19], s99 offen offset:2048 sc1 lds
    v_cvt_pk_bf16_f32 v113, v114, v115
    v_fma_f32 v80, v80, v152, v116
    s_waitcnt lgkmcnt(4)
    v_mfma_f32_32x32x16_bf16 v[96:111], a[144:147], v[192:195], v[96:111]
    v_fma_f32 v81, v81, v152, v117
    v_fma_f32 v82, v82, v152, v118
    v_fma_f32 v83, v83, v152, v119
    v_cvt_pk_bf16_f32 v80, v80, v81
    v_cvt_pk_bf16_f32 v81, v82, v83
    v_mfma_f32_32x32x16_bf16 v[96:111], a[148:151], v[160:163], v[96:111]
    ds_write_b64 v40, v[112:113] offset:0
    ds_write_b64 v38, v[80:81] offset:0
    v_fma_f32 v84, v84, v152, v120
    v_fma_f32 v85, v85, v152, v121
    s_waitcnt lgkmcnt(2)
    v_mfma_f32_32x32x16_bf16 v[96:111], a[152:155], v[164:167], v[96:111]
    v_fma_f32 v86, v86, v152, v122
    v_fma_f32 v87, v87, v152, v123
    v_cvt_pk_bf16_f32 v84, v84, v85
    v_cvt_pk_bf16_f32 v85, v86, v87
    v_fma_f32 v88, v88, v152, v124
    v_mfma_f32_32x32x16_bf16 v[96:111], a[156:159], v[168:171], v[96:111]
    buffer_load_dwordx4 v76, s[16:19], s99 offen offset:3072 sc1 lds
    v_fma_f32 v89, v89, v152, v125
    v_fma_f32 v90, v90, v152, v126
    v_fma_f32 v91, v91, v152, v127
    v_cvt_pk_bf16_f32 v88, v88, v89
    v_cvt_pk_bf16_f32 v89, v90, v91
    ds_write_b64 v38, v[84:85] offset:6400
    ds_write_b64 v38, v[88:89] offset:12800
    v_fma_f32 v92, v92, v152, v128
    v_fma_f32 v93, v93, v152, v129
    v_fma_f32 v94, v94, v152, v130
    v_fma_f32 v95, v95, v152, v131
    v_cvt_pk_bf16_f32 v92, v92, v93
    v_cvt_pk_bf16_f32 v93, v94, v95
    ds_write_b64 v39, v[92:93] offset:0
    v_pk_fma_f32 v[96:97], v[96:97], v[154:155], v[132:133] op_sel_hi:[1,0,1]
    v_pk_fma_f32 v[98:99], v[98:99], v[154:155], v[134:135] op_sel_hi:[1,0,1]
    v_cvt_pk_bf16_f32 v96, v96, v97
    v_cvt_pk_bf16_f32 v97, v98, v99
    v_pk_fma_f32 v[100:101], v[100:101], v[154:155], v[136:137] op_sel_hi:[1,0,1]
    v_pk_fma_f32 v[102:103], v[102:103], v[154:155], v[138:139] op_sel_hi:[1,0,1]
    v_cvt_pk_bf16_f32 v100, v100, v101
    v_cvt_pk_bf16_f32 v101, v102, v103
    ds_write_b64 v38, v[96:97] offset:1600
    ds_write_b64 v38, v[100:101] offset:8000
    v_pk_fma_f32 v[104:105], v[104:105], v[154:155], v[140:141] op_sel_hi:[1,0,1]
    v_pk_fma_f32 v[106:107], v[106:107], v[154:155], v[142:143] op_sel_hi:[1,0,1]
    v_cvt_pk_bf16_f32 v104, v104, v105
    v_cvt_pk_bf16_f32 v105, v106, v107
    v_pk_fma_f32 v[108:109], v[108:109], v[154:155], v[144:145] op_sel_hi:[1,0,1]
    v_pk_fma_f32 v[110:111], v[110:111], v[154:155], v[146:147] op_sel_hi:[1,0,1]
    v_cvt_pk_bf16_f32 v108, v108, v109
    v_cvt_pk_bf16_f32 v109, v110, v111
    ds_write_b64 v38, v[104:105] offset:14400
    ds_write_b64 v39, v[108:109] offset:1600
    v_cmp_u_f32 vcc, v82, v114
    v_cmp_u_f32 s[82:83], v98, v98
    s_lshl_b32 s25, s24, 2
    s_add_u32 s25, s25, 160256
    s_or_b64 vcc, vcc, s[82:83]
    s_cselect_b32 s26, 1, 0
    v_mov_b32 v196, s25
    v_mov_b32 v197, s26
    ds_write_b32 v196, v197
    s_waitcnt lgkmcnt(0)
    s_barrier
    s_sub_u32 s85, s2, 160
    s_cmp_ge_u32 s85, 64
    s_cbranch_scc1 s2_63
    v_mov_b32 v238, 0x3f803f80
    s_lshl_b32 s25, s24, 7
    s_add_u32 s25, s25, 134272
    v_lshrrev_b32 v239, 4, v1
    v_lshl_add_u32 v237, v239, 2, v237
    v_add_u32 v237, s25, v237
se_64:
    v_mov_b32 v240, 0
    v_mov_b32 v241, 0
    v_mov_b32 v242, 0
    v_mov_b32 v243, 0
    s_waitcnt vmcnt(8)
    v_dot2c_f32_bf16 v240, v216, v238
    v_dot2c_f32_bf16 v241, v216, v216
    v_dot2c_f32_bf16 v240, v217, v238
    v_dot2c_f32_bf16 v241, v217, v217
    v_dot2c_f32_bf16 v242, v218, v238
    v_dot2c_f32_bf16 v243, v218, v218
    v_dot2c_f32_bf16 v242, v219, v238
    v_dot2c_f32_bf16 v243, v219, v219
    s_waitcnt vmcnt(7)
    v_dot2c_f32_bf16 v240, v220, v238
    v_dot2c_f32_bf16 v241, v220, v220
    v_dot2c_f32_bf16 v240, v221, v238
    v_dot2c_f32_bf16 v241, v221, v221
    v_dot2c_f32_bf16 v242, v222, v238
    v_dot2c_f32_bf16 v243, v222, v222
    v_dot2c_f32_bf16 v242, v223, v238
    v_dot2c_f32_bf16 v243, v223, v223
    s_waitcnt vmcnt(6)
    v_dot2c_f32_bf16 v240, v224, v238
    v_dot2c_f32_bf16 v241, v224, v224
    v_dot2c_f32_bf16 v240, v225, v238
    v_dot2c_f32_bf16 v241, v225, v225
    v_dot2c_f32_bf16 v242, v226, v238
    v_dot2c_f32_bf16 v243, v226, v226
    v_dot2c_f32_bf16 v242, v227, v238
    v_dot2c_f32_bf16 v243, v227, v227
    s_waitcnt vmcnt(5)
    v_dot2c_f32_bf16 v240, v228, v238
    v_dot2c_f32_bf16 v241, v228, v228
    v_dot2c_f32_bf16 v240, v229, v238
    v_dot2c_f32_bf16 v241, v229, v229
    v_dot2c_f32_bf16 v242, v230, v238
    v_dot2c_f32_bf16 v243, v230, v230
    v_dot2c_f32_bf16 v242, v231, v238
    v_dot2c_f32_bf16 v243, v231, v231
    s_waitcnt vmcnt(4)
    v_dot2c_f32_bf16 v240, v232, v238
    v_dot2c_f32_bf16 v241, v232, v232
    v_dot2c_f32_bf16 v240, v233, v238
    v_dot2c_f32_bf16 v241, v233, v233
    v_dot2c_f32_bf16 v242, v234, v238
    v_dot2c_f32_bf16 v243, v234, v234
    v_dot2c_f32_bf16 v242, v235, v238
    v_dot2c_f32_bf16 v243, v235, v235
    s_nop 2
    v_cmp_u_f32 vcc, v241, v243
    s_nop 0
    s_cbranch_vccnz rd_65
rc_66:
    v_permlane32_swap_b32 v240, v242
    v_permlane32_swap_b32 v241, v243
    v_pk_add_f32 v[240:241], v[240:241], v[242:243]
    s_nop 1
    v_permlane16_swap_b32 v240, v241
    v_add_f32_e64 v240, v240, v241
    s_nop 1
    v_add_f32_dpp v240, v240, v240 row_ror:8 row_mask:0xf bank_mask:0xf
    ds_write_b32 v237, v240
    v_and_b32 v236, 15, v0
    v_lshlrev_b32 v236, 3, v236
    v_add_u32 v237, 134272, v236
    v_mov_b32 v239, 1073741824
    v_cmp_gt_u32 vcc, 16, v0
    s_nop 1
    v_cndmask_b32 v236, v239, v236, vcc
    s_add_u32 s25, s3, 3457024
    s_waitcnt lgkmcnt(0)
    s_barrier
    ds_read_b64 v[216:217], v237 offset:0
    ds_read_b64 v[218:219], v237 offset:128
    ds_read_b64 v[220:221], v237 offset:256
    ds_read_b64 v[222:223], v237 offset:384
    s_waitcnt lgkmcnt(2)
    v_pk_add_f32 v[216:217], v[216:217], v[218:219]
    s_waitcnt lgkmcnt(0)
    v_pk_add_f32 v[220:221], v[220:221], v[222:223]
    v_pk_add_f32 v[216:217], v[216:217], v[220:221]
    v_mul_f32 v239, 0x3acccccd, v216
    v_mul_f32 v217, 0x3acccccd, v217
    v_fma_f32 v217, -v239, v239, v217
    v_max_f32 v217, 0, v217
    v_add_f32 v217, 0x3727c5ac, v217
    v_rsq_f32_e64 v216, v217
    s_nop 0
    v_mul_f32 v217, -v239, v216
    buffer_store_dwordx2 v[216:217], v236, s[16:19], s25 offen sc1
s2_63:
    v_mov_b32 v158, 160256
    ds_read_b128 v[128:131], v158
    v_mov_b32 v94, 0
    v_mov_b32 v95, 0
    v_mov_b32 v98, 0
    v_mov_b32 v99, 0
    s_mov_b64 exec, 0xffff
    ds_read_b64 v[94:95], v42 offset:320
    ds_read_b64 v[98:99], v42 offset:640
    s_mov_b64 exec, -1
    s_nop 0
    ds_read_b64 v[92:93], v41 offset:320
    ds_read_b64 v[96:97], v41 offset:640
    ds_read_b64 v[84:85], v41 offset:6720
    ds_read_b64 v[86:87], v42 offset:6720
    ds_read_b64 v[80:81], v41 offset:6400
    ds_read_b64 v[82:83], v42 offset:6400
    ds_read_b64 v[88:89], v41 offset:7040
    ds_read_b64 v[90:91], v42 offset:7040
    ds_read_b64_tr_b16 v[106:107], v44 offset:0
    ds_read_b64_tr_b16 v[100:101], v43 offset:0
    s_add_u32 m0, s93, 53760
    s_add_u32 s99, s99, 524288
    s_mov_b64 exec, s[80:81]
    buffer_load_dwordx4 v77, s[16:19], s100 offen sc1 lds
    s_mov_b64 exec, -1
    s_add_u32 s100, s100, 524288
    ds_read_b64_tr_b16 v[108:109], v44 offset:320
    ds_read_b64_tr_b16 v[102:103], v43 offset:320
    ds_read_b64_tr_b16 v[110:111], v44 offset:640
    ds_read_b64_tr_b16 v[104:105], v43 offset:640
    v_mov_b32 v156, 0xf149f2ca
    v_cndmask_b32 v152, v32, v156, s[90:91]
    v_cndmask_b32 v153, v33, v156, s[90:91]
    v_cndmask_b32 v154, v34, v156, s[90:91]
    s_add_u32 m0, s92, 55936
    s_nop 0
    buffer_load_dwordx4 v73, s[16:19], s99 offen offset:0 sc1 lds
    v_cndmask_b32 v155, v35, v156, s[90:91]
    s_mov_b32 s82, 0x3ea52b5c
    s_lshl_b32 s25, s98, 4
    s_add_u32 s25, s25, 12058624
    s_lshl_b32 s26, s98, 3
    s_add_u32 s26, s26, 12058624
    s_waitcnt lgkmcnt(15)
    v_or3_b32 v128, v128, v129, v130
    v_or_b32 v128, v128, v131
    buffer_load_dwordx4 v74, s[16:19], s99 offen offset:1024 sc1 lds
    v_cmp_ne_u32_e64 vcc, 0, v128
    s_nop 0
    s_cbranch_vccnz rd_67
rc_68:
    s_waitcnt lgkmcnt(10)
    v_mfma_f32_16x16x32_bf16 v[116:119], v[84:87], v[92:95], v[28:31]
    v_mfma_f32_16x16x32_bf16 v[120:123], v[84:87], v[96:99], v[32:35]
    s_waitcnt lgkmcnt(8)
    v_mfma_f32_16x16x32_bf16 v[112:115], v[80:83], v[92:95], v[152:155]
    s_waitcnt lgkmcnt(6)
    v_mfma_f32_16x16x32_bf16 v[124:127], v[88:91], v[96:99], v[28:31]
    s_nop 5
    v_max_f32 v112, v112, v116
    v_max_f32 v113, v113, v117
    v_max_f32 v114, v114, v118
    buffer_load_dwordx4 v75, s[16:19], s99 offen offset:2048 sc1 lds
    v_max_f32 v115, v115, v119
    v_max3_f32 v156, v112, v113, v114
    v_max_f32 v156, v156, v115
    v_max_f32 v120, v120, v124
    v_max_f32 v121, v121, v125
    v_max_f32 v122, v122, v126
    v_max_f32 v123, v123, v127
    v_max3_f32 v157, v120, v121, v122
    buffer_load_dwordx4 v76, s[16:19], s99 offen offset:3072 sc1 lds
    v_max_f32 v157, v157, v123
    s_nop 1
    v_permlane16_swap_b32 v156, v157
    v_max_f32 v156, v156, v157
    v_mov_b32 v157, v156
    s_nop 1
    v_permlane32_swap_b32 v156, v157
    v_max_f32 v156, v156, v157
    v_mul_f32 v156, s82, v156
    v_mov_b32 v157, v156
    s_add_u32 m0, s93, 73344
    s_add_u32 s99, s99, 524288
    s_mov_b64 exec, s[80:81]
    buffer_load_dwordx4 v77, s[16:19], s100 offen sc1 lds
    s_mov_b64 exec, -1
    s_add_u32 s100, s100, 524288
    v_permlane16_swap_b32_e64 v156, v157
    v_fma_f32 v112, v112, s82, -v156
    v_fma_f32 v113, v113, s82, -v156
    v_fma_f32 v114, v114, s82, -v156
    v_fma_f32 v115, v115, s82, -v156
    v_exp_f32 v112, v112
    v_exp_f32 v113, v113
    v_exp_f32 v114, v114
    s_add_u32 m0, s92, 75520
    s_nop 0
    buffer_load_dwordx4 v73, s[16:19], s99 offen offset:0 sc1 lds
    v_exp_f32_e64 v115, v115
    v_cvt_pk_bf16_f32 v116, v112, v113
    v_cvt_pk_bf16_f32 v117, v114, v115
    v_bfi_b32 v128, v36, 0, v116
    v_and_b32 v130, v36, v116
    v_bfi_b32 v129, v37, 0, v117
    v_and_b32 v131, v37, v117
    s_waitcnt lgkmcnt(3)
    s_nop 0
    v_mfma_f32_16x16x32_bf16 v[144:147], v[106:109], v[128:131], 0
    buffer_load_dwordx4 v74, s[16:19], s99 offen offset:1024 sc1 lds
    s_waitcnt lgkmcnt(2)
    v_mfma_f32_16x16x32_bf16 v[136:139], v[100:103], v[128:131], 0
    v_fma_f32 v120, v120, s82, -v157
    v_fma_f32 v121, v121, s82, -v157
    v_fma_f32 v122, v122, s82, -v157
    v_fma_f32 v123, v123, s82, -v157
    v_exp_f32 v120, v120
    v_exp_f32 v121, v121
    v_exp_f32 v122, v122
    buffer_load_dwordx4 v75, s[16:19], s99 offen offset:2048 sc1 lds
    v_exp_f32_e64 v123, v123
    v_cvt_pk_bf16_f32 v124, v120, v121
    v_cvt_pk_bf16_f32 v125, v122, v123
    v_bfi_b32 v132, v36, 0, v124
    v_and_b32 v134, v36, v124
    v_bfi_b32 v133, v37, 0, v125
    v_and_b32 v135, v37, v125
    s_waitcnt lgkmcnt(1)
    s_nop 0
    v_mfma_f32_16x16x32_bf16 v[148:151], v[108:111], v[132:135], 0
    buffer_load_dwordx4 v76, s[16:19], s99 offen offset:3072 sc1 lds
    s_waitcnt lgkmcnt(0)
    v_mfma_f32_16x16x32_bf16 v[140:143], v[102:105], v[132:135], 0
    v_mov_b32 v158, v144
    s_nop 1
    v_permlane16_swap_b32 v144, v158
    v_rcp_f32 v158, v158
    s_nop 0
    v_pk_mul_f32 v[136:137], v[136:137], v[158:159] op_sel_hi:[1,0]
    v_pk_mul_f32 v[138:139], v[138:139], v[158:159] op_sel_hi:[1,0]
    v_pk_mul_f32 v[144:145], v[144:145], v[158:159] op_sel_hi:[1,0]
    v_pk_mul_f32 v[146:147], v[146:147], v[158:159] op_sel_hi:[1,0]
    s_add_u32 m0, s93, 92928
    s_add_u32 s99, s99, 524288
    s_mov_b64 exec, s[80:81]
    buffer_load_dwordx4 v77, s[16:19], s100 offen sc1 lds
    s_mov_b64 exec, -1
    s_add_u32 s100, s100, 524288
    v_cvt_pk_bf16_f32 v112, v136, v137
    v_cvt_pk_bf16_f32 v116, v144, v145
    v_cvt_pk_bf16_f32 v113, v138, v139
    v_cvt_pk_bf16_f32 v117, v146, v147
    v_mov_b32 v160, v148
    s_nop 1
    v_permlane16_swap_b32 v148, v160
    v_rcp_f32_e64 v160, v160
    s_nop 0
    v_pk_mul_f32 v[140:141], v[140:141], v[160:161] op_sel_hi:[1,0]
    v_pk_mul_f32 v[142:143], v[142:143], v[160:161] op_sel_hi:[1,0]
    v_pk_mul_f32 v[148:149], v[148:149], v[160:161] op_sel_hi:[1,0]
    v_pk_mul_f32 v[150:151], v[150:151], v[160:161] op_sel_hi:[1,0]
    v_cvt_pk_bf16_f32 v114, v140, v141
    v_cvt_pk_bf16_f32 v118, v148, v149
    v_cvt_pk_bf16_f32 v115, v142, v143
    v_cvt_pk_bf16_f32 v119, v150, v151
    v_permlane16_swap_b32 v112, v114
    v_permlane16_swap_b32 v113, v115
    v_permlane16_swap_b32 v116, v118
    v_permlane16_swap_b32 v117, v119
    buffer_store_dwordx4 v[112:115], v45, s[16:19], s25 offen sc1
    s_mov_b64 exec, s[80:81]
    buffer_store_dwordx2 v[116:117], v46, s[16:19], s26 offen sc1
    s_mov_b64 exec, -1
ge_69:
    v_add_u32 v196, 36352, v78
    v_mov_b32_e64 v198, v79
    s_waitcnt vmcnt(12)
    s_barrier
    ds_read_b64 v[160:161], v198 offset:0
    ds_read_b64 v[162:163], v198 offset:64
    ds_read_b64 v[164:165], v196 offset:0
    ds_read_b64 v[166:167], v196 offset:512
    ds_read_b64 v[168:169], v196 offset:256
    ds_read_b64 v[170:171], v196 offset:768
    ds_read_b64 v[172:173], v198 offset:256
    ds_read_b64 v[174:175], v198 offset:320
    ds_read_b64 v[176:177], v196 offset:2048
    ds_read_b64 v[178:179], v196 offset:2560
    ds_read_b64 v[180:181], v196 offset:2304
    ds_read_b64 v[182:183], v196 offset:2816
    s_waitcnt lgkmcnt(6)
    v_mfma_f32_16x16x32_bf16 v[112:115], a[0:3], v[160:163], 0
    ds_read_b64 v[184:185], v198 offset:512
    v_mfma_f32_32x32x16_bf16 v[80:95], a[0:3], v[164:167], 0
    ds_read_b64 v[186:187], v198 offset:576
    ds_read_b64 v[188:189], v196 offset:4096
    ds_read_b64 v[190:191], v196 offset:4608
    v_mfma_f32_32x32x16_bf16 v[96:111], a[0:3], v[168:171], 0
    ds_read_b64 v[192:193], v196 offset:4352
    ds_read_b64 v[194:195], v196 offset:4864
    s_add_u32 m0, s92, 95104
    s_nop 0
    buffer_load_dwordx4 v73, s[16:19], s99 offen offset:0 sc1 lds
    s_waitcnt lgkmcnt(6)
    v_mfma_f32_16x16x32_bf16 v[112:115], a[4:7], v[172:175], v[112:115]
    ds_read_b64 v[160:161], v198 offset:768
    v_mfma_f32_32x32x16_bf16 v[80:95], a[4:7], v[176:179], v[80:95]
    ds_read_b64 v[162:163], v198 offset:832
    ds_read_b64 v[164:165], v196 offset:6144
    ds_read_b64 v[166:167], v196 offset:6656
    v_mfma_f32_32x32x16_bf16 v[96:111], a[4:7], v[180:183], v[96:111]
    ds_read_b64 v[168:169], v196 offset:6400
    ds_read_b64 v[170:171], v196 offset:6912
    buffer_load_dwordx4 v74, s[16:19], s99 offen offset:1024 sc1 lds
    s_waitcnt lgkmcnt(6)
    v_mfma_f32_16x16x32_bf16 v[112:115], a[8:11], v[184:187], v[112:115]
    ds_read_b64 v[172:173], v198 offset:1024
    v_mfma_f32_32x32x16_bf16 v[80:95], a[8:11], v[188:191], v[80:95]
    ds_read_b64 v[174:175], v198 offset:1088
    ds_read_b64 v[176:177], v196 offset:8192
    ds_read_b64 v[178:179], v196 offset:8704
    v_mfma_f32_32x32x16_bf16 v[96:111], a[8:11], v[192:195], v[96:111]
    ds_read_b64 v[180:181], v196 offset:8448
    ds_read_b64 v[182:183], v196 offset:8960
    buffer_load_dwordx4 v75, s[16:19], s99 offen offset:2048 sc1 lds
    s_waitcnt lgkmcnt(6)
    v_mfma_f32_16x16x32_bf16 v[112:115], a[12:15], v[160:163], v[112:115]
    ds_read_b64 v[184:185], v198 offset:1280
    v_mfma_f32_32x32x16_bf16 v[80:95], a[12:15], v[164:167], v[80:95]
    ds_read_b64 v[186:187], v198 offset:1344
    ds_read_b64 v[188:189], v196 offset:10240
    ds_read_b64 v[190:191], v196 offset:10752
    v_mfma_f32_32x32x16_bf16 v[96:111], a[12:15], v[168:171], v[96:111]
    ds_read_b64 v[192:193], v196 offset:10496
    ds_read_b64 v[194:195], v196 offset:11008
    buffer_load_dwordx4 v76, s[16:19], s99 offen offset:3072 sc1 lds
    s_waitcnt lgkmcnt(6)
    v_mfma_f32_16x16x32_bf16 v[112:115], a[16:19], v[172:175], v[112:115]
    ds_read_b64 v[160:161], v198 offset:1536
    v_mfma_f32_32x32x16_bf16 v[80:95], a[16:19], v[176:179], v[80:95]
    ds_read_b64 v[162:163], v198 offset:1600
    ds_read_b64 v[164:165], v196 offset:12288
    ds_read_b64 v[166:167], v196 offset:12800
    v_mfma_f32_32x32x16_bf16 v[96:111], a[16:19], v[180:183], v[96:111]
    ds_read_b64 v[168:169], v196 offset:12544
    ds_read_b64 v[170:171], v196 offset:13056
    s_add_u32 m0, s93, 112512
    s_add_u32 s99, s99, 524288
    s_mov_b64 exec, s[80:81]
    buffer_load_dwordx4 v77, s[16:19], s100 offen sc1 lds
    s_mov_b64 exec, -1
    s_add_u32 s100, s100, 524288
    s_waitcnt lgkmcnt(6)
    v_mfma_f32_16x16x32_bf16 v[112:115], a[20:23], v[184:187], v[112:115]
    ds_read_b64 v[172:173], v198 offset:1792
    v_mfma_f32_32x32x16_bf16 v[80:95], a[20:23], v[188:191], v[80:95]
    ds_read_b64 v[174:175], v198 offset:1856
    ds_read_b64 v[176:177], v196 offset:14336
    ds_read_b64 v[178:179], v196 offset:14848
    v_mfma_f32_32x32x16_bf16 v[96:111], a[20:23], v[192:195], v[96:111]
    ds_read_b64 v[180:181], v196 offset:14592
    ds_read_b64 v[182:183], v196 offset:15104
    s_add_u32 m0, s92, 114688
    s_nop 0
    buffer_load_dwordx4 v73, s[16:19], s99 offen offset:0 sc1 lds
    s_waitcnt vmcnt(13)
    s_barrier
    s_waitcnt lgkmcnt(6)
    v_mfma_f32_16x16x32_bf16 v[112:115], a[24:27], v[160:163], v[112:115]
    v_add_u32 v198, v49, v198
    v_mfma_f32_32x32x16_bf16 v[80:95], a[24:27], v[164:167], v[80:95]
    v_add_u32 v196, 19584, v196
    ds_read_b64 v[184:185], v198 offset:0
    ds_read_b64 v[186:187], v198 offset:64
    ds_read_b64 v[188:189], v196 offset:0
    v_mfma_f32_32x32x16_bf16 v[96:111], a[24:27], v[168:171], v[96:111]
    ds_read_b64 v[190:191], v196 offset:512
    ds_read_b64 v[192:193], v196 offset:256
    ds_read_b64 v[194:195], v196 offset:768
    buffer_load_dwordx4 v74, s[16:19], s99 offen offset:1024 sc1 lds
    s_waitcnt lgkmcnt(6)
    v_mfma_f32_16x16x32_bf16 v[112:115], a[28:31], v[172:175], v[112:115]
    ds_read_b64 v[160:161], v198 offset:256
    v_mfma_f32_32x32x16_bf16 v[80:95], a[28:31], v[176:179], v[80:95]
    ds_read_b64 v[162:163], v198 offset:320
    ds_read_b64 v[164:165], v196 offset:2048
    ds_read_b64 v[166:167], v196 offset:2560
    v_mfma_f32_32x32x16_bf16 v[96:111], a[28:31], v[180:183], v[96:111]
    ds_read_b64 v[168:169], v196 offset:2304
    ds_read_b64 v[170:171], v196 offset:2816
    buffer_load_dwordx4 v75, s[16:19], s99 offen offset:2048 sc1 lds
    s_waitcnt lgkmcnt(6)
    v_mfma_f32_16x16x32_bf16 v[112:115], a[32:35], v[184:187], v[112:115]
    ds_read_b64 v[172:173], v198 offset:512
    v_mfma_f32_32x32x16_bf16 v[80:95], a[32:35], v[188:191], v[80:95]
    ds_read_b64 v[174:175], v198 offset:576
    ds_read_b64 v[176:177], v196 offset:4096
    ds_read_b64 v[178:179], v196 offset:4608
    v_mfma_f32_32x32x16_bf16 v[96:111], a[32:35], v[192:195], v[96:111]
    ds_read_b64 v[180:181], v196 offset:4352
    ds_read_b64 v[182:183], v196 offset:4864
    buffer_load_dwordx4 v76, s[16:19], s99 offen offset:3072 sc1 lds
    s_waitcnt lgkmcnt(6)
    v_mfma_f32_16x16x32_bf16 v[112:115], a[36:39], v[160:163], v[112:115]
    ds_read_b64 v[184:185], v198 offset:768
    v_mfma_f32_32x32x16_bf16 v[80:95], a[36:39], v[164:167], v[80:95]
    ds_read_b64 v[186:187], v198 offset:832
    ds_read_b64 v[188:189], v196 offset:6144
    ds_read_b64 v[190:191], v196 offset:6656
    v_mfma_f32_32x32x16_bf16 v[96:111], a[36:39], v[168:171], v[96:111]
    ds_read_b64 v[192:193], v196 offset:6400
    ds_read_b64 v[194:195], v196 offset:6912
    s_add_u32 m0, s93, 132096
    s_add_u32 s99, s99, 524288
    s_mov_b64 exec, s[80:81]
    buffer_load_dwordx4 v77, s[16:19], s100 offen sc1 lds
    s_mov_b64 exec, -1
    s_add_u32 s100, s100, 524288
    s_waitcnt lgkmcnt(6)
    v_mfma_f32_16x16x32_bf16 v[112:115], a[40:43], v[172:175], v[112:115]
    ds_read_b64 v[160:161], v198 offset:1024
    v_mfma_f32_32x32x16_bf16 v[80:95], a[40:43], v[176:179], v[80:95]
    ds_read_b64 v[162:163], v198 offset:1088
    ds_read_b64 v[164:165], v196 offset:8192
    ds_read_b64 v[166:167], v196 offset:8704
    v_add_u32 v199, 36352, v58
    s_lshl_b32 s32, s24, 11
    v_mfma_f32_32x32x16_bf16 v[96:111], a[40:43], v[180:183], v[96:111]
    ds_read_b64 v[168:169], v196 offset:8448
    ds_read_b64 v[170:171], v196 offset:8960
    v_add_u32 v203, s32, v199
    s_add_u32 s32, s24, 1
    s_waitcnt lgkmcnt(6)
    v_mfma_f32_16x16x32_bf16 v[112:115], a[44:47], v[184:187], v[112:115]
    ds_read_b64 v[172:173], v198 offset:1280
    v_mfma_f32_32x32x16_bf16 v[80:95], a[44:47], v[188:191], v[80:95]
    ds_read_b64 v[174:175], v198 offset:1344
    ds_read_b64 v[176:177], v196 offset:10240
    ds_read_b64 v[178:179], v196 offset:10752
    s_and_b32 s32, s32, 3
    s_mul_i32 s32, s32, 6144
    v_mfma_f32_32x32x16_bf16 v[96:111], a[44:47], v[192:195], v[96:111]
    ds_read_b64 v[180:181], v196 offset:10496
    ds_read_b64 v[182:183], v196 offset:11008
    v_add_u32 v200, s32, v199
    s_add_u32 s32, s24, 2
    s_waitcnt lgkmcnt(6)
    v_mfma_f32_16x16x32_bf16 v[112:115], a[48:51], v[160:163], v[112:115]
    ds_read_b64 v[184:185], v198 offset:1536
    v_mfma_f32_32x32x16_bf16 v[80:95], a[48:51], v[164:167], v[80:95]
    ds_read_b64 v[186:187], v198 offset:1600
    ds_read_b64 v[188:189], v196 offset:12288
    ds_read_b64 v[190:191], v196 offset:12800
    s_and_b32 s32, s32, 3
    s_mul_i32 s32, s32, 6144
    v_mfma_f32_32x32x16_bf16 v[96:111], a[48:51], v[168:171], v[96:111]
    ds_read_b64 v[192:193], v196 offset:12544
    ds_read_b64 v[194:195], v196 offset:13056
    v_add_u32 v201, s32, v199
    s_add_u32 s32, s24, 3
    s_waitcnt lgkmcnt(6)
    v_mfma_f32_16x16x32_bf16 v[112:115], a[52:55], v[172:175], v[112:115]
    ds_read_b64 v[160:161], v198 offset:1792
    v_mfma_f32_32x32x16_bf16 v[80:95], a[52:55], v[176:179], v[80:95]
    ds_read_b64 v[162:163], v198 offset:1856
    ds_read_b64 v[164:165], v196 offset:14336
    ds_read_b64 v[166:167], v196 offset:14848
    s_and_b32 s32, s32, 3
    s_mul_i32 s32, s32, 6144
    v_mfma_f32_32x32x16_bf16 v[96:111], a[52:55], v[180:183], v[96:111]
    ds_read_b64 v[168:169], v196 offset:14592
    ds_read_b64 v[170:171], v196 offset:15104
    v_add_u32 v202, s32, v199
    s_mul_i32 s32, s24, 6144
    s_waitcnt vmcnt(12)
    s_barrier
    s_waitcnt lgkmcnt(6)
    v_mfma_f32_16x16x32_bf16 v[112:115], a[56:59], v[184:187], v[112:115]
    v_add_u32 v198, v49, v198
    v_mfma_f32_32x32x16_bf16 v[80:95], a[56:59], v[188:191], v[80:95]
    v_add_u32 v196, 19584, v196
    ds_read_b64 v[172:173], v198 offset:0
    ds_read_b64 v[174:175], v198 offset:64
    ds_read_b64 v[176:177], v196 offset:0
    v_add_u32_e64 v204, s32, v199
    v_mfma_f32_32x32x16_bf16 v[96:111], a[56:59], v[192:195], v[96:111]
    ds_read_b64 v[178:179], v196 offset:512
    ds_read_b64 v[180:181], v196 offset:256
    ds_read_b64 v[182:183], v196 offset:768
    s_lshl_b32 s32, s24, 8
    s_waitcnt lgkmcnt(6)
    v_mfma_f32_16x16x32_bf16 v[112:115], a[60:63], v[160:163], v[112:115]
    ds_read_b64 v[184:185], v198 offset:256
    v_mfma_f32_32x32x16_bf16 v[80:95], a[60:63], v[164:167], v[80:95]
    ds_read_b64 v[186:187], v198 offset:320
    ds_read_b64 v[188:189], v196 offset:2048
    ds_read_b64 v[190:191], v196 offset:2560
    s_add_u32 s32, s32, 36352
    v_and_b32_e64 v214, 15, v1
    v_mfma_f32_32x32x16_bf16 v[96:111], a[60:63], v[168:171], v[96:111]
    ds_read_b64 v[192:193], v196 offset:2304
    ds_read_b64 v[194:195], v196 offset:2816
    v_lshl_add_u32 v206, v214, 4, s32
    v_lshrrev_b32 v215, 5, v1
    s_waitcnt lgkmcnt(6)
    v_mfma_f32_16x16x32_bf16 v[112:115], a[64:67], v[172:175], v[112:115]
    ds_read_b64 v[160:161], v198 offset:512
    v_mfma_f32_32x32x16_bf16 v[80:95], a[64:67], v[176:179], v[80:95]
    ds_read_b64 v[162:163], v198 offset:576
    ds_read_b64 v[164:165], v196 offset:4096
    ds_read_b64 v[166:167], v196 offset:4608
    v_lshl_add_u32 v205, v215, 10, v206
    v_bfe_u32 v215, v1, 4, 1
    v_mfma_f32_32x32x16_bf16 v[96:111], a[64:67], v[180:183], v[96:111]
    ds_read_b64 v[168:169], v196 offset:4352
    ds_read_b64 v[170:171], v196 offset:4864
    v_lshl_add_u32 v205, v215, 3, v205
    v_lshlrev_b32 v214, 2, v214
    s_waitcnt lgkmcnt(6)
    v_mfma_f32_16x16x32_bf16 v[112:115], a[68:71], v[184:187], v[112:115]
    ds_read_b64 v[172:173], v198 offset:768
    v_mfma_f32_32x32x16_bf16 v[80:95], a[68:71], v[188:191], v[80:95]
    ds_read_b64 v[174:175], v198 offset:832
    ds_read_b64 v[176:177], v196 offset:6144
    ds_read_b64 v[178:179], v196 offset:6656
    v_lshl_add_u32 v214, v215, 10, v214
    s_lshl_b32 s32, s24, 6
    v_mfma_f32_32x32x16_bf16 v[96:111], a[68:71], v[192:195], v[96:111]
    ds_read_b64 v[180:181], v196 offset:6400
    ds_read_b64 v[182:183], v196 offset:6912
    v_lshl_add_u32 v207, v215, 3, s32
    v_and_b32_e64 v215, 12, v1
    s_waitcnt lgkmcnt(6)
    v_mfma_f32_16x16x32_bf16 v[112:115], a[72:75], v[160:163], v[112:115]
    ds_read_b64 v[184:185], v198 offset:1024
    v_mfma_f32_32x32x16_bf16 v[80:95], a[72:75], v[164:167], v[80:95]
    ds_read_b64 v[186:187], v198 offset:1088
    ds_read_b64 v[188:189], v196 offset:8192
    ds_read_b64 v[190:191], v196 offset:8704
    v_lshl_add_u32 v207, v215, 2, v207
    v_and_b32_e64 v215, 2, v1
    v_mfma_f32_32x32x16_bf16 v[96:111], a[72:75], v[168:171], v[96:111]
    ds_read_b64 v[192:193], v196 offset:8448
    ds_read_b64 v[194:195], v196 offset:8960
    s_lshl_b32 s98, s72, 5
    s_add_u32 s98, s98, 256
    s_sub_u32 s95, s98, 4
    s_max_i32 s95, s95, 0
    s_lshl_b32 s94, s98, 3
    s_lshl_b32 s95, s95, 3
    s_add_u32 s94, s94, 3457024
    s_add_u32 s95, s95, 3457024
    s_add_u32 s96, s94, 8192
    buffer_load_dwordx2 v[152:153], v47, s[16:19], s94 offen sc1
    s_waitcnt lgkmcnt(6)
    v_mfma_f32_16x16x32_bf16 v[112:115], a[76:79], v[172:175], v[112:115]
    ds_read_b64 v[160:161], v198 offset:1280
    v_mfma_f32_32x32x16_bf16 v[80:95], a[76:79], v[176:179], v[80:95]
    ds_read_b64 v[162:163], v198 offset:1344
    ds_read_b64 v[164:165], v196 offset:10240
    ds_read_b64 v[166:167], v196 offset:10752
    v_lshl_add_u32 v207, v215, 1, v207
    v_add_u32 v207, 69120, v207
    v_mfma_f32_32x32x16_bf16 v[96:111], a[76:79], v[180:183], v[96:111]
    ds_read_b64 v[168:169], v196 offset:10496
    ds_read_b64 v[170:171], v196 offset:11008
    buffer_load_dwordx2 v[154:155], v47, s[16:19], s96 offen sc1
    v_lshrrev_b32 v215, 4, v1
    s_waitcnt lgkmcnt(6)
    v_mfma_f32_16x16x32_bf16 v[112:115], a[80:83], v[184:187], v[112:115]
    ds_read_b64 v[172:173], v198 offset:1536
    v_mfma_f32_32x32x16_bf16 v[80:95], a[80:83], v[188:191], v[80:95]
    ds_read_b64 v[174:175], v198 offset:1600
    ds_read_b64 v[176:177], v196 offset:12288
    ds_read_b64 v[178:179], v196 offset:12800
    v_lshl_add_u32 v206, v215, 2, v206
    v_mov_b32 v215, 0x3f803f80
    v_mfma_f32_32x32x16_bf16 v[96:111], a[80:83], v[192:195], v[96:111]
    ds_read_b64 v[180:181], v196 offset:12544
    ds_read_b64 v[182:183], v196 offset:13056
    buffer_load_dwordx2 v[156:157], v48, s[16:19], s95 offen sc1
    s_waitcnt lgkmcnt(6)
    v_mfma_f32_16x16x32_bf16 v[112:115], a[84:87], v[160:163], v[112:115]
    ds_read_b64 v[184:185], v198 offset:1792
    v_mfma_f32_32x32x16_bf16 v[80:95], a[84:87], v[164:167], v[80:95]
    ds_read_b64 v[186:187], v198 offset:1856
    ds_read_b64 v[188:189], v196 offset:14336
    ds_read_b64 v[190:191], v196 offset:14848
    v_mfma_f32_32x32x16_bf16 v[96:111], a[84:87], v[168:171], v[96:111]
    ds_read_b64 v[192:193], v196 offset:14592
    ds_read_b64 v[194:195], v196 offset:15104
    s_waitcnt vmcnt(8)
    s_barrier
    s_waitcnt lgkmcnt(6)
    v_mfma_f32_16x16x32_bf16 v[112:115], a[88:91], v[172:175], v[112:115]
    v_add_u32_e64 v198, v49, v198
    v_mfma_f32_32x32x16_bf16 v[80:95], a[88:91], v[176:179], v[80:95]
    v_add_u32 v196, 19584, v196
    ds_read_b64 v[160:161], v198 offset:0
    ds_read_b64 v[162:163], v198 offset:64
    ds_read_b64 v[164:165], v196 offset:0
    v_mfma_f32_32x32x16_bf16 v[96:111], a[88:91], v[180:183], v[96:111]
    ds_read_b64 v[166:167], v196 offset:512
    ds_read_b64 v[168:169], v196 offset:256
    ds_read_b64 v[170:171], v196 offset:768
    s_waitcnt lgkmcnt(6)
    v_mfma_f32_16x16x32_bf16 v[112:115], a[92:95], v[184:187], v[112:115]
    ds_read_b64 v[172:173], v198 offset:256
    v_mfma_f32_32x32x16_bf16 v[80:95], a[92:95], v[188:191], v[80:95]
    ds_read_b64 v[174:175], v198 offset:320
    ds_read_b64 v[176:177], v196 offset:2048
    ds_read_b64 v[178:179], v196 offset:2560
    v_mfma_f32_32x32x16_bf16 v[96:111], a[92:95], v[192:195], v[96:111]
    ds_read_b64 v[180:181], v196 offset:2304
    ds_read_b64 v[182:183], v196 offset:2816
    s_waitcnt lgkmcnt(6)
    v_mfma_f32_16x16x32_bf16 v[112:115], a[96:99], v[160:163], v[112:115]
    ds_read_b64 v[184:185], v198 offset:512
    v_mfma_f32_32x32x16_bf16 v[80:95], a[96:99], v[164:167], v[80:95]
    ds_read_b64 v[186:187], v198 offset:576
    ds_read_b64 v[188:189], v196 offset:4096
    ds_read_b64 v[190:191], v196 offset:4608
    v_mfma_f32_32x32x16_bf16 v[96:111], a[96:99], v[168:171], v[96:111]
    ds_read_b64 v[192:193], v196 offset:4352
    ds_read_b64 v[194:195], v196 offset:4864
    s_waitcnt lgkmcnt(6)
    v_mfma_f32_16x16x32_bf16 v[112:115], a[100:103], v[172:175], v[112:115]
    ds_read_b64 v[160:161], v198 offset:768
    v_mfma_f32_32x32x16_bf16 v[80:95], a[100:103], v[176:179], v[80:95]
    ds_read_b64 v[162:163], v198 offset:832
    ds_read_b64 v[164:165], v196 offset:6144
    ds_read_b64 v[166:167], v196 offset:6656
    v_mfma_f32_32x32x16_bf16 v[96:111], a[100:103], v[180:183], v[96:111]
    ds_read_b64 v[168:169], v196 offset:6400
    ds_read_b64 v[170:171], v196 offset:6912
    s_waitcnt lgkmcnt(6)
    v_mfma_f32_16x16x32_bf16 v[112:115], a[104:107], v[184:187], v[112:115]
    ds_read_b64 v[172:173], v198 offset:1024
    v_mfma_f32_32x32x16_bf16 v[80:95], a[104:107], v[188:191], v[80:95]
    ds_read_b64 v[174:175], v198 offset:1088
    ds_read_b64 v[176:177], v196 offset:8192
    ds_read_b64 v[178:179], v196 offset:8704
    v_mfma_f32_32x32x16_bf16 v[96:111], a[104:107], v[192:195], v[96:111]
    ds_read_b64 v[180:181], v196 offset:8448
    ds_read_b64 v[182:183], v196 offset:8960
    s_waitcnt lgkmcnt(6)
    v_mfma_f32_16x16x32_bf16 v[112:115], a[108:111], v[160:163], v[112:115]
    ds_read_b64 v[184:185], v198 offset:1280
    v_mfma_f32_32x32x16_bf16 v[80:95], a[108:111], v[164:167], v[80:95]
    ds_read_b64 v[186:187], v198 offset:1344
    ds_read_b64 v[188:189], v196 offset:10240
    ds_read_b64 v[190:191], v196 offset:10752
    v_mfma_f32_32x32x16_bf16 v[96:111], a[108:111], v[168:171], v[96:111]
    ds_read_b64 v[192:193], v196 offset:10496
    ds_read_b64 v[194:195], v196 offset:11008
    s_waitcnt lgkmcnt(6)
    v_mfma_f32_16x16x32_bf16 v[112:115], a[112:115], v[172:175], v[112:115]
    ds_read_b64 v[160:161], v198 offset:1536
    v_mfma_f32_32x32x16_bf16 v[80:95], a[112:115], v[176:179], v[80:95]
    ds_read_b64 v[162:163], v198 offset:1600
    ds_read_b64 v[164:165], v196 offset:12288
    ds_read_b64 v[166:167], v196 offset:12800
    v_mfma_f32_32x32x16_bf16 v[96:111], a[112:115], v[180:183], v[96:111]
    ds_read_b64 v[168:169], v196 offset:12544
    ds_read_b64 v[170:171], v196 offset:13056
    s_waitcnt lgkmcnt(6)
    v_mfma_f32_16x16x32_bf16 v[112:115], a[116:119], v[184:187], v[112:115]
    ds_read_b64 v[172:173], v198 offset:1792
    v_mfma_f32_32x32x16_bf16 v[80:95], a[116:119], v[188:191], v[80:95]
    ds_read_b64 v[174:175], v198 offset:1856
    ds_read_b64 v[176:177], v196 offset:14336
    ds_read_b64 v[178:179], v196 offset:14848
    v_mfma_f32_32x32x16_bf16 v[96:111], a[116:119], v[192:195], v[96:111]
    ds_read_b64 v[180:181], v196 offset:14592
    ds_read_b64 v[182:183], v196 offset:15104
sl_70:
    s_waitcnt vmcnt(1)
    v_max3_u32 v2, v152, v153, v154
    s_waitcnt vmcnt(0)
    v_max3_u32 v2, v2, v155, v156
    v_max_u32 v2, v2, v157
    v_cmp_eq_u32 vcc, -1, v2
    s_nop 0
    s_cbranch_vccnz rd_71
rc_72:
    s_barrier
    s_waitcnt lgkmcnt(6)
    v_mfma_f32_16x16x32_bf16 v[112:115], a[120:123], v[160:163], v[112:115]
    v_add_u32 v198, v49, v198
    v_mfma_f32_32x32x16_bf16 v[80:95], a[120:123], v[164:167], v[80:95]
    v_add_u32 v196, 19584, v196
    ds_read_b64 v[184:185], v198 offset:0
    ds_read_b64 v[186:187], v198 offset:64
    v_mul_f32 v148, v24, v157
    v_mul_f32 v149, v25, v157
    v_mfma_f32_32x32x16_bf16 v[96:111], a[120:123], v[168:171], v[96:111]
    ds_read_b64 v[188:189], v196 offset:0
    ds_read_b64 v[190:191], v196 offset:512
    s_mov_b32 s96, 12058624
    buffer_load_dwordx4 v[216:219], v56, s[16:19], s96 offen offset:0 sc1
    v_mul_f32 v150, v26, v157
    v_mul_f32_e64 v151, v27, v157
    s_waitcnt lgkmcnt(4)
    v_mfma_f32_16x16x32_bf16 v[112:115], a[124:127], v[172:175], v[112:115]
    ds_read_b64 v[192:193], v198 offset:256
    v_mfma_f32_32x32x16_bf16 v[80:95], a[124:127], v[176:179], v[80:95]
    ds_read_b64 v[194:195], v198 offset:320
    ds_read_b64 v[160:161], v196 offset:2048
    v_mul_f32 v116, v8, v153
    v_mul_f32 v117, v9, v153
    v_mul_f32_e64 v118, v10, v153
    v_mfma_f32_32x32x16_bf16 v[96:111], a[124:127], v[180:183], v[96:111]
    ds_read_b64 v[162:163], v196 offset:2560
    buffer_load_dwordx4 v[220:223], v56, s[16:19], s96 offen offset:256 sc1
    v_mul_f32 v119, v11, v153
    v_mul_f32_e64 v120, v12, v153
    s_waitcnt lgkmcnt(4)
    v_mfma_f32_16x16x32_bf16 v[112:115], a[128:131], v[184:187], v[112:115]
    ds_read_b64 v[164:165], v198 offset:512
    v_mfma_f32_32x32x16_bf16 v[80:95], a[128:131], v[188:191], v[80:95]
    ds_read_b64 v[166:167], v198 offset:576
    ds_read_b64 v[168:169], v196 offset:4096
    ds_read_b64 v[170:171], v196 offset:4608
    v_mul_f32 v121, v13, v153
    v_mul_f32_e64 v122, v14, v153
    s_waitcnt lgkmcnt(4)
    v_mfma_f32_16x16x32_bf16 v[112:115], a[132:135], v[192:195], v[112:115]
    ds_read_b64 v[172:173], v198 offset:768
    v_mfma_f32_32x32x16_bf16 v[80:95], a[132:135], v[160:163], v[80:95]
    ds_read_b64 v[174:175], v198 offset:832
    ds_read_b64 v[176:177], v196 offset:6144
    ds_read_b64 v[178:179], v196 offset:6656
    s_mov_b32 s96, 12091392
    buffer_load_dwordx4 v[224:227], v56, s[16:19], s96 offen offset:0 sc1
    v_mul_f32 v123, v15, v153
    v_mul_f32_e64 v124, v16, v153
    s_waitcnt lgkmcnt(4)
    v_mfma_f32_16x16x32_bf16 v[112:115], a[136:139], v[164:167], v[112:115]
    ds_read_b64 v[180:181], v198 offset:1024
    v_mfma_f32_32x32x16_bf16 v[80:95], a[136:139], v[168:171], v[80:95]
    ds_read_b64 v[182:183], v198 offset:1088
    ds_read_b64 v[184:185], v196 offset:8192
    ds_read_b64 v[186:187], v196 offset:8704
    v_mul_f32 v125, v17, v153
    v_mul_f32_e64 v126, v18, v153
    s_waitcnt lgkmcnt(4)
    v_mfma_f32_16x16x32_bf16 v[112:115], a[140:143], v[172:175], v[112:115]
    ds_read_b64 v[188:189], v198 offset:1280
    v_mfma_f32_32x32x16_bf16 v[80:95], a[140:143], v[176:179], v[80:95]
    ds_read_b64 v[190:191], v198 offset:1344
    ds_read_b64 v[192:193], v196 offset:10240
    ds_read_b64 v[194:195], v196 offset:10752
    buffer_load_dwordx4 v[228:231], v56, s[16:19], s96 offen offset:256 sc1
    v_mul_f32 v127, v19, v153
    v_mul_f32_e64 v128, v20, v153
    s_waitcnt lgkmcnt(4)
    v_mfma_f32_16x16x32_bf16 v[112:115], a[144:147], v[180:183], v[112:115]
    ds_read_b64 v[160:161], v198 offset:1536
    v_mfma_f32_32x32x16_bf16 v[80:95], a[144:147], v[184:187], v[80:95]
    ds_read_b64 v[162:163], v198 offset:1600
    ds_read_b64 v[164:165], v196 offset:12288
    ds_read_b64 v[166:167], v196 offset:12800
    v_mul_f32 v129, v21, v153
    v_mul_f32_e64 v130, v22, v153
    s_waitcnt lgkmcnt(4)
    v_mfma_f32_16x16x32_bf16 v[112:115], a[148:151], v[188:191], v[112:115]
    ds_read_b64 v[168:169], v198 offset:1792
    v_mfma_f32_32x32x16_bf16 v[80:95], a[148:151], v[192:195], v[80:95]
    ds_read_b64 v[170:171], v198 offset:1856
    ds_read_b64 v[172:173], v196 offset:14336
    ds_read_b64 v[174:175], v196 offset:14848
    s_mov_b32 s96, 12124160
    buffer_load_dwordx4 v[232:235], v56, s[16:19], s96 offen offset:0 sc1
    v_mul_f32 v131, v23, v153
    v_mul_f32_e64 v132, v8, v155
    s_waitcnt lgkmcnt(4)
    v_mfma_f32_16x16x32_bf16 v[112:115], a[152:155], v[160:163], v[112:115]
    ds_read_b64 v[176:177], v196 offset:256
    v_mfma_f32_32x32x16_bf16 v[80:95], a[152:155], v[164:167], v[80:95]
    ds_read_b64 v[178:179], v196 offset:768
    ds_read_b64 v[180:181], v196 offset:2304
    ds_read_b64 v[182:183], v196 offset:2816
    v_mul_f32 v133, v9, v155
    v_mul_f32_e64 v134, v10, v155
    s_waitcnt lgkmcnt(4)
    v_mfma_f32_16x16x32_bf16 v[112:115], a[156:159], v[168:171], v[112:115]
    ds_read_b64 v[184:185], v196 offset:4352
    v_mfma_f32_32x32x16_bf16 v[80:95], a[156:159], v[172:175], v[80:95]
    ds_read_b64 v[186:187], v196 offset:4864
    ds_read_b64 v[188:189], v196 offset:6400
    ds_read_b64 v[190:191], v196 offset:6912
    buffer_load_dwordx4 v[236:239], v56, s[16:19], s96 offen offset:256 sc1
    v_mul_f32 v135, v11, v155
    v_mul_f32 v136, v12, v155
    v_mul_f32 v137, v13, v155
    v_mul_f32 v138, v14, v155
    v_mul_f32 v139, v15, v155
    v_mul_f32 v140, v16, v155
    v_mul_f32 v141, v17, v155
    v_mul_f32 v142, v18, v155
    v_mul_f32 v143, v19, v155
    v_mul_f32 v144, v20, v155
    v_mul_f32 v145, v21, v155
    v_mul_f32 v146, v22, v155
    v_mul_f32 v147, v23, v155
    s_waitcnt lgkmcnt(4)
    v_mfma_f32_32x32x16_bf16 v[96:111], a[128:131], v[176:179], v[96:111]
    ds_read_b64 v[192:193], v196 offset:8448
    ds_read_b64 v[194:195], v196 offset:8960
    v_mfma_f32_32x32x16_bf16 v[96:111], a[132:135], v[180:183], v[96:111]
    ds_read_b64 v[160:161], v196 offset:10496
    ds_read_b64 v[162:163], v196 offset:11008
    s_mov_b32 s96, 12156928
    buffer_load_dwordx4 v[240:243], v56, s[16:19], s96 offen offset:0 sc1
    v_fma_f32 v112, v112, v156, v148
    v_fma_f32 v113, v113, v156, v149
    s_waitcnt lgkmcnt(4)
    v_mfma_f32_32x32x16_bf16 v[96:111], a[136:139], v[184:187], v[96:111]
    ds_read_b64 v[164:165], v196 offset:12544
    ds_read_b64 v[166:167], v196 offset:13056
    v_fma_f32 v114, v114, v156, v150
    v_fma_f32 v115, v115, v156, v151
    v_cvt_pk_bf16_f32 v112, v112, v113
    v_mfma_f32_32x32x16_bf16 v[96:111], a[140:143], v[188:191], v[96:111]
    ds_read_b64 v[168:169], v196 offset:14592
    ds_read_b64 v[170:171], v196 offset:15104
    buffer_load_dwordx4 v[244:247], v56, s[16:19], s96 offen offset:256 sc1
    v_cvt_pk_bf16_f32 v113, v114, v115
    v_fma_f32 v80, v80, v152, v116
    s_waitcnt lgkmcnt(4)
    v_mfma_f32_32x32x16_bf16 v[96:111], a[144:147], v[192:195], v[96:111]
    v_fma_f32 v81, v81, v152, v117
    v_fma_f32 v82, v82, v152, v118
    v_fma_f32 v83, v83, v152, v119
    v_cvt_pk_bf16_f32 v80, v80, v81
    v_cvt_pk_bf16_f32 v81, v82, v83
    v_mfma_f32_32x32x16_bf16 v[96:111], a[148:151], v[160:163], v[96:111]
    ds_write_b64 v40, v[112:113] offset:0
    ds_write_b64 v38, v[80:81] offset:0
    v_fma_f32 v84, v84, v152, v120
    v_fma_f32 v85, v85, v152, v121
    s_waitcnt lgkmcnt(2)
    v_mfma_f32_32x32x16_bf16 v[96:111], a[152:155], v[164:167], v[96:111]
    v_fma_f32 v86, v86, v152, v122
    v_fma_f32 v87, v87, v152, v123
    v_cvt_pk_bf16_f32 v84, v84, v85
    v_cvt_pk_bf16_f32 v85, v86, v87
    v_fma_f32 v88, v88, v152, v124
    v_mfma_f32_32x32x16_bf16 v[96:111], a[156:159], v[168:171], v[96:111]
    s_mov_b32 s96, 12058624
    buffer_load_dwordx2 v[248:249], v57, s[16:19], s96 offen offset:0 sc1
    v_fma_f32 v89, v89, v152, v125
    v_fma_f32 v90, v90, v152, v126
    v_fma_f32 v91, v91, v152, v127
    v_cvt_pk_bf16_f32 v88, v88, v89
    v_cvt_pk_bf16_f32 v89, v90, v91
    ds_write_b64 v38, v[84:85] offset:6400
    ds_write_b64 v38, v[88:89] offset:12800
    v_fma_f32 v92, v92, v152, v128
    v_fma_f32 v93, v93, v152, v129
    v_fma_f32 v94, v94, v152, v130
    v_fma_f32 v95, v95, v152, v131
    v_cvt_pk_bf16_f32 v92, v92, v93
    v_cvt_pk_bf16_f32 v93, v94, v95
    ds_write_b64 v39, v[92:93] offset:0
    v_pk_fma_f32 v[96:97], v[96:97], v[154:155], v[132:133] op_sel_hi:[1,0,1]
    v_pk_fma_f32 v[98:99], v[98:99], v[154:155], v[134:135] op_sel_hi:[1,0,1]
    v_cvt_pk_bf16_f32 v96, v96, v97
    v_cvt_pk_bf16_f32 v97, v98, v99
    v_pk_fma_f32 v[100:101], v[100:101], v[154:155], v[136:137] op_sel_hi:[1,0,1]
    v_pk_fma_f32 v[102:103], v[102:103], v[154:155], v[138:139] op_sel_hi:[1,0,1]
    v_cvt_pk_bf16_f32 v100, v100, v101
    v_cvt_pk_bf16_f32 v101, v102, v103
    ds_write_b64 v38, v[96:97] offset:1600
    ds_write_b64 v38, v[100:101] offset:8000
    v_pk_fma_f32 v[104:105], v[104:105], v[154:155], v[140:141] op_sel_hi:[1,0,1]
    v_pk_fma_f32 v[106:107], v[106:107], v[154:155], v[142:143] op_sel_hi:[1,0,1]
    v_cvt_pk_bf16_f32 v104, v104, v105
    v_cvt_pk_bf16_f32 v105, v106, v107
    v_pk_fma_f32 v[108:109], v[108:109], v[154:155], v[144:145] op_sel_hi:[1,0,1]
    v_pk_fma_f32 v[110:111], v[110:111], v[154:155], v[146:147] op_sel_hi:[1,0,1]
    v_cvt_pk_bf16_f32 v108, v108, v109
    v_cvt_pk_bf16_f32 v109, v110, v111
    ds_write_b64 v38, v[104:105] offset:14400
    ds_write_b64 v39, v[108:109] offset:1600
    v_cmp_u_f32 vcc, v82, v114
    v_cmp_u_f32 s[82:83], v98, v98
    s_lshl_b32 s25, s24, 2
    s_add_u32 s25, s25, 160256
    s_or_b64 vcc, vcc, s[82:83]
    s_cselect_b32 s26, 1, 0
    v_mov_b32 v196, s25
    v_mov_b32 v197, s26
    ds_write_b32 v196, v197
    s_waitcnt lgkmcnt(0)
    s_barrier
    v_mov_b32 v158, 160256
    ds_read_b128 v[128:131], v158
    v_mov_b32 v94, 0
    v_mov_b32 v95, 0
    v_mov_b32 v98, 0
    v_mov_b32_e64 v99, 0
    s_mov_b64 exec, 0xffff
    ds_read_b64 v[94:95], v42 offset:320
    ds_read_b64 v[98:99], v42 offset:640
    s_mov_b64 exec, -1
    s_nop 0
    ds_read_b64 v[92:93], v41 offset:320
    ds_read_b64 v[96:97], v41 offset:640
    ds_read_b64 v[84:85], v41 offset:6720
    ds_read_b64 v[86:87], v42 offset:6720
    ds_read_b64 v[80:81], v41 offset:6400
    ds_read_b64 v[82:83], v42 offset:6400
    ds_read_b64 v[88:89], v41 offset:7040
    ds_read_b64 v[90:91], v42 offset:7040
    ds_read_b64_tr_b16 v[106:107], v44 offset:0
    ds_read_b64_tr_b16 v[100:101], v43 offset:0
    buffer_load_dwordx2 v[252:253], v57, s[16:19], s96 offen offset:128 sc1
    ds_read_b64_tr_b16 v[108:109], v44 offset:320
    ds_read_b64_tr_b16 v[102:103], v43 offset:320
    ds_read_b64_tr_b16 v[110:111], v44 offset:640
    ds_read_b64_tr_b16 v[104:105], v43 offset:640
    s_mov_b32 s82, 0x3ea52b5c
    s_lshl_b32 s25, s98, 4
    s_add_u32 s25, s25, 12058624
    s_lshl_b32 s26, s98, 3
    s_mov_b32 s96, 12075008
    buffer_load_dwordx2 v[250:251], v57, s[16:19], s96 offen offset:0 sc1
    s_add_u32 s26, s26, 12058624
    s_waitcnt lgkmcnt(15)
    v_or3_b32 v128, v128, v129, v130
    v_or_b32 v128, v128, v131
    v_cmp_ne_u32 vcc, 0, v128
    s_nop 0
    s_cbranch_vccnz rd_73
rc_74:
    s_waitcnt lgkmcnt(10)
    v_mfma_f32_16x16x32_bf16 v[116:119], v[84:87], v[92:95], v[28:31]
    v_mfma_f32_16x16x32_bf16 v[120:123], v[84:87], v[96:99], v[32:35]
    s_waitcnt lgkmcnt(8)
    v_mfma_f32_16x16x32_bf16 v[112:115], v[80:83], v[92:95], v[32:35]
    s_waitcnt lgkmcnt(6)
    v_mfma_f32_16x16x32_bf16 v[124:127], v[88:91], v[96:99], v[28:31]
    buffer_load_dwordx2 v[254:255], v57, s[16:19], s96 offen offset:128 sc1
    s_nop 4
    v_max_f32 v112, v112, v116
    v_max_f32 v113, v113, v117
    v_max_f32 v114, v114, v118
    v_max_f32 v115, v115, v119
    v_max3_f32 v156, v112, v113, v114
    v_max_f32 v156, v156, v115
    v_max_f32 v120, v120, v124
    v_max_f32 v121, v121, v125
    s_mov_b32 s96, 9437184
    buffer_load_dwordx4 v[208:211], v59, s[16:19], s96 offen sc1
    v_max_f32 v122, v122, v126
    v_max_f32 v123, v123, v127
    v_max3_f32 v157, v120, v121, v122
    v_max_f32 v157, v157, v123
    s_nop 1
    v_permlane16_swap_b32 v156, v157
    v_max_f32 v156, v156, v157
    v_mov_b32 v157, v156
    s_nop 1
    v_permlane32_swap_b32_e64 v156, v157
    s_add_u32 s97, s36, 9437184
    buffer_load_dword v212, v61, s[16:19], s97 offen sc1
    v_max_f32 v156, v156, v157
    v_mul_f32 v156, s82, v156
    v_mov_b32 v157, v156
    s_nop 1
    v_permlane16_swap_b32_e64 v156, v157
    v_fma_f32 v112, v112, s82, -v156
    v_fma_f32 v113, v113, s82, -v156
    v_fma_f32 v114, v114, s82, -v156
    v_fma_f32 v115, v115, s82, -v156
    v_exp_f32 v112, v112
    v_exp_f32 v113, v113
    v_exp_f32 v114, v114
    v_exp_f32 v115, v115
    v_cvt_pk_bf16_f32 v116, v112, v113
    v_cvt_pk_bf16_f32 v117, v114, v115
    v_bfi_b32 v128, v36, 0, v116
    v_and_b32 v130, v36, v116
    v_bfi_b32 v129, v37, 0, v117
    v_and_b32 v131, v37, v117
    s_waitcnt lgkmcnt(3)
    s_nop 0
    v_mfma_f32_16x16x32_bf16 v[144:147], v[106:109], v[128:131], 0
    s_waitcnt lgkmcnt(2)
    v_mfma_f32_16x16x32_bf16 v[136:139], v[100:103], v[128:131], 0
    v_fma_f32 v120, v120, s82, -v157
    v_fma_f32 v121, v121, s82, -v157
    v_fma_f32 v122, v122, s82, -v157
    v_fma_f32 v123, v123, s82, -v157
    v_exp_f32 v120, v120
    v_exp_f32 v121, v121
    v_exp_f32 v122, v122
    v_exp_f32_e64 v123, v123
    v_cvt_pk_bf16_f32 v124, v120, v121
    v_cvt_pk_bf16_f32 v125, v122, v123
    v_bfi_b32 v132, v36, 0, v124
    v_and_b32 v134, v36, v124
    v_bfi_b32 v133, v37, 0, v125
    v_and_b32 v135, v37, v125
    s_waitcnt lgkmcnt(1)
    s_nop 0
    v_mfma_f32_16x16x32_bf16 v[148:151], v[108:111], v[132:135], 0
    s_waitcnt lgkmcnt(0)
    v_mfma_f32_16x16x32_bf16 v[140:143], v[102:105], v[132:135], 0
    v_mov_b32 v158, v144
    s_nop 1
    v_permlane16_swap_b32 v144, v158
    v_rcp_f32 v158, v158
    s_nop 0
    v_pk_mul_f32 v[136:137], v[136:137], v[158:159] op_sel_hi:[1,0]
    v_pk_mul_f32 v[138:139], v[138:139], v[158:159] op_sel_hi:[1,0]
    v_pk_mul_f32 v[144:145], v[144:145], v[158:159] op_sel_hi:[1,0]
    v_pk_mul_f32 v[146:147], v[146:147], v[158:159] op_sel_hi:[1,0]
    v_cvt_pk_bf16_f32 v112, v136, v137
    v_cvt_pk_bf16_f32 v116, v144, v145
    v_cvt_pk_bf16_f32 v113, v138, v139
    v_cvt_pk_bf16_f32 v117, v146, v147
    v_mov_b32 v160, v148
    s_nop 1
    v_permlane16_swap_b32 v148, v160
    v_rcp_f32_e64 v160, v160
    s_nop 0
    v_pk_mul_f32 v[140:141], v[140:141], v[160:161] op_sel_hi:[1,0]
    v_pk_mul_f32 v[142:143], v[142:143], v[160:161] op_sel_hi:[1,0]
    v_pk_mul_f32 v[148:149], v[148:149], v[160:161] op_sel_hi:[1,0]
    v_pk_mul_f32 v[150:151], v[150:151], v[160:161] op_sel_hi:[1,0]
    v_cvt_pk_bf16_f32 v114, v140, v141
    v_cvt_pk_bf16_f32 v118, v148, v149
    v_cvt_pk_bf16_f32 v115, v142, v143
    v_cvt_pk_bf16_f32 v119, v150, v151
    v_permlane16_swap_b32 v112, v114
    v_permlane16_swap_b32 v113, v115
    v_permlane16_swap_b32 v116, v118
    v_permlane16_swap_b32 v117, v119
    buffer_store_dwordx4 v[112:115], v45, s[16:19], s25 offen sc1
    s_mov_b64 exec, s[80:81]
    buffer_store_dwordx2 v[116:117], v46, s[16:19], s26 offen sc1
    s_mov_b64 exec, -1
oe_75:
    s_waitcnt vmcnt(15)
    v_mfma_f32_16x16x32_bf16 v[112:115], a[176:179], v[216:219], 0
    v_mov_b32 v136, 0
    v_mov_b32 v137, 0
    s_waitcnt vmcnt(14)
    v_mfma_f32_16x16x32_bf16 v[116:119], a[176:179], v[220:223], 0
    v_mov_b32 v138, 0
    v_mov_b32 v139, 0
    s_waitcnt vmcnt(13)
    v_mfma_f32_16x16x32_bf16 v[112:115], a[196:199], v[224:227], v[112:115]
    v_mov_b32 v140, 0
    v_mov_b32 v141, 0
    s_waitcnt vmcnt(12)
    v_mfma_f32_16x16x32_bf16 v[116:119], a[196:199], v[228:231], v[116:119]
    s_mov_b32 s25, 14680064
    s_add_u32 s26, s36, 14680064
    s_waitcnt vmcnt(11)
    v_mfma_f32_16x16x32_bf16 v[112:115], a[216:219], v[232:235], v[112:115]
    s_add_u32 s27, s35, 3506176
    s_mov_b32 s28, 0x99999999
    s_waitcnt vmcnt(10)
    v_mfma_f32_16x16x32_bf16 v[116:119], a[216:219], v[236:239], v[116:119]
    s_mov_b32 s29, 0x99999999
    s_waitcnt vmcnt(9)
    v_mfma_f32_16x16x32_bf16 v[112:115], a[236:239], v[240:243], v[112:115]
    s_waitcnt vmcnt(8)
    v_mfma_f32_16x16x32_bf16 v[116:119], a[236:239], v[244:247], v[116:119]
    s_waitcnt vmcnt(5)
    v_mfma_f32_16x16x32_bf16 v[112:115], v[52:55], v[248:251], v[112:115]
    s_waitcnt vmcnt(4)
    v_mfma_f32_16x16x32_bf16 v[116:119], v[52:55], v[252:255], v[116:119]
    v_mfma_f32_16x16x32_bf16 v[88:91], a[164:167], v[216:219], 0
    v_mfma_f32_16x16x32_bf16 v[92:95], a[164:167], v[220:223], 0
    v_mfma_f32_16x16x32_bf16 v[88:91], a[184:187], v[224:227], v[88:91]
    s_waitcnt vmcnt(3)
    v_max3_u32 v132, v208, v209, v210
    s_waitcnt vmcnt(2)
    v_max3_u32 v132, v132, v211, v212
    v_mfma_f32_16x16x32_bf16 v[92:95], a[184:187], v[228:231], v[92:95]
    v_cmp_eq_u32 s[82:83], -1, v132
    v_mfma_f32_16x16x32_bf16 v[88:91], a[204:207], v[232:235], v[88:91]
    v_mfma_f32_16x16x32_bf16 v[92:95], a[204:207], v[236:239], v[92:95]
    v_cmp_u_f32 vcc, v112, v116
    s_nop 0
    s_or_b64 vcc, vcc, s[82:83]
    s_cbranch_vccnz rd_76
rc_77:
    v_mfma_f32_16x16x32_bf16 v[88:91], a[224:227], v[240:243], v[88:91]
    ds_write_b128 v203, v[112:115] offset:24576
    v_mfma_f32_16x16x32_bf16 v[92:95], a[224:227], v[244:247], v[92:95]
    v_mfma_f32_16x16x32_bf16 v[88:91], a[244:247], v[248:251], v[88:91]
    ds_write_b128 v203, v[116:119] offset:25600
    v_mfma_f32_16x16x32_bf16 v[92:95], a[244:247], v[252:255], v[92:95]
    v_mfma_f32_16x16x32_bf16 v[96:99], a[168:171], v[216:219], 0
    v_lshlrev_b32_e64 v120, 16, v208
    v_and_b32 v121, 0xffff0000, v208
    v_mfma_f32_16x16x32_bf16 v[100:103], a[168:171], v[220:223], 0
    v_lshlrev_b32_e64 v122, 16, v209
    v_and_b32 v123, 0xffff0000, v209
    v_mfma_f32_16x16x32_bf16 v[96:99], a[188:191], v[224:227], v[96:99]
    v_lshlrev_b32_e64 v124, 16, v210
    v_and_b32 v125, 0xffff0000, v210
    v_mfma_f32_16x16x32_bf16 v[100:103], a[188:191], v[228:231], v[100:103]
    v_lshlrev_b32_e64 v126, 16, v211
    v_and_b32 v127, 0xffff0000, v211
    v_mfma_f32_16x16x32_bf16 v[96:99], a[208:211], v[232:235], v[96:99]
    v_lshlrev_b32_e64 v128, 16, v212
    v_and_b32 v129, 0xffff0000, v212
    v_mfma_f32_16x16x32_bf16 v[100:103], a[208:211], v[236:239], v[100:103]
    v_mfma_f32_16x16x32_bf16 v[96:99], a[228:231], v[240:243], v[96:99]
    ds_write_b128 v200, v[88:91] offset:0
    v_mfma_f32_16x16x32_bf16 v[100:103], a[228:231], v[244:247], v[100:103]
    v_mfma_f32_16x16x32_bf16 v[96:99], a[248:251], v[248:251], v[96:99]
    ds_write_b128 v200, v[92:95] offset:1024
    v_mfma_f32_16x16x32_bf16 v[100:103], a[248:251], v[252:255], v[100:103]
    v_mfma_f32_16x16x32_bf16 v[104:107], a[172:175], v[216:219], 0
    v_mfma_f32_16x16x32_bf16 v[108:111], a[172:175], v[220:223], 0
    v_mfma_f32_16x16x32_bf16 v[104:107], a[192:195], v[224:227], v[104:107]
    v_mfma_f32_16x16x32_bf16 v[108:111], a[192:195], v[228:231], v[108:111]
    v_mfma_f32_16x16x32_bf16 v[104:107], a[212:215], v[232:235], v[104:107]
    v_mfma_f32_16x16x32_bf16 v[108:111], a[212:215], v[236:239], v[108:111]
    v_mfma_f32_16x16x32_bf16 v[104:107], a[232:235], v[240:243], v[104:107]
    ds_write_b128 v201, v[96:99] offset:2048
    v_mfma_f32_16x16x32_bf16 v[108:111], a[232:235], v[244:247], v[108:111]
    v_mfma_f32_16x16x32_bf16 v[104:107], a[252:255], v[248:251], v[104:107]
    ds_write_b128 v201, v[100:103] offset:3072
    v_mfma_f32_16x16x32_bf16 v[108:111], a[252:255], v[252:255], v[108:111]
    v_mfma_f32_16x16x32_bf16 v[80:83], a[160:163], v[216:219], v[120:123]
    v_mfma_f32_16x16x32_bf16 v[84:87], a[160:163], v[220:223], v[124:127]
    v_mfma_f32_16x16x32_bf16 v[80:83], a[180:183], v[224:227], v[80:83]
    v_mfma_f32_16x16x32_bf16 v[84:87], a[180:183], v[228:231], v[84:87]
    v_mfma_f32_16x16x32_bf16 v[80:83], a[200:203], v[232:235], v[80:83]
    s_nop 0
    ds_write_b128 v202, v[104:107] offset:4096
    v_mfma_f32_16x16x32_bf16 v[84:87], a[200:203], v[236:239], v[84:87]
    ds_write_b128 v202, v[108:111] offset:5120
    v_mfma_f32_16x16x32_bf16 v[80:83], a[220:223], v[240:243], v[80:83]
    v_mfma_f32_16x16x32_bf16 v[84:87], a[220:223], v[244:247], v[84:87]
    v_mfma_f32_16x16x32_bf16 v[80:83], a[240:243], v[248:251], v[80:83]
    v_mfma_f32_16x16x32_bf16 v[84:87], a[240:243], v[252:255], v[84:87]
    s_waitcnt lgkmcnt(0)
    s_barrier
    s_nop 0
    ds_read_b128 v[88:91], v204 offset:0
    ds_read_b128 v[92:95], v204 offset:1024
    ds_read_b128 v[96:99], v204 offset:2048
    ds_read_b128 v[100:103], v204 offset:3072
    ds_read_b128 v[104:107], v204 offset:4096
    ds_read_b128 v[108:111], v204 offset:5120
    ds_read_b64 v[112:113], v205 offset:24576
    ds_read_b64 v[114:115], v205 offset:26624
    ds_read_b64 v[116:117], v205 offset:28672
    ds_read_b64 v[118:119], v205 offset:30720
    s_mov_b32 s96, 12062720
    buffer_load_dwordx4 v[216:219], v56, s[16:19], s96 offen offset:0 sc1
    buffer_load_dwordx4 v[220:223], v56, s[16:19], s96 offen offset:256 sc1
    s_mov_b32 s96, 12095488
    buffer_load_dwordx4 v[224:227], v56, s[16:19], s96 offen offset:0 sc1
    buffer_load_dwordx4 v[228:231], v56, s[16:19], s96 offen offset:256 sc1
    s_mov_b32 s96, 12128256
    buffer_load_dwordx4 v[232:235], v56, s[16:19], s96 offen offset:0 sc1
    buffer_load_dwordx4 v[236:239], v56, s[16:19], s96 offen offset:256 sc1
    s_waitcnt lgkmcnt(9)
    v_pk_add_f32 v[80:81], v[80:81], v[88:89]
    v_pk_add_f32 v[82:83], v[82:83], v[90:91]
    s_waitcnt lgkmcnt(8)
    v_pk_add_f32 v[84:85], v[84:85], v[92:93]
    v_pk_add_f32 v[86:87], v[86:87], v[94:95]
    s_waitcnt lgkmcnt(7)
    v_pk_add_f32 v[80:81], v[80:81], v[96:97]
    v_pk_add_f32 v[82:83], v[82:83], v[98:99]
    s_waitcnt lgkmcnt(6)
    v_pk_add_f32 v[84:85], v[84:85], v[100:101]
    v_pk_add_f32 v[86:87], v[86:87], v[102:103]
    s_waitcnt lgkmcnt(5)
    v_pk_add_f32 v[80:81], v[80:81], v[104:105]
    v_pk_add_f32 v[82:83], v[82:83], v[106:107]
    s_waitcnt lgkmcnt(4)
    v_pk_add_f32 v[84:85], v[84:85], v[108:109]
    v_pk_add_f32 v[86:87], v[86:87], v[110:111]
    v_cvt_pk_bf16_f32 v132, v80, v81
    v_cvt_pk_bf16_f32 v133, v82, v83
    v_cvt_pk_bf16_f32 v134, v84, v85
    v_cvt_pk_bf16_f32 v135, v86, v87
    s_waitcnt lgkmcnt(3)
    v_pk_add_f32 v[128:129], v[128:129], v[112:113]
    s_waitcnt lgkmcnt(2)
    v_pk_add_f32 v[128:129], v[128:129], v[114:115]
    s_waitcnt lgkmcnt(1)
    v_pk_add_f32 v[128:129], v[128:129], v[116:117]
    s_waitcnt lgkmcnt(0)
    v_pk_add_f32 v[128:129], v[128:129], v[118:119]
    v_cvt_pk_bf16_f32 v130, v128, v129
    buffer_store_dwordx4 v[132:135], v59, s[16:19], s25 offen sc1
    buffer_store_dword v130, v61, s[16:19], s26 offen sc1
    v_dot2c_f32_bf16 v136, v132, v215
    v_dot2c_f32_bf16 v137, v132, v132
    v_dot2c_f32_bf16 v136, v133, v215
    v_dot2c_f32_bf16 v137, v133, v133
    v_dot2c_f32_bf16 v138, v134, v215
    v_dot2c_f32_bf16 v139, v134, v134
    v_dot2c_f32_bf16 v138, v135, v215
    v_dot2c_f32_bf16 v139, v135, v135
    v_dot2c_f32_bf16 v140, v130, v215
    v_dot2c_f32_bf16 v141, v130, v130
    v_permlane32_swap_b32 v136, v138
    v_permlane32_swap_b32 v137, v139
    v_pk_add_f32 v[136:137], v[136:137], v[138:139]
    v_pk_add_f32 v[136:137], v[136:137], v[140:141]
    s_nop 1
    v_permlane16_swap_b32 v136, v137
    v_add_f32_e64 v136, v136, v137
    ds_write_b32 v206, v136 offset:32768
    s_mov_b32 s96, 12161024
    buffer_load_dwordx4 v[240:243], v56, s[16:19], s96 offen offset:0 sc1
    buffer_load_dwordx4 v[244:247], v56, s[16:19], s96 offen offset:256 sc1
    s_mov_b32 s96, 12060672
    buffer_load_dwordx2 v[248:249], v57, s[16:19], s96 offen offset:0 sc1
    buffer_load_dwordx2 v[252:253], v57, s[16:19], s96 offen offset:128 sc1
    s_mov_b32 s96, 12077056
    buffer_load_dwordx2 v[250:251], v57, s[16:19], s96 offen offset:0 sc1
    buffer_load_dwordx2 v[254:255], v57, s[16:19], s96 offen offset:128 sc1
    s_mov_b32 s96, 9439232
    buffer_load_dwordx4 v[208:211], v59, s[16:19], s96 offen sc1
    s_add_u32 s97, s36, 9439232
    buffer_load_dword v212, v61, s[16:19], s97 offen sc1
    s_waitcnt lgkmcnt(0)
    s_barrier
    ds_read2st64_b32 v[136:137], v207 offset0:0 offset1:1
    ds_read2st64_b32 v[138:139], v207 offset0:2 offset1:3
    ds_read_b64_tr_b16 v[144:145], v65 offset:32
    ds_read_b64_tr_b16 v[146:147], v65 offset:0
    ds_read_b64_tr_b16 v[148:149], v65 offset:160
    ds_read_b64_tr_b16 v[150:151], v65 offset:128
    ds_read_b64_tr_b16 v[152:153], v65 offset:288
    ds_read_b64_tr_b16 v[154:155], v65 offset:256
    ds_read_b64_tr_b16 v[156:157], v65 offset:416
    ds_read_b64_tr_b16 v[158:159], v65 offset:384
    ds_read_b64_tr_b16 v[160:161], v65 offset:544
    ds_read_b64_tr_b16 v[162:163], v65 offset:512
    ds_read_b64_tr_b16 v[164:165], v65 offset:672
    ds_read_b64_tr_b16 v[166:167], v65 offset:640
    ds_read_b64_tr_b16 v[168:169], v65 offset:800
    ds_read_b64_tr_b16 v[170:171], v65 offset:768
    ds_read_b64_tr_b16 v[172:173], v65 offset:928
    ds_read_b64_tr_b16 v[174:175], v65 offset:896
    s_waitcnt lgkmcnt(15)
    v_pk_add_f32 v[136:137], v[136:137], v[138:139]
    v_add_f32 v136, v136, v137
    v_cndmask_b32 v136, v136, 1.0, s[28:29]
    s_mov_b64 exec, s[80:81]
    buffer_atomic_add_f32 v136, v214, s[16:19], s27 offen
    s_mov_b64 exec, -1
    v_lshrrev_b32 v176, 4, v0
    v_mul_u32_u24 v176, 1216, v176
    v_and_b32 v177, 15, v0
    v_lshl_add_u32 v176, v177, 3, v176
    v_add_u32 v176, 64, v176
    v_mov_b32 v178, 0
    v_mov_b32 v179, 0
    ds_write_b64 v176, v[178:179]
    v_mov_b32 v70, 0
    v_mov_b32 v71, 0
    v_mov_b32 v72, 0
oe_78:
    s_waitcnt vmcnt(16)
    v_mfma_f32_16x16x32_bf16 v[112:115], a[176:179], v[216:219], 0
    v_mov_b32 v136, 0
    v_mov_b32 v137, 0
    s_waitcnt vmcnt(15)
    v_mfma_f32_16x16x32_bf16 v[116:119], a[176:179], v[220:223], 0
    v_mov_b32 v138, 0
    v_mov_b32 v139, 0
    s_waitcnt vmcnt(14)
    v_mfma_f32_16x16x32_bf16 v[112:115], a[196:199], v[224:227], v[112:115]
    v_mov_b32 v140, 0
    v_mov_b32 v141, 0
    s_waitcnt vmcnt(13)
    v_mfma_f32_16x16x32_bf16 v[116:119], a[196:199], v[228:231], v[116:119]
    s_mov_b32 s25, 14682112
    s_add_u32 s26, s36, 14682112
    s_waitcnt vmcnt(12)
    v_mfma_f32_16x16x32_bf16 v[112:115], a[216:219], v[232:235], v[112:115]
    s_add_u32 s27, s35, 3510272
    s_mov_b32 s28, 0x99999999
    s_waitcnt vmcnt(11)
    v_mfma_f32_16x16x32_bf16 v[116:119], a[216:219], v[236:239], v[116:119]
    s_mov_b32 s29, 0x99999999
    s_waitcnt vmcnt(8)
    v_mfma_f32_16x16x32_bf16 v[112:115], a[236:239], v[240:243], v[112:115]
    s_waitcnt vmcnt(7)
    v_mfma_f32_16x16x32_bf16 v[116:119], a[236:239], v[244:247], v[116:119]
    s_waitcnt vmcnt(4)
    v_mfma_f32_16x16x32_bf16 v[112:115], v[52:55], v[248:251], v[112:115]
    s_waitcnt vmcnt(3)
    v_mfma_f32_16x16x32_bf16 v[116:119], v[52:55], v[252:255], v[116:119]
    v_mfma_f32_16x16x32_bf16 v[88:91], a[164:167], v[216:219], 0
    v_mfma_f32_16x16x32_bf16 v[92:95], a[164:167], v[220:223], 0
    v_mfma_f32_16x16x32_bf16 v[88:91], a[184:187], v[224:227], v[88:91]
    s_waitcnt vmcnt(2)
    v_max3_u32 v132, v208, v209, v210
    s_waitcnt vmcnt(1)
    v_max3_u32 v132, v132, v211, v212
    v_mfma_f32_16x16x32_bf16 v[92:95], a[184:187], v[228:231], v[92:95]
    v_cmp_eq_u32 s[82:83], -1, v132
    v_mfma_f32_16x16x32_bf16 v[88:91], a[204:207], v[232:235], v[88:91]
    v_mfma_f32_16x16x32_bf16 v[92:95], a[204:207], v[236:239], v[92:95]
    v_cmp_u_f32 vcc, v112, v116
    s_nop 0
    s_or_b64 vcc, vcc, s[82:83]
    s_cbranch_vccnz rd_79
rc_80:
    v_mfma_f32_16x16x32_bf16 v[88:91], a[224:227], v[240:243], v[88:91]
    ds_write_b128 v203, v[112:115] offset:24576
    v_mfma_f32_16x16x32_bf16 v[92:95], a[224:227], v[244:247], v[92:95]
    v_mfma_f32_16x16x32_bf16 v[88:91], a[244:247], v[248:251], v[88:91]
    ds_write_b128 v203, v[116:119] offset:25600
    v_mfma_f32_16x16x32_bf16 v[92:95], a[244:247], v[252:255], v[92:95]
    v_mfma_f32_16x16x32_bf16 v[96:99], a[168:171], v[216:219], 0
    v_lshlrev_b32_e64 v120, 16, v208
    v_and_b32 v121, 0xffff0000, v208
    v_mfma_f32_16x16x32_bf16 v[100:103], a[168:171], v[220:223], 0
    v_lshlrev_b32_e64 v122, 16, v209
    v_and_b32 v123, 0xffff0000, v209
    v_mfma_f32_16x16x32_bf16 v[96:99], a[188:191], v[224:227], v[96:99]
    v_lshlrev_b32_e64 v124, 16, v210
    v_and_b32 v125, 0xffff0000, v210
    v_mfma_f32_16x16x32_bf16 v[100:103], a[188:191], v[228:231], v[100:103]
    v_lshlrev_b32_e64 v126, 16, v211
    v_and_b32 v127, 0xffff0000, v211
    v_mfma_f32_16x16x32_bf16 v[96:99], a[208:211], v[232:235], v[96:99]
    v_lshlrev_b32_e64 v128, 16, v212
    v_and_b32 v129, 0xffff0000, v212
    v_mfma_f32_16x16x32_bf16 v[100:103], a[208:211], v[236:239], v[100:103]
    v_mfma_f32_16x16x32_bf16 v[96:99], a[228:231], v[240:243], v[96:99]
    ds_write_b128 v200, v[88:91] offset:0
    v_mfma_f32_16x16x32_bf16 v[100:103], a[228:231], v[244:247], v[100:103]
    v_mfma_f32_16x16x32_bf16 v[96:99], a[248:251], v[248:251], v[96:99]
    ds_write_b128 v200, v[92:95] offset:1024
    v_mfma_f32_16x16x32_bf16 v[100:103], a[248:251], v[252:255], v[100:103]
    v_mfma_f32_16x16x32_bf16 v[104:107], a[172:175], v[216:219], 0
    v_mfma_f32_16x16x32_bf16 v[108:111], a[172:175], v[220:223], 0
    v_mfma_f32_16x16x32_bf16 v[104:107], a[192:195], v[224:227], v[104:107]
    v_mfma_f32_16x16x32_bf16 v[108:111], a[192:195], v[228:231], v[108:111]
    v_mfma_f32_16x16x32_bf16 v[104:107], a[212:215], v[232:235], v[104:107]
    v_mfma_f32_16x16x32_bf16 v[108:111], a[212:215], v[236:239], v[108:111]
    v_mfma_f32_16x16x32_bf16 v[104:107], a[232:235], v[240:243], v[104:107]
    ds_write_b128 v201, v[96:99] offset:2048
    v_mfma_f32_16x16x32_bf16 v[108:111], a[232:235], v[244:247], v[108:111]
    v_mfma_f32_16x16x32_bf16 v[104:107], a[252:255], v[248:251], v[104:107]
    ds_write_b128 v201, v[100:103] offset:3072
    v_mfma_f32_16x16x32_bf16 v[108:111], a[252:255], v[252:255], v[108:111]
    v_mfma_f32_16x16x32_bf16 v[80:83], a[160:163], v[216:219], v[120:123]
    v_mfma_f32_16x16x32_bf16 v[84:87], a[160:163], v[220:223], v[124:127]
    v_mfma_f32_16x16x32_bf16 v[80:83], a[180:183], v[224:227], v[80:83]
    v_mfma_f32_16x16x32_bf16 v[84:87], a[180:183], v[228:231], v[84:87]
    v_mfma_f32_16x16x32_bf16 v[80:83], a[200:203], v[232:235], v[80:83]
    s_nop 0
    ds_write_b128 v202, v[104:107] offset:4096
    v_mfma_f32_16x16x32_bf16 v[84:87], a[200:203], v[236:239], v[84:87]
    ds_write_b128 v202, v[108:111] offset:5120
    v_mfma_f32_16x16x32_bf16 v[80:83], a[220:223], v[240:243], v[80:83]
    v_mfma_f32_16x16x32_bf16 v[84:87], a[220:223], v[244:247], v[84:87]
    v_mfma_f32_16x16x32_bf16 v[80:83], a[240:243], v[248:251], v[80:83]
    v_mfma_f32_16x16x32_bf16 v[84:87], a[240:243], v[252:255], v[84:87]
    s_waitcnt lgkmcnt(0)
    s_barrier
    s_nop 0
    ds_read_b128 v[88:91], v204 offset:0
    ds_read_b128 v[92:95], v204 offset:1024
    ds_read_b128 v[96:99], v204 offset:2048
    ds_read_b128 v[100:103], v204 offset:3072
    ds_read_b128 v[104:107], v204 offset:4096
    ds_read_b128 v[108:111], v204 offset:5120
    ds_read_b64 v[112:113], v205 offset:24576
    ds_read_b64 v[114:115], v205 offset:26624
    ds_read_b64 v[116:117], v205 offset:28672
    ds_read_b64 v[118:119], v205 offset:30720
    s_lshl_b32 s96, s75, 14
    s_add_u32 s96, s96, 14680064
    s_lshl_b32 s97, s24, 12
    s_add_u32 s97, s97, 3506176
    buffer_load_dwordx4 v[176:179], v62, s[16:19], s96 offen offset:0 sc1
    buffer_load_dwordx4 v[180:183], v62, s[16:19], s96 offen offset:1024 sc1
    buffer_load_dwordx4 v[184:187], v62, s[16:19], s97 offen offset:0 sc1
    buffer_load_dwordx4 v[188:191], v62, s[16:19], s97 offen offset:1024 sc1
    buffer_load_dwordx4 v[192:195], v62, s[16:19], s97 offen offset:2048 sc1
    buffer_load_dwordx4 v[196:199], v62, s[16:19], s97 offen offset:3072 sc1
    s_waitcnt lgkmcnt(9)
    v_pk_add_f32 v[80:81], v[80:81], v[88:89]
    v_pk_add_f32 v[82:83], v[82:83], v[90:91]
    s_waitcnt lgkmcnt(8)
    v_pk_add_f32 v[84:85], v[84:85], v[92:93]
    v_pk_add_f32 v[86:87], v[86:87], v[94:95]
    s_waitcnt lgkmcnt(7)
    v_pk_add_f32 v[80:81], v[80:81], v[96:97]
    v_pk_add_f32 v[82:83], v[82:83], v[98:99]
    s_waitcnt lgkmcnt(6)
    v_pk_add_f32 v[84:85], v[84:85], v[100:101]
    v_pk_add_f32 v[86:87], v[86:87], v[102:103]
    s_waitcnt lgkmcnt(5)
    v_pk_add_f32 v[80:81], v[80:81], v[104:105]
    v_pk_add_f32 v[82:83], v[82:83], v[106:107]
    s_waitcnt lgkmcnt(4)
    v_pk_add_f32 v[84:85], v[84:85], v[108:109]
    v_pk_add_f32 v[86:87], v[86:87], v[110:111]
    v_cvt_pk_bf16_f32 v132, v80, v81
    v_cvt_pk_bf16_f32 v133, v82, v83
    v_cvt_pk_bf16_f32 v134, v84, v85
    v_cvt_pk_bf16_f32 v135, v86, v87
    s_waitcnt lgkmcnt(3)
    v_pk_add_f32 v[128:129], v[128:129], v[112:113]
    s_waitcnt lgkmcnt(2)
    v_pk_add_f32 v[128:129], v[128:129], v[114:115]
    s_waitcnt lgkmcnt(1)
    v_pk_add_f32 v[128:129], v[128:129], v[116:117]
    s_waitcnt lgkmcnt(0)
    v_pk_add_f32 v[128:129], v[128:129], v[118:119]
    v_cvt_pk_bf16_f32 v130, v128, v129
    buffer_store_dwordx4 v[132:135], v59, s[16:19], s25 offen sc1
    buffer_store_dword v130, v61, s[16:19], s26 offen sc1
    v_dot2c_f32_bf16 v136, v132, v215
    v_dot2c_f32_bf16 v137, v132, v132
    v_dot2c_f32_bf16 v136, v133, v215
    v_dot2c_f32_bf16 v137, v133, v133
    v_dot2c_f32_bf16 v138, v134, v215
    v_dot2c_f32_bf16 v139, v134, v134
    v_dot2c_f32_bf16 v138, v135, v215
    v_dot2c_f32_bf16 v139, v135, v135
    v_dot2c_f32_bf16 v140, v130, v215
    v_dot2c_f32_bf16 v141, v130, v130
    v_permlane32_swap_b32 v136, v138
    v_permlane32_swap_b32 v137, v139
    v_pk_add_f32 v[136:137], v[136:137], v[138:139]
    v_pk_add_f32 v[136:137], v[136:137], v[140:141]
    s_nop 1
    v_permlane16_swap_b32 v136, v137
    v_add_f32 v136, v136, v137
    ds_write_b32 v206, v136 offset:32768
    s_waitcnt lgkmcnt(0)
    s_barrier
    ds_read2st64_b32 v[136:137], v207 offset0:0 offset1:1
    ds_read2st64_b32 v[138:139], v207 offset0:2 offset1:3
    s_waitcnt lgkmcnt(0)
    v_pk_add_f32 v[136:137], v[136:137], v[138:139]
    v_add_f32 v136, v136, v137
    v_cndmask_b32 v136, v136, 1.0, s[28:29]
    s_mov_b64 exec, s[80:81]
    buffer_atomic_add_f32 v136, v214, s[16:19], s27 offen
    s_mov_b64 exec, -1
    s_cmp_ge_u32 s2, 160
    s_cbranch_scc1 nc_81
    s_waitcnt vmcnt(3)
ce_83:
    v_max3_u32 v208, v176, v177, v178
    v_max3_u32 v208, v208, v179, v180
    v_max3_u32 v208, v208, v181, v182
    v_max_u32 v208, v208, v183
    v_cmp_eq_u32 s[82:83], -1, v208
    v_min3_f32 v209, v184, v187, v188
    v_min3_f32 v209, v209, v191, v192
    v_min3_f32 v209, v209, v195, v196
    v_min_f32 v209, v209, v199
    v_cmp_neq_f32 vcc, 0x41000000, v209
    s_nop 0
    s_or_b64 vcc, vcc, s[82:83]
    s_cbranch_vccnz rd_84
rc_85:
    v_mul_f32 v208, 0x3acccccd, v185
    v_mul_f32 v209, 0x3acccccd, v189
    v_mul_f32 v186, 0x3acccccd, v186
    v_mul_f32 v190, 0x3acccccd, v190
    v_fma_f32 v186, -v208, v208, v186
    v_fma_f32 v190, -v209, v209, v190
    v_max_f32 v186, 0, v186
    v_max_f32 v190, 0, v190
    v_add_f32 v186, 0x3727c5ac, v186
    v_add_f32 v190, 0x3727c5ac, v190
    v_rsq_f32 v185, v186
    v_rsq_f32 v189, v190
    v_mul_f32 v186, -v208, v185
    v_mul_f32 v190, -v209, v189
    v_lshlrev_b32 v80, 16, v176
    v_and_b32 v82, 0xffff0000, v176
    v_lshlrev_b32 v84, 16, v177
    v_and_b32 v86, 0xffff0000, v177
    v_lshlrev_b32 v81, 16, v178
    v_and_b32 v83, 0xffff0000, v178
    v_lshlrev_b32 v85, 16, v179
    v_and_b32 v87, 0xffff0000, v179
    v_fma_f32 v208, v80, v185, v186
    v_fma_f32 v209, v81, v189, v190
    v_cvt_pk_bf16_f32 v176, v208, v209
    v_fma_f32 v208, v82, v185, v186
    v_fma_f32 v209, v83, v189, v190
    v_cvt_pk_bf16_f32 v177, v208, v209
    v_fma_f32 v208, v84, v185, v186
    v_fma_f32 v209, v85, v189, v190
    v_cvt_pk_bf16_f32 v178, v208, v209
    v_fma_f32 v208, v86, v185, v186
    v_fma_f32 v209, v87, v189, v190
    v_cvt_pk_bf16_f32 v179, v208, v209
    ds_write_b32 v63, v176 offset:0
    ds_write_b32 v63, v177 offset:4864
    ds_write_b32 v63, v178 offset:9728
    ds_write_b32 v63, v179 offset:14592
    v_mul_f32 v208, 0x3acccccd, v193
    v_mul_f32 v209, 0x3acccccd, v197
    v_mul_f32 v194, 0x3acccccd, v194
    v_mul_f32 v198, 0x3acccccd, v198
    v_fma_f32 v194, -v208, v208, v194
    v_fma_f32 v198, -v209, v209, v198
    v_max_f32 v194, 0, v194
    v_max_f32 v198, 0, v198
    v_add_f32 v194, 0x3727c5ac, v194
    v_add_f32 v198, 0x3727c5ac, v198
    v_rsq_f32 v193, v194
    v_rsq_f32 v197, v198
    v_mul_f32 v194, -v208, v193
    v_mul_f32 v198, -v209, v197
    v_lshlrev_b32 v88, 16, v180
    v_and_b32 v90, 0xffff0000, v180
    v_lshlrev_b32 v92, 16, v181
    v_and_b32 v94, 0xffff0000, v181
    v_lshlrev_b32 v89, 16, v182
    v_and_b32 v91, 0xffff0000, v182
    v_lshlrev_b32 v93, 16, v183
    v_and_b32 v95, 0xffff0000, v183
    v_fma_f32 v208, v88, v193, v194
    v_fma_f32 v209, v89, v197, v198
    v_cvt_pk_bf16_f32 v180, v208, v209
    v_fma_f32 v208, v90, v193, v194
    v_fma_f32 v209, v91, v197, v198
    v_cvt_pk_bf16_f32 v181, v208, v209
    v_fma_f32 v208, v92, v193, v194
    v_fma_f32 v209, v93, v197, v198
    v_cvt_pk_bf16_f32 v182, v208, v209
    v_fma_f32 v208, v94, v193, v194
    v_fma_f32 v209, v95, v197, v198
    v_cvt_pk_bf16_f32 v183, v208, v209
    ds_write_b32 v63, v180 offset:256
    ds_write_b32 v63, v181 offset:5120
    ds_write_b32 v63, v182 offset:9984
    ds_write_b32 v63, v183 offset:14848
    s_waitcnt lgkmcnt(0)
    s_barrier
    ds_read_b128 v[212:215], v64 offset:96
    ds_read_b128 v[216:219], v64 offset:64
    ds_read_b128 v[220:223], v64 offset:32
    ds_read_b128 v[224:227], v64 offset:0
    s_waitcnt lgkmcnt(3)
    v_mfma_f32_32x32x16_bf16 v[96:111], v[212:215], v[144:147], 0
    ds_read_b128 v[228:231], v64 offset:224
    ds_read_b64_tr_b16 v[176:177], v65 offset:1056
    ds_read_b64_tr_b16 v[178:179], v65 offset:1024
    ds_read_b64_tr_b16 v[180:181], v65 offset:1184
    ds_read_b64_tr_b16 v[182:183], v65 offset:1152
    s_waitcnt lgkmcnt(7)
    v_mfma_f32_32x32x16_bf16 v[96:111], v[216:219], v[148:151], v[96:111]
    ds_read_b128 v[232:235], v64 offset:192
    ds_read_b64_tr_b16 v[184:185], v65 offset:1312
    ds_read_b64_tr_b16 v[186:187], v65 offset:1280
    ds_read_b64_tr_b16 v[188:189], v65 offset:1440
    ds_read_b64_tr_b16 v[190:191], v65 offset:1408
    s_waitcnt lgkmcnt(11)
    v_mfma_f32_32x32x16_bf16 v[96:111], v[220:223], v[152:155], v[96:111]
    ds_read_b128 v[236:239], v64 offset:160
    ds_read_b64_tr_b16 v[192:193], v65 offset:1568
    ds_read_b64_tr_b16 v[194:195], v65 offset:1536
    ds_read_b64_tr_b16 v[196:197], v65 offset:1696
    ds_read_b64_tr_b16 v[198:199], v65 offset:1664
    s_waitcnt lgkmcnt(15)
    v_mfma_f32_32x32x16_bf16 v[96:111], v[224:227], v[156:159], v[96:111]
    ds_read_b128 v[240:243], v64 offset:128
    ds_read_b64_tr_b16 v[200:201], v65 offset:1824
    ds_read_b64_tr_b16 v[202:203], v65 offset:1792
    ds_read_b64_tr_b16 v[204:205], v65 offset:1952
    ds_read_b64_tr_b16 v[206:207], v65 offset:1920
    s_waitcnt lgkmcnt(15)
    v_mfma_f32_32x32x16_bf16 v[112:127], v[228:231], v[144:147], 0
    s_nop 4
    s_waitcnt lgkmcnt(14)
    v_mfma_f32_32x32x16_bf16 v[112:127], v[232:235], v[148:151], v[112:127]
    v_cndmask_b32 v208, v99, v72, s[76:77]
    v_cndmask_b32 v209, v103, v99, s[76:77]
    v_cndmask_b32 v210, v107, v103, s[76:77]
    v_cndmask_b32 v211, v111, v107, s[76:77]
    v_mov_b32_e64 v72, v111
    s_waitcnt lgkmcnt(9)
    v_mfma_f32_32x32x16_bf16 v[112:127], v[236:239], v[152:155], v[112:127]
    v_add_f32_dpp v98, v208, v98 wave_ror:1 row_mask:0xf bank_mask:0xf
    v_add_f32_dpp v102, v209, v102 wave_ror:1 row_mask:0xf bank_mask:0xf
    v_add_f32_dpp v106, v210, v106 wave_ror:1 row_mask:0xf bank_mask:0xf
    v_add_f32_dpp v110, v211, v110 wave_ror:1 row_mask:0xf bank_mask:0xf
    v_cndmask_b32 v208, v98, v71, s[76:77]
    s_waitcnt lgkmcnt(4)
    v_mfma_f32_32x32x16_bf16 v[112:127], v[240:243], v[156:159], v[112:127]
    v_cndmask_b32 v209, v102, v98, s[76:77]
    v_cndmask_b32 v210, v106, v102, s[76:77]
    v_cndmask_b32 v211, v110, v106, s[76:77]
    v_mov_b32 v71, v110
    v_add_f32_dpp v97, v208, v97 wave_ror:1 row_mask:0xf bank_mask:0xf
    v_add_f32_dpp v101, v209, v101 wave_ror:1 row_mask:0xf bank_mask:0xf
    v_mfma_f32_32x32x16_bf16 v[112:127], v[212:215], v[160:163], v[112:127]
    ds_read_b128 v[244:247], v64 offset:352
    v_add_f32_dpp v105, v210, v105 wave_ror:1 row_mask:0xf bank_mask:0xf
    v_add_f32_dpp v109, v211, v109 wave_ror:1 row_mask:0xf bank_mask:0xf
    v_cndmask_b32 v208, v97, v70, s[76:77]
    v_cndmask_b32 v209, v101, v97, s[76:77]
    v_cndmask_b32 v210, v105, v101, s[76:77]
    v_mfma_f32_32x32x16_bf16 v[112:127], v[216:219], v[164:167], v[112:127]
    ds_read_b128 v[216:219], v64 offset:320
    v_cndmask_b32 v211, v109, v105, s[76:77]
    v_mov_b32_e64 v70, v109
    v_add_f32_dpp v96, v208, v96 wave_ror:1 row_mask:0xf bank_mask:0xf
    v_add_f32_dpp v100, v209, v100 wave_ror:1 row_mask:0xf bank_mask:0xf
    v_add_f32_dpp v104, v210, v104 wave_ror:1 row_mask:0xf bank_mask:0xf
    v_mfma_f32_32x32x16_bf16 v[112:127], v[220:223], v[168:171], v[112:127]
    ds_read_b128 v[220:223], v64 offset:288
    v_add_f32_dpp v108, v211, v108 wave_ror:1 row_mask:0xf bank_mask:0xf
    ds_write_b32 v66, v96 offset:0
    v_mfma_f32_32x32x16_bf16 v[112:127], v[224:227], v[172:175], v[112:127]
    ds_read_b128 v[224:227], v64 offset:256
    ds_write_b32 v66, v100 offset:64
    ds_write_b32 v66, v104 offset:128
    s_waitcnt lgkmcnt(6)
    v_mfma_f32_32x32x16_bf16 v[128:143], v[244:247], v[144:147], 0
    ds_write_b32 v66, v108 offset:192
    s_nop 2
    s_waitcnt lgkmcnt(6)
    v_mfma_f32_32x32x16_bf16 v[128:143], v[216:219], v[148:151], v[128:143]
    s_nop 2
    v_cndmask_b32 v208, v115, v72, s[76:77]
    v_cndmask_b32 v209, v119, v115, s[76:77]
    s_waitcnt lgkmcnt(5)
    v_mfma_f32_32x32x16_bf16 v[128:143], v[220:223], v[152:155], v[128:143]
    v_cndmask_b32 v210, v123, v119, s[76:77]
    v_cndmask_b32 v211, v127, v123, s[76:77]
    v_mov_b32 v72, v127
    v_add_f32_dpp v114, v208, v114 wave_ror:1 row_mask:0xf bank_mask:0xf
    v_add_f32_dpp v118, v209, v118 wave_ror:1 row_mask:0xf bank_mask:0xf
    s_waitcnt lgkmcnt(3)
    v_mfma_f32_32x32x16_bf16 v[128:143], v[224:227], v[156:159], v[128:143]
    v_add_f32_dpp v122, v210, v122 wave_ror:1 row_mask:0xf bank_mask:0xf
    v_add_f32_dpp v126, v211, v126 wave_ror:1 row_mask:0xf bank_mask:0xf
    v_cndmask_b32 v208, v114, v71, s[76:77]
    v_cndmask_b32 v209, v118, v114, s[76:77]
    v_cndmask_b32 v210, v122, v118, s[76:77]
    v_cndmask_b32 v211, v126, v122, s[76:77]
    v_mfma_f32_32x32x16_bf16 v[128:143], v[228:231], v[160:163], v[128:143]
    v_mov_b32 v71, v126
    v_add_f32_dpp v113, v208, v113 wave_ror:1 row_mask:0xf bank_mask:0xf
    v_add_f32_dpp v117, v209, v117 wave_ror:1 row_mask:0xf bank_mask:0xf
    v_add_f32_dpp v121, v210, v121 wave_ror:1 row_mask:0xf bank_mask:0xf
    v_add_f32_dpp v125, v211, v125 wave_ror:1 row_mask:0xf bank_mask:0xf
    v_cndmask_b32 v208, v113, v70, s[76:77]
    v_mfma_f32_32x32x16_bf16 v[128:143], v[232:235], v[164:167], v[128:143]
    ds_read_b128 v[232:235], v64 offset:64
    v_cndmask_b32 v209, v117, v113, s[76:77]
    v_cndmask_b32 v210, v121, v117, s[76:77]
    v_cndmask_b32 v211, v125, v121, s[76:77]
    v_mov_b32_e64 v70, v125
    v_add_f32_dpp v112, v208, v112 wave_ror:1 row_mask:0xf bank_mask:0xf
    v_mfma_f32_32x32x16_bf16 v[128:143], v[236:239], v[168:171], v[128:143]
    ds_read_b128 v[236:239], v64 offset:32
    v_add_f32_dpp v116, v209, v116 wave_ror:1 row_mask:0xf bank_mask:0xf
    v_add_f32_dpp v120, v210, v120 wave_ror:1 row_mask:0xf bank_mask:0xf
    v_add_f32_dpp v124, v211, v124 wave_ror:1 row_mask:0xf bank_mask:0xf
    v_mfma_f32_32x32x16_bf16 v[128:143], v[240:243], v[172:175], v[128:143]
    ds_read_b128 v[240:243], v64 offset:0
    ds_write_b32 v66, v112 offset:256
    ds_write_b32 v66, v116 offset:320
    v_mfma_f32_32x32x16_bf16 v[128:143], v[212:215], v[176:179], v[128:143]
    ds_read_b128 v[212:215], v64 offset:480
    ds_write_b32 v66, v120 offset:384
    ds_write_b32 v66, v124 offset:448
    s_waitcnt lgkmcnt(7)
    v_mfma_f32_32x32x16_bf16 v[128:143], v[232:235], v[180:183], v[128:143]
    ds_read_b128 v[232:235], v64 offset:448
    s_waitcnt lgkmcnt(7)
    v_mfma_f32_32x32x16_bf16 v[128:143], v[236:239], v[184:187], v[128:143]
    ds_read_b128 v[236:239], v64 offset:416
    s_waitcnt lgkmcnt(7)
    v_mfma_f32_32x32x16_bf16 v[128:143], v[240:243], v[188:191], v[128:143]
    ds_read_b128 v[240:243], v64 offset:384
    s_nop 3
    s_waitcnt lgkmcnt(5)
    v_mfma_f32_32x32x16_bf16 v[112:127], v[212:215], v[144:147], 0
    s_nop 4
    s_waitcnt lgkmcnt(2)
    v_mfma_f32_32x32x16_bf16 v[112:127], v[232:235], v[148:151], v[112:127]
    v_cndmask_b32 v208, v131, v72, s[76:77]
    v_cndmask_b32 v209, v135, v131, s[76:77]
    v_cndmask_b32 v210, v139, v135, s[76:77]
    v_cndmask_b32 v211, v143, v139, s[76:77]
    v_mov_b32_e64 v72, v143
    s_waitcnt lgkmcnt(1)
    v_mfma_f32_32x32x16_bf16 v[112:127], v[236:239], v[152:155], v[112:127]
    v_add_f32_dpp v130, v208, v130 wave_ror:1 row_mask:0xf bank_mask:0xf
    v_add_f32_dpp v134, v209, v134 wave_ror:1 row_mask:0xf bank_mask:0xf
    v_add_f32_dpp v138, v210, v138 wave_ror:1 row_mask:0xf bank_mask:0xf
    v_add_f32_dpp v142, v211, v142 wave_ror:1 row_mask:0xf bank_mask:0xf
    v_cndmask_b32 v208, v130, v71, s[76:77]
    s_waitcnt lgkmcnt(0)
    v_mfma_f32_32x32x16_bf16 v[112:127], v[240:243], v[156:159], v[112:127]
    v_cndmask_b32 v209, v134, v130, s[76:77]
    v_cndmask_b32 v210, v138, v134, s[76:77]
    v_cndmask_b32 v211, v142, v138, s[76:77]
    v_mov_b32 v71, v142
    v_add_f32_dpp v129, v208, v129 wave_ror:1 row_mask:0xf bank_mask:0xf
    v_add_f32_dpp v133, v209, v133 wave_ror:1 row_mask:0xf bank_mask:0xf
    v_mfma_f32_32x32x16_bf16 v[112:127], v[244:247], v[160:163], v[112:127]
    v_add_f32_dpp v137, v210, v137 wave_ror:1 row_mask:0xf bank_mask:0xf
    v_add_f32_dpp v141, v211, v141 wave_ror:1 row_mask:0xf bank_mask:0xf
    v_cndmask_b32 v208, v129, v70, s[76:77]
    v_cndmask_b32 v209, v133, v129, s[76:77]
    v_cndmask_b32 v210, v137, v133, s[76:77]
    v_cndmask_b32 v211, v141, v137, s[76:77]
    v_mfma_f32_32x32x16_bf16 v[112:127], v[216:219], v[164:167], v[112:127]
    ds_read_b128 v[240:243], v64 offset:192
    v_mov_b32_e64 v70, v141
    v_add_f32_dpp v128, v208, v128 wave_ror:1 row_mask:0xf bank_mask:0xf
    v_add_f32_dpp v132, v209, v132 wave_ror:1 row_mask:0xf bank_mask:0xf
    v_add_f32_dpp v136, v210, v136 wave_ror:1 row_mask:0xf bank_mask:0xf
    v_add_f32_dpp v140, v211, v140 wave_ror:1 row_mask:0xf bank_mask:0xf
    v_mfma_f32_32x32x16_bf16 v[112:127], v[220:223], v[168:171], v[112:127]
    ds_read_b128 v[220:223], v64 offset:160
    ds_write_b32 v66, v128 offset:512
    ds_write_b32 v66, v132 offset:576
    v_mfma_f32_32x32x16_bf16 v[112:127], v[224:227], v[172:175], v[112:127]
    ds_read_b128 v[224:227], v64 offset:128
    ds_write_b32 v66, v136 offset:640
    ds_write_b32 v66, v140 offset:704
    v_mfma_f32_32x32x16_bf16 v[112:127], v[228:231], v[176:179], v[112:127]
    ds_read_b128 v[236:239], v64 offset:96
    s_waitcnt lgkmcnt(7)
    v_mfma_f32_32x32x16_bf16 v[112:127], v[240:243], v[180:183], v[112:127]
    ds_read_b128 v[240:243], v64 offset:64
    s_waitcnt lgkmcnt(7)
    v_mfma_f32_32x32x16_bf16 v[112:127], v[220:223], v[184:187], v[112:127]
    ds_read_b128 v[220:223], v64 offset:32
    s_waitcnt lgkmcnt(5)
    v_mfma_f32_32x32x16_bf16 v[112:127], v[224:227], v[188:191], v[112:127]
    ds_read_b128 v[224:227], v64 offset:0
    s_waitcnt lgkmcnt(3)
    v_mfma_f32_32x32x16_bf16 v[112:127], v[236:239], v[192:195], v[112:127]
    ds_read_b64_tr_b16 v[216:217], v65 offset:544
    ds_read_b64_tr_b16 v[218:219], v65 offset:512
    s_waitcnt lgkmcnt(4)
    v_mfma_f32_32x32x16_bf16 v[112:127], v[240:243], v[196:199], v[112:127]
    ds_read_b64_tr_b16 v[240:241], v65 offset:1056
    ds_read_b64_tr_b16 v[242:243], v65 offset:1024
    s_waitcnt lgkmcnt(5)
    v_mfma_f32_32x32x16_bf16 v[112:127], v[220:223], v[200:203], v[112:127]
    s_waitcnt lgkmcnt(4)
    v_mfma_f32_32x32x16_bf16 v[112:127], v[224:227], v[204:207], v[112:127]
    ds_read_b64_tr_b16 v[224:225], v65 offset:1568
    ds_read_b64_tr_b16 v[226:227], v65 offset:1536
    s_lshl_b32 s96, s75, 14
    s_add_u32 s96, s96, 14680064
    s_lshl_b32 s97, s24, 12
    s_add_u32 s97, s97, 3510272
    buffer_load_dwordx4 v[248:251], v62, s[16:19], s96 offen offset:2048 sc1
    s_waitcnt lgkmcnt(4)
    v_mfma_f32_32x32x16_bf16 v[144:159], v[212:215], v[216:219], 0
    s_nop 3
    v_cndmask_b32 v208, v115, v72, s[76:77]
    s_waitcnt lgkmcnt(2)
    v_mfma_f32_32x32x16_bf16 v[144:159], v[244:247], v[240:243], v[144:159]
    buffer_load_dwordx4 v[252:255], v62, s[16:19], s96 offen offset:3072 sc1
    v_cndmask_b32 v209, v119, v115, s[76:77]
    v_cndmask_b32 v210, v123, v119, s[76:77]
    v_cndmask_b32 v211, v127, v123, s[76:77]
    v_mov_b32_e64 v72, v127
    v_add_f32_dpp v114, v208, v114 wave_ror:1 row_mask:0xf bank_mask:0xf
    v_mfma_f32_32x32x16_bf16 v[160:175], v[212:215], v[240:243], 0
    ds_read_b64_tr_b16 v[216:217], v65 offset:2080
    ds_read_b64_tr_b16 v[218:219], v65 offset:2048
    v_add_f32_dpp v118, v209, v118 wave_ror:1 row_mask:0xf bank_mask:0xf
    v_add_f32_dpp v122, v210, v122 wave_ror:1 row_mask:0xf bank_mask:0xf
    v_add_f32_dpp v126, v211, v126 wave_ror:1 row_mask:0xf bank_mask:0xf
    s_waitcnt lgkmcnt(2)
    v_mfma_f32_32x32x16_bf16 v[144:159], v[228:231], v[224:227], v[144:159]
    buffer_load_dwordx4 v[96:99], v62, s[16:19], s97 offen offset:0 sc1
    v_cndmask_b32 v208, v114, v71, s[76:77]
    v_cndmask_b32 v209, v118, v114, s[76:77]
    v_cndmask_b32 v210, v122, v118, s[76:77]
    v_cndmask_b32 v211, v126, v122, s[76:77]
    v_mov_b32 v71, v126
    v_mfma_f32_32x32x16_bf16 v[160:175], v[244:247], v[224:227], v[160:175]
    v_add_f32_dpp v113, v208, v113 wave_ror:1 row_mask:0xf bank_mask:0xf
    v_add_f32_dpp v117, v209, v117 wave_ror:1 row_mask:0xf bank_mask:0xf
    v_add_f32_dpp v121, v210, v121 wave_ror:1 row_mask:0xf bank_mask:0xf
    v_add_f32_dpp v125, v211, v125 wave_ror:1 row_mask:0xf bank_mask:0xf
    v_cndmask_b32 v208, v113, v70, s[76:77]
    v_cndmask_b32 v209, v117, v113, s[76:77]
    v_mfma_f32_32x32x16_bf16 v[176:191], v[212:215], v[224:227], 0
    buffer_load_dwordx4 v[100:103], v62, s[16:19], s97 offen offset:1024 sc1
    v_cndmask_b32 v210, v121, v117, s[76:77]
    v_cndmask_b32 v211, v125, v121, s[76:77]
    v_mov_b32 v70, v125
    v_add_f32_dpp v112, v208, v112 wave_ror:1 row_mask:0xf bank_mask:0xf
    s_waitcnt lgkmcnt(0)
    v_mfma_f32_32x32x16_bf16 v[144:159], v[236:239], v[216:219], v[144:159]
    ds_read_b64_tr_b16 v[240:241], v65 offset:2592
    ds_read_b64_tr_b16 v[242:243], v65 offset:2560
    v_add_f32_dpp v116, v209, v116 wave_ror:1 row_mask:0xf bank_mask:0xf
    v_add_f32_dpp v120, v210, v120 wave_ror:1 row_mask:0xf bank_mask:0xf
    v_add_f32_dpp v124, v211, v124 wave_ror:1 row_mask:0xf bank_mask:0xf
    v_mfma_f32_32x32x16_bf16 v[160:175], v[228:231], v[216:219], v[160:175]
    buffer_load_dwordx4 v[104:107], v62, s[16:19], s97 offen offset:2048 sc1
    ds_write_b32 v66, v112 offset:768
    ds_write_b32 v66, v116 offset:832
    v_mfma_f32_32x32x16_bf16 v[176:191], v[244:247], v[216:219], v[176:191]
    ds_write_b32 v66, v120 offset:896
    ds_write_b32 v66, v124 offset:960
    v_mfma_f32_32x32x16_bf16 v[192:207], v[212:215], v[216:219], 0
    ds_read_b64_tr_b16 v[212:213], v65 offset:3104
    ds_read_b64_tr_b16 v[214:215], v65 offset:3072
    buffer_load_dwordx4 v[108:111], v62, s[16:19], s97 offen offset:3072 sc1
    s_waitcnt lgkmcnt(6)
    v_mfma_f32_32x32x16_bf16 v[160:175], v[236:239], v[240:243], v[160:175]
    v_mfma_f32_32x32x16_bf16 v[176:191], v[228:231], v[240:243], v[176:191]
    ds_read_b64_tr_b16 v[224:225], v65 offset:3616
    ds_read_b64_tr_b16 v[226:227], v65 offset:3584
    s_waitcnt lgkmcnt(4)
    s_barrier
    v_mfma_f32_32x32x16_bf16 v[192:207], v[244:247], v[240:243], v[192:207]
    ds_read_b64_tr_b16 v[244:245], v65 offset:672
    ds_read_b64_tr_b16 v[246:247], v65 offset:640
    ds_read_b64 v[112:113], v67 offset:0
    ds_read_b64 v[114:115], v67 offset:4224
    ds_read_b64 v[116:117], v67 offset:8448
    s_waitcnt lgkmcnt(7)
    v_mfma_f32_32x32x16_bf16 v[176:191], v[236:239], v[212:215], v[176:191]
    ds_read_b128 v[216:219], v64 offset:320
    ds_read_b64_tr_b16 v[240:241], v65 offset:1184
    ds_read_b64_tr_b16 v[242:243], v65 offset:1152
    ds_read_b64 v[118:119], v67 offset:12672
    ds_read_b64 v[120:121], v67 offset:512
    ds_read_b64 v[122:123], v67 offset:4736
    v_mfma_f32_32x32x16_bf16 v[192:207], v[228:231], v[212:215], v[192:207]
    ds_read_b64 v[124:125], v67 offset:8960
    ds_read_b64 v[126:127], v67 offset:13184
    s_waitcnt lgkmcnt(13)
    v_mfma_f32_32x32x16_bf16 v[192:207], v[236:239], v[224:227], v[192:207]
    ds_read_b128 v[228:231], v64 offset:192
    ds_read_b64_tr_b16 v[236:237], v65 offset:1696
    ds_read_b64_tr_b16 v[238:239], v65 offset:1664
    s_waitcnt lgkmcnt(14)
    v_mfma_f32_32x32x16_bf16 v[144:159], v[232:235], v[244:247], v[144:159]
    s_waitcnt lgkmcnt(8)
    v_mfma_f32_32x32x16_bf16 v[144:159], v[216:219], v[240:243], v[144:159]
    v_mfma_f32_32x32x16_bf16 v[160:175], v[232:235], v[240:243], v[160:175]
    ds_read_b128 v[212:215], v64 offset:64
    ds_read_b64_tr_b16 v[224:225], v65 offset:2208
    ds_read_b64_tr_b16 v[226:227], v65 offset:2176
    s_waitcnt lgkmcnt(6)
    v_add_f32 v112, v112, v80
    s_waitcnt lgkmcnt(3)
    v_mfma_f32_32x32x16_bf16 v[144:159], v[228:231], v[236:239], v[144:159]
    v_add_f32 v113, v113, v81
    v_add_f32 v114, v114, v82
    v_add_f32 v115, v115, v83
    v_add_f32 v116, v116, v84
    v_add_f32 v117, v117, v85
    v_add_f32 v118, v118, v86
    v_mfma_f32_32x32x16_bf16 v[160:175], v[216:219], v[236:239], v[160:175]
    v_add_f32_e64 v119, v119, v87
    v_cvt_pk_bf16_f32 v128, v112, v114
    v_cvt_pk_bf16_f32 v129, v116, v118
    v_cvt_pk_bf16_f32 v130, v113, v115
    v_cvt_pk_bf16_f32 v131, v117, v119
    s_mov_b32 s25, 0
    v_mfma_f32_32x32x16_bf16 v[176:191], v[232:235], v[236:239], v[176:191]
    buffer_store_dwordx2 v[128:129], v68, s[20:23], s25 offen
    s_mov_b32 s25, 5120
    buffer_store_dwordx2 v[130:131], v68, s[20:23], s25 offen
    v_add_f32 v120, v120, v88
    v_add_f32 v121, v121, v89
    s_waitcnt lgkmcnt(0)
    v_mfma_f32_32x32x16_bf16 v[144:159], v[212:215], v[224:227], v[144:159]
    ds_read_b64_tr_b16 v[244:245], v65 offset:2720
    ds_read_b64_tr_b16 v[246:247], v65 offset:2688
    v_add_f32 v122, v122, v90
    v_add_f32 v123, v123, v91
    v_add_f32 v124, v124, v92
    v_add_f32 v125, v125, v93
    v_mfma_f32_32x32x16_bf16 v[160:175], v[228:231], v[224:227], v[160:175]
    v_add_f32 v126, v126, v94
    v_add_f32 v127, v127, v95
    v_cvt_pk_bf16_f32 v132, v120, v122
    v_cvt_pk_bf16_f32 v133, v124, v126
    v_cvt_pk_bf16_f32 v134, v121, v123
    v_cvt_pk_bf16_f32 v135, v125, v127
    v_mfma_f32_32x32x16_bf16 v[176:191], v[216:219], v[224:227], v[176:191]
    s_mov_b32 s25, 655360
    buffer_store_dwordx2 v[132:133], v68, s[20:23], s25 offen
    s_mov_b32 s25, 660480
    buffer_store_dwordx2 v[134:135], v68, s[20:23], s25 offen
    ds_read_b64_tr_b16 v[112:113], v65 offset:32
    ds_read_b64_tr_b16 v[114:115], v65 offset:0
    v_mfma_f32_32x32x16_bf16 v[192:207], v[232:235], v[224:227], v[192:207]
    ds_read_b64_tr_b16 v[232:233], v65 offset:3232
    ds_read_b64_tr_b16 v[234:235], v65 offset:3200
    ds_read_b64_tr_b16 v[116:117], v65 offset:160
    ds_read_b64_tr_b16 v[118:119], v65 offset:128
    ds_read_b64_tr_b16 v[120:121], v65 offset:288
    s_waitcnt lgkmcnt(7)
    v_mfma_f32_32x32x16_bf16 v[160:175], v[212:215], v[244:247], v[160:175]
    ds_read_b64_tr_b16 v[122:123], v65 offset:256
    ds_read_b64_tr_b16 v[124:125], v65 offset:416
    ds_read_b64_tr_b16 v[126:127], v65 offset:384
    ds_read_b64_tr_b16 v[128:129], v65 offset:544
    ds_read_b64_tr_b16 v[130:131], v65 offset:512
    ds_read_b64_tr_b16 v[132:133], v65 offset:672
    v_mfma_f32_32x32x16_bf16 v[176:191], v[228:231], v[244:247], v[176:191]
    ds_read_b64_tr_b16 v[240:241], v65 offset:3744
    ds_read_b64_tr_b16 v[242:243], v65 offset:3712
    ds_read_b64_tr_b16 v[134:135], v65 offset:640
    ds_read_b64_tr_b16 v[136:137], v65 offset:800
    ds_read_b64_tr_b16 v[138:139], v65 offset:768
    ds_read_b64_tr_b16 v[140:141], v65 offset:928
    v_mfma_f32_32x32x16_bf16 v[192:207], v[216:219], v[244:247], v[192:207]
    ds_read_b128 v[216:219], v64 offset:416
    ds_read_b64_tr_b16 v[236:237], v65 offset:800
    ds_read_b64_tr_b16 v[238:239], v65 offset:768
    ds_read_b64_tr_b16 v[142:143], v65 offset:896
    s_waitcnt lgkmcnt(15)
    v_mfma_f32_32x32x16_bf16 v[176:191], v[212:215], v[232:235], v[176:191]
    ds_read_b128 v[224:227], v64 offset:288
    ds_read_b64_tr_b16 v[244:245], v65 offset:1312
    ds_read_b64_tr_b16 v[246:247], v65 offset:1280
    s_waitcnt vmcnt(4)
ce_86:
    v_max3_u32 v208, v248, v249, v250
    v_max3_u32 v208, v208, v251, v252
    v_max3_u32 v208, v208, v253, v254
    v_max_u32 v208, v208, v255
    v_cmp_eq_u32 s[82:83], -1, v208
    v_min3_f32 v209, v96, v99, v100
    v_min3_f32 v209, v209, v103, v104
    v_min3_f32 v209, v209, v107, v108
    v_min_f32 v209, v209, v111
    v_cmp_neq_f32 vcc, 0x41000000, v209
    s_nop 0
    s_or_b64 vcc, vcc, s[82:83]
    s_cbranch_vccnz rd_87
rc_88:
    v_mfma_f32_32x32x16_bf16 v[192:207], v[228:231], v[232:235], v[192:207]
    v_mul_f32 v208, 0x3acccccd, v97
    v_mul_f32 v209, 0x3acccccd, v101
    v_mul_f32 v98, 0x3acccccd, v98
    v_mul_f32 v102, 0x3acccccd, v102
    v_fma_f32 v98, -v208, v208, v98
    s_waitcnt lgkmcnt(11)
    v_mfma_f32_32x32x16_bf16 v[192:207], v[212:215], v[240:243], v[192:207]
    ds_read_b128 v[228:231], v64 offset:160
    ds_read_b64_tr_b16 v[212:213], v65 offset:1824
    ds_read_b64_tr_b16 v[214:215], v65 offset:1792
    v_fma_f32 v102, -v209, v209, v102
    v_max_f32 v98, 0, v98
    s_waitcnt lgkmcnt(7)
    v_mfma_f32_32x32x16_bf16 v[144:159], v[216:219], v[236:239], v[144:159]
    v_max_f32 v102, 0, v102
    v_add_f32 v98, 0x3727c5ac, v98
    v_add_f32 v102, 0x3727c5ac, v102
    v_rsq_f32 v97, v98
    s_waitcnt lgkmcnt(3)
    v_mfma_f32_32x32x16_bf16 v[144:159], v[224:227], v[244:247], v[144:159]
    v_rsq_f32_e64 v101, v102
    v_mul_f32 v98, -v208, v97
    v_mul_f32 v102, -v209, v101
    v_lshlrev_b32_e64 v80, 16, v248
    v_and_b32 v82, 0xffff0000, v248
    v_mfma_f32_32x32x16_bf16 v[160:175], v[216:219], v[244:247], v[160:175]
    ds_read_b64_tr_b16 v[232:233], v65 offset:2336
    ds_read_b64_tr_b16 v[234:235], v65 offset:2304
    v_lshlrev_b32 v84, 16, v249
    v_and_b32 v86, 0xffff0000, v249
    v_lshlrev_b32_e64 v81, 16, v250
    s_waitcnt lgkmcnt(2)
    v_mfma_f32_32x32x16_bf16 v[144:159], v[228:231], v[212:215], v[144:159]
    v_and_b32 v83, 0xffff0000, v250
    v_lshlrev_b32_e64 v85, 16, v251
    v_and_b32 v87, 0xffff0000, v251
    v_fma_f32 v208, v80, v97, v98
    v_fma_f32 v209, v81, v101, v102
    v_cvt_pk_bf16_f32 v248, v208, v209
    v_mfma_f32_32x32x16_bf16 v[160:175], v[224:227], v[212:215], v[160:175]
    v_fma_f32 v208, v82, v97, v98
    v_fma_f32 v209, v83, v101, v102
    v_cvt_pk_bf16_f32 v249, v208, v209
    v_fma_f32 v208, v84, v97, v98
    v_fma_f32 v209, v85, v101, v102
    v_cvt_pk_bf16_f32 v250, v208, v209
    v_mfma_f32_32x32x16_bf16 v[176:191], v[216:219], v[212:215], v[176:191]
    v_fma_f32 v208, v86, v97, v98
    v_fma_f32 v209, v87, v101, v102
    v_cvt_pk_bf16_f32 v251, v208, v209
    s_waitcnt lgkmcnt(0)
    v_mfma_f32_32x32x16_bf16 v[144:159], v[220:223], v[232:235], v[144:159]
    ds_read_b64_tr_b16 v[240:241], v65 offset:2848
    ds_read_b64_tr_b16 v[242:243], v65 offset:2816
    ds_write_b32 v63, v248 offset:512
    ds_write_b32 v63, v249 offset:5376
    v_mfma_f32_32x32x16_bf16 v[160:175], v[228:231], v[232:235], v[160:175]
    ds_write_b32 v63, v250 offset:10240
    ds_write_b32 v63, v251 offset:15104
    v_mul_f32 v208, 0x3acccccd, v105
    v_mul_f32 v209, 0x3acccccd, v109
    v_mfma_f32_32x32x16_bf16 v[176:191], v[224:227], v[232:235], v[176:191]
    v_mul_f32 v106, 0x3acccccd, v106
    v_mul_f32 v110, 0x3acccccd, v110
    v_fma_f32 v106, -v208, v208, v106
    v_fma_f32 v110, -v209, v209, v110
    v_max_f32 v106, 0, v106
    v_max_f32_e64 v110, 0, v110
    v_mfma_f32_32x32x16_bf16 v[192:207], v[216:219], v[232:235], v[192:207]
    ds_read_b64_tr_b16 v[216:217], v65 offset:3360
    ds_read_b64_tr_b16 v[218:219], v65 offset:3328
    v_add_f32 v106, 0x3727c5ac, v106
    v_add_f32 v110, 0x3727c5ac, v110
    s_waitcnt lgkmcnt(6)
    v_mfma_f32_32x32x16_bf16 v[160:175], v[220:223], v[240:243], v[160:175]
    v_rsq_f32 v105, v106
    v_rsq_f32_e64 v109, v110
    v_mul_f32 v106, -v208, v105
    v_mul_f32 v110, -v209, v109
    v_mfma_f32_32x32x16_bf16 v[176:191], v[228:231], v[240:243], v[176:191]
    ds_read_b64_tr_b16 v[236:237], v65 offset:3872
    ds_read_b64_tr_b16 v[238:239], v65 offset:3840
    v_lshlrev_b32 v88, 16, v252
    v_and_b32 v90, 0xffff0000, v252
    v_lshlrev_b32 v92, 16, v253
    v_and_b32 v94, 0xffff0000, v253
    v_mfma_f32_32x32x16_bf16 v[192:207], v[224:227], v[240:243], v[192:207]
    ds_read_b128 v[224:227], v64 offset:384
    ds_read_b64_tr_b16 v[244:245], v65 offset:928
    ds_read_b64_tr_b16 v[246:247], v65 offset:896
    v_lshlrev_b32 v89, 16, v254
    v_and_b32 v91, 0xffff0000, v254
    s_waitcnt lgkmcnt(5)
    v_mfma_f32_32x32x16_bf16 v[176:191], v[220:223], v[216:219], v[176:191]
    ds_read_b128 v[212:215], v64 offset:256
    ds_read_b64_tr_b16 v[232:233], v65 offset:1440
    ds_read_b64_tr_b16 v[234:235], v65 offset:1408
    v_lshlrev_b32_e64 v93, 16, v255
    v_and_b32 v95, 0xffff0000, v255
    v_fma_f32 v208, v88, v105, v106
    v_mfma_f32_32x32x16_bf16 v[192:207], v[228:231], v[216:219], v[192:207]
    v_fma_f32 v209, v89, v109, v110
    v_cvt_pk_bf16_f32 v252, v208, v209
    v_fma_f32 v208, v90, v105, v106
    v_fma_f32 v209, v91, v109, v110
    v_cvt_pk_bf16_f32 v253, v208, v209
    s_waitcnt lgkmcnt(6)
    v_mfma_f32_32x32x16_bf16 v[192:207], v[220:223], v[236:239], v[192:207]
    ds_read_b128 v[220:223], v64 offset:128
    ds_read_b64_tr_b16 v[228:229], v65 offset:1952
    ds_read_b64_tr_b16 v[230:231], v65 offset:1920
    v_fma_f32 v208, v92, v105, v106
    v_fma_f32 v209, v93, v109, v110
    s_waitcnt lgkmcnt(6)
    v_mfma_f32_32x32x16_bf16 v[144:159], v[224:227], v[244:247], v[144:159]
    v_cvt_pk_bf16_f32 v254, v208, v209
    v_fma_f32 v208, v94, v105, v106
    v_fma_f32 v209, v95, v109, v110
    v_cvt_pk_bf16_f32 v255, v208, v209
    s_waitcnt lgkmcnt(3)
    v_mfma_f32_32x32x16_bf16 v[144:159], v[212:215], v[232:235], v[144:159]
    ds_write_b32 v63, v252 offset:768
    ds_write_b32 v63, v253 offset:5632
    ds_write_b32 v63, v254 offset:10496
    v_mfma_f32_32x32x16_bf16 v[160:175], v[224:227], v[232:235], v[160:175]
    ds_read_b128 v[240:243], v64 offset:0
    ds_read_b64_tr_b16 v[216:217], v65 offset:2464
    ds_read_b64_tr_b16 v[218:219], v65 offset:2432
    ds_write_b32 v63, v255 offset:15360
    s_waitcnt lgkmcnt(7)
    v_mfma_f32_32x32x16_bf16 v[144:159], v[220:223], v[228:231], v[144:159]
    v_mfma_f32_32x32x16_bf16 v[160:175], v[212:215], v[228:231], v[160:175]
    v_mfma_f32_32x32x16_bf16 v[176:191], v[224:227], v[228:231], v[176:191]
    s_waitcnt lgkmcnt(1)
    v_mfma_f32_32x32x16_bf16 v[144:159], v[240:243], v[216:219], v[144:159]
    ds_read_b64_tr_b16 v[236:237], v65 offset:2976
    ds_read_b64_tr_b16 v[238:239], v65 offset:2944
    v_mfma_f32_32x32x16_bf16 v[160:175], v[220:223], v[216:219], v[160:175]
    v_mfma_f32_32x32x16_bf16 v[176:191], v[212:215], v[216:219], v[176:191]
    v_mfma_f32_32x32x16_bf16 v[192:207], v[224:227], v[216:219], v[192:207]
    ds_read_b64_tr_b16 v[224:225], v65 offset:3488
    ds_read_b64_tr_b16 v[226:227], v65 offset:3456
    s_waitcnt lgkmcnt(2)
    v_mfma_f32_32x32x16_bf16 v[160:175], v[240:243], v[236:239], v[160:175]
    v_mfma_f32_32x32x16_bf16 v[176:191], v[220:223], v[236:239], v[176:191]
    ds_read_b64_tr_b16 v[244:245], v65 offset:4000
    ds_read_b64_tr_b16 v[246:247], v65 offset:3968
    v_mfma_f32_32x32x16_bf16 v[192:207], v[212:215], v[236:239], v[192:207]
    s_waitcnt lgkmcnt(2)
    v_mfma_f32_32x32x16_bf16 v[176:191], v[240:243], v[224:227], v[176:191]
    v_mfma_f32_32x32x16_bf16 v[192:207], v[220:223], v[224:227], v[192:207]
    s_waitcnt lgkmcnt(0)
    v_mfma_f32_32x32x16_bf16 v[192:207], v[240:243], v[244:247], v[192:207]
    s_waitcnt lgkmcnt(0)
    s_barrier
    ds_read_b128 v[212:215], v64 offset:608
    ds_read_b128 v[216:219], v64 offset:576
    ds_read_b128 v[220:223], v64 offset:544
    ds_read_b128 v[224:227], v64 offset:512
    s_waitcnt lgkmcnt(3)
    v_mfma_f32_32x32x16_bf16 v[144:159], v[212:215], v[112:115], v[144:159]
    ds_read_b128 v[228:231], v64 offset:736
    s_waitcnt lgkmcnt(3)
    v_mfma_f32_32x32x16_bf16 v[144:159], v[216:219], v[116:119], v[144:159]
    ds_read_b128 v[232:235], v64 offset:704
    s_waitcnt lgkmcnt(3)
    v_mfma_f32_32x32x16_bf16 v[144:159], v[220:223], v[120:123], v[144:159]
    ds_read_b128 v[236:239], v64 offset:672
    s_waitcnt lgkmcnt(3)
    v_mfma_f32_32x32x16_bf16 v[144:159], v[224:227], v[124:127], v[144:159]
    ds_read_b128 v[240:243], v64 offset:640
    s_nop 3
    s_waitcnt lgkmcnt(3)
    v_mfma_f32_32x32x16_bf16 v[160:175], v[228:231], v[112:115], v[160:175]
    s_nop 4
    s_waitcnt lgkmcnt(2)
    v_mfma_f32_32x32x16_bf16 v[160:175], v[232:235], v[116:119], v[160:175]
    v_cndmask_b32 v208, v147, v72, s[76:77]
    v_cndmask_b32 v209, v151, v147, s[76:77]
    v_cndmask_b32 v210, v155, v151, s[76:77]
    v_cndmask_b32 v211, v159, v155, s[76:77]
    v_mov_b32 v72, v159
    s_waitcnt lgkmcnt(1)
    v_mfma_f32_32x32x16_bf16 v[160:175], v[236:239], v[120:123], v[160:175]
    v_add_f32_dpp v146, v208, v146 wave_ror:1 row_mask:0xf bank_mask:0xf
    v_add_f32_dpp v150, v209, v150 wave_ror:1 row_mask:0xf bank_mask:0xf
    v_add_f32_dpp v154, v210, v154 wave_ror:1 row_mask:0xf bank_mask:0xf
    v_add_f32_dpp v158, v211, v158 wave_ror:1 row_mask:0xf bank_mask:0xf
    v_cndmask_b32 v208, v146, v71, s[76:77]
    s_waitcnt lgkmcnt(0)
    v_mfma_f32_32x32x16_bf16 v[160:175], v[240:243], v[124:127], v[160:175]
    v_cndmask_b32 v209, v150, v146, s[76:77]
    v_cndmask_b32 v210, v154, v150, s[76:77]
    v_cndmask_b32 v211, v158, v154, s[76:77]
    v_mov_b32 v71, v158
    v_add_f32_dpp v145, v208, v145 wave_ror:1 row_mask:0xf bank_mask:0xf
    v_add_f32_dpp v149, v209, v149 wave_ror:1 row_mask:0xf bank_mask:0xf
    v_mfma_f32_32x32x16_bf16 v[160:175], v[212:215], v[128:131], v[160:175]
    ds_read_b128 v[244:247], v64 offset:864
    v_add_f32_dpp v153, v210, v153 wave_ror:1 row_mask:0xf bank_mask:0xf
    v_add_f32_dpp v157, v211, v157 wave_ror:1 row_mask:0xf bank_mask:0xf
    v_cndmask_b32 v208, v145, v70, s[76:77]
    v_cndmask_b32 v209, v149, v145, s[76:77]
    v_cndmask_b32 v210, v153, v149, s[76:77]
    v_mfma_f32_32x32x16_bf16 v[160:175], v[216:219], v[132:135], v[160:175]
    ds_read_b128 v[248:251], v64 offset:832
    v_cndmask_b32 v211, v157, v153, s[76:77]
    v_mov_b32_e64 v70, v157
    v_add_f32_dpp v144, v208, v144 wave_ror:1 row_mask:0xf bank_mask:0xf
    v_add_f32_dpp v148, v209, v148 wave_ror:1 row_mask:0xf bank_mask:0xf
    v_add_f32_dpp v152, v210, v152 wave_ror:1 row_mask:0xf bank_mask:0xf
    v_mfma_f32_32x32x16_bf16 v[160:175], v[220:223], v[136:139], v[160:175]
    ds_read_b128 v[252:255], v64 offset:800
    v_add_f32_dpp v156, v211, v156 wave_ror:1 row_mask:0xf bank_mask:0xf
    ds_write_b32 v66, v144 offset:0
    v_mfma_f32_32x32x16_bf16 v[160:175], v[224:227], v[140:143], v[160:175]
    ds_read_b128 v[224:227], v64 offset:768
    ds_write_b32 v66, v148 offset:64
    ds_write_b32 v66, v152 offset:128
    s_waitcnt lgkmcnt(6)
    v_mfma_f32_32x32x16_bf16 v[176:191], v[244:247], v[112:115], v[176:191]
    ds_write_b32 v66, v156 offset:192
    s_nop 2
    s_waitcnt lgkmcnt(6)
    v_mfma_f32_32x32x16_bf16 v[176:191], v[248:251], v[116:119], v[176:191]
    s_nop 2
    v_cndmask_b32 v208, v163, v72, s[76:77]
    v_cndmask_b32 v209, v167, v163, s[76:77]
    s_waitcnt lgkmcnt(5)
    v_mfma_f32_32x32x16_bf16 v[176:191], v[252:255], v[120:123], v[176:191]
    v_cndmask_b32 v210, v171, v167, s[76:77]
    v_cndmask_b32 v211, v175, v171, s[76:77]
    v_mov_b32 v72, v175
    v_add_f32_dpp v162, v208, v162 wave_ror:1 row_mask:0xf bank_mask:0xf
    v_add_f32_dpp v166, v209, v166 wave_ror:1 row_mask:0xf bank_mask:0xf
    s_waitcnt lgkmcnt(3)
    v_mfma_f32_32x32x16_bf16 v[176:191], v[224:227], v[124:127], v[176:191]
    v_add_f32_dpp v170, v210, v170 wave_ror:1 row_mask:0xf bank_mask:0xf
    v_add_f32_dpp v174, v211, v174 wave_ror:1 row_mask:0xf bank_mask:0xf
    v_cndmask_b32 v208, v162, v71, s[76:77]
    v_cndmask_b32 v209, v166, v162, s[76:77]
    v_cndmask_b32 v210, v170, v166, s[76:77]
    v_cndmask_b32 v211, v174, v170, s[76:77]
    v_mfma_f32_32x32x16_bf16 v[176:191], v[228:231], v[128:131], v[176:191]
    ds_read_b64_tr_b16 v[228:229], v65 offset:1056
    ds_read_b64_tr_b16 v[230:231], v65 offset:1024
    v_mov_b32 v71, v174
    v_add_f32_dpp v161, v208, v161 wave_ror:1 row_mask:0xf bank_mask:0xf
    v_add_f32_dpp v165, v209, v165 wave_ror:1 row_mask:0xf bank_mask:0xf
    v_add_f32_dpp v169, v210, v169 wave_ror:1 row_mask:0xf bank_mask:0xf
    v_mfma_f32_32x32x16_bf16 v[176:191], v[232:235], v[132:135], v[176:191]
    ds_read_b64_tr_b16 v[232:233], v65 offset:1184
    ds_read_b64_tr_b16 v[234:235], v65 offset:1152
    v_add_f32_dpp v173, v211, v173 wave_ror:1 row_mask:0xf bank_mask:0xf
    v_cndmask_b32 v208, v161, v70, s[76:77]
    v_cndmask_b32 v209, v165, v161, s[76:77]
    v_cndmask_b32 v210, v169, v165, s[76:77]
    v_mfma_f32_32x32x16_bf16 v[176:191], v[236:239], v[136:139], v[176:191]
    ds_read_b64_tr_b16 v[236:237], v65 offset:1312
    ds_read_b64_tr_b16 v[238:239], v65 offset:1280
    v_cndmask_b32 v211, v173, v169, s[76:77]
    v_mov_b32_e64 v70, v173
    v_add_f32_dpp v160, v208, v160 wave_ror:1 row_mask:0xf bank_mask:0xf
    v_add_f32_dpp v164, v209, v164 wave_ror:1 row_mask:0xf bank_mask:0xf
    v_mfma_f32_32x32x16_bf16 v[176:191], v[240:243], v[140:143], v[176:191]
    ds_read_b128 v[240:243], v64 offset:512
    ds_read_b64_tr_b16 v[224:225], v65 offset:1440
    ds_read_b64_tr_b16 v[226:227], v65 offset:1408
    v_add_f32_dpp v168, v210, v168 wave_ror:1 row_mask:0xf bank_mask:0xf
    v_add_f32_dpp v172, v211, v172 wave_ror:1 row_mask:0xf bank_mask:0xf
    s_waitcnt lgkmcnt(7)
    v_mfma_f32_32x32x16_bf16 v[176:191], v[212:215], v[228:231], v[176:191]
    ds_read_b128 v[212:215], v64 offset:992
    ds_write_b32 v66, v160 offset:256
    ds_write_b32 v66, v164 offset:320
    s_waitcnt lgkmcnt(8)
    v_mfma_f32_32x32x16_bf16 v[176:191], v[216:219], v[232:235], v[176:191]
    ds_read_b128 v[216:219], v64 offset:960
    ds_write_b32 v66, v168 offset:384
    ds_write_b32 v66, v172 offset:448
    s_waitcnt lgkmcnt(9)
    v_mfma_f32_32x32x16_bf16 v[176:191], v[220:223], v[236:239], v[176:191]
    ds_read_b128 v[220:223], v64 offset:928
    s_waitcnt lgkmcnt(7)
    v_mfma_f32_32x32x16_bf16 v[176:191], v[240:243], v[224:227], v[176:191]
    ds_read_b128 v[240:243], v64 offset:896
    s_waitcnt lgkmcnt(2)
    s_barrier
    v_mfma_f32_32x32x16_bf16 v[192:207], v[212:215], v[112:115], v[192:207]
    ds_read_b64 v[144:145], v67 offset:0
    ds_read_b64 v[146:147], v67 offset:4224
    ds_read_b64 v[148:149], v67 offset:8448
    ds_read_b64 v[150:151], v67 offset:12672
    s_nop 0
    v_mfma_f32_32x32x16_bf16 v[192:207], v[216:219], v[116:119], v[192:207]
    s_nop 2
    v_cndmask_b32 v208, v179, v72, s[76:77]
    v_cndmask_b32 v209, v183, v179, s[76:77]
    s_waitcnt lgkmcnt(5)
    v_mfma_f32_32x32x16_bf16 v[192:207], v[220:223], v[120:123], v[192:207]
    v_cndmask_b32 v210, v187, v183, s[76:77]
    v_cndmask_b32 v211, v191, v187, s[76:77]
    v_mov_b32 v72, v191
    v_add_f32_dpp v178, v208, v178 wave_ror:1 row_mask:0xf bank_mask:0xf
    v_add_f32_dpp v182, v209, v182 wave_ror:1 row_mask:0xf bank_mask:0xf
    s_waitcnt lgkmcnt(4)
    v_mfma_f32_32x32x16_bf16 v[192:207], v[240:243], v[124:127], v[192:207]
    ds_read_b128 v[212:215], v64 offset:768
    v_add_f32_dpp v186, v210, v186 wave_ror:1 row_mask:0xf bank_mask:0xf
    v_add_f32_dpp v190, v211, v190 wave_ror:1 row_mask:0xf bank_mask:0xf
    v_cndmask_b32 v208, v178, v71, s[76:77]
    v_cndmask_b32 v209, v182, v178, s[76:77]
    v_cndmask_b32 v210, v186, v182, s[76:77]
    v_mfma_f32_32x32x16_bf16 v[192:207], v[244:247], v[128:131], v[192:207]
    ds_read_b128 v[244:247], v64 offset:736
    v_cndmask_b32 v211, v190, v186, s[76:77]
    v_mov_b32 v71, v190
    v_add_f32_dpp v177, v208, v177 wave_ror:1 row_mask:0xf bank_mask:0xf
    v_add_f32_dpp v181, v209, v181 wave_ror:1 row_mask:0xf bank_mask:0xf
    v_add_f32_dpp v185, v210, v185 wave_ror:1 row_mask:0xf bank_mask:0xf
    v_mfma_f32_32x32x16_bf16 v[192:207], v[248:251], v[132:135], v[192:207]
    ds_read_b128 v[248:251], v64 offset:704
    v_add_f32_dpp v189, v211, v189 wave_ror:1 row_mask:0xf bank_mask:0xf
    v_cndmask_b32 v208, v177, v70, s[76:77]
    v_cndmask_b32 v209, v181, v177, s[76:77]
    v_cndmask_b32 v210, v185, v181, s[76:77]
    v_cndmask_b32 v211, v189, v185, s[76:77]
    v_mfma_f32_32x32x16_bf16 v[192:207], v[252:255], v[136:139], v[192:207]
    ds_read_b128 v[252:255], v64 offset:672
    v_mov_b32_e64 v70, v189
    v_add_f32_dpp v176, v208, v176 wave_ror:1 row_mask:0xf bank_mask:0xf
    v_add_f32_dpp v180, v209, v180 wave_ror:1 row_mask:0xf bank_mask:0xf
    v_add_f32_dpp v184, v210, v184 wave_ror:1 row_mask:0xf bank_mask:0xf
    s_waitcnt lgkmcnt(3)
    v_mfma_f32_32x32x16_bf16 v[192:207], v[212:215], v[140:143], v[192:207]
    ds_read_b128 v[216:219], v64 offset:640
    v_add_f32_dpp v188, v211, v188 wave_ror:1 row_mask:0xf bank_mask:0xf
    s_waitcnt lgkmcnt(3)
    v_mfma_f32_32x32x16_bf16 v[192:207], v[244:247], v[228:231], v[192:207]
    ds_read_b128 v[228:231], v64 offset:608
    ds_read_b64_tr_b16 v[220:221], v65 offset:1568
    ds_read_b64_tr_b16 v[222:223], v65 offset:1536
    ds_write_b32 v66, v176 offset:512
    s_waitcnt lgkmcnt(6)
    v_mfma_f32_32x32x16_bf16 v[192:207], v[248:251], v[232:235], v[192:207]
    ds_read_b128 v[232:235], v64 offset:576
    ds_read_b64_tr_b16 v[240:241], v65 offset:1696
    ds_read_b64_tr_b16 v[242:243], v65 offset:1664
    ds_write_b32 v66, v180 offset:576
    s_waitcnt lgkmcnt(9)
    v_mfma_f32_32x32x16_bf16 v[192:207], v[252:255], v[236:239], v[192:207]
    ds_read_b128 v[236:239], v64 offset:544
    ds_read_b64_tr_b16 v[212:213], v65 offset:1824
    ds_read_b64_tr_b16 v[214:215], v65 offset:1792
    ds_write_b32 v66, v184 offset:640
    s_waitcnt lgkmcnt(12)
    v_mfma_f32_32x32x16_bf16 v[192:207], v[216:219], v[224:227], v[192:207]
    ds_read_b128 v[224:227], v64 offset:512
    ds_read_b64_tr_b16 v[244:245], v65 offset:1952
    ds_read_b64_tr_b16 v[246:247], v65 offset:1920
    ds_write_b32 v66, v188 offset:704
    s_waitcnt lgkmcnt(13)
    v_mfma_f32_32x32x16_bf16 v[192:207], v[228:231], v[220:223], v[192:207]
    v_add_f32 v144, v144, v80
    v_add_f32 v145, v145, v81
    v_add_f32 v146, v146, v82
    v_add_f32 v147, v147, v83
    s_waitcnt lgkmcnt(9)
    v_mfma_f32_32x32x16_bf16 v[192:207], v[232:235], v[240:243], v[192:207]
    v_add_f32 v148, v148, v84
    v_add_f32 v149, v149, v85
    v_add_f32 v150, v150, v86
    v_add_f32 v151, v151, v87
    v_cvt_pk_bf16_f32 v160, v144, v146
    s_waitcnt lgkmcnt(5)
    v_mfma_f32_32x32x16_bf16 v[192:207], v[236:239], v[212:215], v[192:207]
    v_cvt_pk_bf16_f32 v161, v148, v150
    v_cvt_pk_bf16_f32 v162, v145, v147
    v_cvt_pk_bf16_f32 v163, v149, v151
    s_mov_b32 s25, 1310720
    s_waitcnt lgkmcnt(1)
    v_mfma_f32_32x32x16_bf16 v[192:207], v[224:227], v[244:247], v[192:207]
    buffer_store_dwordx2 v[160:161], v68, s[20:23], s25 offen
    s_mov_b32 s25, 1315840
    buffer_store_dwordx2 v[162:163], v68, s[20:23], s25 offen
    s_nop 8
    v_cndmask_b32 v208, v195, v72, s[76:77]
    v_cndmask_b32 v209, v199, v195, s[76:77]
    v_cndmask_b32 v210, v203, v199, s[76:77]
    v_cndmask_b32 v211, v207, v203, s[76:77]
    v_mov_b32_e64 v72, v207
    v_add_f32_dpp v194, v208, v194 wave_ror:1 row_mask:0xf bank_mask:0xf
    v_add_f32_dpp v198, v209, v198 wave_ror:1 row_mask:0xf bank_mask:0xf
    v_add_f32_dpp v202, v210, v202 wave_ror:1 row_mask:0xf bank_mask:0xf
    v_add_f32_dpp v206, v211, v206 wave_ror:1 row_mask:0xf bank_mask:0xf
    v_cndmask_b32 v208, v194, v71, s[76:77]
    v_cndmask_b32 v209, v198, v194, s[76:77]
    v_cndmask_b32 v210, v202, v198, s[76:77]
    v_cndmask_b32 v211, v206, v202, s[76:77]
    v_mov_b32_e64 v71, v206
    v_add_f32_dpp v193, v208, v193 wave_ror:1 row_mask:0xf bank_mask:0xf
    v_add_f32_dpp v197, v209, v197 wave_ror:1 row_mask:0xf bank_mask:0xf
    v_add_f32_dpp v201, v210, v201 wave_ror:1 row_mask:0xf bank_mask:0xf
    v_add_f32_dpp v205, v211, v205 wave_ror:1 row_mask:0xf bank_mask:0xf
    v_cndmask_b32 v208, v193, v70, s[76:77]
    v_cndmask_b32 v209, v197, v193, s[76:77]
    v_cndmask_b32 v210, v201, v197, s[76:77]
    v_cndmask_b32 v211, v205, v201, s[76:77]
    v_mov_b32_e64 v70, v205
    v_add_f32_dpp v192, v208, v192 wave_ror:1 row_mask:0xf bank_mask:0xf
    v_add_f32_dpp v196, v209, v196 wave_ror:1 row_mask:0xf bank_mask:0xf
    v_add_f32_dpp v200, v210, v200 wave_ror:1 row_mask:0xf bank_mask:0xf
    v_add_f32_dpp v204, v211, v204 wave_ror:1 row_mask:0xf bank_mask:0xf
    ds_write_b32 v66, v192 offset:768
    ds_write_b32 v66, v196 offset:832
    ds_write_b32 v66, v200 offset:896
    ds_write_b32 v66, v204 offset:960
    s_waitcnt lgkmcnt(0)
    s_barrier
    ds_read_b64 v[152:153], v67 offset:512
    ds_read_b64 v[154:155], v67 offset:4736
    ds_read_b64 v[156:157], v67 offset:8960
    ds_read_b64 v[158:159], v67 offset:13184
    s_waitcnt lgkmcnt(0)
    v_add_f32 v152, v152, v88
    v_add_f32 v153, v153, v89
    v_add_f32 v154, v154, v90
    v_add_f32 v155, v155, v91
    v_add_f32 v156, v156, v92
    v_add_f32 v157, v157, v93
    v_add_f32 v158, v158, v94
    v_add_f32_e64 v159, v159, v95
    v_cvt_pk_bf16_f32 v164, v152, v154
    v_cvt_pk_bf16_f32 v165, v156, v158
    v_cvt_pk_bf16_f32 v166, v153, v155
    v_cvt_pk_bf16_f32 v167, v157, v159
    s_mov_b32 s25, 1966080
    buffer_store_dwordx2 v[164:165], v68, s[20:23], s25 offen
    s_mov_b32 s25, 1971200
    buffer_store_dwordx2 v[166:167], v68, s[20:23], s25 offen
    s_branch ec_82
nc_81:
ec_82:
L_end:
    s_endpgm
ps_4:
    s_mov_b32 s84, 1048576
pl_5:
    global_load_dword v7, v5, s[66:67] sc1
    s_waitcnt vmcnt(0)
    s_sub_u32 s84, s84, 1
    s_cbranch_scc1 pc_6
    v_cmp_gt_u32_e64 vcc, 1, v7
    s_nop 0
    s_and_b64 vcc, vcc, s[50:51]
    s_and_b64 vcc, vcc, 1
    s_cbranch_scc1 pl_5
    s_branch pc_6
ps_7:
    s_mov_b32 s84, 1048576
pl_8:
    buffer_load_dword v7, v4, s[16:19], s87 offen offset:0 sc1
    s_waitcnt vmcnt(0)
    s_sub_u32 s84, s84, 1
    s_cbranch_scc1 pc_9
    v_cmp_gt_u32 vcc, 32, v7
    s_nop 0
    s_and_b64 vcc, vcc, s[50:51]
    s_cbranch_scc1 pl_8
    s_branch pc_9
ps_11:
    s_mov_b32 s84, 1048576
pl_12:
    global_load_dword v7, v5, s[66:67] sc1
    s_waitcnt vmcnt(0)
    s_sub_u32 s84, s84, 1
    s_cbranch_scc1 pc_13
    v_cmp_gt_u32_e64 vcc, 1, v7
    s_nop 0
    s_and_b64 vcc, vcc, s[50:51]
    s_and_b64 vcc, vcc, 1
    s_cbranch_scc1 pl_12
    s_branch pc_13
ps_14:
    s_mov_b32 s84, 1048576
pl_15:
    buffer_load_dword v7, v4, s[16:19], s87 offen offset:0 sc1
    s_waitcnt vmcnt(0)
    s_sub_u32 s84, s84, 1
    s_cbranch_scc1 pc_16
    v_cmp_gt_u32 vcc, 32, v7
    s_nop 0
    s_and_b64 vcc, vcc, s[50:51]
    s_cbranch_scc1 pl_15
    s_branch pc_16
ps_17:
    s_mov_b32 s84, 1048576
pl_18:
    buffer_load_dword v7, v4, s[16:19], s89 offen offset:8 sc1
    s_waitcnt vmcnt(0)
    s_sub_u32 s84, s84, 1
    s_cbranch_scc1 pc_19
    v_cmp_gt_u32_e64 vcc, 32, v7
    s_nop 0
    s_and_b64 vcc, vcc, s[50:51]
    s_cbranch_scc1 pl_18
    s_branch pc_19
rd_21:
    s_cmp_eq_u32 s38, 0
    s_cbranch_scc1 rc_22
    s_sub_u32 s38, s38, 1
    s_nop 7
    s_nop 7
    s_sleep 4
    s_mov_b64 exec, vcc
    s_mov_b32 s96, 4194304
    buffer_load_dwordx4 v[216:219], v56, s[16:19], s96 offen offset:0 sc1
    buffer_load_dwordx4 v[220:223], v56, s[16:19], s96 offen offset:256 sc1
    s_mov_b32 s96, 4227072
    buffer_load_dwordx4 v[224:227], v56, s[16:19], s96 offen offset:0 sc1
    buffer_load_dwordx4 v[228:231], v56, s[16:19], s96 offen offset:256 sc1
    s_mov_b32 s96, 4259840
    buffer_load_dwordx4 v[232:235], v56, s[16:19], s96 offen offset:0 sc1
    buffer_load_dwordx4 v[236:239], v56, s[16:19], s96 offen offset:256 sc1
    s_mov_b32 s96, 4292608
    buffer_load_dwordx4 v[240:243], v56, s[16:19], s96 offen offset:0 sc1
    buffer_load_dwordx4 v[244:247], v56, s[16:19], s96 offen offset:256 sc1
    s_mov_b32 s96, 4194304
    buffer_load_dwordx2 v[248:249], v57, s[16:19], s96 offen offset:0 sc1
    buffer_load_dwordx2 v[252:253], v57, s[16:19], s96 offen offset:128 sc1
    s_mov_b32 s96, 4210688
    buffer_load_dwordx2 v[250:251], v57, s[16:19], s96 offen offset:0 sc1
    buffer_load_dwordx2 v[254:255], v57, s[16:19], s96 offen offset:128 sc1
    s_mov_b32 s96, 0
    s_mov_b32 s97, 5120
    s_waitcnt vmcnt(16)
    buffer_load_dwordx2 v[208:209], v60, s[4:7], s96 offen
    s_waitcnt vmcnt(16)
    buffer_load_dwordx2 v[210:211], v60, s[4:7], s97 offen
    s_waitcnt vmcnt(16)
    v_lshrrev_b32_e64 v212, 5, v1
    v_mul_u32_u24 v212, 5104, v212
    v_bfe_u32 v213, v1, 4, 1
    v_lshlrev_b32 v213, 2, v213
    v_sub_u32 v212, v212, v213
    v_add_u32 v212, v212, v60
    s_mul_i32 s97, s24, 24
    s_sub_u32 s97, 128, s97
    buffer_load_dword v212, v212, s[4:7], s97 offen
    s_mov_b64 exec, -1
    s_waitcnt vmcnt(0) lgkmcnt(0)
    s_branch oe_20
rd_24:
    s_cmp_eq_u32 s38, 0
    s_cbranch_scc1 rc_25
    s_sub_u32 s38, s38, 1
    s_nop 7
    s_nop 7
    s_sleep 4
    s_mov_b64 exec, vcc
    s_mov_b32 s96, 4198400
    buffer_load_dwordx4 v[216:219], v56, s[16:19], s96 offen offset:0 sc1
    buffer_load_dwordx4 v[220:223], v56, s[16:19], s96 offen offset:256 sc1
    s_mov_b32 s96, 4231168
    buffer_load_dwordx4 v[224:227], v56, s[16:19], s96 offen offset:0 sc1
    buffer_load_dwordx4 v[228:231], v56, s[16:19], s96 offen offset:256 sc1
    s_mov_b32 s96, 4263936
    buffer_load_dwordx4 v[232:235], v56, s[16:19], s96 offen offset:0 sc1
    buffer_load_dwordx4 v[236:239], v56, s[16:19], s96 offen offset:256 sc1
    s_mov_b32 s96, 4296704
    buffer_load_dwordx4 v[240:243], v56, s[16:19], s96 offen offset:0 sc1
    buffer_load_dwordx4 v[244:247], v56, s[16:19], s96 offen offset:256 sc1
    s_mov_b32 s96, 4196352
    buffer_load_dwordx2 v[248:249], v57, s[16:19], s96 offen offset:0 sc1
    buffer_load_dwordx2 v[252:253], v57, s[16:19], s96 offen offset:128 sc1
    s_mov_b32 s96, 4212736
    buffer_load_dwordx2 v[250:251], v57, s[16:19], s96 offen offset:0 sc1
    buffer_load_dwordx2 v[254:255], v57, s[16:19], s96 offen offset:128 sc1
    s_mov_b32 s96, 1310720
    s_mov_b32 s97, 1315840
    s_waitcnt vmcnt(14)
    buffer_load_dwordx2 v[208:209], v60, s[4:7], s96 offen
    s_waitcnt vmcnt(14)
    buffer_load_dwordx2 v[210:211], v60, s[4:7], s97 offen
    s_waitcnt vmcnt(14)
    v_lshrrev_b32 v212, 5, v1
    v_mul_u32_u24 v212, 5104, v212
    v_bfe_u32 v213, v1, 4, 1
    v_lshlrev_b32 v213, 2, v213
    v_sub_u32 v212, v212, v213
    v_add_u32 v212, v212, v60
    s_mul_i32 s97, s24, 24
    s_sub_u32 s97, 1310848, s97
    buffer_load_dword v212, v212, s[4:7], s97 offen
    s_mov_b64 exec, -1
    s_waitcnt vmcnt(0) lgkmcnt(0)
    s_branch oe_23
rd_29:
    s_cmp_eq_u32 s38, 0
    s_cbranch_scc1 rc_30
    s_sub_u32 s38, s38, 1
    s_nop 7
    s_nop 7
    s_sleep 4
    s_mov_b64 exec, vcc
    s_lshl_b32 s96, s75, 14
    s_add_u32 s96, s96, 6815744
    s_lshl_b32 s97, s24, 12
    s_add_u32 s97, s97, 3473408
    buffer_load_dwordx4 v[176:179], v62, s[16:19], s96 offen offset:0 sc1
    buffer_load_dwordx4 v[180:183], v62, s[16:19], s96 offen offset:1024 sc1
    buffer_load_dwordx4 v[184:187], v62, s[16:19], s97 offen offset:0 sc1
    buffer_load_dwordx4 v[188:191], v62, s[16:19], s97 offen offset:1024 sc1
    buffer_load_dwordx4 v[192:195], v62, s[16:19], s97 offen offset:2048 sc1
    buffer_load_dwordx4 v[196:199], v62, s[16:19], s97 offen offset:3072 sc1
    s_mov_b64 exec, -1
    s_waitcnt vmcnt(0) lgkmcnt(0)
    s_branch ce_28
rd_32:
    s_cmp_eq_u32 s38, 0
    s_cbranch_scc1 rc_33
    s_sub_u32 s38, s38, 1
    s_nop 7
    s_nop 7
    s_sleep 4
    s_mov_b64 exec, vcc
    s_lshl_b32 s96, s75, 14
    s_add_u32 s96, s96, 6815744
    s_lshl_b32 s97, s24, 12
    s_add_u32 s97, s97, 3477504
    buffer_load_dwordx4 v[248:251], v62, s[16:19], s96 offen offset:2048 sc1
    buffer_load_dwordx4 v[252:255], v62, s[16:19], s96 offen offset:3072 sc1
    buffer_load_dwordx4 v[96:99], v62, s[16:19], s97 offen offset:0 sc1
    buffer_load_dwordx4 v[100:103], v62, s[16:19], s97 offen offset:1024 sc1
    buffer_load_dwordx4 v[104:107], v62, s[16:19], s97 offen offset:2048 sc1
    buffer_load_dwordx4 v[108:111], v62, s[16:19], s97 offen offset:3072 sc1
    s_mov_b64 exec, -1
    s_waitcnt vmcnt(0) lgkmcnt(0)
    s_branch ce_31
gl_34:
    s_add_u32 s82, s86, 16384
    v_lshlrev_b32 v2, 10, v1
    v_mov_b32_e64 v5, 1
    s_mov_b64 exec, 255
    buffer_store_dword v5, v2, s[16:19], s82 offen offset:0 sc1
    s_mov_b64 exec, -1
    s_branch gc_35
ps_36:
    s_mov_b32 s84, 1048576
pl_37:
    buffer_load_dword v7, v4, s[16:19], s89 offen offset:0 sc1
    s_waitcnt vmcnt(0)
    s_sub_u32 s84, s84, 1
    s_cbranch_scc1 pc_38
    v_cmp_gt_u32 vcc, 1, v7
    s_nop 0
    s_and_b64 vcc, vcc, s[50:51]
    s_cbranch_scc1 pl_37
    s_branch pc_38
ps_39:
    s_mov_b32 s84, 1048576
pl_40:
    buffer_load_dword v7, v4, s[16:19], s87 offen offset:8 sc1
    s_waitcnt vmcnt(0)
    s_sub_u32 s84, s84, 1
    s_cbranch_scc1 pc_41
    v_cmp_gt_u32 vcc, 12, v7
    s_nop 0
    s_and_b64 vcc, vcc, s[50:51]
    s_cbranch_scc1 pl_40
    s_branch pc_41
gl_42:
    s_add_u32 s82, s86, 0
    v_lshlrev_b32 v2, 10, v1
    v_mov_b32_e64 v5, 1
    s_mov_b64 exec, 255
    buffer_store_dword v5, v2, s[16:19], s82 offen offset:12 sc1
    s_mov_b64 exec, -1
    s_branch gc_43
ps_44:
    s_mov_b32 s84, 1048576
pl_45:
    buffer_load_dword v7, v4, s[16:19], s89 offen offset:0 sc1
    s_waitcnt vmcnt(0)
    s_sub_u32 s84, s84, 1
    s_cbranch_scc1 pc_46
    v_cmp_gt_u32_e64 vcc, 1, v7
    s_nop 0
    s_and_b64 vcc, vcc, s[50:51]
    s_cbranch_scc1 pl_45
    s_branch pc_46
rd_49:
    s_cmp_eq_u32 s38, 0
    s_cbranch_scc1 rc_50
    s_sub_u32 s38, s38, 1
    s_nop 7
    s_nop 7
    s_sleep 4
    s_mov_b64 exec, vcc
    s_add_u32 s26, s3, 9437184
    buffer_load_dwordx4 v[216:219], v236, s[16:19], s26 offen sc1
    s_add_u32 s26, s26, 524288
    buffer_load_dwordx4 v[220:223], v236, s[16:19], s26 offen sc1
    s_add_u32 s26, s26, 524288
    buffer_load_dwordx4 v[224:227], v236, s[16:19], s26 offen sc1
    s_add_u32 s26, s26, 524288
    buffer_load_dwordx4 v[228:231], v236, s[16:19], s26 offen sc1
    s_add_u32 s26, s26, 524288
    buffer_load_dwordx4 v[232:235], v236, s[16:19], s26 offen sc1
    s_mov_b64 exec, -1
    s_waitcnt vmcnt(0) lgkmcnt(0)
    s_branch se_48
gl_52:
    s_add_u32 s82, s86, 16384
    v_lshlrev_b32 v2, 10, v1
    v_mov_b32_e64 v5, 1
    s_mov_b64 exec, 255
    buffer_store_dword v5, v2, s[16:19], s82 offen offset:4 sc1
    s_mov_b64 exec, -1
    s_branch gc_53
ps_54:
    s_mov_b32 s84, 1048576
pl_55:
    buffer_load_dword v7, v4, s[16:19], s87 offen offset:12 sc1
    s_waitcnt vmcnt(0)
    s_sub_u32 s84, s84, 1
    s_cbranch_scc1 pc_56
    v_cmp_gt_u32_e64 vcc, 1, v7
    s_nop 0
    s_and_b64 vcc, vcc, s[50:51]
    s_cbranch_scc1 pl_55
    s_branch pc_56
rd_58:
    s_cmp_eq_u32 s38, 0
    s_cbranch_scc1 rc_59
    s_sub_u32 s38, s38, 1
    s_nop 7
    s_nop 7
    s_sleep 4
    s_mov_b64 exec, vcc
    s_lshl_b32 s98, s72, 5
    s_add_u32 s98, s98, 0
    s_sub_u32 s95, s98, 4
    s_max_i32 s95, s95, 0
    s_lshl_b32 s94, s98, 3
    s_lshl_b32 s95, s95, 3
    s_add_u32 s94, s94, 3457024
    s_add_u32 s95, s95, 3457024
    s_add_u32 s96, s94, 8192
    buffer_load_dwordx2 v[152:153], v47, s[16:19], s94 offen sc1
    buffer_load_dwordx2 v[154:155], v47, s[16:19], s96 offen sc1
    buffer_load_dwordx2 v[156:157], v48, s[16:19], s95 offen sc1
    s_mov_b64 exec, -1
    s_waitcnt vmcnt(0) lgkmcnt(0)
    s_branch sl_57
ps_60:
    s_mov_b32 s84, 1048576
pl_61:
    buffer_load_dword v7, v4, s[16:19], s89 offen offset:4 sc1
    s_waitcnt vmcnt(0)
    s_sub_u32 s84, s84, 1
    s_cbranch_scc1 pc_62
    v_cmp_gt_u32 vcc, 1, v7
    s_nop 0
    s_and_b64 vcc, vcc, s[50:51]
    s_cbranch_scc1 pl_61
    s_branch pc_62
rd_65:
    s_cmp_eq_u32 s38, 0
    s_cbranch_scc1 rc_66
    s_sub_u32 s38, s38, 1
    s_nop 7
    s_nop 7
    s_sleep 4
    s_mov_b64 exec, vcc
    s_add_u32 s26, s3, 9437184
    buffer_load_dwordx4 v[216:219], v236, s[16:19], s26 offen sc1
    s_add_u32 s26, s26, 524288
    buffer_load_dwordx4 v[220:223], v236, s[16:19], s26 offen sc1
    s_add_u32 s26, s26, 524288
    buffer_load_dwordx4 v[224:227], v236, s[16:19], s26 offen sc1
    s_add_u32 s26, s26, 524288
    buffer_load_dwordx4 v[228:231], v236, s[16:19], s26 offen sc1
    s_add_u32 s26, s26, 524288
    buffer_load_dwordx4 v[232:235], v236, s[16:19], s26 offen sc1
    s_mov_b64 exec, -1
    s_waitcnt vmcnt(0) lgkmcnt(0)
    s_branch se_64
rd_67:
    s_cmp_eq_u32 s39, 0
    s_cbranch_scc1 rc_68
    s_sub_u32 s39, s39, 1
    s_nop 7
    s_nop 7
    s_waitcnt vmcnt(0) lgkmcnt(0)
    s_barrier
    s_lshl_b32 s25, s72, 5
    s_add_u32 s25, s25, 0
    s_sub_u32 s26, s25, 4
    s_max_i32 s26, s26, 0
    s_lshl_b32 s27, s71, 12
    s_add_u32 s27, s27, 9437184
    s_lshl_b32 s99, s25, 3
    s_lshl_b32 s100, s26, 3
    s_lshl_b32 s92, s24, 12
    s_lshl_b32 s93, s24, 9
    s_add_u32 s99, s99, s27
    s_add_u32 s100, s100, s27
    s_add_u32 m0, s92, 36352
    s_nop 0
    buffer_load_dwordx4 v73, s[16:19], s99 offen offset:0 sc1 lds
    buffer_load_dwordx4 v74, s[16:19], s99 offen offset:1024 sc1 lds
    buffer_load_dwordx4 v75, s[16:19], s99 offen offset:2048 sc1 lds
    buffer_load_dwordx4 v76, s[16:19], s99 offen offset:3072 sc1 lds
    s_add_u32 m0, s93, 53760
    s_add_u32 s99, s99, 524288
    s_mov_b64 exec, s[80:81]
    buffer_load_dwordx4 v77, s[16:19], s100 offen sc1 lds
    s_mov_b64 exec, -1
    s_add_u32 s100, s100, 524288
    s_add_u32 m0, s92, 55936
    s_nop 0
    s_nop 0
    buffer_load_dwordx4 v73, s[16:19], s99 offen offset:0 sc1 lds
    buffer_load_dwordx4 v74, s[16:19], s99 offen offset:1024 sc1 lds
    buffer_load_dwordx4 v75, s[16:19], s99 offen offset:2048 sc1 lds
    buffer_load_dwordx4 v76, s[16:19], s99 offen offset:3072 sc1 lds
    s_add_u32 m0, s93, 73344
    s_add_u32 s99, s99, 524288
    s_mov_b64 exec, s[80:81]
    buffer_load_dwordx4 v77, s[16:19], s100 offen sc1 lds
    s_mov_b64 exec, -1
    s_add_u32 s100, s100, 524288
    s_mov_b64 exec, -1
    s_waitcnt vmcnt(0) lgkmcnt(0)
    s_branch ge_51
rd_71:
    s_cmp_eq_u32 s38, 0
    s_cbranch_scc1 rc_72
    s_sub_u32 s38, s38, 1
    s_nop 7
    s_nop 7
    s_sleep 4
    s_mov_b64 exec, vcc
    s_lshl_b32 s98, s72, 5
    s_add_u32 s98, s98, 256
    s_sub_u32 s95, s98, 4
    s_max_i32 s95, s95, 0
    s_lshl_b32 s94, s98, 3
    s_lshl_b32 s95, s95, 3
    s_nop 0
    s_add_u32 s94, s94, 3457024
    s_add_u32 s95, s95, 3457024
    s_add_u32 s96, s94, 8192
    buffer_load_dwordx2 v[152:153], v47, s[16:19], s94 offen sc1
    buffer_load_dwordx2 v[154:155], v47, s[16:19], s96 offen sc1
    buffer_load_dwordx2 v[156:157], v48, s[16:19], s95 offen sc1
    s_mov_b64 exec, -1
    s_waitcnt vmcnt(0) lgkmcnt(0)
    s_branch sl_70
rd_73:
    s_cmp_eq_u32 s39, 0
    s_cbranch_scc1 rc_74
    s_sub_u32 s39, s39, 1
    s_nop 7
    s_nop 7
    s_waitcnt vmcnt(0) lgkmcnt(0)
    s_barrier
    s_lshl_b32 s25, s72, 5
    s_add_u32 s25, s25, 256
    s_sub_u32 s26, s25, 4
    s_max_i32 s26, s26, 0
    s_lshl_b32 s27, s71, 12
    s_add_u32 s27, s27, 9437184
    s_lshl_b32 s99, s25, 3
    s_lshl_b32 s100, s26, 3
    s_lshl_b32 s92, s24, 12
    s_lshl_b32 s93, s24, 9
    s_add_u32 s99, s99, s27
    s_add_u32 s100, s100, s27
    s_add_u32 m0, s92, 36352
    s_nop 0
    s_nop 0
    buffer_load_dwordx4 v73, s[16:19], s99 offen offset:0 sc1 lds
    buffer_load_dwordx4 v74, s[16:19], s99 offen offset:1024 sc1 lds
    buffer_load_dwordx4 v75, s[16:19], s99 offen offset:2048 sc1 lds
    buffer_load_dwordx4 v76, s[16:19], s99 offen offset:3072 sc1 lds
    s_add_u32 m0, s93, 53760
    s_add_u32 s99, s99, 524288
    s_mov_b64 exec, s[80:81]
    buffer_load_dwordx4 v77, s[16:19], s100 offen sc1 lds
    s_mov_b64 exec, -1
    s_add_u32 s100, s100, 524288
    s_add_u32 m0, s92, 55936
    s_nop 0
    s_nop 0
    buffer_load_dwordx4 v73, s[16:19], s99 offen offset:0 sc1 lds
    buffer_load_dwordx4 v74, s[16:19], s99 offen offset:1024 sc1 lds
    buffer_load_dwordx4 v75, s[16:19], s99 offen offset:2048 sc1 lds
    buffer_load_dwordx4 v76, s[16:19], s99 offen offset:3072 sc1 lds
    s_add_u32 m0, s93, 73344
    s_add_u32 s99, s99, 524288
    s_mov_b64 exec, s[80:81]
    buffer_load_dwordx4 v77, s[16:19], s100 offen sc1 lds
    s_mov_b64 exec, -1
    s_add_u32 s100, s100, 524288
    s_add_u32 m0, s92, 75520
    s_nop 0
    s_nop 0
    buffer_load_dwordx4 v73, s[16:19], s99 offen offset:0 sc1 lds
    buffer_load_dwordx4 v74, s[16:19], s99 offen offset:1024 sc1 lds
    buffer_load_dwordx4 v75, s[16:19], s99 offen offset:2048 sc1 lds
    buffer_load_dwordx4 v76, s[16:19], s99 offen offset:3072 sc1 lds
    s_add_u32 m0, s93, 92928
    s_add_u32 s99, s99, 524288
    s_mov_b64 exec, s[80:81]
    buffer_load_dwordx4 v77, s[16:19], s100 offen sc1 lds
    s_mov_b64 exec, -1
    s_add_u32 s100, s100, 524288
    s_mov_b64 exec, -1
    s_waitcnt vmcnt(0) lgkmcnt(0)
    s_branch ge_69
rd_76:
    s_cmp_eq_u32 s38, 0
    s_cbranch_scc1 rc_77
    s_sub_u32 s38, s38, 1
    s_nop 7
    s_nop 7
    s_sleep 4
    s_mov_b64 exec, vcc
    s_mov_b32 s96, 12058624
    buffer_load_dwordx4 v[216:219], v56, s[16:19], s96 offen offset:0 sc1
    buffer_load_dwordx4 v[220:223], v56, s[16:19], s96 offen offset:256 sc1
    s_mov_b32 s96, 12091392
    buffer_load_dwordx4 v[224:227], v56, s[16:19], s96 offen offset:0 sc1
    buffer_load_dwordx4 v[228:231], v56, s[16:19], s96 offen offset:256 sc1
    s_mov_b32 s96, 12124160
    buffer_load_dwordx4 v[232:235], v56, s[16:19], s96 offen offset:0 sc1
    buffer_load_dwordx4 v[236:239], v56, s[16:19], s96 offen offset:256 sc1
    s_mov_b32 s96, 12156928
    buffer_load_dwordx4 v[240:243], v56, s[16:19], s96 offen offset:0 sc1
    buffer_load_dwordx4 v[244:247], v56, s[16:19], s96 offen offset:256 sc1
    s_mov_b32 s96, 12058624
    buffer_load_dwordx2 v[248:249], v57, s[16:19], s96 offen offset:0 sc1
    buffer_load_dwordx2 v[252:253], v57, s[16:19], s96 offen offset:128 sc1
    s_mov_b32 s96, 12075008
    buffer_load_dwordx2 v[250:251], v57, s[16:19], s96 offen offset:0 sc1
    buffer_load_dwordx2 v[254:255], v57, s[16:19], s96 offen offset:128 sc1
    s_mov_b32 s96, 9437184
    buffer_load_dwordx4 v[208:211], v59, s[16:19], s96 offen sc1
    s_add_u32 s97, s36, 9437184
    buffer_load_dword v212, v61, s[16:19], s97 offen sc1
    s_mov_b64 exec, -1
    s_waitcnt vmcnt(0) lgkmcnt(0)
    s_branch oe_75
rd_79:
    s_cmp_eq_u32 s38, 0
    s_cbranch_scc1 rc_80
    s_sub_u32 s38, s38, 1
    s_nop 7
    s_nop 7
    s_sleep 4
    s_mov_b64 exec, vcc
    s_mov_b32 s96, 12062720
    buffer_load_dwordx4 v[216:219], v56, s[16:19], s96 offen offset:0 sc1
    buffer_load_dwordx4 v[220:223], v56, s[16:19], s96 offen offset:256 sc1
    s_mov_b32 s96, 12095488
    buffer_load_dwordx4 v[224:227], v56, s[16:19], s96 offen offset:0 sc1
    buffer_load_dwordx4 v[228:231], v56, s[16:19], s96 offen offset:256 sc1
    s_mov_b32 s96, 12128256
    buffer_load_dwordx4 v[232:235], v56, s[16:19], s96 offen offset:0 sc1
    buffer_load_dwordx4 v[236:239], v56, s[16:19], s96 offen offset:256 sc1
    s_mov_b32 s96, 12161024
    buffer_load_dwordx4 v[240:243], v56, s[16:19], s96 offen offset:0 sc1
    buffer_load_dwordx4 v[244:247], v56, s[16:19], s96 offen offset:256 sc1
    s_mov_b32 s96, 12060672
    buffer_load_dwordx2 v[248:249], v57, s[16:19], s96 offen offset:0 sc1
    buffer_load_dwordx2 v[252:253], v57, s[16:19], s96 offen offset:128 sc1
    s_mov_b32 s96, 12077056
    buffer_load_dwordx2 v[250:251], v57, s[16:19], s96 offen offset:0 sc1
    buffer_load_dwordx2 v[254:255], v57, s[16:19], s96 offen offset:128 sc1
    s_mov_b32 s96, 9439232
    buffer_load_dwordx4 v[208:211], v59, s[16:19], s96 offen sc1
    s_add_u32 s97, s36, 9439232
    buffer_load_dword v212, v61, s[16:19], s97 offen sc1
    s_mov_b64 exec, -1
    s_waitcnt vmcnt(0) lgkmcnt(0)
    s_branch oe_78
rd_84:
    s_cmp_eq_u32 s38, 0
    s_cbranch_scc1 rc_85
    s_sub_u32 s38, s38, 1
    s_nop 7
    s_nop 7
    s_sleep 4
    s_mov_b64 exec, vcc
    s_lshl_b32 s96, s75, 14
    s_add_u32 s96, s96, 14680064
    s_lshl_b32 s97, s24, 12
    s_add_u32 s97, s97, 3506176
    buffer_load_dwordx4 v[176:179], v62, s[16:19], s96 offen offset:0 sc1
    buffer_load_dwordx4 v[180:183], v62, s[16:19], s96 offen offset:1024 sc1
    buffer_load_dwordx4 v[184:187], v62, s[16:19], s97 offen offset:0 sc1
    buffer_load_dwordx4 v[188:191], v62, s[16:19], s97 offen offset:1024 sc1
    buffer_load_dwordx4 v[192:195], v62, s[16:19], s97 offen offset:2048 sc1
    buffer_load_dwordx4 v[196:199], v62, s[16:19], s97 offen offset:3072 sc1
    s_mov_b64 exec, -1
    s_waitcnt vmcnt(0) lgkmcnt(0)
    s_branch ce_83
rd_87:
    s_cmp_eq_u32 s38, 0
    s_cbranch_scc1 rc_88
    s_sub_u32 s38, s38, 1
    s_nop 7
    s_nop 7
    s_sleep 4
    s_mov_b64 exec, vcc
    s_lshl_b32 s96, s75, 14
    s_add_u32 s96, s96, 14680064
    s_lshl_b32 s97, s24, 12
    s_add_u32 s97, s97, 3510272
    buffer_load_dwordx4 v[248:251], v62, s[16:19], s96 offen offset:2048 sc1
    buffer_load_dwordx4 v[252:255], v62, s[16:19], s96 offen offset:3072 sc1
    buffer_load_dwordx4 v[96:99], v62, s[16:19], s97 offen offset:0 sc1
    buffer_load_dwordx4 v[100:103], v62, s[16:19], s97 offen offset:1024 sc1
    buffer_load_dwordx4 v[104:107], v62, s[16:19], s97 offen offset:2048 sc1
    buffer_load_dwordx4 v[108:111], v62, s[16:19], s97 offen offset:3072 sc1
    s_mov_b64 exec, -1
    s_waitcnt vmcnt(0) lgkmcnt(0)
    s_branch ce_86
L_last:
    s_endpgm
.section .rodata,"a"
.p2align 6
.amdhsa_kernel interleave_layers__sliding_local_dilated__ssm_conv_s4d__prompt_kernel
  .amdhsa_next_free_vgpr 512
  .amdhsa_next_free_sgpr 102
  .amdhsa_accum_offset 256
  .amdhsa_group_segment_fixed_size 0
  .amdhsa_kernarg_size 104
  .amdhsa_user_sgpr_count 2
  .amdhsa_user_sgpr_kernarg_segment_ptr 1
  .amdhsa_system_sgpr_workgroup_id_x 1
.end_amdhsa_kernel
```

```asm
; @launch grid=(256,1,1) block=(256,1,1) lds=163840
.amdgcn_target "amdgcn-amd-amdhsa--gfx950"
.text
.globl interleave_layers__sliding_local_dilated__ssm_conv_s4d__prompt_kernel
.p2align 8
.type interleave_layers__sliding_local_dilated__ssm_conv_s4d__prompt_kernel,@function
interleave_layers__sliding_local_dilated__ssm_conv_s4d__prompt_kernel:
    s_getpc_b64 s[42:43]
L_start:
    s_cmp_ge_u32 s2, 256
    s_cbranch_scc1 L_end
    s_load_dwordx16 s[44:59], s[0:1], 0
    s_load_dwordx8 s[60:67], s[0:1], 64
    s_load_dwordx2 s[68:69], s[0:1], 96
    v_and_b32 v1, 63, v0
    v_lshrrev_b32 v2, 6, v0
    s_nop 0
    v_readfirstlane_b32 s24, v2
    s_bfe_u32 s82, s2, 0x40003
    s_lshl_b32 s82, s82, 13
    v_lshrrev_b32 v159, 2, v0
    v_lshl_add_u32 v159, v159, 7, s82
    v_min_u32 v159, L_last-L_start, v159
    global_load_dword v159, v159, s[42:43]
    s_and_b32 s25, s2, 7
    s_lshr_b32 s26, s2, 3
    s_and_b32 s27, s26, 3
    s_lshr_b32 s28, s26, 4
    s_lshl_b32 s28, s28, 2
    s_add_u32 s3, s27, s28
    s_lshl_b32 s27, s3, 2
    s_lshr_b32 s70, 0x75206431, s27
    s_and_b32 s70, s70, 7
    s_and_b32 s27, s25, 1
    s_lshl_b32 s27, s27, 3
    s_add_u32 s70, s70, s27
    s_bfe_u32 s71, s26, 0x10002
    s_bfe_u32 s28, s26, 0x10003
    s_and_b32 s72, s25, 6
    s_add_u32 s72, s72, s28
    s_and_b32 s73, s26, 7
    s_lshr_b32 s28, s26, 3
    s_lshl_b32 s74, s25, 2
    s_add_u32 s74, s74, s28
    s_mul_i32 s75, s25, 20
    s_add_u32 s75, s75, s26
    s_min_u32 s27, s2, 239
    s_mul_i32 s25, s27, 10923
    s_lshr_b32 s25, s25, 16
    s_mul_i32 s26, s25, 6
    s_sub_u32 s26, s27, s26
    s_mul_i32 s27, s25, 61440
    s_mul_i32 s28, s26, 640
    s_add_u32 s27, s27, s28
    s_lshl_b32 s28, s24, 10
    v_add_u32 v85, 0, v0
    v_mul_u32_u24 v84, 1639, v85
    v_lshrrev_b32 v84, 16, v84
    v_mul_u32_u24 v84, 3200, v84
    v_lshl_add_u32 v85, v85, 4, v84
    v_add_u32 v86, 256, v0
    v_mul_u32_u24 v84, 1639, v86
    v_lshrrev_b32_e64 v84, 16, v84
    v_mul_u32_u24 v84, 3200, v84
    v_lshl_add_u32 v86, v86, 4, v84
    v_add_u32 v87, 512, v0
    v_min_u32 v87, 639, v87
    v_mul_u32_u24 v84, 1639, v87
    v_lshrrev_b32_e64 v84, 16, v84
    v_mul_u32_u24 v84, 3200, v84
    v_lshl_add_u32 v87, v87, 4, v84
    s_mov_b32 s76, 0
    s_mov_b32 s77, 0x80000000
    s_mov_b32 s80, -1
    s_mov_b32 s81, 0
    s_nop 0
    s_mov_b32 s78, 0xfe0000fe
    s_mov_b32 s79, 0xfe0000fe
    s_mov_b32 s6, 2621440
    s_mov_b32 s7, 0x20000
    s_mov_b32 s10, 2457600
    s_mov_b32 s11, 0x20000
    s_mov_b32 s14, 819200
    s_mov_b32 s15, 0x20000
    s_mov_b32 s18, 22061056
    s_mov_b32 s19, 0x20000
    s_mov_b32 s22, 2621440
    s_mov_b32 s23, 0x20000
    s_waitcnt lgkmcnt(0)
    s_mov_b32 s4, s44
    s_and_b32 s5, s45, 0xffff
    s_mov_b32 s8, s46
    s_and_b32 s9, s47, 0xffff
    s_mov_b32 s12, s48
    s_and_b32 s13, s49, 0xffff
    s_mov_b32 s16, s68
    s_and_b32 s17, s69, 0xffff
    s_mov_b32 s20, s64
    s_and_b32 s21, s65, 0xffff
    s_cmp_lg_u32 s2, 255
    s_cbranch_scc1 fz_1
    v_mov_b32 v120, 0
    v_mov_b32 v121, 0
    v_mov_b32 v122, 0
    v_mov_b32 v123, 0
    v_lshlrev_b32 v124, 4, v0
    s_mov_b32 s88, 3538944
    buffer_store_dwordx4 v[120:123], v124, s[16:19], s88 offen sc1
    s_mov_b32 s88, 3543040
    buffer_store_dwordx4 v[120:123], v124, s[16:19], s88 offen sc1
    s_mov_b32 s88, 3547136
    buffer_store_dwordx4 v[120:123], v124, s[16:19], s88 offen sc1
    s_mov_b32 s88, 3555328
    buffer_store_dwordx4 v[120:123], v124, s[16:19], s88 offen sc1
    s_mov_b32 s88, 3559424
    buffer_store_dwordx4 v[120:123], v124, s[16:19], s88 offen sc1
    s_mov_b32 s88, 3563520
    buffer_store_dwordx4 v[120:123], v124, s[16:19], s88 offen sc1
fz_1:
    s_min_u32 s96, s75, 159
    s_lshl_b32 s96, s96, 2
    s_add_u32 s96, s96, s24
    s_mul_i32 s97, s96, 384
    s_lshl_b32 s96, s96, 1
    v_lshl_add_u32 v2, v1, 2, s97
    v_mov_b32 v241, s96
    global_load_dword v232, v2, s[52:53]
    global_load_dword v233, v2, s[54:55]
    global_load_dword v234, v2, s[56:57]
    global_load_dword v235, v2, s[58:59]
    global_load_ushort v240, v241, s[60:61]
    s_add_u32 m0, s28, 134272
    s_nop 0
    buffer_load_dwordx4 v85, s[8:11], s27 offen lds
    s_add_u32 m0, s28, 138368
    s_nop 0
    buffer_load_dwordx4 v86, s[8:11], s27 offen lds
    s_add_u32 m0, s28, 142464
    s_nop 0
    buffer_load_dwordx4 v87, s[8:11], s27 offen lds
    s_lshr_b32 s29, s26, 1
    s_and_b32 s30, s26, 1
    s_lshl_b32 s30, s30, 3
    s_lshl_b32 s31, s25, 10
    s_add_u32 s31, s31, 0
    s_cmp_ge_u32 s2, 240
    s_cselect_b32 s31, 1073741824, s31
    v_bfe_u32 v93, v0, 2, 2
    v_bfe_u32 v92, v0, 1, 1
    v_lshl_add_u32 v92, v92, 3, v93
    v_mul_u32_u24 v92, 640, v92
    v_and_b32 v93, 1, v0
    v_mul_u32_u24 v93, 40, v93
    v_add_u32 v91, v92, v93
    v_add_u32 v91, 134272, v91
    v_lshrrev_b32 v88, 4, v0
    v_add_u32 v88, 0, v88
    v_cmp_gt_u32 vcc, 40, v88
    v_min_u32 v88, 39, v88
    v_mul_u32_u24 v89, 13108, v88
    v_lshrrev_b32 v89, 16, v89
    v_mul_u32_u24 v90, 5, v89
    v_sub_u32_e64 v90, v88, v90
    v_mul_u32_u24 v92, 80, v89
    v_lshl_add_u32 v92, v90, 3, v92
    v_add_u32 v111, v92, v91
    v_add_u32 v89, s30, v89
    v_cmp_eq_u32 s[82:83], 4, v90
    v_mov_b32 v92, s29
    s_nop 0
    v_cndmask_b32 v93, v90, v92, s[82:83]
    v_cndmask_b32 v92, v92, 3, s[82:83]
    v_lshl_add_u32 v89, v89, 2, v93
    v_mul_u32_u24 v89, 40960, v89
    v_lshl_add_u32 v89, v92, 8, v89
    v_and_b32 v92, 15, v0
    v_lshl_add_u32 v89, v92, 4, v89
    v_mov_b32 v92, 1073741824
    v_cndmask_b32 v89, v92, v89, vcc
    v_add_u32 v108, s31, v89
    v_lshrrev_b32 v88, 4, v0
    v_add_u32 v88, 16, v88
    v_cmp_gt_u32 vcc, 40, v88
    v_min_u32 v88, 39, v88
    v_mul_u32_u24 v89, 13108, v88
    v_lshrrev_b32 v89, 16, v89
    v_mul_u32_u24 v90, 5, v89
    v_sub_u32_e64 v90, v88, v90
    v_mul_u32_u24 v92, 80, v89
    v_lshl_add_u32 v92, v90, 3, v92
    v_add_u32 v112, v92, v91
    v_add_u32 v89, s30, v89
    v_cmp_eq_u32 s[82:83], 4, v90
    v_mov_b32 v92, s29
    s_nop 0
    v_cndmask_b32 v93, v90, v92, s[82:83]
    v_cndmask_b32 v92, v92, 3, s[82:83]
    v_lshl_add_u32 v89, v89, 2, v93
    v_mul_u32_u24 v89, 40960, v89
    v_lshl_add_u32 v89, v92, 8, v89
    v_and_b32 v92, 15, v0
    v_lshl_add_u32 v89, v92, 4, v89
    v_mov_b32 v92, 1073741824
    v_cndmask_b32 v89, v92, v89, vcc
    v_add_u32 v109, s31, v89
    v_lshrrev_b32 v88, 4, v0
    v_add_u32 v88, 32, v88
    v_cmp_gt_u32 vcc, 40, v88
    v_min_u32 v88, 39, v88
    v_mul_u32_u24 v89, 13108, v88
    v_lshrrev_b32 v89, 16, v89
    v_mul_u32_u24 v90, 5, v89
    v_sub_u32_e64 v90, v88, v90
    v_mul_u32_u24 v92, 80, v89
    v_lshl_add_u32 v92, v90, 3, v92
    v_add_u32 v113, v92, v91
    v_add_u32 v89, s30, v89
    v_cmp_eq_u32 s[82:83], 4, v90
    v_mov_b32 v92, s29
    s_nop 0
    v_cndmask_b32 v93, v90, v92, s[82:83]
    v_cndmask_b32 v92, v92, 3, s[82:83]
    v_lshl_add_u32 v89, v89, 2, v93
    v_mul_u32_u24 v89, 40960, v89
    v_lshl_add_u32 v89, v92, 8, v89
    v_and_b32 v92, 15, v0
    v_lshl_add_u32 v89, v92, 4, v89
    v_mov_b32 v92, 1073741824
    v_cndmask_b32 v89, v92, v89, vcc
    v_add_u32 v110, s31, v89
    s_mul_i32 s25, s3, 18
    s_lshl_b32 s26, s72, 7
    s_add_u32 s25, s25, s26
    s_add_u32 s25, s25, s71
    s_add_u32 s25, s25, -16
    s_max_i32 s25, s25, 0
    s_mul_i32 s25, s25, 1280
    v_lshrrev_b32_e64 v204, 1, v0
    v_min_u32 v204, 89, v204
    v_mul_u32_u24 v205, 6554, v204
    v_lshrrev_b32_e64 v205, 16, v205
    v_mul_u32_u24 v205, 1280, v205
    v_lshl_add_u32 v204, v204, 7, v205
    buffer_load_dword v204, v204, s[4:7], s25 offen
    s_and_b32 s25, s2, 7
    s_lshl_b32 s86, s25, 7
    s_add_u32 s86, s86, 3538944
    s_lshl_b32 s87, s25, 10
    s_add_u32 s87, s87, 3538944
    s_add_u32 s89, s87, 16384
    v_cmp_gt_u32 s[50:51], 8, v0
    v_cmp_eq_u32 vcc, 0, v0
    v_lshlrev_b32 v4, 7, v1
    v_mov_b32 v6, 1073741824
    v_cndmask_b32 v4, v6, v4, s[50:51]
    v_cndmask_b32 v6, v6, 0, vcc
    v_mov_b32 v5, 0
    s_cmp_lg_u32 s2, 255
    s_cbranch_scc1 fr_2
    v_mov_b32 v2, 1
    s_waitcnt vmcnt(9)
    s_barrier
    s_mov_b64 exec, 1
    global_store_dword v5, v2, s[66:67] sc1
    s_mov_b64 exec, -1
fr_2:
    v_mov_b32 v140, 0
    v_mov_b32_e64 v141, 0
    v_mov_b32 v142, 0x3f803f80
    v_mov_b32 v143, 0x3f803f80
    v_lshlrev_b32_e64 v144, 3, v0
    v_add_u32 v144, 155648, v144
    ds_write_b64 v144, v[140:141]
    ds_write_b64 v144, v[142:143] offset:2048
    v_and_b32 v50, 31, v1
    v_lshrrev_b32 v51, 5, v1
    v_mul_u32_u24 v52, 40, v50
    v_mul_u32_u24 v53, 3200, v51
    v_add_u32 v53, v52, v53
    s_lshl_b32 s25, s24, 3
    s_add_u32 s25, s25, 320
    v_add_u32 v38, s25, v53
    s_mul_i32 s25, s24, 6400
    s_add_u32 s25, s25, 352
    v_add_u32 v39, s25, v53
    s_lshl_b32 s31, s71, 12
    v_lshl_add_u32 v47, v50, 3, s31
    v_bfe_u32 v52, v1, 2, 1
    v_and_b32 v53, 3, v1
    v_lshlrev_b32 v54, 13, v52
    v_lshl_add_u32 v54, v53, 3, v54
    v_add_u32_e64 v48, s31, v54
    v_bfe_u32 v54, v1, 4, 1
    v_lshl_add_u32 v52, v54, 1, v52
    v_mul_u32_u24 v52, 40, v52
    v_add_u32 v52, v52, v53
    v_mul_u32_u24_e64 v52, 40, v52
    v_bfe_u32 v53, v1, 3, 1
    v_cmp_eq_u32 s[82:83], v53, v54
    v_lshl_add_u32 v53, v53, 1, v51
    v_cmp_eq_u32 vcc, 3, v53
    v_mov_b32 v54, s24
    s_nop 0
    v_cndmask_b32 v53, v53, v54, vcc
    v_cndmask_b32 v54, v54, 4, vcc
    v_mul_u32_u24 v53, 6400, v53
    v_lshl_add_u32 v52, v54, 3, v52
    v_add_u32_e64 v52, v52, v53
    v_add_u32 v40, 160, v52
    v_mov_b32 v52, 19584
    v_cndmask_b32 v49, 0, v52, s[78:79]
    v_and_b32 v50, 15, v1
    v_lshrrev_b32 v51, 4, v1
    s_and_b32 s25, s24, 1
    s_and_b32 s26, s24, 2
    s_mul_i32 s27, s25, 3200
    s_mul_i32 s28, s26, 320
    s_add_u32 s27, s27, s28
    s_add_u32 s27, s27, 0
    v_and_b32 v52, 1, v1
    v_mul_u32_u24 v52, 1600, v52
    v_lshrrev_b32 v53, 1, v50
    v_mul_u32_u24_e64 v54, 40, v53
    v_add3_u32 v52, v52, v54, s27
    v_lshl_add_u32 v41, v51, 3, v52
    v_add_u32_e64 v42, 32, v52
    v_bfe_u32 v52, v1, 2, 1
    v_mul_u32_u24 v52, 1600, v52
    v_lshrrev_b32 v54, 3, v1
    v_mul_u32_u24 v54, 40, v54
    v_add3_u32 v52, v52, v54, s27
    v_add_u32 v52, 12800, v52
    v_and_b32 v54, 3, v1
    v_lshl_add_u32 v43, v54, 3, v52
    v_add_u32 v52, 32, v52
    v_cmp_eq_u32 vcc, 0, v54
    v_mov_b32 v54, 157696
    s_nop 0
    v_cndmask_b32 v44, v54, v52, vcc
    v_and_b32 v52, 1, v51
    v_add_u32 v52, s26, v52
    v_lshrrev_b32 v54, 2, v50
    v_lshl_add_u32 v52, v52, 2, v54
    v_and_b32 v53, 1, v53
    v_lshl_add_u32 v52, v53, 4, v52
    v_and_b32 v53, 1, v50
    v_lshl_add_u32 v52, v53, 10, v52
    s_lshl_b32 s30, s70, 1
    s_add_u32 s30, s30, s25
    s_lshl_b32 s29, s30, 3
    s_add_u32 s29, s29, s71
    s_lshl_b32 s29, s29, 13
    v_lshrrev_b32 v53, 1, v51
    v_lshlrev_b32 v53, 15, v53
    v_lshl_add_u32 v53, v52, 4, v53
    v_add_u32_e64 v45, s29, v53
    s_lshl_b32 s29, s30, 2
    s_add_u32 s29, s29, s71
    s_lshl_b32 s29, s29, 12
    s_add_u32 s29, s29, 2097152
    v_lshl_add_u32 v46, v52, 3, s29
    s_or_b32 s29, s26, s72
    s_cmp_eq_u32 s29, 0
    s_cselect_b64 s[90:91], -1, 0
    v_lshlrev_b32 v52, 2, v51
    v_sub_u32 v52, v50, v52
    v_mov_b32 v55, 0xf149f2ca
    v_subrev_u32 v53, 0, v52
    v_cmp_lt_u32 vcc, 7, v53
    s_nop 1
    v_cndmask_b32 v28, 0, v55, vcc
    v_cmp_lt_i32 vcc, -9, v53
    s_nop 1
    v_cndmask_b32 v32, 0, v55, vcc
    v_cmp_le_i32 vcc, 0, v53
    v_mov_b32 v54, 0xffff
    s_nop 0
    v_cndmask_b32 v54, 0, v54, vcc
    v_mov_b32 v36, v54
    v_subrev_u32 v53, 1, v52
    v_cmp_lt_u32 vcc, 7, v53
    s_nop 1
    v_cndmask_b32 v29, 0, v55, vcc
    v_cmp_lt_i32 vcc, -9, v53
    s_nop 1
    v_cndmask_b32 v33, 0, v55, vcc
    v_cmp_le_i32 vcc, 0, v53
    v_mov_b32 v54, 0xffff0000
    s_nop 0
    v_cndmask_b32 v54, 0, v54, vcc
    v_or_b32 v36, v36, v54
    v_subrev_u32 v53, 2, v52
    v_cmp_lt_u32 vcc, 7, v53
    s_nop 1
    v_cndmask_b32 v30, 0, v55, vcc
    v_cmp_lt_i32 vcc, -9, v53
    s_nop 1
    v_cndmask_b32 v34, 0, v55, vcc
    v_cmp_le_i32 vcc, 0, v53
    v_mov_b32 v54, 0xffff
    s_nop 0
    v_cndmask_b32 v54, 0, v54, vcc
    v_mov_b32 v37, v54
    v_subrev_u32 v53, 3, v52
    v_cmp_lt_u32 vcc, 7, v53
    s_nop 1
    v_cndmask_b32 v31, 0, v55, vcc
    v_cmp_lt_i32 vcc, -9, v53
    s_nop 1
    v_cndmask_b32 v35, 0, v55, vcc
    v_cmp_le_i32 vcc, 0, v53
    v_mov_b32 v54, 0xffff0000
    s_nop 0
    v_cndmask_b32 v54, 0, v54, vcc
    v_or_b32 v37, v37, v54
    v_and_b32 v62, 15, v1
    v_lshrrev_b32 v63, 4, v1
    s_and_b32 s25, s74, 3
    s_lshr_b32 s26, s74, 2
    s_lshl_b32 s27, s24, 6
    s_add_u32 s27, s27, s25
    s_lshl_b32 s27, s27, 13
    s_lshl_b32 s28, s26, 9
    s_add_u32 s27, s27, s28
    v_lshl_add_u32 v64, v63, 17, s27
    v_lshl_add_u32 v56, v62, 4, v64
    s_lshl_b32 s27, s24, 5
    s_add_u32 s27, s27, s25
    s_lshl_b32 s27, s27, 12
    s_lshl_b32 s28, s26, 8
    s_add_u32 s27, s27, s28
    s_add_u32 s27, s27, 2097152
    v_lshl_add_u32 v64, v63, 15, s27
    v_lshl_add_u32 v57, v62, 3, v64
    v_lshlrev_b32 v58, 4, v1
    s_lshl_b32 s29, s25, 12
    s_add_u32 s29, s29, s28
    v_lshl_add_u32 v64, v62, 4, s29
    v_lshl_add_u32 v61, v63, 2, v64
    s_mul_i32 s30, s73, 20
    s_lshl_b32 s31, s24, 2
    s_add_u32 s30, s30, s31
    s_lshl_b32 s31, s30, 14
    v_lshl_add_u32 v64, v63, 14, v64
    v_add_u32 v59, s31, v64
    s_lshl_b32 s31, s26, 7
    s_add_u32 s31, s31, s25
    s_mul_i32 s31, s31, 1280
    s_lshl_b32 s30, s30, 3
    s_add_u32 s31, s31, s30
    v_mul_u32_u24 v64, 10240, v62
    v_lshl_add_u32 v64, v63, 3, v64
    v_add_u32_e64 v60, s31, v64
    s_lshl_b32 s25, s24, 12
    v_lshl_add_u32 v62, v1, 4, s25
    s_mul_i32 s25, s24, 1216
    s_add_u32 s25, s25, 192
    v_lshl_add_u32 v63, v1, 2, s25
    s_mul_i32 s25, s24, 4864
    s_add_u32 s25, s25, 80
    v_and_b32_e64 v70, 3, v1
    v_mul_u32_u24 v70, 1216, v70
    v_bfe_u32 v71, v1, 2, 3
    v_lshl_add_u32 v70, v71, 4, v70
    v_lshrrev_b32 v71, 5, v1
    v_lshl_add_u32 v70, v71, 4, v70
    v_add_u32 v64, s25, v70
    s_mul_i32 s25, s24, 4160
    s_add_u32 s25, s25, 134368
    v_lshlrev_b32 v71, 6, v71
    v_sub_u32 v71, s25, v71
    v_bfe_u32 v70, v1, 4, 1
    v_lshl_add_u32 v71, v70, 5, v71
    v_and_b32_e64 v70, 3, v1
    v_lshl_add_u32 v71, v70, 3, v71
    v_bfe_u32 v70, v1, 2, 2
    v_lshlrev_b32 v70, 3, v70
    v_sub_u32 v65, v71, v70
    s_mul_i32 s25, s24, 4224
    s_add_u32 s25, s25, 19456
    v_and_b32 v70, 3, v1
    v_mul_u32_u24 v70, 1056, v70
    v_and_b32 v71, 60, v1
    v_add3_u32 v66, v70, v71, s25
    s_mul_i32 s25, s24, 1056
    s_add_u32 s25, s25, 19456
    v_lshl_add_u32 v67, v1, 3, s25
    s_mul_i32 s25, s24, 1280
    s_lshl_b32 s26, s75, 3
    s_add_u32 s25, s25, s26
    v_mul_u32_u24 v70, 10240, v1
    v_add_u32 v68, s25, v70
    s_and_b32 s25, s24, 1
    s_lshl_b32 s25, s25, 6
    s_and_b32 s26, s24, 2
    s_add_u32 s25, s25, s26
    s_mul_i32 s25, s25, 1280
    v_lshrrev_b32 v140, 4, v1
    v_and_b32 v141, 15, v1
    v_xor_b32 v141, v140, v141
    v_lshlrev_b32_e64 v141, 4, v141
    v_mul_u32_u24 v142, 5120, v140
    v_add3_u32 v73, v141, v142, s25
    s_and_b32 s25, s24, 1
    s_lshl_b32 s25, s25, 3
    s_add_u32 s25, s25, s26
    s_mul_i32 s25, s25, 1280
    v_add3_u32 v77, v141, v142, s25
    v_lshrrev_b32 v141, 5, v1
    v_and_b32 v140, 3, v1
    v_xor_b32 v142, v140, v141
    v_lshlrev_b32_e64 v142, 4, v142
    v_lshl_add_u32 v142, v140, 8, v142
    v_bfe_u32 v140, v1, 2, 3
    v_mul_u32_u24 v140, 1088, v140
    v_add_u32 v78, v140, v142
    v_and_b32 v140, 1, v1
    v_xor_b32 v142, v140, v141
    v_lshlrev_b32 v142, 4, v142
    v_lshl_add_u32 v142, v140, 8, v142
    v_bfe_u32 v140, v1, 1, 2
    v_mul_u32_u24 v140, 544, v140
    v_add_u32_e64 v142, v140, v142
    v_add_u32 v74, 19392, v73
    v_add_u32 v75, 38784, v73
    v_add_u32 v76, 58176, v73
    v_add_u32 v142, 53760, v142
    v_and_b32 v140, 31, v1
    v_cmp_eq_u32 vcc, 0, v140
    v_cmp_eq_u32 s[82:83], 24, v140
    s_nop 0
    s_or_b64 vcc, vcc, s[82:83]
    v_mov_b32 v140, 155648
    v_mov_b32 v141, 157696
    v_cndmask_b32_e64 v140, v140, v141, vcc
    v_cndmask_b32 v79, v140, v142, s[78:79]
    v_bfe_u32 v201, v1, 3, 2
    v_and_b32 v202, s24, v201
    v_cmp_eq_u32 vcc, 3, v202
    v_lshrrev_b32 v202, 5, v1
    v_lshl_add_u32 v201, v201, 1, v202
    v_and_b32 v202, 7, v1
    v_lshl_add_u32 v201, v201, 3, v202
    v_lshlrev_b32 v200, 4, v201
    v_mov_b32 v201, 1073741824
    v_cndmask_b32 v200, v200, v201, vcc
    s_lshl_b32 s101, s70, 2
    s_add_u32 s101, s101, s24
    s_mul_i32 s101, s101, 40960
    s_add_u32 s101, s101, 0
    s_lshl_b32 s25, s72, 5
    s_add_u32 s25, s25, 0
    s_sub_u32 s26, s25, 4
    s_max_i32 s26, s26, 0
    s_mul_i32 s27, s71, 1280
    s_mul_i32 s99, s25, 5120
    s_mul_i32 s100, s26, 5120
    s_mul_i32 s92, s24, 4352
    s_mul_i32 s93, s24, 544
    s_add_u32 s99, s99, s27
    s_add_u32 s100, s100, s27
    s_mov_b32 s38, 0x10000
    s_mov_b32 s39, 0x1000
    s_cmp_ge_u32 s2, 160
    s_cbranch_scc1 nc_3
    s_mul_i32 s37, s24, 8704
    s_add_u32 s25, s37, 0
    s_add_u32 s37, s37, 0
    s_mov_b32 m0, s37
    v_and_b32 v199, 31, v1
    v_mul_u32_u24 v199, 272, v199
    v_lshrrev_b32 v215, 5, v1
    v_lshl_add_u32 v199, v215, 4, v199
    v_add_u32 v252, s25, v199
    s_waitcnt vmcnt(4)
    v_lshlrev_b32 v253, 16, v240
    v_mul_f32 v253, 0x3fb8aa3b, v253
    v_exp_f32 v253, v253
    s_nop 0
    v_cvt_pk_bf16_f32 v253, v253, v253
    v_lshlrev_b32 v253, 16, v253
    v_lshlrev_b32 v199, 16, v232
    v_mul_f32 v199, 0x3fb8aa3b, v199
    v_exp_f32 v199, v199
    v_lshlrev_b32 v255, 16, v233
    v_mul_f32 v255, v255, v253
    v_mul_f32 v255, 0x3e22f983, v255
    v_cvt_pk_bf16_f32 v199, v199, v199
    v_lshlrev_b32 v199, 16, v199
    v_mul_f32_e64 v254, v199, v253
    v_mul_f32 v254, 0xbfb8aa3b, v254
    v_mul_f32 v182, 0x41000000, v254
    v_mul_f32 v185, 0x41000000, v255
    v_mul_f32 v184, 0x43800000, v254
    v_mul_f32 v189, 0x43800000, v255
    v_fract_f32 v185, v185
    v_fract_f32 v188, v255
    s_waitcnt vmcnt(1)
    s_barrier
    ds_read_b64_tr_b16 v[96:97], v111
    ds_read_b64_tr_b16 v[98:99], v111 offset:2560
    ds_read_b64_tr_b16 v[100:101], v112
    ds_read_b64_tr_b16 v[102:103], v112 offset:2560
    ds_read_b64_tr_b16 v[104:105], v113
    ds_read_b64_tr_b16 v[106:107], v113 offset:2560
    s_waitcnt lgkmcnt(4)
    buffer_store_dwordx4 v[96:99], v108, s[16:19], 0 offen sc1
    s_waitcnt lgkmcnt(2)
    buffer_store_dwordx4 v[100:103], v109, s[16:19], 0 offen sc1
    s_waitcnt lgkmcnt(0)
    buffer_store_dwordx4 v[104:107], v110, s[16:19], 0 offen sc1
    global_load_dword v7, v5, s[66:67] sc1
    v_fract_f32 v189, v189
    v_exp_f32 v182, v182
    v_exp_f32 v183, v254
    v_exp_f32 v184, v184
    v_cos_f32 v186, v185
    v_sin_f32 v187, v185
    v_cos_f32 v180, v188
    v_sin_f32 v181, v188
    v_cos_f32 v190, v189
    v_sin_f32 v191, v189
    v_lshlrev_b32 v192, 16, v234
    v_lshlrev_b32 v193, 16, v235
    v_add_f32 v199, v253, v253
    v_mul_f32 v192, v192, v199
    v_mul_f32 v193, v193, v199
    v_mul_f32 v186, v186, v182
    v_mul_f32 v187, v187, v182
    v_mul_f32 v180, v180, v183
    v_mul_f32 v181, v181, v183
    v_mul_f32 v190, v190, v184
    v_mul_f32 v191, v191, v184
    v_mov_b32 v242, 0x3f80
    v_cvt_pk_bf16_f32 v243, v186, v187
    v_pk_mul_f32 v[194:195], v[186:187], v[186:187] op_sel:[0,0] op_sel_hi:[0,1]
    v_pk_fma_f32 v[172:173], v[186:187], v[186:187], v[194:195] op_sel:[1,1,0] op_sel_hi:[1,0,1] neg_lo:[0,1,0]
    v_cvt_pk_bf16_f32 v244, v172, v173
    v_pk_mul_f32 v[194:195], v[172:173], v[186:187] op_sel:[0,0] op_sel_hi:[0,1]
    v_pk_fma_f32 v[174:175], v[172:173], v[186:187], v[194:195] op_sel:[1,1,0] op_sel_hi:[1,0,1] neg_lo:[0,1,0]
    v_cvt_pk_bf16_f32 v245, v174, v175
    v_pk_mul_f32 v[194:195], v[174:175], v[186:187] op_sel:[0,0] op_sel_hi:[0,1]
    v_pk_fma_f32 v[172:173], v[174:175], v[186:187], v[194:195] op_sel:[1,1,0] op_sel_hi:[1,0,1] neg_lo:[0,1,0]
    v_cvt_pk_bf16_f32 v246, v172, v173
    v_pk_mul_f32 v[194:195], v[172:173], v[186:187] op_sel:[0,0] op_sel_hi:[0,1]
    v_pk_fma_f32 v[174:175], v[172:173], v[186:187], v[194:195] op_sel:[1,1,0] op_sel_hi:[1,0,1] neg_lo:[0,1,0]
    v_cvt_pk_bf16_f32 v247, v174, v175
    v_pk_mul_f32 v[194:195], v[174:175], v[186:187] op_sel:[0,0] op_sel_hi:[0,1]
    v_pk_fma_f32 v[172:173], v[174:175], v[186:187], v[194:195] op_sel:[1,1,0] op_sel_hi:[1,0,1] neg_lo:[0,1,0]
    v_cvt_pk_bf16_f32 v248, v172, v173
    v_pk_mul_f32 v[194:195], v[172:173], v[186:187] op_sel:[0,0] op_sel_hi:[0,1]
    v_pk_fma_f32 v[174:175], v[172:173], v[186:187], v[194:195] op_sel:[1,1,0] op_sel_hi:[1,0,1] neg_lo:[0,1,0]
    s_min_u32 s96, s75, 159
    s_lshl_b32 s96, s96, 2
    s_add_u32 s96, s96, s24
    s_mul_i32 s97, s96, 384
    s_lshl_b32 s96, s96, 1
    v_lshl_add_u32 v2, v1, 1, s97
    v_mov_b32 v241, s96
    global_load_ushort v236, v2, s[52:53] offset:256
    global_load_ushort v237, v2, s[54:55] offset:256
    global_load_ushort v238, v2, s[56:57] offset:256
    global_load_ushort v239, v2, s[58:59] offset:256
    global_load_ushort v241, v241, s[62:63]
    v_cvt_pk_bf16_f32 v249, v174, v175
    v_pk_mul_f32 v[194:195], v[174:175], v[186:187] op_sel:[0,0] op_sel_hi:[0,1]
    v_pk_fma_f32 v[172:173], v[174:175], v[186:187], v[194:195] op_sel:[1,1,0] op_sel_hi:[1,0,1] neg_lo:[0,1,0]
    v_cvt_pk_bf16_f32 v250, v172, v173
    v_pk_mul_f32 v[194:195], v[172:173], v[186:187] op_sel:[0,0] op_sel_hi:[0,1]
    v_pk_fma_f32 v[174:175], v[172:173], v[186:187], v[194:195] op_sel:[1,1,0] op_sel_hi:[1,0,1] neg_lo:[0,1,0]
    v_cvt_pk_bf16_f32 v251, v174, v175
    ds_write_addtid_b32 v242 offset:0
    ds_write_addtid_b32 v243 offset:272
    ds_write_addtid_b32 v244 offset:544
    ds_write_addtid_b32 v245 offset:816
    ds_write_addtid_b32 v246 offset:1088
    ds_write_addtid_b32 v247 offset:1360
    ds_write_addtid_b32 v248 offset:1632
    ds_write_addtid_b32 v249 offset:1904
    ds_write_addtid_b32 v250 offset:2176
    ds_write_addtid_b32 v251 offset:2448
    v_pk_mul_f32 v[194:195], v[174:175], v[186:187] op_sel:[0,0] op_sel_hi:[0,1]
    v_pk_fma_f32 v[172:173], v[174:175], v[186:187], v[194:195] op_sel:[1,1,0] op_sel_hi:[1,0,1] neg_lo:[0,1,0]
    v_cvt_pk_bf16_f32 v242, v172, v173
    v_pk_mul_f32 v[194:195], v[172:173], v[186:187] op_sel:[0,0] op_sel_hi:[0,1]
    v_pk_fma_f32 v[174:175], v[172:173], v[186:187], v[194:195] op_sel:[1,1,0] op_sel_hi:[1,0,1] neg_lo:[0,1,0]
    v_cvt_pk_bf16_f32 v243, v174, v175
    v_pk_mul_f32 v[194:195], v[174:175], v[186:187] op_sel:[0,0] op_sel_hi:[0,1]
    v_pk_fma_f32 v[172:173], v[174:175], v[186:187], v[194:195] op_sel:[1,1,0] op_sel_hi:[1,0,1] neg_lo:[0,1,0]
    v_cvt_pk_bf16_f32 v244, v172, v173
    v_pk_mul_f32 v[194:195], v[172:173], v[186:187] op_sel:[0,0] op_sel_hi:[0,1]
    v_pk_fma_f32 v[174:175], v[172:173], v[186:187], v[194:195] op_sel:[1,1,0] op_sel_hi:[1,0,1] neg_lo:[0,1,0]
    v_cvt_pk_bf16_f32 v245, v174, v175
    v_pk_mul_f32 v[194:195], v[174:175], v[186:187] op_sel:[0,0] op_sel_hi:[0,1]
    v_pk_fma_f32 v[172:173], v[174:175], v[186:187], v[194:195] op_sel:[1,1,0] op_sel_hi:[1,0,1] neg_lo:[0,1,0]
    v_cvt_pk_bf16_f32 v246, v172, v173
    v_pk_mul_f32 v[194:195], v[172:173], v[186:187] op_sel:[0,0] op_sel_hi:[0,1]
    v_pk_fma_f32 v[174:175], v[172:173], v[186:187], v[194:195] op_sel:[1,1,0] op_sel_hi:[1,0,1] neg_lo:[0,1,0]
    v_cvt_pk_bf16_f32 v247, v174, v175
    v_pk_mul_f32 v[194:195], v[174:175], v[186:187] op_sel:[0,0] op_sel_hi:[0,1]
    v_pk_fma_f32 v[172:173], v[174:175], v[186:187], v[194:195] op_sel:[1,1,0] op_sel_hi:[1,0,1] neg_lo:[0,1,0]
    v_cvt_pk_bf16_f32 v248, v172, v173
    v_pk_mul_f32 v[194:195], v[172:173], v[186:187] op_sel:[0,0] op_sel_hi:[0,1]
    v_pk_fma_f32 v[174:175], v[172:173], v[186:187], v[194:195] op_sel:[1,1,0] op_sel_hi:[1,0,1] neg_lo:[0,1,0]
    v_lshrrev_b32 v132, 5, v0
    v_and_b32 v133, 31, v0
    v_mul_u32_u24 v132, 1280, v132
    v_lshl_add_u32 v134, v133, 4, v132
    v_mov_b32 v135, 1073741824
    v_cmp_gt_u32 vcc, 16, v133
    s_mul_i32 s96, s2, 10240
    buffer_load_dwordx4 v[120:123], v134, s[4:7], s96 offen
    v_cndmask_b32_e64 v135, v135, v134, vcc
    buffer_load_dwordx4 v[124:127], v134, s[4:7], s96 offen offset:512
    buffer_load_dwordx4 v[128:131], v135, s[4:7], s96 offen offset:1024
    v_cvt_pk_bf16_f32 v249, v174, v175
    v_pk_mul_f32 v[194:195], v[174:175], v[186:187] op_sel:[0,0] op_sel_hi:[0,1]
    v_pk_fma_f32 v[172:173], v[174:175], v[186:187], v[194:195] op_sel:[1,1,0] op_sel_hi:[1,0,1] neg_lo:[0,1,0]
    v_cvt_pk_bf16_f32 v250, v172, v173
    v_pk_mul_f32 v[194:195], v[172:173], v[186:187] op_sel:[0,0] op_sel_hi:[0,1]
    v_pk_fma_f32 v[174:175], v[172:173], v[186:187], v[194:195] op_sel:[1,1,0] op_sel_hi:[1,0,1] neg_lo:[0,1,0]
    v_cvt_pk_bf16_f32 v251, v174, v175
    ds_write_addtid_b32 v242 offset:2720
    ds_write_addtid_b32 v243 offset:2992
    ds_write_addtid_b32 v244 offset:3264
    ds_write_addtid_b32 v245 offset:3536
    ds_write_addtid_b32 v246 offset:3808
    ds_write_addtid_b32 v247 offset:4080
    ds_write_addtid_b32 v248 offset:4352
    ds_write_addtid_b32 v249 offset:4624
    ds_write_addtid_b32 v250 offset:4896
    ds_write_addtid_b32 v251 offset:5168
    v_pk_mul_f32 v[194:195], v[174:175], v[186:187] op_sel:[0,0] op_sel_hi:[0,1]
    v_pk_fma_f32 v[172:173], v[174:175], v[186:187], v[194:195] op_sel:[1,1,0] op_sel_hi:[1,0,1] neg_lo:[0,1,0]
    v_cvt_pk_bf16_f32 v242, v172, v173
    v_pk_mul_f32 v[194:195], v[172:173], v[186:187] op_sel:[0,0] op_sel_hi:[0,1]
    v_pk_fma_f32 v[174:175], v[172:173], v[186:187], v[194:195] op_sel:[1,1,0] op_sel_hi:[1,0,1] neg_lo:[0,1,0]
    v_cvt_pk_bf16_f32 v243, v174, v175
    v_pk_mul_f32 v[194:195], v[174:175], v[186:187] op_sel:[0,0] op_sel_hi:[0,1]
    v_pk_fma_f32 v[172:173], v[174:175], v[186:187], v[194:195] op_sel:[1,1,0] op_sel_hi:[1,0,1] neg_lo:[0,1,0]
    v_cvt_pk_bf16_f32 v244, v172, v173
    v_pk_mul_f32 v[194:195], v[172:173], v[186:187] op_sel:[0,0] op_sel_hi:[0,1]
    v_pk_fma_f32 v[174:175], v[172:173], v[186:187], v[194:195] op_sel:[1,1,0] op_sel_hi:[1,0,1] neg_lo:[0,1,0]
    v_cvt_pk_bf16_f32 v245, v174, v175
    v_pk_mul_f32 v[194:195], v[174:175], v[186:187] op_sel:[0,0] op_sel_hi:[0,1]
    v_pk_fma_f32 v[172:173], v[174:175], v[186:187], v[194:195] op_sel:[1,1,0] op_sel_hi:[1,0,1] neg_lo:[0,1,0]
    v_cvt_pk_bf16_f32 v246, v172, v173
    v_pk_mul_f32 v[194:195], v[172:173], v[186:187] op_sel:[0,0] op_sel_hi:[0,1]
    v_pk_fma_f32 v[174:175], v[172:173], v[186:187], v[194:195] op_sel:[1,1,0] op_sel_hi:[1,0,1] neg_lo:[0,1,0]
    v_cvt_pk_bf16_f32 v247, v174, v175
    v_pk_mul_f32 v[194:195], v[174:175], v[186:187] op_sel:[0,0] op_sel_hi:[0,1]
    v_pk_fma_f32 v[172:173], v[174:175], v[186:187], v[194:195] op_sel:[1,1,0] op_sel_hi:[1,0,1] neg_lo:[0,1,0]
    v_cvt_pk_bf16_f32 v248, v172, v173
    v_pk_mul_f32 v[194:195], v[172:173], v[186:187] op_sel:[0,0] op_sel_hi:[0,1]
    v_pk_fma_f32 v[174:175], v[172:173], v[186:187], v[194:195] op_sel:[1,1,0] op_sel_hi:[1,0,1] neg_lo:[0,1,0]
    v_mov_b32 v140, 1073741824
    v_lshlrev_b32 v141, 2, v0
    v_cmp_gt_u32 vcc, 64, v0
    s_nop 1
    v_cndmask_b32 v141, v140, v141, vcc
    v_mov_b32_e64 v140, 0
    s_lshl_b32 s97, s2, 8
    s_add_u32 s97, s97, 3473408
    buffer_store_dword v140, v141, s[16:19], s97 offen sc1
    v_cvt_pk_bf16_f32 v249, v174, v175
    v_pk_mul_f32 v[194:195], v[174:175], v[186:187] op_sel:[0,0] op_sel_hi:[0,1]
    v_pk_fma_f32 v[172:173], v[174:175], v[186:187], v[194:195] op_sel:[1,1,0] op_sel_hi:[1,0,1] neg_lo:[0,1,0]
    v_cvt_pk_bf16_f32 v250, v172, v173
    v_pk_mul_f32 v[194:195], v[172:173], v[186:187] op_sel:[0,0] op_sel_hi:[0,1]
    v_pk_fma_f32 v[174:175], v[172:173], v[186:187], v[194:195] op_sel:[1,1,0] op_sel_hi:[1,0,1] neg_lo:[0,1,0]
    v_cvt_pk_bf16_f32 v251, v174, v175
    ds_write_addtid_b32 v242 offset:5440
    ds_write_addtid_b32 v243 offset:5712
    ds_write_addtid_b32 v244 offset:5984
    ds_write_addtid_b32 v245 offset:6256
    ds_write_addtid_b32 v246 offset:6528
    ds_write_addtid_b32 v247 offset:6800
    ds_write_addtid_b32 v248 offset:7072
    ds_write_addtid_b32 v249 offset:7344
    ds_write_addtid_b32 v250 offset:7616
    ds_write_addtid_b32 v251 offset:7888
    v_pk_mul_f32 v[194:195], v[174:175], v[186:187] op_sel:[0,0] op_sel_hi:[0,1]
    v_pk_fma_f32 v[172:173], v[174:175], v[186:187], v[194:195] op_sel:[1,1,0] op_sel_hi:[1,0,1] neg_lo:[0,1,0]
    v_cvt_pk_bf16_f32 v242, v172, v173
    v_pk_mul_f32 v[194:195], v[172:173], v[186:187] op_sel:[0,0] op_sel_hi:[0,1]
    v_pk_fma_f32 v[174:175], v[172:173], v[186:187], v[194:195] op_sel:[1,1,0] op_sel_hi:[1,0,1] neg_lo:[0,1,0]
    v_cvt_pk_bf16_f32 v243, v174, v175
    ds_write_addtid_b32 v242 offset:8160
    ds_write_addtid_b32 v243 offset:8432
    ds_read_b128 a[160:163], v252 offset:0
    ds_read_b128 a[164:167], v252 offset:32
    ds_read_b128 a[168:171], v252 offset:64
    ds_read_b128 a[172:175], v252 offset:96
    ds_read_b128 a[176:179], v252 offset:128
    ds_read_b128 a[180:183], v252 offset:160
    ds_read_b128 a[184:187], v252 offset:192
    ds_read_b128 a[188:191], v252 offset:224
    v_pk_mul_f32 v[194:195], v[180:181], v[180:181] op_sel:[0,0] op_sel_hi:[0,1]
    v_pk_fma_f32 v[182:183], v[180:181], v[180:181], v[194:195] op_sel:[1,1,0] op_sel_hi:[1,0,1] neg_lo:[0,1,0]
    v_pk_mul_f32 v[194:195], v[182:183], v[182:183] op_sel:[0,0] op_sel_hi:[0,1]
    v_pk_fma_f32 v[184:185], v[182:183], v[182:183], v[194:195] op_sel:[1,1,0] op_sel_hi:[1,0,1] neg_lo:[0,1,0]
    v_cvt_pk_bf16_f32 v242, v192, -v193
    v_pk_mul_f32 v[194:195], v[192:193], v[180:181] op_sel:[0,0] op_sel_hi:[0,1]
    v_pk_fma_f32 v[174:175], v[192:193], v[180:181], v[194:195] op_sel:[1,1,0] op_sel_hi:[1,0,1] neg_lo:[0,1,0]
    v_mov_b32 v142, 1073741824
    v_lshlrev_b32 v143, 2, v0
    v_cmp_gt_u32 vcc, 16, v0
    s_nop 1
    v_cndmask_b32 v143, v142, v143, vcc
    v_mov_b32_e64 v142, -1
    s_lshl_b32 s97, s2, 6
    s_add_u32 s97, s97, 3457024
    buffer_store_dword v142, v143, s[16:19], s97 offen sc1
    v_cvt_pk_bf16_f32 v243, v174, -v175
    v_pk_mul_f32 v[194:195], v[174:175], v[180:181] op_sel:[0,0] op_sel_hi:[0,1]
    v_pk_fma_f32 v[172:173], v[174:175], v[180:181], v[194:195] op_sel:[1,1,0] op_sel_hi:[1,0,1] neg_lo:[0,1,0]
    v_cvt_pk_bf16_f32 v244, v172, -v173
    v_pk_mul_f32 v[194:195], v[172:173], v[180:181] op_sel:[0,0] op_sel_hi:[0,1]
    v_pk_fma_f32 v[174:175], v[172:173], v[180:181], v[194:195] op_sel:[1,1,0] op_sel_hi:[1,0,1] neg_lo:[0,1,0]
    v_cvt_pk_bf16_f32 v245, v174, -v175
    v_pk_mul_f32 v[194:195], v[174:175], v[180:181] op_sel:[0,0] op_sel_hi:[0,1]
    v_pk_fma_f32 v[172:173], v[174:175], v[180:181], v[194:195] op_sel:[1,1,0] op_sel_hi:[1,0,1] neg_lo:[0,1,0]
    v_cvt_pk_bf16_f32 v246, v172, -v173
    v_pk_mul_f32 v[194:195], v[172:173], v[180:181] op_sel:[0,0] op_sel_hi:[0,1]
    v_pk_fma_f32 v[174:175], v[172:173], v[180:181], v[194:195] op_sel:[1,1,0] op_sel_hi:[1,0,1] neg_lo:[0,1,0]
    v_cvt_pk_bf16_f32 v247, v174, -v175
    v_pk_mul_f32 v[194:195], v[174:175], v[180:181] op_sel:[0,0] op_sel_hi:[0,1]
    v_pk_fma_f32 v[172:173], v[174:175], v[180:181], v[194:195] op_sel:[1,1,0] op_sel_hi:[1,0,1] neg_lo:[0,1,0]
    v_cvt_pk_bf16_f32 v248, v172, -v173
    v_pk_mul_f32 v[194:195], v[172:173], v[180:181] op_sel:[0,0] op_sel_hi:[0,1]
    v_pk_fma_f32 v[174:175], v[172:173], v[180:181], v[194:195] op_sel:[1,1,0] op_sel_hi:[1,0,1] neg_lo:[0,1,0]
    v_cvt_pk_bf16_f32 v249, v174, -v175
    v_pk_mul_f32 v[194:195], v[192:193], v[190:191] op_sel:[0,0] op_sel_hi:[0,1]
    v_pk_fma_f32 v[176:177], v[192:193], v[190:191], v[194:195] op_sel:[1,1,0] op_sel_hi:[1,0,1] neg_lo:[0,1,0]
    v_cvt_pk_bf16_f32 v250, v176, -v177
    v_pk_mul_f32 v[194:195], v[176:177], v[182:183] op_sel:[0,0] op_sel_hi:[0,1]
    v_pk_fma_f32 v[174:175], v[176:177], v[182:183], v[194:195] op_sel:[1,1,0] op_sel_hi:[1,0,1] neg_lo:[0,1,0]
    v_cvt_pk_bf16_f32 v251, v174, -v175
    ds_write_addtid_b32 v242 offset:0
    ds_write_addtid_b32 v243 offset:272
    ds_write_addtid_b32 v244 offset:544
    ds_write_addtid_b32 v245 offset:816
    ds_write_addtid_b32 v246 offset:1088
    ds_write_addtid_b32 v247 offset:1360
    ds_write_addtid_b32 v248 offset:1632
    ds_write_addtid_b32 v249 offset:1904
    ds_write_addtid_b32 v250 offset:2176
    ds_write_addtid_b32 v251 offset:2448
    v_pk_mul_f32 v[194:195], v[174:175], v[182:183] op_sel:[0,0] op_sel_hi:[0,1]
    v_pk_fma_f32 v[172:173], v[174:175], v[182:183], v[194:195] op_sel:[1,1,0] op_sel_hi:[1,0,1] neg_lo:[0,1,0]
    v_cvt_pk_bf16_f32 v242, v172, -v173
    v_pk_mul_f32 v[194:195], v[172:173], v[182:183] op_sel:[0,0] op_sel_hi:[0,1]
    v_pk_fma_f32 v[174:175], v[172:173], v[182:183], v[194:195] op_sel:[1,1,0] op_sel_hi:[1,0,1] neg_lo:[0,1,0]
    s_waitcnt vmcnt(11)
    s_waitcnt vmcnt(10)
    v_cmp_gt_u32 vcc, 1, v7
    s_nop 0
    s_and_b64 vcc, vcc, s[50:51]
    s_and_b64 vcc, vcc, 1
    s_cbranch_scc1 ps_5
pc_7:
    s_barrier
    v_lshlrev_b32 v2, 3, v4
    v_mov_b32 v5, 1
    v_cndmask_b32 v2, v4, v2, s[50:51]
    buffer_atomic_add v5, v2, s[16:19], s86 offen offset:0 sc1
    v_cvt_pk_bf16_f32 v243, v174, -v175
    v_pk_mul_f32 v[194:195], v[174:175], v[182:183] op_sel:[0,0] op_sel_hi:[0,1]
    v_pk_fma_f32 v[172:173], v[174:175], v[182:183], v[194:195] op_sel:[1,1,0] op_sel_hi:[1,0,1] neg_lo:[0,1,0]
    v_cvt_pk_bf16_f32 v244, v172, -v173
    v_pk_mul_f32 v[194:195], v[176:177], v[190:191] op_sel:[0,0] op_sel_hi:[0,1]
    v_pk_fma_f32 v[178:179], v[176:177], v[190:191], v[194:195] op_sel:[1,1,0] op_sel_hi:[1,0,1] neg_lo:[0,1,0]
    v_cvt_pk_bf16_f32 v245, v178, -v179
    v_pk_mul_f32 v[194:195], v[178:179], v[184:185] op_sel:[0,0] op_sel_hi:[0,1]
    v_pk_fma_f32 v[174:175], v[178:179], v[184:185], v[194:195] op_sel:[1,1,0] op_sel_hi:[1,0,1] neg_lo:[0,1,0]
    v_cvt_pk_bf16_f32 v246, v174, -v175
    v_pk_mul_f32 v[194:195], v[174:175], v[184:185] op_sel:[0,0] op_sel_hi:[0,1]
    v_pk_fma_f32 v[172:173], v[174:175], v[184:185], v[194:195] op_sel:[1,1,0] op_sel_hi:[1,0,1] neg_lo:[0,1,0]
    v_cvt_pk_bf16_f32 v247, v172, -v173
    v_pk_mul_f32 v[194:195], v[178:179], v[190:191] op_sel:[0,0] op_sel_hi:[0,1]
    v_pk_fma_f32 v[176:177], v[178:179], v[190:191], v[194:195] op_sel:[1,1,0] op_sel_hi:[1,0,1] neg_lo:[0,1,0]
    v_cvt_pk_bf16_f32 v248, v176, -v177
    v_pk_mul_f32 v[194:195], v[176:177], v[184:185] op_sel:[0,0] op_sel_hi:[0,1]
    v_pk_fma_f32 v[174:175], v[176:177], v[184:185], v[194:195] op_sel:[1,1,0] op_sel_hi:[1,0,1] neg_lo:[0,1,0]
    v_cvt_pk_bf16_f32 v249, v174, -v175
    v_pk_mul_f32 v[194:195], v[174:175], v[184:185] op_sel:[0,0] op_sel_hi:[0,1]
    v_pk_fma_f32 v[172:173], v[174:175], v[184:185], v[194:195] op_sel:[1,1,0] op_sel_hi:[1,0,1] neg_lo:[0,1,0]
    v_cvt_pk_bf16_f32 v250, v172, -v173
    v_pk_mul_f32 v[194:195], v[176:177], v[190:191] op_sel:[0,0] op_sel_hi:[0,1]
    v_pk_fma_f32 v[178:179], v[176:177], v[190:191], v[194:195] op_sel:[1,1,0] op_sel_hi:[1,0,1] neg_lo:[0,1,0]
    v_cvt_pk_bf16_f32 v251, v178, -v179
    ds_write_addtid_b32 v242 offset:2720
    ds_write_addtid_b32 v242 offset:3264
    ds_write_addtid_b32 v243 offset:3536
    ds_write_addtid_b32 v244 offset:3808
    ds_write_addtid_b32 v245 offset:4352
    ds_write_addtid_b32 v246 offset:4624
    ds_write_addtid_b32 v247 offset:4896
    ds_write_addtid_b32 v248 offset:5440
    ds_write_addtid_b32 v249 offset:5712
    ds_write_addtid_b32 v250 offset:5984
    v_mov_b32 v144, -1
    v_mov_b32 v145, -1
    v_mov_b32 v146, -1
    v_mov_b32 v147, -1
    v_lshlrev_b32 v148, 4, v0
    s_sub_u32 s88, s2, 0
    s_mul_i32 s88, s88, 20480
    s_min_u32 s88, s88, 5222400
    s_add_u32 s88, s88, 4194304
    buffer_store_dwordx4 v[144:147], v148, s[16:19], s88 offen sc1
    ds_write_addtid_b32 v251 offset:6528
    v_pk_mul_f32 v[194:195], v[178:179], v[186:187] op_sel:[0,0] op_sel_hi:[0,1]
    v_pk_fma_f32 v[174:175], v[178:179], v[186:187], v[194:195] op_sel:[1,1,0] op_sel_hi:[1,0,1] neg_lo:[0,1,0]
    v_cvt_pk_bf16_f32 v242, v174, -v175
    v_pk_mul_f32 v[194:195], v[178:179], v[190:191] op_sel:[0,0] op_sel_hi:[0,1]
    v_pk_fma_f32 v[176:177], v[178:179], v[190:191], v[194:195] op_sel:[1,1,0] op_sel_hi:[1,0,1] neg_lo:[0,1,0]
    v_cvt_pk_bf16_f32 v243, v176, -v177
    v_pk_mul_f32 v[194:195], v[176:177], v[186:187] op_sel:[0,0] op_sel_hi:[0,1]
    v_pk_fma_f32 v[174:175], v[176:177], v[186:187], v[194:195] op_sel:[1,1,0] op_sel_hi:[1,0,1] neg_lo:[0,1,0]
    v_cvt_pk_bf16_f32 v244, v174, -v175
    v_pk_mul_f32 v[194:195], v[176:177], v[190:191] op_sel:[0,0] op_sel_hi:[0,1]
    v_pk_fma_f32 v[178:179], v[176:177], v[190:191], v[194:195] op_sel:[1,1,0] op_sel_hi:[1,0,1] neg_lo:[0,1,0]
    v_cvt_pk_bf16_f32 v245, v178, -v179
    v_pk_mul_f32 v[194:195], v[178:179], v[186:187] op_sel:[0,0] op_sel_hi:[0,1]
    v_pk_fma_f32 v[174:175], v[178:179], v[186:187], v[194:195] op_sel:[1,1,0] op_sel_hi:[1,0,1] neg_lo:[0,1,0]
    v_cvt_pk_bf16_f32 v246, v174, -v175
    v_pk_mul_f32 v[194:195], v[178:179], v[190:191] op_sel:[0,0] op_sel_hi:[0,1]
    v_pk_fma_f32 v[176:177], v[178:179], v[190:191], v[194:195] op_sel:[1,1,0] op_sel_hi:[1,0,1] neg_lo:[0,1,0]
    v_cvt_pk_bf16_f32 v247, v176, -v177
    v_pk_mul_f32 v[194:195], v[176:177], v[186:187] op_sel:[0,0] op_sel_hi:[0,1]
    v_pk_fma_f32 v[174:175], v[176:177], v[186:187], v[194:195] op_sel:[1,1,0] op_sel_hi:[1,0,1] neg_lo:[0,1,0]
    v_cvt_pk_bf16_f32 v248, v174, -v175
    ds_write_addtid_b32 v242 offset:6800
    ds_write_addtid_b32 v243 offset:7072
    ds_write_addtid_b32 v244 offset:7344
    ds_write_addtid_b32 v245 offset:7616
    ds_write_addtid_b32 v246 offset:7888
    ds_write_addtid_b32 v247 offset:8160
    ds_write_addtid_b32 v248 offset:8432
    ds_read_b128 a[192:195], v252 offset:0
    ds_read_b128 a[196:199], v252 offset:32
    ds_read_b128 a[200:203], v252 offset:64
    ds_read_b128 a[204:207], v252 offset:96
    ds_read_b128 a[208:211], v252 offset:128
    ds_read_b128 a[212:215], v252 offset:160
    s_add_u32 s88, s88, 4096
    buffer_store_dwordx4 v[144:147], v148, s[16:19], s88 offen sc1
    ds_read_b128 a[216:219], v252 offset:192
    ds_read_b128 a[220:223], v252 offset:224
    v_and_b32 v199, 0xffff0000, v232
    v_mul_f32 v199, 0x3fb8aa3b, v199
    v_exp_f32 v199, v199
    v_and_b32 v255, 0xffff0000, v233
    v_mul_f32 v255, v255, v253
    v_mul_f32 v255, 0x3e22f983, v255
    v_cvt_pk_bf16_f32 v199, v199, v199
    v_lshlrev_b32 v199, 16, v199
    v_mul_f32 v254, v199, v253
    v_mul_f32 v254, 0xbfb8aa3b, v254
    s_waitcnt lgkmcnt(7)
    v_mfma_f32_32x32x16_bf16 v[216:231], a[192:195], a[160:163], 0
    v_mul_f32 v182, 0x41000000, v254
    v_mul_f32 v185, 0x41000000, v255
    v_mul_f32 v184, 0x43800000, v254
    v_mul_f32 v189, 0x43800000, v255
    s_waitcnt lgkmcnt(6)
    v_mfma_f32_32x32x16_bf16 v[216:231], a[196:199], a[164:167], v[216:231]
    v_fract_f32 v185, v185
    v_fract_f32 v188, v255
    v_fract_f32 v189, v189
    v_exp_f32 v182, v182
    s_waitcnt lgkmcnt(5)
    v_mfma_f32_32x32x16_bf16 v[216:231], a[200:203], a[168:171], v[216:231]
    v_exp_f32 v183, v254
    v_exp_f32 v184, v184
    v_cos_f32 v186, v185
    v_sin_f32 v187, v185
    s_waitcnt lgkmcnt(4)
    v_mfma_f32_32x32x16_bf16 v[216:231], a[204:207], a[172:175], v[216:231]
    v_cos_f32 v180, v188
    v_sin_f32 v181, v188
    v_cos_f32 v190, v189
    v_sin_f32 v191, v189
    s_waitcnt lgkmcnt(3)
    v_mfma_f32_32x32x16_bf16 v[216:231], a[208:211], a[176:179], v[216:231]
    v_and_b32 v192, 0xffff0000, v234
    v_and_b32 v193, 0xffff0000, v235
    s_add_u32 s88, s88, 4096
    buffer_store_dwordx4 v[144:147], v148, s[16:19], s88 offen sc1
    v_add_f32 v199, v253, v253
    v_mul_f32 v192, v192, v199
    s_waitcnt lgkmcnt(2)
    v_mfma_f32_32x32x16_bf16 v[216:231], a[212:215], a[180:183], v[216:231]
    v_mul_f32 v193, v193, v199
    v_mul_f32 v186, v186, v182
    v_mul_f32 v187, v187, v182
    v_mul_f32 v180, v180, v183
    s_waitcnt lgkmcnt(1)
    v_mfma_f32_32x32x16_bf16 v[216:231], a[216:219], a[184:187], v[216:231]
    v_mul_f32 v181, v181, v183
    v_mul_f32 v190, v190, v184
    v_mul_f32 v191, v191, v184
    s_waitcnt lgkmcnt(0)
    v_mfma_f32_32x32x16_bf16 v[216:231], a[220:223], a[188:191], v[216:231]
    v_mov_b32 v242, 0x3f80
    v_cvt_pk_bf16_f32 v243, v186, v187
    v_pk_mul_f32 v[194:195], v[186:187], v[186:187] op_sel:[0,0] op_sel_hi:[0,1]
    v_pk_fma_f32 v[172:173], v[186:187], v[186:187], v[194:195] op_sel:[1,1,0] op_sel_hi:[1,0,1] neg_lo:[0,1,0]
    v_cvt_pk_bf16_f32 v244, v172, v173
    v_pk_mul_f32 v[194:195], v[172:173], v[186:187] op_sel:[0,0] op_sel_hi:[0,1]
    v_pk_fma_f32 v[174:175], v[172:173], v[186:187], v[194:195] op_sel:[1,1,0] op_sel_hi:[1,0,1] neg_lo:[0,1,0]
    v_cvt_pk_bf16_f32 v245, v174, v175
    v_pk_mul_f32 v[194:195], v[174:175], v[186:187] op_sel:[0,0] op_sel_hi:[0,1]
    v_pk_fma_f32 v[172:173], v[174:175], v[186:187], v[194:195] op_sel:[1,1,0] op_sel_hi:[1,0,1] neg_lo:[0,1,0]
    v_cvt_pk_bf16_f32 v246, v172, v173
    v_pk_mul_f32 v[194:195], v[172:173], v[186:187] op_sel:[0,0] op_sel_hi:[0,1]
    v_pk_fma_f32 v[174:175], v[172:173], v[186:187], v[194:195] op_sel:[1,1,0] op_sel_hi:[1,0,1] neg_lo:[0,1,0]
    v_cvt_pk_bf16_f32 v247, v174, v175
    v_pk_mul_f32 v[194:195], v[174:175], v[186:187] op_sel:[0,0] op_sel_hi:[0,1]
    v_pk_fma_f32 v[172:173], v[174:175], v[186:187], v[194:195] op_sel:[1,1,0] op_sel_hi:[1,0,1] neg_lo:[0,1,0]
    v_cvt_pk_bf16_f32 v248, v172, v173
    v_pk_mul_f32 v[194:195], v[172:173], v[186:187] op_sel:[0,0] op_sel_hi:[0,1]
    v_pk_fma_f32 v[174:175], v[172:173], v[186:187], v[194:195] op_sel:[1,1,0] op_sel_hi:[1,0,1] neg_lo:[0,1,0]
    v_cvt_pk_bf16_f32 v249, v174, v175
    v_pk_mul_f32 v[194:195], v[174:175], v[186:187] op_sel:[0,0] op_sel_hi:[0,1]
    v_pk_fma_f32 v[172:173], v[174:175], v[186:187], v[194:195] op_sel:[1,1,0] op_sel_hi:[1,0,1] neg_lo:[0,1,0]
    v_cvt_pk_bf16_f32 v250, v172, v173
    s_add_u32 s88, s88, 4096
    buffer_store_dwordx4 v[144:147], v148, s[16:19], s88 offen sc1
    v_pk_mul_f32 v[194:195], v[172:173], v[186:187] op_sel:[0,0] op_sel_hi:[0,1]
    v_pk_fma_f32 v[174:175], v[172:173], v[186:187], v[194:195] op_sel:[1,1,0] op_sel_hi:[1,0,1] neg_lo:[0,1,0]
    v_cvt_pk_bf16_f32 v251, v174, v175
    ds_write_addtid_b32 v242 offset:0
    ds_write_addtid_b32 v243 offset:272
    ds_write_addtid_b32 v244 offset:544
    ds_write_addtid_b32 v245 offset:816
    ds_write_addtid_b32 v246 offset:1088
    ds_write_addtid_b32 v247 offset:1360
    ds_write_addtid_b32 v248 offset:1632
    ds_write_addtid_b32 v249 offset:1904
    ds_write_addtid_b32 v250 offset:2176
    ds_write_addtid_b32 v251 offset:2448
    v_pk_mul_f32 v[194:195], v[174:175], v[186:187] op_sel:[0,0] op_sel_hi:[0,1]
    v_pk_fma_f32 v[172:173], v[174:175], v[186:187], v[194:195] op_sel:[1,1,0] op_sel_hi:[1,0,1] neg_lo:[0,1,0]
    v_cvt_pk_bf16_f32 v242, v172, v173
    v_pk_mul_f32 v[194:195], v[172:173], v[186:187] op_sel:[0,0] op_sel_hi:[0,1]
    v_pk_fma_f32 v[174:175], v[172:173], v[186:187], v[194:195] op_sel:[1,1,0] op_sel_hi:[1,0,1] neg_lo:[0,1,0]
    v_cvt_pk_bf16_f32 v243, v174, v175
    v_pk_mul_f32 v[194:195], v[174:175], v[186:187] op_sel:[0,0] op_sel_hi:[0,1]
    v_pk_fma_f32 v[172:173], v[174:175], v[186:187], v[194:195] op_sel:[1,1,0] op_sel_hi:[1,0,1] neg_lo:[0,1,0]
    v_cvt_pk_bf16_f32 v244, v172, v173
    v_pk_mul_f32 v[194:195], v[172:173], v[186:187] op_sel:[0,0] op_sel_hi:[0,1]
    v_pk_fma_f32 v[174:175], v[172:173], v[186:187], v[194:195] op_sel:[1,1,0] op_sel_hi:[1,0,1] neg_lo:[0,1,0]
    v_cvt_pk_bf16_f32 v245, v174, v175
    v_pk_mul_f32 v[194:195], v[174:175], v[186:187] op_sel:[0,0] op_sel_hi:[0,1]
    v_pk_fma_f32 v[172:173], v[174:175], v[186:187], v[194:195] op_sel:[1,1,0] op_sel_hi:[1,0,1] neg_lo:[0,1,0]
    v_cvt_pk_bf16_f32 v246, v172, v173
    v_pk_mul_f32 v[194:195], v[172:173], v[186:187] op_sel:[0,0] op_sel_hi:[0,1]
    v_pk_fma_f32 v[174:175], v[172:173], v[186:187], v[194:195] op_sel:[1,1,0] op_sel_hi:[1,0,1] neg_lo:[0,1,0]
    v_cvt_pk_bf16_f32 v247, v174, v175
    v_pk_mul_f32 v[194:195], v[174:175], v[186:187] op_sel:[0,0] op_sel_hi:[0,1]
    v_pk_fma_f32 v[172:173], v[174:175], v[186:187], v[194:195] op_sel:[1,1,0] op_sel_hi:[1,0,1] neg_lo:[0,1,0]
    v_cvt_pk_bf16_f32 v248, v172, v173
    v_pk_mul_f32 v[194:195], v[172:173], v[186:187] op_sel:[0,0] op_sel_hi:[0,1]
    s_add_u32 s88, s88, 4096
    buffer_store_dwordx4 v[144:147], v148, s[16:19], s88 offen sc1
    v_pk_fma_f32 v[174:175], v[172:173], v[186:187], v[194:195] op_sel:[1,1,0] op_sel_hi:[1,0,1] neg_lo:[0,1,0]
    v_cvt_pk_bf16_f32 v249, v174, v175
    v_pk_mul_f32 v[194:195], v[174:175], v[186:187] op_sel:[0,0] op_sel_hi:[0,1]
    v_pk_fma_f32 v[172:173], v[174:175], v[186:187], v[194:195] op_sel:[1,1,0] op_sel_hi:[1,0,1] neg_lo:[0,1,0]
    v_cvt_pk_bf16_f32 v250, v172, v173
    v_pk_mul_f32 v[194:195], v[172:173], v[186:187] op_sel:[0,0] op_sel_hi:[0,1]
    v_pk_fma_f32 v[174:175], v[172:173], v[186:187], v[194:195] op_sel:[1,1,0] op_sel_hi:[1,0,1] neg_lo:[0,1,0]
    v_cvt_pk_bf16_f32 v251, v174, v175
    ds_write_addtid_b32 v242 offset:2720
    ds_write_addtid_b32 v243 offset:2992
    ds_write_addtid_b32 v244 offset:3264
    ds_write_addtid_b32 v245 offset:3536
    ds_write_addtid_b32 v246 offset:3808
    ds_write_addtid_b32 v247 offset:4080
    ds_write_addtid_b32 v248 offset:4352
    ds_write_addtid_b32 v249 offset:4624
    ds_write_addtid_b32 v250 offset:4896
    ds_write_addtid_b32 v251 offset:5168
    v_pk_mul_f32 v[194:195], v[174:175], v[186:187] op_sel:[0,0] op_sel_hi:[0,1]
    v_pk_fma_f32 v[172:173], v[174:175], v[186:187], v[194:195] op_sel:[1,1,0] op_sel_hi:[1,0,1] neg_lo:[0,1,0]
    v_cvt_pk_bf16_f32 v242, v172, v173
    v_pk_mul_f32 v[194:195], v[172:173], v[186:187] op_sel:[0,0] op_sel_hi:[0,1]
    v_pk_fma_f32 v[174:175], v[172:173], v[186:187], v[194:195] op_sel:[1,1,0] op_sel_hi:[1,0,1] neg_lo:[0,1,0]
    v_cvt_pk_bf16_f32 v243, v174, v175
    v_pk_mul_f32 v[194:195], v[174:175], v[186:187] op_sel:[0,0] op_sel_hi:[0,1]
    v_pk_fma_f32 v[172:173], v[174:175], v[186:187], v[194:195] op_sel:[1,1,0] op_sel_hi:[1,0,1] neg_lo:[0,1,0]
    v_cvt_pk_bf16_f32 v244, v172, v173
    v_pk_mul_f32 v[194:195], v[172:173], v[186:187] op_sel:[0,0] op_sel_hi:[0,1]
    v_pk_fma_f32 v[174:175], v[172:173], v[186:187], v[194:195] op_sel:[1,1,0] op_sel_hi:[1,0,1] neg_lo:[0,1,0]
    v_cvt_pk_bf16_f32 v245, v174, v175
    v_pk_mul_f32 v[194:195], v[174:175], v[186:187] op_sel:[0,0] op_sel_hi:[0,1]
    v_pk_fma_f32 v[172:173], v[174:175], v[186:187], v[194:195] op_sel:[1,1,0] op_sel_hi:[1,0,1] neg_lo:[0,1,0]
    v_cvt_pk_bf16_f32 v246, v172, v173
    v_pk_mul_f32 v[194:195], v[172:173], v[186:187] op_sel:[0,0] op_sel_hi:[0,1]
    v_pk_fma_f32 v[174:175], v[172:173], v[186:187], v[194:195] op_sel:[1,1,0] op_sel_hi:[1,0,1] neg_lo:[0,1,0]
    v_mov_b32 v134, 0x3f803f80
    v_mov_b32 v132, 0
    v_mov_b32 v133, 0
    s_waitcnt vmcnt(10)
    v_dot2c_f32_bf16 v132, v120, v134
    v_dot2c_f32_bf16 v133, v120, v120
    v_dot2c_f32_bf16 v132, v121, v134
    v_dot2c_f32_bf16 v133, v121, v121
    v_dot2c_f32_bf16 v132, v122, v134
    v_dot2c_f32_bf16 v133, v122, v122
    v_dot2c_f32_bf16 v132, v123, v134
    v_dot2c_f32_bf16 v133, v123, v123
    s_waitcnt vmcnt(9)
    v_dot2c_f32_bf16 v132, v124, v134
    v_dot2c_f32_bf16 v133, v124, v124
    v_dot2c_f32_bf16 v132, v125, v134
    v_dot2c_f32_bf16 v133, v125, v125
    v_dot2c_f32_bf16 v132, v126, v134
    v_dot2c_f32_bf16 v133, v126, v126
    v_dot2c_f32_bf16 v132, v127, v134
    v_dot2c_f32_bf16 v133, v127, v127
    s_waitcnt vmcnt(8)
    v_dot2c_f32_bf16 v132, v128, v134
    v_dot2c_f32_bf16 v133, v128, v128
    v_dot2c_f32_bf16 v132, v129, v134
    v_dot2c_f32_bf16 v133, v129, v129
    v_dot2c_f32_bf16 v132, v130, v134
    v_dot2c_f32_bf16 v133, v130, v130
    v_dot2c_f32_bf16 v132, v131, v134
    v_dot2c_f32_bf16 v133, v131, v131
    v_lshrrev_b32 v135, 5, v0
    v_and_b32 v121, 3, v135
    v_lshrrev_b32 v135, 2, v135
    v_add_f32_dpp v132, v132, v132 row_shr:1 row_mask:0xf bank_mask:0xf bound_ctrl:0
    v_add_f32_dpp v133, v133, v133 row_shr:1 row_mask:0xf bank_mask:0xf bound_ctrl:0
    v_lshlrev_b32_e64 v135, 3, v135
    v_add_f32_dpp v132, v132, v132 row_shr:2 row_mask:0xf bank_mask:0xf bound_ctrl:0
    v_add_f32_dpp v133, v133, v133 row_shr:2 row_mask:0xf bank_mask:0xf bound_ctrl:0
    v_lshl_add_u32 v135, v121, 12, v135
    v_add_f32_dpp v132, v132, v132 row_shr:4 row_mask:0xf bank_mask:0xf bound_ctrl:0
    v_add_f32_dpp v133, v133, v133 row_shr:4 row_mask:0xf bank_mask:0xf bound_ctrl:0
    v_and_b32_e64 v121, 31, v0
    v_add_f32_dpp v132, v132, v132 row_shr:8 row_mask:0xf bank_mask:0xf bound_ctrl:0
    v_add_f32_dpp v133, v133, v133 row_shr:8 row_mask:0xf bank_mask:0xf bound_ctrl:0
    v_cmp_eq_u32_e64 vcc, 31, v121
    v_add_f32_dpp v132, v132, v132 row_bcast:15 row_mask:0xa bank_mask:0xf
    v_add_f32_dpp v133, v133, v133 row_bcast:15 row_mask:0xa bank_mask:0xf
    v_mov_b32 v121, 1073741824
    v_cndmask_b32_e64 v120, v121, v135, vcc
    s_lshl_b32 s96, s2, 4
    s_add_u32 s96, s96, 3440640
    v_mul_f32 v135, 0x3acccccd, v132
    v_mul_f32 v133, 0x3acccccd, v133
    v_fma_f32 v133, -v135, v135, v133
    v_max_f32 v133, 0, v133
    v_add_f32 v133, 0x3727c5ac, v133
    v_rsq_f32_e64 v132, v133
    s_nop 0
    v_mul_f32 v133, -v135, v132
    buffer_store_dwordx2 v[132:133], v120, s[16:19], s96 offen sc1
    v_cvt_pk_bf16_f32 v247, v174, v175
    v_pk_mul_f32 v[194:195], v[174:175], v[186:187] op_sel:[0,0] op_sel_hi:[0,1]
    v_pk_fma_f32 v[172:173], v[174:175], v[186:187], v[194:195] op_sel:[1,1,0] op_sel_hi:[1,0,1] neg_lo:[0,1,0]
    v_cvt_pk_bf16_f32 v248, v172, v173
    v_pk_mul_f32 v[194:195], v[172:173], v[186:187] op_sel:[0,0] op_sel_hi:[0,1]
    v_pk_fma_f32 v[174:175], v[172:173], v[186:187], v[194:195] op_sel:[1,1,0] op_sel_hi:[1,0,1] neg_lo:[0,1,0]
    v_cvt_pk_bf16_f32 v249, v174, v175
    v_pk_mul_f32 v[194:195], v[174:175], v[186:187] op_sel:[0,0] op_sel_hi:[0,1]
    v_pk_fma_f32 v[172:173], v[174:175], v[186:187], v[194:195] op_sel:[1,1,0] op_sel_hi:[1,0,1] neg_lo:[0,1,0]
    v_cvt_pk_bf16_f32 v250, v172, v173
    v_pk_mul_f32 v[194:195], v[172:173], v[186:187] op_sel:[0,0] op_sel_hi:[0,1]
    v_pk_fma_f32 v[174:175], v[172:173], v[186:187], v[194:195] op_sel:[1,1,0] op_sel_hi:[1,0,1] neg_lo:[0,1,0]
    v_cvt_pk_bf16_f32 v251, v174, v175
    ds_write_addtid_b32 v242 offset:5440
    ds_write_addtid_b32 v243 offset:5712
    ds_write_addtid_b32 v244 offset:5984
    ds_write_addtid_b32 v245 offset:6256
    ds_write_addtid_b32 v246 offset:6528
    ds_write_addtid_b32 v247 offset:6800
    ds_write_addtid_b32 v248 offset:7072
    ds_write_addtid_b32 v249 offset:7344
    ds_write_addtid_b32 v250 offset:7616
    ds_write_addtid_b32 v251 offset:7888
    v_pk_mul_f32 v[194:195], v[174:175], v[186:187] op_sel:[0,0] op_sel_hi:[0,1]
    v_pk_fma_f32 v[172:173], v[174:175], v[186:187], v[194:195] op_sel:[1,1,0] op_sel_hi:[1,0,1] neg_lo:[0,1,0]
    v_cvt_pk_bf16_f32 v242, v172, v173
    v_pk_mul_f32 v[194:195], v[172:173], v[186:187] op_sel:[0,0] op_sel_hi:[0,1]
    v_pk_fma_f32 v[174:175], v[172:173], v[186:187], v[194:195] op_sel:[1,1,0] op_sel_hi:[1,0,1] neg_lo:[0,1,0]
    v_cvt_pk_bf16_f32 v243, v174, v175
    ds_write_addtid_b32 v242 offset:8160
    ds_write_addtid_b32 v243 offset:8432
    ds_read_b128 a[160:163], v252 offset:0
    ds_read_b128 a[164:167], v252 offset:32
    ds_read_b128 a[168:171], v252 offset:64
    ds_read_b128 a[172:175], v252 offset:96
    ds_read_b128 a[176:179], v252 offset:128
    ds_read_b128 a[180:183], v252 offset:160
    ds_read_b128 a[184:187], v252 offset:192
    ds_read_b128 a[188:191], v252 offset:224
    v_pk_mul_f32 v[194:195], v[180:181], v[180:181] op_sel:[0,0] op_sel_hi:[0,1]
    v_pk_fma_f32 v[182:183], v[180:181], v[180:181], v[194:195] op_sel:[1,1,0] op_sel_hi:[1,0,1] neg_lo:[0,1,0]
    v_pk_mul_f32 v[194:195], v[182:183], v[182:183] op_sel:[0,0] op_sel_hi:[0,1]
    v_pk_fma_f32 v[184:185], v[182:183], v[182:183], v[194:195] op_sel:[1,1,0] op_sel_hi:[1,0,1] neg_lo:[0,1,0]
    v_cvt_pk_bf16_f32 v242, v192, -v193
    v_pk_mul_f32 v[194:195], v[192:193], v[180:181] op_sel:[0,0] op_sel_hi:[0,1]
    v_pk_fma_f32 v[174:175], v[192:193], v[180:181], v[194:195] op_sel:[1,1,0] op_sel_hi:[1,0,1] neg_lo:[0,1,0]
    v_cvt_pk_bf16_f32 v243, v174, -v175
    v_pk_mul_f32 v[194:195], v[174:175], v[180:181] op_sel:[0,0] op_sel_hi:[0,1]
    v_pk_fma_f32 v[172:173], v[174:175], v[180:181], v[194:195] op_sel:[1,1,0] op_sel_hi:[1,0,1] neg_lo:[0,1,0]
    v_cvt_pk_bf16_f32 v244, v172, -v173
    v_pk_mul_f32 v[194:195], v[172:173], v[180:181] op_sel:[0,0] op_sel_hi:[0,1]
    v_pk_fma_f32 v[174:175], v[172:173], v[180:181], v[194:195] op_sel:[1,1,0] op_sel_hi:[1,0,1] neg_lo:[0,1,0]
    v_cvt_pk_bf16_f32 v245, v174, -v175
    v_pk_mul_f32 v[194:195], v[174:175], v[180:181] op_sel:[0,0] op_sel_hi:[0,1]
    v_pk_fma_f32 v[172:173], v[174:175], v[180:181], v[194:195] op_sel:[1,1,0] op_sel_hi:[1,0,1] neg_lo:[0,1,0]
    v_cvt_pk_bf16_f32 v246, v172, -v173
    v_pk_mul_f32 v[194:195], v[172:173], v[180:181] op_sel:[0,0] op_sel_hi:[0,1]
    v_pk_fma_f32 v[174:175], v[172:173], v[180:181], v[194:195] op_sel:[1,1,0] op_sel_hi:[1,0,1] neg_lo:[0,1,0]
    v_cvt_pk_bf16_f32 v247, v174, -v175
    v_pk_mul_f32 v[194:195], v[174:175], v[180:181] op_sel:[0,0] op_sel_hi:[0,1]
    buffer_load_dword v7, v4, s[16:19], s87 offen offset:0 sc1
    v_pk_fma_f32 v[172:173], v[174:175], v[180:181], v[194:195] op_sel:[1,1,0] op_sel_hi:[1,0,1] neg_lo:[0,1,0]
    v_cvt_pk_bf16_f32 v248, v172, -v173
    v_pk_mul_f32 v[194:195], v[172:173], v[180:181] op_sel:[0,0] op_sel_hi:[0,1]
    v_pk_fma_f32 v[174:175], v[172:173], v[180:181], v[194:195] op_sel:[1,1,0] op_sel_hi:[1,0,1] neg_lo:[0,1,0]
    v_cvt_pk_bf16_f32 v249, v174, -v175
    v_pk_mul_f32 v[194:195], v[192:193], v[190:191] op_sel:[0,0] op_sel_hi:[0,1]
    v_pk_fma_f32 v[176:177], v[192:193], v[190:191], v[194:195] op_sel:[1,1,0] op_sel_hi:[1,0,1] neg_lo:[0,1,0]
    v_cvt_pk_bf16_f32 v250, v176, -v177
    v_pk_mul_f32 v[194:195], v[176:177], v[182:183] op_sel:[0,0] op_sel_hi:[0,1]
    v_pk_fma_f32 v[174:175], v[176:177], v[182:183], v[194:195] op_sel:[1,1,0] op_sel_hi:[1,0,1] neg_lo:[0,1,0]
    v_cvt_pk_bf16_f32 v251, v174, -v175
    ds_write_addtid_b32 v242 offset:0
    ds_write_addtid_b32 v243 offset:272
    ds_write_addtid_b32 v244 offset:544
    ds_write_addtid_b32 v245 offset:816
    ds_write_addtid_b32 v246 offset:1088
    ds_write_addtid_b32 v247 offset:1360
    ds_write_addtid_b32 v248 offset:1632
    ds_write_addtid_b32 v249 offset:1904
    ds_write_addtid_b32 v250 offset:2176
    ds_write_addtid_b32 v251 offset:2448
    v_pk_mul_f32 v[194:195], v[174:175], v[182:183] op_sel:[0,0] op_sel_hi:[0,1]
    v_pk_fma_f32 v[172:173], v[174:175], v[182:183], v[194:195] op_sel:[1,1,0] op_sel_hi:[1,0,1] neg_lo:[0,1,0]
    v_cvt_pk_bf16_f32 v242, v172, -v173
    v_pk_mul_f32 v[194:195], v[172:173], v[182:183] op_sel:[0,0] op_sel_hi:[0,1]
    v_pk_fma_f32 v[174:175], v[172:173], v[182:183], v[194:195] op_sel:[1,1,0] op_sel_hi:[1,0,1] neg_lo:[0,1,0]
    v_cvt_pk_bf16_f32 v243, v174, -v175
    v_pk_mul_f32 v[194:195], v[174:175], v[182:183] op_sel:[0,0] op_sel_hi:[0,1]
    v_pk_fma_f32 v[172:173], v[174:175], v[182:183], v[194:195] op_sel:[1,1,0] op_sel_hi:[1,0,1] neg_lo:[0,1,0]
    v_cvt_pk_bf16_f32 v244, v172, -v173
    v_pk_mul_f32 v[194:195], v[176:177], v[190:191] op_sel:[0,0] op_sel_hi:[0,1]
    v_pk_fma_f32 v[178:179], v[176:177], v[190:191], v[194:195] op_sel:[1,1,0] op_sel_hi:[1,0,1] neg_lo:[0,1,0]
    v_cvt_pk_bf16_f32 v245, v178, -v179
    v_pk_mul_f32 v[194:195], v[178:179], v[184:185] op_sel:[0,0] op_sel_hi:[0,1]
    v_pk_fma_f32 v[174:175], v[178:179], v[184:185], v[194:195] op_sel:[1,1,0] op_sel_hi:[1,0,1] neg_lo:[0,1,0]
    v_cvt_pk_bf16_f32 v246, v174, -v175
    v_pk_mul_f32 v[194:195], v[174:175], v[184:185] op_sel:[0,0] op_sel_hi:[0,1]
    v_pk_fma_f32 v[172:173], v[174:175], v[184:185], v[194:195] op_sel:[1,1,0] op_sel_hi:[1,0,1] neg_lo:[0,1,0]
    v_cvt_pk_bf16_f32 v247, v172, -v173
    v_pk_mul_f32 v[194:195], v[178:179], v[190:191] op_sel:[0,0] op_sel_hi:[0,1]
    v_pk_fma_f32 v[176:177], v[178:179], v[190:191], v[194:195] op_sel:[1,1,0] op_sel_hi:[1,0,1] neg_lo:[0,1,0]
    v_cvt_pk_bf16_f32 v248, v176, -v177
    v_pk_mul_f32 v[194:195], v[176:177], v[184:185] op_sel:[0,0] op_sel_hi:[0,1]
    v_pk_fma_f32 v[174:175], v[176:177], v[184:185], v[194:195] op_sel:[1,1,0] op_sel_hi:[1,0,1] neg_lo:[0,1,0]
    v_cvt_pk_bf16_f32 v249, v174, -v175
    v_pk_mul_f32 v[194:195], v[174:175], v[184:185] op_sel:[0,0] op_sel_hi:[0,1]
    v_pk_fma_f32 v[172:173], v[174:175], v[184:185], v[194:195] op_sel:[1,1,0] op_sel_hi:[1,0,1] neg_lo:[0,1,0]
    v_cvt_pk_bf16_f32 v250, v172, -v173
    v_pk_mul_f32 v[194:195], v[176:177], v[190:191] op_sel:[0,0] op_sel_hi:[0,1]
    v_pk_fma_f32 v[178:179], v[176:177], v[190:191], v[194:195] op_sel:[1,1,0] op_sel_hi:[1,0,1] neg_lo:[0,1,0]
    v_cvt_pk_bf16_f32 v251, v178, -v179
    ds_write_addtid_b32 v242 offset:2720
    ds_write_addtid_b32 v242 offset:3264
    ds_write_addtid_b32 v243 offset:3536
    ds_write_addtid_b32 v244 offset:3808
    ds_write_addtid_b32 v245 offset:4352
    ds_write_addtid_b32 v246 offset:4624
    ds_write_addtid_b32 v247 offset:4896
    ds_write_addtid_b32 v248 offset:5440
    ds_write_addtid_b32 v249 offset:5712
    ds_write_addtid_b32 v250 offset:5984
    ds_write_addtid_b32 v251 offset:6528
    v_pk_mul_f32 v[194:195], v[178:179], v[186:187] op_sel:[0,0] op_sel_hi:[0,1]
    v_pk_fma_f32 v[174:175], v[178:179], v[186:187], v[194:195] op_sel:[1,1,0] op_sel_hi:[1,0,1] neg_lo:[0,1,0]
    v_cvt_pk_bf16_f32 v242, v174, -v175
    v_pk_mul_f32 v[194:195], v[178:179], v[190:191] op_sel:[0,0] op_sel_hi:[0,1]
    v_pk_fma_f32 v[176:177], v[178:179], v[190:191], v[194:195] op_sel:[1,1,0] op_sel_hi:[1,0,1] neg_lo:[0,1,0]
    v_cvt_pk_bf16_f32 v243, v176, -v177
    v_pk_mul_f32 v[194:195], v[176:177], v[186:187] op_sel:[0,0] op_sel_hi:[0,1]
    v_pk_fma_f32 v[174:175], v[176:177], v[186:187], v[194:195] op_sel:[1,1,0] op_sel_hi:[1,0,1] neg_lo:[0,1,0]
    v_cvt_pk_bf16_f32 v244, v174, -v175
    v_pk_mul_f32 v[194:195], v[176:177], v[190:191] op_sel:[0,0] op_sel_hi:[0,1]
    v_pk_fma_f32 v[178:179], v[176:177], v[190:191], v[194:195] op_sel:[1,1,0] op_sel_hi:[1,0,1] neg_lo:[0,1,0]
    v_cvt_pk_bf16_f32 v245, v178, -v179
    v_pk_mul_f32 v[194:195], v[178:179], v[186:187] op_sel:[0,0] op_sel_hi:[0,1]
    v_pk_fma_f32 v[174:175], v[178:179], v[186:187], v[194:195] op_sel:[1,1,0] op_sel_hi:[1,0,1] neg_lo:[0,1,0]
    v_cvt_pk_bf16_f32 v246, v174, -v175
    v_pk_mul_f32 v[194:195], v[178:179], v[190:191] op_sel:[0,0] op_sel_hi:[0,1]
    v_pk_fma_f32 v[176:177], v[178:179], v[190:191], v[194:195] op_sel:[1,1,0] op_sel_hi:[1,0,1] neg_lo:[0,1,0]
    v_cvt_pk_bf16_f32 v247, v176, -v177
    v_pk_mul_f32 v[194:195], v[176:177], v[186:187] op_sel:[0,0] op_sel_hi:[0,1]
    v_pk_fma_f32 v[174:175], v[176:177], v[186:187], v[194:195] op_sel:[1,1,0] op_sel_hi:[1,0,1] neg_lo:[0,1,0]
    v_cvt_pk_bf16_f32 v248, v174, -v175
    ds_write_addtid_b32 v242 offset:6800
    ds_write_addtid_b32 v243 offset:7072
    ds_write_addtid_b32 v244 offset:7344
    ds_write_addtid_b32 v245 offset:7616
    ds_write_addtid_b32 v246 offset:7888
    ds_write_addtid_b32 v247 offset:8160
    ds_write_addtid_b32 v248 offset:8432
    ds_read_b128 a[192:195], v252 offset:0
    ds_read_b128 a[196:199], v252 offset:32
    ds_read_b128 a[200:203], v252 offset:64
    ds_read_b128 a[204:207], v252 offset:96
    ds_read_b128 a[208:211], v252 offset:128
    ds_read_b128 a[212:215], v252 offset:160
    ds_read_b128 a[216:219], v252 offset:192
    ds_read_b128 a[220:223], v252 offset:224
    s_add_u32 m0, s92, 36352
    s_nop 0
    buffer_load_dwordx4 v73, s[4:7], s99 offen offset:0  lds
    v_lshlrev_b32 v199, 16, v236
    v_mul_f32 v199, 0x3fb8aa3b, v199
    v_exp_f32 v199, v199
    v_lshlrev_b32 v255, 16, v237
    v_mul_f32 v255, v255, v253
    v_mul_f32 v255, 0x3e22f983, v255
    v_cvt_pk_bf16_f32 v199, v199, v199
    v_lshlrev_b32 v199, 16, v199
    v_mul_f32 v254, v199, v253
    v_mul_f32 v254, 0xbfb8aa3b, v254
    s_waitcnt lgkmcnt(7)
    v_mfma_f32_32x32x16_bf16 v[216:231], a[192:195], a[160:163], v[216:231]
    s_add_u32 m0, s92, 36352
    s_nop 0
    buffer_load_dwordx4 v74, s[4:7], s99 offen offset:1088  lds
    v_mul_f32 v182, 0x41000000, v254
    v_mul_f32 v185, 0x41000000, v255
    v_mul_f32 v184, 0x43800000, v254
    v_mul_f32 v189, 0x43800000, v255
    s_waitcnt lgkmcnt(6)
    v_mfma_f32_32x32x16_bf16 v[216:231], a[196:199], a[164:167], v[216:231]
    s_add_u32 m0, s92, 36352
    s_nop 0
    buffer_load_dwordx4 v75, s[4:7], s99 offen offset:2176  lds
    v_fract_f32 v185, v185
    v_fract_f32 v188, v255
    v_fract_f32 v189, v189
    v_exp_f32_e64 v182, v182
    s_waitcnt lgkmcnt(5)
    v_mfma_f32_32x32x16_bf16 v[216:231], a[200:203], a[168:171], v[216:231]
    s_add_u32 m0, s92, 36352
    s_nop 0
    buffer_load_dwordx4 v76, s[4:7], s99 offen offset:3264  lds
    v_exp_f32 v183, v254
    v_exp_f32 v184, v184
    v_cos_f32 v186, v185
    v_sin_f32 v187, v185
    s_waitcnt lgkmcnt(4)
    v_mfma_f32_32x32x16_bf16 v[216:231], a[204:207], a[172:175], v[216:231]
    s_add_u32 m0, s93, 53760
    s_add_u32 s99, s99, 256
    s_mov_b64 exec, s[80:81]
    buffer_load_dwordx4 v77, s[4:7], s100 offen  lds
    s_mov_b64 exec, -1
    s_add_u32 s100, s100, 256
    v_cos_f32 v180, v188
    v_sin_f32 v181, v188
    v_cos_f32 v190, v189
    v_sin_f32_e64 v191, v189
    s_waitcnt lgkmcnt(3)
    v_mfma_f32_32x32x16_bf16 v[216:231], a[208:211], a[176:179], v[216:231]
    s_add_u32 m0, s92, 55936
    s_nop 0
    buffer_load_dwordx4 v73, s[4:7], s99 offen offset:0  lds
    v_lshlrev_b32 v192, 16, v238
    v_lshlrev_b32 v193, 16, v239
    v_add_f32 v199, v253, v253
    v_mul_f32 v192, v192, v199
    s_waitcnt lgkmcnt(2)
    v_mfma_f32_32x32x16_bf16 v[216:231], a[212:215], a[180:183], v[216:231]
    s_add_u32 m0, s92, 55936
    s_nop 0
    buffer_load_dwordx4 v74, s[4:7], s99 offen offset:1088  lds
    v_mul_f32 v193, v193, v199
    v_mul_f32 v186, v186, v182
    v_mul_f32 v187, v187, v182
    v_mul_f32 v180, v180, v183
    s_waitcnt lgkmcnt(1)
    v_mfma_f32_32x32x16_bf16 v[216:231], a[216:219], a[184:187], v[216:231]
    s_add_u32 m0, s92, 55936
    s_nop 0
    buffer_load_dwordx4 v75, s[4:7], s99 offen offset:2176  lds
    v_mul_f32 v181, v181, v183
    v_mul_f32 v190, v190, v184
    v_mul_f32_e64 v191, v191, v184
    s_waitcnt lgkmcnt(0)
    v_mfma_f32_32x32x16_bf16 v[216:231], a[220:223], a[188:191], v[216:231]
    s_add_u32 m0, s92, 55936
    s_nop 0
    buffer_load_dwordx4 v76, s[4:7], s99 offen offset:3264  lds
    s_add_u32 m0, s93, 73344
    s_add_u32 s99, s99, 256
    s_mov_b64 exec, s[80:81]
    buffer_load_dwordx4 v77, s[4:7], s100 offen  lds
    s_mov_b64 exec, -1
    s_add_u32 s100, s100, 256
    s_add_u32 m0, s92, 75520
    s_nop 0
    buffer_load_dwordx4 v73, s[4:7], s99 offen offset:0  lds
    s_add_u32 m0, s92, 75520
    s_nop 0
    buffer_load_dwordx4 v74, s[4:7], s99 offen offset:1088  lds
    s_mov_b32 m0, s37
    v_mov_b32 v242, 0x3f80
    v_cvt_pk_bf16_f32 v243, v186, v187
    v_pk_mul_f32 v[194:195], v[186:187], v[186:187] op_sel:[0,0] op_sel_hi:[0,1]
    v_pk_fma_f32 v[172:173], v[186:187], v[186:187], v[194:195] op_sel:[1,1,0] op_sel_hi:[1,0,1] neg_lo:[0,1,0]
    v_cvt_pk_bf16_f32 v244, v172, v173
    v_pk_mul_f32 v[194:195], v[172:173], v[186:187] op_sel:[0,0] op_sel_hi:[0,1]
    v_pk_fma_f32 v[174:175], v[172:173], v[186:187], v[194:195] op_sel:[1,1,0] op_sel_hi:[1,0,1] neg_lo:[0,1,0]
    v_cvt_pk_bf16_f32 v245, v174, v175
    v_pk_mul_f32 v[194:195], v[174:175], v[186:187] op_sel:[0,0] op_sel_hi:[0,1]
    v_pk_fma_f32 v[172:173], v[174:175], v[186:187], v[194:195] op_sel:[1,1,0] op_sel_hi:[1,0,1] neg_lo:[0,1,0]
    v_cvt_pk_bf16_f32 v246, v172, v173
    v_pk_mul_f32 v[194:195], v[172:173], v[186:187] op_sel:[0,0] op_sel_hi:[0,1]
    v_pk_fma_f32 v[174:175], v[172:173], v[186:187], v[194:195] op_sel:[1,1,0] op_sel_hi:[1,0,1] neg_lo:[0,1,0]
    v_cvt_pk_bf16_f32 v247, v174, v175
    v_pk_mul_f32 v[194:195], v[174:175], v[186:187] op_sel:[0,0] op_sel_hi:[0,1]
    v_pk_fma_f32 v[172:173], v[174:175], v[186:187], v[194:195] op_sel:[1,1,0] op_sel_hi:[1,0,1] neg_lo:[0,1,0]
    v_cvt_pk_bf16_f32 v248, v172, v173
    v_pk_mul_f32 v[194:195], v[172:173], v[186:187] op_sel:[0,0] op_sel_hi:[0,1]
    v_pk_fma_f32 v[174:175], v[172:173], v[186:187], v[194:195] op_sel:[1,1,0] op_sel_hi:[1,0,1] neg_lo:[0,1,0]
    v_cvt_pk_bf16_f32 v249, v174, v175
    v_pk_mul_f32 v[194:195], v[174:175], v[186:187] op_sel:[0,0] op_sel_hi:[0,1]
    v_pk_fma_f32 v[172:173], v[174:175], v[186:187], v[194:195] op_sel:[1,1,0] op_sel_hi:[1,0,1] neg_lo:[0,1,0]
    v_cvt_pk_bf16_f32 v250, v172, v173
    v_pk_mul_f32 v[194:195], v[172:173], v[186:187] op_sel:[0,0] op_sel_hi:[0,1]
    s_waitcnt vmcnt(12)
    v_cmp_gt_u32 vcc, 32, v7
    s_nop 0
    s_and_b64 vcc, vcc, s[50:51]
    s_cbranch_scc1 ps_8
pc_10:
    s_barrier
    v_pk_fma_f32 v[174:175], v[172:173], v[186:187], v[194:195] op_sel:[1,1,0] op_sel_hi:[1,0,1] neg_lo:[0,1,0]
    v_cvt_pk_bf16_f32 v251, v174, v175
    ds_write_addtid_b32 v242 offset:0
    ds_write_addtid_b32 v243 offset:272
    ds_write_addtid_b32 v244 offset:544
    ds_write_addtid_b32 v245 offset:816
    ds_write_addtid_b32 v246 offset:1088
    ds_write_addtid_b32 v247 offset:1360
    ds_write_addtid_b32 v248 offset:1632
    ds_write_addtid_b32 v249 offset:1904
    ds_write_addtid_b32 v250 offset:2176
    ds_write_addtid_b32 v251 offset:2448
    v_pk_mul_f32 v[194:195], v[174:175], v[186:187] op_sel:[0,0] op_sel_hi:[0,1]
    v_pk_fma_f32 v[172:173], v[174:175], v[186:187], v[194:195] op_sel:[1,1,0] op_sel_hi:[1,0,1] neg_lo:[0,1,0]
    v_cvt_pk_bf16_f32 v242, v172, v173
    v_pk_mul_f32 v[194:195], v[172:173], v[186:187] op_sel:[0,0] op_sel_hi:[0,1]
    v_pk_fma_f32 v[174:175], v[172:173], v[186:187], v[194:195] op_sel:[1,1,0] op_sel_hi:[1,0,1] neg_lo:[0,1,0]
    v_cvt_pk_bf16_f32 v243, v174, v175
    buffer_load_dwordx4 a[0:3], v200, s[16:19], s101 offen offset:0 sc1
    v_pk_mul_f32 v[194:195], v[174:175], v[186:187] op_sel:[0,0] op_sel_hi:[0,1]
    v_pk_fma_f32 v[172:173], v[174:175], v[186:187], v[194:195] op_sel:[1,1,0] op_sel_hi:[1,0,1] neg_lo:[0,1,0]
    v_cvt_pk_bf16_f32 v244, v172, v173
    v_pk_mul_f32 v[194:195], v[172:173], v[186:187] op_sel:[0,0] op_sel_hi:[0,1]
    v_pk_fma_f32 v[174:175], v[172:173], v[186:187], v[194:195] op_sel:[1,1,0] op_sel_hi:[1,0,1] neg_lo:[0,1,0]
    v_cvt_pk_bf16_f32 v245, v174, v175
    v_pk_mul_f32 v[194:195], v[174:175], v[186:187] op_sel:[0,0] op_sel_hi:[0,1]
    v_pk_fma_f32 v[172:173], v[174:175], v[186:187], v[194:195] op_sel:[1,1,0] op_sel_hi:[1,0,1] neg_lo:[0,1,0]
    v_cvt_pk_bf16_f32 v246, v172, v173
    v_pk_mul_f32 v[194:195], v[172:173], v[186:187] op_sel:[0,0] op_sel_hi:[0,1]
    v_pk_fma_f32 v[174:175], v[172:173], v[186:187], v[194:195] op_sel:[1,1,0] op_sel_hi:[1,0,1] neg_lo:[0,1,0]
    v_cvt_pk_bf16_f32 v247, v174, v175
    v_pk_mul_f32 v[194:195], v[174:175], v[186:187] op_sel:[0,0] op_sel_hi:[0,1]
    v_pk_fma_f32 v[172:173], v[174:175], v[186:187], v[194:195] op_sel:[1,1,0] op_sel_hi:[1,0,1] neg_lo:[0,1,0]
    v_cvt_pk_bf16_f32 v248, v172, v173
    v_pk_mul_f32 v[194:195], v[172:173], v[186:187] op_sel:[0,0] op_sel_hi:[0,1]
    v_pk_fma_f32 v[174:175], v[172:173], v[186:187], v[194:195] op_sel:[1,1,0] op_sel_hi:[1,0,1] neg_lo:[0,1,0]
    v_cvt_pk_bf16_f32 v249, v174, v175
    buffer_load_dwordx4 a[4:7], v200, s[16:19], s101 offen offset:1024 sc1
    v_pk_mul_f32 v[194:195], v[174:175], v[186:187] op_sel:[0,0] op_sel_hi:[0,1]
    v_pk_fma_f32 v[172:173], v[174:175], v[186:187], v[194:195] op_sel:[1,1,0] op_sel_hi:[1,0,1] neg_lo:[0,1,0]
    v_cvt_pk_bf16_f32 v250, v172, v173
    v_pk_mul_f32 v[194:195], v[172:173], v[186:187] op_sel:[0,0] op_sel_hi:[0,1]
    v_pk_fma_f32 v[174:175], v[172:173], v[186:187], v[194:195] op_sel:[1,1,0] op_sel_hi:[1,0,1] neg_lo:[0,1,0]
    v_cvt_pk_bf16_f32 v251, v174, v175
    ds_write_addtid_b32 v242 offset:2720
    ds_write_addtid_b32 v243 offset:2992
    ds_write_addtid_b32 v244 offset:3264
    ds_write_addtid_b32 v245 offset:3536
    ds_write_addtid_b32 v246 offset:3808
    ds_write_addtid_b32 v247 offset:4080
    ds_write_addtid_b32 v248 offset:4352
    ds_write_addtid_b32 v249 offset:4624
    ds_write_addtid_b32 v250 offset:4896
    ds_write_addtid_b32 v251 offset:5168
    v_pk_mul_f32 v[194:195], v[174:175], v[186:187] op_sel:[0,0] op_sel_hi:[0,1]
    v_pk_fma_f32 v[172:173], v[174:175], v[186:187], v[194:195] op_sel:[1,1,0] op_sel_hi:[1,0,1] neg_lo:[0,1,0]
    buffer_load_dwordx4 a[8:11], v200, s[16:19], s101 offen offset:2048 sc1
    v_cvt_pk_bf16_f32 v242, v172, v173
    v_pk_mul_f32 v[194:195], v[172:173], v[186:187] op_sel:[0,0] op_sel_hi:[0,1]
    v_pk_fma_f32 v[174:175], v[172:173], v[186:187], v[194:195] op_sel:[1,1,0] op_sel_hi:[1,0,1] neg_lo:[0,1,0]
    v_cvt_pk_bf16_f32 v243, v174, v175
    v_pk_mul_f32 v[194:195], v[174:175], v[186:187] op_sel:[0,0] op_sel_hi:[0,1]
    v_pk_fma_f32 v[172:173], v[174:175], v[186:187], v[194:195] op_sel:[1,1,0] op_sel_hi:[1,0,1] neg_lo:[0,1,0]
    v_cvt_pk_bf16_f32 v244, v172, v173
    v_pk_mul_f32 v[194:195], v[172:173], v[186:187] op_sel:[0,0] op_sel_hi:[0,1]
    v_pk_fma_f32 v[174:175], v[172:173], v[186:187], v[194:195] op_sel:[1,1,0] op_sel_hi:[1,0,1] neg_lo:[0,1,0]
    v_cvt_pk_bf16_f32 v245, v174, v175
    v_pk_mul_f32 v[194:195], v[174:175], v[186:187] op_sel:[0,0] op_sel_hi:[0,1]
    v_pk_fma_f32 v[172:173], v[174:175], v[186:187], v[194:195] op_sel:[1,1,0] op_sel_hi:[1,0,1] neg_lo:[0,1,0]
    v_cvt_pk_bf16_f32 v246, v172, v173
    v_pk_mul_f32 v[194:195], v[172:173], v[186:187] op_sel:[0,0] op_sel_hi:[0,1]
    v_pk_fma_f32 v[174:175], v[172:173], v[186:187], v[194:195] op_sel:[1,1,0] op_sel_hi:[1,0,1] neg_lo:[0,1,0]
    v_cvt_pk_bf16_f32 v247, v174, v175
    v_pk_mul_f32 v[194:195], v[174:175], v[186:187] op_sel:[0,0] op_sel_hi:[0,1]
    v_pk_fma_f32 v[172:173], v[174:175], v[186:187], v[194:195] op_sel:[1,1,0] op_sel_hi:[1,0,1] neg_lo:[0,1,0]
    buffer_load_dwordx4 a[12:15], v200, s[16:19], s101 offen offset:3072 sc1
    v_cvt_pk_bf16_f32 v248, v172, v173
    v_pk_mul_f32 v[194:195], v[172:173], v[186:187] op_sel:[0,0] op_sel_hi:[0,1]
    v_pk_fma_f32 v[174:175], v[172:173], v[186:187], v[194:195] op_sel:[1,1,0] op_sel_hi:[1,0,1] neg_lo:[0,1,0]
    v_cvt_pk_bf16_f32 v249, v174, v175
    v_pk_mul_f32 v[194:195], v[174:175], v[186:187] op_sel:[0,0] op_sel_hi:[0,1]
    v_pk_fma_f32 v[172:173], v[174:175], v[186:187], v[194:195] op_sel:[1,1,0] op_sel_hi:[1,0,1] neg_lo:[0,1,0]
    v_cvt_pk_bf16_f32 v250, v172, v173
    v_pk_mul_f32 v[194:195], v[172:173], v[186:187] op_sel:[0,0] op_sel_hi:[0,1]
    v_pk_fma_f32 v[174:175], v[172:173], v[186:187], v[194:195] op_sel:[1,1,0] op_sel_hi:[1,0,1] neg_lo:[0,1,0]
    v_cvt_pk_bf16_f32 v251, v174, v175
    ds_write_addtid_b32 v242 offset:5440
    ds_write_addtid_b32 v243 offset:5712
    ds_write_addtid_b32 v244 offset:5984
    ds_write_addtid_b32 v245 offset:6256
    ds_write_addtid_b32 v246 offset:6528
    ds_write_addtid_b32 v247 offset:6800
    ds_write_addtid_b32 v248 offset:7072
    ds_write_addtid_b32 v249 offset:7344
    s_add_u32 s101, s101, 4096
    buffer_load_dwordx4 a[16:19], v200, s[16:19], s101 offen offset:0 sc1
    ds_write_addtid_b32 v250 offset:7616
    ds_write_addtid_b32 v251 offset:7888
    v_pk_mul_f32 v[194:195], v[174:175], v[186:187] op_sel:[0,0] op_sel_hi:[0,1]
    v_pk_fma_f32 v[172:173], v[174:175], v[186:187], v[194:195] op_sel:[1,1,0] op_sel_hi:[1,0,1] neg_lo:[0,1,0]
    v_cvt_pk_bf16_f32 v242, v172, v173
    v_pk_mul_f32 v[194:195], v[172:173], v[186:187] op_sel:[0,0] op_sel_hi:[0,1]
    v_pk_fma_f32 v[174:175], v[172:173], v[186:187], v[194:195] op_sel:[1,1,0] op_sel_hi:[1,0,1] neg_lo:[0,1,0]
    v_cvt_pk_bf16_f32 v243, v174, v175
    ds_write_addtid_b32 v242 offset:8160
    ds_write_addtid_b32 v243 offset:8432
    ds_read_b128 a[160:163], v252 offset:0
    ds_read_b128 a[164:167], v252 offset:32
    ds_read_b128 a[168:171], v252 offset:64
    ds_read_b128 a[172:175], v252 offset:96
    ds_read_b128 a[176:179], v252 offset:128
    ds_read_b128 a[180:183], v252 offset:160
    ds_read_b128 a[184:187], v252 offset:192
    ds_read_b128 a[188:191], v252 offset:224
    buffer_load_dwordx4 a[20:23], v200, s[16:19], s101 offen offset:1024 sc1
    v_pk_mul_f32 v[194:195], v[180:181], v[180:181] op_sel:[0,0] op_sel_hi:[0,1]
    v_pk_fma_f32 v[182:183], v[180:181], v[180:181], v[194:195] op_sel:[1,1,0] op_sel_hi:[1,0,1] neg_lo:[0,1,0]
    v_pk_mul_f32 v[194:195], v[182:183], v[182:183] op_sel:[0,0] op_sel_hi:[0,1]
    v_pk_fma_f32 v[184:185], v[182:183], v[182:183], v[194:195] op_sel:[1,1,0] op_sel_hi:[1,0,1] neg_lo:[0,1,0]
    v_cvt_pk_bf16_f32 v242, v192, -v193
    v_pk_mul_f32 v[194:195], v[192:193], v[180:181] op_sel:[0,0] op_sel_hi:[0,1]
    v_pk_fma_f32 v[174:175], v[192:193], v[180:181], v[194:195] op_sel:[1,1,0] op_sel_hi:[1,0,1] neg_lo:[0,1,0]
    v_cvt_pk_bf16_f32 v243, v174, -v175
    v_pk_mul_f32 v[194:195], v[174:175], v[180:181] op_sel:[0,0] op_sel_hi:[0,1]
    v_pk_fma_f32 v[172:173], v[174:175], v[180:181], v[194:195] op_sel:[1,1,0] op_sel_hi:[1,0,1] neg_lo:[0,1,0]
    v_cvt_pk_bf16_f32 v244, v172, -v173
    v_pk_mul_f32 v[194:195], v[172:173], v[180:181] op_sel:[0,0] op_sel_hi:[0,1]
    v_pk_fma_f32 v[174:175], v[172:173], v[180:181], v[194:195] op_sel:[1,1,0] op_sel_hi:[1,0,1] neg_lo:[0,1,0]
    v_cvt_pk_bf16_f32 v245, v174, -v175
    v_pk_mul_f32 v[194:195], v[174:175], v[180:181] op_sel:[0,0] op_sel_hi:[0,1]
    v_pk_fma_f32 v[172:173], v[174:175], v[180:181], v[194:195] op_sel:[1,1,0] op_sel_hi:[1,0,1] neg_lo:[0,1,0]
    v_cvt_pk_bf16_f32 v246, v172, -v173
    v_pk_mul_f32 v[194:195], v[172:173], v[180:181] op_sel:[0,0] op_sel_hi:[0,1]
    buffer_load_dwordx4 a[24:27], v200, s[16:19], s101 offen offset:2048 sc1
    v_pk_fma_f32 v[174:175], v[172:173], v[180:181], v[194:195] op_sel:[1,1,0] op_sel_hi:[1,0,1] neg_lo:[0,1,0]
    v_cvt_pk_bf16_f32 v247, v174, -v175
    v_pk_mul_f32 v[194:195], v[174:175], v[180:181] op_sel:[0,0] op_sel_hi:[0,1]
    v_pk_fma_f32 v[172:173], v[174:175], v[180:181], v[194:195] op_sel:[1,1,0] op_sel_hi:[1,0,1] neg_lo:[0,1,0]
    v_cvt_pk_bf16_f32 v248, v172, -v173
    v_pk_mul_f32 v[194:195], v[172:173], v[180:181] op_sel:[0,0] op_sel_hi:[0,1]
    v_pk_fma_f32 v[174:175], v[172:173], v[180:181], v[194:195] op_sel:[1,1,0] op_sel_hi:[1,0,1] neg_lo:[0,1,0]
    v_cvt_pk_bf16_f32 v249, v174, -v175
    v_pk_mul_f32 v[194:195], v[192:193], v[190:191] op_sel:[0,0] op_sel_hi:[0,1]
    v_pk_fma_f32 v[176:177], v[192:193], v[190:191], v[194:195] op_sel:[1,1,0] op_sel_hi:[1,0,1] neg_lo:[0,1,0]
    v_cvt_pk_bf16_f32 v250, v176, -v177
    v_pk_mul_f32 v[194:195], v[176:177], v[182:183] op_sel:[0,0] op_sel_hi:[0,1]
    v_pk_fma_f32 v[174:175], v[176:177], v[182:183], v[194:195] op_sel:[1,1,0] op_sel_hi:[1,0,1] neg_lo:[0,1,0]
    v_cvt_pk_bf16_f32 v251, v174, -v175
    ds_write_addtid_b32 v242 offset:0
    ds_write_addtid_b32 v243 offset:272
    ds_write_addtid_b32 v244 offset:544
    ds_write_addtid_b32 v245 offset:816
    buffer_load_dwordx4 a[28:31], v200, s[16:19], s101 offen offset:3072 sc1
    ds_write_addtid_b32 v246 offset:1088
    ds_write_addtid_b32 v247 offset:1360
    ds_write_addtid_b32 v248 offset:1632
    ds_write_addtid_b32 v249 offset:1904
    ds_write_addtid_b32 v250 offset:2176
    ds_write_addtid_b32 v251 offset:2448
    v_pk_mul_f32 v[194:195], v[174:175], v[182:183] op_sel:[0,0] op_sel_hi:[0,1]
    v_pk_fma_f32 v[172:173], v[174:175], v[182:183], v[194:195] op_sel:[1,1,0] op_sel_hi:[1,0,1] neg_lo:[0,1,0]
    v_cvt_pk_bf16_f32 v242, v172, -v173
    v_pk_mul_f32 v[194:195], v[172:173], v[182:183] op_sel:[0,0] op_sel_hi:[0,1]
    v_pk_fma_f32 v[174:175], v[172:173], v[182:183], v[194:195] op_sel:[1,1,0] op_sel_hi:[1,0,1] neg_lo:[0,1,0]
    v_cvt_pk_bf16_f32 v243, v174, -v175
    v_pk_mul_f32 v[194:195], v[174:175], v[182:183] op_sel:[0,0] op_sel_hi:[0,1]
    v_pk_fma_f32 v[172:173], v[174:175], v[182:183], v[194:195] op_sel:[1,1,0] op_sel_hi:[1,0,1] neg_lo:[0,1,0]
    v_cvt_pk_bf16_f32 v244, v172, -v173
    v_pk_mul_f32 v[194:195], v[176:177], v[190:191] op_sel:[0,0] op_sel_hi:[0,1]
    v_pk_fma_f32 v[178:179], v[176:177], v[190:191], v[194:195] op_sel:[1,1,0] op_sel_hi:[1,0,1] neg_lo:[0,1,0]
    v_cvt_pk_bf16_f32 v245, v178, -v179
    s_add_u32 s101, s101, 4096
    buffer_load_dwordx4 a[32:35], v200, s[16:19], s101 offen offset:0 sc1
    v_pk_mul_f32 v[194:195], v[178:179], v[184:185] op_sel:[0,0] op_sel_hi:[0,1]
    v_pk_fma_f32 v[174:175], v[178:179], v[184:185], v[194:195] op_sel:[1,1,0] op_sel_hi:[1,0,1] neg_lo:[0,1,0]
    v_cvt_pk_bf16_f32 v246, v174, -v175
    v_pk_mul_f32 v[194:195], v[174:175], v[184:185] op_sel:[0,0] op_sel_hi:[0,1]
    v_pk_fma_f32 v[172:173], v[174:175], v[184:185], v[194:195] op_sel:[1,1,0] op_sel_hi:[1,0,1] neg_lo:[0,1,0]
    v_cvt_pk_bf16_f32 v247, v172, -v173
    v_pk_mul_f32 v[194:195], v[178:179], v[190:191] op_sel:[0,0] op_sel_hi:[0,1]
    v_pk_fma_f32 v[176:177], v[178:179], v[190:191], v[194:195] op_sel:[1,1,0] op_sel_hi:[1,0,1] neg_lo:[0,1,0]
    v_cvt_pk_bf16_f32 v248, v176, -v177
    v_pk_mul_f32 v[194:195], v[176:177], v[184:185] op_sel:[0,0] op_sel_hi:[0,1]
    v_pk_fma_f32 v[174:175], v[176:177], v[184:185], v[194:195] op_sel:[1,1,0] op_sel_hi:[1,0,1] neg_lo:[0,1,0]
    v_cvt_pk_bf16_f32 v249, v174, -v175
    v_pk_mul_f32 v[194:195], v[174:175], v[184:185] op_sel:[0,0] op_sel_hi:[0,1]
    v_pk_fma_f32 v[172:173], v[174:175], v[184:185], v[194:195] op_sel:[1,1,0] op_sel_hi:[1,0,1] neg_lo:[0,1,0]
    v_cvt_pk_bf16_f32 v250, v172, -v173
    v_pk_mul_f32 v[194:195], v[176:177], v[190:191] op_sel:[0,0] op_sel_hi:[0,1]
    v_pk_fma_f32 v[178:179], v[176:177], v[190:191], v[194:195] op_sel:[1,1,0] op_sel_hi:[1,0,1] neg_lo:[0,1,0]
    v_cvt_pk_bf16_f32 v251, v178, -v179
    buffer_load_dwordx4 a[36:39], v200, s[16:19], s101 offen offset:1024 sc1
    ds_write_addtid_b32 v242 offset:2720
    ds_write_addtid_b32 v242 offset:3264
    ds_write_addtid_b32 v243 offset:3536
    ds_write_addtid_b32 v244 offset:3808
    ds_write_addtid_b32 v245 offset:4352
    ds_write_addtid_b32 v246 offset:4624
    ds_write_addtid_b32 v247 offset:4896
    ds_write_addtid_b32 v248 offset:5440
    ds_write_addtid_b32 v249 offset:5712
    ds_write_addtid_b32 v250 offset:5984
    ds_write_addtid_b32 v251 offset:6528
    v_pk_mul_f32 v[194:195], v[178:179], v[186:187] op_sel:[0,0] op_sel_hi:[0,1]
    v_pk_fma_f32 v[174:175], v[178:179], v[186:187], v[194:195] op_sel:[1,1,0] op_sel_hi:[1,0,1] neg_lo:[0,1,0]
    v_cvt_pk_bf16_f32 v242, v174, -v175
    v_pk_mul_f32 v[194:195], v[178:179], v[190:191] op_sel:[0,0] op_sel_hi:[0,1]
    v_pk_fma_f32 v[176:177], v[178:179], v[190:191], v[194:195] op_sel:[1,1,0] op_sel_hi:[1,0,1] neg_lo:[0,1,0]
    v_cvt_pk_bf16_f32 v243, v176, -v177
    v_pk_mul_f32 v[194:195], v[176:177], v[186:187] op_sel:[0,0] op_sel_hi:[0,1]
    buffer_load_dwordx4 a[40:43], v200, s[16:19], s101 offen offset:2048 sc1
    v_pk_fma_f32 v[174:175], v[176:177], v[186:187], v[194:195] op_sel:[1,1,0] op_sel_hi:[1,0,1] neg_lo:[0,1,0]
    v_cvt_pk_bf16_f32 v244, v174, -v175
    v_pk_mul_f32 v[194:195], v[176:177], v[190:191] op_sel:[0,0] op_sel_hi:[0,1]
    v_pk_fma_f32 v[178:179], v[176:177], v[190:191], v[194:195] op_sel:[1,1,0] op_sel_hi:[1,0,1] neg_lo:[0,1,0]
    v_cvt_pk_bf16_f32 v245, v178, -v179
    v_pk_mul_f32 v[194:195], v[178:179], v[186:187] op_sel:[0,0] op_sel_hi:[0,1]
    v_pk_fma_f32 v[174:175], v[178:179], v[186:187], v[194:195] op_sel:[1,1,0] op_sel_hi:[1,0,1] neg_lo:[0,1,0]
    v_cvt_pk_bf16_f32 v246, v174, -v175
    v_pk_mul_f32 v[194:195], v[178:179], v[190:191] op_sel:[0,0] op_sel_hi:[0,1]
    v_pk_fma_f32 v[176:177], v[178:179], v[190:191], v[194:195] op_sel:[1,1,0] op_sel_hi:[1,0,1] neg_lo:[0,1,0]
    v_cvt_pk_bf16_f32 v247, v176, -v177
    v_pk_mul_f32 v[194:195], v[176:177], v[186:187] op_sel:[0,0] op_sel_hi:[0,1]
    v_pk_fma_f32 v[174:175], v[176:177], v[186:187], v[194:195] op_sel:[1,1,0] op_sel_hi:[1,0,1] neg_lo:[0,1,0]
    v_cvt_pk_bf16_f32 v248, v174, -v175
    ds_write_addtid_b32 v242 offset:6800
    ds_write_addtid_b32 v243 offset:7072
    ds_write_addtid_b32 v244 offset:7344
    ds_write_addtid_b32 v245 offset:7616
    buffer_load_dwordx4 a[44:47], v200, s[16:19], s101 offen offset:3072 sc1
    ds_write_addtid_b32 v246 offset:7888
    ds_write_addtid_b32 v247 offset:8160
    ds_write_addtid_b32 v248 offset:8432
    ds_read_b128 a[192:195], v252 offset:0
    ds_read_b128 a[196:199], v252 offset:32
    ds_read_b128 a[200:203], v252 offset:64
    ds_read_b128 a[204:207], v252 offset:96
    ds_read_b128 a[208:211], v252 offset:128
    ds_read_b128 a[212:215], v252 offset:160
    ds_read_b128 a[216:219], v252 offset:192
    ds_read_b128 a[220:223], v252 offset:224
    s_add_u32 m0, s92, 75520
    s_nop 0
    buffer_load_dwordx4 v75, s[4:7], s99 offen offset:2176  lds
    s_waitcnt lgkmcnt(7)
    v_mfma_f32_32x32x16_bf16 v[216:231], a[192:195], a[160:163], v[216:231]
    s_add_u32 m0, s92, 75520
    s_nop 0
    buffer_load_dwordx4 v76, s[4:7], s99 offen offset:3264  lds
    s_waitcnt lgkmcnt(6)
    v_mfma_f32_32x32x16_bf16 v[216:231], a[196:199], a[164:167], v[216:231]
    s_add_u32 m0, s93, 92928
    s_add_u32 s101, s101, 4096
    buffer_load_dwordx4 a[48:51], v200, s[16:19], s101 offen offset:0 sc1
    s_add_u32 s99, s99, 256
    s_mov_b64 exec, s[80:81]
    buffer_load_dwordx4 v77, s[4:7], s100 offen  lds
    s_mov_b64 exec, -1
    s_add_u32 s100, s100, 256
    s_waitcnt lgkmcnt(5)
    v_mfma_f32_32x32x16_bf16 v[216:231], a[200:203], a[168:171], v[216:231]
    s_add_u32 m0, s92, 95104
    s_nop 0
    buffer_load_dwordx4 v73, s[4:7], s99 offen offset:0  lds
    s_waitcnt lgkmcnt(4)
    v_mfma_f32_32x32x16_bf16 v[216:231], a[204:207], a[172:175], v[216:231]
    s_add_u32 m0, s92, 95104
    s_nop 0
    buffer_load_dwordx4 v74, s[4:7], s99 offen offset:1088  lds
    s_waitcnt lgkmcnt(3)
    v_mfma_f32_32x32x16_bf16 v[216:231], a[208:211], a[176:179], v[216:231]
    s_add_u32 m0, s92, 95104
    s_nop 0
    buffer_load_dwordx4 v75, s[4:7], s99 offen offset:2176  lds
    s_waitcnt lgkmcnt(2)
    v_mfma_f32_32x32x16_bf16 v[216:231], a[212:215], a[180:183], v[216:231]
    s_add_u32 m0, s92, 95104
    s_nop 0
    buffer_load_dwordx4 v76, s[4:7], s99 offen offset:3264  lds
    s_waitcnt lgkmcnt(1)
    v_mfma_f32_32x32x16_bf16 v[216:231], a[216:219], a[184:187], v[216:231]
    buffer_load_dwordx4 a[52:55], v200, s[16:19], s101 offen offset:1024 sc1
    s_add_u32 m0, s93, 112512
    s_add_u32 s99, s99, 256
    s_mov_b64 exec, s[80:81]
    buffer_load_dwordx4 v77, s[4:7], s100 offen  lds
    s_mov_b64 exec, -1
    s_add_u32 s100, s100, 256
    s_waitcnt lgkmcnt(0)
    v_mfma_f32_32x32x16_bf16 v[216:231], a[220:223], a[188:191], v[216:231]
    s_add_u32 m0, s92, 114688
    s_nop 0
    buffer_load_dwordx4 v73, s[4:7], s99 offen offset:0  lds
    s_add_u32 m0, s92, 114688
    s_nop 0
    buffer_load_dwordx4 v74, s[4:7], s99 offen offset:1088  lds
    s_add_u32 m0, s92, 114688
    s_nop 0
    buffer_load_dwordx4 v75, s[4:7], s99 offen offset:2176  lds
    s_add_u32 m0, s92, 114688
    s_nop 0
    buffer_load_dwordx4 v76, s[4:7], s99 offen offset:3264  lds
    s_add_u32 m0, s93, 132096
    s_add_u32 s99, s99, 256
    s_mov_b64 exec, s[80:81]
    buffer_load_dwordx4 v77, s[4:7], s100 offen  lds
    s_mov_b64 exec, -1
    s_add_u32 s100, s100, 256
    s_mov_b32 m0, s37
    s_branch ec_4
nc_3:
    s_sub_u32 s33, s2, 160
    s_min_u32 s33, s33, 159
    s_mul_i32 s29, s33, 3277
    s_lshr_b32 s29, s29, 16
    s_mul_i32 s30, s29, 20
    s_sub_u32 s30, s33, s30
    s_mul_i32 s31, s30, 13108
    s_lshr_b32 s31, s31, 16
    s_mul_i32 s32, s31, 5
    s_sub_u32 s32, s30, s32
    s_lshl_b32 s28, s24, 10
    s_lshr_b32 s34, s32, 1
    s_mul_i32 s34, s34, 20
    s_and_b32 s35, s32, 1
    s_lshl_b32 s35, s35, 3
    s_add_u32 s34, s34, s35
    s_cmp_eq_u32 s32, 4
    s_cselect_b32 s34, 16, s34
    s_cselect_b32 s35, 20, 4
    s_mul_i32 s36, s31, 160
    s_add_u32 s34, s34, s36
    s_mul_i32 s34, s34, 1280
    s_mul_i32 s36, s29, 160
    s_add_u32 s34, s34, s36
    v_add_u32 v162, 0, v0
    v_mul_u32_u24 v160, 6554, v162
    v_lshrrev_b32 v160, 16, v160
    v_mul_u32_u24 v161, 10, v160
    v_sub_u32 v161, v162, v161
    v_lshrrev_b32 v163, 3, v160
    v_mul_u32_u24 v163, 40, v163
    v_bfe_u32 v164, v160, 2, 1
    v_mul_u32_u24 v164, s35, v164
    v_and_b32_e64 v160, 3, v160
    v_add3_u32 v160, v160, v163, v164
    v_mul_u32_u24 v160, 1280, v160
    v_lshl_add_u32 v162, v161, 4, v160
    s_add_u32 m0, s28, 0
    s_nop 0
    buffer_load_dwordx4 v162, s[12:15], s34 offen lds
    v_add_u32 v162, 256, v0
    v_min_u32 v162, 319, v162
    v_mul_u32_u24 v160, 6554, v162
    v_lshrrev_b32 v160, 16, v160
    v_mul_u32_u24 v161, 10, v160
    v_sub_u32 v161, v162, v161
    v_lshrrev_b32 v163, 3, v160
    v_mul_u32_u24 v163, 40, v163
    v_bfe_u32 v164, v160, 2, 1
    v_mul_u32_u24 v164, s35, v164
    v_and_b32_e64 v160, 3, v160
    v_add3_u32 v160, v160, v163, v164
    v_mul_u32_u24 v160, 1280, v160
    v_lshl_add_u32 v162, v161, 4, v160
    s_add_u32 m0, s28, 4096
    s_nop 0
    buffer_load_dwordx4 v162, s[12:15], s34 offen lds
    v_bfe_u32 v163, v0, 4, 2
    v_bfe_u32 v164, v0, 2, 2
    v_lshl_add_u32 v163, v163, 3, v164
    v_mul_u32_u24 v163, 160, v163
    v_and_b32 v164, 3, v0
    v_lshl_add_u32 v165, v164, 3, v163
    v_add_u32 v165, 0, v165
    s_lshl_b32 s36, s24, 5
    v_add_u32_e64 v166, s36, v165
    s_mul_i32 s33, s33, 5120
    s_add_u32 s33, s33, 2621440
    v_lshl_add_u32 v167, v1, 4, s33
    v_add_u32 v164, 4096, v167
    v_mov_b32 v163, 1073741824
    v_cmp_gt_u32 vcc, 64, v0
    s_sub_u32 s36, s24, s31
    s_and_b32 s36, s36, 3
    s_lshl_b32 s36, s36, 10
    v_cndmask_b32 v168, v163, v164, vcc
    v_add_u32 v167, s36, v167
    s_sub_u32 s33, s2, 64
    s_min_u32 s33, s33, 159
    s_mul_i32 s29, s33, 3277
    s_lshr_b32 s29, s29, 16
    s_mul_i32 s30, s29, 20
    s_sub_u32 s30, s33, s30
    s_mul_i32 s31, s30, 13108
    s_lshr_b32 s31, s31, 16
    s_mul_i32 s32, s31, 5
    s_sub_u32 s32, s30, s32
    s_lshl_b32 s28, s24, 10
    s_lshr_b32 s34, s32, 1
    s_mul_i32 s34, s34, 20
    s_and_b32 s35, s32, 1
    s_lshl_b32 s35, s35, 3
    s_add_u32 s34, s34, s35
    s_cmp_eq_u32 s32, 4
    s_cselect_b32 s34, 16, s34
    s_cselect_b32 s35, 20, 4
    s_mul_i32 s36, s31, 160
    s_add_u32 s34, s34, s36
    s_mul_i32 s34, s34, 1280
    s_mul_i32 s36, s29, 160
    s_add_u32 s34, s34, s36
    v_add_u32 v182, 0, v0
    v_mul_u32_u24 v180, 6554, v182
    v_lshrrev_b32 v180, 16, v180
    v_mul_u32_u24 v181, 10, v180
    v_sub_u32 v181, v182, v181
    v_lshrrev_b32 v183, 3, v180
    v_mul_u32_u24 v183, 40, v183
    v_bfe_u32 v184, v180, 2, 1
    v_mul_u32_u24 v184, s35, v184
    v_and_b32_e64 v180, 3, v180
    v_add3_u32 v180, v180, v183, v184
    v_mul_u32_u24 v180, 1280, v180
    v_lshl_add_u32 v182, v181, 4, v180
    s_add_u32 m0, s28, 8192
    s_nop 0
    buffer_load_dwordx4 v182, s[12:15], s34 offen lds
    v_add_u32 v182, 256, v0
    v_min_u32 v182, 319, v182
    v_mul_u32_u24 v180, 6554, v182
    v_lshrrev_b32 v180, 16, v180
    v_mul_u32_u24 v181, 10, v180
    v_sub_u32 v181, v182, v181
    v_lshrrev_b32 v183, 3, v180
    v_mul_u32_u24 v183, 40, v183
    v_bfe_u32 v184, v180, 2, 1
    v_mul_u32_u24 v184, s35, v184
    v_and_b32 v180, 3, v180
    v_add3_u32 v180, v180, v183, v184
    v_mul_u32_u24 v180, 1280, v180
    v_lshl_add_u32 v182, v181, 4, v180
    s_add_u32 m0, s28, 12288
    s_nop 0
    buffer_load_dwordx4 v182, s[12:15], s34 offen lds
    v_bfe_u32 v183, v0, 4, 2
    v_bfe_u32 v184, v0, 2, 2
    v_lshl_add_u32 v183, v183, 3, v184
    v_mul_u32_u24 v183, 160, v183
    v_and_b32 v184, 3, v0
    v_lshl_add_u32 v185, v184, 3, v183
    v_add_u32 v185, 8192, v185
    s_lshl_b32 s36, s24, 5
    v_add_u32 v186, s36, v185
    s_mul_i32 s33, s33, 5120
    s_add_u32 s33, s33, 2621440
    v_lshl_add_u32 v187, v1, 4, s33
    v_add_u32 v184, 4096, v187
    v_mov_b32 v183, 1073741824
    v_cmp_gt_u32 vcc, 64, v0
    s_sub_u32 s36, s24, s31
    s_and_b32 s36, s36, 3
    s_lshl_b32 s36, s36, 10
    v_cndmask_b32 v188, v183, v184, vcc
    v_add_u32 v187, s36, v187
    v_mov_b32 v216, 0
    v_mov_b32 v217, 0
    v_mov_b32 v218, 0
    v_mov_b32 v219, 0
    v_mov_b32 v220, 0
    v_mov_b32 v221, 0
    v_mov_b32 v222, 0
    v_mov_b32 v223, 0
    v_mov_b32 v224, 0
    v_mov_b32 v225, 0
    v_mov_b32 v226, 0
    v_mov_b32 v227, 0
    v_mov_b32 v228, 0
    v_mov_b32 v229, 0
    v_mov_b32 v230, 0
    v_mov_b32_e64 v231, 0
    s_waitcnt vmcnt(5)
    s_barrier
    ds_read_b64_tr_b16 v[96:97], v111
    ds_read_b64_tr_b16 v[98:99], v111 offset:2560
    ds_read_b64_tr_b16 v[100:101], v112
    ds_read_b64_tr_b16 v[102:103], v112 offset:2560
    ds_read_b64_tr_b16 v[104:105], v113
    ds_read_b64_tr_b16 v[106:107], v113 offset:2560
    s_waitcnt lgkmcnt(4)
    buffer_store_dwordx4 v[96:99], v108, s[16:19], 0 offen sc1
    s_waitcnt lgkmcnt(2)
    buffer_store_dwordx4 v[100:103], v109, s[16:19], 0 offen sc1
    s_waitcnt lgkmcnt(0)
    buffer_store_dwordx4 v[104:107], v110, s[16:19], 0 offen sc1
    global_load_dword v7, v5, s[66:67] sc1
    v_lshrrev_b32 v132, 5, v0
    v_and_b32_e64 v133, 31, v0
    v_mul_u32_u24 v132, 1280, v132
    v_lshl_add_u32 v134, v133, 4, v132
    v_mov_b32 v135, 1073741824
    v_cmp_gt_u32 vcc, 16, v133
    s_mul_i32 s96, s2, 10240
    buffer_load_dwordx4 v[120:123], v134, s[4:7], s96 offen
    v_cndmask_b32_e64 v135, v135, v134, vcc
    buffer_load_dwordx4 v[124:127], v134, s[4:7], s96 offen offset:512
    buffer_load_dwordx4 v[128:131], v135, s[4:7], s96 offen offset:1024
    s_waitcnt vmcnt(4)
    s_waitcnt vmcnt(3)
    v_cmp_gt_u32 vcc, 1, v7
    s_nop 0
    s_and_b64 vcc, vcc, s[50:51]
    s_and_b64 vcc, vcc, 1
    s_cbranch_scc1 ps_11
pc_13:
    s_barrier
    v_lshlrev_b32 v2, 3, v4
    v_mov_b32 v5, 1
    v_cndmask_b32 v2, v4, v2, s[50:51]
    buffer_atomic_add v5, v2, s[16:19], s86 offen offset:0 sc1
    ds_read_b64_tr_b16 v[172:173], v166
    ds_read_b64_tr_b16 v[174:175], v166 offset:640
    ds_read_b64_tr_b16 v[176:177], v165 offset:128
    ds_read_b64_tr_b16 v[178:179], v165 offset:768
    s_waitcnt lgkmcnt(2)
    buffer_store_dwordx4 v[172:175], v167, s[16:19], 0 offen sc1
    s_waitcnt lgkmcnt(0)
    buffer_store_dwordx4 v[176:179], v168, s[16:19], 0 offen sc1
    ds_read_b64_tr_b16 v[192:193], v186
    ds_read_b64_tr_b16 v[194:195], v186 offset:640
    ds_read_b64_tr_b16 v[196:197], v185 offset:128
    ds_read_b64_tr_b16 v[198:199], v185 offset:768
    s_waitcnt lgkmcnt(2)
    buffer_store_dwordx4 v[192:195], v187, s[16:19], 0 offen sc1
    s_waitcnt lgkmcnt(0)
    buffer_store_dwordx4 v[196:199], v188, s[16:19], 0 offen sc1
    v_mov_b32 v134, 0x3f803f80
    v_mov_b32 v132, 0
    v_mov_b32 v133, 0
    s_waitcnt vmcnt(7)
    v_dot2c_f32_bf16 v132, v120, v134
    v_dot2c_f32_bf16 v133, v120, v120
    v_dot2c_f32_bf16 v132, v121, v134
    v_dot2c_f32_bf16 v133, v121, v121
    v_dot2c_f32_bf16 v132, v122, v134
    v_dot2c_f32_bf16 v133, v122, v122
    v_dot2c_f32_bf16 v132, v123, v134
    v_dot2c_f32_bf16 v133, v123, v123
    s_waitcnt vmcnt(6)
    v_dot2c_f32_bf16 v132, v124, v134
    v_dot2c_f32_bf16 v133, v124, v124
    v_dot2c_f32_bf16 v132, v125, v134
    v_dot2c_f32_bf16 v133, v125, v125
    v_dot2c_f32_bf16 v132, v126, v134
    v_dot2c_f32_bf16 v133, v126, v126
    v_dot2c_f32_bf16 v132, v127, v134
    v_dot2c_f32_bf16 v133, v127, v127
    s_waitcnt vmcnt(5)
    v_dot2c_f32_bf16 v132, v128, v134
    v_dot2c_f32_bf16 v133, v128, v128
    v_dot2c_f32_bf16 v132, v129, v134
    v_dot2c_f32_bf16 v133, v129, v129
    v_dot2c_f32_bf16 v132, v130, v134
    v_dot2c_f32_bf16 v133, v130, v130
    v_dot2c_f32_bf16 v132, v131, v134
    v_dot2c_f32_bf16 v133, v131, v131
    v_lshrrev_b32 v135, 5, v0
    v_and_b32 v121, 3, v135
    v_lshrrev_b32 v135, 2, v135
    v_add_f32_dpp v132, v132, v132 row_shr:1 row_mask:0xf bank_mask:0xf bound_ctrl:0
    v_add_f32_dpp v133, v133, v133 row_shr:1 row_mask:0xf bank_mask:0xf bound_ctrl:0
    v_lshlrev_b32_e64 v135, 3, v135
    v_add_f32_dpp v132, v132, v132 row_shr:2 row_mask:0xf bank_mask:0xf bound_ctrl:0
    v_add_f32_dpp v133, v133, v133 row_shr:2 row_mask:0xf bank_mask:0xf bound_ctrl:0
    v_lshl_add_u32 v135, v121, 12, v135
    v_add_f32_dpp v132, v132, v132 row_shr:4 row_mask:0xf bank_mask:0xf bound_ctrl:0
    v_add_f32_dpp v133, v133, v133 row_shr:4 row_mask:0xf bank_mask:0xf bound_ctrl:0
    v_and_b32_e64 v121, 31, v0
    v_add_f32_dpp v132, v132, v132 row_shr:8 row_mask:0xf bank_mask:0xf bound_ctrl:0
    v_add_f32_dpp v133, v133, v133 row_shr:8 row_mask:0xf bank_mask:0xf bound_ctrl:0
    v_cmp_eq_u32_e64 vcc, 31, v121
    v_add_f32_dpp v132, v132, v132 row_bcast:15 row_mask:0xa bank_mask:0xf
    v_add_f32_dpp v133, v133, v133 row_bcast:15 row_mask:0xa bank_mask:0xf
    v_mov_b32 v121, 1073741824
    v_cndmask_b32_e64 v120, v121, v135, vcc
    s_lshl_b32 s96, s2, 4
    s_add_u32 s96, s96, 3440640
    v_mul_f32 v135, 0x3acccccd, v132
    v_mul_f32 v133, 0x3acccccd, v133
    v_fma_f32 v133, -v135, v135, v133
    v_max_f32 v133, 0, v133
    v_add_f32 v133, 0x3727c5ac, v133
    v_rsq_f32_e64 v132, v133
    s_nop 0
    v_mul_f32 v133, -v135, v132
    buffer_store_dwordx2 v[132:133], v120, s[16:19], s96 offen sc1
    s_add_u32 m0, s92, 36352
    s_nop 0
    s_nop 0
    buffer_load_dwordx4 v73, s[4:7], s99 offen offset:0  lds
    buffer_load_dwordx4 v74, s[4:7], s99 offen offset:1088  lds
    buffer_load_dwordx4 v75, s[4:7], s99 offen offset:2176  lds
    buffer_load_dwordx4 v76, s[4:7], s99 offen offset:3264  lds
    s_add_u32 m0, s93, 53760
    s_add_u32 s99, s99, 256
    s_mov_b64 exec, s[80:81]
    buffer_load_dwordx4 v77, s[4:7], s100 offen  lds
    s_mov_b64 exec, -1
    s_add_u32 s100, s100, 256
    s_add_u32 m0, s92, 55936
    s_nop 0
    s_nop 0
    buffer_load_dwordx4 v73, s[4:7], s99 offen offset:0  lds
    buffer_load_dwordx4 v74, s[4:7], s99 offen offset:1088  lds
    buffer_load_dwordx4 v75, s[4:7], s99 offen offset:2176  lds
    buffer_load_dwordx4 v76, s[4:7], s99 offen offset:3264  lds
    s_add_u32 m0, s93, 73344
    s_add_u32 s99, s99, 256
    s_mov_b64 exec, s[80:81]
    buffer_load_dwordx4 v77, s[4:7], s100 offen  lds
    s_mov_b64 exec, -1
    s_add_u32 s100, s100, 256
    v_mov_b32 v140, 1073741824
    v_lshlrev_b32 v141, 2, v0
    v_cmp_gt_u32 vcc, 64, v0
    s_nop 1
    v_cndmask_b32 v141, v140, v141, vcc
    v_mov_b32_e64 v140, 0
    s_lshl_b32 s97, s2, 8
    s_add_u32 s97, s97, 3473408
    buffer_store_dword v140, v141, s[16:19], s97 offen sc1
    v_mov_b32 v142, 1073741824
    v_lshlrev_b32 v143, 2, v0
    v_cmp_gt_u32 vcc, 16, v0
    s_nop 1
    v_cndmask_b32 v143, v142, v143, vcc
    v_mov_b32_e64 v142, -1
    s_lshl_b32 s97, s2, 6
    s_add_u32 s97, s97, 3457024
    buffer_store_dword v142, v143, s[16:19], s97 offen sc1
    v_mov_b32 v144, -1
    v_mov_b32 v145, -1
    v_mov_b32 v146, -1
    v_mov_b32 v147, -1
    v_lshlrev_b32 v148, 4, v0
    s_sub_u32 s88, s2, 0
    s_mul_i32 s88, s88, 20480
    s_min_u32 s88, s88, 5222400
    s_add_u32 s88, s88, 4194304
    buffer_store_dwordx4 v[144:147], v148, s[16:19], s88 offen sc1
    s_add_u32 s88, s88, 4096
    buffer_store_dwordx4 v[144:147], v148, s[16:19], s88 offen sc1
    s_add_u32 s88, s88, 4096
    buffer_store_dwordx4 v[144:147], v148, s[16:19], s88 offen sc1
    s_add_u32 s88, s88, 4096
    buffer_store_dwordx4 v[144:147], v148, s[16:19], s88 offen sc1
    s_add_u32 s88, s88, 4096
    buffer_store_dwordx4 v[144:147], v148, s[16:19], s88 offen sc1
    s_add_u32 m0, s92, 75520
    s_nop 0
    s_nop 0
    buffer_load_dwordx4 v73, s[4:7], s99 offen offset:0  lds
    buffer_load_dwordx4 v74, s[4:7], s99 offen offset:1088  lds
    buffer_load_dwordx4 v75, s[4:7], s99 offen offset:2176  lds
    buffer_load_dwordx4 v76, s[4:7], s99 offen offset:3264  lds
    s_add_u32 m0, s93, 92928
    s_add_u32 s99, s99, 256
    s_mov_b64 exec, s[80:81]
    buffer_load_dwordx4 v77, s[4:7], s100 offen  lds
    s_mov_b64 exec, -1
    s_add_u32 s100, s100, 256
    s_add_u32 m0, s92, 95104
    s_nop 0
    s_nop 0
    buffer_load_dwordx4 v73, s[4:7], s99 offen offset:0  lds
    buffer_load_dwordx4 v74, s[4:7], s99 offen offset:1088  lds
    buffer_load_dwordx4 v75, s[4:7], s99 offen offset:2176  lds
    buffer_load_dwordx4 v76, s[4:7], s99 offen offset:3264  lds
    s_add_u32 m0, s93, 112512
    s_add_u32 s99, s99, 256
    s_mov_b64 exec, s[80:81]
    buffer_load_dwordx4 v77, s[4:7], s100 offen  lds
    s_mov_b64 exec, -1
    s_add_u32 s100, s100, 256
    s_add_u32 m0, s92, 114688
    s_nop 0
    s_nop 0
    buffer_load_dwordx4 v73, s[4:7], s99 offen offset:0  lds
    buffer_load_dwordx4 v74, s[4:7], s99 offen offset:1088  lds
    buffer_load_dwordx4 v75, s[4:7], s99 offen offset:2176  lds
    buffer_load_dwordx4 v76, s[4:7], s99 offen offset:3264  lds
    s_add_u32 m0, s93, 132096
    s_add_u32 s99, s99, 256
    s_mov_b64 exec, s[80:81]
    buffer_load_dwordx4 v77, s[4:7], s100 offen  lds
    s_mov_b64 exec, -1
    s_add_u32 s100, s100, 256
    s_waitcnt vmcnt(15)
    buffer_load_dword v7, v4, s[16:19], s87 offen offset:0 sc1
    s_waitcnt vmcnt(0)
    v_cmp_gt_u32_e64 vcc, 32, v7
    s_nop 0
    s_and_b64 vcc, vcc, s[50:51]
    s_cbranch_scc1 ps_14
pc_16:
    s_barrier
    buffer_load_dwordx4 a[0:3], v200, s[16:19], s101 offen offset:0 sc1
    buffer_load_dwordx4 a[4:7], v200, s[16:19], s101 offen offset:1024 sc1
    buffer_load_dwordx4 a[8:11], v200, s[16:19], s101 offen offset:2048 sc1
    buffer_load_dwordx4 a[12:15], v200, s[16:19], s101 offen offset:3072 sc1
    s_add_u32 s101, s101, 4096
    buffer_load_dwordx4 a[16:19], v200, s[16:19], s101 offen offset:0 sc1
    buffer_load_dwordx4 a[20:23], v200, s[16:19], s101 offen offset:1024 sc1
    buffer_load_dwordx4 a[24:27], v200, s[16:19], s101 offen offset:2048 sc1
    buffer_load_dwordx4 a[28:31], v200, s[16:19], s101 offen offset:3072 sc1
    s_add_u32 s101, s101, 4096
    buffer_load_dwordx4 a[32:35], v200, s[16:19], s101 offen offset:0 sc1
    buffer_load_dwordx4 a[36:39], v200, s[16:19], s101 offen offset:1024 sc1
    buffer_load_dwordx4 a[40:43], v200, s[16:19], s101 offen offset:2048 sc1
    buffer_load_dwordx4 a[44:47], v200, s[16:19], s101 offen offset:3072 sc1
    s_add_u32 s101, s101, 4096
    buffer_load_dwordx4 a[48:51], v200, s[16:19], s101 offen offset:0 sc1
    buffer_load_dwordx4 a[52:55], v200, s[16:19], s101 offen offset:1024 sc1
ec_4:
    v_add_u32 v196, 36352, v78
    v_mov_b32 v198, v79
    v_xor_b32 v197, 32, v196
    s_waitcnt vmcnt(34)
    s_barrier
    s_add_u32 s82, s86, 16384
    v_lshlrev_b32 v2, 3, v4
    v_mov_b32 v5, 1
    v_cndmask_b32 v2, v4, v2, s[50:51]
    buffer_atomic_add v5, v2, s[16:19], s82 offen offset:8 sc1
    ds_read_b128 v[160:163], v198 offset:0
    ds_read_b128 v[164:167], v196 offset:0
    ds_read_b128 v[168:171], v196 offset:8704
    ds_read_b128 v[172:175], v198 offset:32
    ds_read_b128 v[176:179], v197 offset:0
    ds_read_b128 v[180:183], v197 offset:8704
    s_waitcnt lgkmcnt(3)
    s_waitcnt vmcnt(14)
    v_mfma_f32_16x16x32_bf16 v[112:115], a[0:3], v[160:163], 0
    ds_read_b128 v[184:187], v198 offset:64
    v_mfma_f32_32x32x16_bf16 v[80:95], a[0:3], v[164:167], 0
    ds_read_b128 v[188:191], v196 offset:64
    v_mov_b32 v208, 0
    v_mov_b32 v209, 0
    v_lshrrev_b32_e64 v210, 5, v0
    v_mul_u32_u24 v210, 1600, v210
    v_mfma_f32_32x32x16_bf16 v[96:111], a[0:3], v[168:171], 0
    ds_read_b128 v[192:195], v196 offset:8768
    buffer_load_dwordx4 a[56:59], v200, s[16:19], s101 offen offset:2048 sc1
    v_and_b32 v211, 31, v0
    v_min_u32 v211, 19, v211
    s_waitcnt lgkmcnt(3)
    s_waitcnt vmcnt(14)
    v_mfma_f32_16x16x32_bf16 v[112:115], a[4:7], v[172:175], v[112:115]
    ds_read_b128 v[160:163], v198 offset:96
    v_mfma_f32_32x32x16_bf16 v[80:95], a[4:7], v[176:179], v[80:95]
    ds_read_b128 v[164:167], v197 offset:64
    v_lshl_add_u32 v210, v211, 3, v210
    v_add_u32 v210, 6400, v210
    ds_write_b64 v210, v[208:209]
    s_mul_i32 s33, s24, 4160
    v_mfma_f32_32x32x16_bf16 v[96:111], a[4:7], v[180:183], v[96:111]
    ds_read_b128 v[168:171], v197 offset:8768
    buffer_load_dwordx4 a[60:63], v200, s[16:19], s101 offen offset:3072 sc1
    s_add_u32 s33, s33, 134272
    v_and_b32_e64 v250, 31, v1
    s_waitcnt lgkmcnt(4)
    s_waitcnt vmcnt(14)
    v_mfma_f32_16x16x32_bf16 v[112:115], a[8:11], v[184:187], v[112:115]
    ds_read_b128 v[172:175], v198 offset:128
    v_mfma_f32_32x32x16_bf16 v[80:95], a[8:11], v[188:191], v[80:95]
    ds_read_b128 v[176:179], v196 offset:128
    v_lshl_add_u32 v250, v250, 4, s33
    v_lshrrev_b32_e64 v253, 5, v1
    v_lshl_add_u32 v251, v253, 3, v250
    v_lshl_add_u32 v252, v253, 9, v250
    v_mfma_f32_32x32x16_bf16 v[96:111], a[8:11], v[192:195], v[96:111]
    ds_read_b128 v[180:183], v196 offset:8832
    s_add_u32 s101, s101, 4096
    buffer_load_dwordx4 a[64:67], v200, s[16:19], s101 offen offset:0 sc1
    v_lshl_add_u32 v250, v253, 10, v250
    s_waitcnt lgkmcnt(3)
    s_waitcnt vmcnt(14)
    v_mfma_f32_16x16x32_bf16 v[112:115], a[12:15], v[160:163], v[112:115]
    ds_read_b128 v[184:187], v198 offset:160
    v_mfma_f32_32x32x16_bf16 v[80:95], a[12:15], v[164:167], v[80:95]
    ds_read_b128 v[188:191], v197 offset:128
    v_cmp_eq_u32 vcc, 0, v1
    v_lshlrev_b32 v254, 16, v241
    v_min_u32 v253, 15, v1
    v_cndmask_b32 v254, 0, v254, vcc
    v_mfma_f32_32x32x16_bf16 v[96:111], a[12:15], v[168:171], v[96:111]
    ds_read_b128 v[192:195], v197 offset:8832
    buffer_load_dwordx4 a[68:71], v200, s[16:19], s101 offen offset:1024 sc1
    v_lshl_add_u32 v253, v253, 2, s33
    v_add_f32_e64 v216, v216, v254
    s_waitcnt lgkmcnt(3)
    s_waitcnt vmcnt(14)
    v_mfma_f32_16x16x32_bf16 v[112:115], a[16:19], v[172:175], v[112:115]
    ds_read_b128 v[160:163], v198 offset:192
    v_mfma_f32_32x32x16_bf16 v[80:95], a[16:19], v[176:179], v[80:95]
    ds_read_b128 v[164:167], v196 offset:192
    v_and_b32 v254, 1, v1
    v_cmp_eq_u32 vcc, 1, v254
    v_mov_b32_e64 v254, 0
    v_cvt_pk_bf16_f32 v242, v216, v217
    v_mfma_f32_32x32x16_bf16 v[96:111], a[16:19], v[180:183], v[96:111]
    ds_read_b128 v[168:171], v196 offset:8896
    buffer_load_dwordx4 a[72:75], v200, s[16:19], s101 offen offset:2048 sc1
    v_cvt_pk_bf16_f32 v243, v218, v219
    v_cvt_pk_bf16_f32 v244, v220, v220
    s_waitcnt lgkmcnt(3)
    s_waitcnt vmcnt(14)
    v_mfma_f32_16x16x32_bf16 v[112:115], a[20:23], v[184:187], v[112:115]
    ds_read_b128 v[172:175], v198 offset:224
    v_mfma_f32_32x32x16_bf16 v[80:95], a[20:23], v[188:191], v[80:95]
    ds_read_b128 v[176:179], v197 offset:192
    v_cvt_pk_bf16_f32 v245, v221, v222
    v_cvt_pk_bf16_f32 v246, v224, v224
    v_cvt_pk_bf16_f32 v247, v224, v225
    v_cvt_pk_bf16_f32 v248, v225, v225
    v_mfma_f32_32x32x16_bf16 v[96:111], a[20:23], v[192:195], v[96:111]
    ds_read_b128 v[180:183], v197 offset:8896
    buffer_load_dwordx4 a[76:79], v200, s[16:19], s101 offen offset:3072 sc1
    v_cvt_pk_bf16_f32 v249, v226, v226
    ds_write_b32 v253, v254
    s_barrier
    s_waitcnt lgkmcnt(4)
    s_waitcnt vmcnt(14)
    v_mfma_f32_16x16x32_bf16 v[112:115], a[24:27], v[160:163], v[112:115]
    v_add_u32 v198, v49, v198
    v_mfma_f32_32x32x16_bf16 v[80:95], a[24:27], v[164:167], v[80:95]
    v_add_u32 v196, 19584, v196
    v_add_u32 v197, 19584, v197
    ds_read_b128 v[184:187], v198 offset:0
    ds_write_b64 v251, v[242:243] offset:64
    ds_write_b64 v251, v[244:245] offset:576
    v_mfma_f32_32x32x16_bf16 v[96:111], a[24:27], v[168:171], v[96:111]
    ds_read_b128 v[188:191], v196 offset:0
    ds_read_b128 v[192:195], v196 offset:8704
    s_add_u32 s101, s101, 4096
    buffer_load_dwordx4 a[80:83], v200, s[16:19], s101 offen offset:0 sc1
    s_waitcnt lgkmcnt(6)
    s_waitcnt vmcnt(14)
    v_mfma_f32_16x16x32_bf16 v[112:115], a[28:31], v[172:175], v[112:115]
    ds_read_b128 v[160:163], v198 offset:32
    v_mfma_f32_32x32x16_bf16 v[80:95], a[28:31], v[176:179], v[80:95]
    ds_read_b128 v[164:167], v197 offset:0
    ds_write_b128 v252, v[246:249] offset:1088
    v_cndmask_b32 v255, v228, v229, vcc
    v_cvt_pk_bf16_f32 v216, v228, v228
    v_mov_b32 v217, v216
    v_mfma_f32_32x32x16_bf16 v[96:111], a[28:31], v[180:183], v[96:111]
    ds_read_b128 v[168:171], v197 offset:8704
    buffer_load_dwordx4 a[84:87], v200, s[16:19], s101 offen offset:1024 sc1
    v_cvt_pk_bf16_f32 v218, v255, v229
    v_cvt_pk_bf16_f32 v219, v229, v229
    s_waitcnt lgkmcnt(4)
    s_waitcnt vmcnt(14)
    v_mfma_f32_16x16x32_bf16 v[112:115], a[32:35], v[184:187], v[112:115]
    ds_read_b128 v[172:175], v198 offset:64
    v_mfma_f32_32x32x16_bf16 v[80:95], a[32:35], v[188:191], v[80:95]
    ds_read_b128 v[176:179], v196 offset:64
    ds_write_b128 v250, v[216:219] offset:2112
    v_cndmask_b32 v255, v230, v231, vcc
    v_cvt_pk_bf16_f32 v220, v230, v230
    v_mov_b32 v221, v220
    v_mfma_f32_32x32x16_bf16 v[96:111], a[32:35], v[192:195], v[96:111]
    ds_read_b128 v[180:183], v196 offset:8768
    buffer_load_dwordx4 a[88:91], v200, s[16:19], s101 offen offset:2048 sc1
    v_cvt_pk_bf16_f32 v222, v255, v231
    v_cvt_pk_bf16_f32 v223, v231, v231
    s_waitcnt lgkmcnt(4)
    s_waitcnt vmcnt(14)
    v_mfma_f32_16x16x32_bf16 v[112:115], a[36:39], v[160:163], v[112:115]
    ds_read_b128 v[184:187], v198 offset:96
    v_mfma_f32_32x32x16_bf16 v[80:95], a[36:39], v[164:167], v[80:95]
    ds_read_b128 v[188:191], v197 offset:64
    ds_write_b128 v250, v[220:223] offset:2624
    v_mfma_f32_32x32x16_bf16 v[96:111], a[36:39], v[168:171], v[96:111]
    ds_read_b128 v[192:195], v197 offset:8768
    buffer_load_dwordx4 a[92:95], v200, s[16:19], s101 offen offset:3072 sc1
    s_waitcnt lgkmcnt(4)
    s_waitcnt vmcnt(14)
    v_mfma_f32_16x16x32_bf16 v[112:115], a[40:43], v[172:175], v[112:115]
    ds_read_b128 v[160:163], v198 offset:128
    v_mfma_f32_32x32x16_bf16 v[80:95], a[40:43], v[176:179], v[80:95]
    ds_read_b128 v[164:167], v196 offset:128
    v_mfma_f32_32x32x16_bf16 v[96:111], a[40:43], v[180:183], v[96:111]
    ds_read_b128 v[168:171], v196 offset:8832
    s_add_u32 s101, s101, 4096
    buffer_load_dwordx4 a[96:99], v200, s[16:19], s101 offen offset:0 sc1
    s_waitcnt lgkmcnt(3)
    s_waitcnt vmcnt(14)
    v_mfma_f32_16x16x32_bf16 v[112:115], a[44:47], v[184:187], v[112:115]
    ds_read_b128 v[172:175], v198 offset:160
    v_mfma_f32_32x32x16_bf16 v[80:95], a[44:47], v[188:191], v[80:95]
    ds_read_b128 v[176:179], v197 offset:128
    v_mfma_f32_32x32x16_bf16 v[96:111], a[44:47], v[192:195], v[96:111]
    ds_read_b128 v[180:183], v197 offset:8832
    buffer_load_dwordx4 a[100:103], v200, s[16:19], s101 offen offset:1024 sc1
    s_waitcnt lgkmcnt(3)
    s_waitcnt vmcnt(14)
    v_mfma_f32_16x16x32_bf16 v[112:115], a[48:51], v[160:163], v[112:115]
    ds_read_b128 v[184:187], v198 offset:192
    v_mfma_f32_32x32x16_bf16 v[80:95], a[48:51], v[164:167], v[80:95]
    ds_read_b128 v[188:191], v196 offset:192
    v_mfma_f32_32x32x16_bf16 v[96:111], a[48:51], v[168:171], v[96:111]
    ds_read_b128 v[192:195], v196 offset:8896
    buffer_load_dwordx4 a[104:107], v200, s[16:19], s101 offen offset:2048 sc1
    s_waitcnt lgkmcnt(3)
    s_waitcnt vmcnt(14)
    v_mfma_f32_16x16x32_bf16 v[112:115], a[52:55], v[172:175], v[112:115]
    ds_read_b128 v[160:163], v198 offset:224
    v_mfma_f32_32x32x16_bf16 v[80:95], a[52:55], v[176:179], v[80:95]
    ds_read_b128 v[164:167], v197 offset:192
    v_mfma_f32_32x32x16_bf16 v[96:111], a[52:55], v[180:183], v[96:111]
    ds_read_b128 v[168:171], v197 offset:8896
    buffer_load_dwordx4 a[108:111], v200, s[16:19], s101 offen offset:3072 sc1
    s_barrier
    s_waitcnt lgkmcnt(3)
    s_waitcnt vmcnt(13)
    v_mfma_f32_16x16x32_bf16 v[112:115], a[56:59], v[184:187], v[112:115]
    v_add_u32 v198, v49, v198
    v_mfma_f32_32x32x16_bf16 v[80:95], a[56:59], v[188:191], v[80:95]
    v_add_u32 v196, 19584, v196
    v_add_u32 v197, 19584, v197
    ds_read_b128 v[172:175], v198 offset:0
    v_mfma_f32_32x32x16_bf16 v[96:111], a[56:59], v[192:195], v[96:111]
    ds_read_b128 v[176:179], v196 offset:0
    ds_read_b128 v[180:183], v196 offset:8704
    s_add_u32 s101, s101, 4096
    buffer_load_dwordx4 a[112:115], v200, s[16:19], s101 offen offset:0 sc1
    s_waitcnt lgkmcnt(3)
    s_waitcnt vmcnt(13)
    v_mfma_f32_16x16x32_bf16 v[112:115], a[60:63], v[160:163], v[112:115]
    ds_read_b128 v[184:187], v198 offset:32
    v_mfma_f32_32x32x16_bf16 v[80:95], a[60:63], v[164:167], v[80:95]
    ds_read_b128 v[188:191], v197 offset:0
    v_mfma_f32_32x32x16_bf16 v[96:111], a[60:63], v[168:171], v[96:111]
    ds_read_b128 v[192:195], v197 offset:8704
    buffer_load_dwordx4 a[116:119], v200, s[16:19], s101 offen offset:1024 sc1
    s_waitcnt lgkmcnt(3)
    s_waitcnt vmcnt(13)
    v_mfma_f32_16x16x32_bf16 v[112:115], a[64:67], v[172:175], v[112:115]
    ds_read_b128 v[160:163], v198 offset:64
    v_mfma_f32_32x32x16_bf16 v[80:95], a[64:67], v[176:179], v[80:95]
    ds_read_b128 v[164:167], v196 offset:64
    v_mfma_f32_32x32x16_bf16 v[96:111], a[64:67], v[180:183], v[96:111]
    ds_read_b128 v[168:171], v196 offset:8768
    buffer_load_dwordx4 a[120:123], v200, s[16:19], s101 offen offset:2048 sc1
    s_waitcnt lgkmcnt(3)
    s_waitcnt vmcnt(13)
    v_mfma_f32_16x16x32_bf16 v[112:115], a[68:71], v[184:187], v[112:115]
    ds_read_b128 v[172:175], v198 offset:96
    v_mfma_f32_32x32x16_bf16 v[80:95], a[68:71], v[188:191], v[80:95]
    ds_read_b128 v[176:179], v197 offset:64
    v_mfma_f32_32x32x16_bf16 v[96:111], a[68:71], v[192:195], v[96:111]
    ds_read_b128 v[180:183], v197 offset:8768
    buffer_load_dwordx4 a[124:127], v200, s[16:19], s101 offen offset:3072 sc1
    s_waitcnt lgkmcnt(3)
    s_waitcnt vmcnt(13)
    v_mfma_f32_16x16x32_bf16 v[112:115], a[72:75], v[160:163], v[112:115]
    ds_read_b128 v[184:187], v198 offset:128
    v_mfma_f32_32x32x16_bf16 v[80:95], a[72:75], v[164:167], v[80:95]
    ds_read_b128 v[188:191], v196 offset:128
    v_mfma_f32_32x32x16_bf16 v[96:111], a[72:75], v[168:171], v[96:111]
    ds_read_b128 v[192:195], v196 offset:8832
    s_add_u32 s101, s101, 4096
    buffer_load_dwordx4 a[128:131], v200, s[16:19], s101 offen offset:0 sc1
    s_waitcnt lgkmcnt(3)
    s_waitcnt vmcnt(13)
    v_mfma_f32_16x16x32_bf16 v[112:115], a[76:79], v[172:175], v[112:115]
    ds_read_b128 v[160:163], v198 offset:160
    v_mfma_f32_32x32x16_bf16 v[80:95], a[76:79], v[176:179], v[80:95]
    ds_read_b128 v[164:167], v197 offset:128
    v_mfma_f32_32x32x16_bf16 v[96:111], a[76:79], v[180:183], v[96:111]
    ds_read_b128 v[168:171], v197 offset:8832
    buffer_load_dwordx4 a[132:135], v200, s[16:19], s101 offen offset:1024 sc1
    s_waitcnt lgkmcnt(3)
    s_waitcnt vmcnt(13)
    v_mfma_f32_16x16x32_bf16 v[112:115], a[80:83], v[184:187], v[112:115]
    ds_read_b128 v[172:175], v198 offset:192
    v_mfma_f32_32x32x16_bf16 v[80:95], a[80:83], v[188:191], v[80:95]
    ds_read_b128 v[176:179], v196 offset:192
    v_mfma_f32_32x32x16_bf16 v[96:111], a[80:83], v[192:195], v[96:111]
    ds_read_b128 v[180:183], v196 offset:8896
    buffer_load_dwordx4 a[136:139], v200, s[16:19], s101 offen offset:2048 sc1
    s_waitcnt lgkmcnt(3)
    s_waitcnt vmcnt(13)
    v_mfma_f32_16x16x32_bf16 v[112:115], a[84:87], v[160:163], v[112:115]
    ds_read_b128 v[184:187], v198 offset:224
    v_mfma_f32_32x32x16_bf16 v[80:95], a[84:87], v[164:167], v[80:95]
    ds_read_b128 v[188:191], v197 offset:192
    v_mfma_f32_32x32x16_bf16 v[96:111], a[84:87], v[168:171], v[96:111]
    ds_read_b128 v[192:195], v197 offset:8896
    buffer_load_dwordx4 a[140:143], v200, s[16:19], s101 offen offset:3072 sc1
    s_barrier
    s_waitcnt lgkmcnt(3)
    s_waitcnt vmcnt(13)
    v_mfma_f32_16x16x32_bf16 v[112:115], a[88:91], v[172:175], v[112:115]
    v_add_u32 v198, v49, v198
    v_mfma_f32_32x32x16_bf16 v[80:95], a[88:91], v[176:179], v[80:95]
    v_add_u32 v196, 19584, v196
    v_add_u32 v197, 19584, v197
    ds_read_b128 v[160:163], v198 offset:0
    v_mfma_f32_32x32x16_bf16 v[96:111], a[88:91], v[180:183], v[96:111]
    ds_read_b128 v[164:167], v196 offset:0
    ds_read_b128 v[168:171], v196 offset:8704
    s_add_u32 s101, s101, 4096
    buffer_load_dword v7, v4, s[16:19], s89 offen offset:8 sc1
    s_waitcnt lgkmcnt(3)
    s_waitcnt vmcnt(13)
    v_mfma_f32_16x16x32_bf16 v[112:115], a[92:95], v[184:187], v[112:115]
    ds_read_b128 v[172:175], v198 offset:32
    v_mfma_f32_32x32x16_bf16 v[80:95], a[92:95], v[188:191], v[80:95]
    ds_read_b128 v[176:179], v197 offset:0
    v_mfma_f32_32x32x16_bf16 v[96:111], a[92:95], v[192:195], v[96:111]
    ds_read_b128 v[180:183], v197 offset:8704
    buffer_load_dwordx4 a[144:147], v200, s[16:19], s101 offen offset:0 sc1
    s_waitcnt lgkmcnt(3)
    s_waitcnt vmcnt(13)
    v_mfma_f32_16x16x32_bf16 v[112:115], a[96:99], v[160:163], v[112:115]
    ds_read_b128 v[184:187], v198 offset:64
    v_mfma_f32_32x32x16_bf16 v[80:95], a[96:99], v[164:167], v[80:95]
    ds_read_b128 v[188:191], v196 offset:64
    v_mfma_f32_32x32x16_bf16 v[96:111], a[96:99], v[168:171], v[96:111]
    ds_read_b128 v[192:195], v196 offset:8768
    buffer_load_dwordx4 a[148:151], v200, s[16:19], s101 offen offset:1024 sc1
    s_waitcnt lgkmcnt(3)
    s_waitcnt vmcnt(13)
    v_mfma_f32_16x16x32_bf16 v[112:115], a[100:103], v[172:175], v[112:115]
    ds_read_b128 v[160:163], v198 offset:96
    v_mfma_f32_32x32x16_bf16 v[80:95], a[100:103], v[176:179], v[80:95]
    ds_read_b128 v[164:167], v197 offset:64
    v_mfma_f32_32x32x16_bf16 v[96:111], a[100:103], v[180:183], v[96:111]
    ds_read_b128 v[168:171], v197 offset:8768
    buffer_load_dwordx4 a[152:155], v200, s[16:19], s101 offen offset:2048 sc1
    s_waitcnt lgkmcnt(3)
    s_waitcnt vmcnt(13)
    v_mfma_f32_16x16x32_bf16 v[112:115], a[104:107], v[184:187], v[112:115]
    ds_read_b128 v[172:175], v198 offset:128
    v_mfma_f32_32x32x16_bf16 v[80:95], a[104:107], v[188:191], v[80:95]
    ds_read_b128 v[176:179], v196 offset:128
    v_mfma_f32_32x32x16_bf16 v[96:111], a[104:107], v[192:195], v[96:111]
    ds_read_b128 v[180:183], v196 offset:8832
    buffer_load_dwordx4 a[156:159], v200, s[16:19], s101 offen offset:3072 sc1
    s_waitcnt lgkmcnt(3)
    s_waitcnt vmcnt(13)
    v_mfma_f32_16x16x32_bf16 v[112:115], a[108:111], v[160:163], v[112:115]
    ds_read_b128 v[184:187], v198 offset:160
    v_mfma_f32_32x32x16_bf16 v[80:95], a[108:111], v[164:167], v[80:95]
    ds_read_b128 v[188:191], v197 offset:128
    v_mfma_f32_32x32x16_bf16 v[96:111], a[108:111], v[168:171], v[96:111]
    ds_read_b128 v[192:195], v197 offset:8832
    s_add_u32 s101, s101, 4096
    s_lshl_b32 s25, s72, 5
    s_add_u32 s25, s25, 256
    s_sub_u32 s26, s25, 4
    s_max_i32 s26, s26, 0
    s_mul_i32 s27, s71, 1280
    s_mul_i32 s99, s25, 5120
    s_mul_i32 s100, s26, 5120
    s_mul_i32 s92, s24, 4352
    s_mul_i32 s93, s24, 544
    s_add_u32 s99, s99, s27
    s_add_u32 s100, s100, s27
    s_waitcnt lgkmcnt(3)
    s_waitcnt vmcnt(12)
    v_mfma_f32_16x16x32_bf16 v[112:115], a[112:115], v[172:175], v[112:115]
    ds_read_b128 v[160:163], v198 offset:192
    v_mfma_f32_32x32x16_bf16 v[80:95], a[112:115], v[176:179], v[80:95]
    ds_read_b128 v[164:167], v196 offset:192
    v_mfma_f32_32x32x16_bf16 v[96:111], a[112:115], v[180:183], v[96:111]
    ds_read_b128 v[168:171], v196 offset:8896
    s_waitcnt lgkmcnt(3)
    s_waitcnt vmcnt(11)
    v_mfma_f32_16x16x32_bf16 v[112:115], a[116:119], v[184:187], v[112:115]
    ds_read_b128 v[172:175], v198 offset:224
    v_mfma_f32_32x32x16_bf16 v[80:95], a[116:119], v[188:191], v[80:95]
    ds_read_b128 v[176:179], v197 offset:192
    v_mfma_f32_32x32x16_bf16 v[96:111], a[116:119], v[192:195], v[96:111]
    ds_read_b128 v[180:183], v197 offset:8896
    s_waitcnt vmcnt(4)
    v_cmp_gt_u32 vcc, 32, v7
    s_nop 0
    s_and_b64 vcc, vcc, s[50:51]
    s_cbranch_scc1 ps_17
pc_19:
    s_barrier
    s_waitcnt lgkmcnt(3)
    v_mfma_f32_16x16x32_bf16 v[112:115], a[120:123], v[160:163], v[112:115]
    v_add_u32_e64 v198, v49, v198
    v_mfma_f32_32x32x16_bf16 v[80:95], a[120:123], v[164:167], v[80:95]
    v_add_u32 v196, 19584, v196
    v_add_u32 v197, 19584, v197
    s_lshl_b32 s31, s24, 7
    s_add_u32 s31, s31, 159744
    v_bfe_u32 v132, v1, 3, 1
    v_mfma_f32_32x32x16_bf16 v[96:111], a[120:123], v[168:171], v[96:111]
    ds_read_b128 v[184:187], v198 offset:0
    ds_read_b128 v[188:191], v196 offset:0
    s_lshl_b32 s98, s72, 5
    s_add_u32 s98, s98, 0
    s_sub_u32 s95, s98, 4
    s_max_i32 s95, s95, 0
    s_lshl_b32 s94, s98, 3
    s_lshl_b32 s95, s95, 3
    s_add_u32 s94, s94, 3440640
    s_add_u32 s95, s95, 3440640
    s_add_u32 s96, s94, 8192
    buffer_load_dwordx2 v[152:153], v47, s[16:19], s94 offen sc1
    v_lshrrev_b32 v133, 4, v1
    v_lshl_add_u32 v132, v132, 2, v133
    s_waitcnt lgkmcnt(2)
    v_mfma_f32_16x16x32_bf16 v[112:115], a[124:127], v[172:175], v[112:115]
    ds_read_b128 v[192:195], v198 offset:32
    v_mfma_f32_32x32x16_bf16 v[80:95], a[124:127], v[176:179], v[80:95]
    ds_read_b128 v[160:163], v197 offset:0
    v_lshl_add_u32 v132, v132, 4, s31
    v_lshrrev_b32 v133, 5, v1
    v_lshl_add_u32 v133, v133, 4, s31
    v_mfma_f32_32x32x16_bf16 v[96:111], a[124:127], v[180:183], v[96:111]
    buffer_load_dwordx2 v[154:155], v47, s[16:19], s96 offen sc1
    s_waitcnt lgkmcnt(2)
    v_mfma_f32_16x16x32_bf16 v[112:115], a[128:131], v[184:187], v[112:115]
    ds_read_b128 v[164:167], v198 offset:64
    v_mfma_f32_32x32x16_bf16 v[80:95], a[128:131], v[188:191], v[80:95]
    ds_read_b128 v[168:171], v196 offset:64
    s_waitcnt lgkmcnt(2)
    v_mfma_f32_16x16x32_bf16 v[112:115], a[132:135], v[192:195], v[112:115]
    ds_read_b128 v[172:175], v198 offset:96
    v_mfma_f32_32x32x16_bf16 v[80:95], a[132:135], v[160:163], v[80:95]
    ds_read_b128 v[176:179], v197 offset:64
    buffer_load_dwordx2 v[156:157], v48, s[16:19], s95 offen sc1
    s_waitcnt lgkmcnt(2)
    v_mfma_f32_16x16x32_bf16 v[112:115], a[136:139], v[164:167], v[112:115]
    ds_read_b128 v[180:183], v198 offset:128
    v_mfma_f32_32x32x16_bf16 v[80:95], a[136:139], v[168:171], v[80:95]
    ds_read_b128 v[184:187], v196 offset:128
    s_waitcnt lgkmcnt(2)
    v_mfma_f32_16x16x32_bf16 v[112:115], a[140:143], v[172:175], v[112:115]
    ds_read_b128 v[188:191], v198 offset:160
    v_mfma_f32_32x32x16_bf16 v[80:95], a[140:143], v[176:179], v[80:95]
    ds_read_b128 v[192:195], v197 offset:128
    s_add_u32 m0, s92, 36352
    s_nop 0
    buffer_load_dwordx4 v73, s[4:7], s99 offen offset:0  lds
    s_waitcnt lgkmcnt(2)
    s_waitcnt vmcnt(7)
    v_mfma_f32_16x16x32_bf16 v[112:115], a[144:147], v[180:183], v[112:115]
    ds_read_b128 v[160:163], v198 offset:192
    v_mfma_f32_32x32x16_bf16 v[80:95], a[144:147], v[184:187], v[80:95]
    ds_read_b128 v[164:167], v196 offset:192
    s_waitcnt lgkmcnt(2)
    s_waitcnt vmcnt(6)
    v_mfma_f32_16x16x32_bf16 v[112:115], a[148:151], v[188:191], v[112:115]
    ds_read_b128 v[168:171], v198 offset:224
    v_mfma_f32_32x32x16_bf16 v[80:95], a[148:151], v[192:195], v[80:95]
    ds_read_b128 v[172:175], v197 offset:192
    buffer_load_dwordx4 v74, s[4:7], s99 offen offset:1088  lds
    s_waitcnt lgkmcnt(2)
    s_waitcnt vmcnt(6)
    v_mfma_f32_16x16x32_bf16 v[112:115], a[152:155], v[160:163], v[112:115]
    ds_read_b128 v[176:179], v196 offset:8704
    v_mfma_f32_32x32x16_bf16 v[80:95], a[152:155], v[164:167], v[80:95]
    ds_read_b128 v[180:183], v197 offset:8704
    s_waitcnt lgkmcnt(2)
    s_waitcnt vmcnt(5)
    v_mfma_f32_16x16x32_bf16 v[112:115], a[156:159], v[168:171], v[112:115]
    ds_read_b128 v[184:187], v196 offset:8768
    v_mfma_f32_32x32x16_bf16 v[80:95], a[156:159], v[172:175], v[80:95]
    ds_read_b128 v[188:191], v197 offset:8768
    buffer_load_dwordx4 v75, s[4:7], s99 offen offset:2176  lds
    s_waitcnt lgkmcnt(2)
    v_mfma_f32_32x32x16_bf16 v[96:111], a[128:131], v[176:179], v[96:111]
    ds_read_b128 v[192:195], v196 offset:8832
    v_mfma_f32_32x32x16_bf16 v[96:111], a[132:135], v[180:183], v[96:111]
    ds_read_b128 v[160:163], v197 offset:8832
    buffer_load_dwordx4 v76, s[4:7], s99 offen offset:3264  lds
    s_mov_b32 exec_lo, 0x01010101
    s_mov_b32 exec_hi, 0x01010101
    ds_write_b128 v132, v[112:115]
    s_mov_b64 exec, -1
    s_waitcnt lgkmcnt(3)
    v_mfma_f32_32x32x16_bf16 v[96:111], a[136:139], v[184:187], v[96:111]
    ds_read_b128 v[164:167], v196 offset:8896
    ds_read_b128 v[24:27], v132
    ds_read_b128 v[8:11], v133 offset:0
    ds_read_b128 v[12:15], v133 offset:32
    ds_read_b128 v[16:19], v133 offset:64
    v_mfma_f32_32x32x16_bf16 v[96:111], a[140:143], v[188:191], v[96:111]
    ds_read_b128 v[168:171], v197 offset:8896
    s_add_u32 m0, s93, 53760
    s_add_u32 s99, s99, 256
    s_mov_b64 exec, s[80:81]
    buffer_load_dwordx4 v77, s[4:7], s100 offen  lds
    s_mov_b64 exec, -1
    s_add_u32 s100, s100, 256
    ds_read_b128 v[20:23], v133 offset:96
    s_waitcnt vmcnt(5) lgkmcnt(5)
    v_mul_f32 v148, v24, v157
    v_mfma_f32_32x32x16_bf16 v[96:111], a[144:147], v[192:195], v[96:111]
    v_mul_f32 v149, v25, v157
    v_mul_f32 v150, v26, v157
    v_mul_f32 v151, v27, v157
    s_waitcnt lgkmcnt(4)
    v_mul_f32 v116, v8, v153
    v_mul_f32 v117, v9, v153
    v_mfma_f32_32x32x16_bf16 v[96:111], a[148:151], v[160:163], v[96:111]
    v_mul_f32 v118, v10, v153
    v_mul_f32 v119, v11, v153
    s_waitcnt lgkmcnt(3)
    v_mul_f32 v120, v12, v153
    v_mul_f32 v121, v13, v153
    s_waitcnt lgkmcnt(1)
    v_mfma_f32_32x32x16_bf16 v[96:111], a[152:155], v[164:167], v[96:111]
    v_mul_f32 v122, v14, v153
    v_mul_f32 v123, v15, v153
    v_mul_f32 v124, v16, v153
    v_mul_f32 v125, v17, v153
    v_mul_f32_e64 v126, v18, v153
    v_mfma_f32_32x32x16_bf16 v[96:111], a[156:159], v[168:171], v[96:111]
    s_add_u32 m0, s92, 55936
    s_nop 0
    buffer_load_dwordx4 v73, s[4:7], s99 offen offset:0  lds
    v_mul_f32 v127, v19, v153
    s_waitcnt lgkmcnt(0)
    v_mul_f32 v128, v20, v153
    v_mul_f32 v129, v21, v153
    v_mul_f32 v130, v22, v153
    v_mul_f32_e64 v131, v23, v153
    v_fma_f32 v112, v112, v156, v148
    v_fma_f32 v113, v113, v156, v149
    v_fma_f32 v114, v114, v156, v150
    v_fma_f32 v115, v115, v156, v151
    v_cvt_pk_bf16_f32 v112, v112, v113
    v_cvt_pk_bf16_f32 v113, v114, v115
    v_fma_f32 v80, v80, v152, v116
    v_fma_f32 v81, v81, v152, v117
    v_fma_f32 v82, v82, v152, v118
    v_fma_f32 v83, v83, v152, v119
    v_cvt_pk_bf16_f32 v80, v80, v81
    v_cvt_pk_bf16_f32 v81, v82, v83
    ds_write_b64 v40, v[112:113] offset:0
    ds_write_b64 v38, v[80:81] offset:0
    v_fma_f32 v84, v84, v152, v120
    v_fma_f32 v85, v85, v152, v121
    v_fma_f32 v86, v86, v152, v122
    v_fma_f32 v87, v87, v152, v123
    v_cvt_pk_bf16_f32 v84, v84, v85
    v_cvt_pk_bf16_f32 v85, v86, v87
    v_fma_f32 v88, v88, v152, v124
    v_fma_f32 v89, v89, v152, v125
    v_fma_f32 v90, v90, v152, v126
    v_fma_f32 v91, v91, v152, v127
    v_cvt_pk_bf16_f32 v88, v88, v89
    v_cvt_pk_bf16_f32 v89, v90, v91
    ds_write_b64 v38, v[84:85] offset:6400
    ds_write_b64 v38, v[88:89] offset:12800
    v_fma_f32 v92, v92, v152, v128
    v_fma_f32 v93, v93, v152, v129
    v_fma_f32 v94, v94, v152, v130
    v_fma_f32 v95, v95, v152, v131
    v_cvt_pk_bf16_f32 v92, v92, v93
    v_cvt_pk_bf16_f32 v93, v94, v95
    ds_write_b64 v39, v[92:93] offset:0
    v_mul_f32 v132, v8, v155
    v_mul_f32 v133, v9, v155
    v_mul_f32 v134, v10, v155
    v_mul_f32 v135, v11, v155
    v_mul_f32 v136, v12, v155
    v_mul_f32 v137, v13, v155
    v_mul_f32 v138, v14, v155
    v_mul_f32 v139, v15, v155
    v_mul_f32 v140, v16, v155
    v_mul_f32 v141, v17, v155
    v_mul_f32 v142, v18, v155
    v_mul_f32 v143, v19, v155
    v_mul_f32 v144, v20, v155
    v_mul_f32 v145, v21, v155
    v_mul_f32 v146, v22, v155
    v_mul_f32 v147, v23, v155
    v_pk_fma_f32 v[96:97], v[96:97], v[154:155], v[132:133] op_sel_hi:[1,0,1]
    v_pk_fma_f32 v[98:99], v[98:99], v[154:155], v[134:135] op_sel_hi:[1,0,1]
    v_cvt_pk_bf16_f32 v96, v96, v97
    v_cvt_pk_bf16_f32 v97, v98, v99
    v_pk_fma_f32 v[100:101], v[100:101], v[154:155], v[136:137] op_sel_hi:[1,0,1]
    v_pk_fma_f32 v[102:103], v[102:103], v[154:155], v[138:139] op_sel_hi:[1,0,1]
    v_cvt_pk_bf16_f32 v100, v100, v101
    v_cvt_pk_bf16_f32 v101, v102, v103
    ds_write_b64 v38, v[96:97] offset:1600
    ds_write_b64 v38, v[100:101] offset:8000
    v_pk_fma_f32 v[104:105], v[104:105], v[154:155], v[140:141] op_sel_hi:[1,0,1]
    v_pk_fma_f32 v[106:107], v[106:107], v[154:155], v[142:143] op_sel_hi:[1,0,1]
    v_cvt_pk_bf16_f32 v104, v104, v105
    v_cvt_pk_bf16_f32 v105, v106, v107
    v_pk_fma_f32 v[108:109], v[108:109], v[154:155], v[144:145] op_sel_hi:[1,0,1]
    v_pk_fma_f32 v[110:111], v[110:111], v[154:155], v[146:147] op_sel_hi:[1,0,1]
    v_cvt_pk_bf16_f32 v108, v108, v109
    v_cvt_pk_bf16_f32 v109, v110, v111
    ds_write_b64 v38, v[104:105] offset:14400
    ds_write_b64 v39, v[108:109] offset:1600
    s_waitcnt lgkmcnt(0)
    s_barrier
    v_mov_b32 v94, 0
    v_mov_b32 v95, 0
    v_mov_b32 v98, 0
    v_mov_b32 v99, 0
    s_mov_b64 exec, 0xffff
    ds_read_b64 v[94:95], v42 offset:320
    ds_read_b64 v[98:99], v42 offset:640
    s_mov_b64 exec, -1
    s_nop 0
    ds_read_b64 v[92:93], v41 offset:320
    ds_read_b64 v[96:97], v41 offset:640
    ds_read_b64 v[84:85], v41 offset:6720
    ds_read_b64 v[86:87], v42 offset:6720
    ds_read_b64 v[80:81], v41 offset:6400
    ds_read_b64 v[82:83], v42 offset:6400
    ds_read_b64 v[88:89], v41 offset:7040
    ds_read_b64 v[90:91], v42 offset:7040
    ds_read_b64_tr_b16 v[106:107], v44 offset:0
    ds_read_b64_tr_b16 v[100:101], v43 offset:0
    ds_read_b64_tr_b16 v[108:109], v44 offset:320
    ds_read_b64_tr_b16 v[102:103], v43 offset:320
    buffer_load_dwordx4 v74, s[4:7], s99 offen offset:1088  lds
    ds_read_b64_tr_b16 v[110:111], v44 offset:640
    ds_read_b64_tr_b16 v[104:105], v43 offset:640
    v_mov_b32 v156, 0xf149f2ca
    v_cndmask_b32 v152, v32, v156, s[90:91]
    v_cndmask_b32 v153, v33, v156, s[90:91]
    v_cndmask_b32 v154, v34, v156, s[90:91]
    v_cndmask_b32 v155, v35, v156, s[90:91]
    s_mov_b32 s82, 0x3ea52b5c
    buffer_load_dwordx4 v75, s[4:7], s99 offen offset:2176  lds
    s_lshl_b32 s25, s98, 4
    s_add_u32 s25, s25, 4194304
    s_lshl_b32 s26, s98, 3
    s_add_u32 s26, s26, 4194304
    s_waitcnt lgkmcnt(10)
    v_mfma_f32_16x16x32_bf16 v[116:119], v[84:87], v[92:95], v[28:31]
    v_mfma_f32_16x16x32_bf16 v[120:123], v[84:87], v[96:99], v[32:35]
    s_waitcnt lgkmcnt(8)
    v_mfma_f32_16x16x32_bf16 v[112:115], v[80:83], v[92:95], v[152:155]
    s_waitcnt lgkmcnt(6)
    v_mfma_f32_16x16x32_bf16 v[124:127], v[88:91], v[96:99], v[28:31]
    buffer_load_dwordx4 v76, s[4:7], s99 offen offset:3264  lds
    s_nop 4
    v_max_f32 v112, v112, v116
    v_max_f32 v113, v113, v117
    v_max_f32 v114, v114, v118
    v_max_f32 v115, v115, v119
    v_max3_f32 v156, v112, v113, v114
    v_max_f32 v156, v156, v115
    v_max_f32 v120, v120, v124
    v_max_f32_e64 v121, v121, v125
    s_add_u32 m0, s93, 73344
    s_add_u32 s99, s99, 256
    s_mov_b64 exec, s[80:81]
    buffer_load_dwordx4 v77, s[4:7], s100 offen  lds
    s_mov_b64 exec, -1
    s_add_u32 s100, s100, 256
    v_max_f32 v122, v122, v126
    v_max_f32 v123, v123, v127
    v_max3_f32 v157, v120, v121, v122
    v_max_f32 v157, v157, v123
    s_nop 1
    v_permlane16_swap_b32 v156, v157
    v_max_f32 v156, v156, v157
    v_mov_b32 v157, v156
    s_nop 1
    v_permlane32_swap_b32 v156, v157
    s_add_u32 m0, s92, 75520
    s_nop 0
    buffer_load_dwordx4 v73, s[4:7], s99 offen offset:0  lds
    v_max_f32 v156, v156, v157
    v_mul_f32 v156, s82, v156
    v_mov_b32 v157, v156
    s_nop 1
    v_permlane16_swap_b32_e64 v156, v157
    v_fma_f32 v112, v112, s82, -v156
    v_fma_f32 v113, v113, s82, -v156
    v_fma_f32 v114, v114, s82, -v156
    v_fma_f32 v115, v115, s82, -v156
    buffer_load_dwordx4 v74, s[4:7], s99 offen offset:1088  lds
    v_exp_f32 v112, v112
    v_exp_f32 v113, v113
    v_exp_f32 v114, v114
    v_exp_f32 v115, v115
    v_cvt_pk_bf16_f32 v116, v112, v113
    v_cvt_pk_bf16_f32 v117, v114, v115
    v_bfi_b32 v128, v36, 0, v116
    v_and_b32_e64 v130, v36, v116
    buffer_load_dwordx4 v75, s[4:7], s99 offen offset:2176  lds
    v_bfi_b32 v129, v37, 0, v117
    v_and_b32 v131, v37, v117
    s_waitcnt lgkmcnt(3)
    s_nop 0
    v_mfma_f32_16x16x32_bf16 v[144:147], v[106:109], v[128:131], 0
    s_waitcnt lgkmcnt(2)
    v_mfma_f32_16x16x32_bf16 v[136:139], v[100:103], v[128:131], 0
    v_fma_f32 v120, v120, s82, -v157
    v_fma_f32 v121, v121, s82, -v157
    v_fma_f32 v122, v122, s82, -v157
    v_fma_f32 v123, v123, s82, -v157
    buffer_load_dwordx4 v76, s[4:7], s99 offen offset:3264  lds
    v_exp_f32 v120, v120
    v_exp_f32 v121, v121
    v_exp_f32 v122, v122
    v_exp_f32 v123, v123
    v_cvt_pk_bf16_f32 v124, v120, v121
    v_cvt_pk_bf16_f32 v125, v122, v123
    v_bfi_b32 v132, v36, 0, v124
    v_and_b32_e64 v134, v36, v124
    s_add_u32 m0, s93, 92928
    s_add_u32 s99, s99, 256
    s_mov_b64 exec, s[80:81]
    buffer_load_dwordx4 v77, s[4:7], s100 offen  lds
    s_mov_b64 exec, -1
    s_add_u32 s100, s100, 256
    v_bfi_b32 v133, v37, 0, v125
    v_and_b32 v135, v37, v125
    s_waitcnt lgkmcnt(1)
    s_nop 0
    v_mfma_f32_16x16x32_bf16 v[148:151], v[108:111], v[132:135], 0
    s_waitcnt lgkmcnt(0)
    v_mfma_f32_16x16x32_bf16 v[140:143], v[102:105], v[132:135], 0
    v_mov_b32 v158, v144
    s_nop 1
    v_permlane16_swap_b32 v144, v158
    v_rcp_f32 v158, v158
    s_nop 0
    v_pk_mul_f32 v[136:137], v[136:137], v[158:159] op_sel_hi:[1,0]
    s_lshl_b32 s97, s73, 2
    s_add_u32 s97, s97, s24
    s_nop 0
    s_mul_i32 s97, s97, 25600
    s_add_u32 s97, s97, 2621440
    buffer_load_dwordx4 a[160:163], v58, s[16:19], s97 offen offset:0 sc1
    v_pk_mul_f32 v[138:139], v[138:139], v[158:159] op_sel_hi:[1,0]
    v_pk_mul_f32 v[144:145], v[144:145], v[158:159] op_sel_hi:[1,0]
    v_pk_mul_f32 v[146:147], v[146:147], v[158:159] op_sel_hi:[1,0]
    v_cvt_pk_bf16_f32 v112, v136, v137
    v_cvt_pk_bf16_f32 v116, v144, v145
    v_cvt_pk_bf16_f32 v113, v138, v139
    v_cvt_pk_bf16_f32 v117, v146, v147
    v_mov_b32 v160, v148
    buffer_load_dwordx4 a[164:167], v58, s[16:19], s97 offen offset:1024 sc1
    s_nop 0
    v_permlane16_swap_b32 v148, v160
    v_rcp_f32_e64 v160, v160
    s_nop 0
    v_pk_mul_f32 v[140:141], v[140:141], v[160:161] op_sel_hi:[1,0]
    v_pk_mul_f32 v[142:143], v[142:143], v[160:161] op_sel_hi:[1,0]
    v_pk_mul_f32 v[148:149], v[148:149], v[160:161] op_sel_hi:[1,0]
    v_pk_mul_f32 v[150:151], v[150:151], v[160:161] op_sel_hi:[1,0]
    v_cvt_pk_bf16_f32 v114, v140, v141
    v_cvt_pk_bf16_f32 v118, v148, v149
    buffer_load_dwordx4 a[168:171], v58, s[16:19], s97 offen offset:2048 sc1
    v_cvt_pk_bf16_f32 v115, v142, v143
    v_cvt_pk_bf16_f32 v119, v150, v151
    v_permlane16_swap_b32 v112, v114
    v_permlane16_swap_b32 v113, v115
    v_permlane16_swap_b32 v116, v118
    v_permlane16_swap_b32 v117, v119
    buffer_store_dwordx4 v[112:115], v45, s[16:19], s25 offen sc1
    s_mov_b64 exec, s[80:81]
    buffer_store_dwordx2 v[116:117], v46, s[16:19], s26 offen sc1
    s_mov_b64 exec, -1
    buffer_load_dwordx4 a[172:175], v58, s[16:19], s97 offen offset:3072 sc1
    s_add_u32 s97, s97, 4096
    buffer_load_dwordx4 a[176:179], v58, s[16:19], s97 offen offset:0 sc1
    v_add_u32 v196, 36352, v78
    v_mov_b32 v198, v79
    v_xor_b32 v197, 32, v196
    s_waitcnt vmcnt(17)
    s_barrier
    ds_read_b128 v[160:163], v198 offset:0
    ds_read_b128 v[164:167], v196 offset:0
    ds_read_b128 v[168:171], v196 offset:8704
    ds_read_b128 v[172:175], v198 offset:32
    ds_read_b128 v[176:179], v197 offset:0
    ds_read_b128 v[180:183], v197 offset:8704
    s_waitcnt lgkmcnt(3)
    v_mfma_f32_16x16x32_bf16 v[112:115], a[0:3], v[160:163], 0
    ds_read_b128 v[184:187], v198 offset:64
    v_mfma_f32_32x32x16_bf16 v[80:95], a[0:3], v[164:167], 0
    ds_read_b128 v[188:191], v196 offset:64
    v_mfma_f32_32x32x16_bf16 v[96:111], a[0:3], v[168:171], 0
    ds_read_b128 v[192:195], v196 offset:8768
    s_add_u32 m0, s92, 95104
    s_nop 0
    buffer_load_dwordx4 v73, s[4:7], s99 offen offset:0  lds
    s_waitcnt lgkmcnt(3)
    v_mfma_f32_16x16x32_bf16 v[112:115], a[4:7], v[172:175], v[112:115]
    ds_read_b128 v[160:163], v198 offset:96
    v_mfma_f32_32x32x16_bf16 v[80:95], a[4:7], v[176:179], v[80:95]
    ds_read_b128 v[164:167], v197 offset:64
    v_mfma_f32_32x32x16_bf16 v[96:111], a[4:7], v[180:183], v[96:111]
    ds_read_b128 v[168:171], v197 offset:8768
    buffer_load_dwordx4 v74, s[4:7], s99 offen offset:1088  lds
    s_waitcnt lgkmcnt(3)
    v_mfma_f32_16x16x32_bf16 v[112:115], a[8:11], v[184:187], v[112:115]
    ds_read_b128 v[172:175], v198 offset:128
    v_mfma_f32_32x32x16_bf16 v[80:95], a[8:11], v[188:191], v[80:95]
    ds_read_b128 v[176:179], v196 offset:128
    v_mfma_f32_32x32x16_bf16 v[96:111], a[8:11], v[192:195], v[96:111]
    ds_read_b128 v[180:183], v196 offset:8832
    buffer_load_dwordx4 v75, s[4:7], s99 offen offset:2176  lds
    s_waitcnt lgkmcnt(3)
    v_mfma_f32_16x16x32_bf16 v[112:115], a[12:15], v[160:163], v[112:115]
    ds_read_b128 v[184:187], v198 offset:160
    v_mfma_f32_32x32x16_bf16 v[80:95], a[12:15], v[164:167], v[80:95]
    ds_read_b128 v[188:191], v197 offset:128
    v_mfma_f32_32x32x16_bf16 v[96:111], a[12:15], v[168:171], v[96:111]
    ds_read_b128 v[192:195], v197 offset:8832
    buffer_load_dwordx4 v76, s[4:7], s99 offen offset:3264  lds
    s_waitcnt lgkmcnt(3)
    v_mfma_f32_16x16x32_bf16 v[112:115], a[16:19], v[172:175], v[112:115]
    ds_read_b128 v[160:163], v198 offset:192
    v_mfma_f32_32x32x16_bf16 v[80:95], a[16:19], v[176:179], v[80:95]
    ds_read_b128 v[164:167], v196 offset:192
    v_mfma_f32_32x32x16_bf16 v[96:111], a[16:19], v[180:183], v[96:111]
    ds_read_b128 v[168:171], v196 offset:8896
    s_add_u32 m0, s93, 112512
    s_add_u32 s99, s99, 256
    s_mov_b64 exec, s[80:81]
    buffer_load_dwordx4 v77, s[4:7], s100 offen  lds
    s_mov_b64 exec, -1
    s_add_u32 s100, s100, 256
    s_waitcnt lgkmcnt(3)
    v_mfma_f32_16x16x32_bf16 v[112:115], a[20:23], v[184:187], v[112:115]
    ds_read_b128 v[172:175], v198 offset:224
    v_mfma_f32_32x32x16_bf16 v[80:95], a[20:23], v[188:191], v[80:95]
    ds_read_b128 v[176:179], v197 offset:192
    v_mfma_f32_32x32x16_bf16 v[96:111], a[20:23], v[192:195], v[96:111]
    ds_read_b128 v[180:183], v197 offset:8896
    s_add_u32 m0, s92, 114688
    s_nop 0
    buffer_load_dwordx4 v73, s[4:7], s99 offen offset:0  lds
    s_waitcnt vmcnt(18)
    s_barrier
    s_waitcnt lgkmcnt(3)
    v_mfma_f32_16x16x32_bf16 v[112:115], a[24:27], v[160:163], v[112:115]
    v_add_u32 v198, v49, v198
    v_mfma_f32_32x32x16_bf16 v[80:95], a[24:27], v[164:167], v[80:95]
    v_add_u32 v196, 19584, v196
    v_add_u32 v197, 19584, v197
    ds_read_b128 v[184:187], v198 offset:0
    v_mfma_f32_32x32x16_bf16 v[96:111], a[24:27], v[168:171], v[96:111]
    ds_read_b128 v[188:191], v196 offset:0
    ds_read_b128 v[192:195], v196 offset:8704
    buffer_load_dwordx4 v74, s[4:7], s99 offen offset:1088  lds
    s_waitcnt lgkmcnt(3)
    v_mfma_f32_16x16x32_bf16 v[112:115], a[28:31], v[172:175], v[112:115]
    ds_read_b128 v[160:163], v198 offset:32
    v_mfma_f32_32x32x16_bf16 v[80:95], a[28:31], v[176:179], v[80:95]
    ds_read_b128 v[164:167], v197 offset:0
    v_mfma_f32_32x32x16_bf16 v[96:111], a[28:31], v[180:183], v[96:111]
    ds_read_b128 v[168:171], v197 offset:8704
    buffer_load_dwordx4 v75, s[4:7], s99 offen offset:2176  lds
    s_waitcnt lgkmcnt(3)
    v_mfma_f32_16x16x32_bf16 v[112:115], a[32:35], v[184:187], v[112:115]
    ds_read_b128 v[172:175], v198 offset:64
    v_mfma_f32_32x32x16_bf16 v[80:95], a[32:35], v[188:191], v[80:95]
    ds_read_b128 v[176:179], v196 offset:64
    v_mfma_f32_32x32x16_bf16 v[96:111], a[32:35], v[192:195], v[96:111]
    ds_read_b128 v[180:183], v196 offset:8768
    buffer_load_dwordx4 v76, s[4:7], s99 offen offset:3264  lds
    s_waitcnt lgkmcnt(3)
    v_mfma_f32_16x16x32_bf16 v[112:115], a[36:39], v[160:163], v[112:115]
    ds_read_b128 v[184:187], v198 offset:96
    v_mfma_f32_32x32x16_bf16 v[80:95], a[36:39], v[164:167], v[80:95]
    ds_read_b128 v[188:191], v197 offset:64
    v_mfma_f32_32x32x16_bf16 v[96:111], a[36:39], v[168:171], v[96:111]
    ds_read_b128 v[192:195], v197 offset:8768
    s_add_u32 m0, s93, 132096
    s_add_u32 s99, s99, 256
    s_mov_b64 exec, s[80:81]
    buffer_load_dwordx4 v77, s[4:7], s100 offen  lds
    s_mov_b64 exec, -1
    s_add_u32 s100, s100, 256
    s_waitcnt lgkmcnt(3)
    v_mfma_f32_16x16x32_bf16 v[112:115], a[40:43], v[172:175], v[112:115]
    ds_read_b128 v[160:163], v198 offset:128
    v_mfma_f32_32x32x16_bf16 v[80:95], a[40:43], v[176:179], v[80:95]
    ds_read_b128 v[164:167], v196 offset:128
    s_lshl_b32 s25, s24, 6
    s_and_b32 s35, s74, 3
    s_lshl_b32 s35, s35, 13
    s_add_u32 s35, s35, s25
    v_mfma_f32_32x32x16_bf16 v[96:111], a[40:43], v[180:183], v[96:111]
    ds_read_b128 v[168:171], v196 offset:8832
    s_lshl_b32 s98, s72, 5
    s_add_u32 s98, s98, 256
    s_sub_u32 s95, s98, 4
    s_max_i32 s95, s95, 0
    s_lshl_b32 s94, s98, 3
    s_lshl_b32 s95, s95, 3
    s_add_u32 s94, s94, 3440640
    s_add_u32 s95, s95, 3440640
    s_add_u32 s96, s94, 8192
    buffer_load_dwordx2 v[152:153], v47, s[16:19], s94 offen sc1
    s_waitcnt lgkmcnt(3)
    v_mfma_f32_16x16x32_bf16 v[112:115], a[44:47], v[184:187], v[112:115]
    ds_read_b128 v[172:175], v198 offset:160
    v_mfma_f32_32x32x16_bf16 v[80:95], a[44:47], v[188:191], v[80:95]
    ds_read_b128 v[176:179], v197 offset:128
    s_lshr_b32 s25, s74, 4
    s_lshl_b32 s25, s25, 11
    s_add_u32 s35, s35, s25
    s_and_b32 s25, s74, 12
    v_mfma_f32_32x32x16_bf16 v[96:111], a[44:47], v[192:195], v[96:111]
    ds_read_b128 v[180:183], v197 offset:8832
    buffer_load_dwordx2 v[154:155], v47, s[16:19], s96 offen sc1
    s_lshl_b32 s25, s25, 6
    s_add_u32 s35, s35, s25
    s_waitcnt lgkmcnt(3)
    v_mfma_f32_16x16x32_bf16 v[112:115], a[48:51], v[160:163], v[112:115]
    ds_read_b128 v[184:187], v198 offset:192
    v_mfma_f32_32x32x16_bf16 v[80:95], a[48:51], v[164:167], v[80:95]
    ds_read_b128 v[188:191], v196 offset:192
    s_mul_i32 s36, s73, 20
    s_add_u32 s36, s36, s24
    s_add_u32 s36, s36, 16
    s_lshl_b32 s36, s36, 14
    v_mfma_f32_32x32x16_bf16 v[96:111], a[48:51], v[168:171], v[96:111]
    ds_read_b128 v[192:195], v196 offset:8896
    buffer_load_dwordx2 v[156:157], v48, s[16:19], s95 offen sc1
    v_add_u32 v199, 36352, v58
    s_lshl_b32 s32, s24, 11
    s_waitcnt lgkmcnt(3)
    v_mfma_f32_16x16x32_bf16 v[112:115], a[52:55], v[172:175], v[112:115]
    ds_read_b128 v[160:163], v198 offset:224
    v_mfma_f32_32x32x16_bf16 v[80:95], a[52:55], v[176:179], v[80:95]
    ds_read_b128 v[164:167], v197 offset:192
    v_add_u32 v203, s32, v199
    s_add_u32 s32, s24, 1
    s_and_b32 s32, s32, 3
    s_mul_i32 s32, s32, 6144
    v_mfma_f32_32x32x16_bf16 v[96:111], a[52:55], v[180:183], v[96:111]
    ds_read_b128 v[168:171], v197 offset:8896
    buffer_load_dwordx4 a[180:183], v58, s[16:19], s97 offen offset:1024 sc1
    v_add_u32 v200, s32, v199
    s_add_u32 s32, s24, 2
    s_waitcnt vmcnt(21)
    s_barrier
    s_waitcnt lgkmcnt(3)
    v_mfma_f32_16x16x32_bf16 v[112:115], a[56:59], v[184:187], v[112:115]
    v_add_u32 v198, v49, v198
    v_mfma_f32_32x32x16_bf16 v[80:95], a[56:59], v[188:191], v[80:95]
    v_add_u32 v196, 19584, v196
    v_add_u32 v197, 19584, v197
    ds_read_b128 v[172:175], v198 offset:0
    s_and_b32 s32, s32, 3
    s_mul_i32 s32, s32, 6144
    v_mfma_f32_32x32x16_bf16 v[96:111], a[56:59], v[192:195], v[96:111]
    ds_read_b128 v[176:179], v196 offset:0
    ds_read_b128 v[180:183], v196 offset:8704
    buffer_load_dwordx4 a[184:187], v58, s[16:19], s97 offen offset:2048 sc1
    v_add_u32_e64 v201, s32, v199
    s_waitcnt lgkmcnt(3)
    v_mfma_f32_16x16x32_bf16 v[112:115], a[60:63], v[160:163], v[112:115]
    ds_read_b128 v[184:187], v198 offset:32
    v_mfma_f32_32x32x16_bf16 v[80:95], a[60:63], v[164:167], v[80:95]
    ds_read_b128 v[188:191], v197 offset:0
    s_add_u32 s32, s24, 3
    s_and_b32 s32, s32, 3
    s_mul_i32 s32, s32, 6144
    v_add_u32_e64 v202, s32, v199
    v_mfma_f32_32x32x16_bf16 v[96:111], a[60:63], v[168:171], v[96:111]
    ds_read_b128 v[192:195], v197 offset:8704
    buffer_load_dwordx4 a[188:191], v58, s[16:19], s97 offen offset:3072 sc1
    s_mul_i32 s32, s24, 6144
    v_add_u32 v204, s32, v199
    s_waitcnt lgkmcnt(3)
    v_mfma_f32_16x16x32_bf16 v[112:115], a[64:67], v[172:175], v[112:115]
    ds_read_b128 v[160:163], v198 offset:64
    v_mfma_f32_32x32x16_bf16 v[80:95], a[64:67], v[176:179], v[80:95]
    ds_read_b128 v[164:167], v196 offset:64
    s_lshl_b32 s32, s24, 8
    s_add_u32 s32, s32, 36352
    v_and_b32 v214, 15, v1
    v_lshl_add_u32 v206, v214, 4, s32
    v_mfma_f32_32x32x16_bf16 v[96:111], a[64:67], v[180:183], v[96:111]
    ds_read_b128 v[168:171], v196 offset:8768
    s_add_u32 s97, s97, 4096
    buffer_load_dwordx4 a[192:195], v58, s[16:19], s97 offen offset:0 sc1
    v_lshrrev_b32 v215, 5, v1
    s_waitcnt lgkmcnt(3)
    v_mfma_f32_16x16x32_bf16 v[112:115], a[68:71], v[184:187], v[112:115]
    ds_read_b128 v[172:175], v198 offset:96
    v_mfma_f32_32x32x16_bf16 v[80:95], a[68:71], v[188:191], v[80:95]
    ds_read_b128 v[176:179], v197 offset:64
    v_lshl_add_u32 v205, v215, 10, v206
    v_bfe_u32 v215, v1, 4, 1
    v_lshl_add_u32 v205, v215, 3, v205
    v_lshlrev_b32_e64 v214, 2, v214
    v_mfma_f32_32x32x16_bf16 v[96:111], a[68:71], v[192:195], v[96:111]
    ds_read_b128 v[180:183], v197 offset:8768
    buffer_load_dwordx4 a[196:199], v58, s[16:19], s97 offen offset:1024 sc1
    v_lshl_add_u32 v214, v215, 10, v214
    s_lshl_b32 s32, s24, 6
    s_waitcnt lgkmcnt(3)
    v_mfma_f32_16x16x32_bf16 v[112:115], a[72:75], v[160:163], v[112:115]
    ds_read_b128 v[184:187], v198 offset:128
    v_mfma_f32_32x32x16_bf16 v[80:95], a[72:75], v[164:167], v[80:95]
    ds_read_b128 v[188:191], v196 offset:128
    v_lshl_add_u32 v207, v215, 3, s32
    v_and_b32 v215, 12, v1
    v_lshl_add_u32 v207, v215, 2, v207
    v_and_b32 v215, 2, v1
    v_mfma_f32_32x32x16_bf16 v[96:111], a[72:75], v[168:171], v[96:111]
    ds_read_b128 v[192:195], v196 offset:8832
    buffer_load_dwordx4 a[200:203], v58, s[16:19], s97 offen offset:2048 sc1
    v_lshl_add_u32 v207, v215, 1, v207
    v_add_u32 v207, 69120, v207
    s_waitcnt lgkmcnt(3)
    v_mfma_f32_16x16x32_bf16 v[112:115], a[76:79], v[172:175], v[112:115]
    ds_read_b128 v[160:163], v198 offset:160
    v_mfma_f32_32x32x16_bf16 v[80:95], a[76:79], v[176:179], v[80:95]
    ds_read_b128 v[164:167], v197 offset:128
    v_lshrrev_b32 v215, 4, v1
    v_lshl_add_u32 v206, v215, 2, v206
    v_mov_b32 v215, 0x3f803f80
    v_mfma_f32_32x32x16_bf16 v[96:111], a[76:79], v[180:183], v[96:111]
    ds_read_b128 v[168:171], v197 offset:8832
    buffer_load_dwordx4 a[204:207], v58, s[16:19], s97 offen offset:3072 sc1
    s_waitcnt lgkmcnt(3)
    v_mfma_f32_16x16x32_bf16 v[112:115], a[80:83], v[184:187], v[112:115]
    ds_read_b128 v[172:175], v198 offset:192
    v_mfma_f32_32x32x16_bf16 v[80:95], a[80:83], v[188:191], v[80:95]
    ds_read_b128 v[176:179], v196 offset:192
    v_mfma_f32_32x32x16_bf16 v[96:111], a[80:83], v[192:195], v[96:111]
    ds_read_b128 v[180:183], v196 offset:8896
    s_add_u32 s97, s97, 4096
    buffer_load_dwordx4 a[208:211], v58, s[16:19], s97 offen offset:0 sc1
    s_waitcnt lgkmcnt(3)
    v_mfma_f32_16x16x32_bf16 v[112:115], a[84:87], v[160:163], v[112:115]
    ds_read_b128 v[184:187], v198 offset:224
    v_mfma_f32_32x32x16_bf16 v[80:95], a[84:87], v[164:167], v[80:95]
    ds_read_b128 v[188:191], v197 offset:192
    v_mfma_f32_32x32x16_bf16 v[96:111], a[84:87], v[168:171], v[96:111]
    ds_read_b128 v[192:195], v197 offset:8896
    buffer_load_dwordx4 a[212:215], v58, s[16:19], s97 offen offset:1024 sc1
    s_waitcnt vmcnt(17)
    s_barrier
    s_waitcnt lgkmcnt(3)
    v_mfma_f32_16x16x32_bf16 v[112:115], a[88:91], v[172:175], v[112:115]
    v_add_u32 v198, v49, v198
    v_mfma_f32_32x32x16_bf16 v[80:95], a[88:91], v[176:179], v[80:95]
    v_add_u32 v196, 19584, v196
    v_add_u32 v197, 19584, v197
    ds_read_b128 v[160:163], v198 offset:0
    v_mfma_f32_32x32x16_bf16 v[96:111], a[88:91], v[180:183], v[96:111]
    ds_read_b128 v[164:167], v196 offset:0
    ds_read_b128 v[168:171], v196 offset:8704
    buffer_load_dwordx4 a[216:219], v58, s[16:19], s97 offen offset:2048 sc1
    s_waitcnt lgkmcnt(3)
    v_mfma_f32_16x16x32_bf16 v[112:115], a[92:95], v[184:187], v[112:115]
    ds_read_b128 v[172:175], v198 offset:32
    v_mfma_f32_32x32x16_bf16 v[80:95], a[92:95], v[188:191], v[80:95]
    ds_read_b128 v[176:179], v197 offset:0
    v_mfma_f32_32x32x16_bf16 v[96:111], a[92:95], v[192:195], v[96:111]
    ds_read_b128 v[180:183], v197 offset:8704
    buffer_load_dwordx4 a[220:223], v58, s[16:19], s97 offen offset:3072 sc1
    s_waitcnt lgkmcnt(3)
    v_mfma_f32_16x16x32_bf16 v[112:115], a[96:99], v[160:163], v[112:115]
    ds_read_b128 v[184:187], v198 offset:64
    v_mfma_f32_32x32x16_bf16 v[80:95], a[96:99], v[164:167], v[80:95]
    ds_read_b128 v[188:191], v196 offset:64
    v_mfma_f32_32x32x16_bf16 v[96:111], a[96:99], v[168:171], v[96:111]
    ds_read_b128 v[192:195], v196 offset:8768
    s_add_u32 s97, s97, 4096
    buffer_load_dwordx4 a[224:227], v58, s[16:19], s97 offen offset:0 sc1
    s_waitcnt lgkmcnt(3)
    v_mfma_f32_16x16x32_bf16 v[112:115], a[100:103], v[172:175], v[112:115]
    ds_read_b128 v[160:163], v198 offset:96
    v_mfma_f32_32x32x16_bf16 v[80:95], a[100:103], v[176:179], v[80:95]
    ds_read_b128 v[164:167], v197 offset:64
    v_mfma_f32_32x32x16_bf16 v[96:111], a[100:103], v[180:183], v[96:111]
    ds_read_b128 v[168:171], v197 offset:8768
    buffer_load_dwordx4 a[228:231], v58, s[16:19], s97 offen offset:1024 sc1
    s_waitcnt lgkmcnt(3)
    v_mfma_f32_16x16x32_bf16 v[112:115], a[104:107], v[184:187], v[112:115]
    ds_read_b128 v[172:175], v198 offset:128
    v_mfma_f32_32x32x16_bf16 v[80:95], a[104:107], v[188:191], v[80:95]
    ds_read_b128 v[176:179], v196 offset:128
    v_mfma_f32_32x32x16_bf16 v[96:111], a[104:107], v[192:195], v[96:111]
    ds_read_b128 v[180:183], v196 offset:8832
    buffer_load_dwordx4 a[232:235], v58, s[16:19], s97 offen offset:2048 sc1
    s_waitcnt lgkmcnt(3)
    v_mfma_f32_16x16x32_bf16 v[112:115], a[108:111], v[160:163], v[112:115]
    ds_read_b128 v[184:187], v198 offset:160
    v_mfma_f32_32x32x16_bf16 v[80:95], a[108:111], v[164:167], v[80:95]
    ds_read_b128 v[188:191], v197 offset:128
    v_mfma_f32_32x32x16_bf16 v[96:111], a[108:111], v[168:171], v[96:111]
    ds_read_b128 v[192:195], v197 offset:8832
    buffer_load_dwordx4 a[236:239], v58, s[16:19], s97 offen offset:3072 sc1
    s_waitcnt lgkmcnt(3)
    v_mfma_f32_16x16x32_bf16 v[112:115], a[112:115], v[172:175], v[112:115]
    ds_read_b128 v[160:163], v198 offset:192
    v_mfma_f32_32x32x16_bf16 v[80:95], a[112:115], v[176:179], v[80:95]
    ds_read_b128 v[164:167], v196 offset:192
    v_mfma_f32_32x32x16_bf16 v[96:111], a[112:115], v[180:183], v[96:111]
    ds_read_b128 v[168:171], v196 offset:8896
    s_add_u32 s97, s97, 4096
    buffer_load_dwordx4 a[240:243], v58, s[16:19], s97 offen offset:0 sc1
    s_waitcnt lgkmcnt(3)
    v_mfma_f32_16x16x32_bf16 v[112:115], a[116:119], v[184:187], v[112:115]
    ds_read_b128 v[172:175], v198 offset:224
    v_mfma_f32_32x32x16_bf16 v[80:95], a[116:119], v[188:191], v[80:95]
    ds_read_b128 v[176:179], v197 offset:192
    v_mfma_f32_32x32x16_bf16 v[96:111], a[116:119], v[192:195], v[96:111]
    ds_read_b128 v[180:183], v197 offset:8896
    buffer_load_dwordx4 a[244:247], v58, s[16:19], s97 offen offset:1024 sc1
    s_waitcnt vmcnt(20)
    s_barrier
    s_waitcnt lgkmcnt(3)
    v_mfma_f32_16x16x32_bf16 v[112:115], a[120:123], v[160:163], v[112:115]
    v_add_u32_e64 v198, v49, v198
    v_mfma_f32_32x32x16_bf16 v[80:95], a[120:123], v[164:167], v[80:95]
    v_add_u32 v196, 19584, v196
    v_add_u32 v197, 19584, v197
    s_waitcnt vmcnt(17)
    v_mul_f32 v148, v24, v157
    v_mul_f32 v149, v25, v157
    v_mul_f32 v150, v26, v157
    v_mfma_f32_32x32x16_bf16 v[96:111], a[120:123], v[168:171], v[96:111]
    ds_read_b128 v[184:187], v198 offset:0
    ds_read_b128 v[188:191], v196 offset:0
    buffer_load_dwordx4 a[248:251], v58, s[16:19], s97 offen offset:2048 sc1
    v_mul_f32 v151, v27, v157
    v_mul_f32_e64 v116, v8, v153
    s_waitcnt lgkmcnt(2)
    v_mfma_f32_16x16x32_bf16 v[112:115], a[124:127], v[172:175], v[112:115]
    ds_read_b128 v[192:195], v198 offset:32
    v_mfma_f32_32x32x16_bf16 v[80:95], a[124:127], v[176:179], v[80:95]
    ds_read_b128 v[160:163], v197 offset:0
    v_mul_f32 v117, v9, v153
    v_mul_f32 v118, v10, v153
    v_mul_f32 v119, v11, v153
    v_mul_f32 v120, v12, v153
    v_mfma_f32_32x32x16_bf16 v[96:111], a[124:127], v[180:183], v[96:111]
    buffer_load_dwordx4 a[252:255], v58, s[16:19], s97 offen offset:3072 sc1
    v_mul_f32 v121, v13, v153
    v_mul_f32 v122, v14, v153
    v_mul_f32 v123, v15, v153
    s_waitcnt lgkmcnt(2)
    v_mfma_f32_16x16x32_bf16 v[112:115], a[128:131], v[184:187], v[112:115]
    ds_read_b128 v[164:167], v198 offset:64
    v_mfma_f32_32x32x16_bf16 v[80:95], a[128:131], v[188:191], v[80:95]
    ds_read_b128 v[168:171], v196 offset:64
    v_mul_f32 v124, v16, v153
    v_mul_f32 v125, v17, v153
    v_mul_f32 v126, v18, v153
    s_waitcnt lgkmcnt(2)
    v_mfma_f32_16x16x32_bf16 v[112:115], a[132:135], v[192:195], v[112:115]
    ds_read_b128 v[172:175], v198 offset:96
    v_mfma_f32_32x32x16_bf16 v[80:95], a[132:135], v[160:163], v[80:95]
    ds_read_b128 v[176:179], v197 offset:64
    s_add_u32 s97, s97, 4096
    buffer_load_dwordx4 v[52:55], v58, s[16:19], s97 offen offset:0 sc1
    v_mul_f32 v127, v19, v153
    v_mul_f32_e64 v128, v20, v153
    s_waitcnt lgkmcnt(2)
    v_mfma_f32_16x16x32_bf16 v[112:115], a[136:139], v[164:167], v[112:115]
    ds_read_b128 v[180:183], v198 offset:128
    v_mfma_f32_32x32x16_bf16 v[80:95], a[136:139], v[168:171], v[80:95]
    ds_read_b128 v[184:187], v196 offset:128
    v_mul_f32 v129, v21, v153
    v_mul_f32 v130, v22, v153
    v_mul_f32 v131, v23, v153
    s_waitcnt lgkmcnt(2)
    v_mfma_f32_16x16x32_bf16 v[112:115], a[140:143], v[172:175], v[112:115]
    ds_read_b128 v[188:191], v198 offset:160
    v_mfma_f32_32x32x16_bf16 v[80:95], a[140:143], v[176:179], v[80:95]
    ds_read_b128 v[192:195], v197 offset:128
    s_mov_b32 s96, 4194304
    buffer_load_dwordx4 v[216:219], v56, s[16:19], s96 offen offset:0 sc1
    v_mul_f32 v132, v8, v155
    v_mul_f32_e64 v133, v9, v155
    s_waitcnt lgkmcnt(2)
    v_mfma_f32_16x16x32_bf16 v[112:115], a[144:147], v[180:183], v[112:115]
    ds_read_b128 v[160:163], v198 offset:192
    v_mfma_f32_32x32x16_bf16 v[80:95], a[144:147], v[184:187], v[80:95]
    ds_read_b128 v[164:167], v196 offset:192
    v_mul_f32 v134, v10, v155
    v_mul_f32 v135, v11, v155
    v_mul_f32 v136, v12, v155
    s_waitcnt lgkmcnt(2)
    v_mfma_f32_16x16x32_bf16 v[112:115], a[148:151], v[188:191], v[112:115]
    ds_read_b128 v[168:171], v198 offset:224
    v_mfma_f32_32x32x16_bf16 v[80:95], a[148:151], v[192:195], v[80:95]
    ds_read_b128 v[172:175], v197 offset:192
    buffer_load_dwordx4 v[220:223], v56, s[16:19], s96 offen offset:256 sc1
    v_mul_f32 v137, v13, v155
    v_mul_f32_e64 v138, v14, v155
    s_waitcnt lgkmcnt(2)
    v_mfma_f32_16x16x32_bf16 v[112:115], a[152:155], v[160:163], v[112:115]
    ds_read_b128 v[176:179], v196 offset:8704
    v_mfma_f32_32x32x16_bf16 v[80:95], a[152:155], v[164:167], v[80:95]
    ds_read_b128 v[180:183], v197 offset:8704
    v_mul_f32 v139, v15, v155
    v_mul_f32 v140, v16, v155
    v_mul_f32 v141, v17, v155
    s_waitcnt lgkmcnt(2)
    v_mfma_f32_16x16x32_bf16 v[112:115], a[156:159], v[168:171], v[112:115]
    ds_read_b128 v[184:187], v196 offset:8768
    v_mfma_f32_32x32x16_bf16 v[80:95], a[156:159], v[172:175], v[80:95]
    ds_read_b128 v[188:191], v197 offset:8768
    s_mov_b32 s96, 4227072
    buffer_load_dwordx4 v[224:227], v56, s[16:19], s96 offen offset:0 sc1
    v_mul_f32 v142, v18, v155
    v_mul_f32 v143, v19, v155
    v_mul_f32 v144, v20, v155
    v_mul_f32 v145, v21, v155
    v_mul_f32 v146, v22, v155
    v_mul_f32_e64 v147, v23, v155
    s_waitcnt lgkmcnt(2)
    v_mfma_f32_32x32x16_bf16 v[96:111], a[128:131], v[176:179], v[96:111]
    ds_read_b128 v[192:195], v196 offset:8832
    v_mfma_f32_32x32x16_bf16 v[96:111], a[132:135], v[180:183], v[96:111]
    ds_read_b128 v[160:163], v197 offset:8832
    buffer_load_dwordx4 v[228:231], v56, s[16:19], s96 offen offset:256 sc1
    v_fma_f32 v112, v112, v156, v148
    v_fma_f32 v113, v113, v156, v149
    s_waitcnt lgkmcnt(2)
    v_mfma_f32_32x32x16_bf16 v[96:111], a[136:139], v[184:187], v[96:111]
    ds_read_b128 v[164:167], v196 offset:8896
    v_fma_f32 v114, v114, v156, v150
    v_fma_f32 v115, v115, v156, v151
    v_cvt_pk_bf16_f32 v112, v112, v113
    v_cvt_pk_bf16_f32 v113, v114, v115
    v_mfma_f32_32x32x16_bf16 v[96:111], a[140:143], v[188:191], v[96:111]
    ds_read_b128 v[168:171], v197 offset:8896
    s_mov_b32 s96, 4259840
    buffer_load_dwordx4 v[232:235], v56, s[16:19], s96 offen offset:0 sc1
    v_fma_f32 v80, v80, v152, v116
    v_fma_f32 v81, v81, v152, v117
    s_waitcnt lgkmcnt(2)
    v_mfma_f32_32x32x16_bf16 v[96:111], a[144:147], v[192:195], v[96:111]
    v_fma_f32 v82, v82, v152, v118
    v_fma_f32 v83, v83, v152, v119
    v_cvt_pk_bf16_f32 v80, v80, v81
    v_cvt_pk_bf16_f32 v81, v82, v83
    ds_write_b64 v40, v[112:113] offset:0
    v_mfma_f32_32x32x16_bf16 v[96:111], a[148:151], v[160:163], v[96:111]
    ds_write_b64 v38, v[80:81] offset:0
    v_fma_f32 v84, v84, v152, v120
    v_fma_f32 v85, v85, v152, v121
    v_fma_f32 v86, v86, v152, v122
    s_waitcnt lgkmcnt(2)
    v_mfma_f32_32x32x16_bf16 v[96:111], a[152:155], v[164:167], v[96:111]
    v_fma_f32 v87, v87, v152, v123
    v_cvt_pk_bf16_f32 v84, v84, v85
    v_cvt_pk_bf16_f32 v85, v86, v87
    v_fma_f32 v88, v88, v152, v124
    v_fma_f32 v89, v89, v152, v125
    v_mfma_f32_32x32x16_bf16 v[96:111], a[156:159], v[168:171], v[96:111]
    buffer_load_dwordx4 v[236:239], v56, s[16:19], s96 offen offset:256 sc1
    v_fma_f32 v90, v90, v152, v126
    v_fma_f32 v91, v91, v152, v127
    v_cvt_pk_bf16_f32 v88, v88, v89
    v_cvt_pk_bf16_f32 v89, v90, v91
    ds_write_b64 v38, v[84:85] offset:6400
    ds_write_b64 v38, v[88:89] offset:12800
    v_fma_f32 v92, v92, v152, v128
    v_fma_f32 v93, v93, v152, v129
    v_fma_f32 v94, v94, v152, v130
    v_fma_f32 v95, v95, v152, v131
    v_cvt_pk_bf16_f32 v92, v92, v93
    v_cvt_pk_bf16_f32 v93, v94, v95
    ds_write_b64 v39, v[92:93] offset:0
    v_pk_fma_f32 v[96:97], v[96:97], v[154:155], v[132:133] op_sel_hi:[1,0,1]
    v_pk_fma_f32 v[98:99], v[98:99], v[154:155], v[134:135] op_sel_hi:[1,0,1]
    v_cvt_pk_bf16_f32 v96, v96, v97
    v_cvt_pk_bf16_f32 v97, v98, v99
    v_pk_fma_f32 v[100:101], v[100:101], v[154:155], v[136:137] op_sel_hi:[1,0,1]
    v_pk_fma_f32 v[102:103], v[102:103], v[154:155], v[138:139] op_sel_hi:[1,0,1]
    v_cvt_pk_bf16_f32 v100, v100, v101
    v_cvt_pk_bf16_f32 v101, v102, v103
    ds_write_b64 v38, v[96:97] offset:1600
    ds_write_b64 v38, v[100:101] offset:8000
    v_pk_fma_f32 v[104:105], v[104:105], v[154:155], v[140:141] op_sel_hi:[1,0,1]
    v_pk_fma_f32 v[106:107], v[106:107], v[154:155], v[142:143] op_sel_hi:[1,0,1]
    v_cvt_pk_bf16_f32 v104, v104, v105
    v_cvt_pk_bf16_f32 v105, v106, v107
    v_pk_fma_f32 v[108:109], v[108:109], v[154:155], v[144:145] op_sel_hi:[1,0,1]
    v_pk_fma_f32 v[110:111], v[110:111], v[154:155], v[146:147] op_sel_hi:[1,0,1]
    v_cvt_pk_bf16_f32 v108, v108, v109
    v_cvt_pk_bf16_f32 v109, v110, v111
    ds_write_b64 v38, v[104:105] offset:14400
    ds_write_b64 v39, v[108:109] offset:1600
    s_waitcnt lgkmcnt(0)
    s_barrier
    v_mov_b32 v94, 0
    v_mov_b32 v95, 0
    v_mov_b32 v98, 0
    v_mov_b32_e64 v99, 0
    s_mov_b64 exec, 0xffff
    ds_read_b64 v[94:95], v42 offset:320
    ds_read_b64 v[98:99], v42 offset:640
    s_mov_b64 exec, -1
    s_nop 0
    ds_read_b64 v[92:93], v41 offset:320
    ds_read_b64 v[96:97], v41 offset:640
    ds_read_b64 v[84:85], v41 offset:6720
    ds_read_b64 v[86:87], v42 offset:6720
    ds_read_b64 v[80:81], v41 offset:6400
    ds_read_b64 v[82:83], v42 offset:6400
    ds_read_b64 v[88:89], v41 offset:7040
    ds_read_b64 v[90:91], v42 offset:7040
    ds_read_b64_tr_b16 v[106:107], v44 offset:0
    ds_read_b64_tr_b16 v[100:101], v43 offset:0
    ds_read_b64_tr_b16 v[108:109], v44 offset:320
    ds_read_b64_tr_b16 v[102:103], v43 offset:320
    s_mov_b32 s96, 4292608
    buffer_load_dwordx4 v[240:243], v56, s[16:19], s96 offen offset:0 sc1
    ds_read_b64_tr_b16 v[110:111], v44 offset:640
    ds_read_b64_tr_b16 v[104:105], v43 offset:640
    s_mov_b32 s82, 0x3ea52b5c
    s_lshl_b32 s25, s98, 4
    s_add_u32 s25, s25, 4194304
    s_lshl_b32 s26, s98, 3
    s_add_u32 s26, s26, 4194304
    s_waitcnt lgkmcnt(10)
    v_mfma_f32_16x16x32_bf16 v[116:119], v[84:87], v[92:95], v[28:31]
    buffer_load_dwordx4 v[244:247], v56, s[16:19], s96 offen offset:256 sc1
    v_mfma_f32_16x16x32_bf16 v[120:123], v[84:87], v[96:99], v[32:35]
    s_waitcnt lgkmcnt(8)
    v_mfma_f32_16x16x32_bf16 v[112:115], v[80:83], v[92:95], v[32:35]
    s_waitcnt lgkmcnt(6)
    v_mfma_f32_16x16x32_bf16 v[124:127], v[88:91], v[96:99], v[28:31]
    s_nop 5
    v_max_f32 v112, v112, v116
    v_max_f32 v113, v113, v117
    v_max_f32 v114, v114, v118
    v_max_f32 v115, v115, v119
    v_max3_f32 v156, v112, v113, v114
    s_mov_b32 s96, 4194304
    buffer_load_dwordx2 v[248:249], v57, s[16:19], s96 offen offset:0 sc1
    v_max_f32 v156, v156, v115
    v_max_f32 v120, v120, v124
    v_max_f32 v121, v121, v125
    v_max_f32 v122, v122, v126
    v_max_f32 v123, v123, v127
    v_max3_f32 v157, v120, v121, v122
    v_max_f32 v157, v157, v123
    s_nop 1
    v_permlane16_swap_b32 v156, v157
    buffer_load_dwordx2 v[252:253], v57, s[16:19], s96 offen offset:128 sc1
    v_max_f32 v156, v156, v157
    v_mov_b32 v157, v156
    s_nop 1
    v_permlane32_swap_b32 v156, v157
    v_max_f32 v156, v156, v157
    v_mul_f32 v156, s82, v156
    v_mov_b32 v157, v156
    s_nop 1
    v_permlane16_swap_b32_e64 v156, v157
    v_fma_f32 v112, v112, s82, -v156
    s_mov_b32 s96, 4210688
    buffer_load_dwordx2 v[250:251], v57, s[16:19], s96 offen offset:0 sc1
    v_fma_f32 v113, v113, s82, -v156
    v_fma_f32 v114, v114, s82, -v156
    v_fma_f32 v115, v115, s82, -v156
    v_exp_f32 v112, v112
    v_exp_f32 v113, v113
    v_exp_f32 v114, v114
    v_exp_f32 v115, v115
    v_cvt_pk_bf16_f32 v116, v112, v113
    buffer_load_dwordx2 v[254:255], v57, s[16:19], s96 offen offset:128 sc1
    v_cvt_pk_bf16_f32 v117, v114, v115
    v_bfi_b32 v128, v36, 0, v116
    v_and_b32 v130, v36, v116
    v_bfi_b32 v129, v37, 0, v117
    v_and_b32 v131, v37, v117
    s_waitcnt lgkmcnt(3)
    s_nop 0
    v_mfma_f32_16x16x32_bf16 v[144:147], v[106:109], v[128:131], 0
    s_waitcnt lgkmcnt(2)
    v_mfma_f32_16x16x32_bf16 v[136:139], v[100:103], v[128:131], 0
    v_fma_f32 v120, v120, s82, -v157
    s_mov_b32 s96, 0
    s_mov_b32 s97, 5120
    buffer_load_dwordx2 v[208:209], v60, s[4:7], s96 offen
    v_fma_f32 v121, v121, s82, -v157
    v_fma_f32 v122, v122, s82, -v157
    v_fma_f32 v123, v123, s82, -v157
    v_exp_f32 v120, v120
    v_exp_f32 v121, v121
    v_exp_f32 v122, v122
    v_exp_f32 v123, v123
    v_cvt_pk_bf16_f32 v124, v120, v121
    buffer_load_dwordx2 v[210:211], v60, s[4:7], s97 offen
    v_cvt_pk_bf16_f32 v125, v122, v123
    v_bfi_b32 v132, v36, 0, v124
    v_and_b32 v134, v36, v124
    v_bfi_b32 v133, v37, 0, v125
    v_and_b32 v135, v37, v125
    s_waitcnt lgkmcnt(1)
    s_nop 0
    v_mfma_f32_16x16x32_bf16 v[148:151], v[108:111], v[132:135], 0
    s_waitcnt lgkmcnt(0)
    v_mfma_f32_16x16x32_bf16 v[140:143], v[102:105], v[132:135], 0
    v_mov_b32 v158, v144
    v_lshrrev_b32_e64 v212, 5, v1
    v_mul_u32_u24 v212, 5104, v212
    v_bfe_u32 v213, v1, 4, 1
    v_lshlrev_b32 v213, 2, v213
    v_sub_u32 v212, v212, v213
    v_add_u32 v212, v212, v60
    s_mul_i32 s97, s24, 24
    s_sub_u32 s97, 128, s97
    buffer_load_dword v212, v212, s[4:7], s97 offen
    v_permlane16_swap_b32 v144, v158
    v_rcp_f32_e64 v158, v158
    s_nop 0
    v_pk_mul_f32 v[136:137], v[136:137], v[158:159] op_sel_hi:[1,0]
    v_pk_mul_f32 v[138:139], v[138:139], v[158:159] op_sel_hi:[1,0]
    v_pk_mul_f32 v[144:145], v[144:145], v[158:159] op_sel_hi:[1,0]
    v_pk_mul_f32 v[146:147], v[146:147], v[158:159] op_sel_hi:[1,0]
    v_cvt_pk_bf16_f32 v112, v136, v137
    v_cvt_pk_bf16_f32 v116, v144, v145
    v_cvt_pk_bf16_f32 v113, v138, v139
    v_cvt_pk_bf16_f32 v117, v146, v147
    v_mov_b32 v160, v148
    s_nop 1
    v_permlane16_swap_b32 v148, v160
    v_rcp_f32_e64 v160, v160
    s_nop 0
    v_pk_mul_f32 v[140:141], v[140:141], v[160:161] op_sel_hi:[1,0]
    v_pk_mul_f32 v[142:143], v[142:143], v[160:161] op_sel_hi:[1,0]
    v_pk_mul_f32 v[148:149], v[148:149], v[160:161] op_sel_hi:[1,0]
    v_pk_mul_f32 v[150:151], v[150:151], v[160:161] op_sel_hi:[1,0]
    v_cvt_pk_bf16_f32 v114, v140, v141
    v_cvt_pk_bf16_f32 v118, v148, v149
    v_cvt_pk_bf16_f32 v115, v142, v143
    v_cvt_pk_bf16_f32 v119, v150, v151
    v_permlane16_swap_b32 v112, v114
    v_permlane16_swap_b32 v113, v115
    v_permlane16_swap_b32 v116, v118
    v_permlane16_swap_b32 v117, v119
    buffer_store_dwordx4 v[112:115], v45, s[16:19], s25 offen sc1
    s_mov_b64 exec, s[80:81]
    buffer_store_dwordx2 v[116:117], v46, s[16:19], s26 offen sc1
    s_mov_b64 exec, -1
oe_20:
    s_waitcnt vmcnt(16)
    v_mfma_f32_16x16x32_bf16 v[112:115], a[176:179], v[216:219], 0
    v_mov_b32 v136, 0
    v_mov_b32 v137, 0
    s_waitcnt vmcnt(15)
    v_mfma_f32_16x16x32_bf16 v[116:119], a[176:179], v[220:223], 0
    v_mov_b32 v138, 0
    v_mov_b32 v139, 0
    s_waitcnt vmcnt(14)
    v_mfma_f32_16x16x32_bf16 v[112:115], a[196:199], v[224:227], v[112:115]
    v_mov_b32 v140, 0
    v_mov_b32 v141, 0
    s_waitcnt vmcnt(13)
    v_mfma_f32_16x16x32_bf16 v[116:119], a[196:199], v[228:231], v[116:119]
    s_mov_b32 s25, 6815744
    s_add_u32 s26, s36, 6815744
    s_waitcnt vmcnt(12)
    v_mfma_f32_16x16x32_bf16 v[112:115], a[216:219], v[232:235], v[112:115]
    s_add_u32 s27, s35, 3473408
    s_mov_b32 s28, 0x99999999
    s_waitcnt vmcnt(11)
    v_mfma_f32_16x16x32_bf16 v[116:119], a[216:219], v[236:239], v[116:119]
    s_mov_b32 s29, 0x99999999
    s_waitcnt vmcnt(10)
    v_mfma_f32_16x16x32_bf16 v[112:115], a[236:239], v[240:243], v[112:115]
    s_waitcnt vmcnt(9)
    v_mfma_f32_16x16x32_bf16 v[116:119], a[236:239], v[244:247], v[116:119]
    s_waitcnt vmcnt(6)
    v_mfma_f32_16x16x32_bf16 v[112:115], v[52:55], v[248:251], v[112:115]
    s_waitcnt vmcnt(5)
    v_mfma_f32_16x16x32_bf16 v[116:119], v[52:55], v[252:255], v[116:119]
    v_mfma_f32_16x16x32_bf16 v[88:91], a[164:167], v[216:219], 0
    v_mfma_f32_16x16x32_bf16 v[92:95], a[164:167], v[220:223], 0
    v_mfma_f32_16x16x32_bf16 v[88:91], a[184:187], v[224:227], v[88:91]
    v_mfma_f32_16x16x32_bf16 v[92:95], a[184:187], v[228:231], v[92:95]
    v_mfma_f32_16x16x32_bf16 v[88:91], a[204:207], v[232:235], v[88:91]
    v_mfma_f32_16x16x32_bf16 v[92:95], a[204:207], v[236:239], v[92:95]
    s_nop 1
    v_cmp_u_f32 vcc, v112, v116
    s_nop 0
    s_cbranch_vccnz rd_21
rc_22:
    v_mfma_f32_16x16x32_bf16 v[88:91], a[224:227], v[240:243], v[88:91]
    ds_write_b128 v203, v[112:115] offset:24576
    v_mfma_f32_16x16x32_bf16 v[92:95], a[224:227], v[244:247], v[92:95]
    v_mfma_f32_16x16x32_bf16 v[88:91], a[244:247], v[248:251], v[88:91]
    ds_write_b128 v203, v[116:119] offset:25600
    v_mfma_f32_16x16x32_bf16 v[92:95], a[244:247], v[252:255], v[92:95]
    v_mfma_f32_16x16x32_bf16 v[96:99], a[168:171], v[216:219], 0
    s_waitcnt vmcnt(4)
    v_lshlrev_b32 v120, 16, v208
    v_and_b32 v121, 0xffff0000, v208
    v_mfma_f32_16x16x32_bf16 v[100:103], a[168:171], v[220:223], 0
    v_lshlrev_b32_e64 v122, 16, v209
    v_and_b32 v123, 0xffff0000, v209
    v_mfma_f32_16x16x32_bf16 v[96:99], a[188:191], v[224:227], v[96:99]
    s_waitcnt vmcnt(3)
    v_lshlrev_b32 v124, 16, v210
    v_and_b32 v125, 0xffff0000, v210
    v_mfma_f32_16x16x32_bf16 v[100:103], a[188:191], v[228:231], v[100:103]
    v_lshlrev_b32_e64 v126, 16, v211
    v_and_b32 v127, 0xffff0000, v211
    v_mfma_f32_16x16x32_bf16 v[96:99], a[208:211], v[232:235], v[96:99]
    s_waitcnt vmcnt(2)
    v_lshlrev_b32 v128, 16, v212
    v_and_b32 v129, 0xffff0000, v212
    v_mfma_f32_16x16x32_bf16 v[100:103], a[208:211], v[236:239], v[100:103]
    v_mfma_f32_16x16x32_bf16 v[96:99], a[228:231], v[240:243], v[96:99]
    ds_write_b128 v200, v[88:91] offset:0
    v_mfma_f32_16x16x32_bf16 v[100:103], a[228:231], v[244:247], v[100:103]
    v_mfma_f32_16x16x32_bf16 v[96:99], a[248:251], v[248:251], v[96:99]
    ds_write_b128 v200, v[92:95] offset:1024
    v_mfma_f32_16x16x32_bf16 v[100:103], a[248:251], v[252:255], v[100:103]
    v_mfma_f32_16x16x32_bf16 v[104:107], a[172:175], v[216:219], 0
    v_mfma_f32_16x16x32_bf16 v[108:111], a[172:175], v[220:223], 0
    v_mfma_f32_16x16x32_bf16 v[104:107], a[192:195], v[224:227], v[104:107]
    v_mfma_f32_16x16x32_bf16 v[108:111], a[192:195], v[228:231], v[108:111]
    v_mfma_f32_16x16x32_bf16 v[104:107], a[212:215], v[232:235], v[104:107]
    v_mfma_f32_16x16x32_bf16 v[108:111], a[212:215], v[236:239], v[108:111]
    v_mfma_f32_16x16x32_bf16 v[104:107], a[232:235], v[240:243], v[104:107]
    ds_write_b128 v201, v[96:99] offset:2048
    v_mfma_f32_16x16x32_bf16 v[108:111], a[232:235], v[244:247], v[108:111]
    v_mfma_f32_16x16x32_bf16 v[104:107], a[252:255], v[248:251], v[104:107]
    ds_write_b128 v201, v[100:103] offset:3072
    v_mfma_f32_16x16x32_bf16 v[108:111], a[252:255], v[252:255], v[108:111]
    v_mfma_f32_16x16x32_bf16 v[80:83], a[160:163], v[216:219], v[120:123]
    v_mfma_f32_16x16x32_bf16 v[84:87], a[160:163], v[220:223], v[124:127]
    v_mfma_f32_16x16x32_bf16 v[80:83], a[180:183], v[224:227], v[80:83]
    v_mfma_f32_16x16x32_bf16 v[84:87], a[180:183], v[228:231], v[84:87]
    v_mfma_f32_16x16x32_bf16 v[80:83], a[200:203], v[232:235], v[80:83]
    s_nop 0
    ds_write_b128 v202, v[104:107] offset:4096
    v_mfma_f32_16x16x32_bf16 v[84:87], a[200:203], v[236:239], v[84:87]
    ds_write_b128 v202, v[108:111] offset:5120
    v_mfma_f32_16x16x32_bf16 v[80:83], a[220:223], v[240:243], v[80:83]
    v_mfma_f32_16x16x32_bf16 v[84:87], a[220:223], v[244:247], v[84:87]
    v_mfma_f32_16x16x32_bf16 v[80:83], a[240:243], v[248:251], v[80:83]
    v_mfma_f32_16x16x32_bf16 v[84:87], a[240:243], v[252:255], v[84:87]
    s_waitcnt lgkmcnt(0)
    s_barrier
    s_nop 0
    ds_read_b128 v[88:91], v204 offset:0
    ds_read_b128 v[92:95], v204 offset:1024
    ds_read_b128 v[96:99], v204 offset:2048
    ds_read_b128 v[100:103], v204 offset:3072
    ds_read_b128 v[104:107], v204 offset:4096
    ds_read_b128 v[108:111], v204 offset:5120
    ds_read_b64 v[112:113], v205 offset:24576
    ds_read_b64 v[114:115], v205 offset:26624
    ds_read_b64 v[116:117], v205 offset:28672
    ds_read_b64 v[118:119], v205 offset:30720
    s_waitcnt lgkmcnt(9)
    v_pk_add_f32 v[80:81], v[80:81], v[88:89]
    v_pk_add_f32 v[82:83], v[82:83], v[90:91]
    s_waitcnt lgkmcnt(8)
    v_pk_add_f32 v[84:85], v[84:85], v[92:93]
    v_pk_add_f32 v[86:87], v[86:87], v[94:95]
    s_waitcnt lgkmcnt(7)
    v_pk_add_f32 v[80:81], v[80:81], v[96:97]
    v_pk_add_f32 v[82:83], v[82:83], v[98:99]
    s_waitcnt lgkmcnt(6)
    v_pk_add_f32 v[84:85], v[84:85], v[100:101]
    v_pk_add_f32 v[86:87], v[86:87], v[102:103]
    s_waitcnt lgkmcnt(5)
    v_pk_add_f32 v[80:81], v[80:81], v[104:105]
    v_pk_add_f32 v[82:83], v[82:83], v[106:107]
    s_waitcnt lgkmcnt(4)
    v_pk_add_f32 v[84:85], v[84:85], v[108:109]
    v_pk_add_f32 v[86:87], v[86:87], v[110:111]
    v_cvt_pk_bf16_f32 v132, v80, v81
    v_cvt_pk_bf16_f32 v133, v82, v83
    v_cvt_pk_bf16_f32 v134, v84, v85
    v_cvt_pk_bf16_f32 v135, v86, v87
    s_waitcnt lgkmcnt(3)
    v_pk_add_f32 v[128:129], v[128:129], v[112:113]
    s_waitcnt lgkmcnt(2)
    v_pk_add_f32 v[128:129], v[128:129], v[114:115]
    s_waitcnt lgkmcnt(1)
    v_pk_add_f32 v[128:129], v[128:129], v[116:117]
    s_waitcnt lgkmcnt(0)
    v_pk_add_f32 v[128:129], v[128:129], v[118:119]
    v_cvt_pk_bf16_f32 v130, v128, v129
    buffer_store_dwordx4 v[132:135], v59, s[16:19], s25 offen sc1
    buffer_store_dword v130, v61, s[16:19], s26 offen sc1
    v_dot2c_f32_bf16 v136, v132, v215
    v_dot2c_f32_bf16 v137, v132, v132
    v_dot2c_f32_bf16 v136, v133, v215
    v_dot2c_f32_bf16 v137, v133, v133
    v_dot2c_f32_bf16 v138, v134, v215
    v_dot2c_f32_bf16 v139, v134, v134
    v_dot2c_f32_bf16 v138, v135, v215
    v_dot2c_f32_bf16 v139, v135, v135
    v_dot2c_f32_bf16 v140, v130, v215
    v_dot2c_f32_bf16 v141, v130, v130
    v_permlane32_swap_b32 v136, v138
    v_permlane32_swap_b32 v137, v139
    v_pk_add_f32 v[136:137], v[136:137], v[138:139]
    v_pk_add_f32 v[136:137], v[136:137], v[140:141]
    s_nop 1
    v_permlane16_swap_b32 v136, v137
    v_add_f32_e64 v136, v136, v137
    ds_write_b32 v206, v136 offset:32768
    s_mov_b32 s96, 4198400
    buffer_load_dwordx4 v[216:219], v56, s[16:19], s96 offen offset:0 sc1
    buffer_load_dwordx4 v[220:223], v56, s[16:19], s96 offen offset:256 sc1
    s_mov_b32 s96, 4231168
    buffer_load_dwordx4 v[224:227], v56, s[16:19], s96 offen offset:0 sc1
    buffer_load_dwordx4 v[228:231], v56, s[16:19], s96 offen offset:256 sc1
    s_mov_b32 s96, 4263936
    buffer_load_dwordx4 v[232:235], v56, s[16:19], s96 offen offset:0 sc1
    buffer_load_dwordx4 v[236:239], v56, s[16:19], s96 offen offset:256 sc1
    s_waitcnt lgkmcnt(0)
    s_barrier
    ds_read2st64_b32 v[136:137], v207 offset0:0 offset1:1
    ds_read2st64_b32 v[138:139], v207 offset0:2 offset1:3
    ds_read_b64_tr_b16 v[144:145], v65 offset:32
    ds_read_b64_tr_b16 v[146:147], v65 offset:0
    ds_read_b64_tr_b16 v[148:149], v65 offset:160
    ds_read_b64_tr_b16 v[150:151], v65 offset:128
    ds_read_b64_tr_b16 v[152:153], v65 offset:288
    ds_read_b64_tr_b16 v[154:155], v65 offset:256
    ds_read_b64_tr_b16 v[156:157], v65 offset:416
    ds_read_b64_tr_b16 v[158:159], v65 offset:384
    ds_read_b64_tr_b16 v[160:161], v65 offset:544
    ds_read_b64_tr_b16 v[162:163], v65 offset:512
    ds_read_b64_tr_b16 v[164:165], v65 offset:672
    ds_read_b64_tr_b16 v[166:167], v65 offset:640
    ds_read_b64_tr_b16 v[168:169], v65 offset:800
    ds_read_b64_tr_b16 v[170:171], v65 offset:768
    ds_read_b64_tr_b16 v[172:173], v65 offset:928
    ds_read_b64_tr_b16 v[174:175], v65 offset:896
    s_waitcnt lgkmcnt(15)
    v_pk_add_f32 v[136:137], v[136:137], v[138:139]
    v_add_f32 v136, v136, v137
    v_cndmask_b32 v136, v136, 1.0, s[28:29]
    s_mov_b64 exec, s[80:81]
    buffer_atomic_add_f32 v136, v214, s[16:19], s27 offen
    s_mov_b64 exec, -1
    s_mov_b32 s96, 4296704
    buffer_load_dwordx4 v[240:243], v56, s[16:19], s96 offen offset:0 sc1
    buffer_load_dwordx4 v[244:247], v56, s[16:19], s96 offen offset:256 sc1
    s_mov_b32 s96, 4196352
    buffer_load_dwordx2 v[248:249], v57, s[16:19], s96 offen offset:0 sc1
    buffer_load_dwordx2 v[252:253], v57, s[16:19], s96 offen offset:128 sc1
    s_mov_b32 s96, 4212736
    buffer_load_dwordx2 v[250:251], v57, s[16:19], s96 offen offset:0 sc1
    buffer_load_dwordx2 v[254:255], v57, s[16:19], s96 offen offset:128 sc1
    s_mov_b32 s96, 1310720
    s_mov_b32 s97, 1315840
    buffer_load_dwordx2 v[208:209], v60, s[4:7], s96 offen
    buffer_load_dwordx2 v[210:211], v60, s[4:7], s97 offen
    v_lshrrev_b32_e64 v212, 5, v1
    v_mul_u32_u24 v212, 5104, v212
    v_bfe_u32 v213, v1, 4, 1
    v_lshlrev_b32 v213, 2, v213
    v_sub_u32 v212, v212, v213
    v_add_u32 v212, v212, v60
    s_mul_i32 s97, s24, 24
    s_sub_u32 s97, 1310848, s97
    buffer_load_dword v212, v212, s[4:7], s97 offen
    v_lshrrev_b32 v176, 4, v0
    v_mul_u32_u24 v176, 1216, v176
    v_and_b32 v177, 15, v0
    v_lshl_add_u32 v176, v177, 3, v176
    v_add_u32 v176, 64, v176
    v_mov_b32 v178, 0
    v_mov_b32 v179, 0
    ds_write_b64 v176, v[178:179]
    v_mov_b32 v70, 0
    v_mov_b32 v71, 0
    v_mov_b32 v72, 0
    s_lshl_b32 s25, s24, 17
    v_lshrrev_b32 v176, 5, v1
    v_lshl_add_u32 v176, v176, 14, s25
    v_bfe_u32 v177, v1, 4, 1
    v_lshl_add_u32 v176, v177, 13, v176
    v_and_b32_e64 v177, 15, v1
    v_lshl_add_u32 v73, v177, 4, v176
    v_bfe_u32 v176, v1, 2, 3
    v_lshl_add_u32 v176, v176, 14, s25
    v_bfe_u32 v177, v1, 1, 1
    v_lshl_add_u32 v176, v177, 13, v176
    v_and_b32 v177, 1, v1
    v_lshl_add_u32 v77, v177, 4, v176
    v_lshrrev_b32 v177, 5, v1
    v_and_b32 v176, 31, v1
    v_lshlrev_b32 v176, 3, v176
    v_lshl_add_u32 v78, v177, 10, v176
    v_and_b32 v176, 7, v1
    v_lshlrev_b32 v176, 3, v176
    v_lshl_add_u32 v178, v177, 7, v176
    v_add_u32 v74, 31744, v73
    v_add_u32 v75, 63488, v73
    v_add_u32 v76, 95232, v73
    v_add_u32 v178, 53760, v178
    v_and_b32 v176, 31, v1
    v_cmp_eq_u32 vcc, 0, v176
    v_cmp_eq_u32 s[82:83], 24, v176
    s_nop 0
    s_or_b64 vcc, vcc, s[82:83]
    v_mov_b32 v176, 155648
    v_mov_b32 v177, 157696
    v_cndmask_b32 v176, v176, v177, vcc
    v_cndmask_b32 v79, v176, v178, s[78:79]
oe_23:
    s_waitcnt vmcnt(15)
    v_mfma_f32_16x16x32_bf16 v[112:115], a[176:179], v[216:219], 0
    v_mov_b32 v136, 0
    v_mov_b32 v137, 0
    s_waitcnt vmcnt(14)
    v_mfma_f32_16x16x32_bf16 v[116:119], a[176:179], v[220:223], 0
    v_mov_b32 v138, 0
    v_mov_b32 v139, 0
    s_waitcnt vmcnt(13)
    v_mfma_f32_16x16x32_bf16 v[112:115], a[196:199], v[224:227], v[112:115]
    v_mov_b32 v140, 0
    v_mov_b32_e64 v141, 0
    s_waitcnt vmcnt(12)
    v_mfma_f32_16x16x32_bf16 v[116:119], a[196:199], v[228:231], v[116:119]
    s_mov_b32 s25, 6817792
    s_add_u32 s26, s36, 6817792
    s_waitcnt vmcnt(11)
    v_mfma_f32_16x16x32_bf16 v[112:115], a[216:219], v[232:235], v[112:115]
    s_add_u32 s27, s35, 3477504
    s_mov_b32 s28, 0x99999999
    s_waitcnt vmcnt(10)
    v_mfma_f32_16x16x32_bf16 v[116:119], a[216:219], v[236:239], v[116:119]
    s_mov_b32 s29, 0x99999999
    s_waitcnt vmcnt(8)
    v_mfma_f32_16x16x32_bf16 v[112:115], a[236:239], v[240:243], v[112:115]
    s_waitcnt vmcnt(7)
    v_mfma_f32_16x16x32_bf16 v[116:119], a[236:239], v[244:247], v[116:119]
    s_waitcnt vmcnt(4)
    v_mfma_f32_16x16x32_bf16 v[112:115], v[52:55], v[248:251], v[112:115]
    s_waitcnt vmcnt(3)
    v_mfma_f32_16x16x32_bf16 v[116:119], v[52:55], v[252:255], v[116:119]
    v_mfma_f32_16x16x32_bf16 v[88:91], a[164:167], v[216:219], 0
    v_mfma_f32_16x16x32_bf16 v[92:95], a[164:167], v[220:223], 0
    v_mfma_f32_16x16x32_bf16 v[88:91], a[184:187], v[224:227], v[88:91]
    v_mfma_f32_16x16x32_bf16 v[92:95], a[184:187], v[228:231], v[92:95]
    v_mfma_f32_16x16x32_bf16 v[88:91], a[204:207], v[232:235], v[88:91]
    v_mfma_f32_16x16x32_bf16 v[92:95], a[204:207], v[236:239], v[92:95]
    s_nop 1
    v_cmp_u_f32 vcc, v112, v116
    s_nop 0
    s_cbranch_vccnz rd_24
rc_25:
    v_mfma_f32_16x16x32_bf16 v[88:91], a[224:227], v[240:243], v[88:91]
    ds_write_b128 v203, v[112:115] offset:24576
    v_mfma_f32_16x16x32_bf16 v[92:95], a[224:227], v[244:247], v[92:95]
    v_mfma_f32_16x16x32_bf16 v[88:91], a[244:247], v[248:251], v[88:91]
    ds_write_b128 v203, v[116:119] offset:25600
    v_mfma_f32_16x16x32_bf16 v[92:95], a[244:247], v[252:255], v[92:95]
    v_mfma_f32_16x16x32_bf16 v[96:99], a[168:171], v[216:219], 0
    s_waitcnt vmcnt(2)
    v_lshlrev_b32 v120, 16, v208
    v_and_b32 v121, 0xffff0000, v208
    v_mfma_f32_16x16x32_bf16 v[100:103], a[168:171], v[220:223], 0
    v_lshlrev_b32_e64 v122, 16, v209
    v_and_b32 v123, 0xffff0000, v209
    v_mfma_f32_16x16x32_bf16 v[96:99], a[188:191], v[224:227], v[96:99]
    s_waitcnt vmcnt(1)
    v_lshlrev_b32 v124, 16, v210
    v_and_b32 v125, 0xffff0000, v210
    v_mfma_f32_16x16x32_bf16 v[100:103], a[188:191], v[228:231], v[100:103]
    v_lshlrev_b32_e64 v126, 16, v211
    v_and_b32 v127, 0xffff0000, v211
    v_mfma_f32_16x16x32_bf16 v[96:99], a[208:211], v[232:235], v[96:99]
    s_waitcnt vmcnt(0)
    v_lshlrev_b32 v128, 16, v212
    v_and_b32 v129, 0xffff0000, v212
    v_mfma_f32_16x16x32_bf16 v[100:103], a[208:211], v[236:239], v[100:103]
    v_mfma_f32_16x16x32_bf16 v[96:99], a[228:231], v[240:243], v[96:99]
    ds_write_b128 v200, v[88:91] offset:0
    v_mfma_f32_16x16x32_bf16 v[100:103], a[228:231], v[244:247], v[100:103]
    v_mfma_f32_16x16x32_bf16 v[96:99], a[248:251], v[248:251], v[96:99]
    ds_write_b128 v200, v[92:95] offset:1024
    v_mfma_f32_16x16x32_bf16 v[100:103], a[248:251], v[252:255], v[100:103]
    v_mfma_f32_16x16x32_bf16 v[104:107], a[172:175], v[216:219], 0
    v_mfma_f32_16x16x32_bf16 v[108:111], a[172:175], v[220:223], 0
    v_mfma_f32_16x16x32_bf16 v[104:107], a[192:195], v[224:227], v[104:107]
    v_mfma_f32_16x16x32_bf16 v[108:111], a[192:195], v[228:231], v[108:111]
    v_mfma_f32_16x16x32_bf16 v[104:107], a[212:215], v[232:235], v[104:107]
    v_mfma_f32_16x16x32_bf16 v[108:111], a[212:215], v[236:239], v[108:111]
    v_mfma_f32_16x16x32_bf16 v[104:107], a[232:235], v[240:243], v[104:107]
    ds_write_b128 v201, v[96:99] offset:2048
    v_mfma_f32_16x16x32_bf16 v[108:111], a[232:235], v[244:247], v[108:111]
    v_mfma_f32_16x16x32_bf16 v[104:107], a[252:255], v[248:251], v[104:107]
    ds_write_b128 v201, v[100:103] offset:3072
    v_mfma_f32_16x16x32_bf16 v[108:111], a[252:255], v[252:255], v[108:111]
    v_mfma_f32_16x16x32_bf16 v[80:83], a[160:163], v[216:219], v[120:123]
    v_mfma_f32_16x16x32_bf16 v[84:87], a[160:163], v[220:223], v[124:127]
    v_mfma_f32_16x16x32_bf16 v[80:83], a[180:183], v[224:227], v[80:83]
    v_mfma_f32_16x16x32_bf16 v[84:87], a[180:183], v[228:231], v[84:87]
    v_mfma_f32_16x16x32_bf16 v[80:83], a[200:203], v[232:235], v[80:83]
    s_nop 0
    ds_write_b128 v202, v[104:107] offset:4096
    v_mfma_f32_16x16x32_bf16 v[84:87], a[200:203], v[236:239], v[84:87]
    ds_write_b128 v202, v[108:111] offset:5120
    v_mfma_f32_16x16x32_bf16 v[80:83], a[220:223], v[240:243], v[80:83]
    v_mfma_f32_16x16x32_bf16 v[84:87], a[220:223], v[244:247], v[84:87]
    v_mfma_f32_16x16x32_bf16 v[80:83], a[240:243], v[248:251], v[80:83]
    v_mfma_f32_16x16x32_bf16 v[84:87], a[240:243], v[252:255], v[84:87]
    s_waitcnt lgkmcnt(0)
    s_barrier
    s_nop 0
    ds_read_b128 v[88:91], v204 offset:0
    ds_read_b128 v[92:95], v204 offset:1024
    ds_read_b128 v[96:99], v204 offset:2048
    ds_read_b128 v[100:103], v204 offset:3072
    ds_read_b128 v[104:107], v204 offset:4096
    ds_read_b128 v[108:111], v204 offset:5120
    ds_read_b64 v[112:113], v205 offset:24576
    ds_read_b64 v[114:115], v205 offset:26624
    ds_read_b64 v[116:117], v205 offset:28672
    ds_read_b64 v[118:119], v205 offset:30720
    s_waitcnt lgkmcnt(9)
    v_pk_add_f32 v[80:81], v[80:81], v[88:89]
    v_pk_add_f32 v[82:83], v[82:83], v[90:91]
    s_waitcnt lgkmcnt(8)
    v_pk_add_f32 v[84:85], v[84:85], v[92:93]
    v_pk_add_f32 v[86:87], v[86:87], v[94:95]
    s_waitcnt lgkmcnt(7)
    v_pk_add_f32 v[80:81], v[80:81], v[96:97]
    v_pk_add_f32 v[82:83], v[82:83], v[98:99]
    s_waitcnt lgkmcnt(6)
    v_pk_add_f32 v[84:85], v[84:85], v[100:101]
    v_pk_add_f32 v[86:87], v[86:87], v[102:103]
    s_waitcnt lgkmcnt(5)
    v_pk_add_f32 v[80:81], v[80:81], v[104:105]
    v_pk_add_f32 v[82:83], v[82:83], v[106:107]
    s_waitcnt lgkmcnt(4)
    v_pk_add_f32 v[84:85], v[84:85], v[108:109]
    v_pk_add_f32 v[86:87], v[86:87], v[110:111]
    v_cvt_pk_bf16_f32 v132, v80, v81
    v_cvt_pk_bf16_f32 v133, v82, v83
    v_cvt_pk_bf16_f32 v134, v84, v85
    v_cvt_pk_bf16_f32 v135, v86, v87
    s_waitcnt lgkmcnt(3)
    v_pk_add_f32 v[128:129], v[128:129], v[112:113]
    s_waitcnt lgkmcnt(2)
    v_pk_add_f32 v[128:129], v[128:129], v[114:115]
    s_waitcnt lgkmcnt(1)
    v_pk_add_f32 v[128:129], v[128:129], v[116:117]
    s_waitcnt lgkmcnt(0)
    v_pk_add_f32 v[128:129], v[128:129], v[118:119]
    v_cvt_pk_bf16_f32 v130, v128, v129
    buffer_store_dwordx4 v[132:135], v59, s[16:19], s25 offen sc1
    buffer_store_dword v130, v61, s[16:19], s26 offen sc1
    v_dot2c_f32_bf16 v136, v132, v215
    v_dot2c_f32_bf16 v137, v132, v132
    v_dot2c_f32_bf16 v136, v133, v215
    v_dot2c_f32_bf16 v137, v133, v133
    v_dot2c_f32_bf16 v138, v134, v215
    v_dot2c_f32_bf16 v139, v134, v134
    v_dot2c_f32_bf16 v138, v135, v215
    v_dot2c_f32_bf16 v139, v135, v135
    v_dot2c_f32_bf16 v140, v130, v215
    v_dot2c_f32_bf16 v141, v130, v130
    v_permlane32_swap_b32 v136, v138
    v_permlane32_swap_b32 v137, v139
    v_pk_add_f32 v[136:137], v[136:137], v[138:139]
    v_pk_add_f32 v[136:137], v[136:137], v[140:141]
    s_nop 1
    v_permlane16_swap_b32 v136, v137
    v_add_f32 v136, v136, v137
    ds_write_b32 v206, v136 offset:32768
    s_lshl_b32 s96, s75, 14
    s_add_u32 s96, s96, 6815744
    s_lshl_b32 s97, s24, 12
    s_nop 0
    s_add_u32 s97, s97, 3473408
    buffer_load_dwordx4 v[176:179], v62, s[16:19], s96 offen offset:0 sc1
    buffer_load_dwordx4 v[180:183], v62, s[16:19], s96 offen offset:1024 sc1
    buffer_load_dwordx4 v[184:187], v62, s[16:19], s97 offen offset:0 sc1
    buffer_load_dwordx4 v[188:191], v62, s[16:19], s97 offen offset:1024 sc1
    buffer_load_dwordx4 v[192:195], v62, s[16:19], s97 offen offset:2048 sc1
    buffer_load_dwordx4 v[196:199], v62, s[16:19], s97 offen offset:3072 sc1
    s_waitcnt lgkmcnt(0)
    s_barrier
    ds_read2st64_b32 v[136:137], v207 offset0:0 offset1:1
    ds_read2st64_b32 v[138:139], v207 offset0:2 offset1:3
    s_waitcnt lgkmcnt(0)
    v_pk_add_f32 v[136:137], v[136:137], v[138:139]
    v_add_f32 v136, v136, v137
    v_cndmask_b32 v136, v136, 1.0, s[28:29]
    s_mov_b64 exec, s[80:81]
    buffer_atomic_add_f32 v136, v214, s[16:19], s27 offen
    s_mov_b64 exec, -1
    s_cmp_ge_u32 s2, 160
    s_cbranch_scc1 nc_26
    s_waitcnt vmcnt(1)
ce_28:
    v_max3_u32 v208, v176, v177, v178
    v_max3_u32 v208, v208, v179, v180
    v_max3_u32 v208, v208, v181, v182
    v_max_u32_e64 v208, v208, v183
    v_cmp_eq_u32 s[82:83], -1, v208
    v_min3_f32 v209, v184, v187, v188
    v_min3_f32 v209, v209, v191, v192
    v_min3_f32 v209, v209, v195, v196
    v_min_f32 v209, v209, v199
    v_cmp_neq_f32 vcc, 0x41000000, v209
    s_nop 0
    s_or_b64 vcc, vcc, s[82:83]
    s_cbranch_vccnz rd_29
rc_30:
    v_mul_f32 v208, 0x3acccccd, v185
    v_mul_f32 v209, 0x3acccccd, v189
    v_mul_f32 v186, 0x3acccccd, v186
    v_mul_f32 v190, 0x3acccccd, v190
    v_fma_f32 v186, -v208, v208, v186
    v_fma_f32 v190, -v209, v209, v190
    v_max_f32 v186, 0, v186
    v_max_f32 v190, 0, v190
    v_add_f32 v186, 0x3727c5ac, v186
    v_add_f32 v190, 0x3727c5ac, v190
    v_rsq_f32 v185, v186
    v_rsq_f32 v189, v190
    v_mul_f32 v186, -v208, v185
    v_mul_f32 v190, -v209, v189
    v_lshlrev_b32 v80, 16, v176
    v_and_b32 v82, 0xffff0000, v176
    v_lshlrev_b32 v84, 16, v177
    v_and_b32 v86, 0xffff0000, v177
    v_lshlrev_b32 v81, 16, v178
    v_and_b32 v83, 0xffff0000, v178
    v_lshlrev_b32 v85, 16, v179
    v_and_b32 v87, 0xffff0000, v179
    v_fma_f32 v208, v80, v185, v186
    v_fma_f32 v209, v81, v189, v190
    v_cvt_pk_bf16_f32 v176, v208, v209
    v_fma_f32 v208, v82, v185, v186
    v_fma_f32 v209, v83, v189, v190
    v_cvt_pk_bf16_f32 v177, v208, v209
    v_fma_f32 v208, v84, v185, v186
    v_fma_f32 v209, v85, v189, v190
    v_cvt_pk_bf16_f32 v178, v208, v209
    v_fma_f32 v208, v86, v185, v186
    v_fma_f32 v209, v87, v189, v190
    v_cvt_pk_bf16_f32 v179, v208, v209
    ds_write_b32 v63, v176 offset:0
    ds_write_b32 v63, v177 offset:4864
    ds_write_b32 v63, v178 offset:9728
    ds_write_b32 v63, v179 offset:14592
    v_mul_f32 v208, 0x3acccccd, v193
    v_mul_f32 v209, 0x3acccccd, v197
    v_mul_f32 v194, 0x3acccccd, v194
    v_mul_f32 v198, 0x3acccccd, v198
    v_fma_f32 v194, -v208, v208, v194
    v_fma_f32 v198, -v209, v209, v198
    v_max_f32 v194, 0, v194
    v_max_f32 v198, 0, v198
    v_add_f32 v194, 0x3727c5ac, v194
    v_add_f32 v198, 0x3727c5ac, v198
    v_rsq_f32 v193, v194
    v_rsq_f32 v197, v198
    v_mul_f32 v194, -v208, v193
    v_mul_f32 v198, -v209, v197
    v_lshlrev_b32 v88, 16, v180
    v_and_b32 v90, 0xffff0000, v180
    v_lshlrev_b32 v92, 16, v181
    v_and_b32 v94, 0xffff0000, v181
    v_lshlrev_b32 v89, 16, v182
    v_and_b32 v91, 0xffff0000, v182
    v_lshlrev_b32 v93, 16, v183
    v_and_b32 v95, 0xffff0000, v183
    v_fma_f32 v208, v88, v193, v194
    v_fma_f32 v209, v89, v197, v198
    v_cvt_pk_bf16_f32 v180, v208, v209
    v_fma_f32 v208, v90, v193, v194
    v_fma_f32 v209, v91, v197, v198
    v_cvt_pk_bf16_f32 v181, v208, v209
    v_fma_f32 v208, v92, v193, v194
    v_fma_f32 v209, v93, v197, v198
    v_cvt_pk_bf16_f32 v182, v208, v209
    v_fma_f32 v208, v94, v193, v194
    v_fma_f32 v209, v95, v197, v198
    v_cvt_pk_bf16_f32 v183, v208, v209
    ds_write_b32 v63, v180 offset:256
    ds_write_b32 v63, v181 offset:5120
    ds_write_b32 v63, v182 offset:9984
    ds_write_b32 v63, v183 offset:14848
    s_waitcnt lgkmcnt(0)
    s_barrier
    ds_read_b128 v[212:215], v64 offset:96
    ds_read_b128 v[216:219], v64 offset:64
    ds_read_b128 v[220:223], v64 offset:32
    ds_read_b128 v[224:227], v64 offset:0
    s_waitcnt lgkmcnt(3)
    v_mfma_f32_32x32x16_bf16 v[96:111], v[212:215], v[144:147], 0
    ds_read_b128 v[228:231], v64 offset:224
    ds_read_b64_tr_b16 v[176:177], v65 offset:1056
    ds_read_b64_tr_b16 v[178:179], v65 offset:1024
    ds_read_b64_tr_b16 v[180:181], v65 offset:1184
    ds_read_b64_tr_b16 v[182:183], v65 offset:1152
    s_waitcnt lgkmcnt(7)
    v_mfma_f32_32x32x16_bf16 v[96:111], v[216:219], v[148:151], v[96:111]
    ds_read_b128 v[232:235], v64 offset:192
    ds_read_b64_tr_b16 v[184:185], v65 offset:1312
    ds_read_b64_tr_b16 v[186:187], v65 offset:1280
    ds_read_b64_tr_b16 v[188:189], v65 offset:1440
    ds_read_b64_tr_b16 v[190:191], v65 offset:1408
    s_waitcnt lgkmcnt(11)
    v_mfma_f32_32x32x16_bf16 v[96:111], v[220:223], v[152:155], v[96:111]
    ds_read_b128 v[236:239], v64 offset:160
    ds_read_b64_tr_b16 v[192:193], v65 offset:1568
    ds_read_b64_tr_b16 v[194:195], v65 offset:1536
    ds_read_b64_tr_b16 v[196:197], v65 offset:1696
    ds_read_b64_tr_b16 v[198:199], v65 offset:1664
    s_waitcnt lgkmcnt(15)
    v_mfma_f32_32x32x16_bf16 v[96:111], v[224:227], v[156:159], v[96:111]
    ds_read_b128 v[240:243], v64 offset:128
    ds_read_b64_tr_b16 v[200:201], v65 offset:1824
    ds_read_b64_tr_b16 v[202:203], v65 offset:1792
    ds_read_b64_tr_b16 v[204:205], v65 offset:1952
    ds_read_b64_tr_b16 v[206:207], v65 offset:1920
    s_waitcnt lgkmcnt(15)
    v_mfma_f32_32x32x16_bf16 v[112:127], v[228:231], v[144:147], 0
    v_mov_b32 v248, -1
    v_mov_b32 v249, -1
    v_mov_b32 v250, -1
    v_mov_b32 v251, -1
    s_lshl_b32 s88, s75, 14
    s_add_u32 s88, s88, 9437184
    buffer_store_dwordx4 v[248:251], v62, s[16:19], s88 offen offset:0 sc1
    s_waitcnt lgkmcnt(14)
    v_mfma_f32_32x32x16_bf16 v[112:127], v[232:235], v[148:151], v[112:127]
    v_cndmask_b32 v208, v99, v72, s[76:77]
    v_cndmask_b32 v209, v103, v99, s[76:77]
    v_cndmask_b32 v210, v107, v103, s[76:77]
    v_cndmask_b32 v211, v111, v107, s[76:77]
    v_mov_b32_e64 v72, v111
    s_waitcnt lgkmcnt(9)
    v_mfma_f32_32x32x16_bf16 v[112:127], v[236:239], v[152:155], v[112:127]
    v_add_f32_dpp v98, v208, v98 wave_ror:1 row_mask:0xf bank_mask:0xf
    v_add_f32_dpp v102, v209, v102 wave_ror:1 row_mask:0xf bank_mask:0xf
    v_add_f32_dpp v106, v210, v106 wave_ror:1 row_mask:0xf bank_mask:0xf
    v_add_f32_dpp v110, v211, v110 wave_ror:1 row_mask:0xf bank_mask:0xf
    v_cndmask_b32 v208, v98, v71, s[76:77]
    s_waitcnt lgkmcnt(4)
    v_mfma_f32_32x32x16_bf16 v[112:127], v[240:243], v[156:159], v[112:127]
    v_cndmask_b32 v209, v102, v98, s[76:77]
    v_cndmask_b32 v210, v106, v102, s[76:77]
    v_cndmask_b32 v211, v110, v106, s[76:77]
    v_mov_b32 v71, v110
    v_add_f32_dpp v97, v208, v97 wave_ror:1 row_mask:0xf bank_mask:0xf
    v_add_f32_dpp v101, v209, v101 wave_ror:1 row_mask:0xf bank_mask:0xf
    v_mfma_f32_32x32x16_bf16 v[112:127], v[212:215], v[160:163], v[112:127]
    ds_read_b128 v[244:247], v64 offset:352
    v_add_f32_dpp v105, v210, v105 wave_ror:1 row_mask:0xf bank_mask:0xf
    v_add_f32_dpp v109, v211, v109 wave_ror:1 row_mask:0xf bank_mask:0xf
    v_cndmask_b32 v208, v97, v70, s[76:77]
    v_cndmask_b32 v209, v101, v97, s[76:77]
    v_cndmask_b32 v210, v105, v101, s[76:77]
    v_mfma_f32_32x32x16_bf16 v[112:127], v[216:219], v[164:167], v[112:127]
    ds_read_b128 v[216:219], v64 offset:320
    v_cndmask_b32 v211, v109, v105, s[76:77]
    v_mov_b32_e64 v70, v109
    v_add_f32_dpp v96, v208, v96 wave_ror:1 row_mask:0xf bank_mask:0xf
    v_add_f32_dpp v100, v209, v100 wave_ror:1 row_mask:0xf bank_mask:0xf
    v_add_f32_dpp v104, v210, v104 wave_ror:1 row_mask:0xf bank_mask:0xf
    v_mfma_f32_32x32x16_bf16 v[112:127], v[220:223], v[168:171], v[112:127]
    ds_read_b128 v[220:223], v64 offset:288
    buffer_store_dwordx4 v[248:251], v62, s[16:19], s88 offen offset:1024 sc1
    v_add_f32_dpp v108, v211, v108 wave_ror:1 row_mask:0xf bank_mask:0xf
    v_mfma_f32_32x32x16_bf16 v[112:127], v[224:227], v[172:175], v[112:127]
    ds_read_b128 v[224:227], v64 offset:256
    ds_write_b32 v66, v96 offset:0
    ds_write_b32 v66, v100 offset:64
    s_waitcnt lgkmcnt(5)
    v_mfma_f32_32x32x16_bf16 v[128:143], v[244:247], v[144:147], 0
    ds_write_b32 v66, v104 offset:128
    ds_write_b32 v66, v108 offset:192
    s_nop 0
    s_waitcnt lgkmcnt(6)
    v_mfma_f32_32x32x16_bf16 v[128:143], v[216:219], v[148:151], v[128:143]
    s_nop 3
    v_cndmask_b32 v208, v115, v72, s[76:77]
    s_waitcnt lgkmcnt(5)
    v_mfma_f32_32x32x16_bf16 v[128:143], v[220:223], v[152:155], v[128:143]
    v_cndmask_b32 v209, v119, v115, s[76:77]
    v_cndmask_b32 v210, v123, v119, s[76:77]
    v_cndmask_b32 v211, v127, v123, s[76:77]
    v_mov_b32 v72, v127
    v_add_f32_dpp v114, v208, v114 wave_ror:1 row_mask:0xf bank_mask:0xf
    s_waitcnt lgkmcnt(4)
    v_mfma_f32_32x32x16_bf16 v[128:143], v[224:227], v[156:159], v[128:143]
    v_add_f32_dpp v118, v209, v118 wave_ror:1 row_mask:0xf bank_mask:0xf
    v_add_f32_dpp v122, v210, v122 wave_ror:1 row_mask:0xf bank_mask:0xf
    v_add_f32_dpp v126, v211, v126 wave_ror:1 row_mask:0xf bank_mask:0xf
    v_cndmask_b32 v208, v114, v71, s[76:77]
    v_cndmask_b32 v209, v118, v114, s[76:77]
    v_cndmask_b32 v210, v122, v118, s[76:77]
    v_mfma_f32_32x32x16_bf16 v[128:143], v[228:231], v[160:163], v[128:143]
    buffer_store_dwordx4 v[248:251], v62, s[16:19], s88 offen offset:2048 sc1
    v_cndmask_b32 v211, v126, v122, s[76:77]
    v_mov_b32 v71, v126
    v_add_f32_dpp v113, v208, v113 wave_ror:1 row_mask:0xf bank_mask:0xf
    v_add_f32_dpp v117, v209, v117 wave_ror:1 row_mask:0xf bank_mask:0xf
    v_add_f32_dpp v121, v210, v121 wave_ror:1 row_mask:0xf bank_mask:0xf
    v_mfma_f32_32x32x16_bf16 v[128:143], v[232:235], v[164:167], v[128:143]
    ds_read_b128 v[232:235], v64 offset:64
    v_add_f32_dpp v125, v211, v125 wave_ror:1 row_mask:0xf bank_mask:0xf
    v_cndmask_b32 v208, v113, v70, s[76:77]
    v_cndmask_b32 v209, v117, v113, s[76:77]
    v_cndmask_b32 v210, v121, v117, s[76:77]
    v_cndmask_b32 v211, v125, v121, s[76:77]
    v_mfma_f32_32x32x16_bf16 v[128:143], v[236:239], v[168:171], v[128:143]
    ds_read_b128 v[236:239], v64 offset:32
    v_mov_b32_e64 v70, v125
    v_add_f32_dpp v112, v208, v112 wave_ror:1 row_mask:0xf bank_mask:0xf
    v_add_f32_dpp v116, v209, v116 wave_ror:1 row_mask:0xf bank_mask:0xf
    v_add_f32_dpp v120, v210, v120 wave_ror:1 row_mask:0xf bank_mask:0xf
    v_add_f32_dpp v124, v211, v124 wave_ror:1 row_mask:0xf bank_mask:0xf
    v_mfma_f32_32x32x16_bf16 v[128:143], v[240:243], v[172:175], v[128:143]
    ds_read_b128 v[240:243], v64 offset:0
    ds_write_b32 v66, v112 offset:256
    ds_write_b32 v66, v116 offset:320
    v_mfma_f32_32x32x16_bf16 v[128:143], v[212:215], v[176:179], v[128:143]
    ds_read_b128 v[212:215], v64 offset:480
    ds_write_b32 v66, v120 offset:384
    ds_write_b32 v66, v124 offset:448
    s_waitcnt lgkmcnt(7)
    v_mfma_f32_32x32x16_bf16 v[128:143], v[232:235], v[180:183], v[128:143]
    ds_read_b128 v[232:235], v64 offset:448
    s_waitcnt lgkmcnt(7)
    v_mfma_f32_32x32x16_bf16 v[128:143], v[236:239], v[184:187], v[128:143]
    ds_read_b128 v[236:239], v64 offset:416
    buffer_store_dwordx4 v[248:251], v62, s[16:19], s88 offen offset:3072 sc1
    s_waitcnt lgkmcnt(7)
    v_mfma_f32_32x32x16_bf16 v[128:143], v[240:243], v[188:191], v[128:143]
    ds_read_b128 v[240:243], v64 offset:384
    s_nop 3
    s_waitcnt lgkmcnt(5)
    v_mfma_f32_32x32x16_bf16 v[112:127], v[212:215], v[144:147], 0
    s_nop 4
    s_waitcnt lgkmcnt(2)
    v_mfma_f32_32x32x16_bf16 v[112:127], v[232:235], v[148:151], v[112:127]
    v_cndmask_b32 v208, v131, v72, s[76:77]
    v_cndmask_b32 v209, v135, v131, s[76:77]
    v_cndmask_b32 v210, v139, v135, s[76:77]
    v_cndmask_b32 v211, v143, v139, s[76:77]
    v_mov_b32_e64 v72, v143
    s_waitcnt lgkmcnt(1)
    v_mfma_f32_32x32x16_bf16 v[112:127], v[236:239], v[152:155], v[112:127]
    v_add_f32_dpp v130, v208, v130 wave_ror:1 row_mask:0xf bank_mask:0xf
    v_add_f32_dpp v134, v209, v134 wave_ror:1 row_mask:0xf bank_mask:0xf
    v_add_f32_dpp v138, v210, v138 wave_ror:1 row_mask:0xf bank_mask:0xf
    v_add_f32_dpp v142, v211, v142 wave_ror:1 row_mask:0xf bank_mask:0xf
    v_cndmask_b32 v208, v130, v71, s[76:77]
    s_waitcnt lgkmcnt(0)
    v_mfma_f32_32x32x16_bf16 v[112:127], v[240:243], v[156:159], v[112:127]
    v_cndmask_b32 v209, v134, v130, s[76:77]
    v_cndmask_b32 v210, v138, v134, s[76:77]
    v_cndmask_b32 v211, v142, v138, s[76:77]
    v_mov_b32 v71, v142
    v_add_f32_dpp v129, v208, v129 wave_ror:1 row_mask:0xf bank_mask:0xf
    v_add_f32_dpp v133, v209, v133 wave_ror:1 row_mask:0xf bank_mask:0xf
    v_mfma_f32_32x32x16_bf16 v[112:127], v[244:247], v[160:163], v[112:127]
    v_add_f32_dpp v137, v210, v137 wave_ror:1 row_mask:0xf bank_mask:0xf
    v_add_f32_dpp v141, v211, v141 wave_ror:1 row_mask:0xf bank_mask:0xf
    v_cndmask_b32 v208, v129, v70, s[76:77]
    v_cndmask_b32 v209, v133, v129, s[76:77]
    v_cndmask_b32 v210, v137, v133, s[76:77]
    v_cndmask_b32 v211, v141, v137, s[76:77]
    v_mfma_f32_32x32x16_bf16 v[112:127], v[216:219], v[164:167], v[112:127]
    ds_read_b128 v[240:243], v64 offset:192
    v_mov_b32_e64 v70, v141
    v_add_f32_dpp v128, v208, v128 wave_ror:1 row_mask:0xf bank_mask:0xf
    v_add_f32_dpp v132, v209, v132 wave_ror:1 row_mask:0xf bank_mask:0xf
    v_add_f32_dpp v136, v210, v136 wave_ror:1 row_mask:0xf bank_mask:0xf
    v_add_f32_dpp v140, v211, v140 wave_ror:1 row_mask:0xf bank_mask:0xf
    v_mfma_f32_32x32x16_bf16 v[112:127], v[220:223], v[168:171], v[112:127]
    ds_read_b128 v[220:223], v64 offset:160
    ds_write_b32 v66, v128 offset:512
    ds_write_b32 v66, v132 offset:576
    v_mfma_f32_32x32x16_bf16 v[112:127], v[224:227], v[172:175], v[112:127]
    ds_read_b128 v[224:227], v64 offset:128
    ds_write_b32 v66, v136 offset:640
    ds_write_b32 v66, v140 offset:704
    v_mfma_f32_32x32x16_bf16 v[112:127], v[228:231], v[176:179], v[112:127]
    ds_read_b128 v[236:239], v64 offset:96
    s_waitcnt lgkmcnt(7)
    v_mfma_f32_32x32x16_bf16 v[112:127], v[240:243], v[180:183], v[112:127]
    ds_read_b128 v[240:243], v64 offset:64
    s_waitcnt lgkmcnt(7)
    v_mfma_f32_32x32x16_bf16 v[112:127], v[220:223], v[184:187], v[112:127]
    ds_read_b128 v[220:223], v64 offset:32
    s_waitcnt lgkmcnt(5)
    v_mfma_f32_32x32x16_bf16 v[112:127], v[224:227], v[188:191], v[112:127]
    ds_read_b128 v[224:227], v64 offset:0
    s_waitcnt lgkmcnt(3)
    v_mfma_f32_32x32x16_bf16 v[112:127], v[236:239], v[192:195], v[112:127]
    ds_read_b64_tr_b16 v[216:217], v65 offset:544
    ds_read_b64_tr_b16 v[218:219], v65 offset:512
    s_waitcnt lgkmcnt(4)
    v_mfma_f32_32x32x16_bf16 v[112:127], v[240:243], v[196:199], v[112:127]
    ds_read_b64_tr_b16 v[240:241], v65 offset:1056
    ds_read_b64_tr_b16 v[242:243], v65 offset:1024
    s_waitcnt lgkmcnt(5)
    v_mfma_f32_32x32x16_bf16 v[112:127], v[220:223], v[200:203], v[112:127]
    s_waitcnt lgkmcnt(4)
    v_mfma_f32_32x32x16_bf16 v[112:127], v[224:227], v[204:207], v[112:127]
    ds_read_b64_tr_b16 v[224:225], v65 offset:1568
    ds_read_b64_tr_b16 v[226:227], v65 offset:1536
    s_lshl_b32 s96, s75, 14
    s_add_u32 s96, s96, 6815744
    s_lshl_b32 s97, s24, 12
    s_add_u32 s97, s97, 3477504
    buffer_load_dwordx4 v[248:251], v62, s[16:19], s96 offen offset:2048 sc1
    s_waitcnt lgkmcnt(4)
    v_mfma_f32_32x32x16_bf16 v[144:159], v[212:215], v[216:219], 0
    s_nop 3
    v_cndmask_b32 v208, v115, v72, s[76:77]
    s_waitcnt lgkmcnt(2)
    v_mfma_f32_32x32x16_bf16 v[144:159], v[244:247], v[240:243], v[144:159]
    buffer_load_dwordx4 v[252:255], v62, s[16:19], s96 offen offset:3072 sc1
    v_cndmask_b32 v209, v119, v115, s[76:77]
    v_cndmask_b32 v210, v123, v119, s[76:77]
    v_cndmask_b32 v211, v127, v123, s[76:77]
    v_mov_b32_e64 v72, v127
    v_add_f32_dpp v114, v208, v114 wave_ror:1 row_mask:0xf bank_mask:0xf
    v_mfma_f32_32x32x16_bf16 v[160:175], v[212:215], v[240:243], 0
    ds_read_b64_tr_b16 v[216:217], v65 offset:2080
    ds_read_b64_tr_b16 v[218:219], v65 offset:2048
    v_add_f32_dpp v118, v209, v118 wave_ror:1 row_mask:0xf bank_mask:0xf
    v_add_f32_dpp v122, v210, v122 wave_ror:1 row_mask:0xf bank_mask:0xf
    v_add_f32_dpp v126, v211, v126 wave_ror:1 row_mask:0xf bank_mask:0xf
    s_waitcnt lgkmcnt(2)
    v_mfma_f32_32x32x16_bf16 v[144:159], v[228:231], v[224:227], v[144:159]
    buffer_load_dwordx4 v[96:99], v62, s[16:19], s97 offen offset:0 sc1
    v_cndmask_b32 v208, v114, v71, s[76:77]
    v_cndmask_b32 v209, v118, v114, s[76:77]
    v_cndmask_b32 v210, v122, v118, s[76:77]
    v_cndmask_b32 v211, v126, v122, s[76:77]
    v_mov_b32 v71, v126
    v_mfma_f32_32x32x16_bf16 v[160:175], v[244:247], v[224:227], v[160:175]
    v_add_f32_dpp v113, v208, v113 wave_ror:1 row_mask:0xf bank_mask:0xf
    v_add_f32_dpp v117, v209, v117 wave_ror:1 row_mask:0xf bank_mask:0xf
    v_add_f32_dpp v121, v210, v121 wave_ror:1 row_mask:0xf bank_mask:0xf
    v_add_f32_dpp v125, v211, v125 wave_ror:1 row_mask:0xf bank_mask:0xf
    v_cndmask_b32 v208, v113, v70, s[76:77]
    v_cndmask_b32 v209, v117, v113, s[76:77]
    v_mfma_f32_32x32x16_bf16 v[176:191], v[212:215], v[224:227], 0
    buffer_load_dwordx4 v[100:103], v62, s[16:19], s97 offen offset:1024 sc1
    v_cndmask_b32 v210, v121, v117, s[76:77]
    v_cndmask_b32 v211, v125, v121, s[76:77]
    v_mov_b32 v70, v125
    v_add_f32_dpp v112, v208, v112 wave_ror:1 row_mask:0xf bank_mask:0xf
    s_waitcnt lgkmcnt(0)
    v_mfma_f32_32x32x16_bf16 v[144:159], v[236:239], v[216:219], v[144:159]
    ds_read_b64_tr_b16 v[240:241], v65 offset:2592
    ds_read_b64_tr_b16 v[242:243], v65 offset:2560
    v_add_f32_dpp v116, v209, v116 wave_ror:1 row_mask:0xf bank_mask:0xf
    v_add_f32_dpp v120, v210, v120 wave_ror:1 row_mask:0xf bank_mask:0xf
    v_add_f32_dpp v124, v211, v124 wave_ror:1 row_mask:0xf bank_mask:0xf
    v_mfma_f32_32x32x16_bf16 v[160:175], v[228:231], v[216:219], v[160:175]
    buffer_load_dwordx4 v[104:107], v62, s[16:19], s97 offen offset:2048 sc1
    ds_write_b32 v66, v112 offset:768
    ds_write_b32 v66, v116 offset:832
    v_mfma_f32_32x32x16_bf16 v[176:191], v[244:247], v[216:219], v[176:191]
    ds_write_b32 v66, v120 offset:896
    ds_write_b32 v66, v124 offset:960
    v_mfma_f32_32x32x16_bf16 v[192:207], v[212:215], v[216:219], 0
    ds_read_b64_tr_b16 v[212:213], v65 offset:3104
    ds_read_b64_tr_b16 v[214:215], v65 offset:3072
    buffer_load_dwordx4 v[108:111], v62, s[16:19], s97 offen offset:3072 sc1
    s_waitcnt lgkmcnt(6)
    v_mfma_f32_32x32x16_bf16 v[160:175], v[236:239], v[240:243], v[160:175]
    v_mfma_f32_32x32x16_bf16 v[176:191], v[228:231], v[240:243], v[176:191]
    ds_read_b64_tr_b16 v[224:225], v65 offset:3616
    ds_read_b64_tr_b16 v[226:227], v65 offset:3584
    s_waitcnt vmcnt(6) lgkmcnt(4)
    s_barrier
    v_mfma_f32_32x32x16_bf16 v[192:207], v[244:247], v[240:243], v[192:207]
    ds_read_b64_tr_b16 v[244:245], v65 offset:672
    ds_read_b64_tr_b16 v[246:247], v65 offset:640
    ds_read_b64 v[112:113], v67 offset:0
    ds_read_b64 v[114:115], v67 offset:4224
    ds_read_b64 v[116:117], v67 offset:8448
    s_waitcnt lgkmcnt(7)
    v_mfma_f32_32x32x16_bf16 v[176:191], v[236:239], v[212:215], v[176:191]
    ds_read_b128 v[216:219], v64 offset:320
    ds_read_b64_tr_b16 v[240:241], v65 offset:1184
    ds_read_b64_tr_b16 v[242:243], v65 offset:1152
    ds_read_b64 v[118:119], v67 offset:12672
    ds_read_b64 v[120:121], v67 offset:512
    ds_read_b64 v[122:123], v67 offset:4736
    v_mfma_f32_32x32x16_bf16 v[192:207], v[228:231], v[212:215], v[192:207]
    ds_read_b64 v[124:125], v67 offset:8960
    ds_read_b64 v[126:127], v67 offset:13184
    s_lshl_b32 s25, s75, 14
    s_add_u32 s25, s25, 9437184
    s_waitcnt lgkmcnt(13)
    v_mfma_f32_32x32x16_bf16 v[192:207], v[236:239], v[224:227], v[192:207]
    ds_read_b128 v[228:231], v64 offset:192
    ds_read_b64_tr_b16 v[236:237], v65 offset:1696
    ds_read_b64_tr_b16 v[238:239], v65 offset:1664
    s_waitcnt lgkmcnt(14)
    v_mfma_f32_32x32x16_bf16 v[144:159], v[232:235], v[244:247], v[144:159]
    v_mov_b32 v5, 1
    s_add_u32 s82, s86, 24576
    buffer_atomic_add v5, v6, s[16:19], s82 offen offset:0 sc0 sc1
    s_waitcnt lgkmcnt(8)
    v_mfma_f32_32x32x16_bf16 v[144:159], v[216:219], v[240:243], v[144:159]
    v_mfma_f32_32x32x16_bf16 v[160:175], v[232:235], v[240:243], v[160:175]
    ds_read_b128 v[212:215], v64 offset:64
    ds_read_b64_tr_b16 v[224:225], v65 offset:2208
    ds_read_b64_tr_b16 v[226:227], v65 offset:2176
    s_waitcnt lgkmcnt(3)
    v_mfma_f32_32x32x16_bf16 v[144:159], v[228:231], v[236:239], v[144:159]
    v_mfma_f32_32x32x16_bf16 v[160:175], v[216:219], v[236:239], v[160:175]
    v_add_f32 v112, v112, v80
    v_add_f32 v113, v113, v81
    v_add_f32 v114, v114, v82
    v_add_f32 v115, v115, v83
    v_add_f32 v116, v116, v84
    v_mfma_f32_32x32x16_bf16 v[176:191], v[232:235], v[236:239], v[176:191]
    v_add_f32 v117, v117, v85
    v_add_f32 v118, v118, v86
    v_add_f32 v119, v119, v87
    v_cvt_pk_bf16_f32 v128, v112, v114
    v_cvt_pk_bf16_f32 v129, v116, v118
    s_waitcnt lgkmcnt(0)
    v_mfma_f32_32x32x16_bf16 v[144:159], v[212:215], v[224:227], v[144:159]
    ds_read_b64_tr_b16 v[244:245], v65 offset:2720
    ds_read_b64_tr_b16 v[246:247], v65 offset:2688
    v_cvt_pk_bf16_f32 v130, v113, v115
    v_cvt_pk_bf16_f32 v131, v117, v119
    v_mfma_f32_32x32x16_bf16 v[160:175], v[228:231], v[224:227], v[160:175]
    buffer_store_dwordx4 v[128:131], v62, s[16:19], s25 offen offset:0 sc1
    v_add_f32 v120, v120, v88
    v_add_f32 v121, v121, v89
    v_add_f32 v122, v122, v90
    v_add_f32 v123, v123, v91
    v_add_f32 v124, v124, v92
    v_mfma_f32_32x32x16_bf16 v[176:191], v[216:219], v[224:227], v[176:191]
    v_add_f32 v125, v125, v93
    v_add_f32 v126, v126, v94
    v_add_f32_e64 v127, v127, v95
    v_cvt_pk_bf16_f32 v132, v120, v122
    v_cvt_pk_bf16_f32 v133, v124, v126
    v_cvt_pk_bf16_f32 v134, v121, v123
    v_mfma_f32_32x32x16_bf16 v[192:207], v[232:235], v[224:227], v[192:207]
    ds_read_b64_tr_b16 v[232:233], v65 offset:3232
    ds_read_b64_tr_b16 v[234:235], v65 offset:3200
    v_cvt_pk_bf16_f32 v135, v125, v127
    s_waitcnt lgkmcnt(2)
    v_mfma_f32_32x32x16_bf16 v[160:175], v[212:215], v[244:247], v[160:175]
    buffer_store_dwordx4 v[132:135], v62, s[16:19], s25 offen offset:1024 sc1
    ds_read_b64_tr_b16 v[112:113], v65 offset:32
    ds_read_b64_tr_b16 v[114:115], v65 offset:0
    ds_read_b64_tr_b16 v[116:117], v65 offset:160
    ds_read_b64_tr_b16 v[118:119], v65 offset:128
    ds_read_b64_tr_b16 v[120:121], v65 offset:288
    v_mfma_f32_32x32x16_bf16 v[176:191], v[228:231], v[244:247], v[176:191]
    ds_read_b64_tr_b16 v[240:241], v65 offset:3744
    ds_read_b64_tr_b16 v[242:243], v65 offset:3712
    ds_read_b64_tr_b16 v[122:123], v65 offset:256
    ds_read_b64_tr_b16 v[124:125], v65 offset:416
    ds_read_b64_tr_b16 v[126:127], v65 offset:384
    ds_read_b64_tr_b16 v[128:129], v65 offset:544
    v_mfma_f32_32x32x16_bf16 v[192:207], v[216:219], v[244:247], v[192:207]
    ds_read_b128 v[216:219], v64 offset:416
    ds_read_b64_tr_b16 v[236:237], v65 offset:800
    ds_read_b64_tr_b16 v[238:239], v65 offset:768
    ds_read_b64_tr_b16 v[130:131], v65 offset:512
    ds_read_b64_tr_b16 v[132:133], v65 offset:672
    s_waitcnt lgkmcnt(15)
    v_mfma_f32_32x32x16_bf16 v[176:191], v[212:215], v[232:235], v[176:191]
    ds_read_b128 v[224:227], v64 offset:288
    ds_read_b64_tr_b16 v[244:245], v65 offset:1312
    ds_read_b64_tr_b16 v[246:247], v65 offset:1280
    ds_read_b64_tr_b16 v[134:135], v65 offset:640
    ds_read_b64_tr_b16 v[136:137], v65 offset:800
    ds_read_b64_tr_b16 v[138:139], v65 offset:768
    v_mfma_f32_32x32x16_bf16 v[192:207], v[228:231], v[232:235], v[192:207]
    ds_read_b64_tr_b16 v[140:141], v65 offset:928
    ds_read_b64_tr_b16 v[142:143], v65 offset:896
    s_waitcnt lgkmcnt(15)
    v_mfma_f32_32x32x16_bf16 v[192:207], v[212:215], v[240:243], v[192:207]
    ds_read_b128 v[228:231], v64 offset:160
    ds_read_b64_tr_b16 v[212:213], v65 offset:1824
    ds_read_b64_tr_b16 v[214:215], v65 offset:1792
    s_waitcnt vmcnt(3)
ce_31:
    v_max3_u32 v208, v248, v249, v250
    v_max3_u32 v208, v208, v251, v252
    v_max3_u32 v208, v208, v253, v254
    v_max_u32_e64 v208, v208, v255
    v_cmp_eq_u32 s[82:83], -1, v208
    v_min3_f32 v209, v96, v99, v100
    v_min3_f32 v209, v209, v103, v104
    v_min3_f32 v209, v209, v107, v108
    v_min_f32 v209, v209, v111
    v_cmp_neq_f32 vcc, 0x41000000, v209
    s_nop 0
    s_or_b64 vcc, vcc, s[82:83]
    s_cbranch_vccnz rd_32
rc_33:
    s_waitcnt lgkmcnt(13)
    v_mfma_f32_32x32x16_bf16 v[144:159], v[216:219], v[236:239], v[144:159]
    v_mul_f32 v208, 0x3acccccd, v97
    v_mul_f32 v209, 0x3acccccd, v101
    v_mul_f32 v98, 0x3acccccd, v98
    v_mul_f32 v102, 0x3acccccd, v102
    v_fma_f32 v98, -v208, v208, v98
    s_waitcnt lgkmcnt(8)
    v_mfma_f32_32x32x16_bf16 v[144:159], v[224:227], v[244:247], v[144:159]
    v_fma_f32 v102, -v209, v209, v102
    v_max_f32 v98, 0, v98
    v_max_f32 v102, 0, v102
    v_add_f32 v98, 0x3727c5ac, v98
    v_add_f32 v102, 0x3727c5ac, v102
    v_mfma_f32_32x32x16_bf16 v[160:175], v[216:219], v[244:247], v[160:175]
    ds_read_b64_tr_b16 v[232:233], v65 offset:2336
    ds_read_b64_tr_b16 v[234:235], v65 offset:2304
    v_rsq_f32 v97, v98
    s_waitcnt lgkmcnt(2)
    v_mfma_f32_32x32x16_bf16 v[144:159], v[228:231], v[212:215], v[144:159]
    v_rsq_f32_e64 v101, v102
    v_mul_f32 v98, -v208, v97
    v_mul_f32 v102, -v209, v101
    v_lshlrev_b32_e64 v80, 16, v248
    v_and_b32 v82, 0xffff0000, v248
    v_mfma_f32_32x32x16_bf16 v[160:175], v[224:227], v[212:215], v[160:175]
    v_lshlrev_b32 v84, 16, v249
    v_and_b32 v86, 0xffff0000, v249
    v_lshlrev_b32 v81, 16, v250
    v_and_b32 v83, 0xffff0000, v250
    v_lshlrev_b32_e64 v85, 16, v251
    v_and_b32 v87, 0xffff0000, v251
    v_mfma_f32_32x32x16_bf16 v[176:191], v[216:219], v[212:215], v[176:191]
    v_fma_f32 v208, v80, v97, v98
    v_fma_f32 v209, v81, v101, v102
    v_cvt_pk_bf16_f32 v248, v208, v209
    v_fma_f32 v208, v82, v97, v98
    v_fma_f32 v209, v83, v101, v102
    s_waitcnt lgkmcnt(0)
    v_mfma_f32_32x32x16_bf16 v[144:159], v[220:223], v[232:235], v[144:159]
    ds_read_b64_tr_b16 v[240:241], v65 offset:2848
    ds_read_b64_tr_b16 v[242:243], v65 offset:2816
    v_cvt_pk_bf16_f32 v249, v208, v209
    v_fma_f32 v208, v84, v97, v98
    v_fma_f32 v209, v85, v101, v102
    v_cvt_pk_bf16_f32 v250, v208, v209
    v_mfma_f32_32x32x16_bf16 v[160:175], v[228:231], v[232:235], v[160:175]
    v_fma_f32 v208, v86, v97, v98
    v_fma_f32 v209, v87, v101, v102
    v_cvt_pk_bf16_f32 v251, v208, v209
    v_mfma_f32_32x32x16_bf16 v[176:191], v[224:227], v[232:235], v[176:191]
    ds_write_b32 v63, v248 offset:512
    ds_write_b32 v63, v249 offset:5376
    ds_write_b32 v63, v250 offset:10240
    v_mfma_f32_32x32x16_bf16 v[192:207], v[216:219], v[232:235], v[192:207]
    ds_read_b64_tr_b16 v[216:217], v65 offset:3360
    ds_read_b64_tr_b16 v[218:219], v65 offset:3328
    ds_write_b32 v63, v251 offset:15104
    v_mul_f32 v208, 0x3acccccd, v105
    s_waitcnt lgkmcnt(6)
    v_mfma_f32_32x32x16_bf16 v[160:175], v[220:223], v[240:243], v[160:175]
    v_mul_f32 v209, 0x3acccccd, v109
    v_mul_f32 v106, 0x3acccccd, v106
    v_mul_f32 v110, 0x3acccccd, v110
    v_fma_f32 v106, -v208, v208, v106
    v_fma_f32 v110, -v209, v209, v110
    v_max_f32_e64 v106, 0, v106
    v_mfma_f32_32x32x16_bf16 v[176:191], v[228:231], v[240:243], v[176:191]
    ds_read_b64_tr_b16 v[236:237], v65 offset:3872
    ds_read_b64_tr_b16 v[238:239], v65 offset:3840
    v_max_f32_e64 v110, 0, v110
    v_add_f32 v106, 0x3727c5ac, v106
    v_add_f32 v110, 0x3727c5ac, v110
    v_mfma_f32_32x32x16_bf16 v[192:207], v[224:227], v[240:243], v[192:207]
    ds_read_b128 v[224:227], v64 offset:384
    ds_read_b64_tr_b16 v[244:245], v65 offset:928
    ds_read_b64_tr_b16 v[246:247], v65 offset:896
    v_rsq_f32 v105, v106
    s_waitcnt lgkmcnt(6)
    v_mfma_f32_32x32x16_bf16 v[176:191], v[220:223], v[216:219], v[176:191]
    ds_read_b128 v[212:215], v64 offset:256
    ds_read_b64_tr_b16 v[232:233], v65 offset:1440
    ds_read_b64_tr_b16 v[234:235], v65 offset:1408
    v_rsq_f32_e64 v109, v110
    v_mul_f32 v106, -v208, v105
    v_mfma_f32_32x32x16_bf16 v[192:207], v[228:231], v[216:219], v[192:207]
    v_mul_f32 v110, -v209, v109
    v_lshlrev_b32 v88, 16, v252
    v_and_b32 v90, 0xffff0000, v252
    v_lshlrev_b32 v92, 16, v253
    v_and_b32 v94, 0xffff0000, v253
    s_waitcnt lgkmcnt(6)
    v_mfma_f32_32x32x16_bf16 v[192:207], v[220:223], v[236:239], v[192:207]
    ds_read_b128 v[220:223], v64 offset:128
    ds_read_b64_tr_b16 v[228:229], v65 offset:1952
    ds_read_b64_tr_b16 v[230:231], v65 offset:1920
    v_lshlrev_b32 v89, 16, v254
    v_and_b32 v91, 0xffff0000, v254
    s_waitcnt lgkmcnt(6)
    v_mfma_f32_32x32x16_bf16 v[144:159], v[224:227], v[244:247], v[144:159]
    v_lshlrev_b32 v93, 16, v255
    v_and_b32 v95, 0xffff0000, v255
    v_fma_f32 v208, v88, v105, v106
    v_fma_f32 v209, v89, v109, v110
    v_cvt_pk_bf16_f32 v252, v208, v209
    s_waitcnt lgkmcnt(3)
    v_mfma_f32_32x32x16_bf16 v[144:159], v[212:215], v[232:235], v[144:159]
    v_fma_f32 v208, v90, v105, v106
    v_fma_f32 v209, v91, v109, v110
    v_cvt_pk_bf16_f32 v253, v208, v209
    v_fma_f32 v208, v92, v105, v106
    v_fma_f32 v209, v93, v109, v110
    v_cvt_pk_bf16_f32 v254, v208, v209
    v_mfma_f32_32x32x16_bf16 v[160:175], v[224:227], v[232:235], v[160:175]
    ds_read_b128 v[240:243], v64 offset:0
    ds_read_b64_tr_b16 v[216:217], v65 offset:2464
    ds_read_b64_tr_b16 v[218:219], v65 offset:2432
    v_fma_f32 v208, v94, v105, v106
    v_fma_f32 v209, v95, v109, v110
    s_waitcnt lgkmcnt(3)
    v_mfma_f32_32x32x16_bf16 v[144:159], v[220:223], v[228:231], v[144:159]
    v_cvt_pk_bf16_f32 v255, v208, v209
    ds_write_b32 v63, v252 offset:768
    v_mfma_f32_32x32x16_bf16 v[160:175], v[212:215], v[228:231], v[160:175]
    ds_write_b32 v63, v253 offset:5632
    ds_write_b32 v63, v254 offset:10496
    ds_write_b32 v63, v255 offset:15360
    v_mfma_f32_32x32x16_bf16 v[176:191], v[224:227], v[228:231], v[176:191]
    s_waitcnt vmcnt(2)
    v_cmp_eq_u32 vcc, 19, v5
    s_nop 0
    s_cbranch_vccnz gl_34
gc_35:
    s_lshl_b32 s25, s72, 5
    s_add_u32 s25, s25, 0
    s_sub_u32 s26, s25, 4
    s_waitcnt lgkmcnt(4)
    v_mfma_f32_32x32x16_bf16 v[144:159], v[240:243], v[216:219], v[144:159]
    ds_read_b64_tr_b16 v[236:237], v65 offset:2976
    ds_read_b64_tr_b16 v[238:239], v65 offset:2944
    s_max_i32 s26, s26, 0
    s_lshl_b32 s27, s71, 12
    s_add_u32 s27, s27, 9437184
    s_lshl_b32 s99, s25, 3
    v_mfma_f32_32x32x16_bf16 v[160:175], v[220:223], v[216:219], v[160:175]
    s_lshl_b32 s100, s26, 3
    s_lshl_b32 s92, s24, 12
    s_lshl_b32 s93, s24, 9
    s_add_u32 s99, s99, s27
    s_add_u32 s100, s100, s27
    v_mfma_f32_32x32x16_bf16 v[176:191], v[212:215], v[216:219], v[176:191]
    v_mfma_f32_32x32x16_bf16 v[192:207], v[224:227], v[216:219], v[192:207]
    ds_read_b64_tr_b16 v[224:225], v65 offset:3488
    ds_read_b64_tr_b16 v[226:227], v65 offset:3456
    s_waitcnt lgkmcnt(2)
    v_mfma_f32_32x32x16_bf16 v[160:175], v[240:243], v[236:239], v[160:175]
    v_mfma_f32_32x32x16_bf16 v[176:191], v[220:223], v[236:239], v[176:191]
    ds_read_b64_tr_b16 v[244:245], v65 offset:4000
    ds_read_b64_tr_b16 v[246:247], v65 offset:3968
    v_mfma_f32_32x32x16_bf16 v[192:207], v[212:215], v[236:239], v[192:207]
    s_waitcnt lgkmcnt(2)
    v_mfma_f32_32x32x16_bf16 v[176:191], v[240:243], v[224:227], v[176:191]
    v_mfma_f32_32x32x16_bf16 v[192:207], v[220:223], v[224:227], v[192:207]
    s_waitcnt lgkmcnt(0)
    v_mfma_f32_32x32x16_bf16 v[192:207], v[240:243], v[244:247], v[192:207]
    s_waitcnt lgkmcnt(0)
    s_barrier
    ds_read_b128 v[212:215], v64 offset:608
    ds_read_b128 v[216:219], v64 offset:576
    ds_read_b128 v[220:223], v64 offset:544
    ds_read_b128 v[224:227], v64 offset:512
    s_waitcnt lgkmcnt(3)
    v_mfma_f32_32x32x16_bf16 v[144:159], v[212:215], v[112:115], v[144:159]
    ds_read_b128 v[228:231], v64 offset:736
    s_waitcnt lgkmcnt(3)
    v_mfma_f32_32x32x16_bf16 v[144:159], v[216:219], v[116:119], v[144:159]
    ds_read_b128 v[232:235], v64 offset:704
    s_waitcnt lgkmcnt(3)
    v_mfma_f32_32x32x16_bf16 v[144:159], v[220:223], v[120:123], v[144:159]
    ds_read_b128 v[236:239], v64 offset:672
    s_waitcnt lgkmcnt(3)
    v_mfma_f32_32x32x16_bf16 v[144:159], v[224:227], v[124:127], v[144:159]
    ds_read_b128 v[240:243], v64 offset:640
    s_nop 3
    s_waitcnt lgkmcnt(3)
    v_mfma_f32_32x32x16_bf16 v[160:175], v[228:231], v[112:115], v[160:175]
    s_nop 4
    s_waitcnt lgkmcnt(2)
    v_mfma_f32_32x32x16_bf16 v[160:175], v[232:235], v[116:119], v[160:175]
    v_cndmask_b32 v208, v147, v72, s[76:77]
    v_cndmask_b32 v209, v151, v147, s[76:77]
    v_cndmask_b32 v210, v155, v151, s[76:77]
    v_cndmask_b32 v211, v159, v155, s[76:77]
    v_mov_b32_e64 v72, v159
    s_waitcnt lgkmcnt(1)
    v_mfma_f32_32x32x16_bf16 v[160:175], v[236:239], v[120:123], v[160:175]
    v_add_f32_dpp v146, v208, v146 wave_ror:1 row_mask:0xf bank_mask:0xf
    v_add_f32_dpp v150, v209, v150 wave_ror:1 row_mask:0xf bank_mask:0xf
    v_add_f32_dpp v154, v210, v154 wave_ror:1 row_mask:0xf bank_mask:0xf
    v_add_f32_dpp v158, v211, v158 wave_ror:1 row_mask:0xf bank_mask:0xf
    v_cndmask_b32 v208, v146, v71, s[76:77]
    s_waitcnt lgkmcnt(0)
    v_mfma_f32_32x32x16_bf16 v[160:175], v[240:243], v[124:127], v[160:175]
    v_cndmask_b32 v209, v150, v146, s[76:77]
    v_cndmask_b32 v210, v154, v150, s[76:77]
    v_cndmask_b32 v211, v158, v154, s[76:77]
    v_mov_b32 v71, v158
    v_add_f32_dpp v145, v208, v145 wave_ror:1 row_mask:0xf bank_mask:0xf
    v_add_f32_dpp v149, v209, v149 wave_ror:1 row_mask:0xf bank_mask:0xf
    v_mfma_f32_32x32x16_bf16 v[160:175], v[212:215], v[128:131], v[160:175]
    ds_read_b128 v[244:247], v64 offset:864
    v_add_f32_dpp v153, v210, v153 wave_ror:1 row_mask:0xf bank_mask:0xf
    v_add_f32_dpp v157, v211, v157 wave_ror:1 row_mask:0xf bank_mask:0xf
    v_cndmask_b32 v208, v145, v70, s[76:77]
    v_cndmask_b32 v209, v149, v145, s[76:77]
    v_cndmask_b32 v210, v153, v149, s[76:77]
    v_mfma_f32_32x32x16_bf16 v[160:175], v[216:219], v[132:135], v[160:175]
    ds_read_b128 v[248:251], v64 offset:832
    v_cndmask_b32 v211, v157, v153, s[76:77]
    v_mov_b32_e64 v70, v157
    v_add_f32_dpp v144, v208, v144 wave_ror:1 row_mask:0xf bank_mask:0xf
    v_add_f32_dpp v148, v209, v148 wave_ror:1 row_mask:0xf bank_mask:0xf
    v_add_f32_dpp v152, v210, v152 wave_ror:1 row_mask:0xf bank_mask:0xf
    v_mfma_f32_32x32x16_bf16 v[160:175], v[220:223], v[136:139], v[160:175]
    ds_read_b128 v[252:255], v64 offset:800
    v_add_f32_dpp v156, v211, v156 wave_ror:1 row_mask:0xf bank_mask:0xf
    ds_write_b32 v66, v144 offset:0
    v_mfma_f32_32x32x16_bf16 v[160:175], v[224:227], v[140:143], v[160:175]
    ds_read_b128 v[224:227], v64 offset:768
    ds_write_b32 v66, v148 offset:64
    ds_write_b32 v66, v152 offset:128
    s_waitcnt lgkmcnt(6)
    v_mfma_f32_32x32x16_bf16 v[176:191], v[244:247], v[112:115], v[176:191]
    ds_write_b32 v66, v156 offset:192
    s_nop 2
    s_waitcnt lgkmcnt(6)
    v_mfma_f32_32x32x16_bf16 v[176:191], v[248:251], v[116:119], v[176:191]
    s_nop 2
    v_cndmask_b32 v208, v163, v72, s[76:77]
    v_cndmask_b32 v209, v167, v163, s[76:77]
    s_waitcnt lgkmcnt(5)
    v_mfma_f32_32x32x16_bf16 v[176:191], v[252:255], v[120:123], v[176:191]
    v_cndmask_b32 v210, v171, v167, s[76:77]
    v_cndmask_b32 v211, v175, v171, s[76:77]
    v_mov_b32 v72, v175
    v_add_f32_dpp v162, v208, v162 wave_ror:1 row_mask:0xf bank_mask:0xf
    v_add_f32_dpp v166, v209, v166 wave_ror:1 row_mask:0xf bank_mask:0xf
    s_waitcnt lgkmcnt(3)
    v_mfma_f32_32x32x16_bf16 v[176:191], v[224:227], v[124:127], v[176:191]
    v_add_f32_dpp v170, v210, v170 wave_ror:1 row_mask:0xf bank_mask:0xf
    v_add_f32_dpp v174, v211, v174 wave_ror:1 row_mask:0xf bank_mask:0xf
    v_cndmask_b32 v208, v162, v71, s[76:77]
    v_cndmask_b32 v209, v166, v162, s[76:77]
    v_cndmask_b32 v210, v170, v166, s[76:77]
    v_cndmask_b32 v211, v174, v170, s[76:77]
    v_mfma_f32_32x32x16_bf16 v[176:191], v[228:231], v[128:131], v[176:191]
    ds_read_b64_tr_b16 v[228:229], v65 offset:1056
    ds_read_b64_tr_b16 v[230:231], v65 offset:1024
    v_mov_b32 v71, v174
    v_add_f32_dpp v161, v208, v161 wave_ror:1 row_mask:0xf bank_mask:0xf
    v_add_f32_dpp v165, v209, v165 wave_ror:1 row_mask:0xf bank_mask:0xf
    v_add_f32_dpp v169, v210, v169 wave_ror:1 row_mask:0xf bank_mask:0xf
    v_mfma_f32_32x32x16_bf16 v[176:191], v[232:235], v[132:135], v[176:191]
    ds_read_b64_tr_b16 v[232:233], v65 offset:1184
    ds_read_b64_tr_b16 v[234:235], v65 offset:1152
    v_add_f32_dpp v173, v211, v173 wave_ror:1 row_mask:0xf bank_mask:0xf
    v_cndmask_b32 v208, v161, v70, s[76:77]
    v_cndmask_b32 v209, v165, v161, s[76:77]
    v_cndmask_b32 v210, v169, v165, s[76:77]
    v_mfma_f32_32x32x16_bf16 v[176:191], v[236:239], v[136:139], v[176:191]
    ds_read_b64_tr_b16 v[236:237], v65 offset:1312
    ds_read_b64_tr_b16 v[238:239], v65 offset:1280
    v_cndmask_b32 v211, v173, v169, s[76:77]
    v_mov_b32_e64 v70, v173
    v_add_f32_dpp v160, v208, v160 wave_ror:1 row_mask:0xf bank_mask:0xf
    v_add_f32_dpp v164, v209, v164 wave_ror:1 row_mask:0xf bank_mask:0xf
    v_mfma_f32_32x32x16_bf16 v[176:191], v[240:243], v[140:143], v[176:191]
    ds_read_b128 v[240:243], v64 offset:512
    ds_read_b64_tr_b16 v[224:225], v65 offset:1440
    ds_read_b64_tr_b16 v[226:227], v65 offset:1408
    v_add_f32_dpp v168, v210, v168 wave_ror:1 row_mask:0xf bank_mask:0xf
    v_add_f32_dpp v172, v211, v172 wave_ror:1 row_mask:0xf bank_mask:0xf
    s_waitcnt lgkmcnt(7)
    v_mfma_f32_32x32x16_bf16 v[176:191], v[212:215], v[228:231], v[176:191]
    ds_read_b128 v[212:215], v64 offset:992
    ds_write_b32 v66, v160 offset:256
    ds_write_b32 v66, v164 offset:320
    s_waitcnt lgkmcnt(8)
    v_mfma_f32_32x32x16_bf16 v[176:191], v[216:219], v[232:235], v[176:191]
    ds_read_b128 v[216:219], v64 offset:960
    ds_write_b32 v66, v168 offset:384
    ds_write_b32 v66, v172 offset:448
    s_waitcnt lgkmcnt(9)
    v_mfma_f32_32x32x16_bf16 v[176:191], v[220:223], v[236:239], v[176:191]
    ds_read_b128 v[220:223], v64 offset:928
    s_waitcnt lgkmcnt(7)
    v_mfma_f32_32x32x16_bf16 v[176:191], v[240:243], v[224:227], v[176:191]
    ds_read_b128 v[240:243], v64 offset:896
    s_waitcnt lgkmcnt(2)
    s_barrier
    v_mfma_f32_32x32x16_bf16 v[192:207], v[212:215], v[112:115], v[192:207]
    ds_read_b64 v[144:145], v67 offset:0
    ds_read_b64 v[146:147], v67 offset:4224
    ds_read_b64 v[148:149], v67 offset:8448
    ds_read_b64 v[150:151], v67 offset:12672
    s_lshl_b32 s25, s75, 14
    v_mfma_f32_32x32x16_bf16 v[192:207], v[216:219], v[116:119], v[192:207]
    buffer_load_dword v7, v4, s[16:19], s89 offen offset:0 sc1
    s_add_u32 s25, s25, 9437184
    s_nop 0
    v_cndmask_b32 v208, v179, v72, s[76:77]
    v_cndmask_b32 v209, v183, v179, s[76:77]
    s_waitcnt lgkmcnt(5)
    v_mfma_f32_32x32x16_bf16 v[192:207], v[220:223], v[120:123], v[192:207]
    v_cndmask_b32 v210, v187, v183, s[76:77]
    v_cndmask_b32 v211, v191, v187, s[76:77]
    v_mov_b32 v72, v191
    v_add_f32_dpp v178, v208, v178 wave_ror:1 row_mask:0xf bank_mask:0xf
    v_add_f32_dpp v182, v209, v182 wave_ror:1 row_mask:0xf bank_mask:0xf
    s_waitcnt lgkmcnt(4)
    v_mfma_f32_32x32x16_bf16 v[192:207], v[240:243], v[124:127], v[192:207]
    ds_read_b128 v[212:215], v64 offset:768
    v_add_f32_dpp v186, v210, v186 wave_ror:1 row_mask:0xf bank_mask:0xf
    v_add_f32_dpp v190, v211, v190 wave_ror:1 row_mask:0xf bank_mask:0xf
    v_cndmask_b32 v208, v178, v71, s[76:77]
    v_cndmask_b32 v209, v182, v178, s[76:77]
    v_cndmask_b32 v210, v186, v182, s[76:77]
    v_mfma_f32_32x32x16_bf16 v[192:207], v[244:247], v[128:131], v[192:207]
    ds_read_b128 v[244:247], v64 offset:736
    v_cndmask_b32 v211, v190, v186, s[76:77]
    v_mov_b32 v71, v190
    v_add_f32_dpp v177, v208, v177 wave_ror:1 row_mask:0xf bank_mask:0xf
    v_add_f32_dpp v181, v209, v181 wave_ror:1 row_mask:0xf bank_mask:0xf
    v_add_f32_dpp v185, v210, v185 wave_ror:1 row_mask:0xf bank_mask:0xf
    v_mfma_f32_32x32x16_bf16 v[192:207], v[248:251], v[132:135], v[192:207]
    ds_read_b128 v[248:251], v64 offset:704
    v_add_f32_dpp v189, v211, v189 wave_ror:1 row_mask:0xf bank_mask:0xf
    v_cndmask_b32 v208, v177, v70, s[76:77]
    v_cndmask_b32 v209, v181, v177, s[76:77]
    v_cndmask_b32 v210, v185, v181, s[76:77]
    v_cndmask_b32 v211, v189, v185, s[76:77]
    v_mfma_f32_32x32x16_bf16 v[192:207], v[252:255], v[136:139], v[192:207]
    ds_read_b128 v[252:255], v64 offset:672
    v_mov_b32_e64 v70, v189
    v_add_f32_dpp v176, v208, v176 wave_ror:1 row_mask:0xf bank_mask:0xf
    v_add_f32_dpp v180, v209, v180 wave_ror:1 row_mask:0xf bank_mask:0xf
    v_add_f32_dpp v184, v210, v184 wave_ror:1 row_mask:0xf bank_mask:0xf
    s_waitcnt lgkmcnt(3)
    v_mfma_f32_32x32x16_bf16 v[192:207], v[212:215], v[140:143], v[192:207]
    ds_read_b128 v[216:219], v64 offset:640
    v_add_f32_dpp v188, v211, v188 wave_ror:1 row_mask:0xf bank_mask:0xf
    s_waitcnt lgkmcnt(3)
    v_mfma_f32_32x32x16_bf16 v[192:207], v[244:247], v[228:231], v[192:207]
    ds_read_b128 v[228:231], v64 offset:608
    ds_read_b64_tr_b16 v[220:221], v65 offset:1568
    ds_read_b64_tr_b16 v[222:223], v65 offset:1536
    ds_write_b32 v66, v176 offset:512
    s_waitcnt lgkmcnt(6)
    v_mfma_f32_32x32x16_bf16 v[192:207], v[248:251], v[232:235], v[192:207]
    ds_read_b128 v[232:235], v64 offset:576
    ds_read_b64_tr_b16 v[240:241], v65 offset:1696
    ds_read_b64_tr_b16 v[242:243], v65 offset:1664
    ds_write_b32 v66, v180 offset:576
    s_waitcnt lgkmcnt(9)
    v_mfma_f32_32x32x16_bf16 v[192:207], v[252:255], v[236:239], v[192:207]
    ds_read_b128 v[236:239], v64 offset:544
    ds_read_b64_tr_b16 v[212:213], v65 offset:1824
    ds_read_b64_tr_b16 v[214:215], v65 offset:1792
    ds_write_b32 v66, v184 offset:640
    s_waitcnt lgkmcnt(12)
    v_mfma_f32_32x32x16_bf16 v[192:207], v[216:219], v[224:227], v[192:207]
    ds_read_b128 v[224:227], v64 offset:512
    ds_read_b64_tr_b16 v[244:245], v65 offset:1952
    ds_read_b64_tr_b16 v[246:247], v65 offset:1920
    ds_write_b32 v66, v188 offset:704
    s_waitcnt lgkmcnt(13)
    v_mfma_f32_32x32x16_bf16 v[192:207], v[228:231], v[220:223], v[192:207]
    v_add_f32 v144, v144, v80
    v_add_f32 v145, v145, v81
    v_add_f32 v146, v146, v82
    v_add_f32 v147, v147, v83
    s_waitcnt lgkmcnt(9)
    v_mfma_f32_32x32x16_bf16 v[192:207], v[232:235], v[240:243], v[192:207]
    v_add_f32 v148, v148, v84
    v_add_f32 v149, v149, v85
    v_add_f32 v150, v150, v86
    v_add_f32 v151, v151, v87
    v_cvt_pk_bf16_f32 v160, v144, v146
    s_waitcnt lgkmcnt(5)
    v_mfma_f32_32x32x16_bf16 v[192:207], v[236:239], v[212:215], v[192:207]
    v_cvt_pk_bf16_f32 v161, v148, v150
    v_cvt_pk_bf16_f32 v162, v145, v147
    v_cvt_pk_bf16_f32 v163, v149, v151
    s_waitcnt lgkmcnt(1)
    v_mfma_f32_32x32x16_bf16 v[192:207], v[224:227], v[244:247], v[192:207]
    buffer_store_dwordx4 v[160:163], v62, s[16:19], s25 offen offset:2048 sc1
    s_nop 10
    v_cndmask_b32 v208, v195, v72, s[76:77]
    v_cndmask_b32 v209, v199, v195, s[76:77]
    v_cndmask_b32 v210, v203, v199, s[76:77]
    v_cndmask_b32 v211, v207, v203, s[76:77]
    v_mov_b32_e64 v72, v207
    v_add_f32_dpp v194, v208, v194 wave_ror:1 row_mask:0xf bank_mask:0xf
    v_add_f32_dpp v198, v209, v198 wave_ror:1 row_mask:0xf bank_mask:0xf
    v_add_f32_dpp v202, v210, v202 wave_ror:1 row_mask:0xf bank_mask:0xf
    v_add_f32_dpp v206, v211, v206 wave_ror:1 row_mask:0xf bank_mask:0xf
    v_cndmask_b32 v208, v194, v71, s[76:77]
    v_cndmask_b32 v209, v198, v194, s[76:77]
    v_cndmask_b32 v210, v202, v198, s[76:77]
    v_cndmask_b32 v211, v206, v202, s[76:77]
    v_mov_b32_e64 v71, v206
    v_add_f32_dpp v193, v208, v193 wave_ror:1 row_mask:0xf bank_mask:0xf
    v_add_f32_dpp v197, v209, v197 wave_ror:1 row_mask:0xf bank_mask:0xf
    v_add_f32_dpp v201, v210, v201 wave_ror:1 row_mask:0xf bank_mask:0xf
    v_add_f32_dpp v205, v211, v205 wave_ror:1 row_mask:0xf bank_mask:0xf
    v_cndmask_b32 v208, v193, v70, s[76:77]
    v_cndmask_b32 v209, v197, v193, s[76:77]
    v_cndmask_b32 v210, v201, v197, s[76:77]
    v_cndmask_b32 v211, v205, v201, s[76:77]
    v_mov_b32_e64 v70, v205
    v_add_f32_dpp v192, v208, v192 wave_ror:1 row_mask:0xf bank_mask:0xf
    v_add_f32_dpp v196, v209, v196 wave_ror:1 row_mask:0xf bank_mask:0xf
    v_add_f32_dpp v200, v210, v200 wave_ror:1 row_mask:0xf bank_mask:0xf
    v_add_f32_dpp v204, v211, v204 wave_ror:1 row_mask:0xf bank_mask:0xf
    ds_write_b32 v66, v192 offset:768
    ds_write_b32 v66, v196 offset:832
    ds_write_b32 v66, v200 offset:896
    ds_write_b32 v66, v204 offset:960
    s_waitcnt lgkmcnt(0)
    s_waitcnt vmcnt(1)
    v_cmp_gt_u32_e64 vcc, 1, v7
    s_nop 0
    s_and_b64 vcc, vcc, s[50:51]
    s_cbranch_scc1 ps_36
pc_38:
    s_barrier
    ds_read_b64 v[152:153], v67 offset:512
    ds_read_b64 v[154:155], v67 offset:4736
    ds_read_b64 v[156:157], v67 offset:8960
    ds_read_b64 v[158:159], v67 offset:13184
    s_add_u32 m0, s92, 36352
    s_nop 0
    s_nop 0
    buffer_load_dwordx4 v73, s[16:19], s99 offen offset:0 sc1 lds
    buffer_load_dwordx4 v74, s[16:19], s99 offen offset:1024 sc1 lds
    buffer_load_dwordx4 v75, s[16:19], s99 offen offset:2048 sc1 lds
    buffer_load_dwordx4 v76, s[16:19], s99 offen offset:3072 sc1 lds
    s_add_u32 m0, s93, 53760
    s_add_u32 s99, s99, 524288
    s_mov_b64 exec, s[80:81]
    buffer_load_dwordx4 v77, s[16:19], s100 offen sc1 lds
    s_mov_b64 exec, -1
    s_add_u32 s100, s100, 524288
    s_lshl_b32 s25, s75, 14
    s_add_u32 s25, s25, 9437184
    s_waitcnt lgkmcnt(0)
    v_add_f32 v152, v152, v88
    v_add_f32 v153, v153, v89
    v_add_f32 v154, v154, v90
    v_add_f32 v155, v155, v91
    v_add_f32 v156, v156, v92
    v_add_f32 v157, v157, v93
    v_add_f32 v158, v158, v94
    v_add_f32 v159, v159, v95
    v_cvt_pk_bf16_f32 v164, v152, v154
    v_cvt_pk_bf16_f32 v165, v156, v158
    v_cvt_pk_bf16_f32 v166, v153, v155
    v_cvt_pk_bf16_f32 v167, v157, v159
    buffer_store_dwordx4 v[164:167], v62, s[16:19], s25 offen offset:3072 sc1
    v_mov_b32_e64 v5, 1
    s_add_u32 s82, s86, 24576
    buffer_atomic_add v5, v6, s[16:19], s82 offen offset:4 sc0 sc1
    s_add_u32 m0, s92, 55936
    s_nop 0
    s_nop 0
    buffer_load_dwordx4 v73, s[16:19], s99 offen offset:0 sc1 lds
    buffer_load_dwordx4 v74, s[16:19], s99 offen offset:1024 sc1 lds
    buffer_load_dwordx4 v75, s[16:19], s99 offen offset:2048 sc1 lds
    buffer_load_dwordx4 v76, s[16:19], s99 offen offset:3072 sc1 lds
    s_add_u32 m0, s93, 73344
    s_add_u32 s99, s99, 524288
    s_mov_b64 exec, s[80:81]
    buffer_load_dwordx4 v77, s[16:19], s100 offen sc1 lds
    s_mov_b64 exec, -1
    s_add_u32 s100, s100, 524288
    s_branch ec_27
nc_26:
    v_lshlrev_b32 v2, 3, v4
    v_mov_b32_e64 v5, 1
    v_cndmask_b32 v2, v4, v2, s[50:51]
    buffer_atomic_add v5, v2, s[16:19], s86 offen offset:8 sc1
    buffer_load_dword v7, v4, s[16:19], s87 offen offset:8 sc1
    s_waitcnt vmcnt(0)
    v_cmp_gt_u32 vcc, 12, v7
    s_nop 0
    s_and_b64 vcc, vcc, s[50:51]
    s_cbranch_scc1 ps_39
pc_41:
    v_mov_b32 v100, -1
    v_mov_b32 v101, -1
    v_mov_b32 v102, -1
    v_mov_b32 v103, -1
    v_lshlrev_b32 v104, 4, v0
    s_sub_u32 s88, s2, 160
    s_mul_i32 s88, s88, 57344
    s_min_u32 s88, s88, 5185536
    s_add_u32 s88, s88, 12058624
    buffer_store_dwordx4 v[100:103], v104, s[16:19], s88 offen sc1
    s_add_u32 s88, s88, 4096
    buffer_store_dwordx4 v[100:103], v104, s[16:19], s88 offen sc1
    s_add_u32 s88, s88, 4096
    buffer_store_dwordx4 v[100:103], v104, s[16:19], s88 offen sc1
    s_add_u32 s88, s88, 4096
    buffer_store_dwordx4 v[100:103], v104, s[16:19], s88 offen sc1
    s_add_u32 s88, s88, 4096
    buffer_store_dwordx4 v[100:103], v104, s[16:19], s88 offen sc1
    s_add_u32 s88, s88, 4096
    buffer_store_dwordx4 v[100:103], v104, s[16:19], s88 offen sc1
    s_add_u32 s88, s88, 4096
    buffer_store_dwordx4 v[100:103], v104, s[16:19], s88 offen sc1
    s_add_u32 s88, s88, 4096
    buffer_store_dwordx4 v[100:103], v104, s[16:19], s88 offen sc1
    s_add_u32 s88, s88, 4096
    buffer_store_dwordx4 v[100:103], v104, s[16:19], s88 offen sc1
    s_add_u32 s88, s88, 4096
    buffer_store_dwordx4 v[100:103], v104, s[16:19], s88 offen sc1
    s_add_u32 s88, s88, 4096
    buffer_store_dwordx4 v[100:103], v104, s[16:19], s88 offen sc1
    s_add_u32 s88, s88, 4096
    buffer_store_dwordx4 v[100:103], v104, s[16:19], s88 offen sc1
    s_add_u32 s88, s88, 4096
    buffer_store_dwordx4 v[100:103], v104, s[16:19], s88 offen sc1
    s_add_u32 s88, s88, 4096
    buffer_store_dwordx4 v[100:103], v104, s[16:19], s88 offen sc1
    s_waitcnt vmcnt(0)
    s_barrier
    v_mov_b32_e64 v5, 1
    s_add_u32 s82, s86, 8192
    buffer_atomic_add v5, v6, s[16:19], s82 offen offset:12 sc0 sc1
    s_waitcnt vmcnt(0)
    v_cmp_eq_u32 vcc, 11, v5
    s_nop 0
    s_cbranch_vccnz gl_42
gc_43:
    buffer_load_dword v7, v4, s[16:19], s89 offen offset:0 sc1
    s_waitcnt vmcnt(0)
    v_cmp_gt_u32 vcc, 1, v7
    s_nop 0
    s_and_b64 vcc, vcc, s[50:51]
    s_cbranch_scc1 ps_44
pc_46:
    s_barrier
    s_sub_u32 s3, s2, 160
    s_and_b32 s3, s3, 63
    s_add_u32 s3, s3, 0
    s_and_b32 s25, s3, 3
    s_lshl_b32 s25, s25, 12
    s_lshr_b32 s26, s3, 2
    s_lshl_b32 s26, s26, 7
    s_add_u32 s3, s25, s26
    v_lshrrev_b32 v236, 3, v0
    v_and_b32 v237, 7, v0
    v_lshlrev_b32 v237, 4, v237
    v_lshl_add_u32 v236, v236, 14, v237
    s_sub_u32 s25, s2, 160
    s_cmp_lt_u32 s25, 64
    s_cselect_b32 s25, 0, 1073741824
    v_add_u32_e64 v236, s25, v236
    s_add_u32 s26, s3, 9437184
    buffer_load_dwordx4 v[216:219], v236, s[16:19], s26 offen sc1
    s_add_u32 s26, s26, 524288
    buffer_load_dwordx4 v[220:223], v236, s[16:19], s26 offen sc1
    s_add_u32 s26, s26, 524288
    buffer_load_dwordx4 v[224:227], v236, s[16:19], s26 offen sc1
    s_add_u32 s26, s26, 524288
    buffer_load_dwordx4 v[228:231], v236, s[16:19], s26 offen sc1
    s_add_u32 s26, s26, 524288
    buffer_load_dwordx4 v[232:235], v236, s[16:19], s26 offen sc1
    s_lshl_b32 s25, s72, 5
    s_add_u32 s25, s25, 0
    s_sub_u32 s26, s25, 4
    s_max_i32 s26, s26, 0
    s_lshl_b32 s27, s71, 12
    s_add_u32 s27, s27, 9437184
    s_lshl_b32 s99, s25, 3
    s_lshl_b32 s100, s26, 3
    s_lshl_b32 s92, s24, 12
    s_lshl_b32 s93, s24, 9
    s_add_u32 s99, s99, s27
    s_add_u32 s100, s100, s27
    s_add_u32 m0, s92, 36352
    s_nop 0
    buffer_load_dwordx4 v73, s[16:19], s99 offen offset:0 sc1 lds
    buffer_load_dwordx4 v74, s[16:19], s99 offen offset:1024 sc1 lds
    buffer_load_dwordx4 v75, s[16:19], s99 offen offset:2048 sc1 lds
    buffer_load_dwordx4 v76, s[16:19], s99 offen offset:3072 sc1 lds
    s_add_u32 m0, s93, 53760
    s_add_u32 s99, s99, 524288
    s_mov_b64 exec, s[80:81]
    buffer_load_dwordx4 v77, s[16:19], s100 offen sc1 lds
    s_mov_b64 exec, -1
    s_add_u32 s100, s100, 524288
    s_add_u32 m0, s92, 55936
    s_nop 0
    s_nop 0
    buffer_load_dwordx4 v73, s[16:19], s99 offen offset:0 sc1 lds
    buffer_load_dwordx4 v74, s[16:19], s99 offen offset:1024 sc1 lds
    buffer_load_dwordx4 v75, s[16:19], s99 offen offset:2048 sc1 lds
    buffer_load_dwordx4 v76, s[16:19], s99 offen offset:3072 sc1 lds
    s_add_u32 m0, s93, 73344
    s_add_u32 s99, s99, 524288
    s_mov_b64 exec, s[80:81]
    buffer_load_dwordx4 v77, s[16:19], s100 offen sc1 lds
    s_mov_b64 exec, -1
    s_add_u32 s100, s100, 524288
    s_sub_u32 s85, s2, 160
    s_cmp_ge_u32 s85, 64
    s_cbranch_scc1 s2_47
    v_mov_b32 v238, 0x3f803f80
    s_lshl_b32 s25, s24, 7
    s_add_u32 s25, s25, 134272
    v_lshrrev_b32 v239, 4, v1
    v_lshl_add_u32 v237, v239, 2, v237
    v_add_u32 v237, s25, v237
se_48:
    v_mov_b32 v240, 0
    v_mov_b32 v241, 0
    v_mov_b32 v242, 0
    v_mov_b32 v243, 0
    s_waitcnt vmcnt(14)
    v_dot2c_f32_bf16 v240, v216, v238
    v_dot2c_f32_bf16 v241, v216, v216
    v_dot2c_f32_bf16 v240, v217, v238
    v_dot2c_f32_bf16 v241, v217, v217
    v_dot2c_f32_bf16 v242, v218, v238
    v_dot2c_f32_bf16 v243, v218, v218
    v_dot2c_f32_bf16 v242, v219, v238
    v_dot2c_f32_bf16 v243, v219, v219
    s_waitcnt vmcnt(13)
    v_dot2c_f32_bf16 v240, v220, v238
    v_dot2c_f32_bf16 v241, v220, v220
    v_dot2c_f32_bf16 v240, v221, v238
    v_dot2c_f32_bf16 v241, v221, v221
    v_dot2c_f32_bf16 v242, v222, v238
    v_dot2c_f32_bf16 v243, v222, v222
    v_dot2c_f32_bf16 v242, v223, v238
    v_dot2c_f32_bf16 v243, v223, v223
    s_waitcnt vmcnt(12)
    v_dot2c_f32_bf16 v240, v224, v238
    v_dot2c_f32_bf16 v241, v224, v224
    v_dot2c_f32_bf16 v240, v225, v238
    v_dot2c_f32_bf16 v241, v225, v225
    v_dot2c_f32_bf16 v242, v226, v238
    v_dot2c_f32_bf16 v243, v226, v226
    v_dot2c_f32_bf16 v242, v227, v238
    v_dot2c_f32_bf16 v243, v227, v227
    s_waitcnt vmcnt(11)
    v_dot2c_f32_bf16 v240, v228, v238
    v_dot2c_f32_bf16 v241, v228, v228
    v_dot2c_f32_bf16 v240, v229, v238
    v_dot2c_f32_bf16 v241, v229, v229
    v_dot2c_f32_bf16 v242, v230, v238
    v_dot2c_f32_bf16 v243, v230, v230
    v_dot2c_f32_bf16 v242, v231, v238
    v_dot2c_f32_bf16 v243, v231, v231
    s_waitcnt vmcnt(10)
    v_dot2c_f32_bf16 v240, v232, v238
    v_dot2c_f32_bf16 v241, v232, v232
    v_dot2c_f32_bf16 v240, v233, v238
    v_dot2c_f32_bf16 v241, v233, v233
    v_dot2c_f32_bf16 v242, v234, v238
    v_dot2c_f32_bf16 v243, v234, v234
    v_dot2c_f32_bf16 v242, v235, v238
    v_dot2c_f32_bf16 v243, v235, v235
    s_nop 2
    v_cmp_u_f32 vcc, v241, v243
    s_nop 0
    s_cbranch_vccnz rd_49
rc_50:
    v_permlane32_swap_b32 v240, v242
    v_permlane32_swap_b32 v241, v243
    v_pk_add_f32 v[240:241], v[240:241], v[242:243]
    s_nop 1
    v_permlane16_swap_b32 v240, v241
    v_add_f32 v240, v240, v241
    s_nop 1
    v_add_f32_dpp v240, v240, v240 row_ror:8 row_mask:0xf bank_mask:0xf
    ds_write_b32 v237, v240
    v_and_b32 v236, 15, v0
    v_lshlrev_b32 v236, 3, v236
    v_add_u32 v237, 134272, v236
    v_mov_b32 v239, 1073741824
    v_cmp_gt_u32 vcc, 16, v0
    s_nop 1
    v_cndmask_b32 v236, v239, v236, vcc
    s_add_u32 s25, s3, 3457024
    s_waitcnt lgkmcnt(0)
    s_barrier
    ds_read_b64 v[216:217], v237 offset:0
    ds_read_b64 v[218:219], v237 offset:128
    ds_read_b64 v[220:221], v237 offset:256
    ds_read_b64 v[222:223], v237 offset:384
    s_waitcnt lgkmcnt(2)
    v_pk_add_f32 v[216:217], v[216:217], v[218:219]
    s_waitcnt lgkmcnt(0)
    v_pk_add_f32 v[220:221], v[220:221], v[222:223]
    v_pk_add_f32 v[216:217], v[216:217], v[220:221]
    v_mul_f32 v239, 0x3acccccd, v216
    v_mul_f32 v217, 0x3acccccd, v217
    v_fma_f32 v217, -v239, v239, v217
    v_max_f32 v217, 0, v217
    v_add_f32 v217, 0x3727c5ac, v217
    v_rsq_f32_e64 v216, v217
    s_nop 0
    v_mul_f32 v217, -v239, v216
    buffer_store_dwordx2 v[216:217], v236, s[16:19], s25 offen sc1
s2_47:
ec_27:
ge_51:
    v_add_u32 v196, 36352, v78
    v_mov_b32_e64 v198, v79
    s_waitcnt vmcnt(5)
    s_barrier
    ds_read_b64 v[160:161], v198 offset:0
    ds_read_b64 v[162:163], v198 offset:64
    ds_read_b64 v[164:165], v196 offset:0
    ds_read_b64 v[166:167], v196 offset:512
    ds_read_b64 v[168:169], v196 offset:256
    ds_read_b64 v[170:171], v196 offset:768
    ds_read_b64 v[172:173], v198 offset:256
    ds_read_b64 v[174:175], v198 offset:320
    ds_read_b64 v[176:177], v196 offset:2048
    ds_read_b64 v[178:179], v196 offset:2560
    ds_read_b64 v[180:181], v196 offset:2304
    ds_read_b64 v[182:183], v196 offset:2816
    s_waitcnt lgkmcnt(6)
    v_mfma_f32_16x16x32_bf16 v[112:115], a[0:3], v[160:163], 0
    ds_read_b64 v[184:185], v198 offset:512
    v_mfma_f32_32x32x16_bf16 v[80:95], a[0:3], v[164:167], 0
    ds_read_b64 v[186:187], v198 offset:576
    ds_read_b64 v[188:189], v196 offset:4096
    ds_read_b64 v[190:191], v196 offset:4608
    v_mov_b32 v208, 0
    v_mov_b32_e64 v209, 0
    v_mfma_f32_32x32x16_bf16 v[96:111], a[0:3], v[168:171], 0
    ds_read_b64 v[192:193], v196 offset:4352
    ds_read_b64 v[194:195], v196 offset:4864
    s_add_u32 m0, s92, 75520
    s_nop 0
    buffer_load_dwordx4 v73, s[16:19], s99 offen offset:0 sc1 lds
    s_waitcnt lgkmcnt(6)
    v_mfma_f32_16x16x32_bf16 v[112:115], a[4:7], v[172:175], v[112:115]
    ds_read_b64 v[160:161], v198 offset:768
    v_mfma_f32_32x32x16_bf16 v[80:95], a[4:7], v[176:179], v[80:95]
    ds_read_b64 v[162:163], v198 offset:832
    ds_read_b64 v[164:165], v196 offset:6144
    ds_read_b64 v[166:167], v196 offset:6656
    v_lshrrev_b32_e64 v210, 5, v0
    v_mul_u32_u24 v210, 1600, v210
    v_mfma_f32_32x32x16_bf16 v[96:111], a[4:7], v[180:183], v[96:111]
    ds_read_b64 v[168:169], v196 offset:6400
    ds_read_b64 v[170:171], v196 offset:6912
    buffer_load_dwordx4 v74, s[16:19], s99 offen offset:1024 sc1 lds
    v_and_b32 v211, 31, v0
    s_waitcnt lgkmcnt(6)
    v_mfma_f32_16x16x32_bf16 v[112:115], a[8:11], v[184:187], v[112:115]
    ds_read_b64 v[172:173], v198 offset:1024
    v_mfma_f32_32x32x16_bf16 v[80:95], a[8:11], v[188:191], v[80:95]
    ds_read_b64 v[174:175], v198 offset:1088
    ds_read_b64 v[176:177], v196 offset:8192
    ds_read_b64 v[178:179], v196 offset:8704
    v_min_u32_e64 v211, 19, v211
    v_lshl_add_u32 v210, v211, 3, v210
    v_mfma_f32_32x32x16_bf16 v[96:111], a[8:11], v[192:195], v[96:111]
    ds_read_b64 v[180:181], v196 offset:8448
    ds_read_b64 v[182:183], v196 offset:8960
    buffer_load_dwordx4 v75, s[16:19], s99 offen offset:2048 sc1 lds
    v_add_u32 v210, 6400, v210
    s_waitcnt lgkmcnt(6)
    v_mfma_f32_16x16x32_bf16 v[112:115], a[12:15], v[160:163], v[112:115]
    ds_read_b64 v[184:185], v198 offset:1280
    v_mfma_f32_32x32x16_bf16 v[80:95], a[12:15], v[164:167], v[80:95]
    ds_read_b64 v[186:187], v198 offset:1344
    ds_read_b64 v[188:189], v196 offset:10240
    ds_read_b64 v[190:191], v196 offset:10752
    ds_write_b64 v210, v[208:209]
    v_mfma_f32_32x32x16_bf16 v[96:111], a[12:15], v[168:171], v[96:111]
    ds_read_b64 v[192:193], v196 offset:10496
    ds_read_b64 v[194:195], v196 offset:11008
    buffer_load_dwordx4 v76, s[16:19], s99 offen offset:3072 sc1 lds
    s_waitcnt lgkmcnt(7)
    v_mfma_f32_16x16x32_bf16 v[112:115], a[16:19], v[172:175], v[112:115]
    ds_read_b64 v[160:161], v198 offset:1536
    v_mfma_f32_32x32x16_bf16 v[80:95], a[16:19], v[176:179], v[80:95]
    ds_read_b64 v[162:163], v198 offset:1600
    ds_read_b64 v[164:165], v196 offset:12288
    ds_read_b64 v[166:167], v196 offset:12800
    v_mfma_f32_32x32x16_bf16 v[96:111], a[16:19], v[180:183], v[96:111]
    ds_read_b64 v[168:169], v196 offset:12544
    ds_read_b64 v[170:171], v196 offset:13056
    s_add_u32 m0, s93, 92928
    s_add_u32 s99, s99, 524288
    s_mov_b64 exec, s[80:81]
    buffer_load_dwordx4 v77, s[16:19], s100 offen sc1 lds
    s_mov_b64 exec, -1
    s_add_u32 s100, s100, 524288
    s_waitcnt lgkmcnt(6)
    v_mfma_f32_16x16x32_bf16 v[112:115], a[20:23], v[184:187], v[112:115]
    ds_read_b64 v[172:173], v198 offset:1792
    v_mfma_f32_32x32x16_bf16 v[80:95], a[20:23], v[188:191], v[80:95]
    ds_read_b64 v[174:175], v198 offset:1856
    ds_read_b64 v[176:177], v196 offset:14336
    ds_read_b64 v[178:179], v196 offset:14848
    v_mfma_f32_32x32x16_bf16 v[96:111], a[20:23], v[192:195], v[96:111]
    ds_read_b64 v[180:181], v196 offset:14592
    ds_read_b64 v[182:183], v196 offset:15104
    buffer_load_dword v7, v4, s[16:19], s87 offen offset:12 sc1
    v_cmp_eq_u32 vcc, 19, v5
    s_nop 0
    s_cbranch_vccnz gl_52
gc_53:
    s_waitcnt vmcnt(6)
    s_barrier
    s_waitcnt lgkmcnt(6)
    v_mfma_f32_16x16x32_bf16 v[112:115], a[24:27], v[160:163], v[112:115]
    v_add_u32 v198, v49, v198
    v_mfma_f32_32x32x16_bf16 v[80:95], a[24:27], v[164:167], v[80:95]
    v_add_u32 v196, 19584, v196
    ds_read_b64 v[184:185], v198 offset:0
    ds_read_b64 v[186:187], v198 offset:64
    ds_read_b64 v[188:189], v196 offset:0
    v_mfma_f32_32x32x16_bf16 v[96:111], a[24:27], v[168:171], v[96:111]
    ds_read_b64 v[190:191], v196 offset:512
    ds_read_b64 v[192:193], v196 offset:256
    ds_read_b64 v[194:195], v196 offset:768
    s_add_u32 m0, s92, 95104
    s_nop 0
    buffer_load_dwordx4 v73, s[16:19], s99 offen offset:0 sc1 lds
    s_waitcnt lgkmcnt(6)
    v_mfma_f32_16x16x32_bf16 v[112:115], a[28:31], v[172:175], v[112:115]
    ds_read_b64 v[160:161], v198 offset:256
    v_mfma_f32_32x32x16_bf16 v[80:95], a[28:31], v[176:179], v[80:95]
    ds_read_b64 v[162:163], v198 offset:320
    ds_read_b64 v[164:165], v196 offset:2048
    ds_read_b64 v[166:167], v196 offset:2560
    v_mfma_f32_32x32x16_bf16 v[96:111], a[28:31], v[180:183], v[96:111]
    ds_read_b64 v[168:169], v196 offset:2304
    ds_read_b64 v[170:171], v196 offset:2816
    buffer_load_dwordx4 v74, s[16:19], s99 offen offset:1024 sc1 lds
    s_waitcnt lgkmcnt(6)
    v_mfma_f32_16x16x32_bf16 v[112:115], a[32:35], v[184:187], v[112:115]
    ds_read_b64 v[172:173], v198 offset:512
    v_mfma_f32_32x32x16_bf16 v[80:95], a[32:35], v[188:191], v[80:95]
    ds_read_b64 v[174:175], v198 offset:576
    ds_read_b64 v[176:177], v196 offset:4096
    ds_read_b64 v[178:179], v196 offset:4608
    v_mfma_f32_32x32x16_bf16 v[96:111], a[32:35], v[192:195], v[96:111]
    ds_read_b64 v[180:181], v196 offset:4352
    ds_read_b64 v[182:183], v196 offset:4864
    buffer_load_dwordx4 v75, s[16:19], s99 offen offset:2048 sc1 lds
    s_waitcnt lgkmcnt(6)
    v_mfma_f32_16x16x32_bf16 v[112:115], a[36:39], v[160:163], v[112:115]
    ds_read_b64 v[184:185], v198 offset:768
    v_mfma_f32_32x32x16_bf16 v[80:95], a[36:39], v[164:167], v[80:95]
    ds_read_b64 v[186:187], v198 offset:832
    ds_read_b64 v[188:189], v196 offset:6144
    ds_read_b64 v[190:191], v196 offset:6656
    v_mfma_f32_32x32x16_bf16 v[96:111], a[36:39], v[168:171], v[96:111]
    ds_read_b64 v[192:193], v196 offset:6400
    ds_read_b64 v[194:195], v196 offset:6912
    buffer_load_dwordx4 v76, s[16:19], s99 offen offset:3072 sc1 lds
    s_waitcnt lgkmcnt(6)
    v_mfma_f32_16x16x32_bf16 v[112:115], a[40:43], v[172:175], v[112:115]
    ds_read_b64 v[160:161], v198 offset:1024
    v_mfma_f32_32x32x16_bf16 v[80:95], a[40:43], v[176:179], v[80:95]
    ds_read_b64 v[162:163], v198 offset:1088
    ds_read_b64 v[164:165], v196 offset:8192
    ds_read_b64 v[166:167], v196 offset:8704
    v_mfma_f32_32x32x16_bf16 v[96:111], a[40:43], v[180:183], v[96:111]
    ds_read_b64 v[168:169], v196 offset:8448
    ds_read_b64 v[170:171], v196 offset:8960
    s_add_u32 m0, s93, 112512
    s_add_u32 s99, s99, 524288
    s_mov_b64 exec, s[80:81]
    buffer_load_dwordx4 v77, s[16:19], s100 offen sc1 lds
    s_mov_b64 exec, -1
    s_add_u32 s100, s100, 524288
    s_waitcnt lgkmcnt(6)
    v_mfma_f32_16x16x32_bf16 v[112:115], a[44:47], v[184:187], v[112:115]
    ds_read_b64 v[172:173], v198 offset:1280
    v_mfma_f32_32x32x16_bf16 v[80:95], a[44:47], v[188:191], v[80:95]
    ds_read_b64 v[174:175], v198 offset:1344
    ds_read_b64 v[176:177], v196 offset:10240
    ds_read_b64 v[178:179], v196 offset:10752
    v_mfma_f32_32x32x16_bf16 v[96:111], a[44:47], v[192:195], v[96:111]
    ds_read_b64 v[180:181], v196 offset:10496
    ds_read_b64 v[182:183], v196 offset:11008
    s_add_u32 m0, s92, 114688
    s_nop 0
    buffer_load_dwordx4 v73, s[16:19], s99 offen offset:0 sc1 lds
    s_waitcnt lgkmcnt(6)
    v_mfma_f32_16x16x32_bf16 v[112:115], a[48:51], v[160:163], v[112:115]
    ds_read_b64 v[184:185], v198 offset:1536
    v_mfma_f32_32x32x16_bf16 v[80:95], a[48:51], v[164:167], v[80:95]
    ds_read_b64 v[186:187], v198 offset:1600
    ds_read_b64 v[188:189], v196 offset:12288
    ds_read_b64 v[190:191], v196 offset:12800
    v_mfma_f32_32x32x16_bf16 v[96:111], a[48:51], v[168:171], v[96:111]
    ds_read_b64 v[192:193], v196 offset:12544
    ds_read_b64 v[194:195], v196 offset:13056
    buffer_load_dwordx4 v74, s[16:19], s99 offen offset:1024 sc1 lds
    s_waitcnt lgkmcnt(6)
    v_mfma_f32_16x16x32_bf16 v[112:115], a[52:55], v[172:175], v[112:115]
    ds_read_b64 v[160:161], v198 offset:1792
    v_mfma_f32_32x32x16_bf16 v[80:95], a[52:55], v[176:179], v[80:95]
    ds_read_b64 v[162:163], v198 offset:1856
    ds_read_b64 v[164:165], v196 offset:14336
    ds_read_b64 v[166:167], v196 offset:14848
    v_mfma_f32_32x32x16_bf16 v[96:111], a[52:55], v[180:183], v[96:111]
    ds_read_b64 v[168:169], v196 offset:14592
    ds_read_b64 v[170:171], v196 offset:15104
    buffer_load_dwordx4 v75, s[16:19], s99 offen offset:2048 sc1 lds
    s_waitcnt vmcnt(8)
    v_cmp_gt_u32 vcc, 1, v7
    s_nop 0
    s_and_b64 vcc, vcc, s[50:51]
    s_cbranch_scc1 ps_54
pc_56:
    s_barrier
    s_waitcnt lgkmcnt(6)
    v_mfma_f32_16x16x32_bf16 v[112:115], a[56:59], v[184:187], v[112:115]
    v_add_u32_e64 v198, v49, v198
    v_mfma_f32_32x32x16_bf16 v[80:95], a[56:59], v[188:191], v[80:95]
    v_add_u32 v196, 19584, v196
    ds_read_b64 v[172:173], v198 offset:0
    ds_read_b64 v[174:175], v198 offset:64
    ds_read_b64 v[176:177], v196 offset:0
    v_mfma_f32_32x32x16_bf16 v[96:111], a[56:59], v[192:195], v[96:111]
    ds_read_b64 v[178:179], v196 offset:512
    ds_read_b64 v[180:181], v196 offset:256
    ds_read_b64 v[182:183], v196 offset:768
    buffer_load_dwordx4 v76, s[16:19], s99 offen offset:3072 sc1 lds
    s_waitcnt lgkmcnt(6)
    v_mfma_f32_16x16x32_bf16 v[112:115], a[60:63], v[160:163], v[112:115]
    ds_read_b64 v[184:185], v198 offset:256
    v_mfma_f32_32x32x16_bf16 v[80:95], a[60:63], v[164:167], v[80:95]
    ds_read_b64 v[186:187], v198 offset:320
    ds_read_b64 v[188:189], v196 offset:2048
    ds_read_b64 v[190:191], v196 offset:2560
    v_mfma_f32_32x32x16_bf16 v[96:111], a[60:63], v[168:171], v[96:111]
    ds_read_b64 v[192:193], v196 offset:2304
    ds_read_b64 v[194:195], v196 offset:2816
    s_add_u32 m0, s93, 132096
    s_add_u32 s99, s99, 524288
    s_mov_b64 exec, s[80:81]
    buffer_load_dwordx4 v77, s[16:19], s100 offen sc1 lds
    s_mov_b64 exec, -1
    s_add_u32 s100, s100, 524288
    s_waitcnt lgkmcnt(6)
    v_mfma_f32_16x16x32_bf16 v[112:115], a[64:67], v[172:175], v[112:115]
    ds_read_b64 v[160:161], v198 offset:512
    v_mfma_f32_32x32x16_bf16 v[80:95], a[64:67], v[176:179], v[80:95]
    ds_read_b64 v[162:163], v198 offset:576
    ds_read_b64 v[164:165], v196 offset:4096
    ds_read_b64 v[166:167], v196 offset:4608
    v_mfma_f32_32x32x16_bf16 v[96:111], a[64:67], v[180:183], v[96:111]
    ds_read_b64 v[168:169], v196 offset:4352
    ds_read_b64 v[170:171], v196 offset:4864
    s_lshl_b32 s25, s72, 5
    s_add_u32 s25, s25, 256
    s_sub_u32 s26, s25, 4
    s_max_i32 s26, s26, 0
    s_lshl_b32 s27, s71, 12
    s_add_u32 s27, s27, 9437184
    s_lshl_b32 s99, s25, 3
    s_lshl_b32 s100, s26, 3
    s_lshl_b32 s92, s24, 12
    s_lshl_b32 s93, s24, 9
    s_add_u32 s99, s99, s27
    s_add_u32 s100, s100, s27
    s_waitcnt lgkmcnt(6)
    v_mfma_f32_16x16x32_bf16 v[112:115], a[68:71], v[184:187], v[112:115]
    ds_read_b64 v[172:173], v198 offset:768
    v_mfma_f32_32x32x16_bf16 v[80:95], a[68:71], v[188:191], v[80:95]
    ds_read_b64 v[174:175], v198 offset:832
    ds_read_b64 v[176:177], v196 offset:6144
    ds_read_b64 v[178:179], v196 offset:6656
    v_mfma_f32_32x32x16_bf16 v[96:111], a[68:71], v[192:195], v[96:111]
    ds_read_b64 v[180:181], v196 offset:6400
    ds_read_b64 v[182:183], v196 offset:6912
    s_waitcnt lgkmcnt(6)
    v_mfma_f32_16x16x32_bf16 v[112:115], a[72:75], v[160:163], v[112:115]
    ds_read_b64 v[184:185], v198 offset:1024
    v_mfma_f32_32x32x16_bf16 v[80:95], a[72:75], v[164:167], v[80:95]
    ds_read_b64 v[186:187], v198 offset:1088
    ds_read_b64 v[188:189], v196 offset:8192
    ds_read_b64 v[190:191], v196 offset:8704
    v_mfma_f32_32x32x16_bf16 v[96:111], a[72:75], v[168:171], v[96:111]
    ds_read_b64 v[192:193], v196 offset:8448
    ds_read_b64 v[194:195], v196 offset:8960
    s_waitcnt lgkmcnt(6)
    v_mfma_f32_16x16x32_bf16 v[112:115], a[76:79], v[172:175], v[112:115]
    ds_read_b64 v[160:161], v198 offset:1280
    v_mfma_f32_32x32x16_bf16 v[80:95], a[76:79], v[176:179], v[80:95]
    ds_read_b64 v[162:163], v198 offset:1344
    ds_read_b64 v[164:165], v196 offset:10240
    ds_read_b64 v[166:167], v196 offset:10752
    v_mfma_f32_32x32x16_bf16 v[96:111], a[76:79], v[180:183], v[96:111]
    ds_read_b64 v[168:169], v196 offset:10496
    ds_read_b64 v[170:171], v196 offset:11008
    s_waitcnt lgkmcnt(6)
    v_mfma_f32_16x16x32_bf16 v[112:115], a[80:83], v[184:187], v[112:115]
    ds_read_b64 v[172:173], v198 offset:1536
    v_mfma_f32_32x32x16_bf16 v[80:95], a[80:83], v[188:191], v[80:95]
    ds_read_b64 v[174:175], v198 offset:1600
    ds_read_b64 v[176:177], v196 offset:12288
    ds_read_b64 v[178:179], v196 offset:12800
    v_mfma_f32_32x32x16_bf16 v[96:111], a[80:83], v[192:195], v[96:111]
    ds_read_b64 v[180:181], v196 offset:12544
    ds_read_b64 v[182:183], v196 offset:13056
    s_lshl_b32 s98, s72, 5
    s_add_u32 s98, s98, 0
    s_sub_u32 s95, s98, 4
    s_max_i32 s95, s95, 0
    s_lshl_b32 s94, s98, 3
    s_lshl_b32 s95, s95, 3
    s_add_u32 s94, s94, 3457024
    s_add_u32 s95, s95, 3457024
    s_add_u32 s96, s94, 8192
    buffer_load_dwordx2 v[152:153], v47, s[16:19], s94 offen sc1
    s_waitcnt lgkmcnt(6)
    v_mfma_f32_16x16x32_bf16 v[112:115], a[84:87], v[160:163], v[112:115]
    ds_read_b64 v[184:185], v198 offset:1792
    v_mfma_f32_32x32x16_bf16 v[80:95], a[84:87], v[164:167], v[80:95]
    ds_read_b64 v[186:187], v198 offset:1856
    ds_read_b64 v[188:189], v196 offset:14336
    ds_read_b64 v[190:191], v196 offset:14848
    v_mfma_f32_32x32x16_bf16 v[96:111], a[84:87], v[168:171], v[96:111]
    ds_read_b64 v[192:193], v196 offset:14592
    ds_read_b64 v[194:195], v196 offset:15104
    buffer_load_dwordx2 v[154:155], v47, s[16:19], s96 offen sc1
    s_waitcnt vmcnt(7)
    s_barrier
    s_waitcnt lgkmcnt(6)
    v_mfma_f32_16x16x32_bf16 v[112:115], a[88:91], v[172:175], v[112:115]
    v_add_u32_e64 v198, v49, v198
    v_mfma_f32_32x32x16_bf16 v[80:95], a[88:91], v[176:179], v[80:95]
    v_add_u32 v196, 19584, v196
    ds_read_b64 v[160:161], v198 offset:0
    ds_read_b64 v[162:163], v198 offset:64
    ds_read_b64 v[164:165], v196 offset:0
    v_mfma_f32_32x32x16_bf16 v[96:111], a[88:91], v[180:183], v[96:111]
    ds_read_b64 v[166:167], v196 offset:512
    ds_read_b64 v[168:169], v196 offset:256
    ds_read_b64 v[170:171], v196 offset:768
    buffer_load_dwordx2 v[156:157], v48, s[16:19], s95 offen sc1
    s_waitcnt lgkmcnt(6)
    v_mfma_f32_16x16x32_bf16 v[112:115], a[92:95], v[184:187], v[112:115]
    ds_read_b64 v[172:173], v198 offset:256
    v_mfma_f32_32x32x16_bf16 v[80:95], a[92:95], v[188:191], v[80:95]
    ds_read_b64 v[174:175], v198 offset:320
    ds_read_b64 v[176:177], v196 offset:2048
    ds_read_b64 v[178:179], v196 offset:2560
    v_mfma_f32_32x32x16_bf16 v[96:111], a[92:95], v[192:195], v[96:111]
    ds_read_b64 v[180:181], v196 offset:2304
    ds_read_b64 v[182:183], v196 offset:2816
    buffer_load_dword v7, v4, s[16:19], s89 offen offset:4 sc1
    s_waitcnt lgkmcnt(6)
    v_mfma_f32_16x16x32_bf16 v[112:115], a[96:99], v[160:163], v[112:115]
    ds_read_b64 v[184:185], v198 offset:512
    v_mfma_f32_32x32x16_bf16 v[80:95], a[96:99], v[164:167], v[80:95]
    ds_read_b64 v[186:187], v198 offset:576
    ds_read_b64 v[188:189], v196 offset:4096
    ds_read_b64 v[190:191], v196 offset:4608
    v_mfma_f32_32x32x16_bf16 v[96:111], a[96:99], v[168:171], v[96:111]
    ds_read_b64 v[192:193], v196 offset:4352
    ds_read_b64 v[194:195], v196 offset:4864
    s_waitcnt lgkmcnt(6)
    v_mfma_f32_16x16x32_bf16 v[112:115], a[100:103], v[172:175], v[112:115]
    ds_read_b64 v[160:161], v198 offset:768
    v_mfma_f32_32x32x16_bf16 v[80:95], a[100:103], v[176:179], v[80:95]
    ds_read_b64 v[162:163], v198 offset:832
    ds_read_b64 v[164:165], v196 offset:6144
    ds_read_b64 v[166:167], v196 offset:6656
    v_mfma_f32_32x32x16_bf16 v[96:111], a[100:103], v[180:183], v[96:111]
    ds_read_b64 v[168:169], v196 offset:6400
    ds_read_b64 v[170:171], v196 offset:6912
    s_waitcnt lgkmcnt(6)
    v_mfma_f32_16x16x32_bf16 v[112:115], a[104:107], v[184:187], v[112:115]
    ds_read_b64 v[172:173], v198 offset:1024
    v_mfma_f32_32x32x16_bf16 v[80:95], a[104:107], v[188:191], v[80:95]
    ds_read_b64 v[174:175], v198 offset:1088
    ds_read_b64 v[176:177], v196 offset:8192
    ds_read_b64 v[178:179], v196 offset:8704
    v_mfma_f32_32x32x16_bf16 v[96:111], a[104:107], v[192:195], v[96:111]
    ds_read_b64 v[180:181], v196 offset:8448
    ds_read_b64 v[182:183], v196 offset:8960
    s_waitcnt lgkmcnt(6)
    v_mfma_f32_16x16x32_bf16 v[112:115], a[108:111], v[160:163], v[112:115]
    ds_read_b64 v[184:185], v198 offset:1280
    v_mfma_f32_32x32x16_bf16 v[80:95], a[108:111], v[164:167], v[80:95]
    ds_read_b64 v[186:187], v198 offset:1344
    ds_read_b64 v[188:189], v196 offset:10240
    ds_read_b64 v[190:191], v196 offset:10752
    v_mfma_f32_32x32x16_bf16 v[96:111], a[108:111], v[168:171], v[96:111]
    ds_read_b64 v[192:193], v196 offset:10496
    ds_read_b64 v[194:195], v196 offset:11008
    s_waitcnt lgkmcnt(6)
    v_mfma_f32_16x16x32_bf16 v[112:115], a[112:115], v[172:175], v[112:115]
    ds_read_b64 v[160:161], v198 offset:1536
    v_mfma_f32_32x32x16_bf16 v[80:95], a[112:115], v[176:179], v[80:95]
    ds_read_b64 v[162:163], v198 offset:1600
    ds_read_b64 v[164:165], v196 offset:12288
    ds_read_b64 v[166:167], v196 offset:12800
    v_mfma_f32_32x32x16_bf16 v[96:111], a[112:115], v[180:183], v[96:111]
    ds_read_b64 v[168:169], v196 offset:12544
    ds_read_b64 v[170:171], v196 offset:13056
    s_waitcnt lgkmcnt(6)
    v_mfma_f32_16x16x32_bf16 v[112:115], a[116:119], v[184:187], v[112:115]
    ds_read_b64 v[172:173], v198 offset:1792
    v_mfma_f32_32x32x16_bf16 v[80:95], a[116:119], v[188:191], v[80:95]
    ds_read_b64 v[174:175], v198 offset:1856
    ds_read_b64 v[176:177], v196 offset:14336
    ds_read_b64 v[178:179], v196 offset:14848
    v_mfma_f32_32x32x16_bf16 v[96:111], a[116:119], v[192:195], v[96:111]
    ds_read_b64 v[180:181], v196 offset:14592
    ds_read_b64 v[182:183], v196 offset:15104
sl_57:
    s_waitcnt vmcnt(2)
    v_max3_u32 v2, v152, v153, v154
    s_waitcnt vmcnt(1)
    v_max3_u32 v2, v2, v155, v156
    v_max_u32 v2, v2, v157
    v_cmp_eq_u32 vcc, -1, v2
    s_nop 0
    s_cbranch_vccnz rd_58
rc_59:
    s_waitcnt vmcnt(0)
    v_cmp_gt_u32 vcc, 1, v7
    s_nop 0
    s_and_b64 vcc, vcc, s[50:51]
    s_cbranch_scc1 ps_60
pc_62:
    s_barrier
    s_waitcnt lgkmcnt(6)
    v_mfma_f32_16x16x32_bf16 v[112:115], a[120:123], v[160:163], v[112:115]
    v_add_u32_e64 v198, v49, v198
    v_mfma_f32_32x32x16_bf16 v[80:95], a[120:123], v[164:167], v[80:95]
    v_add_u32 v196, 19584, v196
    ds_read_b64 v[184:185], v198 offset:0
    ds_read_b64 v[186:187], v198 offset:64
    v_mul_f32 v148, v24, v157
    v_mul_f32 v149, v25, v157
    v_mfma_f32_32x32x16_bf16 v[96:111], a[120:123], v[168:171], v[96:111]
    ds_read_b64 v[188:189], v196 offset:0
    ds_read_b64 v[190:191], v196 offset:512
    s_sub_u32 s3, s2, 160
    s_and_b32 s3, s3, 63
    s_add_u32 s3, s3, 64
    s_and_b32 s25, s3, 3
    s_lshl_b32 s25, s25, 12
    s_lshr_b32 s26, s3, 2
    s_lshl_b32 s26, s26, 7
    s_add_u32 s3, s25, s26
    v_lshrrev_b32 v236, 3, v0
    v_and_b32 v237, 7, v0
    v_lshlrev_b32 v237, 4, v237
    v_lshl_add_u32 v236, v236, 14, v237
    s_sub_u32 s25, s2, 160
    s_cmp_lt_u32 s25, 64
    s_cselect_b32 s25, 0, 1073741824
    v_add_u32_e64 v236, s25, v236
    s_add_u32 s26, s3, 9437184
    buffer_load_dwordx4 v[216:219], v236, s[16:19], s26 offen sc1
    v_mul_f32 v150, v26, v157
    v_mul_f32_e64 v151, v27, v157
    s_waitcnt lgkmcnt(4)
    v_mfma_f32_16x16x32_bf16 v[112:115], a[124:127], v[172:175], v[112:115]
    ds_read_b64 v[192:193], v198 offset:256
    v_mfma_f32_32x32x16_bf16 v[80:95], a[124:127], v[176:179], v[80:95]
    ds_read_b64 v[194:195], v198 offset:320
    ds_read_b64 v[160:161], v196 offset:2048
    v_mul_f32 v116, v8, v153
    v_mul_f32 v117, v9, v153
    v_mul_f32_e64 v118, v10, v153
    v_mfma_f32_32x32x16_bf16 v[96:111], a[124:127], v[180:183], v[96:111]
    ds_read_b64 v[162:163], v196 offset:2560
    s_add_u32 s26, s26, 524288
    buffer_load_dwordx4 v[220:223], v236, s[16:19], s26 offen sc1
    v_mul_f32 v119, v11, v153
    v_mul_f32_e64 v120, v12, v153
    s_waitcnt lgkmcnt(4)
    v_mfma_f32_16x16x32_bf16 v[112:115], a[128:131], v[184:187], v[112:115]
    ds_read_b64 v[164:165], v198 offset:512
    v_mfma_f32_32x32x16_bf16 v[80:95], a[128:131], v[188:191], v[80:95]
    ds_read_b64 v[166:167], v198 offset:576
    ds_read_b64 v[168:169], v196 offset:4096
    ds_read_b64 v[170:171], v196 offset:4608
    v_mul_f32 v121, v13, v153
    v_mul_f32_e64 v122, v14, v153
    s_waitcnt lgkmcnt(4)
    v_mfma_f32_16x16x32_bf16 v[112:115], a[132:135], v[192:195], v[112:115]
    ds_read_b64 v[172:173], v198 offset:768
    v_mfma_f32_32x32x16_bf16 v[80:95], a[132:135], v[160:163], v[80:95]
    ds_read_b64 v[174:175], v198 offset:832
    ds_read_b64 v[176:177], v196 offset:6144
    ds_read_b64 v[178:179], v196 offset:6656
    s_add_u32 s26, s26, 524288
    buffer_load_dwordx4 v[224:227], v236, s[16:19], s26 offen sc1
    v_mul_f32 v123, v15, v153
    v_mul_f32_e64 v124, v16, v153
    s_waitcnt lgkmcnt(4)
    v_mfma_f32_16x16x32_bf16 v[112:115], a[136:139], v[164:167], v[112:115]
    ds_read_b64 v[180:181], v198 offset:1024
    v_mfma_f32_32x32x16_bf16 v[80:95], a[136:139], v[168:171], v[80:95]
    ds_read_b64 v[182:183], v198 offset:1088
    ds_read_b64 v[184:185], v196 offset:8192
    ds_read_b64 v[186:187], v196 offset:8704
    v_mul_f32 v125, v17, v153
    v_mul_f32_e64 v126, v18, v153
    s_waitcnt lgkmcnt(4)
    v_mfma_f32_16x16x32_bf16 v[112:115], a[140:143], v[172:175], v[112:115]
    ds_read_b64 v[188:189], v198 offset:1280
    v_mfma_f32_32x32x16_bf16 v[80:95], a[140:143], v[176:179], v[80:95]
    ds_read_b64 v[190:191], v198 offset:1344
    ds_read_b64 v[192:193], v196 offset:10240
    ds_read_b64 v[194:195], v196 offset:10752
    s_add_u32 s26, s26, 524288
    buffer_load_dwordx4 v[228:231], v236, s[16:19], s26 offen sc1
    v_mul_f32 v127, v19, v153
    v_mul_f32_e64 v128, v20, v153
    s_waitcnt lgkmcnt(4)
    v_mfma_f32_16x16x32_bf16 v[112:115], a[144:147], v[180:183], v[112:115]
    ds_read_b64 v[160:161], v198 offset:1536
    v_mfma_f32_32x32x16_bf16 v[80:95], a[144:147], v[184:187], v[80:95]
    ds_read_b64 v[162:163], v198 offset:1600
    ds_read_b64 v[164:165], v196 offset:12288
    ds_read_b64 v[166:167], v196 offset:12800
    v_mul_f32 v129, v21, v153
    v_mul_f32_e64 v130, v22, v153
    s_waitcnt lgkmcnt(4)
    v_mfma_f32_16x16x32_bf16 v[112:115], a[148:151], v[188:191], v[112:115]
    ds_read_b64 v[168:169], v198 offset:1792
    v_mfma_f32_32x32x16_bf16 v[80:95], a[148:151], v[192:195], v[80:95]
    ds_read_b64 v[170:171], v198 offset:1856
    ds_read_b64 v[172:173], v196 offset:14336
    ds_read_b64 v[174:175], v196 offset:14848
    s_add_u32 s26, s26, 524288
    buffer_load_dwordx4 v[232:235], v236, s[16:19], s26 offen sc1
    v_mul_f32 v131, v23, v153
    v_mul_f32_e64 v132, v8, v155
    s_waitcnt lgkmcnt(4)
    v_mfma_f32_16x16x32_bf16 v[112:115], a[152:155], v[160:163], v[112:115]
    ds_read_b64 v[176:177], v196 offset:256
    v_mfma_f32_32x32x16_bf16 v[80:95], a[152:155], v[164:167], v[80:95]
    ds_read_b64 v[178:179], v196 offset:768
    ds_read_b64 v[180:181], v196 offset:2304
    ds_read_b64 v[182:183], v196 offset:2816
    v_mul_f32 v133, v9, v155
    v_mul_f32_e64 v134, v10, v155
    s_waitcnt lgkmcnt(4)
    v_mfma_f32_16x16x32_bf16 v[112:115], a[156:159], v[168:171], v[112:115]
    ds_read_b64 v[184:185], v196 offset:4352
    v_mfma_f32_32x32x16_bf16 v[80:95], a[156:159], v[172:175], v[80:95]
    ds_read_b64 v[186:187], v196 offset:4864
    ds_read_b64 v[188:189], v196 offset:6400
    ds_read_b64 v[190:191], v196 offset:6912
    s_add_u32 m0, s92, 36352
    s_nop 0
    buffer_load_dwordx4 v73, s[16:19], s99 offen offset:0 sc1 lds
    v_mul_f32 v135, v11, v155
    v_mul_f32 v136, v12, v155
    v_mul_f32 v137, v13, v155
    v_mul_f32 v138, v14, v155
    v_mul_f32 v139, v15, v155
    v_mul_f32 v140, v16, v155
    v_mul_f32 v141, v17, v155
    v_mul_f32 v142, v18, v155
    v_mul_f32 v143, v19, v155
    v_mul_f32 v144, v20, v155
    v_mul_f32 v145, v21, v155
    v_mul_f32 v146, v22, v155
    v_mul_f32_e64 v147, v23, v155
    s_waitcnt lgkmcnt(4)
    v_mfma_f32_32x32x16_bf16 v[96:111], a[128:131], v[176:179], v[96:111]
    ds_read_b64 v[192:193], v196 offset:8448
    ds_read_b64 v[194:195], v196 offset:8960
    v_mfma_f32_32x32x16_bf16 v[96:111], a[132:135], v[180:183], v[96:111]
    ds_read_b64 v[160:161], v196 offset:10496
    ds_read_b64 v[162:163], v196 offset:11008
    buffer_load_dwordx4 v74, s[16:19], s99 offen offset:1024 sc1 lds
    v_fma_f32 v112, v112, v156, v148
    v_fma_f32 v113, v113, v156, v149
    s_waitcnt lgkmcnt(4)
    v_mfma_f32_32x32x16_bf16 v[96:111], a[136:139], v[184:187], v[96:111]
    ds_read_b64 v[164:165], v196 offset:12544
    ds_read_b64 v[166:167], v196 offset:13056
    v_fma_f32 v114, v114, v156, v150
    v_fma_f32 v115, v115, v156, v151
    v_cvt_pk_bf16_f32 v112, v112, v113
    v_mfma_f32_32x32x16_bf16 v[96:111], a[140:143], v[188:191], v[96:111]
    ds_read_b64 v[168:169], v196 offset:14592
    ds_read_b64 v[170:171], v196 offset:15104
    buffer_load_dwordx4 v75, s[16:19], s99 offen offset:2048 sc1 lds
    v_cvt_pk_bf16_f32 v113, v114, v115
    v_fma_f32 v80, v80, v152, v116
    s_waitcnt lgkmcnt(4)
    v_mfma_f32_32x32x16_bf16 v[96:111], a[144:147], v[192:195], v[96:111]
    v_fma_f32 v81, v81, v152, v117
    v_fma_f32 v82, v82, v152, v118
    v_fma_f32 v83, v83, v152, v119
    v_cvt_pk_bf16_f32 v80, v80, v81
    v_cvt_pk_bf16_f32 v81, v82, v83
    v_mfma_f32_32x32x16_bf16 v[96:111], a[148:151], v[160:163], v[96:111]
    ds_write_b64 v40, v[112:113] offset:0
    ds_write_b64 v38, v[80:81] offset:0
    v_fma_f32 v84, v84, v152, v120
    v_fma_f32 v85, v85, v152, v121
    s_waitcnt lgkmcnt(2)
    v_mfma_f32_32x32x16_bf16 v[96:111], a[152:155], v[164:167], v[96:111]
    v_fma_f32 v86, v86, v152, v122
    v_fma_f32 v87, v87, v152, v123
    v_cvt_pk_bf16_f32 v84, v84, v85
    v_cvt_pk_bf16_f32 v85, v86, v87
    v_fma_f32 v88, v88, v152, v124
    v_mfma_f32_32x32x16_bf16 v[96:111], a[156:159], v[168:171], v[96:111]
    buffer_load_dwordx4 v76, s[16:19], s99 offen offset:3072 sc1 lds
    v_fma_f32 v89, v89, v152, v125
    v_fma_f32 v90, v90, v152, v126
    v_fma_f32 v91, v91, v152, v127
    v_cvt_pk_bf16_f32 v88, v88, v89
    v_cvt_pk_bf16_f32 v89, v90, v91
    ds_write_b64 v38, v[84:85] offset:6400
    ds_write_b64 v38, v[88:89] offset:12800
    v_fma_f32 v92, v92, v152, v128
    v_fma_f32 v93, v93, v152, v129
    v_fma_f32 v94, v94, v152, v130
    v_fma_f32 v95, v95, v152, v131
    v_cvt_pk_bf16_f32 v92, v92, v93
    v_cvt_pk_bf16_f32 v93, v94, v95
    ds_write_b64 v39, v[92:93] offset:0
    v_pk_fma_f32 v[96:97], v[96:97], v[154:155], v[132:133] op_sel_hi:[1,0,1]
    v_pk_fma_f32 v[98:99], v[98:99], v[154:155], v[134:135] op_sel_hi:[1,0,1]
    v_cvt_pk_bf16_f32 v96, v96, v97
    v_cvt_pk_bf16_f32 v97, v98, v99
    v_pk_fma_f32 v[100:101], v[100:101], v[154:155], v[136:137] op_sel_hi:[1,0,1]
    v_pk_fma_f32 v[102:103], v[102:103], v[154:155], v[138:139] op_sel_hi:[1,0,1]
    v_cvt_pk_bf16_f32 v100, v100, v101
    v_cvt_pk_bf16_f32 v101, v102, v103
    ds_write_b64 v38, v[96:97] offset:1600
    ds_write_b64 v38, v[100:101] offset:8000
    v_pk_fma_f32 v[104:105], v[104:105], v[154:155], v[140:141] op_sel_hi:[1,0,1]
    v_pk_fma_f32 v[106:107], v[106:107], v[154:155], v[142:143] op_sel_hi:[1,0,1]
    v_cvt_pk_bf16_f32 v104, v104, v105
    v_cvt_pk_bf16_f32 v105, v106, v107
    v_pk_fma_f32 v[108:109], v[108:109], v[154:155], v[144:145] op_sel_hi:[1,0,1]
    v_pk_fma_f32 v[110:111], v[110:111], v[154:155], v[146:147] op_sel_hi:[1,0,1]
    v_cvt_pk_bf16_f32 v108, v108, v109
    v_cvt_pk_bf16_f32 v109, v110, v111
    ds_write_b64 v38, v[104:105] offset:14400
    ds_write_b64 v39, v[108:109] offset:1600
    v_cmp_u_f32 vcc, v82, v114
    v_cmp_u_f32 s[82:83], v98, v98
    s_lshl_b32 s25, s24, 2
    s_add_u32 s25, s25, 160256
    s_or_b64 vcc, vcc, s[82:83]
    s_cselect_b32 s26, 1, 0
    v_mov_b32 v196, s25
    v_mov_b32 v197, s26
    ds_write_b32 v196, v197
    s_waitcnt lgkmcnt(0)
    s_barrier
    s_sub_u32 s85, s2, 160
    s_cmp_ge_u32 s85, 64
    s_cbranch_scc1 s2_63
    v_mov_b32 v238, 0x3f803f80
    s_lshl_b32 s25, s24, 7
    s_add_u32 s25, s25, 134272
    v_lshrrev_b32 v239, 4, v1
    v_lshl_add_u32 v237, v239, 2, v237
    v_add_u32 v237, s25, v237
se_64:
    v_mov_b32 v240, 0
    v_mov_b32 v241, 0
    v_mov_b32 v242, 0
    v_mov_b32 v243, 0
    s_waitcnt vmcnt(8)
    v_dot2c_f32_bf16 v240, v216, v238
    v_dot2c_f32_bf16 v241, v216, v216
    v_dot2c_f32_bf16 v240, v217, v238
    v_dot2c_f32_bf16 v241, v217, v217
    v_dot2c_f32_bf16 v242, v218, v238
    v_dot2c_f32_bf16 v243, v218, v218
    v_dot2c_f32_bf16 v242, v219, v238
    v_dot2c_f32_bf16 v243, v219, v219
    s_waitcnt vmcnt(7)
    v_dot2c_f32_bf16 v240, v220, v238
    v_dot2c_f32_bf16 v241, v220, v220
    v_dot2c_f32_bf16 v240, v221, v238
    v_dot2c_f32_bf16 v241, v221, v221
    v_dot2c_f32_bf16 v242, v222, v238
    v_dot2c_f32_bf16 v243, v222, v222
    v_dot2c_f32_bf16 v242, v223, v238
    v_dot2c_f32_bf16 v243, v223, v223
    s_waitcnt vmcnt(6)
    v_dot2c_f32_bf16 v240, v224, v238
    v_dot2c_f32_bf16 v241, v224, v224
    v_dot2c_f32_bf16 v240, v225, v238
    v_dot2c_f32_bf16 v241, v225, v225
    v_dot2c_f32_bf16 v242, v226, v238
    v_dot2c_f32_bf16 v243, v226, v226
    v_dot2c_f32_bf16 v242, v227, v238
    v_dot2c_f32_bf16 v243, v227, v227
    s_waitcnt vmcnt(5)
    v_dot2c_f32_bf16 v240, v228, v238
    v_dot2c_f32_bf16 v241, v228, v228
    v_dot2c_f32_bf16 v240, v229, v238
    v_dot2c_f32_bf16 v241, v229, v229
    v_dot2c_f32_bf16 v242, v230, v238
    v_dot2c_f32_bf16 v243, v230, v230
    v_dot2c_f32_bf16 v242, v231, v238
    v_dot2c_f32_bf16 v243, v231, v231
    s_waitcnt vmcnt(4)
    v_dot2c_f32_bf16 v240, v232, v238
    v_dot2c_f32_bf16 v241, v232, v232
    v_dot2c_f32_bf16 v240, v233, v238
    v_dot2c_f32_bf16 v241, v233, v233
    v_dot2c_f32_bf16 v242, v234, v238
    v_dot2c_f32_bf16 v243, v234, v234
    v_dot2c_f32_bf16 v242, v235, v238
    v_dot2c_f32_bf16 v243, v235, v235
    s_nop 2
    v_cmp_u_f32 vcc, v241, v243
    s_nop 0
    s_cbranch_vccnz rd_65
rc_66:
    v_permlane32_swap_b32 v240, v242
    v_permlane32_swap_b32 v241, v243
    v_pk_add_f32 v[240:241], v[240:241], v[242:243]
    s_nop 1
    v_permlane16_swap_b32 v240, v241
    v_add_f32_e64 v240, v240, v241
    s_nop 1
    v_add_f32_dpp v240, v240, v240 row_ror:8 row_mask:0xf bank_mask:0xf
    ds_write_b32 v237, v240
    v_and_b32 v236, 15, v0
    v_lshlrev_b32 v236, 3, v236
    v_add_u32 v237, 134272, v236
    v_mov_b32 v239, 1073741824
    v_cmp_gt_u32 vcc, 16, v0
    s_nop 1
    v_cndmask_b32 v236, v239, v236, vcc
    s_add_u32 s25, s3, 3457024
    s_waitcnt lgkmcnt(0)
    s_barrier
    ds_read_b64 v[216:217], v237 offset:0
    ds_read_b64 v[218:219], v237 offset:128
    ds_read_b64 v[220:221], v237 offset:256
    ds_read_b64 v[222:223], v237 offset:384
    s_waitcnt lgkmcnt(2)
    v_pk_add_f32 v[216:217], v[216:217], v[218:219]
    s_waitcnt lgkmcnt(0)
    v_pk_add_f32 v[220:221], v[220:221], v[222:223]
    v_pk_add_f32 v[216:217], v[216:217], v[220:221]
    v_mul_f32 v239, 0x3acccccd, v216
    v_mul_f32 v217, 0x3acccccd, v217
    v_fma_f32 v217, -v239, v239, v217
    v_max_f32 v217, 0, v217
    v_add_f32 v217, 0x3727c5ac, v217
    v_rsq_f32_e64 v216, v217
    s_nop 0
    v_mul_f32 v217, -v239, v216
    buffer_store_dwordx2 v[216:217], v236, s[16:19], s25 offen sc1
s2_63:
    v_mov_b32 v158, 160256
    ds_read_b128 v[128:131], v158
    v_mov_b32 v94, 0
    v_mov_b32 v95, 0
    v_mov_b32 v98, 0
    v_mov_b32 v99, 0
    s_mov_b64 exec, 0xffff
    ds_read_b64 v[94:95], v42 offset:320
    ds_read_b64 v[98:99], v42 offset:640
    s_mov_b64 exec, -1
    s_nop 0
    ds_read_b64 v[92:93], v41 offset:320
    ds_read_b64 v[96:97], v41 offset:640
    ds_read_b64 v[84:85], v41 offset:6720
    ds_read_b64 v[86:87], v42 offset:6720
    ds_read_b64 v[80:81], v41 offset:6400
    ds_read_b64 v[82:83], v42 offset:6400
    ds_read_b64 v[88:89], v41 offset:7040
    ds_read_b64 v[90:91], v42 offset:7040
    ds_read_b64_tr_b16 v[106:107], v44 offset:0
    ds_read_b64_tr_b16 v[100:101], v43 offset:0
    s_add_u32 m0, s93, 53760
    s_add_u32 s99, s99, 524288
    s_mov_b64 exec, s[80:81]
    buffer_load_dwordx4 v77, s[16:19], s100 offen sc1 lds
    s_mov_b64 exec, -1
    s_add_u32 s100, s100, 524288
    ds_read_b64_tr_b16 v[108:109], v44 offset:320
    ds_read_b64_tr_b16 v[102:103], v43 offset:320
    ds_read_b64_tr_b16 v[110:111], v44 offset:640
    ds_read_b64_tr_b16 v[104:105], v43 offset:640
    v_mov_b32 v156, 0xf149f2ca
    v_cndmask_b32 v152, v32, v156, s[90:91]
    v_cndmask_b32 v153, v33, v156, s[90:91]
    v_cndmask_b32 v154, v34, v156, s[90:91]
    s_add_u32 m0, s92, 55936
    s_nop 0
    buffer_load_dwordx4 v73, s[16:19], s99 offen offset:0 sc1 lds
    v_cndmask_b32 v155, v35, v156, s[90:91]
    s_mov_b32 s82, 0x3ea52b5c
    s_lshl_b32 s25, s98, 4
    s_add_u32 s25, s25, 12058624
    s_lshl_b32 s26, s98, 3
    s_add_u32 s26, s26, 12058624
    s_waitcnt lgkmcnt(15)
    v_or3_b32 v128, v128, v129, v130
    v_or_b32 v128, v128, v131
    buffer_load_dwordx4 v74, s[16:19], s99 offen offset:1024 sc1 lds
    v_cmp_ne_u32_e64 vcc, 0, v128
    s_nop 0
    s_cbranch_vccnz rd_67
rc_68:
    s_waitcnt lgkmcnt(10)
    v_mfma_f32_16x16x32_bf16 v[116:119], v[84:87], v[92:95], v[28:31]
    v_mfma_f32_16x16x32_bf16 v[120:123], v[84:87], v[96:99], v[32:35]
    s_waitcnt lgkmcnt(8)
    v_mfma_f32_16x16x32_bf16 v[112:115], v[80:83], v[92:95], v[152:155]
    s_waitcnt lgkmcnt(6)
    v_mfma_f32_16x16x32_bf16 v[124:127], v[88:91], v[96:99], v[28:31]
    s_nop 5
    v_max_f32 v112, v112, v116
    v_max_f32 v113, v113, v117
    v_max_f32 v114, v114, v118
    buffer_load_dwordx4 v75, s[16:19], s99 offen offset:2048 sc1 lds
    v_max_f32 v115, v115, v119
    v_max3_f32 v156, v112, v113, v114
    v_max_f32 v156, v156, v115
    v_max_f32 v120, v120, v124
    v_max_f32 v121, v121, v125
    v_max_f32 v122, v122, v126
    v_max_f32 v123, v123, v127
    v_max3_f32 v157, v120, v121, v122
    buffer_load_dwordx4 v76, s[16:19], s99 offen offset:3072 sc1 lds
    v_max_f32 v157, v157, v123
    s_nop 1
    v_permlane16_swap_b32 v156, v157
    v_max_f32 v156, v156, v157
    v_mov_b32 v157, v156
    s_nop 1
    v_permlane32_swap_b32 v156, v157
    v_max_f32 v156, v156, v157
    v_mul_f32 v156, s82, v156
    v_mov_b32 v157, v156
    s_add_u32 m0, s93, 73344
    s_add_u32 s99, s99, 524288
    s_mov_b64 exec, s[80:81]
    buffer_load_dwordx4 v77, s[16:19], s100 offen sc1 lds
    s_mov_b64 exec, -1
    s_add_u32 s100, s100, 524288
    v_permlane16_swap_b32_e64 v156, v157
    v_fma_f32 v112, v112, s82, -v156
    v_fma_f32 v113, v113, s82, -v156
    v_fma_f32 v114, v114, s82, -v156
    v_fma_f32 v115, v115, s82, -v156
    v_exp_f32 v112, v112
    v_exp_f32 v113, v113
    v_exp_f32 v114, v114
    s_add_u32 m0, s92, 75520
    s_nop 0
    buffer_load_dwordx4 v73, s[16:19], s99 offen offset:0 sc1 lds
    v_exp_f32_e64 v115, v115
    v_cvt_pk_bf16_f32 v116, v112, v113
    v_cvt_pk_bf16_f32 v117, v114, v115
    v_bfi_b32 v128, v36, 0, v116
    v_and_b32 v130, v36, v116
    v_bfi_b32 v129, v37, 0, v117
    v_and_b32 v131, v37, v117
    s_waitcnt lgkmcnt(3)
    s_nop 0
    v_mfma_f32_16x16x32_bf16 v[144:147], v[106:109], v[128:131], 0
    buffer_load_dwordx4 v74, s[16:19], s99 offen offset:1024 sc1 lds
    s_waitcnt lgkmcnt(2)
    v_mfma_f32_16x16x32_bf16 v[136:139], v[100:103], v[128:131], 0
    v_fma_f32 v120, v120, s82, -v157
    v_fma_f32 v121, v121, s82, -v157
    v_fma_f32 v122, v122, s82, -v157
    v_fma_f32 v123, v123, s82, -v157
    v_exp_f32 v120, v120
    v_exp_f32 v121, v121
    v_exp_f32 v122, v122
    buffer_load_dwordx4 v75, s[16:19], s99 offen offset:2048 sc1 lds
    v_exp_f32_e64 v123, v123
    v_cvt_pk_bf16_f32 v124, v120, v121
    v_cvt_pk_bf16_f32 v125, v122, v123
    v_bfi_b32 v132, v36, 0, v124
    v_and_b32 v134, v36, v124
    v_bfi_b32 v133, v37, 0, v125
    v_and_b32 v135, v37, v125
    s_waitcnt lgkmcnt(1)
    s_nop 0
    v_mfma_f32_16x16x32_bf16 v[148:151], v[108:111], v[132:135], 0
    buffer_load_dwordx4 v76, s[16:19], s99 offen offset:3072 sc1 lds
    s_waitcnt lgkmcnt(0)
    v_mfma_f32_16x16x32_bf16 v[140:143], v[102:105], v[132:135], 0
    v_mov_b32 v158, v144
    s_nop 1
    v_permlane16_swap_b32 v144, v158
    v_rcp_f32 v158, v158
    s_nop 0
    v_pk_mul_f32 v[136:137], v[136:137], v[158:159] op_sel_hi:[1,0]
    v_pk_mul_f32 v[138:139], v[138:139], v[158:159] op_sel_hi:[1,0]
    v_pk_mul_f32 v[144:145], v[144:145], v[158:159] op_sel_hi:[1,0]
    v_pk_mul_f32 v[146:147], v[146:147], v[158:159] op_sel_hi:[1,0]
    s_add_u32 m0, s93, 92928
    s_add_u32 s99, s99, 524288
    s_mov_b64 exec, s[80:81]
    buffer_load_dwordx4 v77, s[16:19], s100 offen sc1 lds
    s_mov_b64 exec, -1
    s_add_u32 s100, s100, 524288
    v_cvt_pk_bf16_f32 v112, v136, v137
    v_cvt_pk_bf16_f32 v116, v144, v145
    v_cvt_pk_bf16_f32 v113, v138, v139
    v_cvt_pk_bf16_f32 v117, v146, v147
    v_mov_b32 v160, v148
    s_nop 1
    v_permlane16_swap_b32 v148, v160
    v_rcp_f32_e64 v160, v160
    s_nop 0
    v_pk_mul_f32 v[140:141], v[140:141], v[160:161] op_sel_hi:[1,0]
    v_pk_mul_f32 v[142:143], v[142:143], v[160:161] op_sel_hi:[1,0]
    v_pk_mul_f32 v[148:149], v[148:149], v[160:161] op_sel_hi:[1,0]
    v_pk_mul_f32 v[150:151], v[150:151], v[160:161] op_sel_hi:[1,0]
    v_cvt_pk_bf16_f32 v114, v140, v141
    v_cvt_pk_bf16_f32 v118, v148, v149
    v_cvt_pk_bf16_f32 v115, v142, v143
    v_cvt_pk_bf16_f32 v119, v150, v151
    v_permlane16_swap_b32 v112, v114
    v_permlane16_swap_b32 v113, v115
    v_permlane16_swap_b32 v116, v118
    v_permlane16_swap_b32 v117, v119
    buffer_store_dwordx4 v[112:115], v45, s[16:19], s25 offen sc1
    s_mov_b64 exec, s[80:81]
    buffer_store_dwordx2 v[116:117], v46, s[16:19], s26 offen sc1
    s_mov_b64 exec, -1
ge_69:
    v_add_u32 v196, 36352, v78
    v_mov_b32_e64 v198, v79
    s_waitcnt vmcnt(12)
    s_barrier
    ds_read_b64 v[160:161], v198 offset:0
    ds_read_b64 v[162:163], v198 offset:64
    ds_read_b64 v[164:165], v196 offset:0
    ds_read_b64 v[166:167], v196 offset:512
    ds_read_b64 v[168:169], v196 offset:256
    ds_read_b64 v[170:171], v196 offset:768
    ds_read_b64 v[172:173], v198 offset:256
    ds_read_b64 v[174:175], v198 offset:320
    ds_read_b64 v[176:177], v196 offset:2048
    ds_read_b64 v[178:179], v196 offset:2560
    ds_read_b64 v[180:181], v196 offset:2304
    ds_read_b64 v[182:183], v196 offset:2816
    s_waitcnt lgkmcnt(6)
    v_mfma_f32_16x16x32_bf16 v[112:115], a[0:3], v[160:163], 0
    ds_read_b64 v[184:185], v198 offset:512
    v_mfma_f32_32x32x16_bf16 v[80:95], a[0:3], v[164:167], 0
    ds_read_b64 v[186:187], v198 offset:576
    ds_read_b64 v[188:189], v196 offset:4096
    ds_read_b64 v[190:191], v196 offset:4608
    v_mfma_f32_32x32x16_bf16 v[96:111], a[0:3], v[168:171], 0
    ds_read_b64 v[192:193], v196 offset:4352
    ds_read_b64 v[194:195], v196 offset:4864
    s_add_u32 m0, s92, 95104
    s_nop 0
    buffer_load_dwordx4 v73, s[16:19], s99 offen offset:0 sc1 lds
    s_waitcnt lgkmcnt(6)
    v_mfma_f32_16x16x32_bf16 v[112:115], a[4:7], v[172:175], v[112:115]
    ds_read_b64 v[160:161], v198 offset:768
    v_mfma_f32_32x32x16_bf16 v[80:95], a[4:7], v[176:179], v[80:95]
    ds_read_b64 v[162:163], v198 offset:832
    ds_read_b64 v[164:165], v196 offset:6144
    ds_read_b64 v[166:167], v196 offset:6656
    v_mfma_f32_32x32x16_bf16 v[96:111], a[4:7], v[180:183], v[96:111]
    ds_read_b64 v[168:169], v196 offset:6400
    ds_read_b64 v[170:171], v196 offset:6912
    buffer_load_dwordx4 v74, s[16:19], s99 offen offset:1024 sc1 lds
    s_waitcnt lgkmcnt(6)
    v_mfma_f32_16x16x32_bf16 v[112:115], a[8:11], v[184:187], v[112:115]
    ds_read_b64 v[172:173], v198 offset:1024
    v_mfma_f32_32x32x16_bf16 v[80:95], a[8:11], v[188:191], v[80:95]
    ds_read_b64 v[174:175], v198 offset:1088
    ds_read_b64 v[176:177], v196 offset:8192
    ds_read_b64 v[178:179], v196 offset:8704
    v_mfma_f32_32x32x16_bf16 v[96:111], a[8:11], v[192:195], v[96:111]
    ds_read_b64 v[180:181], v196 offset:8448
    ds_read_b64 v[182:183], v196 offset:8960
    buffer_load_dwordx4 v75, s[16:19], s99 offen offset:2048 sc1 lds
    s_waitcnt lgkmcnt(6)
    v_mfma_f32_16x16x32_bf16 v[112:115], a[12:15], v[160:163], v[112:115]
    ds_read_b64 v[184:185], v198 offset:1280
    v_mfma_f32_32x32x16_bf16 v[80:95], a[12:15], v[164:167], v[80:95]
    ds_read_b64 v[186:187], v198 offset:1344
    ds_read_b64 v[188:189], v196 offset:10240
    ds_read_b64 v[190:191], v196 offset:10752
    v_mfma_f32_32x32x16_bf16 v[96:111], a[12:15], v[168:171], v[96:111]
    ds_read_b64 v[192:193], v196 offset:10496
    ds_read_b64 v[194:195], v196 offset:11008
    buffer_load_dwordx4 v76, s[16:19], s99 offen offset:3072 sc1 lds
    s_waitcnt lgkmcnt(6)
    v_mfma_f32_16x16x32_bf16 v[112:115], a[16:19], v[172:175], v[112:115]
    ds_read_b64 v[160:161], v198 offset:1536
    v_mfma_f32_32x32x16_bf16 v[80:95], a[16:19], v[176:179], v[80:95]
    ds_read_b64 v[162:163], v198 offset:1600
    ds_read_b64 v[164:165], v196 offset:12288
    ds_read_b64 v[166:167], v196 offset:12800
    v_mfma_f32_32x32x16_bf16 v[96:111], a[16:19], v[180:183], v[96:111]
    ds_read_b64 v[168:169], v196 offset:12544
    ds_read_b64 v[170:171], v196 offset:13056
    s_add_u32 m0, s93, 112512
    s_add_u32 s99, s99, 524288
    s_mov_b64 exec, s[80:81]
    buffer_load_dwordx4 v77, s[16:19], s100 offen sc1 lds
    s_mov_b64 exec, -1
    s_add_u32 s100, s100, 524288
    s_waitcnt lgkmcnt(6)
    v_mfma_f32_16x16x32_bf16 v[112:115], a[20:23], v[184:187], v[112:115]
    ds_read_b64 v[172:173], v198 offset:1792
    v_mfma_f32_32x32x16_bf16 v[80:95], a[20:23], v[188:191], v[80:95]
    ds_read_b64 v[174:175], v198 offset:1856
    ds_read_b64 v[176:177], v196 offset:14336
    ds_read_b64 v[178:179], v196 offset:14848
    v_mfma_f32_32x32x16_bf16 v[96:111], a[20:23], v[192:195], v[96:111]
    ds_read_b64 v[180:181], v196 offset:14592
    ds_read_b64 v[182:183], v196 offset:15104
    s_add_u32 m0, s92, 114688
    s_nop 0
    buffer_load_dwordx4 v73, s[16:19], s99 offen offset:0 sc1 lds
    s_waitcnt vmcnt(13)
    s_barrier
    s_waitcnt lgkmcnt(6)
    v_mfma_f32_16x16x32_bf16 v[112:115], a[24:27], v[160:163], v[112:115]
    v_add_u32 v198, v49, v198
    v_mfma_f32_32x32x16_bf16 v[80:95], a[24:27], v[164:167], v[80:95]
    v_add_u32 v196, 19584, v196
    ds_read_b64 v[184:185], v198 offset:0
    ds_read_b64 v[186:187], v198 offset:64
    ds_read_b64 v[188:189], v196 offset:0
    v_mfma_f32_32x32x16_bf16 v[96:111], a[24:27], v[168:171], v[96:111]
    ds_read_b64 v[190:191], v196 offset:512
    ds_read_b64 v[192:193], v196 offset:256
    ds_read_b64 v[194:195], v196 offset:768
    buffer_load_dwordx4 v74, s[16:19], s99 offen offset:1024 sc1 lds
    s_waitcnt lgkmcnt(6)
    v_mfma_f32_16x16x32_bf16 v[112:115], a[28:31], v[172:175], v[112:115]
    ds_read_b64 v[160:161], v198 offset:256
    v_mfma_f32_32x32x16_bf16 v[80:95], a[28:31], v[176:179], v[80:95]
    ds_read_b64 v[162:163], v198 offset:320
    ds_read_b64 v[164:165], v196 offset:2048
    ds_read_b64 v[166:167], v196 offset:2560
    v_mfma_f32_32x32x16_bf16 v[96:111], a[28:31], v[180:183], v[96:111]
    ds_read_b64 v[168:169], v196 offset:2304
    ds_read_b64 v[170:171], v196 offset:2816
    buffer_load_dwordx4 v75, s[16:19], s99 offen offset:2048 sc1 lds
    s_waitcnt lgkmcnt(6)
    v_mfma_f32_16x16x32_bf16 v[112:115], a[32:35], v[184:187], v[112:115]
    ds_read_b64 v[172:173], v198 offset:512
    v_mfma_f32_32x32x16_bf16 v[80:95], a[32:35], v[188:191], v[80:95]
    ds_read_b64 v[174:175], v198 offset:576
    ds_read_b64 v[176:177], v196 offset:4096
    ds_read_b64 v[178:179], v196 offset:4608
    v_mfma_f32_32x32x16_bf16 v[96:111], a[32:35], v[192:195], v[96:111]
    ds_read_b64 v[180:181], v196 offset:4352
    ds_read_b64 v[182:183], v196 offset:4864
    buffer_load_dwordx4 v76, s[16:19], s99 offen offset:3072 sc1 lds
    s_waitcnt lgkmcnt(6)
    v_mfma_f32_16x16x32_bf16 v[112:115], a[36:39], v[160:163], v[112:115]
    ds_read_b64 v[184:185], v198 offset:768
    v_mfma_f32_32x32x16_bf16 v[80:95], a[36:39], v[164:167], v[80:95]
    ds_read_b64 v[186:187], v198 offset:832
    ds_read_b64 v[188:189], v196 offset:6144
    ds_read_b64 v[190:191], v196 offset:6656
    v_mfma_f32_32x32x16_bf16 v[96:111], a[36:39], v[168:171], v[96:111]
    ds_read_b64 v[192:193], v196 offset:6400
    ds_read_b64 v[194:195], v196 offset:6912
    s_add_u32 m0, s93, 132096
    s_add_u32 s99, s99, 524288
    s_mov_b64 exec, s[80:81]
    buffer_load_dwordx4 v77, s[16:19], s100 offen sc1 lds
    s_mov_b64 exec, -1
    s_add_u32 s100, s100, 524288
    s_waitcnt lgkmcnt(6)
    v_mfma_f32_16x16x32_bf16 v[112:115], a[40:43], v[172:175], v[112:115]
    ds_read_b64 v[160:161], v198 offset:1024
    v_mfma_f32_32x32x16_bf16 v[80:95], a[40:43], v[176:179], v[80:95]
    ds_read_b64 v[162:163], v198 offset:1088
    ds_read_b64 v[164:165], v196 offset:8192
    ds_read_b64 v[166:167], v196 offset:8704
    v_add_u32 v199, 36352, v58
    s_lshl_b32 s32, s24, 11
    v_mfma_f32_32x32x16_bf16 v[96:111], a[40:43], v[180:183], v[96:111]
    ds_read_b64 v[168:169], v196 offset:8448
    ds_read_b64 v[170:171], v196 offset:8960
    v_add_u32 v203, s32, v199
    s_add_u32 s32, s24, 1
    s_waitcnt lgkmcnt(6)
    v_mfma_f32_16x16x32_bf16 v[112:115], a[44:47], v[184:187], v[112:115]
    ds_read_b64 v[172:173], v198 offset:1280
    v_mfma_f32_32x32x16_bf16 v[80:95], a[44:47], v[188:191], v[80:95]
    ds_read_b64 v[174:175], v198 offset:1344
    ds_read_b64 v[176:177], v196 offset:10240
    ds_read_b64 v[178:179], v196 offset:10752
    s_and_b32 s32, s32, 3
    s_mul_i32 s32, s32, 6144
    v_mfma_f32_32x32x16_bf16 v[96:111], a[44:47], v[192:195], v[96:111]
    ds_read_b64 v[180:181], v196 offset:10496
    ds_read_b64 v[182:183], v196 offset:11008
    v_add_u32 v200, s32, v199
    s_add_u32 s32, s24, 2
    s_waitcnt lgkmcnt(6)
    v_mfma_f32_16x16x32_bf16 v[112:115], a[48:51], v[160:163], v[112:115]
    ds_read_b64 v[184:185], v198 offset:1536
    v_mfma_f32_32x32x16_bf16 v[80:95], a[48:51], v[164:167], v[80:95]
    ds_read_b64 v[186:187], v198 offset:1600
    ds_read_b64 v[188:189], v196 offset:12288
    ds_read_b64 v[190:191], v196 offset:12800
    s_and_b32 s32, s32, 3
    s_mul_i32 s32, s32, 6144
    v_mfma_f32_32x32x16_bf16 v[96:111], a[48:51], v[168:171], v[96:111]
    ds_read_b64 v[192:193], v196 offset:12544
    ds_read_b64 v[194:195], v196 offset:13056
    v_add_u32 v201, s32, v199
    s_add_u32 s32, s24, 3
    s_waitcnt lgkmcnt(6)
    v_mfma_f32_16x16x32_bf16 v[112:115], a[52:55], v[172:175], v[112:115]
    ds_read_b64 v[160:161], v198 offset:1792
    v_mfma_f32_32x32x16_bf16 v[80:95], a[52:55], v[176:179], v[80:95]
    ds_read_b64 v[162:163], v198 offset:1856
    ds_read_b64 v[164:165], v196 offset:14336
    ds_read_b64 v[166:167], v196 offset:14848
    s_and_b32 s32, s32, 3
    s_mul_i32 s32, s32, 6144
    v_mfma_f32_32x32x16_bf16 v[96:111], a[52:55], v[180:183], v[96:111]
    ds_read_b64 v[168:169], v196 offset:14592
    ds_read_b64 v[170:171], v196 offset:15104
    v_add_u32 v202, s32, v199
    s_mul_i32 s32, s24, 6144
    s_waitcnt vmcnt(12)
    s_barrier
    s_waitcnt lgkmcnt(6)
    v_mfma_f32_16x16x32_bf16 v[112:115], a[56:59], v[184:187], v[112:115]
    v_add_u32 v198, v49, v198
    v_mfma_f32_32x32x16_bf16 v[80:95], a[56:59], v[188:191], v[80:95]
    v_add_u32 v196, 19584, v196
    ds_read_b64 v[172:173], v198 offset:0
    ds_read_b64 v[174:175], v198 offset:64
    ds_read_b64 v[176:177], v196 offset:0
    v_add_u32_e64 v204, s32, v199
    v_mfma_f32_32x32x16_bf16 v[96:111], a[56:59], v[192:195], v[96:111]
    ds_read_b64 v[178:179], v196 offset:512
    ds_read_b64 v[180:181], v196 offset:256
    ds_read_b64 v[182:183], v196 offset:768
    s_lshl_b32 s32, s24, 8
    s_waitcnt lgkmcnt(6)
    v_mfma_f32_16x16x32_bf16 v[112:115], a[60:63], v[160:163], v[112:115]
    ds_read_b64 v[184:185], v198 offset:256
    v_mfma_f32_32x32x16_bf16 v[80:95], a[60:63], v[164:167], v[80:95]
    ds_read_b64 v[186:187], v198 offset:320
    ds_read_b64 v[188:189], v196 offset:2048
    ds_read_b64 v[190:191], v196 offset:2560
    s_add_u32 s32, s32, 36352
    v_and_b32_e64 v214, 15, v1
    v_mfma_f32_32x32x16_bf16 v[96:111], a[60:63], v[168:171], v[96:111]
    ds_read_b64 v[192:193], v196 offset:2304
    ds_read_b64 v[194:195], v196 offset:2816
    v_lshl_add_u32 v206, v214, 4, s32
    v_lshrrev_b32 v215, 5, v1
    s_waitcnt lgkmcnt(6)
    v_mfma_f32_16x16x32_bf16 v[112:115], a[64:67], v[172:175], v[112:115]
    ds_read_b64 v[160:161], v198 offset:512
    v_mfma_f32_32x32x16_bf16 v[80:95], a[64:67], v[176:179], v[80:95]
    ds_read_b64 v[162:163], v198 offset:576
    ds_read_b64 v[164:165], v196 offset:4096
    ds_read_b64 v[166:167], v196 offset:4608
    v_lshl_add_u32 v205, v215, 10, v206
    v_bfe_u32 v215, v1, 4, 1
    v_mfma_f32_32x32x16_bf16 v[96:111], a[64:67], v[180:183], v[96:111]
    ds_read_b64 v[168:169], v196 offset:4352
    ds_read_b64 v[170:171], v196 offset:4864
    v_lshl_add_u32 v205, v215, 3, v205
    v_lshlrev_b32 v214, 2, v214
    s_waitcnt lgkmcnt(6)
    v_mfma_f32_16x16x32_bf16 v[112:115], a[68:71], v[184:187], v[112:115]
    ds_read_b64 v[172:173], v198 offset:768
    v_mfma_f32_32x32x16_bf16 v[80:95], a[68:71], v[188:191], v[80:95]
    ds_read_b64 v[174:175], v198 offset:832
    ds_read_b64 v[176:177], v196 offset:6144
    ds_read_b64 v[178:179], v196 offset:6656
    v_lshl_add_u32 v214, v215, 10, v214
    s_lshl_b32 s32, s24, 6
    v_mfma_f32_32x32x16_bf16 v[96:111], a[68:71], v[192:195], v[96:111]
    ds_read_b64 v[180:181], v196 offset:6400
    ds_read_b64 v[182:183], v196 offset:6912
    v_lshl_add_u32 v207, v215, 3, s32
    v_and_b32_e64 v215, 12, v1
    s_waitcnt lgkmcnt(6)
    v_mfma_f32_16x16x32_bf16 v[112:115], a[72:75], v[160:163], v[112:115]
    ds_read_b64 v[184:185], v198 offset:1024
    v_mfma_f32_32x32x16_bf16 v[80:95], a[72:75], v[164:167], v[80:95]
    ds_read_b64 v[186:187], v198 offset:1088
    ds_read_b64 v[188:189], v196 offset:8192
    ds_read_b64 v[190:191], v196 offset:8704
    v_lshl_add_u32 v207, v215, 2, v207
    v_and_b32_e64 v215, 2, v1
    v_mfma_f32_32x32x16_bf16 v[96:111], a[72:75], v[168:171], v[96:111]
    ds_read_b64 v[192:193], v196 offset:8448
    ds_read_b64 v[194:195], v196 offset:8960
    s_lshl_b32 s98, s72, 5
    s_add_u32 s98, s98, 256
    s_sub_u32 s95, s98, 4
    s_max_i32 s95, s95, 0
    s_lshl_b32 s94, s98, 3
    s_lshl_b32 s95, s95, 3
    s_add_u32 s94, s94, 3457024
    s_add_u32 s95, s95, 3457024
    s_add_u32 s96, s94, 8192
    buffer_load_dwordx2 v[152:153], v47, s[16:19], s94 offen sc1
    s_waitcnt lgkmcnt(6)
    v_mfma_f32_16x16x32_bf16 v[112:115], a[76:79], v[172:175], v[112:115]
    ds_read_b64 v[160:161], v198 offset:1280
    v_mfma_f32_32x32x16_bf16 v[80:95], a[76:79], v[176:179], v[80:95]
    ds_read_b64 v[162:163], v198 offset:1344
    ds_read_b64 v[164:165], v196 offset:10240
    ds_read_b64 v[166:167], v196 offset:10752
    v_lshl_add_u32 v207, v215, 1, v207
    v_add_u32 v207, 69120, v207
    v_mfma_f32_32x32x16_bf16 v[96:111], a[76:79], v[180:183], v[96:111]
    ds_read_b64 v[168:169], v196 offset:10496
    ds_read_b64 v[170:171], v196 offset:11008
    buffer_load_dwordx2 v[154:155], v47, s[16:19], s96 offen sc1
    v_lshrrev_b32 v215, 4, v1
    s_waitcnt lgkmcnt(6)
    v_mfma_f32_16x16x32_bf16 v[112:115], a[80:83], v[184:187], v[112:115]
    ds_read_b64 v[172:173], v198 offset:1536
    v_mfma_f32_32x32x16_bf16 v[80:95], a[80:83], v[188:191], v[80:95]
    ds_read_b64 v[174:175], v198 offset:1600
    ds_read_b64 v[176:177], v196 offset:12288
    ds_read_b64 v[178:179], v196 offset:12800
    v_lshl_add_u32 v206, v215, 2, v206
    v_mov_b32 v215, 0x3f803f80
    v_mfma_f32_32x32x16_bf16 v[96:111], a[80:83], v[192:195], v[96:111]
    ds_read_b64 v[180:181], v196 offset:12544
    ds_read_b64 v[182:183], v196 offset:13056
    buffer_load_dwordx2 v[156:157], v48, s[16:19], s95 offen sc1
    s_waitcnt lgkmcnt(6)
    v_mfma_f32_16x16x32_bf16 v[112:115], a[84:87], v[160:163], v[112:115]
    ds_read_b64 v[184:185], v198 offset:1792
    v_mfma_f32_32x32x16_bf16 v[80:95], a[84:87], v[164:167], v[80:95]
    ds_read_b64 v[186:187], v198 offset:1856
    ds_read_b64 v[188:189], v196 offset:14336
    ds_read_b64 v[190:191], v196 offset:14848
    v_mfma_f32_32x32x16_bf16 v[96:111], a[84:87], v[168:171], v[96:111]
    ds_read_b64 v[192:193], v196 offset:14592
    ds_read_b64 v[194:195], v196 offset:15104
    s_waitcnt vmcnt(8)
    s_barrier
    s_waitcnt lgkmcnt(6)
    v_mfma_f32_16x16x32_bf16 v[112:115], a[88:91], v[172:175], v[112:115]
    v_add_u32_e64 v198, v49, v198
    v_mfma_f32_32x32x16_bf16 v[80:95], a[88:91], v[176:179], v[80:95]
    v_add_u32 v196, 19584, v196
    ds_read_b64 v[160:161], v198 offset:0
    ds_read_b64 v[162:163], v198 offset:64
    ds_read_b64 v[164:165], v196 offset:0
    v_mfma_f32_32x32x16_bf16 v[96:111], a[88:91], v[180:183], v[96:111]
    ds_read_b64 v[166:167], v196 offset:512
    ds_read_b64 v[168:169], v196 offset:256
    ds_read_b64 v[170:171], v196 offset:768
    s_waitcnt lgkmcnt(6)
    v_mfma_f32_16x16x32_bf16 v[112:115], a[92:95], v[184:187], v[112:115]
    ds_read_b64 v[172:173], v198 offset:256
    v_mfma_f32_32x32x16_bf16 v[80:95], a[92:95], v[188:191], v[80:95]
    ds_read_b64 v[174:175], v198 offset:320
    ds_read_b64 v[176:177], v196 offset:2048
    ds_read_b64 v[178:179], v196 offset:2560
    v_mfma_f32_32x32x16_bf16 v[96:111], a[92:95], v[192:195], v[96:111]
    ds_read_b64 v[180:181], v196 offset:2304
    ds_read_b64 v[182:183], v196 offset:2816
    s_waitcnt lgkmcnt(6)
    v_mfma_f32_16x16x32_bf16 v[112:115], a[96:99], v[160:163], v[112:115]
    ds_read_b64 v[184:185], v198 offset:512
    v_mfma_f32_32x32x16_bf16 v[80:95], a[96:99], v[164:167], v[80:95]
    ds_read_b64 v[186:187], v198 offset:576
    ds_read_b64 v[188:189], v196 offset:4096
    ds_read_b64 v[190:191], v196 offset:4608
    v_mfma_f32_32x32x16_bf16 v[96:111], a[96:99], v[168:171], v[96:111]
    ds_read_b64 v[192:193], v196 offset:4352
    ds_read_b64 v[194:195], v196 offset:4864
    s_waitcnt lgkmcnt(6)
    v_mfma_f32_16x16x32_bf16 v[112:115], a[100:103], v[172:175], v[112:115]
    ds_read_b64 v[160:161], v198 offset:768
    v_mfma_f32_32x32x16_bf16 v[80:95], a[100:103], v[176:179], v[80:95]
    ds_read_b64 v[162:163], v198 offset:832
    ds_read_b64 v[164:165], v196 offset:6144
    ds_read_b64 v[166:167], v196 offset:6656
    v_mfma_f32_32x32x16_bf16 v[96:111], a[100:103], v[180:183], v[96:111]
    ds_read_b64 v[168:169], v196 offset:6400
    ds_read_b64 v[170:171], v196 offset:6912
    s_waitcnt lgkmcnt(6)
    v_mfma_f32_16x16x32_bf16 v[112:115], a[104:107], v[184:187], v[112:115]
    ds_read_b64 v[172:173], v198 offset:1024
    v_mfma_f32_32x32x16_bf16 v[80:95], a[104:107], v[188:191], v[80:95]
    ds_read_b64 v[174:175], v198 offset:1088
    ds_read_b64 v[176:177], v196 offset:8192
    ds_read_b64 v[178:179], v196 offset:8704
    v_mfma_f32_32x32x16_bf16 v[96:111], a[104:107], v[192:195], v[96:111]
    ds_read_b64 v[180:181], v196 offset:8448
    ds_read_b64 v[182:183], v196 offset:8960
    s_waitcnt lgkmcnt(6)
    v_mfma_f32_16x16x32_bf16 v[112:115], a[108:111], v[160:163], v[112:115]
    ds_read_b64 v[184:185], v198 offset:1280
    v_mfma_f32_32x32x16_bf16 v[80:95], a[108:111], v[164:167], v[80:95]
    ds_read_b64 v[186:187], v198 offset:1344
    ds_read_b64 v[188:189], v196 offset:10240
    ds_read_b64 v[190:191], v196 offset:10752
    v_mfma_f32_32x32x16_bf16 v[96:111], a[108:111], v[168:171], v[96:111]
    ds_read_b64 v[192:193], v196 offset:10496
    ds_read_b64 v[194:195], v196 offset:11008
    s_waitcnt lgkmcnt(6)
    v_mfma_f32_16x16x32_bf16 v[112:115], a[112:115], v[172:175], v[112:115]
    ds_read_b64 v[160:161], v198 offset:1536
    v_mfma_f32_32x32x16_bf16 v[80:95], a[112:115], v[176:179], v[80:95]
    ds_read_b64 v[162:163], v198 offset:1600
    ds_read_b64 v[164:165], v196 offset:12288
    ds_read_b64 v[166:167], v196 offset:12800
    v_mfma_f32_32x32x16_bf16 v[96:111], a[112:115], v[180:183], v[96:111]
    ds_read_b64 v[168:169], v196 offset:12544
    ds_read_b64 v[170:171], v196 offset:13056
    s_waitcnt lgkmcnt(6)
    v_mfma_f32_16x16x32_bf16 v[112:115], a[116:119], v[184:187], v[112:115]
    ds_read_b64 v[172:173], v198 offset:1792
    v_mfma_f32_32x32x16_bf16 v[80:95], a[116:119], v[188:191], v[80:95]
    ds_read_b64 v[174:175], v198 offset:1856
    ds_read_b64 v[176:177], v196 offset:14336
    ds_read_b64 v[178:179], v196 offset:14848
    v_mfma_f32_32x32x16_bf16 v[96:111], a[116:119], v[192:195], v[96:111]
    ds_read_b64 v[180:181], v196 offset:14592
    ds_read_b64 v[182:183], v196 offset:15104
sl_70:
    s_waitcnt vmcnt(1)
    v_max3_u32 v2, v152, v153, v154
    s_waitcnt vmcnt(0)
    v_max3_u32 v2, v2, v155, v156
    v_max_u32 v2, v2, v157
    v_cmp_eq_u32 vcc, -1, v2
    s_nop 0
    s_cbranch_vccnz rd_71
rc_72:
    s_barrier
    s_waitcnt lgkmcnt(6)
    v_mfma_f32_16x16x32_bf16 v[112:115], a[120:123], v[160:163], v[112:115]
    v_add_u32 v198, v49, v198
    v_mfma_f32_32x32x16_bf16 v[80:95], a[120:123], v[164:167], v[80:95]
    v_add_u32 v196, 19584, v196
    ds_read_b64 v[184:185], v198 offset:0
    ds_read_b64 v[186:187], v198 offset:64
    v_mul_f32 v148, v24, v157
    v_mul_f32 v149, v25, v157
    v_mfma_f32_32x32x16_bf16 v[96:111], a[120:123], v[168:171], v[96:111]
    ds_read_b64 v[188:189], v196 offset:0
    ds_read_b64 v[190:191], v196 offset:512
    s_mov_b32 s96, 12058624
    buffer_load_dwordx4 v[216:219], v56, s[16:19], s96 offen offset:0 sc1
    v_mul_f32 v150, v26, v157
    v_mul_f32_e64 v151, v27, v157
    s_waitcnt lgkmcnt(4)
    v_mfma_f32_16x16x32_bf16 v[112:115], a[124:127], v[172:175], v[112:115]
    ds_read_b64 v[192:193], v198 offset:256
    v_mfma_f32_32x32x16_bf16 v[80:95], a[124:127], v[176:179], v[80:95]
    ds_read_b64 v[194:195], v198 offset:320
    ds_read_b64 v[160:161], v196 offset:2048
    v_mul_f32 v116, v8, v153
    v_mul_f32 v117, v9, v153
    v_mul_f32_e64 v118, v10, v153
    v_mfma_f32_32x32x16_bf16 v[96:111], a[124:127], v[180:183], v[96:111]
    ds_read_b64 v[162:163], v196 offset:2560
    buffer_load_dwordx4 v[220:223], v56, s[16:19], s96 offen offset:256 sc1
    v_mul_f32 v119, v11, v153
    v_mul_f32_e64 v120, v12, v153
    s_waitcnt lgkmcnt(4)
    v_mfma_f32_16x16x32_bf16 v[112:115], a[128:131], v[184:187], v[112:115]
    ds_read_b64 v[164:165], v198 offset:512
    v_mfma_f32_32x32x16_bf16 v[80:95], a[128:131], v[188:191], v[80:95]
    ds_read_b64 v[166:167], v198 offset:576
    ds_read_b64 v[168:169], v196 offset:4096
    ds_read_b64 v[170:171], v196 offset:4608
    v_mul_f32 v121, v13, v153
    v_mul_f32_e64 v122, v14, v153
    s_waitcnt lgkmcnt(4)
    v_mfma_f32_16x16x32_bf16 v[112:115], a[132:135], v[192:195], v[112:115]
    ds_read_b64 v[172:173], v198 offset:768
    v_mfma_f32_32x32x16_bf16 v[80:95], a[132:135], v[160:163], v[80:95]
    ds_read_b64 v[174:175], v198 offset:832
    ds_read_b64 v[176:177], v196 offset:6144
    ds_read_b64 v[178:179], v196 offset:6656
    s_mov_b32 s96, 12091392
    buffer_load_dwordx4 v[224:227], v56, s[16:19], s96 offen offset:0 sc1
    v_mul_f32 v123, v15, v153
    v_mul_f32_e64 v124, v16, v153
    s_waitcnt lgkmcnt(4)
    v_mfma_f32_16x16x32_bf16 v[112:115], a[136:139], v[164:167], v[112:115]
    ds_read_b64 v[180:181], v198 offset:1024
    v_mfma_f32_32x32x16_bf16 v[80:95], a[136:139], v[168:171], v[80:95]
    ds_read_b64 v[182:183], v198 offset:1088
    ds_read_b64 v[184:185], v196 offset:8192
    ds_read_b64 v[186:187], v196 offset:8704
    v_mul_f32 v125, v17, v153
    v_mul_f32_e64 v126, v18, v153
    s_waitcnt lgkmcnt(4)
    v_mfma_f32_16x16x32_bf16 v[112:115], a[140:143], v[172:175], v[112:115]
    ds_read_b64 v[188:189], v198 offset:1280
    v_mfma_f32_32x32x16_bf16 v[80:95], a[140:143], v[176:179], v[80:95]
    ds_read_b64 v[190:191], v198 offset:1344
    ds_read_b64 v[192:193], v196 offset:10240
    ds_read_b64 v[194:195], v196 offset:10752
    buffer_load_dwordx4 v[228:231], v56, s[16:19], s96 offen offset:256 sc1
    v_mul_f32 v127, v19, v153
    v_mul_f32_e64 v128, v20, v153
    s_waitcnt lgkmcnt(4)
    v_mfma_f32_16x16x32_bf16 v[112:115], a[144:147], v[180:183], v[112:115]
    ds_read_b64 v[160:161], v198 offset:1536
    v_mfma_f32_32x32x16_bf16 v[80:95], a[144:147], v[184:187], v[80:95]
    ds_read_b64 v[162:163], v198 offset:1600
    ds_read_b64 v[164:165], v196 offset:12288
    ds_read_b64 v[166:167], v196 offset:12800
    v_mul_f32 v129, v21, v153
    v_mul_f32_e64 v130, v22, v153
    s_waitcnt lgkmcnt(4)
    v_mfma_f32_16x16x32_bf16 v[112:115], a[148:151], v[188:191], v[112:115]
    ds_read_b64 v[168:169], v198 offset:1792
    v_mfma_f32_32x32x16_bf16 v[80:95], a[148:151], v[192:195], v[80:95]
    ds_read_b64 v[170:171], v198 offset:1856
    ds_read_b64 v[172:173], v196 offset:14336
    ds_read_b64 v[174:175], v196 offset:14848
    s_mov_b32 s96, 12124160
    buffer_load_dwordx4 v[232:235], v56, s[16:19], s96 offen offset:0 sc1
    v_mul_f32 v131, v23, v153
    v_mul_f32_e64 v132, v8, v155
    s_waitcnt lgkmcnt(4)
    v_mfma_f32_16x16x32_bf16 v[112:115], a[152:155], v[160:163], v[112:115]
    ds_read_b64 v[176:177], v196 offset:256
    v_mfma_f32_32x32x16_bf16 v[80:95], a[152:155], v[164:167], v[80:95]
    ds_read_b64 v[178:179], v196 offset:768
    ds_read_b64 v[180:181], v196 offset:2304
    ds_read_b64 v[182:183], v196 offset:2816
    v_mul_f32 v133, v9, v155
    v_mul_f32_e64 v134, v10, v155
    s_waitcnt lgkmcnt(4)
    v_mfma_f32_16x16x32_bf16 v[112:115], a[156:159], v[168:171], v[112:115]
    ds_read_b64 v[184:185], v196 offset:4352
    v_mfma_f32_32x32x16_bf16 v[80:95], a[156:159], v[172:175], v[80:95]
    ds_read_b64 v[186:187], v196 offset:4864
    ds_read_b64 v[188:189], v196 offset:6400
    ds_read_b64 v[190:191], v196 offset:6912
    buffer_load_dwordx4 v[236:239], v56, s[16:19], s96 offen offset:256 sc1
    v_mul_f32 v135, v11, v155
    v_mul_f32 v136, v12, v155
    v_mul_f32 v137, v13, v155
    v_mul_f32 v138, v14, v155
    v_mul_f32 v139, v15, v155
    v_mul_f32 v140, v16, v155
    v_mul_f32 v141, v17, v155
    v_mul_f32 v142, v18, v155
    v_mul_f32 v143, v19, v155
    v_mul_f32 v144, v20, v155
    v_mul_f32 v145, v21, v155
    v_mul_f32 v146, v22, v155
    v_mul_f32 v147, v23, v155
    s_waitcnt lgkmcnt(4)
    v_mfma_f32_32x32x16_bf16 v[96:111], a[128:131], v[176:179], v[96:111]
    ds_read_b64 v[192:193], v196 offset:8448
    ds_read_b64 v[194:195], v196 offset:8960
    v_mfma_f32_32x32x16_bf16 v[96:111], a[132:135], v[180:183], v[96:111]
    ds_read_b64 v[160:161], v196 offset:10496
    ds_read_b64 v[162:163], v196 offset:11008
    s_mov_b32 s96, 12156928
    buffer_load_dwordx4 v[240:243], v56, s[16:19], s96 offen offset:0 sc1
    v_fma_f32 v112, v112, v156, v148
    v_fma_f32 v113, v113, v156, v149
    s_waitcnt lgkmcnt(4)
    v_mfma_f32_32x32x16_bf16 v[96:111], a[136:139], v[184:187], v[96:111]
    ds_read_b64 v[164:165], v196 offset:12544
    ds_read_b64 v[166:167], v196 offset:13056
    v_fma_f32 v114, v114, v156, v150
    v_fma_f32 v115, v115, v156, v151
    v_cvt_pk_bf16_f32 v112, v112, v113
    v_mfma_f32_32x32x16_bf16 v[96:111], a[140:143], v[188:191], v[96:111]
    ds_read_b64 v[168:169], v196 offset:14592
    ds_read_b64 v[170:171], v196 offset:15104
    buffer_load_dwordx4 v[244:247], v56, s[16:19], s96 offen offset:256 sc1
    v_cvt_pk_bf16_f32 v113, v114, v115
    v_fma_f32 v80, v80, v152, v116
    s_waitcnt lgkmcnt(4)
    v_mfma_f32_32x32x16_bf16 v[96:111], a[144:147], v[192:195], v[96:111]
    v_fma_f32 v81, v81, v152, v117
    v_fma_f32 v82, v82, v152, v118
    v_fma_f32 v83, v83, v152, v119
    v_cvt_pk_bf16_f32 v80, v80, v81
    v_cvt_pk_bf16_f32 v81, v82, v83
    v_mfma_f32_32x32x16_bf16 v[96:111], a[148:151], v[160:163], v[96:111]
    ds_write_b64 v40, v[112:113] offset:0
    ds_write_b64 v38, v[80:81] offset:0
    v_fma_f32 v84, v84, v152, v120
    v_fma_f32 v85, v85, v152, v121
    s_waitcnt lgkmcnt(2)
    v_mfma_f32_32x32x16_bf16 v[96:111], a[152:155], v[164:167], v[96:111]
    v_fma_f32 v86, v86, v152, v122
    v_fma_f32 v87, v87, v152, v123
    v_cvt_pk_bf16_f32 v84, v84, v85
    v_cvt_pk_bf16_f32 v85, v86, v87
    v_fma_f32 v88, v88, v152, v124
    v_mfma_f32_32x32x16_bf16 v[96:111], a[156:159], v[168:171], v[96:111]
    s_mov_b32 s96, 12058624
    buffer_load_dwordx2 v[248:249], v57, s[16:19], s96 offen offset:0 sc1
    v_fma_f32 v89, v89, v152, v125
    v_fma_f32 v90, v90, v152, v126
    v_fma_f32 v91, v91, v152, v127
    v_cvt_pk_bf16_f32 v88, v88, v89
    v_cvt_pk_bf16_f32 v89, v90, v91
    ds_write_b64 v38, v[84:85] offset:6400
    ds_write_b64 v38, v[88:89] offset:12800
    v_fma_f32 v92, v92, v152, v128
    v_fma_f32 v93, v93, v152, v129
    v_fma_f32 v94, v94, v152, v130
    v_fma_f32 v95, v95, v152, v131
    v_cvt_pk_bf16_f32 v92, v92, v93
    v_cvt_pk_bf16_f32 v93, v94, v95
    ds_write_b64 v39, v[92:93] offset:0
    v_pk_fma_f32 v[96:97], v[96:97], v[154:155], v[132:133] op_sel_hi:[1,0,1]
    v_pk_fma_f32 v[98:99], v[98:99], v[154:155], v[134:135] op_sel_hi:[1,0,1]
    v_cvt_pk_bf16_f32 v96, v96, v97
    v_cvt_pk_bf16_f32 v97, v98, v99
    v_pk_fma_f32 v[100:101], v[100:101], v[154:155], v[136:137] op_sel_hi:[1,0,1]
    v_pk_fma_f32 v[102:103], v[102:103], v[154:155], v[138:139] op_sel_hi:[1,0,1]
    v_cvt_pk_bf16_f32 v100, v100, v101
    v_cvt_pk_bf16_f32 v101, v102, v103
    ds_write_b64 v38, v[96:97] offset:1600
    ds_write_b64 v38, v[100:101] offset:8000
    v_pk_fma_f32 v[104:105], v[104:105], v[154:155], v[140:141] op_sel_hi:[1,0,1]
    v_pk_fma_f32 v[106:107], v[106:107], v[154:155], v[142:143] op_sel_hi:[1,0,1]
    v_cvt_pk_bf16_f32 v104, v104, v105
    v_cvt_pk_bf16_f32 v105, v106, v107
    v_pk_fma_f32 v[108:109], v[108:109], v[154:155], v[144:145] op_sel_hi:[1,0,1]
    v_pk_fma_f32 v[110:111], v[110:111], v[154:155], v[146:147] op_sel_hi:[1,0,1]
    v_cvt_pk_bf16_f32 v108, v108, v109
    v_cvt_pk_bf16_f32 v109, v110, v111
    ds_write_b64 v38, v[104:105] offset:14400
    ds_write_b64 v39, v[108:109] offset:1600
    v_cmp_u_f32 vcc, v82, v114
    v_cmp_u_f32 s[82:83], v98, v98
    s_lshl_b32 s25, s24, 2
    s_add_u32 s25, s25, 160256
    s_or_b64 vcc, vcc, s[82:83]
    s_cselect_b32 s26, 1, 0
    v_mov_b32 v196, s25
    v_mov_b32 v197, s26
    ds_write_b32 v196, v197
    s_waitcnt lgkmcnt(0)
    s_barrier
    v_mov_b32 v158, 160256
    ds_read_b128 v[128:131], v158
    v_mov_b32 v94, 0
    v_mov_b32 v95, 0
    v_mov_b32 v98, 0
    v_mov_b32_e64 v99, 0
    s_mov_b64 exec, 0xffff
    ds_read_b64 v[94:95], v42 offset:320
    ds_read_b64 v[98:99], v42 offset:640
    s_mov_b64 exec, -1
    s_nop 0
    ds_read_b64 v[92:93], v41 offset:320
    ds_read_b64 v[96:97], v41 offset:640
    ds_read_b64 v[84:85], v41 offset:6720
    ds_read_b64 v[86:87], v42 offset:6720
    ds_read_b64 v[80:81], v41 offset:6400
    ds_read_b64 v[82:83], v42 offset:6400
    ds_read_b64 v[88:89], v41 offset:7040
    ds_read_b64 v[90:91], v42 offset:7040
    ds_read_b64_tr_b16 v[106:107], v44 offset:0
    ds_read_b64_tr_b16 v[100:101], v43 offset:0
    buffer_load_dwordx2 v[252:253], v57, s[16:19], s96 offen offset:128 sc1
    ds_read_b64_tr_b16 v[108:109], v44 offset:320
    ds_read_b64_tr_b16 v[102:103], v43 offset:320
    ds_read_b64_tr_b16 v[110:111], v44 offset:640
    ds_read_b64_tr_b16 v[104:105], v43 offset:640
    s_mov_b32 s82, 0x3ea52b5c
    s_lshl_b32 s25, s98, 4
    s_add_u32 s25, s25, 12058624
    s_lshl_b32 s26, s98, 3
    s_mov_b32 s96, 12075008
    buffer_load_dwordx2 v[250:251], v57, s[16:19], s96 offen offset:0 sc1
    s_add_u32 s26, s26, 12058624
    s_waitcnt lgkmcnt(15)
    v_or3_b32 v128, v128, v129, v130
    v_or_b32 v128, v128, v131
    v_cmp_ne_u32 vcc, 0, v128
    s_nop 0
    s_cbranch_vccnz rd_73
rc_74:
    s_waitcnt lgkmcnt(10)
    v_mfma_f32_16x16x32_bf16 v[116:119], v[84:87], v[92:95], v[28:31]
    v_mfma_f32_16x16x32_bf16 v[120:123], v[84:87], v[96:99], v[32:35]
    s_waitcnt lgkmcnt(8)
    v_mfma_f32_16x16x32_bf16 v[112:115], v[80:83], v[92:95], v[32:35]
    s_waitcnt lgkmcnt(6)
    v_mfma_f32_16x16x32_bf16 v[124:127], v[88:91], v[96:99], v[28:31]
    buffer_load_dwordx2 v[254:255], v57, s[16:19], s96 offen offset:128 sc1
    s_nop 4
    v_max_f32 v112, v112, v116
    v_max_f32 v113, v113, v117
    v_max_f32 v114, v114, v118
    v_max_f32 v115, v115, v119
    v_max3_f32 v156, v112, v113, v114
    v_max_f32 v156, v156, v115
    v_max_f32 v120, v120, v124
    v_max_f32 v121, v121, v125
    s_mov_b32 s96, 9437184
    buffer_load_dwordx4 v[208:211], v59, s[16:19], s96 offen sc1
    v_max_f32 v122, v122, v126
    v_max_f32 v123, v123, v127
    v_max3_f32 v157, v120, v121, v122
    v_max_f32 v157, v157, v123
    s_nop 1
    v_permlane16_swap_b32 v156, v157
    v_max_f32 v156, v156, v157
    v_mov_b32 v157, v156
    s_nop 1
    v_permlane32_swap_b32_e64 v156, v157
    s_add_u32 s97, s36, 9437184
    buffer_load_dword v212, v61, s[16:19], s97 offen sc1
    v_max_f32 v156, v156, v157
    v_mul_f32 v156, s82, v156
    v_mov_b32 v157, v156
    s_nop 1
    v_permlane16_swap_b32_e64 v156, v157
    v_fma_f32 v112, v112, s82, -v156
    v_fma_f32 v113, v113, s82, -v156
    v_fma_f32 v114, v114, s82, -v156
    v_fma_f32 v115, v115, s82, -v156
    v_exp_f32 v112, v112
    v_exp_f32 v113, v113
    v_exp_f32 v114, v114
    v_exp_f32 v115, v115
    v_cvt_pk_bf16_f32 v116, v112, v113
    v_cvt_pk_bf16_f32 v117, v114, v115
    v_bfi_b32 v128, v36, 0, v116
    v_and_b32 v130, v36, v116
    v_bfi_b32 v129, v37, 0, v117
    v_and_b32 v131, v37, v117
    s_waitcnt lgkmcnt(3)
    s_nop 0
    v_mfma_f32_16x16x32_bf16 v[144:147], v[106:109], v[128:131], 0
    s_waitcnt lgkmcnt(2)
    v_mfma_f32_16x16x32_bf16 v[136:139], v[100:103], v[128:131], 0
    v_fma_f32 v120, v120, s82, -v157
    v_fma_f32 v121, v121, s82, -v157
    v_fma_f32 v122, v122, s82, -v157
    v_fma_f32 v123, v123, s82, -v157
    v_exp_f32 v120, v120
    v_exp_f32 v121, v121
    v_exp_f32 v122, v122
    v_exp_f32_e64 v123, v123
    v_cvt_pk_bf16_f32 v124, v120, v121
    v_cvt_pk_bf16_f32 v125, v122, v123
    v_bfi_b32 v132, v36, 0, v124
    v_and_b32 v134, v36, v124
    v_bfi_b32 v133, v37, 0, v125
    v_and_b32 v135, v37, v125
    s_waitcnt lgkmcnt(1)
    s_nop 0
    v_mfma_f32_16x16x32_bf16 v[148:151], v[108:111], v[132:135], 0
    s_waitcnt lgkmcnt(0)
    v_mfma_f32_16x16x32_bf16 v[140:143], v[102:105], v[132:135], 0
    v_mov_b32 v158, v144
    s_nop 1
    v_permlane16_swap_b32 v144, v158
    v_rcp_f32 v158, v158
    s_nop 0
    v_pk_mul_f32 v[136:137], v[136:137], v[158:159] op_sel_hi:[1,0]
    v_pk_mul_f32 v[138:139], v[138:139], v[158:159] op_sel_hi:[1,0]
    v_pk_mul_f32 v[144:145], v[144:145], v[158:159] op_sel_hi:[1,0]
    v_pk_mul_f32 v[146:147], v[146:147], v[158:159] op_sel_hi:[1,0]
    v_cvt_pk_bf16_f32 v112, v136, v137
    v_cvt_pk_bf16_f32 v116, v144, v145
    v_cvt_pk_bf16_f32 v113, v138, v139
    v_cvt_pk_bf16_f32 v117, v146, v147
    v_mov_b32 v160, v148
    s_nop 1
    v_permlane16_swap_b32 v148, v160
    v_rcp_f32_e64 v160, v160
    s_nop 0
    v_pk_mul_f32 v[140:141], v[140:141], v[160:161] op_sel_hi:[1,0]
    v_pk_mul_f32 v[142:143], v[142:143], v[160:161] op_sel_hi:[1,0]
    v_pk_mul_f32 v[148:149], v[148:149], v[160:161] op_sel_hi:[1,0]
    v_pk_mul_f32 v[150:151], v[150:151], v[160:161] op_sel_hi:[1,0]
    v_cvt_pk_bf16_f32 v114, v140, v141
    v_cvt_pk_bf16_f32 v118, v148, v149
    v_cvt_pk_bf16_f32 v115, v142, v143
    v_cvt_pk_bf16_f32 v119, v150, v151
    v_permlane16_swap_b32 v112, v114
    v_permlane16_swap_b32 v113, v115
    v_permlane16_swap_b32 v116, v118
    v_permlane16_swap_b32 v117, v119
    buffer_store_dwordx4 v[112:115], v45, s[16:19], s25 offen sc1
    s_mov_b64 exec, s[80:81]
    buffer_store_dwordx2 v[116:117], v46, s[16:19], s26 offen sc1
    s_mov_b64 exec, -1
oe_75:
    s_waitcnt vmcnt(15)
    v_mfma_f32_16x16x32_bf16 v[112:115], a[176:179], v[216:219], 0
    v_mov_b32 v136, 0
    v_mov_b32 v137, 0
    s_waitcnt vmcnt(14)
    v_mfma_f32_16x16x32_bf16 v[116:119], a[176:179], v[220:223], 0
    v_mov_b32 v138, 0
    v_mov_b32 v139, 0
    s_waitcnt vmcnt(13)
    v_mfma_f32_16x16x32_bf16 v[112:115], a[196:199], v[224:227], v[112:115]
    v_mov_b32 v140, 0
    v_mov_b32 v141, 0
    s_waitcnt vmcnt(12)
    v_mfma_f32_16x16x32_bf16 v[116:119], a[196:199], v[228:231], v[116:119]
    s_mov_b32 s25, 14680064
    s_add_u32 s26, s36, 14680064
    s_waitcnt vmcnt(11)
    v_mfma_f32_16x16x32_bf16 v[112:115], a[216:219], v[232:235], v[112:115]
    s_add_u32 s27, s35, 3506176
    s_mov_b32 s28, 0x99999999
    s_waitcnt vmcnt(10)
    v_mfma_f32_16x16x32_bf16 v[116:119], a[216:219], v[236:239], v[116:119]
    s_mov_b32 s29, 0x99999999
    s_waitcnt vmcnt(9)
    v_mfma_f32_16x16x32_bf16 v[112:115], a[236:239], v[240:243], v[112:115]
    s_waitcnt vmcnt(8)
    v_mfma_f32_16x16x32_bf16 v[116:119], a[236:239], v[244:247], v[116:119]
    s_waitcnt vmcnt(5)
    v_mfma_f32_16x16x32_bf16 v[112:115], v[52:55], v[248:251], v[112:115]
    s_waitcnt vmcnt(4)
    v_mfma_f32_16x16x32_bf16 v[116:119], v[52:55], v[252:255], v[116:119]
    v_mfma_f32_16x16x32_bf16 v[88:91], a[164:167], v[216:219], 0
    v_mfma_f32_16x16x32_bf16 v[92:95], a[164:167], v[220:223], 0
    v_mfma_f32_16x16x32_bf16 v[88:91], a[184:187], v[224:227], v[88:91]
    s_waitcnt vmcnt(3)
    v_max3_u32 v132, v208, v209, v210
    s_waitcnt vmcnt(2)
    v_max3_u32 v132, v132, v211, v212
    v_mfma_f32_16x16x32_bf16 v[92:95], a[184:187], v[228:231], v[92:95]
    v_cmp_eq_u32 s[82:83], -1, v132
    v_mfma_f32_16x16x32_bf16 v[88:91], a[204:207], v[232:235], v[88:91]
    v_mfma_f32_16x16x32_bf16 v[92:95], a[204:207], v[236:239], v[92:95]
    v_cmp_u_f32 vcc, v112, v116
    s_nop 0
    s_or_b64 vcc, vcc, s[82:83]
    s_cbranch_vccnz rd_76
rc_77:
    v_mfma_f32_16x16x32_bf16 v[88:91], a[224:227], v[240:243], v[88:91]
    ds_write_b128 v203, v[112:115] offset:24576
    v_mfma_f32_16x16x32_bf16 v[92:95], a[224:227], v[244:247], v[92:95]
    v_mfma_f32_16x16x32_bf16 v[88:91], a[244:247], v[248:251], v[88:91]
    ds_write_b128 v203, v[116:119] offset:25600
    v_mfma_f32_16x16x32_bf16 v[92:95], a[244:247], v[252:255], v[92:95]
    v_mfma_f32_16x16x32_bf16 v[96:99], a[168:171], v[216:219], 0
    v_lshlrev_b32_e64 v120, 16, v208
    v_and_b32 v121, 0xffff0000, v208
    v_mfma_f32_16x16x32_bf16 v[100:103], a[168:171], v[220:223], 0
    v_lshlrev_b32_e64 v122, 16, v209
    v_and_b32 v123, 0xffff0000, v209
    v_mfma_f32_16x16x32_bf16 v[96:99], a[188:191], v[224:227], v[96:99]
    v_lshlrev_b32_e64 v124, 16, v210
    v_and_b32 v125, 0xffff0000, v210
    v_mfma_f32_16x16x32_bf16 v[100:103], a[188:191], v[228:231], v[100:103]
    v_lshlrev_b32_e64 v126, 16, v211
    v_and_b32 v127, 0xffff0000, v211
    v_mfma_f32_16x16x32_bf16 v[96:99], a[208:211], v[232:235], v[96:99]
    v_lshlrev_b32_e64 v128, 16, v212
    v_and_b32 v129, 0xffff0000, v212
    v_mfma_f32_16x16x32_bf16 v[100:103], a[208:211], v[236:239], v[100:103]
    v_mfma_f32_16x16x32_bf16 v[96:99], a[228:231], v[240:243], v[96:99]
    ds_write_b128 v200, v[88:91] offset:0
    v_mfma_f32_16x16x32_bf16 v[100:103], a[228:231], v[244:247], v[100:103]
    v_mfma_f32_16x16x32_bf16 v[96:99], a[248:251], v[248:251], v[96:99]
    ds_write_b128 v200, v[92:95] offset:1024
    v_mfma_f32_16x16x32_bf16 v[100:103], a[248:251], v[252:255], v[100:103]
    v_mfma_f32_16x16x32_bf16 v[104:107], a[172:175], v[216:219], 0
    v_mfma_f32_16x16x32_bf16 v[108:111], a[172:175], v[220:223], 0
    v_mfma_f32_16x16x32_bf16 v[104:107], a[192:195], v[224:227], v[104:107]
    v_mfma_f32_16x16x32_bf16 v[108:111], a[192:195], v[228:231], v[108:111]
    v_mfma_f32_16x16x32_bf16 v[104:107], a[212:215], v[232:235], v[104:107]
    v_mfma_f32_16x16x32_bf16 v[108:111], a[212:215], v[236:239], v[108:111]
    v_mfma_f32_16x16x32_bf16 v[104:107], a[232:235], v[240:243], v[104:107]
    ds_write_b128 v201, v[96:99] offset:2048
    v_mfma_f32_16x16x32_bf16 v[108:111], a[232:235], v[244:247], v[108:111]
    v_mfma_f32_16x16x32_bf16 v[104:107], a[252:255], v[248:251], v[104:107]
    ds_write_b128 v201, v[100:103] offset:3072
    v_mfma_f32_16x16x32_bf16 v[108:111], a[252:255], v[252:255], v[108:111]
    v_mfma_f32_16x16x32_bf16 v[80:83], a[160:163], v[216:219], v[120:123]
    v_mfma_f32_16x16x32_bf16 v[84:87], a[160:163], v[220:223], v[124:127]
    v_mfma_f32_16x16x32_bf16 v[80:83], a[180:183], v[224:227], v[80:83]
    v_mfma_f32_16x16x32_bf16 v[84:87], a[180:183], v[228:231], v[84:87]
    v_mfma_f32_16x16x32_bf16 v[80:83], a[200:203], v[232:235], v[80:83]
    s_nop 0
    ds_write_b128 v202, v[104:107] offset:4096
    v_mfma_f32_16x16x32_bf16 v[84:87], a[200:203], v[236:239], v[84:87]
    ds_write_b128 v202, v[108:111] offset:5120
    v_mfma_f32_16x16x32_bf16 v[80:83], a[220:223], v[240:243], v[80:83]
    v_mfma_f32_16x16x32_bf16 v[84:87], a[220:223], v[244:247], v[84:87]
    v_mfma_f32_16x16x32_bf16 v[80:83], a[240:243], v[248:251], v[80:83]
    v_mfma_f32_16x16x32_bf16 v[84:87], a[240:243], v[252:255], v[84:87]
    s_waitcnt lgkmcnt(0)
    s_barrier
    s_nop 0
    ds_read_b128 v[88:91], v204 offset:0
    ds_read_b128 v[92:95], v204 offset:1024
    ds_read_b128 v[96:99], v204 offset:2048
    ds_read_b128 v[100:103], v204 offset:3072
    ds_read_b128 v[104:107], v204 offset:4096
    ds_read_b128 v[108:111], v204 offset:5120
    ds_read_b64 v[112:113], v205 offset:24576
    ds_read_b64 v[114:115], v205 offset:26624
    ds_read_b64 v[116:117], v205 offset:28672
    ds_read_b64 v[118:119], v205 offset:30720
    s_mov_b32 s96, 12062720
    buffer_load_dwordx4 v[216:219], v56, s[16:19], s96 offen offset:0 sc1
    buffer_load_dwordx4 v[220:223], v56, s[16:19], s96 offen offset:256 sc1
    s_mov_b32 s96, 12095488
    buffer_load_dwordx4 v[224:227], v56, s[16:19], s96 offen offset:0 sc1
    buffer_load_dwordx4 v[228:231], v56, s[16:19], s96 offen offset:256 sc1
    s_mov_b32 s96, 12128256
    buffer_load_dwordx4 v[232:235], v56, s[16:19], s96 offen offset:0 sc1
    buffer_load_dwordx4 v[236:239], v56, s[16:19], s96 offen offset:256 sc1
    s_waitcnt lgkmcnt(9)
    v_pk_add_f32 v[80:81], v[80:81], v[88:89]
    v_pk_add_f32 v[82:83], v[82:83], v[90:91]
    s_waitcnt lgkmcnt(8)
    v_pk_add_f32 v[84:85], v[84:85], v[92:93]
    v_pk_add_f32 v[86:87], v[86:87], v[94:95]
    s_waitcnt lgkmcnt(7)
    v_pk_add_f32 v[80:81], v[80:81], v[96:97]
    v_pk_add_f32 v[82:83], v[82:83], v[98:99]
    s_waitcnt lgkmcnt(6)
    v_pk_add_f32 v[84:85], v[84:85], v[100:101]
    v_pk_add_f32 v[86:87], v[86:87], v[102:103]
    s_waitcnt lgkmcnt(5)
    v_pk_add_f32 v[80:81], v[80:81], v[104:105]
    v_pk_add_f32 v[82:83], v[82:83], v[106:107]
    s_waitcnt lgkmcnt(4)
    v_pk_add_f32 v[84:85], v[84:85], v[108:109]
    v_pk_add_f32 v[86:87], v[86:87], v[110:111]
    v_cvt_pk_bf16_f32 v132, v80, v81
    v_cvt_pk_bf16_f32 v133, v82, v83
    v_cvt_pk_bf16_f32 v134, v84, v85
    v_cvt_pk_bf16_f32 v135, v86, v87
    s_waitcnt lgkmcnt(3)
    v_pk_add_f32 v[128:129], v[128:129], v[112:113]
    s_waitcnt lgkmcnt(2)
    v_pk_add_f32 v[128:129], v[128:129], v[114:115]
    s_waitcnt lgkmcnt(1)
    v_pk_add_f32 v[128:129], v[128:129], v[116:117]
    s_waitcnt lgkmcnt(0)
    v_pk_add_f32 v[128:129], v[128:129], v[118:119]
    v_cvt_pk_bf16_f32 v130, v128, v129
    buffer_store_dwordx4 v[132:135], v59, s[16:19], s25 offen sc1
    buffer_store_dword v130, v61, s[16:19], s26 offen sc1
    v_dot2c_f32_bf16 v136, v132, v215
    v_dot2c_f32_bf16 v137, v132, v132
    v_dot2c_f32_bf16 v136, v133, v215
    v_dot2c_f32_bf16 v137, v133, v133
    v_dot2c_f32_bf16 v138, v134, v215
    v_dot2c_f32_bf16 v139, v134, v134
    v_dot2c_f32_bf16 v138, v135, v215
    v_dot2c_f32_bf16 v139, v135, v135
    v_dot2c_f32_bf16 v140, v130, v215
    v_dot2c_f32_bf16 v141, v130, v130
    v_permlane32_swap_b32 v136, v138
    v_permlane32_swap_b32 v137, v139
    v_pk_add_f32 v[136:137], v[136:137], v[138:139]
    v_pk_add_f32 v[136:137], v[136:137], v[140:141]
    s_nop 1
    v_permlane16_swap_b32 v136, v137
    v_add_f32_e64 v136, v136, v137
    ds_write_b32 v206, v136 offset:32768
    s_mov_b32 s96, 12161024
    buffer_load_dwordx4 v[240:243], v56, s[16:19], s96 offen offset:0 sc1
    buffer_load_dwordx4 v[244:247], v56, s[16:19], s96 offen offset:256 sc1
    s_mov_b32 s96, 12060672
    buffer_load_dwordx2 v[248:249], v57, s[16:19], s96 offen offset:0 sc1
    buffer_load_dwordx2 v[252:253], v57, s[16:19], s96 offen offset:128 sc1
    s_mov_b32 s96, 12077056
    buffer_load_dwordx2 v[250:251], v57, s[16:19], s96 offen offset:0 sc1
    buffer_load_dwordx2 v[254:255], v57, s[16:19], s96 offen offset:128 sc1
    s_mov_b32 s96, 9439232
    buffer_load_dwordx4 v[208:211], v59, s[16:19], s96 offen sc1
    s_add_u32 s97, s36, 9439232
    buffer_load_dword v212, v61, s[16:19], s97 offen sc1
    s_waitcnt lgkmcnt(0)
    s_barrier
    ds_read2st64_b32 v[136:137], v207 offset0:0 offset1:1
    ds_read2st64_b32 v[138:139], v207 offset0:2 offset1:3
    ds_read_b64_tr_b16 v[144:145], v65 offset:32
    ds_read_b64_tr_b16 v[146:147], v65 offset:0
    ds_read_b64_tr_b16 v[148:149], v65 offset:160
    ds_read_b64_tr_b16 v[150:151], v65 offset:128
    ds_read_b64_tr_b16 v[152:153], v65 offset:288
    ds_read_b64_tr_b16 v[154:155], v65 offset:256
    ds_read_b64_tr_b16 v[156:157], v65 offset:416
    ds_read_b64_tr_b16 v[158:159], v65 offset:384
    ds_read_b64_tr_b16 v[160:161], v65 offset:544
    ds_read_b64_tr_b16 v[162:163], v65 offset:512
    ds_read_b64_tr_b16 v[164:165], v65 offset:672
    ds_read_b64_tr_b16 v[166:167], v65 offset:640
    ds_read_b64_tr_b16 v[168:169], v65 offset:800
    ds_read_b64_tr_b16 v[170:171], v65 offset:768
    ds_read_b64_tr_b16 v[172:173], v65 offset:928
    ds_read_b64_tr_b16 v[174:175], v65 offset:896
    s_waitcnt lgkmcnt(15)
    v_pk_add_f32 v[136:137], v[136:137], v[138:139]
    v_add_f32 v136, v136, v137
    v_cndmask_b32 v136, v136, 1.0, s[28:29]
    s_mov_b64 exec, s[80:81]
    buffer_atomic_add_f32 v136, v214, s[16:19], s27 offen
    s_mov_b64 exec, -1
    v_lshrrev_b32 v176, 4, v0
    v_mul_u32_u24 v176, 1216, v176
    v_and_b32 v177, 15, v0
    v_lshl_add_u32 v176, v177, 3, v176
    v_add_u32 v176, 64, v176
    v_mov_b32 v178, 0
    v_mov_b32 v179, 0
    ds_write_b64 v176, v[178:179]
    v_mov_b32 v70, 0
    v_mov_b32 v71, 0
    v_mov_b32 v72, 0
oe_78:
    s_waitcnt vmcnt(16)
    v_mfma_f32_16x16x32_bf16 v[112:115], a[176:179], v[216:219], 0
    v_mov_b32 v136, 0
    v_mov_b32 v137, 0
    s_waitcnt vmcnt(15)
    v_mfma_f32_16x16x32_bf16 v[116:119], a[176:179], v[220:223], 0
    v_mov_b32 v138, 0
    v_mov_b32 v139, 0
    s_waitcnt vmcnt(14)
    v_mfma_f32_16x16x32_bf16 v[112:115], a[196:199], v[224:227], v[112:115]
    v_mov_b32 v140, 0
    v_mov_b32 v141, 0
    s_waitcnt vmcnt(13)
    v_mfma_f32_16x16x32_bf16 v[116:119], a[196:199], v[228:231], v[116:119]
    s_mov_b32 s25, 14682112
    s_add_u32 s26, s36, 14682112
    s_waitcnt vmcnt(12)
    v_mfma_f32_16x16x32_bf16 v[112:115], a[216:219], v[232:235], v[112:115]
    s_add_u32 s27, s35, 3510272
    s_mov_b32 s28, 0x99999999
    s_waitcnt vmcnt(11)
    v_mfma_f32_16x16x32_bf16 v[116:119], a[216:219], v[236:239], v[116:119]
    s_mov_b32 s29, 0x99999999
    s_waitcnt vmcnt(8)
    v_mfma_f32_16x16x32_bf16 v[112:115], a[236:239], v[240:243], v[112:115]
    s_waitcnt vmcnt(7)
    v_mfma_f32_16x16x32_bf16 v[116:119], a[236:239], v[244:247], v[116:119]
    s_waitcnt vmcnt(4)
    v_mfma_f32_16x16x32_bf16 v[112:115], v[52:55], v[248:251], v[112:115]
    s_waitcnt vmcnt(3)
    v_mfma_f32_16x16x32_bf16 v[116:119], v[52:55], v[252:255], v[116:119]
    v_mfma_f32_16x16x32_bf16 v[88:91], a[164:167], v[216:219], 0
    v_mfma_f32_16x16x32_bf16 v[92:95], a[164:167], v[220:223], 0
    v_mfma_f32_16x16x32_bf16 v[88:91], a[184:187], v[224:227], v[88:91]
    s_waitcnt vmcnt(2)
    v_max3_u32 v132, v208, v209, v210
    s_waitcnt vmcnt(1)
    v_max3_u32 v132, v132, v211, v212
    v_mfma_f32_16x16x32_bf16 v[92:95], a[184:187], v[228:231], v[92:95]
    v_cmp_eq_u32 s[82:83], -1, v132
    v_mfma_f32_16x16x32_bf16 v[88:91], a[204:207], v[232:235], v[88:91]
    v_mfma_f32_16x16x32_bf16 v[92:95], a[204:207], v[236:239], v[92:95]
    v_cmp_u_f32 vcc, v112, v116
    s_nop 0
    s_or_b64 vcc, vcc, s[82:83]
    s_cbranch_vccnz rd_79
rc_80:
    v_mfma_f32_16x16x32_bf16 v[88:91], a[224:227], v[240:243], v[88:91]
    ds_write_b128 v203, v[112:115] offset:24576
    v_mfma_f32_16x16x32_bf16 v[92:95], a[224:227], v[244:247], v[92:95]
    v_mfma_f32_16x16x32_bf16 v[88:91], a[244:247], v[248:251], v[88:91]
    ds_write_b128 v203, v[116:119] offset:25600
    v_mfma_f32_16x16x32_bf16 v[92:95], a[244:247], v[252:255], v[92:95]
    v_mfma_f32_16x16x32_bf16 v[96:99], a[168:171], v[216:219], 0
    v_lshlrev_b32_e64 v120, 16, v208
    v_and_b32 v121, 0xffff0000, v208
    v_mfma_f32_16x16x32_bf16 v[100:103], a[168:171], v[220:223], 0
    v_lshlrev_b32_e64 v122, 16, v209
    v_and_b32 v123, 0xffff0000, v209
    v_mfma_f32_16x16x32_bf16 v[96:99], a[188:191], v[224:227], v[96:99]
    v_lshlrev_b32_e64 v124, 16, v210
    v_and_b32 v125, 0xffff0000, v210
    v_mfma_f32_16x16x32_bf16 v[100:103], a[188:191], v[228:231], v[100:103]
    v_lshlrev_b32_e64 v126, 16, v211
    v_and_b32 v127, 0xffff0000, v211
    v_mfma_f32_16x16x32_bf16 v[96:99], a[208:211], v[232:235], v[96:99]
    v_lshlrev_b32_e64 v128, 16, v212
    v_and_b32 v129, 0xffff0000, v212
    v_mfma_f32_16x16x32_bf16 v[100:103], a[208:211], v[236:239], v[100:103]
    v_mfma_f32_16x16x32_bf16 v[96:99], a[228:231], v[240:243], v[96:99]
    ds_write_b128 v200, v[88:91] offset:0
    v_mfma_f32_16x16x32_bf16 v[100:103], a[228:231], v[244:247], v[100:103]
    v_mfma_f32_16x16x32_bf16 v[96:99], a[248:251], v[248:251], v[96:99]
    ds_write_b128 v200, v[92:95] offset:1024
    v_mfma_f32_16x16x32_bf16 v[100:103], a[248:251], v[252:255], v[100:103]
    v_mfma_f32_16x16x32_bf16 v[104:107], a[172:175], v[216:219], 0
    v_mfma_f32_16x16x32_bf16 v[108:111], a[172:175], v[220:223], 0
    v_mfma_f32_16x16x32_bf16 v[104:107], a[192:195], v[224:227], v[104:107]
    v_mfma_f32_16x16x32_bf16 v[108:111], a[192:195], v[228:231], v[108:111]
    v_mfma_f32_16x16x32_bf16 v[104:107], a[212:215], v[232:235], v[104:107]
    v_mfma_f32_16x16x32_bf16 v[108:111], a[212:215], v[236:239], v[108:111]
    v_mfma_f32_16x16x32_bf16 v[104:107], a[232:235], v[240:243], v[104:107]
    ds_write_b128 v201, v[96:99] offset:2048
    v_mfma_f32_16x16x32_bf16 v[108:111], a[232:235], v[244:247], v[108:111]
    v_mfma_f32_16x16x32_bf16 v[104:107], a[252:255], v[248:251], v[104:107]
    ds_write_b128 v201, v[100:103] offset:3072
    v_mfma_f32_16x16x32_bf16 v[108:111], a[252:255], v[252:255], v[108:111]
    v_mfma_f32_16x16x32_bf16 v[80:83], a[160:163], v[216:219], v[120:123]
    v_mfma_f32_16x16x32_bf16 v[84:87], a[160:163], v[220:223], v[124:127]
    v_mfma_f32_16x16x32_bf16 v[80:83], a[180:183], v[224:227], v[80:83]
    v_mfma_f32_16x16x32_bf16 v[84:87], a[180:183], v[228:231], v[84:87]
    v_mfma_f32_16x16x32_bf16 v[80:83], a[200:203], v[232:235], v[80:83]
    s_nop 0
    ds_write_b128 v202, v[104:107] offset:4096
    v_mfma_f32_16x16x32_bf16 v[84:87], a[200:203], v[236:239], v[84:87]
    ds_write_b128 v202, v[108:111] offset:5120
    v_mfma_f32_16x16x32_bf16 v[80:83], a[220:223], v[240:243], v[80:83]
    v_mfma_f32_16x16x32_bf16 v[84:87], a[220:223], v[244:247], v[84:87]
    v_mfma_f32_16x16x32_bf16 v[80:83], a[240:243], v[248:251], v[80:83]
    v_mfma_f32_16x16x32_bf16 v[84:87], a[240:243], v[252:255], v[84:87]
    s_waitcnt lgkmcnt(0)
    s_barrier
    s_nop 0
    ds_read_b128 v[88:91], v204 offset:0
    ds_read_b128 v[92:95], v204 offset:1024
    ds_read_b128 v[96:99], v204 offset:2048
    ds_read_b128 v[100:103], v204 offset:3072
    ds_read_b128 v[104:107], v204 offset:4096
    ds_read_b128 v[108:111], v204 offset:5120
    ds_read_b64 v[112:113], v205 offset:24576
    ds_read_b64 v[114:115], v205 offset:26624
    ds_read_b64 v[116:117], v205 offset:28672
    ds_read_b64 v[118:119], v205 offset:30720
    s_lshl_b32 s96, s75, 14
    s_add_u32 s96, s96, 14680064
    s_lshl_b32 s97, s24, 12
    s_add_u32 s97, s97, 3506176
    buffer_load_dwordx4 v[176:179], v62, s[16:19], s96 offen offset:0 sc1
    buffer_load_dwordx4 v[180:183], v62, s[16:19], s96 offen offset:1024 sc1
    buffer_load_dwordx4 v[184:187], v62, s[16:19], s97 offen offset:0 sc1
    buffer_load_dwordx4 v[188:191], v62, s[16:19], s97 offen offset:1024 sc1
    buffer_load_dwordx4 v[192:195], v62, s[16:19], s97 offen offset:2048 sc1
    buffer_load_dwordx4 v[196:199], v62, s[16:19], s97 offen offset:3072 sc1
    s_waitcnt lgkmcnt(9)
    v_pk_add_f32 v[80:81], v[80:81], v[88:89]
    v_pk_add_f32 v[82:83], v[82:83], v[90:91]
    s_waitcnt lgkmcnt(8)
    v_pk_add_f32 v[84:85], v[84:85], v[92:93]
    v_pk_add_f32 v[86:87], v[86:87], v[94:95]
    s_waitcnt lgkmcnt(7)
    v_pk_add_f32 v[80:81], v[80:81], v[96:97]
    v_pk_add_f32 v[82:83], v[82:83], v[98:99]
    s_waitcnt lgkmcnt(6)
    v_pk_add_f32 v[84:85], v[84:85], v[100:101]
    v_pk_add_f32 v[86:87], v[86:87], v[102:103]
    s_waitcnt lgkmcnt(5)
    v_pk_add_f32 v[80:81], v[80:81], v[104:105]
    v_pk_add_f32 v[82:83], v[82:83], v[106:107]
    s_waitcnt lgkmcnt(4)
    v_pk_add_f32 v[84:85], v[84:85], v[108:109]
    v_pk_add_f32 v[86:87], v[86:87], v[110:111]
    v_cvt_pk_bf16_f32 v132, v80, v81
    v_cvt_pk_bf16_f32 v133, v82, v83
    v_cvt_pk_bf16_f32 v134, v84, v85
    v_cvt_pk_bf16_f32 v135, v86, v87
    s_waitcnt lgkmcnt(3)
    v_pk_add_f32 v[128:129], v[128:129], v[112:113]
    s_waitcnt lgkmcnt(2)
    v_pk_add_f32 v[128:129], v[128:129], v[114:115]
    s_waitcnt lgkmcnt(1)
    v_pk_add_f32 v[128:129], v[128:129], v[116:117]
    s_waitcnt lgkmcnt(0)
    v_pk_add_f32 v[128:129], v[128:129], v[118:119]
    v_cvt_pk_bf16_f32 v130, v128, v129
    buffer_store_dwordx4 v[132:135], v59, s[16:19], s25 offen sc1
    buffer_store_dword v130, v61, s[16:19], s26 offen sc1
    v_dot2c_f32_bf16 v136, v132, v215
    v_dot2c_f32_bf16 v137, v132, v132
    v_dot2c_f32_bf16 v136, v133, v215
    v_dot2c_f32_bf16 v137, v133, v133
    v_dot2c_f32_bf16 v138, v134, v215
    v_dot2c_f32_bf16 v139, v134, v134
    v_dot2c_f32_bf16 v138, v135, v215
    v_dot2c_f32_bf16 v139, v135, v135
    v_dot2c_f32_bf16 v140, v130, v215
    v_dot2c_f32_bf16 v141, v130, v130
    v_permlane32_swap_b32 v136, v138
    v_permlane32_swap_b32 v137, v139
    v_pk_add_f32 v[136:137], v[136:137], v[138:139]
    v_pk_add_f32 v[136:137], v[136:137], v[140:141]
    s_nop 1
    v_permlane16_swap_b32 v136, v137
    v_add_f32 v136, v136, v137
    ds_write_b32 v206, v136 offset:32768
    s_waitcnt lgkmcnt(0)
    s_barrier
    ds_read2st64_b32 v[136:137], v207 offset0:0 offset1:1
    ds_read2st64_b32 v[138:139], v207 offset0:2 offset1:3
    s_waitcnt lgkmcnt(0)
    v_pk_add_f32 v[136:137], v[136:137], v[138:139]
    v_add_f32 v136, v136, v137
    v_cndmask_b32 v136, v136, 1.0, s[28:29]
    s_mov_b64 exec, s[80:81]
    buffer_atomic_add_f32 v136, v214, s[16:19], s27 offen
    s_mov_b64 exec, -1
    s_cmp_ge_u32 s2, 160
    s_cbranch_scc1 nc_81
    s_waitcnt vmcnt(3)
ce_83:
    v_max3_u32 v208, v176, v177, v178
    v_max3_u32 v208, v208, v179, v180
    v_max3_u32 v208, v208, v181, v182
    v_max_u32 v208, v208, v183
    v_cmp_eq_u32 s[82:83], -1, v208
    v_min3_f32 v209, v184, v187, v188
    v_min3_f32 v209, v209, v191, v192
    v_min3_f32 v209, v209, v195, v196
    v_min_f32 v209, v209, v199
    v_cmp_neq_f32 vcc, 0x41000000, v209
    s_nop 0
    s_or_b64 vcc, vcc, s[82:83]
    s_cbranch_vccnz rd_84
rc_85:
    v_mul_f32 v208, 0x3acccccd, v185
    v_mul_f32 v209, 0x3acccccd, v189
    v_mul_f32 v186, 0x3acccccd, v186
    v_mul_f32 v190, 0x3acccccd, v190
    v_fma_f32 v186, -v208, v208, v186
    v_fma_f32 v190, -v209, v209, v190
    v_max_f32 v186, 0, v186
    v_max_f32 v190, 0, v190
    v_add_f32 v186, 0x3727c5ac, v186
    v_add_f32 v190, 0x3727c5ac, v190
    v_rsq_f32 v185, v186
    v_rsq_f32 v189, v190
    v_mul_f32 v186, -v208, v185
    v_mul_f32 v190, -v209, v189
    v_lshlrev_b32 v80, 16, v176
    v_and_b32 v82, 0xffff0000, v176
    v_lshlrev_b32 v84, 16, v177
    v_and_b32 v86, 0xffff0000, v177
    v_lshlrev_b32 v81, 16, v178
    v_and_b32 v83, 0xffff0000, v178
    v_lshlrev_b32 v85, 16, v179
    v_and_b32 v87, 0xffff0000, v179
    v_fma_f32 v208, v80, v185, v186
    v_fma_f32 v209, v81, v189, v190
    v_cvt_pk_bf16_f32 v176, v208, v209
    v_fma_f32 v208, v82, v185, v186
    v_fma_f32 v209, v83, v189, v190
    v_cvt_pk_bf16_f32 v177, v208, v209
    v_fma_f32 v208, v84, v185, v186
    v_fma_f32 v209, v85, v189, v190
    v_cvt_pk_bf16_f32 v178, v208, v209
    v_fma_f32 v208, v86, v185, v186
    v_fma_f32 v209, v87, v189, v190
    v_cvt_pk_bf16_f32 v179, v208, v209
    ds_write_b32 v63, v176 offset:0
    ds_write_b32 v63, v177 offset:4864
    ds_write_b32 v63, v178 offset:9728
    ds_write_b32 v63, v179 offset:14592
    v_mul_f32 v208, 0x3acccccd, v193
    v_mul_f32 v209, 0x3acccccd, v197
    v_mul_f32 v194, 0x3acccccd, v194
    v_mul_f32 v198, 0x3acccccd, v198
    v_fma_f32 v194, -v208, v208, v194
    v_fma_f32 v198, -v209, v209, v198
    v_max_f32 v194, 0, v194
    v_max_f32 v198, 0, v198
    v_add_f32 v194, 0x3727c5ac, v194
    v_add_f32 v198, 0x3727c5ac, v198
    v_rsq_f32 v193, v194
    v_rsq_f32 v197, v198
    v_mul_f32 v194, -v208, v193
    v_mul_f32 v198, -v209, v197
    v_lshlrev_b32 v88, 16, v180
    v_and_b32 v90, 0xffff0000, v180
    v_lshlrev_b32 v92, 16, v181
    v_and_b32 v94, 0xffff0000, v181
    v_lshlrev_b32 v89, 16, v182
    v_and_b32 v91, 0xffff0000, v182
    v_lshlrev_b32 v93, 16, v183
    v_and_b32 v95, 0xffff0000, v183
    v_fma_f32 v208, v88, v193, v194
    v_fma_f32 v209, v89, v197, v198
    v_cvt_pk_bf16_f32 v180, v208, v209
    v_fma_f32 v208, v90, v193, v194
    v_fma_f32 v209, v91, v197, v198
    v_cvt_pk_bf16_f32 v181, v208, v209
    v_fma_f32 v208, v92, v193, v194
    v_fma_f32 v209, v93, v197, v198
    v_cvt_pk_bf16_f32 v182, v208, v209
    v_fma_f32 v208, v94, v193, v194
    v_fma_f32 v209, v95, v197, v198
    v_cvt_pk_bf16_f32 v183, v208, v209
    ds_write_b32 v63, v180 offset:256
    ds_write_b32 v63, v181 offset:5120
    ds_write_b32 v63, v182 offset:9984
    ds_write_b32 v63, v183 offset:14848
    s_waitcnt lgkmcnt(0)
    s_barrier
    ds_read_b128 v[212:215], v64 offset:96
    ds_read_b128 v[216:219], v64 offset:64
    ds_read_b128 v[220:223], v64 offset:32
    ds_read_b128 v[224:227], v64 offset:0
    s_waitcnt lgkmcnt(3)
    v_mfma_f32_32x32x16_bf16 v[96:111], v[212:215], v[144:147], 0
    ds_read_b128 v[228:231], v64 offset:224
    ds_read_b64_tr_b16 v[176:177], v65 offset:1056
    ds_read_b64_tr_b16 v[178:179], v65 offset:1024
    ds_read_b64_tr_b16 v[180:181], v65 offset:1184
    ds_read_b64_tr_b16 v[182:183], v65 offset:1152
    s_waitcnt lgkmcnt(7)
    v_mfma_f32_32x32x16_bf16 v[96:111], v[216:219], v[148:151], v[96:111]
    ds_read_b128 v[232:235], v64 offset:192
    ds_read_b64_tr_b16 v[184:185], v65 offset:1312
    ds_read_b64_tr_b16 v[186:187], v65 offset:1280
    ds_read_b64_tr_b16 v[188:189], v65 offset:1440
    ds_read_b64_tr_b16 v[190:191], v65 offset:1408
    s_waitcnt lgkmcnt(11)
    v_mfma_f32_32x32x16_bf16 v[96:111], v[220:223], v[152:155], v[96:111]
    ds_read_b128 v[236:239], v64 offset:160
    ds_read_b64_tr_b16 v[192:193], v65 offset:1568
    ds_read_b64_tr_b16 v[194:195], v65 offset:1536
    ds_read_b64_tr_b16 v[196:197], v65 offset:1696
    ds_read_b64_tr_b16 v[198:199], v65 offset:1664
    s_waitcnt lgkmcnt(15)
    v_mfma_f32_32x32x16_bf16 v[96:111], v[224:227], v[156:159], v[96:111]
    ds_read_b128 v[240:243], v64 offset:128
    ds_read_b64_tr_b16 v[200:201], v65 offset:1824
    ds_read_b64_tr_b16 v[202:203], v65 offset:1792
    ds_read_b64_tr_b16 v[204:205], v65 offset:1952
    ds_read_b64_tr_b16 v[206:207], v65 offset:1920
    s_waitcnt lgkmcnt(15)
    v_mfma_f32_32x32x16_bf16 v[112:127], v[228:231], v[144:147], 0
    s_nop 4
    s_waitcnt lgkmcnt(14)
    v_mfma_f32_32x32x16_bf16 v[112:127], v[232:235], v[148:151], v[112:127]
    v_cndmask_b32 v208, v99, v72, s[76:77]
    v_cndmask_b32 v209, v103, v99, s[76:77]
    v_cndmask_b32 v210, v107, v103, s[76:77]
    v_cndmask_b32 v211, v111, v107, s[76:77]
    v_mov_b32_e64 v72, v111
    s_waitcnt lgkmcnt(9)
    v_mfma_f32_32x32x16_bf16 v[112:127], v[236:239], v[152:155], v[112:127]
    v_add_f32_dpp v98, v208, v98 wave_ror:1 row_mask:0xf bank_mask:0xf
    v_add_f32_dpp v102, v209, v102 wave_ror:1 row_mask:0xf bank_mask:0xf
    v_add_f32_dpp v106, v210, v106 wave_ror:1 row_mask:0xf bank_mask:0xf
    v_add_f32_dpp v110, v211, v110 wave_ror:1 row_mask:0xf bank_mask:0xf
    v_cndmask_b32 v208, v98, v71, s[76:77]
    s_waitcnt lgkmcnt(4)
    v_mfma_f32_32x32x16_bf16 v[112:127], v[240:243], v[156:159], v[112:127]
    v_cndmask_b32 v209, v102, v98, s[76:77]
    v_cndmask_b32 v210, v106, v102, s[76:77]
    v_cndmask_b32 v211, v110, v106, s[76:77]
    v_mov_b32 v71, v110
    v_add_f32_dpp v97, v208, v97 wave_ror:1 row_mask:0xf bank_mask:0xf
    v_add_f32_dpp v101, v209, v101 wave_ror:1 row_mask:0xf bank_mask:0xf
    v_mfma_f32_32x32x16_bf16 v[112:127], v[212:215], v[160:163], v[112:127]
    ds_read_b128 v[244:247], v64 offset:352
    v_add_f32_dpp v105, v210, v105 wave_ror:1 row_mask:0xf bank_mask:0xf
    v_add_f32_dpp v109, v211, v109 wave_ror:1 row_mask:0xf bank_mask:0xf
    v_cndmask_b32 v208, v97, v70, s[76:77]
    v_cndmask_b32 v209, v101, v97, s[76:77]
    v_cndmask_b32 v210, v105, v101, s[76:77]
    v_mfma_f32_32x32x16_bf16 v[112:127], v[216:219], v[164:167], v[112:127]
    ds_read_b128 v[216:219], v64 offset:320
    v_cndmask_b32 v211, v109, v105, s[76:77]
    v_mov_b32_e64 v70, v109
    v_add_f32_dpp v96, v208, v96 wave_ror:1 row_mask:0xf bank_mask:0xf
    v_add_f32_dpp v100, v209, v100 wave_ror:1 row_mask:0xf bank_mask:0xf
    v_add_f32_dpp v104, v210, v104 wave_ror:1 row_mask:0xf bank_mask:0xf
    v_mfma_f32_32x32x16_bf16 v[112:127], v[220:223], v[168:171], v[112:127]
    ds_read_b128 v[220:223], v64 offset:288
    v_add_f32_dpp v108, v211, v108 wave_ror:1 row_mask:0xf bank_mask:0xf
    ds_write_b32 v66, v96 offset:0
    v_mfma_f32_32x32x16_bf16 v[112:127], v[224:227], v[172:175], v[112:127]
    ds_read_b128 v[224:227], v64 offset:256
    ds_write_b32 v66, v100 offset:64
    ds_write_b32 v66, v104 offset:128
    s_waitcnt lgkmcnt(6)
    v_mfma_f32_32x32x16_bf16 v[128:143], v[244:247], v[144:147], 0
    ds_write_b32 v66, v108 offset:192
    s_nop 2
    s_waitcnt lgkmcnt(6)
    v_mfma_f32_32x32x16_bf16 v[128:143], v[216:219], v[148:151], v[128:143]
    s_nop 2
    v_cndmask_b32 v208, v115, v72, s[76:77]
    v_cndmask_b32 v209, v119, v115, s[76:77]
    s_waitcnt lgkmcnt(5)
    v_mfma_f32_32x32x16_bf16 v[128:143], v[220:223], v[152:155], v[128:143]
    v_cndmask_b32 v210, v123, v119, s[76:77]
    v_cndmask_b32 v211, v127, v123, s[76:77]
    v_mov_b32 v72, v127
    v_add_f32_dpp v114, v208, v114 wave_ror:1 row_mask:0xf bank_mask:0xf
    v_add_f32_dpp v118, v209, v118 wave_ror:1 row_mask:0xf bank_mask:0xf
    s_waitcnt lgkmcnt(3)
    v_mfma_f32_32x32x16_bf16 v[128:143], v[224:227], v[156:159], v[128:143]
    v_add_f32_dpp v122, v210, v122 wave_ror:1 row_mask:0xf bank_mask:0xf
    v_add_f32_dpp v126, v211, v126 wave_ror:1 row_mask:0xf bank_mask:0xf
    v_cndmask_b32 v208, v114, v71, s[76:77]
    v_cndmask_b32 v209, v118, v114, s[76:77]
    v_cndmask_b32 v210, v122, v118, s[76:77]
    v_cndmask_b32 v211, v126, v122, s[76:77]
    v_mfma_f32_32x32x16_bf16 v[128:143], v[228:231], v[160:163], v[128:143]
    v_mov_b32 v71, v126
    v_add_f32_dpp v113, v208, v113 wave_ror:1 row_mask:0xf bank_mask:0xf
    v_add_f32_dpp v117, v209, v117 wave_ror:1 row_mask:0xf bank_mask:0xf
    v_add_f32_dpp v121, v210, v121 wave_ror:1 row_mask:0xf bank_mask:0xf
    v_add_f32_dpp v125, v211, v125 wave_ror:1 row_mask:0xf bank_mask:0xf
    v_cndmask_b32 v208, v113, v70, s[76:77]
    v_mfma_f32_32x32x16_bf16 v[128:143], v[232:235], v[164:167], v[128:143]
    ds_read_b128 v[232:235], v64 offset:64
    v_cndmask_b32 v209, v117, v113, s[76:77]
    v_cndmask_b32 v210, v121, v117, s[76:77]
    v_cndmask_b32 v211, v125, v121, s[76:77]
    v_mov_b32_e64 v70, v125
    v_add_f32_dpp v112, v208, v112 wave_ror:1 row_mask:0xf bank_mask:0xf
    v_mfma_f32_32x32x16_bf16 v[128:143], v[236:239], v[168:171], v[128:143]
    ds_read_b128 v[236:239], v64 offset:32
    v_add_f32_dpp v116, v209, v116 wave_ror:1 row_mask:0xf bank_mask:0xf
    v_add_f32_dpp v120, v210, v120 wave_ror:1 row_mask:0xf bank_mask:0xf
    v_add_f32_dpp v124, v211, v124 wave_ror:1 row_mask:0xf bank_mask:0xf
    v_mfma_f32_32x32x16_bf16 v[128:143], v[240:243], v[172:175], v[128:143]
    ds_read_b128 v[240:243], v64 offset:0
    ds_write_b32 v66, v112 offset:256
    ds_write_b32 v66, v116 offset:320
    v_mfma_f32_32x32x16_bf16 v[128:143], v[212:215], v[176:179], v[128:143]
    ds_read_b128 v[212:215], v64 offset:480
    ds_write_b32 v66, v120 offset:384
    ds_write_b32 v66, v124 offset:448
    s_waitcnt lgkmcnt(7)
    v_mfma_f32_32x32x16_bf16 v[128:143], v[232:235], v[180:183], v[128:143]
    ds_read_b128 v[232:235], v64 offset:448
    s_waitcnt lgkmcnt(7)
    v_mfma_f32_32x32x16_bf16 v[128:143], v[236:239], v[184:187], v[128:143]
    ds_read_b128 v[236:239], v64 offset:416
    s_waitcnt lgkmcnt(7)
    v_mfma_f32_32x32x16_bf16 v[128:143], v[240:243], v[188:191], v[128:143]
    ds_read_b128 v[240:243], v64 offset:384
    s_nop 3
    s_waitcnt lgkmcnt(5)
    v_mfma_f32_32x32x16_bf16 v[112:127], v[212:215], v[144:147], 0
    s_nop 4
    s_waitcnt lgkmcnt(2)
    v_mfma_f32_32x32x16_bf16 v[112:127], v[232:235], v[148:151], v[112:127]
    v_cndmask_b32 v208, v131, v72, s[76:77]
    v_cndmask_b32 v209, v135, v131, s[76:77]
    v_cndmask_b32 v210, v139, v135, s[76:77]
    v_cndmask_b32 v211, v143, v139, s[76:77]
    v_mov_b32_e64 v72, v143
    s_waitcnt lgkmcnt(1)
    v_mfma_f32_32x32x16_bf16 v[112:127], v[236:239], v[152:155], v[112:127]
    v_add_f32_dpp v130, v208, v130 wave_ror:1 row_mask:0xf bank_mask:0xf
    v_add_f32_dpp v134, v209, v134 wave_ror:1 row_mask:0xf bank_mask:0xf
    v_add_f32_dpp v138, v210, v138 wave_ror:1 row_mask:0xf bank_mask:0xf
    v_add_f32_dpp v142, v211, v142 wave_ror:1 row_mask:0xf bank_mask:0xf
    v_cndmask_b32 v208, v130, v71, s[76:77]
    s_waitcnt lgkmcnt(0)
    v_mfma_f32_32x32x16_bf16 v[112:127], v[240:243], v[156:159], v[112:127]
    v_cndmask_b32 v209, v134, v130, s[76:77]
    v_cndmask_b32 v210, v138, v134, s[76:77]
    v_cndmask_b32 v211, v142, v138, s[76:77]
    v_mov_b32 v71, v142
    v_add_f32_dpp v129, v208, v129 wave_ror:1 row_mask:0xf bank_mask:0xf
    v_add_f32_dpp v133, v209, v133 wave_ror:1 row_mask:0xf bank_mask:0xf
    v_mfma_f32_32x32x16_bf16 v[112:127], v[244:247], v[160:163], v[112:127]
    v_add_f32_dpp v137, v210, v137 wave_ror:1 row_mask:0xf bank_mask:0xf
    v_add_f32_dpp v141, v211, v141 wave_ror:1 row_mask:0xf bank_mask:0xf
    v_cndmask_b32 v208, v129, v70, s[76:77]
    v_cndmask_b32 v209, v133, v129, s[76:77]
    v_cndmask_b32 v210, v137, v133, s[76:77]
    v_cndmask_b32 v211, v141, v137, s[76:77]
    v_mfma_f32_32x32x16_bf16 v[112:127], v[216:219], v[164:167], v[112:127]
    ds_read_b128 v[240:243], v64 offset:192
    v_mov_b32_e64 v70, v141
    v_add_f32_dpp v128, v208, v128 wave_ror:1 row_mask:0xf bank_mask:0xf
    v_add_f32_dpp v132, v209, v132 wave_ror:1 row_mask:0xf bank_mask:0xf
    v_add_f32_dpp v136, v210, v136 wave_ror:1 row_mask:0xf bank_mask:0xf
    v_add_f32_dpp v140, v211, v140 wave_ror:1 row_mask:0xf bank_mask:0xf
    v_mfma_f32_32x32x16_bf16 v[112:127], v[220:223], v[168:171], v[112:127]
    ds_read_b128 v[220:223], v64 offset:160
    ds_write_b32 v66, v128 offset:512
    ds_write_b32 v66, v132 offset:576
    v_mfma_f32_32x32x16_bf16 v[112:127], v[224:227], v[172:175], v[112:127]
    ds_read_b128 v[224:227], v64 offset:128
    ds_write_b32 v66, v136 offset:640
    ds_write_b32 v66, v140 offset:704
    v_mfma_f32_32x32x16_bf16 v[112:127], v[228:231], v[176:179], v[112:127]
    ds_read_b128 v[236:239], v64 offset:96
    s_waitcnt lgkmcnt(7)
    v_mfma_f32_32x32x16_bf16 v[112:127], v[240:243], v[180:183], v[112:127]
    ds_read_b128 v[240:243], v64 offset:64
    s_waitcnt lgkmcnt(7)
    v_mfma_f32_32x32x16_bf16 v[112:127], v[220:223], v[184:187], v[112:127]
    ds_read_b128 v[220:223], v64 offset:32
    s_waitcnt lgkmcnt(5)
    v_mfma_f32_32x32x16_bf16 v[112:127], v[224:227], v[188:191], v[112:127]
    ds_read_b128 v[224:227], v64 offset:0
    s_waitcnt lgkmcnt(3)
    v_mfma_f32_32x32x16_bf16 v[112:127], v[236:239], v[192:195], v[112:127]
    ds_read_b64_tr_b16 v[216:217], v65 offset:544
    ds_read_b64_tr_b16 v[218:219], v65 offset:512
    s_waitcnt lgkmcnt(4)
    v_mfma_f32_32x32x16_bf16 v[112:127], v[240:243], v[196:199], v[112:127]
    ds_read_b64_tr_b16 v[240:241], v65 offset:1056
    ds_read_b64_tr_b16 v[242:243], v65 offset:1024
    s_waitcnt lgkmcnt(5)
    v_mfma_f32_32x32x16_bf16 v[112:127], v[220:223], v[200:203], v[112:127]
    s_waitcnt lgkmcnt(4)
    v_mfma_f32_32x32x16_bf16 v[112:127], v[224:227], v[204:207], v[112:127]
    ds_read_b64_tr_b16 v[224:225], v65 offset:1568
    ds_read_b64_tr_b16 v[226:227], v65 offset:1536
    s_lshl_b32 s96, s75, 14
    s_add_u32 s96, s96, 14680064
    s_lshl_b32 s97, s24, 12
    s_add_u32 s97, s97, 3510272
    buffer_load_dwordx4 v[248:251], v62, s[16:19], s96 offen offset:2048 sc1
    s_waitcnt lgkmcnt(4)
    v_mfma_f32_32x32x16_bf16 v[144:159], v[212:215], v[216:219], 0
    s_nop 3
    v_cndmask_b32 v208, v115, v72, s[76:77]
    s_waitcnt lgkmcnt(2)
    v_mfma_f32_32x32x16_bf16 v[144:159], v[244:247], v[240:243], v[144:159]
    buffer_load_dwordx4 v[252:255], v62, s[16:19], s96 offen offset:3072 sc1
    v_cndmask_b32 v209, v119, v115, s[76:77]
    v_cndmask_b32 v210, v123, v119, s[76:77]
    v_cndmask_b32 v211, v127, v123, s[76:77]
    v_mov_b32_e64 v72, v127
    v_add_f32_dpp v114, v208, v114 wave_ror:1 row_mask:0xf bank_mask:0xf
    v_mfma_f32_32x32x16_bf16 v[160:175], v[212:215], v[240:243], 0
    ds_read_b64_tr_b16 v[216:217], v65 offset:2080
    ds_read_b64_tr_b16 v[218:219], v65 offset:2048
    v_add_f32_dpp v118, v209, v118 wave_ror:1 row_mask:0xf bank_mask:0xf
    v_add_f32_dpp v122, v210, v122 wave_ror:1 row_mask:0xf bank_mask:0xf
    v_add_f32_dpp v126, v211, v126 wave_ror:1 row_mask:0xf bank_mask:0xf
    s_waitcnt lgkmcnt(2)
    v_mfma_f32_32x32x16_bf16 v[144:159], v[228:231], v[224:227], v[144:159]
    buffer_load_dwordx4 v[96:99], v62, s[16:19], s97 offen offset:0 sc1
    v_cndmask_b32 v208, v114, v71, s[76:77]
    v_cndmask_b32 v209, v118, v114, s[76:77]
    v_cndmask_b32 v210, v122, v118, s[76:77]
    v_cndmask_b32 v211, v126, v122, s[76:77]
    v_mov_b32 v71, v126
    v_mfma_f32_32x32x16_bf16 v[160:175], v[244:247], v[224:227], v[160:175]
    v_add_f32_dpp v113, v208, v113 wave_ror:1 row_mask:0xf bank_mask:0xf
    v_add_f32_dpp v117, v209, v117 wave_ror:1 row_mask:0xf bank_mask:0xf
    v_add_f32_dpp v121, v210, v121 wave_ror:1 row_mask:0xf bank_mask:0xf
    v_add_f32_dpp v125, v211, v125 wave_ror:1 row_mask:0xf bank_mask:0xf
    v_cndmask_b32 v208, v113, v70, s[76:77]
    v_cndmask_b32 v209, v117, v113, s[76:77]
    v_mfma_f32_32x32x16_bf16 v[176:191], v[212:215], v[224:227], 0
    buffer_load_dwordx4 v[100:103], v62, s[16:19], s97 offen offset:1024 sc1
    v_cndmask_b32 v210, v121, v117, s[76:77]
    v_cndmask_b32 v211, v125, v121, s[76:77]
    v_mov_b32 v70, v125
    v_add_f32_dpp v112, v208, v112 wave_ror:1 row_mask:0xf bank_mask:0xf
    s_waitcnt lgkmcnt(0)
    v_mfma_f32_32x32x16_bf16 v[144:159], v[236:239], v[216:219], v[144:159]
    ds_read_b64_tr_b16 v[240:241], v65 offset:2592
    ds_read_b64_tr_b16 v[242:243], v65 offset:2560
    v_add_f32_dpp v116, v209, v116 wave_ror:1 row_mask:0xf bank_mask:0xf
    v_add_f32_dpp v120, v210, v120 wave_ror:1 row_mask:0xf bank_mask:0xf
    v_add_f32_dpp v124, v211, v124 wave_ror:1 row_mask:0xf bank_mask:0xf
    v_mfma_f32_32x32x16_bf16 v[160:175], v[228:231], v[216:219], v[160:175]
    buffer_load_dwordx4 v[104:107], v62, s[16:19], s97 offen offset:2048 sc1
    ds_write_b32 v66, v112 offset:768
    ds_write_b32 v66, v116 offset:832
    v_mfma_f32_32x32x16_bf16 v[176:191], v[244:247], v[216:219], v[176:191]
    ds_write_b32 v66, v120 offset:896
    ds_write_b32 v66, v124 offset:960
    v_mfma_f32_32x32x16_bf16 v[192:207], v[212:215], v[216:219], 0
    ds_read_b64_tr_b16 v[212:213], v65 offset:3104
    ds_read_b64_tr_b16 v[214:215], v65 offset:3072
    buffer_load_dwordx4 v[108:111], v62, s[16:19], s97 offen offset:3072 sc1
    s_waitcnt lgkmcnt(6)
    v_mfma_f32_32x32x16_bf16 v[160:175], v[236:239], v[240:243], v[160:175]
    v_mfma_f32_32x32x16_bf16 v[176:191], v[228:231], v[240:243], v[176:191]
    ds_read_b64_tr_b16 v[224:225], v65 offset:3616
    ds_read_b64_tr_b16 v[226:227], v65 offset:3584
    s_waitcnt lgkmcnt(4)
    s_barrier
    v_mfma_f32_32x32x16_bf16 v[192:207], v[244:247], v[240:243], v[192:207]
    ds_read_b64_tr_b16 v[244:245], v65 offset:672
    ds_read_b64_tr_b16 v[246:247], v65 offset:640
    ds_read_b64 v[112:113], v67 offset:0
    ds_read_b64 v[114:115], v67 offset:4224
    ds_read_b64 v[116:117], v67 offset:8448
    s_waitcnt lgkmcnt(7)
    v_mfma_f32_32x32x16_bf16 v[176:191], v[236:239], v[212:215], v[176:191]
    ds_read_b128 v[216:219], v64 offset:320
    ds_read_b64_tr_b16 v[240:241], v65 offset:1184
    ds_read_b64_tr_b16 v[242:243], v65 offset:1152
    ds_read_b64 v[118:119], v67 offset:12672
    ds_read_b64 v[120:121], v67 offset:512
    ds_read_b64 v[122:123], v67 offset:4736
    v_mfma_f32_32x32x16_bf16 v[192:207], v[228:231], v[212:215], v[192:207]
    ds_read_b64 v[124:125], v67 offset:8960
    ds_read_b64 v[126:127], v67 offset:13184
    s_waitcnt lgkmcnt(13)
    v_mfma_f32_32x32x16_bf16 v[192:207], v[236:239], v[224:227], v[192:207]
    ds_read_b128 v[228:231], v64 offset:192
    ds_read_b64_tr_b16 v[236:237], v65 offset:1696
    ds_read_b64_tr_b16 v[238:239], v65 offset:1664
    s_waitcnt lgkmcnt(14)
    v_mfma_f32_32x32x16_bf16 v[144:159], v[232:235], v[244:247], v[144:159]
    s_waitcnt lgkmcnt(8)
    v_mfma_f32_32x32x16_bf16 v[144:159], v[216:219], v[240:243], v[144:159]
    v_mfma_f32_32x32x16_bf16 v[160:175], v[232:235], v[240:243], v[160:175]
    ds_read_b128 v[212:215], v64 offset:64
    ds_read_b64_tr_b16 v[224:225], v65 offset:2208
    ds_read_b64_tr_b16 v[226:227], v65 offset:2176
    s_waitcnt lgkmcnt(6)
    v_add_f32 v112, v112, v80
    s_waitcnt lgkmcnt(3)
    v_mfma_f32_32x32x16_bf16 v[144:159], v[228:231], v[236:239], v[144:159]
    v_add_f32 v113, v113, v81
    v_add_f32 v114, v114, v82
    v_add_f32 v115, v115, v83
    v_add_f32 v116, v116, v84
    v_add_f32 v117, v117, v85
    v_add_f32 v118, v118, v86
    v_mfma_f32_32x32x16_bf16 v[160:175], v[216:219], v[236:239], v[160:175]
    v_add_f32_e64 v119, v119, v87
    v_cvt_pk_bf16_f32 v128, v112, v114
    v_cvt_pk_bf16_f32 v129, v116, v118
    v_cvt_pk_bf16_f32 v130, v113, v115
    v_cvt_pk_bf16_f32 v131, v117, v119
    s_mov_b32 s25, 0
    v_mfma_f32_32x32x16_bf16 v[176:191], v[232:235], v[236:239], v[176:191]
    buffer_store_dwordx2 v[128:129], v68, s[20:23], s25 offen
    s_mov_b32 s25, 5120
    buffer_store_dwordx2 v[130:131], v68, s[20:23], s25 offen
    v_add_f32 v120, v120, v88
    v_add_f32 v121, v121, v89
    s_waitcnt lgkmcnt(0)
    v_mfma_f32_32x32x16_bf16 v[144:159], v[212:215], v[224:227], v[144:159]
    ds_read_b64_tr_b16 v[244:245], v65 offset:2720
    ds_read_b64_tr_b16 v[246:247], v65 offset:2688
    v_add_f32 v122, v122, v90
    v_add_f32 v123, v123, v91
    v_add_f32 v124, v124, v92
    v_add_f32 v125, v125, v93
    v_mfma_f32_32x32x16_bf16 v[160:175], v[228:231], v[224:227], v[160:175]
    v_add_f32 v126, v126, v94
    v_add_f32 v127, v127, v95
    v_cvt_pk_bf16_f32 v132, v120, v122
    v_cvt_pk_bf16_f32 v133, v124, v126
    v_cvt_pk_bf16_f32 v134, v121, v123
    v_cvt_pk_bf16_f32 v135, v125, v127
    v_mfma_f32_32x32x16_bf16 v[176:191], v[216:219], v[224:227], v[176:191]
    s_mov_b32 s25, 655360
    buffer_store_dwordx2 v[132:133], v68, s[20:23], s25 offen
    s_mov_b32 s25, 660480
    buffer_store_dwordx2 v[134:135], v68, s[20:23], s25 offen
    ds_read_b64_tr_b16 v[112:113], v65 offset:32
    ds_read_b64_tr_b16 v[114:115], v65 offset:0
    v_mfma_f32_32x32x16_bf16 v[192:207], v[232:235], v[224:227], v[192:207]
    ds_read_b64_tr_b16 v[232:233], v65 offset:3232
    ds_read_b64_tr_b16 v[234:235], v65 offset:3200
    ds_read_b64_tr_b16 v[116:117], v65 offset:160
    ds_read_b64_tr_b16 v[118:119], v65 offset:128
    ds_read_b64_tr_b16 v[120:121], v65 offset:288
    s_waitcnt lgkmcnt(7)
    v_mfma_f32_32x32x16_bf16 v[160:175], v[212:215], v[244:247], v[160:175]
    ds_read_b64_tr_b16 v[122:123], v65 offset:256
    ds_read_b64_tr_b16 v[124:125], v65 offset:416
    ds_read_b64_tr_b16 v[126:127], v65 offset:384
    ds_read_b64_tr_b16 v[128:129], v65 offset:544
    ds_read_b64_tr_b16 v[130:131], v65 offset:512
    ds_read_b64_tr_b16 v[132:133], v65 offset:672
    v_mfma_f32_32x32x16_bf16 v[176:191], v[228:231], v[244:247], v[176:191]
    ds_read_b64_tr_b16 v[240:241], v65 offset:3744
    ds_read_b64_tr_b16 v[242:243], v65 offset:3712
    ds_read_b64_tr_b16 v[134:135], v65 offset:640
    ds_read_b64_tr_b16 v[136:137], v65 offset:800
    ds_read_b64_tr_b16 v[138:139], v65 offset:768
    ds_read_b64_tr_b16 v[140:141], v65 offset:928
    v_mfma_f32_32x32x16_bf16 v[192:207], v[216:219], v[244:247], v[192:207]
    ds_read_b128 v[216:219], v64 offset:416
    ds_read_b64_tr_b16 v[236:237], v65 offset:800
    ds_read_b64_tr_b16 v[238:239], v65 offset:768
    ds_read_b64_tr_b16 v[142:143], v65 offset:896
    s_waitcnt lgkmcnt(15)
    v_mfma_f32_32x32x16_bf16 v[176:191], v[212:215], v[232:235], v[176:191]
    ds_read_b128 v[224:227], v64 offset:288
    ds_read_b64_tr_b16 v[244:245], v65 offset:1312
    ds_read_b64_tr_b16 v[246:247], v65 offset:1280
    s_waitcnt vmcnt(4)
ce_86:
    v_max3_u32 v208, v248, v249, v250
    v_max3_u32 v208, v208, v251, v252
    v_max3_u32 v208, v208, v253, v254
    v_max_u32 v208, v208, v255
    v_cmp_eq_u32 s[82:83], -1, v208
    v_min3_f32 v209, v96, v99, v100
    v_min3_f32 v209, v209, v103, v104
    v_min3_f32 v209, v209, v107, v108
    v_min_f32 v209, v209, v111
    v_cmp_neq_f32 vcc, 0x41000000, v209
    s_nop 0
    s_or_b64 vcc, vcc, s[82:83]
    s_cbranch_vccnz rd_87
rc_88:
    v_mfma_f32_32x32x16_bf16 v[192:207], v[228:231], v[232:235], v[192:207]
    v_mul_f32 v208, 0x3acccccd, v97
    v_mul_f32 v209, 0x3acccccd, v101
    v_mul_f32 v98, 0x3acccccd, v98
    v_mul_f32 v102, 0x3acccccd, v102
    v_fma_f32 v98, -v208, v208, v98
    s_waitcnt lgkmcnt(11)
    v_mfma_f32_32x32x16_bf16 v[192:207], v[212:215], v[240:243], v[192:207]
    ds_read_b128 v[228:231], v64 offset:160
    ds_read_b64_tr_b16 v[212:213], v65 offset:1824
    ds_read_b64_tr_b16 v[214:215], v65 offset:1792
    v_fma_f32 v102, -v209, v209, v102
    v_max_f32 v98, 0, v98
    s_waitcnt lgkmcnt(7)
    v_mfma_f32_32x32x16_bf16 v[144:159], v[216:219], v[236:239], v[144:159]
    v_max_f32 v102, 0, v102
    v_add_f32 v98, 0x3727c5ac, v98
    v_add_f32 v102, 0x3727c5ac, v102
    v_rsq_f32 v97, v98
    s_waitcnt lgkmcnt(3)
    v_mfma_f32_32x32x16_bf16 v[144:159], v[224:227], v[244:247], v[144:159]
    v_rsq_f32_e64 v101, v102
    v_mul_f32 v98, -v208, v97
    v_mul_f32 v102, -v209, v101
    v_lshlrev_b32_e64 v80, 16, v248
    v_and_b32 v82, 0xffff0000, v248
    v_mfma_f32_32x32x16_bf16 v[160:175], v[216:219], v[244:247], v[160:175]
    ds_read_b64_tr_b16 v[232:233], v65 offset:2336
    ds_read_b64_tr_b16 v[234:235], v65 offset:2304
    v_lshlrev_b32 v84, 16, v249
    v_and_b32 v86, 0xffff0000, v249
    v_lshlrev_b32_e64 v81, 16, v250
    s_waitcnt lgkmcnt(2)
    v_mfma_f32_32x32x16_bf16 v[144:159], v[228:231], v[212:215], v[144:159]
    v_and_b32 v83, 0xffff0000, v250
    v_lshlrev_b32_e64 v85, 16, v251
    v_and_b32 v87, 0xffff0000, v251
    v_fma_f32 v208, v80, v97, v98
    v_fma_f32 v209, v81, v101, v102
    v_cvt_pk_bf16_f32 v248, v208, v209
    v_mfma_f32_32x32x16_bf16 v[160:175], v[224:227], v[212:215], v[160:175]
    v_fma_f32 v208, v82, v97, v98
    v_fma_f32 v209, v83, v101, v102
    v_cvt_pk_bf16_f32 v249, v208, v209
    v_fma_f32 v208, v84, v97, v98
    v_fma_f32 v209, v85, v101, v102
    v_cvt_pk_bf16_f32 v250, v208, v209
    v_mfma_f32_32x32x16_bf16 v[176:191], v[216:219], v[212:215], v[176:191]
    v_fma_f32 v208, v86, v97, v98
    v_fma_f32 v209, v87, v101, v102
    v_cvt_pk_bf16_f32 v251, v208, v209
    s_waitcnt lgkmcnt(0)
    v_mfma_f32_32x32x16_bf16 v[144:159], v[220:223], v[232:235], v[144:159]
    ds_read_b64_tr_b16 v[240:241], v65 offset:2848
    ds_read_b64_tr_b16 v[242:243], v65 offset:2816
    ds_write_b32 v63, v248 offset:512
    ds_write_b32 v63, v249 offset:5376
    v_mfma_f32_32x32x16_bf16 v[160:175], v[228:231], v[232:235], v[160:175]
    ds_write_b32 v63, v250 offset:10240
    ds_write_b32 v63, v251 offset:15104
    v_mul_f32 v208, 0x3acccccd, v105
    v_mul_f32 v209, 0x3acccccd, v109
    v_mfma_f32_32x32x16_bf16 v[176:191], v[224:227], v[232:235], v[176:191]
    v_mul_f32 v106, 0x3acccccd, v106
    v_mul_f32 v110, 0x3acccccd, v110
    v_fma_f32 v106, -v208, v208, v106
    v_fma_f32 v110, -v209, v209, v110
    v_max_f32 v106, 0, v106
    v_max_f32_e64 v110, 0, v110
    v_mfma_f32_32x32x16_bf16 v[192:207], v[216:219], v[232:235], v[192:207]
    ds_read_b64_tr_b16 v[216:217], v65 offset:3360
    ds_read_b64_tr_b16 v[218:219], v65 offset:3328
    v_add_f32 v106, 0x3727c5ac, v106
    v_add_f32 v110, 0x3727c5ac, v110
    s_waitcnt lgkmcnt(6)
    v_mfma_f32_32x32x16_bf16 v[160:175], v[220:223], v[240:243], v[160:175]
    v_rsq_f32 v105, v106
    v_rsq_f32_e64 v109, v110
    v_mul_f32 v106, -v208, v105
    v_mul_f32 v110, -v209, v109
    v_mfma_f32_32x32x16_bf16 v[176:191], v[228:231], v[240:243], v[176:191]
    ds_read_b64_tr_b16 v[236:237], v65 offset:3872
    ds_read_b64_tr_b16 v[238:239], v65 offset:3840
    v_lshlrev_b32 v88, 16, v252
    v_and_b32 v90, 0xffff0000, v252
    v_lshlrev_b32 v92, 16, v253
    v_and_b32 v94, 0xffff0000, v253
    v_mfma_f32_32x32x16_bf16 v[192:207], v[224:227], v[240:243], v[192:207]
    ds_read_b128 v[224:227], v64 offset:384
    ds_read_b64_tr_b16 v[244:245], v65 offset:928
    ds_read_b64_tr_b16 v[246:247], v65 offset:896
    v_lshlrev_b32 v89, 16, v254
    v_and_b32 v91, 0xffff0000, v254
    s_waitcnt lgkmcnt(5)
    v_mfma_f32_32x32x16_bf16 v[176:191], v[220:223], v[216:219], v[176:191]
    ds_read_b128 v[212:215], v64 offset:256
    ds_read_b64_tr_b16 v[232:233], v65 offset:1440
    ds_read_b64_tr_b16 v[234:235], v65 offset:1408
    v_lshlrev_b32_e64 v93, 16, v255
    v_and_b32 v95, 0xffff0000, v255
    v_fma_f32 v208, v88, v105, v106
    v_mfma_f32_32x32x16_bf16 v[192:207], v[228:231], v[216:219], v[192:207]
    v_fma_f32 v209, v89, v109, v110
    v_cvt_pk_bf16_f32 v252, v208, v209
    v_fma_f32 v208, v90, v105, v106
    v_fma_f32 v209, v91, v109, v110
    v_cvt_pk_bf16_f32 v253, v208, v209
    s_waitcnt lgkmcnt(6)
    v_mfma_f32_32x32x16_bf16 v[192:207], v[220:223], v[236:239], v[192:207]
    ds_read_b128 v[220:223], v64 offset:128
    ds_read_b64_tr_b16 v[228:229], v65 offset:1952
    ds_read_b64_tr_b16 v[230:231], v65 offset:1920
    v_fma_f32 v208, v92, v105, v106
    v_fma_f32 v209, v93, v109, v110
    s_waitcnt lgkmcnt(6)
    v_mfma_f32_32x32x16_bf16 v[144:159], v[224:227], v[244:247], v[144:159]
    v_cvt_pk_bf16_f32 v254, v208, v209
    v_fma_f32 v208, v94, v105, v106
    v_fma_f32 v209, v95, v109, v110
    v_cvt_pk_bf16_f32 v255, v208, v209
    s_waitcnt lgkmcnt(3)
    v_mfma_f32_32x32x16_bf16 v[144:159], v[212:215], v[232:235], v[144:159]
    ds_write_b32 v63, v252 offset:768
    ds_write_b32 v63, v253 offset:5632
    ds_write_b32 v63, v254 offset:10496
    v_mfma_f32_32x32x16_bf16 v[160:175], v[224:227], v[232:235], v[160:175]
    ds_read_b128 v[240:243], v64 offset:0
    ds_read_b64_tr_b16 v[216:217], v65 offset:2464
    ds_read_b64_tr_b16 v[218:219], v65 offset:2432
    ds_write_b32 v63, v255 offset:15360
    s_waitcnt lgkmcnt(7)
    v_mfma_f32_32x32x16_bf16 v[144:159], v[220:223], v[228:231], v[144:159]
    v_mfma_f32_32x32x16_bf16 v[160:175], v[212:215], v[228:231], v[160:175]
    v_mfma_f32_32x32x16_bf16 v[176:191], v[224:227], v[228:231], v[176:191]
    s_waitcnt lgkmcnt(1)
    v_mfma_f32_32x32x16_bf16 v[144:159], v[240:243], v[216:219], v[144:159]
    ds_read_b64_tr_b16 v[236:237], v65 offset:2976
    ds_read_b64_tr_b16 v[238:239], v65 offset:2944
    v_mfma_f32_32x32x16_bf16 v[160:175], v[220:223], v[216:219], v[160:175]
    v_mfma_f32_32x32x16_bf16 v[176:191], v[212:215], v[216:219], v[176:191]
    v_mfma_f32_32x32x16_bf16 v[192:207], v[224:227], v[216:219], v[192:207]
    ds_read_b64_tr_b16 v[224:225], v65 offset:3488
    ds_read_b64_tr_b16 v[226:227], v65 offset:3456
    s_waitcnt lgkmcnt(2)
    v_mfma_f32_32x32x16_bf16 v[160:175], v[240:243], v[236:239], v[160:175]
    v_mfma_f32_32x32x16_bf16 v[176:191], v[220:223], v[236:239], v[176:191]
    ds_read_b64_tr_b16 v[244:245], v65 offset:4000
    ds_read_b64_tr_b16 v[246:247], v65 offset:3968
    v_mfma_f32_32x32x16_bf16 v[192:207], v[212:215], v[236:239], v[192:207]
    s_waitcnt lgkmcnt(2)
    v_mfma_f32_32x32x16_bf16 v[176:191], v[240:243], v[224:227], v[176:191]
    v_mfma_f32_32x32x16_bf16 v[192:207], v[220:223], v[224:227], v[192:207]
    s_waitcnt lgkmcnt(0)
    v_mfma_f32_32x32x16_bf16 v[192:207], v[240:243], v[244:247], v[192:207]
    s_waitcnt lgkmcnt(0)
    s_barrier
    ds_read_b128 v[212:215], v64 offset:608
    ds_read_b128 v[216:219], v64 offset:576
    ds_read_b128 v[220:223], v64 offset:544
    ds_read_b128 v[224:227], v64 offset:512
    s_waitcnt lgkmcnt(3)
    v_mfma_f32_32x32x16_bf16 v[144:159], v[212:215], v[112:115], v[144:159]
    ds_read_b128 v[228:231], v64 offset:736
    s_waitcnt lgkmcnt(3)
    v_mfma_f32_32x32x16_bf16 v[144:159], v[216:219], v[116:119], v[144:159]
    ds_read_b128 v[232:235], v64 offset:704
    s_waitcnt lgkmcnt(3)
    v_mfma_f32_32x32x16_bf16 v[144:159], v[220:223], v[120:123], v[144:159]
    ds_read_b128 v[236:239], v64 offset:672
    s_waitcnt lgkmcnt(3)
    v_mfma_f32_32x32x16_bf16 v[144:159], v[224:227], v[124:127], v[144:159]
    ds_read_b128 v[240:243], v64 offset:640
    s_nop 3
    s_waitcnt lgkmcnt(3)
    v_mfma_f32_32x32x16_bf16 v[160:175], v[228:231], v[112:115], v[160:175]
    s_nop 4
    s_waitcnt lgkmcnt(2)
    v_mfma_f32_32x32x16_bf16 v[160:175], v[232:235], v[116:119], v[160:175]
    v_cndmask_b32 v208, v147, v72, s[76:77]
    v_cndmask_b32 v209, v151, v147, s[76:77]
    v_cndmask_b32 v210, v155, v151, s[76:77]
    v_cndmask_b32 v211, v159, v155, s[76:77]
    v_mov_b32 v72, v159
    s_waitcnt lgkmcnt(1)
    v_mfma_f32_32x32x16_bf16 v[160:175], v[236:239], v[120:123], v[160:175]
    v_add_f32_dpp v146, v208, v146 wave_ror:1 row_mask:0xf bank_mask:0xf
    v_add_f32_dpp v150, v209, v150 wave_ror:1 row_mask:0xf bank_mask:0xf
    v_add_f32_dpp v154, v210, v154 wave_ror:1 row_mask:0xf bank_mask:0xf
    v_add_f32_dpp v158, v211, v158 wave_ror:1 row_mask:0xf bank_mask:0xf
    v_cndmask_b32 v208, v146, v71, s[76:77]
    s_waitcnt lgkmcnt(0)
    v_mfma_f32_32x32x16_bf16 v[160:175], v[240:243], v[124:127], v[160:175]
    v_cndmask_b32 v209, v150, v146, s[76:77]
    v_cndmask_b32 v210, v154, v150, s[76:77]
    v_cndmask_b32 v211, v158, v154, s[76:77]
    v_mov_b32 v71, v158
    v_add_f32_dpp v145, v208, v145 wave_ror:1 row_mask:0xf bank_mask:0xf
    v_add_f32_dpp v149, v209, v149 wave_ror:1 row_mask:0xf bank_mask:0xf
    v_mfma_f32_32x32x16_bf16 v[160:175], v[212:215], v[128:131], v[160:175]
    ds_read_b128 v[244:247], v64 offset:864
    v_add_f32_dpp v153, v210, v153 wave_ror:1 row_mask:0xf bank_mask:0xf
    v_add_f32_dpp v157, v211, v157 wave_ror:1 row_mask:0xf bank_mask:0xf
    v_cndmask_b32 v208, v145, v70, s[76:77]
    v_cndmask_b32 v209, v149, v145, s[76:77]
    v_cndmask_b32 v210, v153, v149, s[76:77]
    v_mfma_f32_32x32x16_bf16 v[160:175], v[216:219], v[132:135], v[160:175]
    ds_read_b128 v[248:251], v64 offset:832
    v_cndmask_b32 v211, v157, v153, s[76:77]
    v_mov_b32_e64 v70, v157
    v_add_f32_dpp v144, v208, v144 wave_ror:1 row_mask:0xf bank_mask:0xf
    v_add_f32_dpp v148, v209, v148 wave_ror:1 row_mask:0xf bank_mask:0xf
    v_add_f32_dpp v152, v210, v152 wave_ror:1 row_mask:0xf bank_mask:0xf
    v_mfma_f32_32x32x16_bf16 v[160:175], v[220:223], v[136:139], v[160:175]
    ds_read_b128 v[252:255], v64 offset:800
    v_add_f32_dpp v156, v211, v156 wave_ror:1 row_mask:0xf bank_mask:0xf
    ds_write_b32 v66, v144 offset:0
    v_mfma_f32_32x32x16_bf16 v[160:175], v[224:227], v[140:143], v[160:175]
    ds_read_b128 v[224:227], v64 offset:768
    ds_write_b32 v66, v148 offset:64
    ds_write_b32 v66, v152 offset:128
    s_waitcnt lgkmcnt(6)
    v_mfma_f32_32x32x16_bf16 v[176:191], v[244:247], v[112:115], v[176:191]
    ds_write_b32 v66, v156 offset:192
    s_nop 2
    s_waitcnt lgkmcnt(6)
    v_mfma_f32_32x32x16_bf16 v[176:191], v[248:251], v[116:119], v[176:191]
    s_nop 2
    v_cndmask_b32 v208, v163, v72, s[76:77]
    v_cndmask_b32 v209, v167, v163, s[76:77]
    s_waitcnt lgkmcnt(5)
    v_mfma_f32_32x32x16_bf16 v[176:191], v[252:255], v[120:123], v[176:191]
    v_cndmask_b32 v210, v171, v167, s[76:77]
    v_cndmask_b32 v211, v175, v171, s[76:77]
    v_mov_b32 v72, v175
    v_add_f32_dpp v162, v208, v162 wave_ror:1 row_mask:0xf bank_mask:0xf
    v_add_f32_dpp v166, v209, v166 wave_ror:1 row_mask:0xf bank_mask:0xf
    s_waitcnt lgkmcnt(3)
    v_mfma_f32_32x32x16_bf16 v[176:191], v[224:227], v[124:127], v[176:191]
    v_add_f32_dpp v170, v210, v170 wave_ror:1 row_mask:0xf bank_mask:0xf
    v_add_f32_dpp v174, v211, v174 wave_ror:1 row_mask:0xf bank_mask:0xf
    v_cndmask_b32 v208, v162, v71, s[76:77]
    v_cndmask_b32 v209, v166, v162, s[76:77]
    v_cndmask_b32 v210, v170, v166, s[76:77]
    v_cndmask_b32 v211, v174, v170, s[76:77]
    v_mfma_f32_32x32x16_bf16 v[176:191], v[228:231], v[128:131], v[176:191]
    ds_read_b64_tr_b16 v[228:229], v65 offset:1056
    ds_read_b64_tr_b16 v[230:231], v65 offset:1024
    v_mov_b32 v71, v174
    v_add_f32_dpp v161, v208, v161 wave_ror:1 row_mask:0xf bank_mask:0xf
    v_add_f32_dpp v165, v209, v165 wave_ror:1 row_mask:0xf bank_mask:0xf
    v_add_f32_dpp v169, v210, v169 wave_ror:1 row_mask:0xf bank_mask:0xf
    v_mfma_f32_32x32x16_bf16 v[176:191], v[232:235], v[132:135], v[176:191]
    ds_read_b64_tr_b16 v[232:233], v65 offset:1184
    ds_read_b64_tr_b16 v[234:235], v65 offset:1152
    v_add_f32_dpp v173, v211, v173 wave_ror:1 row_mask:0xf bank_mask:0xf
    v_cndmask_b32 v208, v161, v70, s[76:77]
    v_cndmask_b32 v209, v165, v161, s[76:77]
    v_cndmask_b32 v210, v169, v165, s[76:77]
    v_mfma_f32_32x32x16_bf16 v[176:191], v[236:239], v[136:139], v[176:191]
    ds_read_b64_tr_b16 v[236:237], v65 offset:1312
    ds_read_b64_tr_b16 v[238:239], v65 offset:1280
    v_cndmask_b32 v211, v173, v169, s[76:77]
    v_mov_b32_e64 v70, v173
    v_add_f32_dpp v160, v208, v160 wave_ror:1 row_mask:0xf bank_mask:0xf
    v_add_f32_dpp v164, v209, v164 wave_ror:1 row_mask:0xf bank_mask:0xf
    v_mfma_f32_32x32x16_bf16 v[176:191], v[240:243], v[140:143], v[176:191]
    ds_read_b128 v[240:243], v64 offset:512
    ds_read_b64_tr_b16 v[224:225], v65 offset:1440
    ds_read_b64_tr_b16 v[226:227], v65 offset:1408
    v_add_f32_dpp v168, v210, v168 wave_ror:1 row_mask:0xf bank_mask:0xf
    v_add_f32_dpp v172, v211, v172 wave_ror:1 row_mask:0xf bank_mask:0xf
    s_waitcnt lgkmcnt(7)
    v_mfma_f32_32x32x16_bf16 v[176:191], v[212:215], v[228:231], v[176:191]
    ds_read_b128 v[212:215], v64 offset:992
    ds_write_b32 v66, v160 offset:256
    ds_write_b32 v66, v164 offset:320
    s_waitcnt lgkmcnt(8)
    v_mfma_f32_32x32x16_bf16 v[176:191], v[216:219], v[232:235], v[176:191]
    ds_read_b128 v[216:219], v64 offset:960
    ds_write_b32 v66, v168 offset:384
    ds_write_b32 v66, v172 offset:448
    s_waitcnt lgkmcnt(9)
    v_mfma_f32_32x32x16_bf16 v[176:191], v[220:223], v[236:239], v[176:191]
    ds_read_b128 v[220:223], v64 offset:928
    s_waitcnt lgkmcnt(7)
    v_mfma_f32_32x32x16_bf16 v[176:191], v[240:243], v[224:227], v[176:191]
    ds_read_b128 v[240:243], v64 offset:896
    s_waitcnt lgkmcnt(2)
    s_barrier
    v_mfma_f32_32x32x16_bf16 v[192:207], v[212:215], v[112:115], v[192:207]
    ds_read_b64 v[144:145], v67 offset:0
    ds_read_b64 v[146:147], v67 offset:4224
    ds_read_b64 v[148:149], v67 offset:8448
    ds_read_b64 v[150:151], v67 offset:12672
    s_nop 0
    v_mfma_f32_32x32x16_bf16 v[192:207], v[216:219], v[116:119], v[192:207]
    s_nop 2
    v_cndmask_b32 v208, v179, v72, s[76:77]
    v_cndmask_b32 v209, v183, v179, s[76:77]
    s_waitcnt lgkmcnt(5)
    v_mfma_f32_32x32x16_bf16 v[192:207], v[220:223], v[120:123], v[192:207]
    v_cndmask_b32 v210, v187, v183, s[76:77]
    v_cndmask_b32 v211, v191, v187, s[76:77]
    v_mov_b32 v72, v191
    v_add_f32_dpp v178, v208, v178 wave_ror:1 row_mask:0xf bank_mask:0xf
    v_add_f32_dpp v182, v209, v182 wave_ror:1 row_mask:0xf bank_mask:0xf
    s_waitcnt lgkmcnt(4)
    v_mfma_f32_32x32x16_bf16 v[192:207], v[240:243], v[124:127], v[192:207]
    ds_read_b128 v[212:215], v64 offset:768
    v_add_f32_dpp v186, v210, v186 wave_ror:1 row_mask:0xf bank_mask:0xf
    v_add_f32_dpp v190, v211, v190 wave_ror:1 row_mask:0xf bank_mask:0xf
    v_cndmask_b32 v208, v178, v71, s[76:77]
    v_cndmask_b32 v209, v182, v178, s[76:77]
    v_cndmask_b32 v210, v186, v182, s[76:77]
    v_mfma_f32_32x32x16_bf16 v[192:207], v[244:247], v[128:131], v[192:207]
    ds_read_b128 v[244:247], v64 offset:736
    v_cndmask_b32 v211, v190, v186, s[76:77]
    v_mov_b32 v71, v190
    v_add_f32_dpp v177, v208, v177 wave_ror:1 row_mask:0xf bank_mask:0xf
    v_add_f32_dpp v181, v209, v181 wave_ror:1 row_mask:0xf bank_mask:0xf
    v_add_f32_dpp v185, v210, v185 wave_ror:1 row_mask:0xf bank_mask:0xf
    v_mfma_f32_32x32x16_bf16 v[192:207], v[248:251], v[132:135], v[192:207]
    ds_read_b128 v[248:251], v64 offset:704
    v_add_f32_dpp v189, v211, v189 wave_ror:1 row_mask:0xf bank_mask:0xf
    v_cndmask_b32 v208, v177, v70, s[76:77]
    v_cndmask_b32 v209, v181, v177, s[76:77]
    v_cndmask_b32 v210, v185, v181, s[76:77]
    v_cndmask_b32 v211, v189, v185, s[76:77]
    v_mfma_f32_32x32x16_bf16 v[192:207], v[252:255], v[136:139], v[192:207]
    ds_read_b128 v[252:255], v64 offset:672
    v_mov_b32_e64 v70, v189
    v_add_f32_dpp v176, v208, v176 wave_ror:1 row_mask:0xf bank_mask:0xf
    v_add_f32_dpp v180, v209, v180 wave_ror:1 row_mask:0xf bank_mask:0xf
    v_add_f32_dpp v184, v210, v184 wave_ror:1 row_mask:0xf bank_mask:0xf
    s_waitcnt lgkmcnt(3)
    v_mfma_f32_32x32x16_bf16 v[192:207], v[212:215], v[140:143], v[192:207]
    ds_read_b128 v[216:219], v64 offset:640
    v_add_f32_dpp v188, v211, v188 wave_ror:1 row_mask:0xf bank_mask:0xf
    s_waitcnt lgkmcnt(3)
    v_mfma_f32_32x32x16_bf16 v[192:207], v[244:247], v[228:231], v[192:207]
    ds_read_b128 v[228:231], v64 offset:608
    ds_read_b64_tr_b16 v[220:221], v65 offset:1568
    ds_read_b64_tr_b16 v[222:223], v65 offset:1536
    ds_write_b32 v66, v176 offset:512
    s_waitcnt lgkmcnt(6)
    v_mfma_f32_32x32x16_bf16 v[192:207], v[248:251], v[232:235], v[192:207]
    ds_read_b128 v[232:235], v64 offset:576
    ds_read_b64_tr_b16 v[240:241], v65 offset:1696
    ds_read_b64_tr_b16 v[242:243], v65 offset:1664
    ds_write_b32 v66, v180 offset:576
    s_waitcnt lgkmcnt(9)
    v_mfma_f32_32x32x16_bf16 v[192:207], v[252:255], v[236:239], v[192:207]
    ds_read_b128 v[236:239], v64 offset:544
    ds_read_b64_tr_b16 v[212:213], v65 offset:1824
    ds_read_b64_tr_b16 v[214:215], v65 offset:1792
    ds_write_b32 v66, v184 offset:640
    s_waitcnt lgkmcnt(12)
    v_mfma_f32_32x32x16_bf16 v[192:207], v[216:219], v[224:227], v[192:207]
    ds_read_b128 v[224:227], v64 offset:512
    ds_read_b64_tr_b16 v[244:245], v65 offset:1952
    ds_read_b64_tr_b16 v[246:247], v65 offset:1920
    ds_write_b32 v66, v188 offset:704
    s_waitcnt lgkmcnt(13)
    v_mfma_f32_32x32x16_bf16 v[192:207], v[228:231], v[220:223], v[192:207]
    v_add_f32 v144, v144, v80
    v_add_f32 v145, v145, v81
    v_add_f32 v146, v146, v82
    v_add_f32 v147, v147, v83
    s_waitcnt lgkmcnt(9)
    v_mfma_f32_32x32x16_bf16 v[192:207], v[232:235], v[240:243], v[192:207]
    v_add_f32 v148, v148, v84
    v_add_f32 v149, v149, v85
    v_add_f32 v150, v150, v86
    v_add_f32 v151, v151, v87
    v_cvt_pk_bf16_f32 v160, v144, v146
    s_waitcnt lgkmcnt(5)
    v_mfma_f32_32x32x16_bf16 v[192:207], v[236:239], v[212:215], v[192:207]
    v_cvt_pk_bf16_f32 v161, v148, v150
    v_cvt_pk_bf16_f32 v162, v145, v147
    v_cvt_pk_bf16_f32 v163, v149, v151
    s_mov_b32 s25, 1310720
    s_waitcnt lgkmcnt(1)
    v_mfma_f32_32x32x16_bf16 v[192:207], v[224:227], v[244:247], v[192:207]
    buffer_store_dwordx2 v[160:161], v68, s[20:23], s25 offen
    s_mov_b32 s25, 1315840
    buffer_store_dwordx2 v[162:163], v68, s[20:23], s25 offen
    s_nop 8
    v_cndmask_b32 v208, v195, v72, s[76:77]
    v_cndmask_b32 v209, v199, v195, s[76:77]
    v_cndmask_b32 v210, v203, v199, s[76:77]
    v_cndmask_b32 v211, v207, v203, s[76:77]
    v_mov_b32_e64 v72, v207
    v_add_f32_dpp v194, v208, v194 wave_ror:1 row_mask:0xf bank_mask:0xf
    v_add_f32_dpp v198, v209, v198 wave_ror:1 row_mask:0xf bank_mask:0xf
    v_add_f32_dpp v202, v210, v202 wave_ror:1 row_mask:0xf bank_mask:0xf
    v_add_f32_dpp v206, v211, v206 wave_ror:1 row_mask:0xf bank_mask:0xf
    v_cndmask_b32 v208, v194, v71, s[76:77]
    v_cndmask_b32 v209, v198, v194, s[76:77]
    v_cndmask_b32 v210, v202, v198, s[76:77]
    v_cndmask_b32 v211, v206, v202, s[76:77]
    v_mov_b32_e64 v71, v206
    v_add_f32_dpp v193, v208, v193 wave_ror:1 row_mask:0xf bank_mask:0xf
    v_add_f32_dpp v197, v209, v197 wave_ror:1 row_mask:0xf bank_mask:0xf
    v_add_f32_dpp v201, v210, v201 wave_ror:1 row_mask:0xf bank_mask:0xf
    v_add_f32_dpp v205, v211, v205 wave_ror:1 row_mask:0xf bank_mask:0xf
    v_cndmask_b32 v208, v193, v70, s[76:77]
    v_cndmask_b32 v209, v197, v193, s[76:77]
    v_cndmask_b32 v210, v201, v197, s[76:77]
    v_cndmask_b32 v211, v205, v201, s[76:77]
    v_mov_b32_e64 v70, v205
    v_add_f32_dpp v192, v208, v192 wave_ror:1 row_mask:0xf bank_mask:0xf
    v_add_f32_dpp v196, v209, v196 wave_ror:1 row_mask:0xf bank_mask:0xf
    v_add_f32_dpp v200, v210, v200 wave_ror:1 row_mask:0xf bank_mask:0xf
    v_add_f32_dpp v204, v211, v204 wave_ror:1 row_mask:0xf bank_mask:0xf
    ds_write_b32 v66, v192 offset:768
    ds_write_b32 v66, v196 offset:832
    ds_write_b32 v66, v200 offset:896
    ds_write_b32 v66, v204 offset:960
    s_waitcnt lgkmcnt(0)
    s_barrier
    ds_read_b64 v[152:153], v67 offset:512
    ds_read_b64 v[154:155], v67 offset:4736
    ds_read_b64 v[156:157], v67 offset:8960
    ds_read_b64 v[158:159], v67 offset:13184
    s_waitcnt lgkmcnt(0)
    v_add_f32 v152, v152, v88
    v_add_f32 v153, v153, v89
    v_add_f32 v154, v154, v90
    v_add_f32 v155, v155, v91
    v_add_f32 v156, v156, v92
    v_add_f32 v157, v157, v93
    v_add_f32 v158, v158, v94
    v_add_f32_e64 v159, v159, v95
    v_cvt_pk_bf16_f32 v164, v152, v154
    v_cvt_pk_bf16_f32 v165, v156, v158
    v_cvt_pk_bf16_f32 v166, v153, v155
    v_cvt_pk_bf16_f32 v167, v157, v159
    s_mov_b32 s25, 1966080
    buffer_store_dwordx2 v[164:165], v68, s[20:23], s25 offen
    s_mov_b32 s25, 1971200
    buffer_store_dwordx2 v[166:167], v68, s[20:23], s25 offen
    s_branch ec_82
nc_81:
ec_82:
L_end:
    s_endpgm
ps_5:
    s_mov_b32 s84, 1048576
pl_6:
    global_load_dword v7, v5, s[66:67] sc1
    s_waitcnt vmcnt(0)
    s_sub_u32 s84, s84, 1
    s_cbranch_scc1 pc_7
    v_cmp_gt_u32_e64 vcc, 1, v7
    s_nop 0
    s_and_b64 vcc, vcc, s[50:51]
    s_and_b64 vcc, vcc, 1
    s_cbranch_scc1 pl_6
    s_branch pc_7
ps_8:
    s_mov_b32 s84, 1048576
pl_9:
    buffer_load_dword v7, v4, s[16:19], s87 offen offset:0 sc1
    s_waitcnt vmcnt(0)
    s_sub_u32 s84, s84, 1
    s_cbranch_scc1 pc_10
    v_cmp_gt_u32 vcc, 32, v7
    s_nop 0
    s_and_b64 vcc, vcc, s[50:51]
    s_cbranch_scc1 pl_9
    s_branch pc_10
ps_11:
    s_mov_b32 s84, 1048576
pl_12:
    global_load_dword v7, v5, s[66:67] sc1
    s_waitcnt vmcnt(0)
    s_sub_u32 s84, s84, 1
    s_cbranch_scc1 pc_13
    v_cmp_gt_u32_e64 vcc, 1, v7
    s_nop 0
    s_and_b64 vcc, vcc, s[50:51]
    s_and_b64 vcc, vcc, 1
    s_cbranch_scc1 pl_12
    s_branch pc_13
ps_14:
    s_mov_b32 s84, 1048576
pl_15:
    buffer_load_dword v7, v4, s[16:19], s87 offen offset:0 sc1
    s_waitcnt vmcnt(0)
    s_sub_u32 s84, s84, 1
    s_cbranch_scc1 pc_16
    v_cmp_gt_u32 vcc, 32, v7
    s_nop 0
    s_and_b64 vcc, vcc, s[50:51]
    s_cbranch_scc1 pl_15
    s_branch pc_16
ps_17:
    s_mov_b32 s84, 1048576
pl_18:
    buffer_load_dword v7, v4, s[16:19], s89 offen offset:8 sc1
    s_waitcnt vmcnt(0)
    s_sub_u32 s84, s84, 1
    s_cbranch_scc1 pc_19
    v_cmp_gt_u32_e64 vcc, 32, v7
    s_nop 0
    s_and_b64 vcc, vcc, s[50:51]
    s_cbranch_scc1 pl_18
    s_branch pc_19
rd_21:
    s_cmp_eq_u32 s38, 0
    s_cbranch_scc1 rc_22
    s_sub_u32 s38, s38, 1
    s_nop 7
    s_nop 7
    s_sleep 4
    s_mov_b64 exec, vcc
    s_mov_b32 s96, 4194304
    buffer_load_dwordx4 v[216:219], v56, s[16:19], s96 offen offset:0 sc1
    buffer_load_dwordx4 v[220:223], v56, s[16:19], s96 offen offset:256 sc1
    s_mov_b32 s96, 4227072
    buffer_load_dwordx4 v[224:227], v56, s[16:19], s96 offen offset:0 sc1
    buffer_load_dwordx4 v[228:231], v56, s[16:19], s96 offen offset:256 sc1
    s_mov_b32 s96, 4259840
    buffer_load_dwordx4 v[232:235], v56, s[16:19], s96 offen offset:0 sc1
    buffer_load_dwordx4 v[236:239], v56, s[16:19], s96 offen offset:256 sc1
    s_mov_b32 s96, 4292608
    buffer_load_dwordx4 v[240:243], v56, s[16:19], s96 offen offset:0 sc1
    buffer_load_dwordx4 v[244:247], v56, s[16:19], s96 offen offset:256 sc1
    s_mov_b32 s96, 4194304
    buffer_load_dwordx2 v[248:249], v57, s[16:19], s96 offen offset:0 sc1
    buffer_load_dwordx2 v[252:253], v57, s[16:19], s96 offen offset:128 sc1
    s_mov_b32 s96, 4210688
    buffer_load_dwordx2 v[250:251], v57, s[16:19], s96 offen offset:0 sc1
    buffer_load_dwordx2 v[254:255], v57, s[16:19], s96 offen offset:128 sc1
    s_mov_b32 s96, 0
    s_mov_b32 s97, 5120
    s_waitcnt vmcnt(16)
    buffer_load_dwordx2 v[208:209], v60, s[4:7], s96 offen
    s_waitcnt vmcnt(16)
    buffer_load_dwordx2 v[210:211], v60, s[4:7], s97 offen
    s_waitcnt vmcnt(16)
    v_lshrrev_b32_e64 v212, 5, v1
    v_mul_u32_u24 v212, 5104, v212
    v_bfe_u32 v213, v1, 4, 1
    v_lshlrev_b32 v213, 2, v213
    v_sub_u32 v212, v212, v213
    v_add_u32 v212, v212, v60
    s_mul_i32 s97, s24, 24
    s_sub_u32 s97, 128, s97
    buffer_load_dword v212, v212, s[4:7], s97 offen
    s_mov_b64 exec, -1
    s_waitcnt vmcnt(0) lgkmcnt(0)
    s_branch oe_20
rd_24:
    s_cmp_eq_u32 s38, 0
    s_cbranch_scc1 rc_25
    s_sub_u32 s38, s38, 1
    s_nop 7
    s_nop 7
    s_sleep 4
    s_mov_b64 exec, vcc
    s_mov_b32 s96, 4198400
    buffer_load_dwordx4 v[216:219], v56, s[16:19], s96 offen offset:0 sc1
    buffer_load_dwordx4 v[220:223], v56, s[16:19], s96 offen offset:256 sc1
    s_mov_b32 s96, 4231168
    buffer_load_dwordx4 v[224:227], v56, s[16:19], s96 offen offset:0 sc1
    buffer_load_dwordx4 v[228:231], v56, s[16:19], s96 offen offset:256 sc1
    s_mov_b32 s96, 4263936
    buffer_load_dwordx4 v[232:235], v56, s[16:19], s96 offen offset:0 sc1
    buffer_load_dwordx4 v[236:239], v56, s[16:19], s96 offen offset:256 sc1
    s_mov_b32 s96, 4296704
    buffer_load_dwordx4 v[240:243], v56, s[16:19], s96 offen offset:0 sc1
    buffer_load_dwordx4 v[244:247], v56, s[16:19], s96 offen offset:256 sc1
    s_mov_b32 s96, 4196352
    buffer_load_dwordx2 v[248:249], v57, s[16:19], s96 offen offset:0 sc1
    buffer_load_dwordx2 v[252:253], v57, s[16:19], s96 offen offset:128 sc1
    s_mov_b32 s96, 4212736
    buffer_load_dwordx2 v[250:251], v57, s[16:19], s96 offen offset:0 sc1
    buffer_load_dwordx2 v[254:255], v57, s[16:19], s96 offen offset:128 sc1
    s_mov_b32 s96, 1310720
    s_mov_b32 s97, 1315840
    s_waitcnt vmcnt(14)
    buffer_load_dwordx2 v[208:209], v60, s[4:7], s96 offen
    s_waitcnt vmcnt(14)
    buffer_load_dwordx2 v[210:211], v60, s[4:7], s97 offen
    s_waitcnt vmcnt(14)
    v_lshrrev_b32 v212, 5, v1
    v_mul_u32_u24 v212, 5104, v212
    v_bfe_u32 v213, v1, 4, 1
    v_lshlrev_b32 v213, 2, v213
    v_sub_u32 v212, v212, v213
    v_add_u32 v212, v212, v60
    s_mul_i32 s97, s24, 24
    s_sub_u32 s97, 1310848, s97
    buffer_load_dword v212, v212, s[4:7], s97 offen
    s_mov_b64 exec, -1
    s_waitcnt vmcnt(0) lgkmcnt(0)
    s_branch oe_23
rd_29:
    s_cmp_eq_u32 s38, 0
    s_cbranch_scc1 rc_30
    s_sub_u32 s38, s38, 1
    s_nop 7
    s_nop 7
    s_sleep 4
    s_mov_b64 exec, vcc
    s_lshl_b32 s96, s75, 14
    s_add_u32 s96, s96, 6815744
    s_lshl_b32 s97, s24, 12
    s_add_u32 s97, s97, 3473408
    buffer_load_dwordx4 v[176:179], v62, s[16:19], s96 offen offset:0 sc1
    buffer_load_dwordx4 v[180:183], v62, s[16:19], s96 offen offset:1024 sc1
    buffer_load_dwordx4 v[184:187], v62, s[16:19], s97 offen offset:0 sc1
    buffer_load_dwordx4 v[188:191], v62, s[16:19], s97 offen offset:1024 sc1
    buffer_load_dwordx4 v[192:195], v62, s[16:19], s97 offen offset:2048 sc1
    buffer_load_dwordx4 v[196:199], v62, s[16:19], s97 offen offset:3072 sc1
    s_mov_b64 exec, -1
    s_waitcnt vmcnt(0) lgkmcnt(0)
    s_branch ce_28
rd_32:
    s_cmp_eq_u32 s38, 0
    s_cbranch_scc1 rc_33
    s_sub_u32 s38, s38, 1
    s_nop 7
    s_nop 7
    s_sleep 4
    s_mov_b64 exec, vcc
    s_lshl_b32 s96, s75, 14
    s_add_u32 s96, s96, 6815744
    s_lshl_b32 s97, s24, 12
    s_add_u32 s97, s97, 3477504
    buffer_load_dwordx4 v[248:251], v62, s[16:19], s96 offen offset:2048 sc1
    buffer_load_dwordx4 v[252:255], v62, s[16:19], s96 offen offset:3072 sc1
    buffer_load_dwordx4 v[96:99], v62, s[16:19], s97 offen offset:0 sc1
    buffer_load_dwordx4 v[100:103], v62, s[16:19], s97 offen offset:1024 sc1
    buffer_load_dwordx4 v[104:107], v62, s[16:19], s97 offen offset:2048 sc1
    buffer_load_dwordx4 v[108:111], v62, s[16:19], s97 offen offset:3072 sc1
    s_mov_b64 exec, -1
    s_waitcnt vmcnt(0) lgkmcnt(0)
    s_branch ce_31
gl_34:
    s_add_u32 s82, s86, 16384
    v_lshlrev_b32 v2, 10, v1
    v_mov_b32_e64 v5, 1
    s_mov_b64 exec, 255
    buffer_store_dword v5, v2, s[16:19], s82 offen offset:0 sc1
    s_mov_b64 exec, -1
    s_branch gc_35
ps_36:
    s_mov_b32 s84, 1048576
pl_37:
    buffer_load_dword v7, v4, s[16:19], s89 offen offset:0 sc1
    s_waitcnt vmcnt(0)
    s_sub_u32 s84, s84, 1
    s_cbranch_scc1 pc_38
    v_cmp_gt_u32 vcc, 1, v7
    s_nop 0
    s_and_b64 vcc, vcc, s[50:51]
    s_cbranch_scc1 pl_37
    s_branch pc_38
ps_39:
    s_mov_b32 s84, 1048576
pl_40:
    buffer_load_dword v7, v4, s[16:19], s87 offen offset:8 sc1
    s_waitcnt vmcnt(0)
    s_sub_u32 s84, s84, 1
    s_cbranch_scc1 pc_41
    v_cmp_gt_u32 vcc, 12, v7
    s_nop 0
    s_and_b64 vcc, vcc, s[50:51]
    s_cbranch_scc1 pl_40
    s_branch pc_41
gl_42:
    s_add_u32 s82, s86, 0
    v_lshlrev_b32 v2, 10, v1
    v_mov_b32_e64 v5, 1
    s_mov_b64 exec, 255
    buffer_store_dword v5, v2, s[16:19], s82 offen offset:12 sc1
    s_mov_b64 exec, -1
    s_branch gc_43
ps_44:
    s_mov_b32 s84, 1048576
pl_45:
    buffer_load_dword v7, v4, s[16:19], s89 offen offset:0 sc1
    s_waitcnt vmcnt(0)
    s_sub_u32 s84, s84, 1
    s_cbranch_scc1 pc_46
    v_cmp_gt_u32_e64 vcc, 1, v7
    s_nop 0
    s_and_b64 vcc, vcc, s[50:51]
    s_cbranch_scc1 pl_45
    s_branch pc_46
rd_49:
    s_cmp_eq_u32 s38, 0
    s_cbranch_scc1 rc_50
    s_sub_u32 s38, s38, 1
    s_nop 7
    s_nop 7
    s_sleep 4
    s_mov_b64 exec, vcc
    s_add_u32 s26, s3, 9437184
    buffer_load_dwordx4 v[216:219], v236, s[16:19], s26 offen sc1
    s_add_u32 s26, s26, 524288
    buffer_load_dwordx4 v[220:223], v236, s[16:19], s26 offen sc1
    s_add_u32 s26, s26, 524288
    buffer_load_dwordx4 v[224:227], v236, s[16:19], s26 offen sc1
    s_add_u32 s26, s26, 524288
    buffer_load_dwordx4 v[228:231], v236, s[16:19], s26 offen sc1
    s_add_u32 s26, s26, 524288
    buffer_load_dwordx4 v[232:235], v236, s[16:19], s26 offen sc1
    s_mov_b64 exec, -1
    s_waitcnt vmcnt(0) lgkmcnt(0)
    s_branch se_48
gl_52:
    s_add_u32 s82, s86, 16384
    v_lshlrev_b32 v2, 10, v1
    v_mov_b32_e64 v5, 1
    s_mov_b64 exec, 255
    buffer_store_dword v5, v2, s[16:19], s82 offen offset:4 sc1
    s_mov_b64 exec, -1
    s_branch gc_53
ps_54:
    s_mov_b32 s84, 1048576
pl_55:
    buffer_load_dword v7, v4, s[16:19], s87 offen offset:12 sc1
    s_waitcnt vmcnt(0)
    s_sub_u32 s84, s84, 1
    s_cbranch_scc1 pc_56
    v_cmp_gt_u32_e64 vcc, 1, v7
    s_nop 0
    s_and_b64 vcc, vcc, s[50:51]
    s_cbranch_scc1 pl_55
    s_branch pc_56
rd_58:
    s_cmp_eq_u32 s38, 0
    s_cbranch_scc1 rc_59
    s_sub_u32 s38, s38, 1
    s_nop 7
    s_nop 7
    s_sleep 4
    s_mov_b64 exec, vcc
    s_lshl_b32 s98, s72, 5
    s_add_u32 s98, s98, 0
    s_sub_u32 s95, s98, 4
    s_max_i32 s95, s95, 0
    s_lshl_b32 s94, s98, 3
    s_lshl_b32 s95, s95, 3
    s_add_u32 s94, s94, 3457024
    s_add_u32 s95, s95, 3457024
    s_add_u32 s96, s94, 8192
    buffer_load_dwordx2 v[152:153], v47, s[16:19], s94 offen sc1
    buffer_load_dwordx2 v[154:155], v47, s[16:19], s96 offen sc1
    buffer_load_dwordx2 v[156:157], v48, s[16:19], s95 offen sc1
    s_mov_b64 exec, -1
    s_waitcnt vmcnt(0) lgkmcnt(0)
    s_branch sl_57
ps_60:
    s_mov_b32 s84, 1048576
pl_61:
    buffer_load_dword v7, v4, s[16:19], s89 offen offset:4 sc1
    s_waitcnt vmcnt(0)
    s_sub_u32 s84, s84, 1
    s_cbranch_scc1 pc_62
    v_cmp_gt_u32 vcc, 1, v7
    s_nop 0
    s_and_b64 vcc, vcc, s[50:51]
    s_cbranch_scc1 pl_61
    s_branch pc_62
rd_65:
    s_cmp_eq_u32 s38, 0
    s_cbranch_scc1 rc_66
    s_sub_u32 s38, s38, 1
    s_nop 7
    s_nop 7
    s_sleep 4
    s_mov_b64 exec, vcc
    s_add_u32 s26, s3, 9437184
    buffer_load_dwordx4 v[216:219], v236, s[16:19], s26 offen sc1
    s_add_u32 s26, s26, 524288
    buffer_load_dwordx4 v[220:223], v236, s[16:19], s26 offen sc1
    s_add_u32 s26, s26, 524288
    buffer_load_dwordx4 v[224:227], v236, s[16:19], s26 offen sc1
    s_add_u32 s26, s26, 524288
    buffer_load_dwordx4 v[228:231], v236, s[16:19], s26 offen sc1
    s_add_u32 s26, s26, 524288
    buffer_load_dwordx4 v[232:235], v236, s[16:19], s26 offen sc1
    s_mov_b64 exec, -1
    s_waitcnt vmcnt(0) lgkmcnt(0)
    s_branch se_64
rd_67:
    s_cmp_eq_u32 s39, 0
    s_cbranch_scc1 rc_68
    s_sub_u32 s39, s39, 1
    s_nop 7
    s_nop 7
    s_waitcnt vmcnt(0) lgkmcnt(0)
    s_barrier
    s_lshl_b32 s25, s72, 5
    s_add_u32 s25, s25, 0
    s_sub_u32 s26, s25, 4
    s_max_i32 s26, s26, 0
    s_lshl_b32 s27, s71, 12
    s_add_u32 s27, s27, 9437184
    s_lshl_b32 s99, s25, 3
    s_lshl_b32 s100, s26, 3
    s_lshl_b32 s92, s24, 12
    s_lshl_b32 s93, s24, 9
    s_add_u32 s99, s99, s27
    s_add_u32 s100, s100, s27
    s_add_u32 m0, s92, 36352
    s_nop 0
    buffer_load_dwordx4 v73, s[16:19], s99 offen offset:0 sc1 lds
    buffer_load_dwordx4 v74, s[16:19], s99 offen offset:1024 sc1 lds
    buffer_load_dwordx4 v75, s[16:19], s99 offen offset:2048 sc1 lds
    buffer_load_dwordx4 v76, s[16:19], s99 offen offset:3072 sc1 lds
    s_add_u32 m0, s93, 53760
    s_add_u32 s99, s99, 524288
    s_mov_b64 exec, s[80:81]
    buffer_load_dwordx4 v77, s[16:19], s100 offen sc1 lds
    s_mov_b64 exec, -1
    s_add_u32 s100, s100, 524288
    s_add_u32 m0, s92, 55936
    s_nop 0
    s_nop 0
    buffer_load_dwordx4 v73, s[16:19], s99 offen offset:0 sc1 lds
    buffer_load_dwordx4 v74, s[16:19], s99 offen offset:1024 sc1 lds
    buffer_load_dwordx4 v75, s[16:19], s99 offen offset:2048 sc1 lds
    buffer_load_dwordx4 v76, s[16:19], s99 offen offset:3072 sc1 lds
    s_add_u32 m0, s93, 73344
    s_add_u32 s99, s99, 524288
    s_mov_b64 exec, s[80:81]
    buffer_load_dwordx4 v77, s[16:19], s100 offen sc1 lds
    s_mov_b64 exec, -1
    s_add_u32 s100, s100, 524288
    s_mov_b64 exec, -1
    s_waitcnt vmcnt(0) lgkmcnt(0)
    s_branch ge_51
rd_71:
    s_cmp_eq_u32 s38, 0
    s_cbranch_scc1 rc_72
    s_sub_u32 s38, s38, 1
    s_nop 7
    s_nop 7
    s_sleep 4
    s_mov_b64 exec, vcc
    s_lshl_b32 s98, s72, 5
    s_add_u32 s98, s98, 256
    s_sub_u32 s95, s98, 4
    s_max_i32 s95, s95, 0
    s_lshl_b32 s94, s98, 3
    s_lshl_b32 s95, s95, 3
    s_nop 0
    s_add_u32 s94, s94, 3457024
    s_add_u32 s95, s95, 3457024
    s_add_u32 s96, s94, 8192
    buffer_load_dwordx2 v[152:153], v47, s[16:19], s94 offen sc1
    buffer_load_dwordx2 v[154:155], v47, s[16:19], s96 offen sc1
    buffer_load_dwordx2 v[156:157], v48, s[16:19], s95 offen sc1
    s_mov_b64 exec, -1
    s_waitcnt vmcnt(0) lgkmcnt(0)
    s_branch sl_70
rd_73:
    s_cmp_eq_u32 s39, 0
    s_cbranch_scc1 rc_74
    s_sub_u32 s39, s39, 1
    s_nop 7
    s_nop 7
    s_waitcnt vmcnt(0) lgkmcnt(0)
    s_barrier
    s_lshl_b32 s25, s72, 5
    s_add_u32 s25, s25, 256
    s_sub_u32 s26, s25, 4
    s_max_i32 s26, s26, 0
    s_lshl_b32 s27, s71, 12
    s_add_u32 s27, s27, 9437184
    s_lshl_b32 s99, s25, 3
    s_lshl_b32 s100, s26, 3
    s_lshl_b32 s92, s24, 12
    s_lshl_b32 s93, s24, 9
    s_add_u32 s99, s99, s27
    s_add_u32 s100, s100, s27
    s_add_u32 m0, s92, 36352
    s_nop 0
    s_nop 0
    buffer_load_dwordx4 v73, s[16:19], s99 offen offset:0 sc1 lds
    buffer_load_dwordx4 v74, s[16:19], s99 offen offset:1024 sc1 lds
    buffer_load_dwordx4 v75, s[16:19], s99 offen offset:2048 sc1 lds
    buffer_load_dwordx4 v76, s[16:19], s99 offen offset:3072 sc1 lds
    s_add_u32 m0, s93, 53760
    s_add_u32 s99, s99, 524288
    s_mov_b64 exec, s[80:81]
    buffer_load_dwordx4 v77, s[16:19], s100 offen sc1 lds
    s_mov_b64 exec, -1
    s_add_u32 s100, s100, 524288
    s_add_u32 m0, s92, 55936
    s_nop 0
    s_nop 0
    buffer_load_dwordx4 v73, s[16:19], s99 offen offset:0 sc1 lds
    buffer_load_dwordx4 v74, s[16:19], s99 offen offset:1024 sc1 lds
    buffer_load_dwordx4 v75, s[16:19], s99 offen offset:2048 sc1 lds
    buffer_load_dwordx4 v76, s[16:19], s99 offen offset:3072 sc1 lds
    s_add_u32 m0, s93, 73344
    s_add_u32 s99, s99, 524288
    s_mov_b64 exec, s[80:81]
    buffer_load_dwordx4 v77, s[16:19], s100 offen sc1 lds
    s_mov_b64 exec, -1
    s_add_u32 s100, s100, 524288
    s_add_u32 m0, s92, 75520
    s_nop 0
    s_nop 0
    buffer_load_dwordx4 v73, s[16:19], s99 offen offset:0 sc1 lds
    buffer_load_dwordx4 v74, s[16:19], s99 offen offset:1024 sc1 lds
    buffer_load_dwordx4 v75, s[16:19], s99 offen offset:2048 sc1 lds
    buffer_load_dwordx4 v76, s[16:19], s99 offen offset:3072 sc1 lds
    s_add_u32 m0, s93, 92928
    s_add_u32 s99, s99, 524288
    s_mov_b64 exec, s[80:81]
    buffer_load_dwordx4 v77, s[16:19], s100 offen sc1 lds
    s_mov_b64 exec, -1
    s_add_u32 s100, s100, 524288
    s_mov_b64 exec, -1
    s_waitcnt vmcnt(0) lgkmcnt(0)
    s_branch ge_69
rd_76:
    s_cmp_eq_u32 s38, 0
    s_cbranch_scc1 rc_77
    s_sub_u32 s38, s38, 1
    s_nop 7
    s_nop 7
    s_sleep 4
    s_mov_b64 exec, vcc
    s_mov_b32 s96, 12058624
    buffer_load_dwordx4 v[216:219], v56, s[16:19], s96 offen offset:0 sc1
    buffer_load_dwordx4 v[220:223], v56, s[16:19], s96 offen offset:256 sc1
    s_mov_b32 s96, 12091392
    buffer_load_dwordx4 v[224:227], v56, s[16:19], s96 offen offset:0 sc1
    buffer_load_dwordx4 v[228:231], v56, s[16:19], s96 offen offset:256 sc1
    s_mov_b32 s96, 12124160
    buffer_load_dwordx4 v[232:235], v56, s[16:19], s96 offen offset:0 sc1
    buffer_load_dwordx4 v[236:239], v56, s[16:19], s96 offen offset:256 sc1
    s_mov_b32 s96, 12156928
    buffer_load_dwordx4 v[240:243], v56, s[16:19], s96 offen offset:0 sc1
    buffer_load_dwordx4 v[244:247], v56, s[16:19], s96 offen offset:256 sc1
    s_mov_b32 s96, 12058624
    buffer_load_dwordx2 v[248:249], v57, s[16:19], s96 offen offset:0 sc1
    buffer_load_dwordx2 v[252:253], v57, s[16:19], s96 offen offset:128 sc1
    s_mov_b32 s96, 12075008
    buffer_load_dwordx2 v[250:251], v57, s[16:19], s96 offen offset:0 sc1
    buffer_load_dwordx2 v[254:255], v57, s[16:19], s96 offen offset:128 sc1
    s_mov_b32 s96, 9437184
    buffer_load_dwordx4 v[208:211], v59, s[16:19], s96 offen sc1
    s_add_u32 s97, s36, 9437184
    buffer_load_dword v212, v61, s[16:19], s97 offen sc1
    s_mov_b64 exec, -1
    s_waitcnt vmcnt(0) lgkmcnt(0)
    s_branch oe_75
rd_79:
    s_cmp_eq_u32 s38, 0
    s_cbranch_scc1 rc_80
    s_sub_u32 s38, s38, 1
    s_nop 7
    s_nop 7
    s_sleep 4
    s_mov_b64 exec, vcc
    s_mov_b32 s96, 12062720
    buffer_load_dwordx4 v[216:219], v56, s[16:19], s96 offen offset:0 sc1
    buffer_load_dwordx4 v[220:223], v56, s[16:19], s96 offen offset:256 sc1
    s_mov_b32 s96, 12095488
    buffer_load_dwordx4 v[224:227], v56, s[16:19], s96 offen offset:0 sc1
    buffer_load_dwordx4 v[228:231], v56, s[16:19], s96 offen offset:256 sc1
    s_mov_b32 s96, 12128256
    buffer_load_dwordx4 v[232:235], v56, s[16:19], s96 offen offset:0 sc1
    buffer_load_dwordx4 v[236:239], v56, s[16:19], s96 offen offset:256 sc1
    s_mov_b32 s96, 12161024
    buffer_load_dwordx4 v[240:243], v56, s[16:19], s96 offen offset:0 sc1
    buffer_load_dwordx4 v[244:247], v56, s[16:19], s96 offen offset:256 sc1
    s_mov_b32 s96, 12060672
    buffer_load_dwordx2 v[248:249], v57, s[16:19], s96 offen offset:0 sc1
    buffer_load_dwordx2 v[252:253], v57, s[16:19], s96 offen offset:128 sc1
    s_mov_b32 s96, 12077056
    buffer_load_dwordx2 v[250:251], v57, s[16:19], s96 offen offset:0 sc1
    buffer_load_dwordx2 v[254:255], v57, s[16:19], s96 offen offset:128 sc1
    s_mov_b32 s96, 9439232
    buffer_load_dwordx4 v[208:211], v59, s[16:19], s96 offen sc1
    s_add_u32 s97, s36, 9439232
    buffer_load_dword v212, v61, s[16:19], s97 offen sc1
    s_mov_b64 exec, -1
    s_waitcnt vmcnt(0) lgkmcnt(0)
    s_branch oe_78
rd_84:
    s_cmp_eq_u32 s38, 0
    s_cbranch_scc1 rc_85
    s_sub_u32 s38, s38, 1
    s_nop 7
    s_nop 7
    s_sleep 4
    s_mov_b64 exec, vcc
    s_lshl_b32 s96, s75, 14
    s_add_u32 s96, s96, 14680064
    s_lshl_b32 s97, s24, 12
    s_add_u32 s97, s97, 3506176
    buffer_load_dwordx4 v[176:179], v62, s[16:19], s96 offen offset:0 sc1
    buffer_load_dwordx4 v[180:183], v62, s[16:19], s96 offen offset:1024 sc1
    buffer_load_dwordx4 v[184:187], v62, s[16:19], s97 offen offset:0 sc1
    buffer_load_dwordx4 v[188:191], v62, s[16:19], s97 offen offset:1024 sc1
    buffer_load_dwordx4 v[192:195], v62, s[16:19], s97 offen offset:2048 sc1
    buffer_load_dwordx4 v[196:199], v62, s[16:19], s97 offen offset:3072 sc1
    s_mov_b64 exec, -1
    s_waitcnt vmcnt(0) lgkmcnt(0)
    s_branch ce_83
rd_87:
    s_cmp_eq_u32 s38, 0
    s_cbranch_scc1 rc_88
    s_sub_u32 s38, s38, 1
    s_nop 7
    s_nop 7
    s_sleep 4
    s_mov_b64 exec, vcc
    s_lshl_b32 s96, s75, 14
    s_add_u32 s96, s96, 14680064
    s_lshl_b32 s97, s24, 12
    s_add_u32 s97, s97, 3510272
    buffer_load_dwordx4 v[248:251], v62, s[16:19], s96 offen offset:2048 sc1
    buffer_load_dwordx4 v[252:255], v62, s[16:19], s96 offen offset:3072 sc1
    buffer_load_dwordx4 v[96:99], v62, s[16:19], s97 offen offset:0 sc1
    buffer_load_dwordx4 v[100:103], v62, s[16:19], s97 offen offset:1024 sc1
    buffer_load_dwordx4 v[104:107], v62, s[16:19], s97 offen offset:2048 sc1
    buffer_load_dwordx4 v[108:111], v62, s[16:19], s97 offen offset:3072 sc1
    s_mov_b64 exec, -1
    s_waitcnt vmcnt(0) lgkmcnt(0)
    s_branch ce_86
L_last:
    s_endpgm
.section .rodata,"a"
.p2align 6
.amdhsa_kernel interleave_layers__sliding_local_dilated__ssm_conv_s4d__prompt_kernel
  .amdhsa_next_free_vgpr 512
  .amdhsa_next_free_sgpr 102
  .amdhsa_accum_offset 256
  .amdhsa_group_segment_fixed_size 0
  .amdhsa_kernarg_size 104
  .amdhsa_user_sgpr_count 2
  .amdhsa_user_sgpr_kernarg_segment_ptr 1
  .amdhsa_system_sgpr_workgroup_id_x 1
.end_amdhsa_kernel
```

```asm
; @launch grid=(256,1,1) block=(256,1,1) lds=163840
.amdgcn_target "amdgcn-amd-amdhsa--gfx950"
.text
.globl interleave_layers__sliding_local_dilated__ssm_conv_s4d__prompt_kernel
.p2align 8
.type interleave_layers__sliding_local_dilated__ssm_conv_s4d__prompt_kernel,@function
interleave_layers__sliding_local_dilated__ssm_conv_s4d__prompt_kernel:
    s_getpc_b64 s[42:43]
L_start:
    s_cmp_ge_u32 s2, 256
    s_cbranch_scc1 L_end
    s_load_dwordx16 s[44:59], s[0:1], 0
    s_load_dwordx8 s[60:67], s[0:1], 64
    s_load_dwordx2 s[68:69], s[0:1], 96
    v_and_b32 v1, 63, v0
    v_lshrrev_b32 v2, 6, v0
    s_nop 0
    v_readfirstlane_b32 s24, v2
    s_bfe_u32 s82, s2, 0x40003
    s_lshl_b32 s82, s82, 13
    v_lshrrev_b32 v159, 2, v0
    v_lshl_add_u32 v159, v159, 7, s82
    v_min_u32 v159, L_last-L_start, v159
    global_load_dword v159, v159, s[42:43]
    s_and_b32 s25, s2, 7
    s_lshr_b32 s26, s2, 3
    s_and_b32 s27, s26, 3
    s_lshr_b32 s28, s26, 4
    s_lshl_b32 s28, s28, 2
    s_add_u32 s3, s27, s28
    s_lshl_b32 s27, s3, 2
    s_lshr_b32 s70, 0x75206431, s27
    s_and_b32 s70, s70, 7
    s_and_b32 s27, s25, 1
    s_lshl_b32 s27, s27, 3
    s_add_u32 s70, s70, s27
    s_bfe_u32 s71, s26, 0x10002
    s_bfe_u32 s28, s26, 0x10003
    s_and_b32 s72, s25, 6
    s_add_u32 s72, s72, s28
    s_and_b32 s73, s26, 7
    s_lshr_b32 s28, s26, 3
    s_lshl_b32 s74, s25, 2
    s_add_u32 s74, s74, s28
    s_mul_i32 s75, s25, 20
    s_add_u32 s75, s75, s26
    s_min_u32 s27, s2, 239
    s_mul_i32 s25, s27, 10923
    s_lshr_b32 s25, s25, 16
    s_mul_i32 s26, s25, 6
    s_sub_u32 s26, s27, s26
    s_mul_i32 s27, s25, 61440
    s_mul_i32 s28, s26, 640
    s_add_u32 s27, s27, s28
    s_lshl_b32 s28, s24, 10
    v_add_u32 v85, 0, v0
    v_mul_u32_u24 v84, 1639, v85
    v_lshrrev_b32 v84, 16, v84
    v_mul_u32_u24 v84, 3200, v84
    v_lshl_add_u32 v85, v85, 4, v84
    v_add_u32 v86, 256, v0
    v_mul_u32_u24 v84, 1639, v86
    v_lshrrev_b32_e64 v84, 16, v84
    v_mul_u32_u24 v84, 3200, v84
    v_lshl_add_u32 v86, v86, 4, v84
    v_add_u32 v87, 512, v0
    v_min_u32 v87, 639, v87
    v_mul_u32_u24 v84, 1639, v87
    v_lshrrev_b32_e64 v84, 16, v84
    v_mul_u32_u24 v84, 3200, v84
    v_lshl_add_u32 v87, v87, 4, v84
    s_mov_b32 s76, 0
    s_mov_b32 s77, 0x80000000
    s_mov_b32 s80, -1
    s_mov_b32 s81, 0
    s_nop 0
    s_mov_b32 s78, 0xfe0000fe
    s_mov_b32 s79, 0xfe0000fe
    s_mov_b32 s6, 2621440
    s_mov_b32 s7, 0x20000
    s_mov_b32 s10, 2457600
    s_mov_b32 s11, 0x20000
    s_mov_b32 s14, 819200
    s_mov_b32 s15, 0x20000
    s_mov_b32 s18, 22061056
    s_mov_b32 s19, 0x20000
    s_mov_b32 s22, 2621440
    s_mov_b32 s23, 0x20000
    s_waitcnt lgkmcnt(0)
    s_mov_b32 s4, s44
    s_and_b32 s5, s45, 0xffff
    s_mov_b32 s8, s46
    s_and_b32 s9, s47, 0xffff
    s_mov_b32 s12, s48
    s_and_b32 s13, s49, 0xffff
    s_mov_b32 s16, s68
    s_and_b32 s17, s69, 0xffff
    s_mov_b32 s20, s64
    s_and_b32 s21, s65, 0xffff
    s_cmp_lg_u32 s2, 255
    s_cbranch_scc1 fz_1
    v_mov_b32 v120, 0
    v_mov_b32 v121, 0
    v_mov_b32 v122, 0
    v_mov_b32 v123, 0
    v_lshlrev_b32 v124, 4, v0
    s_mov_b32 s88, 3538944
    buffer_store_dwordx4 v[120:123], v124, s[16:19], s88 offen sc1
    s_mov_b32 s88, 3543040
    buffer_store_dwordx4 v[120:123], v124, s[16:19], s88 offen sc1
    s_mov_b32 s88, 3547136
    buffer_store_dwordx4 v[120:123], v124, s[16:19], s88 offen sc1
    s_mov_b32 s88, 3555328
    buffer_store_dwordx4 v[120:123], v124, s[16:19], s88 offen sc1
    s_mov_b32 s88, 3559424
    buffer_store_dwordx4 v[120:123], v124, s[16:19], s88 offen sc1
    s_mov_b32 s88, 3563520
    buffer_store_dwordx4 v[120:123], v124, s[16:19], s88 offen sc1
fz_1:
    s_min_u32 s96, s75, 159
    s_lshl_b32 s96, s96, 2
    s_add_u32 s96, s96, s24
    s_mul_i32 s97, s96, 384
    s_lshl_b32 s96, s96, 1
    v_lshl_add_u32 v2, v1, 2, s97
    v_mov_b32 v241, s96
    global_load_dword v232, v2, s[52:53]
    global_load_dword v233, v2, s[54:55]
    global_load_dword v234, v2, s[56:57]
    global_load_dword v235, v2, s[58:59]
    global_load_ushort v240, v241, s[60:61]
    s_add_u32 m0, s28, 134272
    s_nop 0
    buffer_load_dwordx4 v85, s[8:11], s27 offen lds
    s_add_u32 m0, s28, 138368
    s_nop 0
    buffer_load_dwordx4 v86, s[8:11], s27 offen lds
    s_add_u32 m0, s28, 142464
    s_nop 0
    buffer_load_dwordx4 v87, s[8:11], s27 offen lds
    s_lshr_b32 s29, s26, 1
    s_and_b32 s30, s26, 1
    s_lshl_b32 s30, s30, 3
    s_lshl_b32 s31, s25, 10
    s_add_u32 s31, s31, 0
    s_cmp_ge_u32 s2, 240
    s_cselect_b32 s31, 1073741824, s31
    v_bfe_u32 v93, v0, 2, 2
    v_bfe_u32 v92, v0, 1, 1
    v_lshl_add_u32 v92, v92, 3, v93
    v_mul_u32_u24 v92, 640, v92
    v_and_b32 v93, 1, v0
    v_mul_u32_u24 v93, 40, v93
    v_add_u32 v91, v92, v93
    v_add_u32 v91, 134272, v91
    v_lshrrev_b32 v88, 4, v0
    v_add_u32 v88, 0, v88
    v_cmp_gt_u32 vcc, 40, v88
    v_min_u32 v88, 39, v88
    v_mul_u32_u24 v89, 13108, v88
    v_lshrrev_b32 v89, 16, v89
    v_mul_u32_u24 v90, 5, v89
    v_sub_u32_e64 v90, v88, v90
    v_mul_u32_u24 v92, 80, v89
    v_lshl_add_u32 v92, v90, 3, v92
    v_add_u32 v111, v92, v91
    v_add_u32 v89, s30, v89
    v_cmp_eq_u32 s[82:83], 4, v90
    v_mov_b32 v92, s29
    s_nop 0
    v_cndmask_b32 v93, v90, v92, s[82:83]
    v_cndmask_b32 v92, v92, 3, s[82:83]
    v_lshl_add_u32 v89, v89, 2, v93
    v_mul_u32_u24 v89, 40960, v89
    v_lshl_add_u32 v89, v92, 8, v89
    v_and_b32 v92, 15, v0
    v_lshl_add_u32 v89, v92, 4, v89
    v_mov_b32 v92, 1073741824
    v_cndmask_b32 v89, v92, v89, vcc
    v_add_u32 v108, s31, v89
    v_lshrrev_b32 v88, 4, v0
    v_add_u32 v88, 16, v88
    v_cmp_gt_u32 vcc, 40, v88
    v_min_u32 v88, 39, v88
    v_mul_u32_u24 v89, 13108, v88
    v_lshrrev_b32 v89, 16, v89
    v_mul_u32_u24 v90, 5, v89
    v_sub_u32_e64 v90, v88, v90
    v_mul_u32_u24 v92, 80, v89
    v_lshl_add_u32 v92, v90, 3, v92
    v_add_u32 v112, v92, v91
    v_add_u32 v89, s30, v89
    v_cmp_eq_u32 s[82:83], 4, v90
    v_mov_b32 v92, s29
    s_nop 0
    v_cndmask_b32 v93, v90, v92, s[82:83]
    v_cndmask_b32 v92, v92, 3, s[82:83]
    v_lshl_add_u32 v89, v89, 2, v93
    v_mul_u32_u24 v89, 40960, v89
    v_lshl_add_u32 v89, v92, 8, v89
    v_and_b32 v92, 15, v0
    v_lshl_add_u32 v89, v92, 4, v89
    v_mov_b32 v92, 1073741824
    v_cndmask_b32 v89, v92, v89, vcc
    v_add_u32 v109, s31, v89
    v_lshrrev_b32 v88, 4, v0
    v_add_u32 v88, 32, v88
    v_cmp_gt_u32 vcc, 40, v88
    v_min_u32 v88, 39, v88
    v_mul_u32_u24 v89, 13108, v88
    v_lshrrev_b32 v89, 16, v89
    v_mul_u32_u24 v90, 5, v89
    v_sub_u32_e64 v90, v88, v90
    v_mul_u32_u24 v92, 80, v89
    v_lshl_add_u32 v92, v90, 3, v92
    v_add_u32 v113, v92, v91
    v_add_u32 v89, s30, v89
    v_cmp_eq_u32 s[82:83], 4, v90
    v_mov_b32 v92, s29
    s_nop 0
    v_cndmask_b32 v93, v90, v92, s[82:83]
    v_cndmask_b32 v92, v92, 3, s[82:83]
    v_lshl_add_u32 v89, v89, 2, v93
    v_mul_u32_u24 v89, 40960, v89
    v_lshl_add_u32 v89, v92, 8, v89
    v_and_b32 v92, 15, v0
    v_lshl_add_u32 v89, v92, 4, v89
    v_mov_b32 v92, 1073741824
    v_cndmask_b32 v89, v92, v89, vcc
    v_add_u32 v110, s31, v89
    s_mul_i32 s25, s3, 18
    s_lshl_b32 s26, s72, 7
    s_add_u32 s25, s25, s26
    s_add_u32 s25, s25, s71
    s_add_u32 s25, s25, -16
    s_max_i32 s25, s25, 0
    s_mul_i32 s25, s25, 1280
    v_lshrrev_b32_e64 v204, 1, v0
    v_min_u32 v204, 89, v204
    v_mul_u32_u24 v205, 6554, v204
    v_lshrrev_b32_e64 v205, 16, v205
    v_mul_u32_u24 v205, 1280, v205
    v_lshl_add_u32 v204, v204, 7, v205
    buffer_load_dword v204, v204, s[4:7], s25 offen
    s_and_b32 s25, s2, 7
    s_lshl_b32 s86, s25, 7
    s_add_u32 s86, s86, 3538944
    s_lshl_b32 s87, s25, 10
    s_add_u32 s87, s87, 3538944
    s_add_u32 s89, s87, 16384
    v_cmp_gt_u32 s[50:51], 8, v0
    v_cmp_eq_u32 vcc, 0, v0
    v_lshlrev_b32 v4, 7, v1
    v_mov_b32 v6, 1073741824
    v_cndmask_b32 v4, v6, v4, s[50:51]
    v_cndmask_b32 v6, v6, 0, vcc
    v_mov_b32 v5, 0
    s_cmp_lg_u32 s2, 255
    s_cbranch_scc1 fr_2
    v_mov_b32 v2, 1
    s_waitcnt vmcnt(9)
    s_barrier
    s_mov_b64 exec, 1
    global_store_dword v5, v2, s[66:67] sc1
    s_mov_b64 exec, -1
fr_2:
    v_mov_b32 v140, 0
    v_mov_b32_e64 v141, 0
    v_mov_b32 v142, 0x3f803f80
    v_mov_b32 v143, 0x3f803f80
    v_lshlrev_b32_e64 v144, 3, v0
    v_add_u32 v144, 155648, v144
    ds_write_b64 v144, v[140:141]
    ds_write_b64 v144, v[142:143] offset:2048
    v_and_b32 v50, 31, v1
    v_lshrrev_b32 v51, 5, v1
    v_mul_u32_u24 v52, 40, v50
    v_mul_u32_u24 v53, 3200, v51
    v_add_u32 v53, v52, v53
    s_lshl_b32 s25, s24, 3
    s_add_u32 s25, s25, 320
    v_add_u32 v38, s25, v53
    s_mul_i32 s25, s24, 6400
    s_add_u32 s25, s25, 352
    v_add_u32 v39, s25, v53
    s_lshl_b32 s31, s71, 12
    v_lshl_add_u32 v47, v50, 3, s31
    v_bfe_u32 v52, v1, 2, 1
    v_and_b32 v53, 3, v1
    v_lshlrev_b32 v54, 13, v52
    v_lshl_add_u32 v54, v53, 3, v54
    v_add_u32_e64 v48, s31, v54
    v_bfe_u32 v54, v1, 4, 1
    v_lshl_add_u32 v52, v54, 1, v52
    v_mul_u32_u24 v52, 40, v52
    v_add_u32 v52, v52, v53
    v_mul_u32_u24_e64 v52, 40, v52
    v_bfe_u32 v53, v1, 3, 1
    v_cmp_eq_u32 s[82:83], v53, v54
    v_lshl_add_u32 v53, v53, 1, v51
    v_cmp_eq_u32 vcc, 3, v53
    v_mov_b32 v54, s24
    s_nop 0
    v_cndmask_b32 v53, v53, v54, vcc
    v_cndmask_b32 v54, v54, 4, vcc
    v_mul_u32_u24 v53, 6400, v53
    v_lshl_add_u32 v52, v54, 3, v52
    v_add_u32_e64 v52, v52, v53
    v_add_u32 v40, 160, v52
    v_mov_b32 v52, 19584
    v_cndmask_b32 v49, 0, v52, s[78:79]
    v_and_b32 v50, 15, v1
    v_lshrrev_b32 v51, 4, v1
    s_and_b32 s25, s24, 1
    s_and_b32 s26, s24, 2
    s_mul_i32 s27, s25, 3200
    s_mul_i32 s28, s26, 320
    s_add_u32 s27, s27, s28
    s_add_u32 s27, s27, 0
    v_and_b32 v52, 1, v1
    v_mul_u32_u24 v52, 1600, v52
    v_lshrrev_b32 v53, 1, v50
    v_mul_u32_u24_e64 v54, 40, v53
    v_add3_u32 v52, v52, v54, s27
    v_lshl_add_u32 v41, v51, 3, v52
    v_add_u32_e64 v42, 32, v52
    v_bfe_u32 v52, v1, 2, 1
    v_mul_u32_u24 v52, 1600, v52
    v_lshrrev_b32 v54, 3, v1
    v_mul_u32_u24 v54, 40, v54
    v_add3_u32 v52, v52, v54, s27
    v_add_u32 v52, 12800, v52
    v_and_b32 v54, 3, v1
    v_lshl_add_u32 v43, v54, 3, v52
    v_add_u32 v52, 32, v52
    v_cmp_eq_u32 vcc, 0, v54
    v_mov_b32 v54, 157696
    s_nop 0
    v_cndmask_b32 v44, v54, v52, vcc
    v_and_b32 v52, 1, v51
    v_add_u32 v52, s26, v52
    v_lshrrev_b32 v54, 2, v50
    v_lshl_add_u32 v52, v52, 2, v54
    v_and_b32 v53, 1, v53
    v_lshl_add_u32 v52, v53, 4, v52
    v_and_b32 v53, 1, v50
    v_lshl_add_u32 v52, v53, 10, v52
    s_lshl_b32 s30, s70, 1
    s_add_u32 s30, s30, s25
    s_lshl_b32 s29, s30, 3
    s_add_u32 s29, s29, s71
    s_lshl_b32 s29, s29, 13
    v_lshrrev_b32 v53, 1, v51
    v_lshlrev_b32 v53, 15, v53
    v_lshl_add_u32 v53, v52, 4, v53
    v_add_u32_e64 v45, s29, v53
    s_lshl_b32 s29, s30, 2
    s_add_u32 s29, s29, s71
    s_lshl_b32 s29, s29, 12
    s_add_u32 s29, s29, 2097152
    v_lshl_add_u32 v46, v52, 3, s29
    s_or_b32 s29, s26, s72
    s_cmp_eq_u32 s29, 0
    s_cselect_b64 s[90:91], -1, 0
    v_lshlrev_b32 v52, 2, v51
    v_sub_u32 v52, v50, v52
    v_mov_b32 v55, 0xf149f2ca
    v_subrev_u32 v53, 0, v52
    v_cmp_lt_u32 vcc, 7, v53
    s_nop 1
    v_cndmask_b32 v28, 0, v55, vcc
    v_cmp_lt_i32 vcc, -9, v53
    s_nop 1
    v_cndmask_b32 v32, 0, v55, vcc
    v_cmp_le_i32 vcc, 0, v53
    v_mov_b32 v54, 0xffff
    s_nop 0
    v_cndmask_b32 v54, 0, v54, vcc
    v_mov_b32 v36, v54
    v_subrev_u32 v53, 1, v52
    v_cmp_lt_u32 vcc, 7, v53
    s_nop 1
    v_cndmask_b32 v29, 0, v55, vcc
    v_cmp_lt_i32 vcc, -9, v53
    s_nop 1
    v_cndmask_b32 v33, 0, v55, vcc
    v_cmp_le_i32 vcc, 0, v53
    v_mov_b32 v54, 0xffff0000
    s_nop 0
    v_cndmask_b32 v54, 0, v54, vcc
    v_or_b32 v36, v36, v54
    v_subrev_u32 v53, 2, v52
    v_cmp_lt_u32 vcc, 7, v53
    s_nop 1
    v_cndmask_b32 v30, 0, v55, vcc
    v_cmp_lt_i32 vcc, -9, v53
    s_nop 1
    v_cndmask_b32 v34, 0, v55, vcc
    v_cmp_le_i32 vcc, 0, v53
    v_mov_b32 v54, 0xffff
    s_nop 0
    v_cndmask_b32 v54, 0, v54, vcc
    v_mov_b32 v37, v54
    v_subrev_u32 v53, 3, v52
    v_cmp_lt_u32 vcc, 7, v53
    s_nop 1
    v_cndmask_b32 v31, 0, v55, vcc
    v_cmp_lt_i32 vcc, -9, v53
    s_nop 1
    v_cndmask_b32 v35, 0, v55, vcc
    v_cmp_le_i32 vcc, 0, v53
    v_mov_b32 v54, 0xffff0000
    s_nop 0
    v_cndmask_b32 v54, 0, v54, vcc
    v_or_b32 v37, v37, v54
    v_and_b32 v62, 15, v1
    v_lshrrev_b32 v63, 4, v1
    s_and_b32 s25, s74, 3
    s_lshr_b32 s26, s74, 2
    s_lshl_b32 s27, s24, 6
    s_add_u32 s27, s27, s25
    s_lshl_b32 s27, s27, 13
    s_lshl_b32 s28, s26, 9
    s_add_u32 s27, s27, s28
    v_lshl_add_u32 v64, v63, 17, s27
    v_lshl_add_u32 v56, v62, 4, v64
    s_lshl_b32 s27, s24, 5
    s_add_u32 s27, s27, s25
    s_lshl_b32 s27, s27, 12
    s_lshl_b32 s28, s26, 8
    s_add_u32 s27, s27, s28
    s_add_u32 s27, s27, 2097152
    v_lshl_add_u32 v64, v63, 15, s27
    v_lshl_add_u32 v57, v62, 3, v64
    v_lshlrev_b32 v58, 4, v1
    s_lshl_b32 s29, s25, 12
    s_add_u32 s29, s29, s28
    v_lshl_add_u32 v64, v62, 4, s29
    v_lshl_add_u32 v61, v63, 2, v64
    s_mul_i32 s30, s73, 20
    s_lshl_b32 s31, s24, 2
    s_add_u32 s30, s30, s31
    s_lshl_b32 s31, s30, 14
    v_lshl_add_u32 v64, v63, 14, v64
    v_add_u32 v59, s31, v64
    s_lshl_b32 s31, s26, 7
    s_add_u32 s31, s31, s25
    s_mul_i32 s31, s31, 1280
    s_lshl_b32 s30, s30, 3
    s_add_u32 s31, s31, s30
    v_mul_u32_u24 v64, 10240, v62
    v_lshl_add_u32 v64, v63, 3, v64
    v_add_u32_e64 v60, s31, v64
    s_lshl_b32 s25, s24, 12
    v_lshl_add_u32 v62, v1, 4, s25
    s_mul_i32 s25, s24, 1216
    s_add_u32 s25, s25, 192
    v_lshl_add_u32 v63, v1, 2, s25
    s_mul_i32 s25, s24, 4864
    s_add_u32 s25, s25, 80
    v_and_b32_e64 v70, 3, v1
    v_mul_u32_u24 v70, 1216, v70
    v_bfe_u32 v71, v1, 2, 3
    v_lshl_add_u32 v70, v71, 4, v70
    v_lshrrev_b32 v71, 5, v1
    v_lshl_add_u32 v70, v71, 4, v70
    v_add_u32 v64, s25, v70
    s_mul_i32 s25, s24, 4160
    s_add_u32 s25, s25, 134368
    v_lshlrev_b32 v71, 6, v71
    v_sub_u32 v71, s25, v71
    v_bfe_u32 v70, v1, 4, 1
    v_lshl_add_u32 v71, v70, 5, v71
    v_and_b32_e64 v70, 3, v1
    v_lshl_add_u32 v71, v70, 3, v71
    v_bfe_u32 v70, v1, 2, 2
    v_lshlrev_b32 v70, 3, v70
    v_sub_u32 v65, v71, v70
    s_mul_i32 s25, s24, 4224
    s_add_u32 s25, s25, 19456
    v_and_b32 v70, 3, v1
    v_mul_u32_u24 v70, 1056, v70
    v_and_b32 v71, 60, v1
    v_add3_u32 v66, v70, v71, s25
    s_mul_i32 s25, s24, 1056
    s_add_u32 s25, s25, 19456
    v_lshl_add_u32 v67, v1, 3, s25
    s_mul_i32 s25, s24, 1280
    s_lshl_b32 s26, s75, 3
    s_add_u32 s25, s25, s26
    v_mul_u32_u24 v70, 10240, v1
    v_add_u32 v68, s25, v70
    s_and_b32 s25, s24, 1
    s_lshl_b32 s25, s25, 6
    s_and_b32 s26, s24, 2
    s_add_u32 s25, s25, s26
    s_mul_i32 s25, s25, 1280
    v_lshrrev_b32 v140, 4, v1
    v_and_b32 v141, 15, v1
    v_xor_b32 v141, v140, v141
    v_lshlrev_b32_e64 v141, 4, v141
    v_mul_u32_u24 v142, 5120, v140
    v_add3_u32 v73, v141, v142, s25
    s_and_b32 s25, s24, 1
    s_lshl_b32 s25, s25, 3
    s_add_u32 s25, s25, s26
    s_mul_i32 s25, s25, 1280
    v_add3_u32 v77, v141, v142, s25
    v_lshrrev_b32 v141, 5, v1
    v_and_b32 v140, 3, v1
    v_xor_b32 v142, v140, v141
    v_lshlrev_b32_e64 v142, 4, v142
    v_lshl_add_u32 v142, v140, 8, v142
    v_bfe_u32 v140, v1, 2, 3
    v_mul_u32_u24 v140, 1088, v140
    v_add_u32 v78, v140, v142
    v_and_b32 v140, 1, v1
    v_xor_b32 v142, v140, v141
    v_lshlrev_b32 v142, 4, v142
    v_lshl_add_u32 v142, v140, 8, v142
    v_bfe_u32 v140, v1, 1, 2
    v_mul_u32_u24 v140, 544, v140
    v_add_u32_e64 v142, v140, v142
    v_add_u32 v74, 19392, v73
    v_add_u32 v75, 38784, v73
    v_add_u32 v76, 58176, v73
    v_add_u32 v142, 53760, v142
    v_and_b32 v140, 31, v1
    v_cmp_eq_u32 vcc, 0, v140
    v_cmp_eq_u32 s[82:83], 24, v140
    s_nop 0
    s_or_b64 vcc, vcc, s[82:83]
    v_mov_b32 v140, 155648
    v_mov_b32 v141, 157696
    v_cndmask_b32_e64 v140, v140, v141, vcc
    v_cndmask_b32 v79, v140, v142, s[78:79]
    v_bfe_u32 v201, v1, 3, 2
    v_and_b32 v202, s24, v201
    v_cmp_eq_u32 vcc, 3, v202
    v_lshrrev_b32 v202, 5, v1
    v_lshl_add_u32 v201, v201, 1, v202
    v_and_b32 v202, 7, v1
    v_lshl_add_u32 v201, v201, 3, v202
    v_lshlrev_b32 v200, 4, v201
    v_mov_b32 v201, 1073741824
    v_cndmask_b32 v200, v200, v201, vcc
    s_lshl_b32 s101, s70, 2
    s_add_u32 s101, s101, s24
    s_mul_i32 s101, s101, 40960
    s_add_u32 s101, s101, 0
    s_lshl_b32 s25, s72, 5
    s_add_u32 s25, s25, 0
    s_sub_u32 s26, s25, 4
    s_max_i32 s26, s26, 0
    s_mul_i32 s27, s71, 1280
    s_mul_i32 s99, s25, 5120
    s_mul_i32 s100, s26, 5120
    s_mul_i32 s92, s24, 4352
    s_mul_i32 s93, s24, 544
    s_add_u32 s99, s99, s27
    s_add_u32 s100, s100, s27
    s_mov_b32 s38, 0x10000
    s_mov_b32 s39, 0x1000
    s_cmp_ge_u32 s2, 160
    s_cbranch_scc1 nc_3
    s_mul_i32 s37, s24, 8704
    s_add_u32 s25, s37, 0
    s_add_u32 s37, s37, 0
    s_mov_b32 m0, s37
    v_and_b32 v199, 31, v1
    v_mul_u32_u24 v199, 272, v199
    v_lshrrev_b32 v215, 5, v1
    v_lshl_add_u32 v199, v215, 4, v199
    v_add_u32 v252, s25, v199
    s_waitcnt vmcnt(4)
    v_lshlrev_b32 v253, 16, v240
    v_mul_f32 v253, 0x3fb8aa3b, v253
    v_exp_f32 v253, v253
    s_nop 0
    v_cvt_pk_bf16_f32 v253, v253, v253
    v_lshlrev_b32 v253, 16, v253
    v_lshlrev_b32 v199, 16, v232
    v_mul_f32 v199, 0x3fb8aa3b, v199
    v_exp_f32 v199, v199
    v_lshlrev_b32 v255, 16, v233
    v_mul_f32 v255, v255, v253
    v_mul_f32 v255, 0x3e22f983, v255
    v_cvt_pk_bf16_f32 v199, v199, v199
    v_lshlrev_b32 v199, 16, v199
    v_mul_f32_e64 v254, v199, v253
    v_mul_f32 v254, 0xbfb8aa3b, v254
    v_mul_f32 v182, 0x41000000, v254
    v_mul_f32 v185, 0x41000000, v255
    v_mul_f32 v184, 0x43800000, v254
    v_mul_f32 v189, 0x43800000, v255
    v_fract_f32 v185, v185
    v_fract_f32 v188, v255
    s_waitcnt vmcnt(1)
    s_barrier
    ds_read_b64_tr_b16 v[96:97], v111
    ds_read_b64_tr_b16 v[98:99], v111 offset:2560
    ds_read_b64_tr_b16 v[100:101], v112
    ds_read_b64_tr_b16 v[102:103], v112 offset:2560
    ds_read_b64_tr_b16 v[104:105], v113
    ds_read_b64_tr_b16 v[106:107], v113 offset:2560
    s_waitcnt lgkmcnt(4)
    buffer_store_dwordx4 v[96:99], v108, s[16:19], 0 offen sc1
    s_waitcnt lgkmcnt(2)
    buffer_store_dwordx4 v[100:103], v109, s[16:19], 0 offen sc1
    s_waitcnt lgkmcnt(0)
    buffer_store_dwordx4 v[104:107], v110, s[16:19], 0 offen sc1
    global_load_dword v7, v5, s[66:67] sc1
    v_fract_f32 v189, v189
    v_exp_f32 v182, v182
    v_exp_f32 v183, v254
    v_exp_f32 v184, v184
    v_cos_f32 v186, v185
    v_sin_f32 v187, v185
    v_cos_f32 v180, v188
    v_sin_f32 v181, v188
    v_cos_f32 v190, v189
    v_sin_f32 v191, v189
    v_lshlrev_b32 v192, 16, v234
    v_lshlrev_b32 v193, 16, v235
    v_add_f32 v199, v253, v253
    v_mul_f32 v192, v192, v199
    v_mul_f32 v193, v193, v199
    v_mul_f32 v186, v186, v182
    v_mul_f32 v187, v187, v182
    v_mul_f32 v180, v180, v183
    v_mul_f32 v181, v181, v183
    v_mul_f32 v190, v190, v184
    v_mul_f32 v191, v191, v184
    v_mov_b32 v242, 0x3f80
    v_cvt_pk_bf16_f32 v243, v186, v187
    v_pk_mul_f32 v[194:195], v[186:187], v[186:187] op_sel:[0,0] op_sel_hi:[0,1]
    v_pk_fma_f32 v[172:173], v[186:187], v[186:187], v[194:195] op_sel:[1,1,0] op_sel_hi:[1,0,1] neg_lo:[0,1,0]
    v_cvt_pk_bf16_f32 v244, v172, v173
    v_pk_mul_f32 v[194:195], v[172:173], v[186:187] op_sel:[0,0] op_sel_hi:[0,1]
    v_pk_fma_f32 v[174:175], v[172:173], v[186:187], v[194:195] op_sel:[1,1,0] op_sel_hi:[1,0,1] neg_lo:[0,1,0]
    v_cvt_pk_bf16_f32 v245, v174, v175
    v_pk_mul_f32 v[194:195], v[174:175], v[186:187] op_sel:[0,0] op_sel_hi:[0,1]
    v_pk_fma_f32 v[172:173], v[174:175], v[186:187], v[194:195] op_sel:[1,1,0] op_sel_hi:[1,0,1] neg_lo:[0,1,0]
    v_cvt_pk_bf16_f32 v246, v172, v173
    v_pk_mul_f32 v[194:195], v[172:173], v[186:187] op_sel:[0,0] op_sel_hi:[0,1]
    v_pk_fma_f32 v[174:175], v[172:173], v[186:187], v[194:195] op_sel:[1,1,0] op_sel_hi:[1,0,1] neg_lo:[0,1,0]
    v_cvt_pk_bf16_f32 v247, v174, v175
    v_pk_mul_f32 v[194:195], v[174:175], v[186:187] op_sel:[0,0] op_sel_hi:[0,1]
    v_pk_fma_f32 v[172:173], v[174:175], v[186:187], v[194:195] op_sel:[1,1,0] op_sel_hi:[1,0,1] neg_lo:[0,1,0]
    v_cvt_pk_bf16_f32 v248, v172, v173
    v_pk_mul_f32 v[194:195], v[172:173], v[186:187] op_sel:[0,0] op_sel_hi:[0,1]
    v_pk_fma_f32 v[174:175], v[172:173], v[186:187], v[194:195] op_sel:[1,1,0] op_sel_hi:[1,0,1] neg_lo:[0,1,0]
    s_min_u32 s96, s75, 159
    s_lshl_b32 s96, s96, 2
    s_add_u32 s96, s96, s24
    s_mul_i32 s97, s96, 384
    s_lshl_b32 s96, s96, 1
    v_lshl_add_u32 v2, v1, 1, s97
    v_mov_b32 v241, s96
    global_load_ushort v236, v2, s[52:53] offset:256
    global_load_ushort v237, v2, s[54:55] offset:256
    global_load_ushort v238, v2, s[56:57] offset:256
    global_load_ushort v239, v2, s[58:59] offset:256
    global_load_ushort v241, v241, s[62:63]
    v_cvt_pk_bf16_f32 v249, v174, v175
    v_pk_mul_f32 v[194:195], v[174:175], v[186:187] op_sel:[0,0] op_sel_hi:[0,1]
    v_pk_fma_f32 v[172:173], v[174:175], v[186:187], v[194:195] op_sel:[1,1,0] op_sel_hi:[1,0,1] neg_lo:[0,1,0]
    v_cvt_pk_bf16_f32 v250, v172, v173
    v_pk_mul_f32 v[194:195], v[172:173], v[186:187] op_sel:[0,0] op_sel_hi:[0,1]
    v_pk_fma_f32 v[174:175], v[172:173], v[186:187], v[194:195] op_sel:[1,1,0] op_sel_hi:[1,0,1] neg_lo:[0,1,0]
    v_cvt_pk_bf16_f32 v251, v174, v175
    ds_write_addtid_b32 v242 offset:0
    ds_write_addtid_b32 v243 offset:272
    ds_write_addtid_b32 v244 offset:544
    ds_write_addtid_b32 v245 offset:816
    ds_write_addtid_b32 v246 offset:1088
    ds_write_addtid_b32 v247 offset:1360
    ds_write_addtid_b32 v248 offset:1632
    ds_write_addtid_b32 v249 offset:1904
    ds_write_addtid_b32 v250 offset:2176
    ds_write_addtid_b32 v251 offset:2448
    v_pk_mul_f32 v[194:195], v[174:175], v[186:187] op_sel:[0,0] op_sel_hi:[0,1]
    v_pk_fma_f32 v[172:173], v[174:175], v[186:187], v[194:195] op_sel:[1,1,0] op_sel_hi:[1,0,1] neg_lo:[0,1,0]
    v_cvt_pk_bf16_f32 v242, v172, v173
    v_pk_mul_f32 v[194:195], v[172:173], v[186:187] op_sel:[0,0] op_sel_hi:[0,1]
    v_pk_fma_f32 v[174:175], v[172:173], v[186:187], v[194:195] op_sel:[1,1,0] op_sel_hi:[1,0,1] neg_lo:[0,1,0]
    v_cvt_pk_bf16_f32 v243, v174, v175
    v_pk_mul_f32 v[194:195], v[174:175], v[186:187] op_sel:[0,0] op_sel_hi:[0,1]
    v_pk_fma_f32 v[172:173], v[174:175], v[186:187], v[194:195] op_sel:[1,1,0] op_sel_hi:[1,0,1] neg_lo:[0,1,0]
    v_cvt_pk_bf16_f32 v244, v172, v173
    v_pk_mul_f32 v[194:195], v[172:173], v[186:187] op_sel:[0,0] op_sel_hi:[0,1]
    v_pk_fma_f32 v[174:175], v[172:173], v[186:187], v[194:195] op_sel:[1,1,0] op_sel_hi:[1,0,1] neg_lo:[0,1,0]
    v_cvt_pk_bf16_f32 v245, v174, v175
    v_pk_mul_f32 v[194:195], v[174:175], v[186:187] op_sel:[0,0] op_sel_hi:[0,1]
    v_pk_fma_f32 v[172:173], v[174:175], v[186:187], v[194:195] op_sel:[1,1,0] op_sel_hi:[1,0,1] neg_lo:[0,1,0]
    v_cvt_pk_bf16_f32 v246, v172, v173
    v_pk_mul_f32 v[194:195], v[172:173], v[186:187] op_sel:[0,0] op_sel_hi:[0,1]
    v_pk_fma_f32 v[174:175], v[172:173], v[186:187], v[194:195] op_sel:[1,1,0] op_sel_hi:[1,0,1] neg_lo:[0,1,0]
    v_cvt_pk_bf16_f32 v247, v174, v175
    v_pk_mul_f32 v[194:195], v[174:175], v[186:187] op_sel:[0,0] op_sel_hi:[0,1]
    v_pk_fma_f32 v[172:173], v[174:175], v[186:187], v[194:195] op_sel:[1,1,0] op_sel_hi:[1,0,1] neg_lo:[0,1,0]
    v_cvt_pk_bf16_f32 v248, v172, v173
    v_pk_mul_f32 v[194:195], v[172:173], v[186:187] op_sel:[0,0] op_sel_hi:[0,1]
    v_pk_fma_f32 v[174:175], v[172:173], v[186:187], v[194:195] op_sel:[1,1,0] op_sel_hi:[1,0,1] neg_lo:[0,1,0]
    v_lshrrev_b32 v132, 5, v0
    v_and_b32 v133, 31, v0
    v_mul_u32_u24 v132, 1280, v132
    v_lshl_add_u32 v134, v133, 4, v132
    v_mov_b32 v135, 1073741824
    v_cmp_gt_u32 vcc, 16, v133
    s_mul_i32 s96, s2, 10240
    buffer_load_dwordx4 v[120:123], v134, s[4:7], s96 offen
    v_cndmask_b32_e64 v135, v135, v134, vcc
    buffer_load_dwordx4 v[124:127], v134, s[4:7], s96 offen offset:512
    buffer_load_dwordx4 v[128:131], v135, s[4:7], s96 offen offset:1024
    v_cvt_pk_bf16_f32 v249, v174, v175
    v_pk_mul_f32 v[194:195], v[174:175], v[186:187] op_sel:[0,0] op_sel_hi:[0,1]
    v_pk_fma_f32 v[172:173], v[174:175], v[186:187], v[194:195] op_sel:[1,1,0] op_sel_hi:[1,0,1] neg_lo:[0,1,0]
    v_cvt_pk_bf16_f32 v250, v172, v173
    v_pk_mul_f32 v[194:195], v[172:173], v[186:187] op_sel:[0,0] op_sel_hi:[0,1]
    v_pk_fma_f32 v[174:175], v[172:173], v[186:187], v[194:195] op_sel:[1,1,0] op_sel_hi:[1,0,1] neg_lo:[0,1,0]
    v_cvt_pk_bf16_f32 v251, v174, v175
    ds_write_addtid_b32 v242 offset:2720
    ds_write_addtid_b32 v243 offset:2992
    ds_write_addtid_b32 v244 offset:3264
    ds_write_addtid_b32 v245 offset:3536
    ds_write_addtid_b32 v246 offset:3808
    ds_write_addtid_b32 v247 offset:4080
    ds_write_addtid_b32 v248 offset:4352
    ds_write_addtid_b32 v249 offset:4624
    ds_write_addtid_b32 v250 offset:4896
    ds_write_addtid_b32 v251 offset:5168
    v_pk_mul_f32 v[194:195], v[174:175], v[186:187] op_sel:[0,0] op_sel_hi:[0,1]
    v_pk_fma_f32 v[172:173], v[174:175], v[186:187], v[194:195] op_sel:[1,1,0] op_sel_hi:[1,0,1] neg_lo:[0,1,0]
    v_cvt_pk_bf16_f32 v242, v172, v173
    v_pk_mul_f32 v[194:195], v[172:173], v[186:187] op_sel:[0,0] op_sel_hi:[0,1]
    v_pk_fma_f32 v[174:175], v[172:173], v[186:187], v[194:195] op_sel:[1,1,0] op_sel_hi:[1,0,1] neg_lo:[0,1,0]
    v_cvt_pk_bf16_f32 v243, v174, v175
    v_pk_mul_f32 v[194:195], v[174:175], v[186:187] op_sel:[0,0] op_sel_hi:[0,1]
    v_pk_fma_f32 v[172:173], v[174:175], v[186:187], v[194:195] op_sel:[1,1,0] op_sel_hi:[1,0,1] neg_lo:[0,1,0]
    v_cvt_pk_bf16_f32 v244, v172, v173
    v_pk_mul_f32 v[194:195], v[172:173], v[186:187] op_sel:[0,0] op_sel_hi:[0,1]
    v_pk_fma_f32 v[174:175], v[172:173], v[186:187], v[194:195] op_sel:[1,1,0] op_sel_hi:[1,0,1] neg_lo:[0,1,0]
    v_cvt_pk_bf16_f32 v245, v174, v175
    v_pk_mul_f32 v[194:195], v[174:175], v[186:187] op_sel:[0,0] op_sel_hi:[0,1]
    v_pk_fma_f32 v[172:173], v[174:175], v[186:187], v[194:195] op_sel:[1,1,0] op_sel_hi:[1,0,1] neg_lo:[0,1,0]
    v_cvt_pk_bf16_f32 v246, v172, v173
    v_pk_mul_f32 v[194:195], v[172:173], v[186:187] op_sel:[0,0] op_sel_hi:[0,1]
    v_pk_fma_f32 v[174:175], v[172:173], v[186:187], v[194:195] op_sel:[1,1,0] op_sel_hi:[1,0,1] neg_lo:[0,1,0]
    v_cvt_pk_bf16_f32 v247, v174, v175
    v_pk_mul_f32 v[194:195], v[174:175], v[186:187] op_sel:[0,0] op_sel_hi:[0,1]
    v_pk_fma_f32 v[172:173], v[174:175], v[186:187], v[194:195] op_sel:[1,1,0] op_sel_hi:[1,0,1] neg_lo:[0,1,0]
    v_cvt_pk_bf16_f32 v248, v172, v173
    v_pk_mul_f32 v[194:195], v[172:173], v[186:187] op_sel:[0,0] op_sel_hi:[0,1]
    v_pk_fma_f32 v[174:175], v[172:173], v[186:187], v[194:195] op_sel:[1,1,0] op_sel_hi:[1,0,1] neg_lo:[0,1,0]
    v_mov_b32 v140, 1073741824
    v_lshlrev_b32 v141, 2, v0
    v_cmp_gt_u32 vcc, 64, v0
    s_nop 1
    v_cndmask_b32 v141, v140, v141, vcc
    v_mov_b32_e64 v140, 0
    s_lshl_b32 s97, s2, 8
    s_add_u32 s97, s97, 3473408
    buffer_store_dword v140, v141, s[16:19], s97 offen sc1
    v_cvt_pk_bf16_f32 v249, v174, v175
    v_pk_mul_f32 v[194:195], v[174:175], v[186:187] op_sel:[0,0] op_sel_hi:[0,1]
    v_pk_fma_f32 v[172:173], v[174:175], v[186:187], v[194:195] op_sel:[1,1,0] op_sel_hi:[1,0,1] neg_lo:[0,1,0]
    v_cvt_pk_bf16_f32 v250, v172, v173
    v_pk_mul_f32 v[194:195], v[172:173], v[186:187] op_sel:[0,0] op_sel_hi:[0,1]
    v_pk_fma_f32 v[174:175], v[172:173], v[186:187], v[194:195] op_sel:[1,1,0] op_sel_hi:[1,0,1] neg_lo:[0,1,0]
    v_cvt_pk_bf16_f32 v251, v174, v175
    ds_write_addtid_b32 v242 offset:5440
    ds_write_addtid_b32 v243 offset:5712
    ds_write_addtid_b32 v244 offset:5984
    ds_write_addtid_b32 v245 offset:6256
    ds_write_addtid_b32 v246 offset:6528
    ds_write_addtid_b32 v247 offset:6800
    ds_write_addtid_b32 v248 offset:7072
    ds_write_addtid_b32 v249 offset:7344
    ds_write_addtid_b32 v250 offset:7616
    ds_write_addtid_b32 v251 offset:7888
    v_pk_mul_f32 v[194:195], v[174:175], v[186:187] op_sel:[0,0] op_sel_hi:[0,1]
    v_pk_fma_f32 v[172:173], v[174:175], v[186:187], v[194:195] op_sel:[1,1,0] op_sel_hi:[1,0,1] neg_lo:[0,1,0]
    v_cvt_pk_bf16_f32 v242, v172, v173
    v_pk_mul_f32 v[194:195], v[172:173], v[186:187] op_sel:[0,0] op_sel_hi:[0,1]
    v_pk_fma_f32 v[174:175], v[172:173], v[186:187], v[194:195] op_sel:[1,1,0] op_sel_hi:[1,0,1] neg_lo:[0,1,0]
    v_cvt_pk_bf16_f32 v243, v174, v175
    ds_write_addtid_b32 v242 offset:8160
    ds_write_addtid_b32 v243 offset:8432
    ds_read_b128 a[160:163], v252 offset:0
    ds_read_b128 a[164:167], v252 offset:32
    ds_read_b128 a[168:171], v252 offset:64
    ds_read_b128 a[172:175], v252 offset:96
    ds_read_b128 a[176:179], v252 offset:128
    ds_read_b128 a[180:183], v252 offset:160
    ds_read_b128 a[184:187], v252 offset:192
    ds_read_b128 a[188:191], v252 offset:224
    v_pk_mul_f32 v[194:195], v[180:181], v[180:181] op_sel:[0,0] op_sel_hi:[0,1]
    v_pk_fma_f32 v[182:183], v[180:181], v[180:181], v[194:195] op_sel:[1,1,0] op_sel_hi:[1,0,1] neg_lo:[0,1,0]
    v_pk_mul_f32 v[194:195], v[182:183], v[182:183] op_sel:[0,0] op_sel_hi:[0,1]
    v_pk_fma_f32 v[184:185], v[182:183], v[182:183], v[194:195] op_sel:[1,1,0] op_sel_hi:[1,0,1] neg_lo:[0,1,0]
    v_cvt_pk_bf16_f32 v242, v192, -v193
    v_pk_mul_f32 v[194:195], v[192:193], v[180:181] op_sel:[0,0] op_sel_hi:[0,1]
    v_pk_fma_f32 v[174:175], v[192:193], v[180:181], v[194:195] op_sel:[1,1,0] op_sel_hi:[1,0,1] neg_lo:[0,1,0]
    v_mov_b32 v142, 1073741824
    v_lshlrev_b32 v143, 2, v0
    v_cmp_gt_u32 vcc, 16, v0
    s_nop 1
    v_cndmask_b32 v143, v142, v143, vcc
    v_mov_b32_e64 v142, -1
    s_lshl_b32 s97, s2, 6
    s_add_u32 s97, s97, 3457024
    buffer_store_dword v142, v143, s[16:19], s97 offen sc1
    v_cvt_pk_bf16_f32 v243, v174, -v175
    v_pk_mul_f32 v[194:195], v[174:175], v[180:181] op_sel:[0,0] op_sel_hi:[0,1]
    v_pk_fma_f32 v[172:173], v[174:175], v[180:181], v[194:195] op_sel:[1,1,0] op_sel_hi:[1,0,1] neg_lo:[0,1,0]
    v_cvt_pk_bf16_f32 v244, v172, -v173
    v_pk_mul_f32 v[194:195], v[172:173], v[180:181] op_sel:[0,0] op_sel_hi:[0,1]
    v_pk_fma_f32 v[174:175], v[172:173], v[180:181], v[194:195] op_sel:[1,1,0] op_sel_hi:[1,0,1] neg_lo:[0,1,0]
    v_cvt_pk_bf16_f32 v245, v174, -v175
    v_pk_mul_f32 v[194:195], v[174:175], v[180:181] op_sel:[0,0] op_sel_hi:[0,1]
    v_pk_fma_f32 v[172:173], v[174:175], v[180:181], v[194:195] op_sel:[1,1,0] op_sel_hi:[1,0,1] neg_lo:[0,1,0]
    v_cvt_pk_bf16_f32 v246, v172, -v173
    v_pk_mul_f32 v[194:195], v[172:173], v[180:181] op_sel:[0,0] op_sel_hi:[0,1]
    v_pk_fma_f32 v[174:175], v[172:173], v[180:181], v[194:195] op_sel:[1,1,0] op_sel_hi:[1,0,1] neg_lo:[0,1,0]
    v_cvt_pk_bf16_f32 v247, v174, -v175
    v_pk_mul_f32 v[194:195], v[174:175], v[180:181] op_sel:[0,0] op_sel_hi:[0,1]
    v_pk_fma_f32 v[172:173], v[174:175], v[180:181], v[194:195] op_sel:[1,1,0] op_sel_hi:[1,0,1] neg_lo:[0,1,0]
    v_cvt_pk_bf16_f32 v248, v172, -v173
    v_pk_mul_f32 v[194:195], v[172:173], v[180:181] op_sel:[0,0] op_sel_hi:[0,1]
    v_pk_fma_f32 v[174:175], v[172:173], v[180:181], v[194:195] op_sel:[1,1,0] op_sel_hi:[1,0,1] neg_lo:[0,1,0]
    v_cvt_pk_bf16_f32 v249, v174, -v175
    v_pk_mul_f32 v[194:195], v[192:193], v[190:191] op_sel:[0,0] op_sel_hi:[0,1]
    v_pk_fma_f32 v[176:177], v[192:193], v[190:191], v[194:195] op_sel:[1,1,0] op_sel_hi:[1,0,1] neg_lo:[0,1,0]
    v_cvt_pk_bf16_f32 v250, v176, -v177
    v_pk_mul_f32 v[194:195], v[176:177], v[182:183] op_sel:[0,0] op_sel_hi:[0,1]
    v_pk_fma_f32 v[174:175], v[176:177], v[182:183], v[194:195] op_sel:[1,1,0] op_sel_hi:[1,0,1] neg_lo:[0,1,0]
    v_cvt_pk_bf16_f32 v251, v174, -v175
    ds_write_addtid_b32 v242 offset:0
    ds_write_addtid_b32 v243 offset:272
    ds_write_addtid_b32 v244 offset:544
    ds_write_addtid_b32 v245 offset:816
    ds_write_addtid_b32 v246 offset:1088
    ds_write_addtid_b32 v247 offset:1360
    ds_write_addtid_b32 v248 offset:1632
    ds_write_addtid_b32 v249 offset:1904
    ds_write_addtid_b32 v250 offset:2176
    ds_write_addtid_b32 v251 offset:2448
    v_pk_mul_f32 v[194:195], v[174:175], v[182:183] op_sel:[0,0] op_sel_hi:[0,1]
    v_pk_fma_f32 v[172:173], v[174:175], v[182:183], v[194:195] op_sel:[1,1,0] op_sel_hi:[1,0,1] neg_lo:[0,1,0]
    v_cvt_pk_bf16_f32 v242, v172, -v173
    v_pk_mul_f32 v[194:195], v[172:173], v[182:183] op_sel:[0,0] op_sel_hi:[0,1]
    v_pk_fma_f32 v[174:175], v[172:173], v[182:183], v[194:195] op_sel:[1,1,0] op_sel_hi:[1,0,1] neg_lo:[0,1,0]
    s_waitcnt vmcnt(11)
    s_waitcnt vmcnt(10)
    v_cmp_gt_u32 vcc, 1, v7
    s_nop 0
    s_and_b64 vcc, vcc, s[50:51]
    s_and_b64 vcc, vcc, 1
    s_cbranch_scc1 ps_5
pc_7:
    s_barrier
    v_lshlrev_b32 v2, 3, v4
    v_mov_b32 v5, 1
    v_cndmask_b32 v2, v4, v2, s[50:51]
    buffer_atomic_add v5, v2, s[16:19], s86 offen offset:0 sc1
    v_cvt_pk_bf16_f32 v243, v174, -v175
    v_pk_mul_f32 v[194:195], v[174:175], v[182:183] op_sel:[0,0] op_sel_hi:[0,1]
    v_pk_fma_f32 v[172:173], v[174:175], v[182:183], v[194:195] op_sel:[1,1,0] op_sel_hi:[1,0,1] neg_lo:[0,1,0]
    v_cvt_pk_bf16_f32 v244, v172, -v173
    v_pk_mul_f32 v[194:195], v[176:177], v[190:191] op_sel:[0,0] op_sel_hi:[0,1]
    v_pk_fma_f32 v[178:179], v[176:177], v[190:191], v[194:195] op_sel:[1,1,0] op_sel_hi:[1,0,1] neg_lo:[0,1,0]
    v_cvt_pk_bf16_f32 v245, v178, -v179
    v_pk_mul_f32 v[194:195], v[178:179], v[184:185] op_sel:[0,0] op_sel_hi:[0,1]
    v_pk_fma_f32 v[174:175], v[178:179], v[184:185], v[194:195] op_sel:[1,1,0] op_sel_hi:[1,0,1] neg_lo:[0,1,0]
    v_cvt_pk_bf16_f32 v246, v174, -v175
    v_pk_mul_f32 v[194:195], v[174:175], v[184:185] op_sel:[0,0] op_sel_hi:[0,1]
    v_pk_fma_f32 v[172:173], v[174:175], v[184:185], v[194:195] op_sel:[1,1,0] op_sel_hi:[1,0,1] neg_lo:[0,1,0]
    v_cvt_pk_bf16_f32 v247, v172, -v173
    v_pk_mul_f32 v[194:195], v[178:179], v[190:191] op_sel:[0,0] op_sel_hi:[0,1]
    v_pk_fma_f32 v[176:177], v[178:179], v[190:191], v[194:195] op_sel:[1,1,0] op_sel_hi:[1,0,1] neg_lo:[0,1,0]
    v_cvt_pk_bf16_f32 v248, v176, -v177
    v_pk_mul_f32 v[194:195], v[176:177], v[184:185] op_sel:[0,0] op_sel_hi:[0,1]
    v_pk_fma_f32 v[174:175], v[176:177], v[184:185], v[194:195] op_sel:[1,1,0] op_sel_hi:[1,0,1] neg_lo:[0,1,0]
    v_cvt_pk_bf16_f32 v249, v174, -v175
    v_pk_mul_f32 v[194:195], v[174:175], v[184:185] op_sel:[0,0] op_sel_hi:[0,1]
    v_pk_fma_f32 v[172:173], v[174:175], v[184:185], v[194:195] op_sel:[1,1,0] op_sel_hi:[1,0,1] neg_lo:[0,1,0]
    v_cvt_pk_bf16_f32 v250, v172, -v173
    v_pk_mul_f32 v[194:195], v[176:177], v[190:191] op_sel:[0,0] op_sel_hi:[0,1]
    v_pk_fma_f32 v[178:179], v[176:177], v[190:191], v[194:195] op_sel:[1,1,0] op_sel_hi:[1,0,1] neg_lo:[0,1,0]
    v_cvt_pk_bf16_f32 v251, v178, -v179
    ds_write_addtid_b32 v242 offset:2720
    ds_write_addtid_b32 v242 offset:3264
    ds_write_addtid_b32 v243 offset:3536
    ds_write_addtid_b32 v244 offset:3808
    ds_write_addtid_b32 v245 offset:4352
    ds_write_addtid_b32 v246 offset:4624
    ds_write_addtid_b32 v247 offset:4896
    ds_write_addtid_b32 v248 offset:5440
    ds_write_addtid_b32 v249 offset:5712
    ds_write_addtid_b32 v250 offset:5984
    v_mov_b32 v144, -1
    v_mov_b32 v145, -1
    v_mov_b32 v146, -1
    v_mov_b32 v147, -1
    v_lshlrev_b32 v148, 4, v0
    s_sub_u32 s88, s2, 0
    s_mul_i32 s88, s88, 20480
    s_min_u32 s88, s88, 5222400
    s_add_u32 s88, s88, 4194304
    buffer_store_dwordx4 v[144:147], v148, s[16:19], s88 offen sc1
    ds_write_addtid_b32 v251 offset:6528
    v_pk_mul_f32 v[194:195], v[178:179], v[186:187] op_sel:[0,0] op_sel_hi:[0,1]
    v_pk_fma_f32 v[174:175], v[178:179], v[186:187], v[194:195] op_sel:[1,1,0] op_sel_hi:[1,0,1] neg_lo:[0,1,0]
    v_cvt_pk_bf16_f32 v242, v174, -v175
    v_pk_mul_f32 v[194:195], v[178:179], v[190:191] op_sel:[0,0] op_sel_hi:[0,1]
    v_pk_fma_f32 v[176:177], v[178:179], v[190:191], v[194:195] op_sel:[1,1,0] op_sel_hi:[1,0,1] neg_lo:[0,1,0]
    v_cvt_pk_bf16_f32 v243, v176, -v177
    v_pk_mul_f32 v[194:195], v[176:177], v[186:187] op_sel:[0,0] op_sel_hi:[0,1]
    v_pk_fma_f32 v[174:175], v[176:177], v[186:187], v[194:195] op_sel:[1,1,0] op_sel_hi:[1,0,1] neg_lo:[0,1,0]
    v_cvt_pk_bf16_f32 v244, v174, -v175
    v_pk_mul_f32 v[194:195], v[176:177], v[190:191] op_sel:[0,0] op_sel_hi:[0,1]
    v_pk_fma_f32 v[178:179], v[176:177], v[190:191], v[194:195] op_sel:[1,1,0] op_sel_hi:[1,0,1] neg_lo:[0,1,0]
    v_cvt_pk_bf16_f32 v245, v178, -v179
    v_pk_mul_f32 v[194:195], v[178:179], v[186:187] op_sel:[0,0] op_sel_hi:[0,1]
    v_pk_fma_f32 v[174:175], v[178:179], v[186:187], v[194:195] op_sel:[1,1,0] op_sel_hi:[1,0,1] neg_lo:[0,1,0]
    v_cvt_pk_bf16_f32 v246, v174, -v175
    v_pk_mul_f32 v[194:195], v[178:179], v[190:191] op_sel:[0,0] op_sel_hi:[0,1]
    v_pk_fma_f32 v[176:177], v[178:179], v[190:191], v[194:195] op_sel:[1,1,0] op_sel_hi:[1,0,1] neg_lo:[0,1,0]
    v_cvt_pk_bf16_f32 v247, v176, -v177
    v_pk_mul_f32 v[194:195], v[176:177], v[186:187] op_sel:[0,0] op_sel_hi:[0,1]
    v_pk_fma_f32 v[174:175], v[176:177], v[186:187], v[194:195] op_sel:[1,1,0] op_sel_hi:[1,0,1] neg_lo:[0,1,0]
    v_cvt_pk_bf16_f32 v248, v174, -v175
    ds_write_addtid_b32 v242 offset:6800
    ds_write_addtid_b32 v243 offset:7072
    ds_write_addtid_b32 v244 offset:7344
    ds_write_addtid_b32 v245 offset:7616
    ds_write_addtid_b32 v246 offset:7888
    ds_write_addtid_b32 v247 offset:8160
    ds_write_addtid_b32 v248 offset:8432
    ds_read_b128 a[192:195], v252 offset:0
    ds_read_b128 a[196:199], v252 offset:32
    ds_read_b128 a[200:203], v252 offset:64
    ds_read_b128 a[204:207], v252 offset:96
    ds_read_b128 a[208:211], v252 offset:128
    ds_read_b128 a[212:215], v252 offset:160
    s_add_u32 s88, s88, 4096
    buffer_store_dwordx4 v[144:147], v148, s[16:19], s88 offen sc1
    ds_read_b128 a[216:219], v252 offset:192
    ds_read_b128 a[220:223], v252 offset:224
    v_and_b32 v199, 0xffff0000, v232
    v_mul_f32 v199, 0x3fb8aa3b, v199
    v_exp_f32 v199, v199
    v_and_b32 v255, 0xffff0000, v233
    v_mul_f32 v255, v255, v253
    v_mul_f32 v255, 0x3e22f983, v255
    v_cvt_pk_bf16_f32 v199, v199, v199
    v_lshlrev_b32 v199, 16, v199
    v_mul_f32 v254, v199, v253
    v_mul_f32 v254, 0xbfb8aa3b, v254
    s_waitcnt lgkmcnt(7)
    v_mfma_f32_32x32x16_bf16 v[216:231], a[192:195], a[160:163], 0
    v_mul_f32 v182, 0x41000000, v254
    v_mul_f32 v185, 0x41000000, v255
    v_mul_f32 v184, 0x43800000, v254
    v_mul_f32 v189, 0x43800000, v255
    s_waitcnt lgkmcnt(6)
    v_mfma_f32_32x32x16_bf16 v[216:231], a[196:199], a[164:167], v[216:231]
    v_fract_f32 v185, v185
    v_fract_f32 v188, v255
    v_fract_f32 v189, v189
    v_exp_f32 v182, v182
    s_waitcnt lgkmcnt(5)
    v_mfma_f32_32x32x16_bf16 v[216:231], a[200:203], a[168:171], v[216:231]
    v_exp_f32 v183, v254
    v_exp_f32 v184, v184
    v_cos_f32 v186, v185
    v_sin_f32 v187, v185
    s_waitcnt lgkmcnt(4)
    v_mfma_f32_32x32x16_bf16 v[216:231], a[204:207], a[172:175], v[216:231]
    v_cos_f32 v180, v188
    v_sin_f32 v181, v188
    v_cos_f32 v190, v189
    v_sin_f32 v191, v189
    s_waitcnt lgkmcnt(3)
    v_mfma_f32_32x32x16_bf16 v[216:231], a[208:211], a[176:179], v[216:231]
    v_and_b32 v192, 0xffff0000, v234
    v_and_b32 v193, 0xffff0000, v235
    s_add_u32 s88, s88, 4096
    buffer_store_dwordx4 v[144:147], v148, s[16:19], s88 offen sc1
    v_add_f32 v199, v253, v253
    v_mul_f32 v192, v192, v199
    s_waitcnt lgkmcnt(2)
    v_mfma_f32_32x32x16_bf16 v[216:231], a[212:215], a[180:183], v[216:231]
    v_mul_f32 v193, v193, v199
    v_mul_f32 v186, v186, v182
    v_mul_f32 v187, v187, v182
    v_mul_f32 v180, v180, v183
    s_waitcnt lgkmcnt(1)
    v_mfma_f32_32x32x16_bf16 v[216:231], a[216:219], a[184:187], v[216:231]
    v_mul_f32 v181, v181, v183
    v_mul_f32 v190, v190, v184
    v_mul_f32 v191, v191, v184
    s_waitcnt lgkmcnt(0)
    v_mfma_f32_32x32x16_bf16 v[216:231], a[220:223], a[188:191], v[216:231]
    v_mov_b32 v242, 0x3f80
    v_cvt_pk_bf16_f32 v243, v186, v187
    v_pk_mul_f32 v[194:195], v[186:187], v[186:187] op_sel:[0,0] op_sel_hi:[0,1]
    v_pk_fma_f32 v[172:173], v[186:187], v[186:187], v[194:195] op_sel:[1,1,0] op_sel_hi:[1,0,1] neg_lo:[0,1,0]
    v_cvt_pk_bf16_f32 v244, v172, v173
    v_pk_mul_f32 v[194:195], v[172:173], v[186:187] op_sel:[0,0] op_sel_hi:[0,1]
    v_pk_fma_f32 v[174:175], v[172:173], v[186:187], v[194:195] op_sel:[1,1,0] op_sel_hi:[1,0,1] neg_lo:[0,1,0]
    v_cvt_pk_bf16_f32 v245, v174, v175
    v_pk_mul_f32 v[194:195], v[174:175], v[186:187] op_sel:[0,0] op_sel_hi:[0,1]
    v_pk_fma_f32 v[172:173], v[174:175], v[186:187], v[194:195] op_sel:[1,1,0] op_sel_hi:[1,0,1] neg_lo:[0,1,0]
    v_cvt_pk_bf16_f32 v246, v172, v173
    v_pk_mul_f32 v[194:195], v[172:173], v[186:187] op_sel:[0,0] op_sel_hi:[0,1]
    v_pk_fma_f32 v[174:175], v[172:173], v[186:187], v[194:195] op_sel:[1,1,0] op_sel_hi:[1,0,1] neg_lo:[0,1,0]
    v_cvt_pk_bf16_f32 v247, v174, v175
    v_pk_mul_f32 v[194:195], v[174:175], v[186:187] op_sel:[0,0] op_sel_hi:[0,1]
    v_pk_fma_f32 v[172:173], v[174:175], v[186:187], v[194:195] op_sel:[1,1,0] op_sel_hi:[1,0,1] neg_lo:[0,1,0]
    v_cvt_pk_bf16_f32 v248, v172, v173
    v_pk_mul_f32 v[194:195], v[172:173], v[186:187] op_sel:[0,0] op_sel_hi:[0,1]
    v_pk_fma_f32 v[174:175], v[172:173], v[186:187], v[194:195] op_sel:[1,1,0] op_sel_hi:[1,0,1] neg_lo:[0,1,0]
    v_cvt_pk_bf16_f32 v249, v174, v175
    v_pk_mul_f32 v[194:195], v[174:175], v[186:187] op_sel:[0,0] op_sel_hi:[0,1]
    v_pk_fma_f32 v[172:173], v[174:175], v[186:187], v[194:195] op_sel:[1,1,0] op_sel_hi:[1,0,1] neg_lo:[0,1,0]
    v_cvt_pk_bf16_f32 v250, v172, v173
    s_add_u32 s88, s88, 4096
    buffer_store_dwordx4 v[144:147], v148, s[16:19], s88 offen sc1
    v_pk_mul_f32 v[194:195], v[172:173], v[186:187] op_sel:[0,0] op_sel_hi:[0,1]
    v_pk_fma_f32 v[174:175], v[172:173], v[186:187], v[194:195] op_sel:[1,1,0] op_sel_hi:[1,0,1] neg_lo:[0,1,0]
    v_cvt_pk_bf16_f32 v251, v174, v175
    ds_write_addtid_b32 v242 offset:0
    ds_write_addtid_b32 v243 offset:272
    ds_write_addtid_b32 v244 offset:544
    ds_write_addtid_b32 v245 offset:816
    ds_write_addtid_b32 v246 offset:1088
    ds_write_addtid_b32 v247 offset:1360
    ds_write_addtid_b32 v248 offset:1632
    ds_write_addtid_b32 v249 offset:1904
    ds_write_addtid_b32 v250 offset:2176
    ds_write_addtid_b32 v251 offset:2448
    v_pk_mul_f32 v[194:195], v[174:175], v[186:187] op_sel:[0,0] op_sel_hi:[0,1]
    v_pk_fma_f32 v[172:173], v[174:175], v[186:187], v[194:195] op_sel:[1,1,0] op_sel_hi:[1,0,1] neg_lo:[0,1,0]
    v_cvt_pk_bf16_f32 v242, v172, v173
    v_pk_mul_f32 v[194:195], v[172:173], v[186:187] op_sel:[0,0] op_sel_hi:[0,1]
    v_pk_fma_f32 v[174:175], v[172:173], v[186:187], v[194:195] op_sel:[1,1,0] op_sel_hi:[1,0,1] neg_lo:[0,1,0]
    v_cvt_pk_bf16_f32 v243, v174, v175
    v_pk_mul_f32 v[194:195], v[174:175], v[186:187] op_sel:[0,0] op_sel_hi:[0,1]
    v_pk_fma_f32 v[172:173], v[174:175], v[186:187], v[194:195] op_sel:[1,1,0] op_sel_hi:[1,0,1] neg_lo:[0,1,0]
    v_cvt_pk_bf16_f32 v244, v172, v173
    v_pk_mul_f32 v[194:195], v[172:173], v[186:187] op_sel:[0,0] op_sel_hi:[0,1]
    v_pk_fma_f32 v[174:175], v[172:173], v[186:187], v[194:195] op_sel:[1,1,0] op_sel_hi:[1,0,1] neg_lo:[0,1,0]
    v_cvt_pk_bf16_f32 v245, v174, v175
    v_pk_mul_f32 v[194:195], v[174:175], v[186:187] op_sel:[0,0] op_sel_hi:[0,1]
    v_pk_fma_f32 v[172:173], v[174:175], v[186:187], v[194:195] op_sel:[1,1,0] op_sel_hi:[1,0,1] neg_lo:[0,1,0]
    v_cvt_pk_bf16_f32 v246, v172, v173
    v_pk_mul_f32 v[194:195], v[172:173], v[186:187] op_sel:[0,0] op_sel_hi:[0,1]
    v_pk_fma_f32 v[174:175], v[172:173], v[186:187], v[194:195] op_sel:[1,1,0] op_sel_hi:[1,0,1] neg_lo:[0,1,0]
    v_cvt_pk_bf16_f32 v247, v174, v175
    v_pk_mul_f32 v[194:195], v[174:175], v[186:187] op_sel:[0,0] op_sel_hi:[0,1]
    v_pk_fma_f32 v[172:173], v[174:175], v[186:187], v[194:195] op_sel:[1,1,0] op_sel_hi:[1,0,1] neg_lo:[0,1,0]
    v_cvt_pk_bf16_f32 v248, v172, v173
    v_pk_mul_f32 v[194:195], v[172:173], v[186:187] op_sel:[0,0] op_sel_hi:[0,1]
    s_add_u32 s88, s88, 4096
    buffer_store_dwordx4 v[144:147], v148, s[16:19], s88 offen sc1
    v_pk_fma_f32 v[174:175], v[172:173], v[186:187], v[194:195] op_sel:[1,1,0] op_sel_hi:[1,0,1] neg_lo:[0,1,0]
    v_cvt_pk_bf16_f32 v249, v174, v175
    v_pk_mul_f32 v[194:195], v[174:175], v[186:187] op_sel:[0,0] op_sel_hi:[0,1]
    v_pk_fma_f32 v[172:173], v[174:175], v[186:187], v[194:195] op_sel:[1,1,0] op_sel_hi:[1,0,1] neg_lo:[0,1,0]
    v_cvt_pk_bf16_f32 v250, v172, v173
    v_pk_mul_f32 v[194:195], v[172:173], v[186:187] op_sel:[0,0] op_sel_hi:[0,1]
    v_pk_fma_f32 v[174:175], v[172:173], v[186:187], v[194:195] op_sel:[1,1,0] op_sel_hi:[1,0,1] neg_lo:[0,1,0]
    v_cvt_pk_bf16_f32 v251, v174, v175
    ds_write_addtid_b32 v242 offset:2720
    ds_write_addtid_b32 v243 offset:2992
    ds_write_addtid_b32 v244 offset:3264
    ds_write_addtid_b32 v245 offset:3536
    ds_write_addtid_b32 v246 offset:3808
    ds_write_addtid_b32 v247 offset:4080
    ds_write_addtid_b32 v248 offset:4352
    ds_write_addtid_b32 v249 offset:4624
    ds_write_addtid_b32 v250 offset:4896
    ds_write_addtid_b32 v251 offset:5168
    v_pk_mul_f32 v[194:195], v[174:175], v[186:187] op_sel:[0,0] op_sel_hi:[0,1]
    v_pk_fma_f32 v[172:173], v[174:175], v[186:187], v[194:195] op_sel:[1,1,0] op_sel_hi:[1,0,1] neg_lo:[0,1,0]
    v_cvt_pk_bf16_f32 v242, v172, v173
    v_pk_mul_f32 v[194:195], v[172:173], v[186:187] op_sel:[0,0] op_sel_hi:[0,1]
    v_pk_fma_f32 v[174:175], v[172:173], v[186:187], v[194:195] op_sel:[1,1,0] op_sel_hi:[1,0,1] neg_lo:[0,1,0]
    v_cvt_pk_bf16_f32 v243, v174, v175
    v_pk_mul_f32 v[194:195], v[174:175], v[186:187] op_sel:[0,0] op_sel_hi:[0,1]
    v_pk_fma_f32 v[172:173], v[174:175], v[186:187], v[194:195] op_sel:[1,1,0] op_sel_hi:[1,0,1] neg_lo:[0,1,0]
    v_cvt_pk_bf16_f32 v244, v172, v173
    v_pk_mul_f32 v[194:195], v[172:173], v[186:187] op_sel:[0,0] op_sel_hi:[0,1]
    v_pk_fma_f32 v[174:175], v[172:173], v[186:187], v[194:195] op_sel:[1,1,0] op_sel_hi:[1,0,1] neg_lo:[0,1,0]
    v_cvt_pk_bf16_f32 v245, v174, v175
    v_pk_mul_f32 v[194:195], v[174:175], v[186:187] op_sel:[0,0] op_sel_hi:[0,1]
    v_pk_fma_f32 v[172:173], v[174:175], v[186:187], v[194:195] op_sel:[1,1,0] op_sel_hi:[1,0,1] neg_lo:[0,1,0]
    v_cvt_pk_bf16_f32 v246, v172, v173
    v_pk_mul_f32 v[194:195], v[172:173], v[186:187] op_sel:[0,0] op_sel_hi:[0,1]
    v_pk_fma_f32 v[174:175], v[172:173], v[186:187], v[194:195] op_sel:[1,1,0] op_sel_hi:[1,0,1] neg_lo:[0,1,0]
    v_mov_b32 v134, 0x3f803f80
    v_mov_b32 v132, 0
    v_mov_b32 v133, 0
    s_waitcnt vmcnt(10)
    v_dot2c_f32_bf16 v132, v120, v134
    v_dot2c_f32_bf16 v133, v120, v120
    v_dot2c_f32_bf16 v132, v121, v134
    v_dot2c_f32_bf16 v133, v121, v121
    v_dot2c_f32_bf16 v132, v122, v134
    v_dot2c_f32_bf16 v133, v122, v122
    v_dot2c_f32_bf16 v132, v123, v134
    v_dot2c_f32_bf16 v133, v123, v123
    s_waitcnt vmcnt(9)
    v_dot2c_f32_bf16 v132, v124, v134
    v_dot2c_f32_bf16 v133, v124, v124
    v_dot2c_f32_bf16 v132, v125, v134
    v_dot2c_f32_bf16 v133, v125, v125
    v_dot2c_f32_bf16 v132, v126, v134
    v_dot2c_f32_bf16 v133, v126, v126
    v_dot2c_f32_bf16 v132, v127, v134
    v_dot2c_f32_bf16 v133, v127, v127
    s_waitcnt vmcnt(8)
    v_dot2c_f32_bf16 v132, v128, v134
    v_dot2c_f32_bf16 v133, v128, v128
    v_dot2c_f32_bf16 v132, v129, v134
    v_dot2c_f32_bf16 v133, v129, v129
    v_dot2c_f32_bf16 v132, v130, v134
    v_dot2c_f32_bf16 v133, v130, v130
    v_dot2c_f32_bf16 v132, v131, v134
    v_dot2c_f32_bf16 v133, v131, v131
    v_lshrrev_b32 v135, 5, v0
    v_and_b32 v121, 3, v135
    v_lshrrev_b32 v135, 2, v135
    v_add_f32_dpp v132, v132, v132 row_shr:1 row_mask:0xf bank_mask:0xf bound_ctrl:0
    v_add_f32_dpp v133, v133, v133 row_shr:1 row_mask:0xf bank_mask:0xf bound_ctrl:0
    v_lshlrev_b32_e64 v135, 3, v135
    v_add_f32_dpp v132, v132, v132 row_shr:2 row_mask:0xf bank_mask:0xf bound_ctrl:0
    v_add_f32_dpp v133, v133, v133 row_shr:2 row_mask:0xf bank_mask:0xf bound_ctrl:0
    v_lshl_add_u32 v135, v121, 12, v135
    v_add_f32_dpp v132, v132, v132 row_shr:4 row_mask:0xf bank_mask:0xf bound_ctrl:0
    v_add_f32_dpp v133, v133, v133 row_shr:4 row_mask:0xf bank_mask:0xf bound_ctrl:0
    v_and_b32_e64 v121, 31, v0
    v_add_f32_dpp v132, v132, v132 row_shr:8 row_mask:0xf bank_mask:0xf bound_ctrl:0
    v_add_f32_dpp v133, v133, v133 row_shr:8 row_mask:0xf bank_mask:0xf bound_ctrl:0
    v_cmp_eq_u32_e64 vcc, 31, v121
    v_add_f32_dpp v132, v132, v132 row_bcast:15 row_mask:0xa bank_mask:0xf
    v_add_f32_dpp v133, v133, v133 row_bcast:15 row_mask:0xa bank_mask:0xf
    v_mov_b32 v121, 1073741824
    v_cndmask_b32_e64 v120, v121, v135, vcc
    s_lshl_b32 s96, s2, 4
    s_add_u32 s96, s96, 3440640
    v_mul_f32 v135, 0x3acccccd, v132
    v_mul_f32 v133, 0x3acccccd, v133
    v_fma_f32 v133, -v135, v135, v133
    v_max_f32 v133, 0, v133
    v_add_f32 v133, 0x3727c5ac, v133
    v_rsq_f32_e64 v132, v133
    s_nop 0
    v_mul_f32 v133, -v135, v132
    buffer_store_dwordx2 v[132:133], v120, s[16:19], s96 offen sc1
    v_cvt_pk_bf16_f32 v247, v174, v175
    v_pk_mul_f32 v[194:195], v[174:175], v[186:187] op_sel:[0,0] op_sel_hi:[0,1]
    v_pk_fma_f32 v[172:173], v[174:175], v[186:187], v[194:195] op_sel:[1,1,0] op_sel_hi:[1,0,1] neg_lo:[0,1,0]
    v_cvt_pk_bf16_f32 v248, v172, v173
    v_pk_mul_f32 v[194:195], v[172:173], v[186:187] op_sel:[0,0] op_sel_hi:[0,1]
    v_pk_fma_f32 v[174:175], v[172:173], v[186:187], v[194:195] op_sel:[1,1,0] op_sel_hi:[1,0,1] neg_lo:[0,1,0]
    v_cvt_pk_bf16_f32 v249, v174, v175
    v_pk_mul_f32 v[194:195], v[174:175], v[186:187] op_sel:[0,0] op_sel_hi:[0,1]
    v_pk_fma_f32 v[172:173], v[174:175], v[186:187], v[194:195] op_sel:[1,1,0] op_sel_hi:[1,0,1] neg_lo:[0,1,0]
    v_cvt_pk_bf16_f32 v250, v172, v173
    v_pk_mul_f32 v[194:195], v[172:173], v[186:187] op_sel:[0,0] op_sel_hi:[0,1]
    v_pk_fma_f32 v[174:175], v[172:173], v[186:187], v[194:195] op_sel:[1,1,0] op_sel_hi:[1,0,1] neg_lo:[0,1,0]
    v_cvt_pk_bf16_f32 v251, v174, v175
    ds_write_addtid_b32 v242 offset:5440
    ds_write_addtid_b32 v243 offset:5712
    ds_write_addtid_b32 v244 offset:5984
    ds_write_addtid_b32 v245 offset:6256
    ds_write_addtid_b32 v246 offset:6528
    ds_write_addtid_b32 v247 offset:6800
    ds_write_addtid_b32 v248 offset:7072
    ds_write_addtid_b32 v249 offset:7344
    ds_write_addtid_b32 v250 offset:7616
    ds_write_addtid_b32 v251 offset:7888
    v_pk_mul_f32 v[194:195], v[174:175], v[186:187] op_sel:[0,0] op_sel_hi:[0,1]
    v_pk_fma_f32 v[172:173], v[174:175], v[186:187], v[194:195] op_sel:[1,1,0] op_sel_hi:[1,0,1] neg_lo:[0,1,0]
    v_cvt_pk_bf16_f32 v242, v172, v173
    v_pk_mul_f32 v[194:195], v[172:173], v[186:187] op_sel:[0,0] op_sel_hi:[0,1]
    v_pk_fma_f32 v[174:175], v[172:173], v[186:187], v[194:195] op_sel:[1,1,0] op_sel_hi:[1,0,1] neg_lo:[0,1,0]
    v_cvt_pk_bf16_f32 v243, v174, v175
    ds_write_addtid_b32 v242 offset:8160
    ds_write_addtid_b32 v243 offset:8432
    ds_read_b128 a[160:163], v252 offset:0
    ds_read_b128 a[164:167], v252 offset:32
    ds_read_b128 a[168:171], v252 offset:64
    ds_read_b128 a[172:175], v252 offset:96
    ds_read_b128 a[176:179], v252 offset:128
    ds_read_b128 a[180:183], v252 offset:160
    ds_read_b128 a[184:187], v252 offset:192
    ds_read_b128 a[188:191], v252 offset:224
    v_pk_mul_f32 v[194:195], v[180:181], v[180:181] op_sel:[0,0] op_sel_hi:[0,1]
    v_pk_fma_f32 v[182:183], v[180:181], v[180:181], v[194:195] op_sel:[1,1,0] op_sel_hi:[1,0,1] neg_lo:[0,1,0]
    v_pk_mul_f32 v[194:195], v[182:183], v[182:183] op_sel:[0,0] op_sel_hi:[0,1]
    v_pk_fma_f32 v[184:185], v[182:183], v[182:183], v[194:195] op_sel:[1,1,0] op_sel_hi:[1,0,1] neg_lo:[0,1,0]
    v_cvt_pk_bf16_f32 v242, v192, -v193
    v_pk_mul_f32 v[194:195], v[192:193], v[180:181] op_sel:[0,0] op_sel_hi:[0,1]
    v_pk_fma_f32 v[174:175], v[192:193], v[180:181], v[194:195] op_sel:[1,1,0] op_sel_hi:[1,0,1] neg_lo:[0,1,0]
    v_cvt_pk_bf16_f32 v243, v174, -v175
    v_pk_mul_f32 v[194:195], v[174:175], v[180:181] op_sel:[0,0] op_sel_hi:[0,1]
    v_pk_fma_f32 v[172:173], v[174:175], v[180:181], v[194:195] op_sel:[1,1,0] op_sel_hi:[1,0,1] neg_lo:[0,1,0]
    v_cvt_pk_bf16_f32 v244, v172, -v173
    v_pk_mul_f32 v[194:195], v[172:173], v[180:181] op_sel:[0,0] op_sel_hi:[0,1]
    v_pk_fma_f32 v[174:175], v[172:173], v[180:181], v[194:195] op_sel:[1,1,0] op_sel_hi:[1,0,1] neg_lo:[0,1,0]
    v_cvt_pk_bf16_f32 v245, v174, -v175
    v_pk_mul_f32 v[194:195], v[174:175], v[180:181] op_sel:[0,0] op_sel_hi:[0,1]
    v_pk_fma_f32 v[172:173], v[174:175], v[180:181], v[194:195] op_sel:[1,1,0] op_sel_hi:[1,0,1] neg_lo:[0,1,0]
    v_cvt_pk_bf16_f32 v246, v172, -v173
    v_pk_mul_f32 v[194:195], v[172:173], v[180:181] op_sel:[0,0] op_sel_hi:[0,1]
    v_pk_fma_f32 v[174:175], v[172:173], v[180:181], v[194:195] op_sel:[1,1,0] op_sel_hi:[1,0,1] neg_lo:[0,1,0]
    v_cvt_pk_bf16_f32 v247, v174, -v175
    v_pk_mul_f32 v[194:195], v[174:175], v[180:181] op_sel:[0,0] op_sel_hi:[0,1]
    buffer_load_dword v7, v4, s[16:19], s87 offen offset:0 sc1
    v_pk_fma_f32 v[172:173], v[174:175], v[180:181], v[194:195] op_sel:[1,1,0] op_sel_hi:[1,0,1] neg_lo:[0,1,0]
    v_cvt_pk_bf16_f32 v248, v172, -v173
    v_pk_mul_f32 v[194:195], v[172:173], v[180:181] op_sel:[0,0] op_sel_hi:[0,1]
    v_pk_fma_f32 v[174:175], v[172:173], v[180:181], v[194:195] op_sel:[1,1,0] op_sel_hi:[1,0,1] neg_lo:[0,1,0]
    v_cvt_pk_bf16_f32 v249, v174, -v175
    v_pk_mul_f32 v[194:195], v[192:193], v[190:191] op_sel:[0,0] op_sel_hi:[0,1]
    v_pk_fma_f32 v[176:177], v[192:193], v[190:191], v[194:195] op_sel:[1,1,0] op_sel_hi:[1,0,1] neg_lo:[0,1,0]
    v_cvt_pk_bf16_f32 v250, v176, -v177
    v_pk_mul_f32 v[194:195], v[176:177], v[182:183] op_sel:[0,0] op_sel_hi:[0,1]
    v_pk_fma_f32 v[174:175], v[176:177], v[182:183], v[194:195] op_sel:[1,1,0] op_sel_hi:[1,0,1] neg_lo:[0,1,0]
    v_cvt_pk_bf16_f32 v251, v174, -v175
    ds_write_addtid_b32 v242 offset:0
    ds_write_addtid_b32 v243 offset:272
    ds_write_addtid_b32 v244 offset:544
    ds_write_addtid_b32 v245 offset:816
    ds_write_addtid_b32 v246 offset:1088
    ds_write_addtid_b32 v247 offset:1360
    ds_write_addtid_b32 v248 offset:1632
    ds_write_addtid_b32 v249 offset:1904
    ds_write_addtid_b32 v250 offset:2176
    ds_write_addtid_b32 v251 offset:2448
    v_pk_mul_f32 v[194:195], v[174:175], v[182:183] op_sel:[0,0] op_sel_hi:[0,1]
    v_pk_fma_f32 v[172:173], v[174:175], v[182:183], v[194:195] op_sel:[1,1,0] op_sel_hi:[1,0,1] neg_lo:[0,1,0]
    v_cvt_pk_bf16_f32 v242, v172, -v173
    v_pk_mul_f32 v[194:195], v[172:173], v[182:183] op_sel:[0,0] op_sel_hi:[0,1]
    v_pk_fma_f32 v[174:175], v[172:173], v[182:183], v[194:195] op_sel:[1,1,0] op_sel_hi:[1,0,1] neg_lo:[0,1,0]
    v_cvt_pk_bf16_f32 v243, v174, -v175
    v_pk_mul_f32 v[194:195], v[174:175], v[182:183] op_sel:[0,0] op_sel_hi:[0,1]
    v_pk_fma_f32 v[172:173], v[174:175], v[182:183], v[194:195] op_sel:[1,1,0] op_sel_hi:[1,0,1] neg_lo:[0,1,0]
    v_cvt_pk_bf16_f32 v244, v172, -v173
    v_pk_mul_f32 v[194:195], v[176:177], v[190:191] op_sel:[0,0] op_sel_hi:[0,1]
    v_pk_fma_f32 v[178:179], v[176:177], v[190:191], v[194:195] op_sel:[1,1,0] op_sel_hi:[1,0,1] neg_lo:[0,1,0]
    v_cvt_pk_bf16_f32 v245, v178, -v179
    v_pk_mul_f32 v[194:195], v[178:179], v[184:185] op_sel:[0,0] op_sel_hi:[0,1]
    v_pk_fma_f32 v[174:175], v[178:179], v[184:185], v[194:195] op_sel:[1,1,0] op_sel_hi:[1,0,1] neg_lo:[0,1,0]
    v_cvt_pk_bf16_f32 v246, v174, -v175
    v_pk_mul_f32 v[194:195], v[174:175], v[184:185] op_sel:[0,0] op_sel_hi:[0,1]
    v_pk_fma_f32 v[172:173], v[174:175], v[184:185], v[194:195] op_sel:[1,1,0] op_sel_hi:[1,0,1] neg_lo:[0,1,0]
    v_cvt_pk_bf16_f32 v247, v172, -v173
    v_pk_mul_f32 v[194:195], v[178:179], v[190:191] op_sel:[0,0] op_sel_hi:[0,1]
    v_pk_fma_f32 v[176:177], v[178:179], v[190:191], v[194:195] op_sel:[1,1,0] op_sel_hi:[1,0,1] neg_lo:[0,1,0]
    v_cvt_pk_bf16_f32 v248, v176, -v177
    v_pk_mul_f32 v[194:195], v[176:177], v[184:185] op_sel:[0,0] op_sel_hi:[0,1]
    v_pk_fma_f32 v[174:175], v[176:177], v[184:185], v[194:195] op_sel:[1,1,0] op_sel_hi:[1,0,1] neg_lo:[0,1,0]
    v_cvt_pk_bf16_f32 v249, v174, -v175
    v_pk_mul_f32 v[194:195], v[174:175], v[184:185] op_sel:[0,0] op_sel_hi:[0,1]
    v_pk_fma_f32 v[172:173], v[174:175], v[184:185], v[194:195] op_sel:[1,1,0] op_sel_hi:[1,0,1] neg_lo:[0,1,0]
    v_cvt_pk_bf16_f32 v250, v172, -v173
    v_pk_mul_f32 v[194:195], v[176:177], v[190:191] op_sel:[0,0] op_sel_hi:[0,1]
    v_pk_fma_f32 v[178:179], v[176:177], v[190:191], v[194:195] op_sel:[1,1,0] op_sel_hi:[1,0,1] neg_lo:[0,1,0]
    v_cvt_pk_bf16_f32 v251, v178, -v179
    ds_write_addtid_b32 v242 offset:2720
    ds_write_addtid_b32 v242 offset:3264
    ds_write_addtid_b32 v243 offset:3536
    ds_write_addtid_b32 v244 offset:3808
    ds_write_addtid_b32 v245 offset:4352
    ds_write_addtid_b32 v246 offset:4624
    ds_write_addtid_b32 v247 offset:4896
    ds_write_addtid_b32 v248 offset:5440
    ds_write_addtid_b32 v249 offset:5712
    ds_write_addtid_b32 v250 offset:5984
    ds_write_addtid_b32 v251 offset:6528
    v_pk_mul_f32 v[194:195], v[178:179], v[186:187] op_sel:[0,0] op_sel_hi:[0,1]
    v_pk_fma_f32 v[174:175], v[178:179], v[186:187], v[194:195] op_sel:[1,1,0] op_sel_hi:[1,0,1] neg_lo:[0,1,0]
    v_cvt_pk_bf16_f32 v242, v174, -v175
    v_pk_mul_f32 v[194:195], v[178:179], v[190:191] op_sel:[0,0] op_sel_hi:[0,1]
    v_pk_fma_f32 v[176:177], v[178:179], v[190:191], v[194:195] op_sel:[1,1,0] op_sel_hi:[1,0,1] neg_lo:[0,1,0]
    v_cvt_pk_bf16_f32 v243, v176, -v177
    v_pk_mul_f32 v[194:195], v[176:177], v[186:187] op_sel:[0,0] op_sel_hi:[0,1]
    v_pk_fma_f32 v[174:175], v[176:177], v[186:187], v[194:195] op_sel:[1,1,0] op_sel_hi:[1,0,1] neg_lo:[0,1,0]
    v_cvt_pk_bf16_f32 v244, v174, -v175
    v_pk_mul_f32 v[194:195], v[176:177], v[190:191] op_sel:[0,0] op_sel_hi:[0,1]
    v_pk_fma_f32 v[178:179], v[176:177], v[190:191], v[194:195] op_sel:[1,1,0] op_sel_hi:[1,0,1] neg_lo:[0,1,0]
    v_cvt_pk_bf16_f32 v245, v178, -v179
    v_pk_mul_f32 v[194:195], v[178:179], v[186:187] op_sel:[0,0] op_sel_hi:[0,1]
    v_pk_fma_f32 v[174:175], v[178:179], v[186:187], v[194:195] op_sel:[1,1,0] op_sel_hi:[1,0,1] neg_lo:[0,1,0]
    v_cvt_pk_bf16_f32 v246, v174, -v175
    v_pk_mul_f32 v[194:195], v[178:179], v[190:191] op_sel:[0,0] op_sel_hi:[0,1]
    v_pk_fma_f32 v[176:177], v[178:179], v[190:191], v[194:195] op_sel:[1,1,0] op_sel_hi:[1,0,1] neg_lo:[0,1,0]
    v_cvt_pk_bf16_f32 v247, v176, -v177
    v_pk_mul_f32 v[194:195], v[176:177], v[186:187] op_sel:[0,0] op_sel_hi:[0,1]
    v_pk_fma_f32 v[174:175], v[176:177], v[186:187], v[194:195] op_sel:[1,1,0] op_sel_hi:[1,0,1] neg_lo:[0,1,0]
    v_cvt_pk_bf16_f32 v248, v174, -v175
    ds_write_addtid_b32 v242 offset:6800
    ds_write_addtid_b32 v243 offset:7072
    ds_write_addtid_b32 v244 offset:7344
    ds_write_addtid_b32 v245 offset:7616
    ds_write_addtid_b32 v246 offset:7888
    ds_write_addtid_b32 v247 offset:8160
    ds_write_addtid_b32 v248 offset:8432
    ds_read_b128 a[192:195], v252 offset:0
    ds_read_b128 a[196:199], v252 offset:32
    ds_read_b128 a[200:203], v252 offset:64
    ds_read_b128 a[204:207], v252 offset:96
    ds_read_b128 a[208:211], v252 offset:128
    ds_read_b128 a[212:215], v252 offset:160
    ds_read_b128 a[216:219], v252 offset:192
    ds_read_b128 a[220:223], v252 offset:224
    s_add_u32 m0, s92, 36352
    s_nop 0
    buffer_load_dwordx4 v73, s[4:7], s99 offen offset:0  lds
    v_lshlrev_b32 v199, 16, v236
    v_mul_f32 v199, 0x3fb8aa3b, v199
    v_exp_f32 v199, v199
    v_lshlrev_b32 v255, 16, v237
    v_mul_f32 v255, v255, v253
    v_mul_f32 v255, 0x3e22f983, v255
    v_cvt_pk_bf16_f32 v199, v199, v199
    v_lshlrev_b32 v199, 16, v199
    v_mul_f32 v254, v199, v253
    v_mul_f32 v254, 0xbfb8aa3b, v254
    s_waitcnt lgkmcnt(7)
    v_mfma_f32_32x32x16_bf16 v[216:231], a[192:195], a[160:163], v[216:231]
    s_add_u32 m0, s92, 36352
    s_nop 0
    buffer_load_dwordx4 v74, s[4:7], s99 offen offset:1088  lds
    v_mul_f32 v182, 0x41000000, v254
    v_mul_f32 v185, 0x41000000, v255
    v_mul_f32 v184, 0x43800000, v254
    v_mul_f32 v189, 0x43800000, v255
    s_waitcnt lgkmcnt(6)
    v_mfma_f32_32x32x16_bf16 v[216:231], a[196:199], a[164:167], v[216:231]
    s_add_u32 m0, s92, 36352
    s_nop 0
    buffer_load_dwordx4 v75, s[4:7], s99 offen offset:2176  lds
    v_fract_f32 v185, v185
    v_fract_f32 v188, v255
    v_fract_f32 v189, v189
    v_exp_f32_e64 v182, v182
    s_waitcnt lgkmcnt(5)
    v_mfma_f32_32x32x16_bf16 v[216:231], a[200:203], a[168:171], v[216:231]
    s_add_u32 m0, s92, 36352
    s_nop 0
    buffer_load_dwordx4 v76, s[4:7], s99 offen offset:3264  lds
    v_exp_f32 v183, v254
    v_exp_f32 v184, v184
    v_cos_f32 v186, v185
    v_sin_f32 v187, v185
    s_waitcnt lgkmcnt(4)
    v_mfma_f32_32x32x16_bf16 v[216:231], a[204:207], a[172:175], v[216:231]
    s_add_u32 m0, s93, 53760
    s_add_u32 s99, s99, 256
    s_mov_b64 exec, s[80:81]
    buffer_load_dwordx4 v77, s[4:7], s100 offen  lds
    s_mov_b64 exec, -1
    s_add_u32 s100, s100, 256
    v_cos_f32 v180, v188
    v_sin_f32 v181, v188
    v_cos_f32 v190, v189
    v_sin_f32_e64 v191, v189
    s_waitcnt lgkmcnt(3)
    v_mfma_f32_32x32x16_bf16 v[216:231], a[208:211], a[176:179], v[216:231]
    s_add_u32 m0, s92, 55936
    s_nop 0
    buffer_load_dwordx4 v73, s[4:7], s99 offen offset:0  lds
    v_lshlrev_b32 v192, 16, v238
    v_lshlrev_b32 v193, 16, v239
    v_add_f32 v199, v253, v253
    v_mul_f32 v192, v192, v199
    s_waitcnt lgkmcnt(2)
    v_mfma_f32_32x32x16_bf16 v[216:231], a[212:215], a[180:183], v[216:231]
    s_add_u32 m0, s92, 55936
    s_nop 0
    buffer_load_dwordx4 v74, s[4:7], s99 offen offset:1088  lds
    v_mul_f32 v193, v193, v199
    v_mul_f32 v186, v186, v182
    v_mul_f32 v187, v187, v182
    v_mul_f32 v180, v180, v183
    s_waitcnt lgkmcnt(1)
    v_mfma_f32_32x32x16_bf16 v[216:231], a[216:219], a[184:187], v[216:231]
    s_add_u32 m0, s92, 55936
    s_nop 0
    buffer_load_dwordx4 v75, s[4:7], s99 offen offset:2176  lds
    v_mul_f32 v181, v181, v183
    v_mul_f32 v190, v190, v184
    v_mul_f32_e64 v191, v191, v184
    s_waitcnt lgkmcnt(0)
    v_mfma_f32_32x32x16_bf16 v[216:231], a[220:223], a[188:191], v[216:231]
    s_add_u32 m0, s92, 55936
    s_nop 0
    buffer_load_dwordx4 v76, s[4:7], s99 offen offset:3264  lds
    s_add_u32 m0, s93, 73344
    s_add_u32 s99, s99, 256
    s_mov_b64 exec, s[80:81]
    buffer_load_dwordx4 v77, s[4:7], s100 offen  lds
    s_mov_b64 exec, -1
    s_add_u32 s100, s100, 256
    s_add_u32 m0, s92, 75520
    s_nop 0
    buffer_load_dwordx4 v73, s[4:7], s99 offen offset:0  lds
    s_add_u32 m0, s92, 75520
    s_nop 0
    buffer_load_dwordx4 v74, s[4:7], s99 offen offset:1088  lds
    s_mov_b32 m0, s37
    v_mov_b32 v242, 0x3f80
    v_cvt_pk_bf16_f32 v243, v186, v187
    v_pk_mul_f32 v[194:195], v[186:187], v[186:187] op_sel:[0,0] op_sel_hi:[0,1]
    v_pk_fma_f32 v[172:173], v[186:187], v[186:187], v[194:195] op_sel:[1,1,0] op_sel_hi:[1,0,1] neg_lo:[0,1,0]
    v_cvt_pk_bf16_f32 v244, v172, v173
    v_pk_mul_f32 v[194:195], v[172:173], v[186:187] op_sel:[0,0] op_sel_hi:[0,1]
    v_pk_fma_f32 v[174:175], v[172:173], v[186:187], v[194:195] op_sel:[1,1,0] op_sel_hi:[1,0,1] neg_lo:[0,1,0]
    v_cvt_pk_bf16_f32 v245, v174, v175
    v_pk_mul_f32 v[194:195], v[174:175], v[186:187] op_sel:[0,0] op_sel_hi:[0,1]
    v_pk_fma_f32 v[172:173], v[174:175], v[186:187], v[194:195] op_sel:[1,1,0] op_sel_hi:[1,0,1] neg_lo:[0,1,0]
    v_cvt_pk_bf16_f32 v246, v172, v173
    v_pk_mul_f32 v[194:195], v[172:173], v[186:187] op_sel:[0,0] op_sel_hi:[0,1]
    v_pk_fma_f32 v[174:175], v[172:173], v[186:187], v[194:195] op_sel:[1,1,0] op_sel_hi:[1,0,1] neg_lo:[0,1,0]
    v_cvt_pk_bf16_f32 v247, v174, v175
    v_pk_mul_f32 v[194:195], v[174:175], v[186:187] op_sel:[0,0] op_sel_hi:[0,1]
    v_pk_fma_f32 v[172:173], v[174:175], v[186:187], v[194:195] op_sel:[1,1,0] op_sel_hi:[1,0,1] neg_lo:[0,1,0]
    v_cvt_pk_bf16_f32 v248, v172, v173
    v_pk_mul_f32 v[194:195], v[172:173], v[186:187] op_sel:[0,0] op_sel_hi:[0,1]
    v_pk_fma_f32 v[174:175], v[172:173], v[186:187], v[194:195] op_sel:[1,1,0] op_sel_hi:[1,0,1] neg_lo:[0,1,0]
    v_cvt_pk_bf16_f32 v249, v174, v175
    v_pk_mul_f32 v[194:195], v[174:175], v[186:187] op_sel:[0,0] op_sel_hi:[0,1]
    v_pk_fma_f32 v[172:173], v[174:175], v[186:187], v[194:195] op_sel:[1,1,0] op_sel_hi:[1,0,1] neg_lo:[0,1,0]
    v_cvt_pk_bf16_f32 v250, v172, v173
    v_pk_mul_f32 v[194:195], v[172:173], v[186:187] op_sel:[0,0] op_sel_hi:[0,1]
    s_waitcnt vmcnt(12)
    v_cmp_gt_u32 vcc, 32, v7
    s_nop 0
    s_and_b64 vcc, vcc, s[50:51]
    s_cbranch_scc1 ps_8
pc_10:
    s_barrier
    v_pk_fma_f32 v[174:175], v[172:173], v[186:187], v[194:195] op_sel:[1,1,0] op_sel_hi:[1,0,1] neg_lo:[0,1,0]
    v_cvt_pk_bf16_f32 v251, v174, v175
    ds_write_addtid_b32 v242 offset:0
    ds_write_addtid_b32 v243 offset:272
    ds_write_addtid_b32 v244 offset:544
    ds_write_addtid_b32 v245 offset:816
    ds_write_addtid_b32 v246 offset:1088
    ds_write_addtid_b32 v247 offset:1360
    ds_write_addtid_b32 v248 offset:1632
    ds_write_addtid_b32 v249 offset:1904
    ds_write_addtid_b32 v250 offset:2176
    ds_write_addtid_b32 v251 offset:2448
    v_pk_mul_f32 v[194:195], v[174:175], v[186:187] op_sel:[0,0] op_sel_hi:[0,1]
    v_pk_fma_f32 v[172:173], v[174:175], v[186:187], v[194:195] op_sel:[1,1,0] op_sel_hi:[1,0,1] neg_lo:[0,1,0]
    v_cvt_pk_bf16_f32 v242, v172, v173
    v_pk_mul_f32 v[194:195], v[172:173], v[186:187] op_sel:[0,0] op_sel_hi:[0,1]
    v_pk_fma_f32 v[174:175], v[172:173], v[186:187], v[194:195] op_sel:[1,1,0] op_sel_hi:[1,0,1] neg_lo:[0,1,0]
    v_cvt_pk_bf16_f32 v243, v174, v175
    buffer_load_dwordx4 a[0:3], v200, s[16:19], s101 offen offset:0 sc1
    v_pk_mul_f32 v[194:195], v[174:175], v[186:187] op_sel:[0,0] op_sel_hi:[0,1]
    v_pk_fma_f32 v[172:173], v[174:175], v[186:187], v[194:195] op_sel:[1,1,0] op_sel_hi:[1,0,1] neg_lo:[0,1,0]
    v_cvt_pk_bf16_f32 v244, v172, v173
    v_pk_mul_f32 v[194:195], v[172:173], v[186:187] op_sel:[0,0] op_sel_hi:[0,1]
    v_pk_fma_f32 v[174:175], v[172:173], v[186:187], v[194:195] op_sel:[1,1,0] op_sel_hi:[1,0,1] neg_lo:[0,1,0]
    v_cvt_pk_bf16_f32 v245, v174, v175
    v_pk_mul_f32 v[194:195], v[174:175], v[186:187] op_sel:[0,0] op_sel_hi:[0,1]
    v_pk_fma_f32 v[172:173], v[174:175], v[186:187], v[194:195] op_sel:[1,1,0] op_sel_hi:[1,0,1] neg_lo:[0,1,0]
    v_cvt_pk_bf16_f32 v246, v172, v173
    v_pk_mul_f32 v[194:195], v[172:173], v[186:187] op_sel:[0,0] op_sel_hi:[0,1]
    v_pk_fma_f32 v[174:175], v[172:173], v[186:187], v[194:195] op_sel:[1,1,0] op_sel_hi:[1,0,1] neg_lo:[0,1,0]
    v_cvt_pk_bf16_f32 v247, v174, v175
    v_pk_mul_f32 v[194:195], v[174:175], v[186:187] op_sel:[0,0] op_sel_hi:[0,1]
    v_pk_fma_f32 v[172:173], v[174:175], v[186:187], v[194:195] op_sel:[1,1,0] op_sel_hi:[1,0,1] neg_lo:[0,1,0]
    v_cvt_pk_bf16_f32 v248, v172, v173
    v_pk_mul_f32 v[194:195], v[172:173], v[186:187] op_sel:[0,0] op_sel_hi:[0,1]
    v_pk_fma_f32 v[174:175], v[172:173], v[186:187], v[194:195] op_sel:[1,1,0] op_sel_hi:[1,0,1] neg_lo:[0,1,0]
    v_cvt_pk_bf16_f32 v249, v174, v175
    buffer_load_dwordx4 a[4:7], v200, s[16:19], s101 offen offset:1024 sc1
    v_pk_mul_f32 v[194:195], v[174:175], v[186:187] op_sel:[0,0] op_sel_hi:[0,1]
    v_pk_fma_f32 v[172:173], v[174:175], v[186:187], v[194:195] op_sel:[1,1,0] op_sel_hi:[1,0,1] neg_lo:[0,1,0]
    v_cvt_pk_bf16_f32 v250, v172, v173
    v_pk_mul_f32 v[194:195], v[172:173], v[186:187] op_sel:[0,0] op_sel_hi:[0,1]
    v_pk_fma_f32 v[174:175], v[172:173], v[186:187], v[194:195] op_sel:[1,1,0] op_sel_hi:[1,0,1] neg_lo:[0,1,0]
    v_cvt_pk_bf16_f32 v251, v174, v175
    ds_write_addtid_b32 v242 offset:2720
    ds_write_addtid_b32 v243 offset:2992
    ds_write_addtid_b32 v244 offset:3264
    ds_write_addtid_b32 v245 offset:3536
    ds_write_addtid_b32 v246 offset:3808
    ds_write_addtid_b32 v247 offset:4080
    ds_write_addtid_b32 v248 offset:4352
    ds_write_addtid_b32 v249 offset:4624
    ds_write_addtid_b32 v250 offset:4896
    ds_write_addtid_b32 v251 offset:5168
    v_pk_mul_f32 v[194:195], v[174:175], v[186:187] op_sel:[0,0] op_sel_hi:[0,1]
    v_pk_fma_f32 v[172:173], v[174:175], v[186:187], v[194:195] op_sel:[1,1,0] op_sel_hi:[1,0,1] neg_lo:[0,1,0]
    buffer_load_dwordx4 a[8:11], v200, s[16:19], s101 offen offset:2048 sc1
    v_cvt_pk_bf16_f32 v242, v172, v173
    v_pk_mul_f32 v[194:195], v[172:173], v[186:187] op_sel:[0,0] op_sel_hi:[0,1]
    v_pk_fma_f32 v[174:175], v[172:173], v[186:187], v[194:195] op_sel:[1,1,0] op_sel_hi:[1,0,1] neg_lo:[0,1,0]
    v_cvt_pk_bf16_f32 v243, v174, v175
    v_pk_mul_f32 v[194:195], v[174:175], v[186:187] op_sel:[0,0] op_sel_hi:[0,1]
    v_pk_fma_f32 v[172:173], v[174:175], v[186:187], v[194:195] op_sel:[1,1,0] op_sel_hi:[1,0,1] neg_lo:[0,1,0]
    v_cvt_pk_bf16_f32 v244, v172, v173
    v_pk_mul_f32 v[194:195], v[172:173], v[186:187] op_sel:[0,0] op_sel_hi:[0,1]
    v_pk_fma_f32 v[174:175], v[172:173], v[186:187], v[194:195] op_sel:[1,1,0] op_sel_hi:[1,0,1] neg_lo:[0,1,0]
    v_cvt_pk_bf16_f32 v245, v174, v175
    v_pk_mul_f32 v[194:195], v[174:175], v[186:187] op_sel:[0,0] op_sel_hi:[0,1]
    v_pk_fma_f32 v[172:173], v[174:175], v[186:187], v[194:195] op_sel:[1,1,0] op_sel_hi:[1,0,1] neg_lo:[0,1,0]
    v_cvt_pk_bf16_f32 v246, v172, v173
    v_pk_mul_f32 v[194:195], v[172:173], v[186:187] op_sel:[0,0] op_sel_hi:[0,1]
    v_pk_fma_f32 v[174:175], v[172:173], v[186:187], v[194:195] op_sel:[1,1,0] op_sel_hi:[1,0,1] neg_lo:[0,1,0]
    v_cvt_pk_bf16_f32 v247, v174, v175
    v_pk_mul_f32 v[194:195], v[174:175], v[186:187] op_sel:[0,0] op_sel_hi:[0,1]
    v_pk_fma_f32 v[172:173], v[174:175], v[186:187], v[194:195] op_sel:[1,1,0] op_sel_hi:[1,0,1] neg_lo:[0,1,0]
    buffer_load_dwordx4 a[12:15], v200, s[16:19], s101 offen offset:3072 sc1
    v_cvt_pk_bf16_f32 v248, v172, v173
    v_pk_mul_f32 v[194:195], v[172:173], v[186:187] op_sel:[0,0] op_sel_hi:[0,1]
    v_pk_fma_f32 v[174:175], v[172:173], v[186:187], v[194:195] op_sel:[1,1,0] op_sel_hi:[1,0,1] neg_lo:[0,1,0]
    v_cvt_pk_bf16_f32 v249, v174, v175
    v_pk_mul_f32 v[194:195], v[174:175], v[186:187] op_sel:[0,0] op_sel_hi:[0,1]
    v_pk_fma_f32 v[172:173], v[174:175], v[186:187], v[194:195] op_sel:[1,1,0] op_sel_hi:[1,0,1] neg_lo:[0,1,0]
    v_cvt_pk_bf16_f32 v250, v172, v173
    v_pk_mul_f32 v[194:195], v[172:173], v[186:187] op_sel:[0,0] op_sel_hi:[0,1]
    v_pk_fma_f32 v[174:175], v[172:173], v[186:187], v[194:195] op_sel:[1,1,0] op_sel_hi:[1,0,1] neg_lo:[0,1,0]
    v_cvt_pk_bf16_f32 v251, v174, v175
    ds_write_addtid_b32 v242 offset:5440
    ds_write_addtid_b32 v243 offset:5712
    ds_write_addtid_b32 v244 offset:5984
    ds_write_addtid_b32 v245 offset:6256
    ds_write_addtid_b32 v246 offset:6528
    ds_write_addtid_b32 v247 offset:6800
    ds_write_addtid_b32 v248 offset:7072
    ds_write_addtid_b32 v249 offset:7344
    s_add_u32 s101, s101, 4096
    buffer_load_dwordx4 a[16:19], v200, s[16:19], s101 offen offset:0 sc1
    ds_write_addtid_b32 v250 offset:7616
    ds_write_addtid_b32 v251 offset:7888
    v_pk_mul_f32 v[194:195], v[174:175], v[186:187] op_sel:[0,0] op_sel_hi:[0,1]
    v_pk_fma_f32 v[172:173], v[174:175], v[186:187], v[194:195] op_sel:[1,1,0] op_sel_hi:[1,0,1] neg_lo:[0,1,0]
    v_cvt_pk_bf16_f32 v242, v172, v173
    v_pk_mul_f32 v[194:195], v[172:173], v[186:187] op_sel:[0,0] op_sel_hi:[0,1]
    v_pk_fma_f32 v[174:175], v[172:173], v[186:187], v[194:195] op_sel:[1,1,0] op_sel_hi:[1,0,1] neg_lo:[0,1,0]
    v_cvt_pk_bf16_f32 v243, v174, v175
    ds_write_addtid_b32 v242 offset:8160
    ds_write_addtid_b32 v243 offset:8432
    ds_read_b128 a[160:163], v252 offset:0
    ds_read_b128 a[164:167], v252 offset:32
    ds_read_b128 a[168:171], v252 offset:64
    ds_read_b128 a[172:175], v252 offset:96
    ds_read_b128 a[176:179], v252 offset:128
    ds_read_b128 a[180:183], v252 offset:160
    ds_read_b128 a[184:187], v252 offset:192
    ds_read_b128 a[188:191], v252 offset:224
    buffer_load_dwordx4 a[20:23], v200, s[16:19], s101 offen offset:1024 sc1
    v_pk_mul_f32 v[194:195], v[180:181], v[180:181] op_sel:[0,0] op_sel_hi:[0,1]
    v_pk_fma_f32 v[182:183], v[180:181], v[180:181], v[194:195] op_sel:[1,1,0] op_sel_hi:[1,0,1] neg_lo:[0,1,0]
    v_pk_mul_f32 v[194:195], v[182:183], v[182:183] op_sel:[0,0] op_sel_hi:[0,1]
    v_pk_fma_f32 v[184:185], v[182:183], v[182:183], v[194:195] op_sel:[1,1,0] op_sel_hi:[1,0,1] neg_lo:[0,1,0]
    v_cvt_pk_bf16_f32 v242, v192, -v193
    v_pk_mul_f32 v[194:195], v[192:193], v[180:181] op_sel:[0,0] op_sel_hi:[0,1]
    v_pk_fma_f32 v[174:175], v[192:193], v[180:181], v[194:195] op_sel:[1,1,0] op_sel_hi:[1,0,1] neg_lo:[0,1,0]
    v_cvt_pk_bf16_f32 v243, v174, -v175
    v_pk_mul_f32 v[194:195], v[174:175], v[180:181] op_sel:[0,0] op_sel_hi:[0,1]
    v_pk_fma_f32 v[172:173], v[174:175], v[180:181], v[194:195] op_sel:[1,1,0] op_sel_hi:[1,0,1] neg_lo:[0,1,0]
    v_cvt_pk_bf16_f32 v244, v172, -v173
    v_pk_mul_f32 v[194:195], v[172:173], v[180:181] op_sel:[0,0] op_sel_hi:[0,1]
    v_pk_fma_f32 v[174:175], v[172:173], v[180:181], v[194:195] op_sel:[1,1,0] op_sel_hi:[1,0,1] neg_lo:[0,1,0]
    v_cvt_pk_bf16_f32 v245, v174, -v175
    v_pk_mul_f32 v[194:195], v[174:175], v[180:181] op_sel:[0,0] op_sel_hi:[0,1]
    v_pk_fma_f32 v[172:173], v[174:175], v[180:181], v[194:195] op_sel:[1,1,0] op_sel_hi:[1,0,1] neg_lo:[0,1,0]
    v_cvt_pk_bf16_f32 v246, v172, -v173
    v_pk_mul_f32 v[194:195], v[172:173], v[180:181] op_sel:[0,0] op_sel_hi:[0,1]
    buffer_load_dwordx4 a[24:27], v200, s[16:19], s101 offen offset:2048 sc1
    v_pk_fma_f32 v[174:175], v[172:173], v[180:181], v[194:195] op_sel:[1,1,0] op_sel_hi:[1,0,1] neg_lo:[0,1,0]
    v_cvt_pk_bf16_f32 v247, v174, -v175
    v_pk_mul_f32 v[194:195], v[174:175], v[180:181] op_sel:[0,0] op_sel_hi:[0,1]
    v_pk_fma_f32 v[172:173], v[174:175], v[180:181], v[194:195] op_sel:[1,1,0] op_sel_hi:[1,0,1] neg_lo:[0,1,0]
    v_cvt_pk_bf16_f32 v248, v172, -v173
    v_pk_mul_f32 v[194:195], v[172:173], v[180:181] op_sel:[0,0] op_sel_hi:[0,1]
    v_pk_fma_f32 v[174:175], v[172:173], v[180:181], v[194:195] op_sel:[1,1,0] op_sel_hi:[1,0,1] neg_lo:[0,1,0]
    v_cvt_pk_bf16_f32 v249, v174, -v175
    v_pk_mul_f32 v[194:195], v[192:193], v[190:191] op_sel:[0,0] op_sel_hi:[0,1]
    v_pk_fma_f32 v[176:177], v[192:193], v[190:191], v[194:195] op_sel:[1,1,0] op_sel_hi:[1,0,1] neg_lo:[0,1,0]
    v_cvt_pk_bf16_f32 v250, v176, -v177
    v_pk_mul_f32 v[194:195], v[176:177], v[182:183] op_sel:[0,0] op_sel_hi:[0,1]
    v_pk_fma_f32 v[174:175], v[176:177], v[182:183], v[194:195] op_sel:[1,1,0] op_sel_hi:[1,0,1] neg_lo:[0,1,0]
    v_cvt_pk_bf16_f32 v251, v174, -v175
    ds_write_addtid_b32 v242 offset:0
    ds_write_addtid_b32 v243 offset:272
    ds_write_addtid_b32 v244 offset:544
    ds_write_addtid_b32 v245 offset:816
    buffer_load_dwordx4 a[28:31], v200, s[16:19], s101 offen offset:3072 sc1
    ds_write_addtid_b32 v246 offset:1088
    ds_write_addtid_b32 v247 offset:1360
    ds_write_addtid_b32 v248 offset:1632
    ds_write_addtid_b32 v249 offset:1904
    ds_write_addtid_b32 v250 offset:2176
    ds_write_addtid_b32 v251 offset:2448
    v_pk_mul_f32 v[194:195], v[174:175], v[182:183] op_sel:[0,0] op_sel_hi:[0,1]
    v_pk_fma_f32 v[172:173], v[174:175], v[182:183], v[194:195] op_sel:[1,1,0] op_sel_hi:[1,0,1] neg_lo:[0,1,0]
    v_cvt_pk_bf16_f32 v242, v172, -v173
    v_pk_mul_f32 v[194:195], v[172:173], v[182:183] op_sel:[0,0] op_sel_hi:[0,1]
    v_pk_fma_f32 v[174:175], v[172:173], v[182:183], v[194:195] op_sel:[1,1,0] op_sel_hi:[1,0,1] neg_lo:[0,1,0]
    v_cvt_pk_bf16_f32 v243, v174, -v175
    v_pk_mul_f32 v[194:195], v[174:175], v[182:183] op_sel:[0,0] op_sel_hi:[0,1]
    v_pk_fma_f32 v[172:173], v[174:175], v[182:183], v[194:195] op_sel:[1,1,0] op_sel_hi:[1,0,1] neg_lo:[0,1,0]
    v_cvt_pk_bf16_f32 v244, v172, -v173
    v_pk_mul_f32 v[194:195], v[176:177], v[190:191] op_sel:[0,0] op_sel_hi:[0,1]
    v_pk_fma_f32 v[178:179], v[176:177], v[190:191], v[194:195] op_sel:[1,1,0] op_sel_hi:[1,0,1] neg_lo:[0,1,0]
    v_cvt_pk_bf16_f32 v245, v178, -v179
    s_add_u32 s101, s101, 4096
    buffer_load_dwordx4 a[32:35], v200, s[16:19], s101 offen offset:0 sc1
    v_pk_mul_f32 v[194:195], v[178:179], v[184:185] op_sel:[0,0] op_sel_hi:[0,1]
    v_pk_fma_f32 v[174:175], v[178:179], v[184:185], v[194:195] op_sel:[1,1,0] op_sel_hi:[1,0,1] neg_lo:[0,1,0]
    v_cvt_pk_bf16_f32 v246, v174, -v175
    v_pk_mul_f32 v[194:195], v[174:175], v[184:185] op_sel:[0,0] op_sel_hi:[0,1]
    v_pk_fma_f32 v[172:173], v[174:175], v[184:185], v[194:195] op_sel:[1,1,0] op_sel_hi:[1,0,1] neg_lo:[0,1,0]
    v_cvt_pk_bf16_f32 v247, v172, -v173
    v_pk_mul_f32 v[194:195], v[178:179], v[190:191] op_sel:[0,0] op_sel_hi:[0,1]
    v_pk_fma_f32 v[176:177], v[178:179], v[190:191], v[194:195] op_sel:[1,1,0] op_sel_hi:[1,0,1] neg_lo:[0,1,0]
    v_cvt_pk_bf16_f32 v248, v176, -v177
    v_pk_mul_f32 v[194:195], v[176:177], v[184:185] op_sel:[0,0] op_sel_hi:[0,1]
    v_pk_fma_f32 v[174:175], v[176:177], v[184:185], v[194:195] op_sel:[1,1,0] op_sel_hi:[1,0,1] neg_lo:[0,1,0]
    v_cvt_pk_bf16_f32 v249, v174, -v175
    v_pk_mul_f32 v[194:195], v[174:175], v[184:185] op_sel:[0,0] op_sel_hi:[0,1]
    v_pk_fma_f32 v[172:173], v[174:175], v[184:185], v[194:195] op_sel:[1,1,0] op_sel_hi:[1,0,1] neg_lo:[0,1,0]
    v_cvt_pk_bf16_f32 v250, v172, -v173
    v_pk_mul_f32 v[194:195], v[176:177], v[190:191] op_sel:[0,0] op_sel_hi:[0,1]
    v_pk_fma_f32 v[178:179], v[176:177], v[190:191], v[194:195] op_sel:[1,1,0] op_sel_hi:[1,0,1] neg_lo:[0,1,0]
    v_cvt_pk_bf16_f32 v251, v178, -v179
    buffer_load_dwordx4 a[36:39], v200, s[16:19], s101 offen offset:1024 sc1
    ds_write_addtid_b32 v242 offset:2720
    ds_write_addtid_b32 v242 offset:3264
    ds_write_addtid_b32 v243 offset:3536
    ds_write_addtid_b32 v244 offset:3808
    ds_write_addtid_b32 v245 offset:4352
    ds_write_addtid_b32 v246 offset:4624
    ds_write_addtid_b32 v247 offset:4896
    ds_write_addtid_b32 v248 offset:5440
    ds_write_addtid_b32 v249 offset:5712
    ds_write_addtid_b32 v250 offset:5984
    ds_write_addtid_b32 v251 offset:6528
    v_pk_mul_f32 v[194:195], v[178:179], v[186:187] op_sel:[0,0] op_sel_hi:[0,1]
    v_pk_fma_f32 v[174:175], v[178:179], v[186:187], v[194:195] op_sel:[1,1,0] op_sel_hi:[1,0,1] neg_lo:[0,1,0]
    v_cvt_pk_bf16_f32 v242, v174, -v175
    v_pk_mul_f32 v[194:195], v[178:179], v[190:191] op_sel:[0,0] op_sel_hi:[0,1]
    v_pk_fma_f32 v[176:177], v[178:179], v[190:191], v[194:195] op_sel:[1,1,0] op_sel_hi:[1,0,1] neg_lo:[0,1,0]
    v_cvt_pk_bf16_f32 v243, v176, -v177
    v_pk_mul_f32 v[194:195], v[176:177], v[186:187] op_sel:[0,0] op_sel_hi:[0,1]
    buffer_load_dwordx4 a[40:43], v200, s[16:19], s101 offen offset:2048 sc1
    v_pk_fma_f32 v[174:175], v[176:177], v[186:187], v[194:195] op_sel:[1,1,0] op_sel_hi:[1,0,1] neg_lo:[0,1,0]
    v_cvt_pk_bf16_f32 v244, v174, -v175
    v_pk_mul_f32 v[194:195], v[176:177], v[190:191] op_sel:[0,0] op_sel_hi:[0,1]
    v_pk_fma_f32 v[178:179], v[176:177], v[190:191], v[194:195] op_sel:[1,1,0] op_sel_hi:[1,0,1] neg_lo:[0,1,0]
    v_cvt_pk_bf16_f32 v245, v178, -v179
    v_pk_mul_f32 v[194:195], v[178:179], v[186:187] op_sel:[0,0] op_sel_hi:[0,1]
    v_pk_fma_f32 v[174:175], v[178:179], v[186:187], v[194:195] op_sel:[1,1,0] op_sel_hi:[1,0,1] neg_lo:[0,1,0]
    v_cvt_pk_bf16_f32 v246, v174, -v175
    v_pk_mul_f32 v[194:195], v[178:179], v[190:191] op_sel:[0,0] op_sel_hi:[0,1]
    v_pk_fma_f32 v[176:177], v[178:179], v[190:191], v[194:195] op_sel:[1,1,0] op_sel_hi:[1,0,1] neg_lo:[0,1,0]
    v_cvt_pk_bf16_f32 v247, v176, -v177
    v_pk_mul_f32 v[194:195], v[176:177], v[186:187] op_sel:[0,0] op_sel_hi:[0,1]
    v_pk_fma_f32 v[174:175], v[176:177], v[186:187], v[194:195] op_sel:[1,1,0] op_sel_hi:[1,0,1] neg_lo:[0,1,0]
    v_cvt_pk_bf16_f32 v248, v174, -v175
    ds_write_addtid_b32 v242 offset:6800
    ds_write_addtid_b32 v243 offset:7072
    ds_write_addtid_b32 v244 offset:7344
    ds_write_addtid_b32 v245 offset:7616
    buffer_load_dwordx4 a[44:47], v200, s[16:19], s101 offen offset:3072 sc1
    ds_write_addtid_b32 v246 offset:7888
    ds_write_addtid_b32 v247 offset:8160
    ds_write_addtid_b32 v248 offset:8432
    ds_read_b128 a[192:195], v252 offset:0
    ds_read_b128 a[196:199], v252 offset:32
    ds_read_b128 a[200:203], v252 offset:64
    ds_read_b128 a[204:207], v252 offset:96
    ds_read_b128 a[208:211], v252 offset:128
    ds_read_b128 a[212:215], v252 offset:160
    ds_read_b128 a[216:219], v252 offset:192
    ds_read_b128 a[220:223], v252 offset:224
    s_add_u32 m0, s92, 75520
    s_nop 0
    buffer_load_dwordx4 v75, s[4:7], s99 offen offset:2176  lds
    s_waitcnt lgkmcnt(7)
    v_mfma_f32_32x32x16_bf16 v[216:231], a[192:195], a[160:163], v[216:231]
    s_add_u32 m0, s92, 75520
    s_nop 0
    buffer_load_dwordx4 v76, s[4:7], s99 offen offset:3264  lds
    s_waitcnt lgkmcnt(6)
    v_mfma_f32_32x32x16_bf16 v[216:231], a[196:199], a[164:167], v[216:231]
    s_add_u32 m0, s93, 92928
    s_add_u32 s101, s101, 4096
    buffer_load_dwordx4 a[48:51], v200, s[16:19], s101 offen offset:0 sc1
    s_add_u32 s99, s99, 256
    s_mov_b64 exec, s[80:81]
    buffer_load_dwordx4 v77, s[4:7], s100 offen  lds
    s_mov_b64 exec, -1
    s_add_u32 s100, s100, 256
    s_waitcnt lgkmcnt(5)
    v_mfma_f32_32x32x16_bf16 v[216:231], a[200:203], a[168:171], v[216:231]
    s_add_u32 m0, s92, 95104
    s_nop 0
    buffer_load_dwordx4 v73, s[4:7], s99 offen offset:0  lds
    s_waitcnt lgkmcnt(4)
    v_mfma_f32_32x32x16_bf16 v[216:231], a[204:207], a[172:175], v[216:231]
    s_add_u32 m0, s92, 95104
    s_nop 0
    buffer_load_dwordx4 v74, s[4:7], s99 offen offset:1088  lds
    s_waitcnt lgkmcnt(3)
    v_mfma_f32_32x32x16_bf16 v[216:231], a[208:211], a[176:179], v[216:231]
    s_add_u32 m0, s92, 95104
    s_nop 0
    buffer_load_dwordx4 v75, s[4:7], s99 offen offset:2176  lds
    s_waitcnt lgkmcnt(2)
    v_mfma_f32_32x32x16_bf16 v[216:231], a[212:215], a[180:183], v[216:231]
    s_add_u32 m0, s92, 95104
    s_nop 0
    buffer_load_dwordx4 v76, s[4:7], s99 offen offset:3264  lds
    s_waitcnt lgkmcnt(1)
    v_mfma_f32_32x32x16_bf16 v[216:231], a[216:219], a[184:187], v[216:231]
    buffer_load_dwordx4 a[52:55], v200, s[16:19], s101 offen offset:1024 sc1
    s_add_u32 m0, s93, 112512
    s_add_u32 s99, s99, 256
    s_mov_b64 exec, s[80:81]
    buffer_load_dwordx4 v77, s[4:7], s100 offen  lds
    s_mov_b64 exec, -1
    s_add_u32 s100, s100, 256
    s_waitcnt lgkmcnt(0)
    v_mfma_f32_32x32x16_bf16 v[216:231], a[220:223], a[188:191], v[216:231]
    s_add_u32 m0, s92, 114688
    s_nop 0
    buffer_load_dwordx4 v73, s[4:7], s99 offen offset:0  lds
    s_add_u32 m0, s92, 114688
    s_nop 0
    buffer_load_dwordx4 v74, s[4:7], s99 offen offset:1088  lds
    s_add_u32 m0, s92, 114688
    s_nop 0
    buffer_load_dwordx4 v75, s[4:7], s99 offen offset:2176  lds
    s_add_u32 m0, s92, 114688
    s_nop 0
    buffer_load_dwordx4 v76, s[4:7], s99 offen offset:3264  lds
    s_add_u32 m0, s93, 132096
    s_add_u32 s99, s99, 256
    s_mov_b64 exec, s[80:81]
    buffer_load_dwordx4 v77, s[4:7], s100 offen  lds
    s_mov_b64 exec, -1
    s_add_u32 s100, s100, 256
    s_mov_b32 m0, s37
    s_branch ec_4
nc_3:
    s_sub_u32 s33, s2, 160
    s_min_u32 s33, s33, 159
    s_mul_i32 s29, s33, 3277
    s_lshr_b32 s29, s29, 16
    s_mul_i32 s30, s29, 20
    s_sub_u32 s30, s33, s30
    s_mul_i32 s31, s30, 13108
    s_lshr_b32 s31, s31, 16
    s_mul_i32 s32, s31, 5
    s_sub_u32 s32, s30, s32
    s_lshl_b32 s28, s24, 10
    s_lshr_b32 s34, s32, 1
    s_mul_i32 s34, s34, 20
    s_and_b32 s35, s32, 1
    s_lshl_b32 s35, s35, 3
    s_add_u32 s34, s34, s35
    s_cmp_eq_u32 s32, 4
    s_cselect_b32 s34, 16, s34
    s_cselect_b32 s35, 20, 4
    s_mul_i32 s36, s31, 160
    s_add_u32 s34, s34, s36
    s_mul_i32 s34, s34, 1280
    s_mul_i32 s36, s29, 160
    s_add_u32 s34, s34, s36
    v_add_u32 v162, 0, v0
    v_mul_u32_u24 v160, 6554, v162
    v_lshrrev_b32 v160, 16, v160
    v_mul_u32_u24 v161, 10, v160
    v_sub_u32 v161, v162, v161
    v_lshrrev_b32 v163, 3, v160
    v_mul_u32_u24 v163, 40, v163
    v_bfe_u32 v164, v160, 2, 1
    v_mul_u32_u24 v164, s35, v164
    v_and_b32_e64 v160, 3, v160
    v_add3_u32 v160, v160, v163, v164
    v_mul_u32_u24 v160, 1280, v160
    v_lshl_add_u32 v162, v161, 4, v160
    s_add_u32 m0, s28, 0
    s_nop 0
    buffer_load_dwordx4 v162, s[12:15], s34 offen lds
    v_add_u32 v162, 256, v0
    v_min_u32 v162, 319, v162
    v_mul_u32_u24 v160, 6554, v162
    v_lshrrev_b32 v160, 16, v160
    v_mul_u32_u24 v161, 10, v160
    v_sub_u32 v161, v162, v161
    v_lshrrev_b32 v163, 3, v160
    v_mul_u32_u24 v163, 40, v163
    v_bfe_u32 v164, v160, 2, 1
    v_mul_u32_u24 v164, s35, v164
    v_and_b32_e64 v160, 3, v160
    v_add3_u32 v160, v160, v163, v164
    v_mul_u32_u24 v160, 1280, v160
    v_lshl_add_u32 v162, v161, 4, v160
    s_add_u32 m0, s28, 4096
    s_nop 0
    buffer_load_dwordx4 v162, s[12:15], s34 offen lds
    v_bfe_u32 v163, v0, 4, 2
    v_bfe_u32 v164, v0, 2, 2
    v_lshl_add_u32 v163, v163, 3, v164
    v_mul_u32_u24 v163, 160, v163
    v_and_b32 v164, 3, v0
    v_lshl_add_u32 v165, v164, 3, v163
    v_add_u32 v165, 0, v165
    s_lshl_b32 s36, s24, 5
    v_add_u32_e64 v166, s36, v165
    s_mul_i32 s33, s33, 5120
    s_add_u32 s33, s33, 2621440
    v_lshl_add_u32 v167, v1, 4, s33
    v_add_u32 v164, 4096, v167
    v_mov_b32 v163, 1073741824
    v_cmp_gt_u32 vcc, 64, v0
    s_sub_u32 s36, s24, s31
    s_and_b32 s36, s36, 3
    s_lshl_b32 s36, s36, 10
    v_cndmask_b32 v168, v163, v164, vcc
    v_add_u32 v167, s36, v167
    s_sub_u32 s33, s2, 64
    s_min_u32 s33, s33, 159
    s_mul_i32 s29, s33, 3277
    s_lshr_b32 s29, s29, 16
    s_mul_i32 s30, s29, 20
    s_sub_u32 s30, s33, s30
    s_mul_i32 s31, s30, 13108
    s_lshr_b32 s31, s31, 16
    s_mul_i32 s32, s31, 5
    s_sub_u32 s32, s30, s32
    s_lshl_b32 s28, s24, 10
    s_lshr_b32 s34, s32, 1
    s_mul_i32 s34, s34, 20
    s_and_b32 s35, s32, 1
    s_lshl_b32 s35, s35, 3
    s_add_u32 s34, s34, s35
    s_cmp_eq_u32 s32, 4
    s_cselect_b32 s34, 16, s34
    s_cselect_b32 s35, 20, 4
    s_mul_i32 s36, s31, 160
    s_add_u32 s34, s34, s36
    s_mul_i32 s34, s34, 1280
    s_mul_i32 s36, s29, 160
    s_add_u32 s34, s34, s36
    v_add_u32 v182, 0, v0
    v_mul_u32_u24 v180, 6554, v182
    v_lshrrev_b32 v180, 16, v180
    v_mul_u32_u24 v181, 10, v180
    v_sub_u32 v181, v182, v181
    v_lshrrev_b32 v183, 3, v180
    v_mul_u32_u24 v183, 40, v183
    v_bfe_u32 v184, v180, 2, 1
    v_mul_u32_u24 v184, s35, v184
    v_and_b32_e64 v180, 3, v180
    v_add3_u32 v180, v180, v183, v184
    v_mul_u32_u24 v180, 1280, v180
    v_lshl_add_u32 v182, v181, 4, v180
    s_add_u32 m0, s28, 8192
    s_nop 0
    buffer_load_dwordx4 v182, s[12:15], s34 offen lds
    v_add_u32 v182, 256, v0
    v_min_u32 v182, 319, v182
    v_mul_u32_u24 v180, 6554, v182
    v_lshrrev_b32 v180, 16, v180
    v_mul_u32_u24 v181, 10, v180
    v_sub_u32 v181, v182, v181
    v_lshrrev_b32 v183, 3, v180
    v_mul_u32_u24 v183, 40, v183
    v_bfe_u32 v184, v180, 2, 1
    v_mul_u32_u24 v184, s35, v184
    v_and_b32 v180, 3, v180
    v_add3_u32 v180, v180, v183, v184
    v_mul_u32_u24 v180, 1280, v180
    v_lshl_add_u32 v182, v181, 4, v180
    s_add_u32 m0, s28, 12288
    s_nop 0
    buffer_load_dwordx4 v182, s[12:15], s34 offen lds
    v_bfe_u32 v183, v0, 4, 2
    v_bfe_u32 v184, v0, 2, 2
    v_lshl_add_u32 v183, v183, 3, v184
    v_mul_u32_u24 v183, 160, v183
    v_and_b32 v184, 3, v0
    v_lshl_add_u32 v185, v184, 3, v183
    v_add_u32 v185, 8192, v185
    s_lshl_b32 s36, s24, 5
    v_add_u32 v186, s36, v185
    s_mul_i32 s33, s33, 5120
    s_add_u32 s33, s33, 2621440
    v_lshl_add_u32 v187, v1, 4, s33
    v_add_u32 v184, 4096, v187
    v_mov_b32 v183, 1073741824
    v_cmp_gt_u32 vcc, 64, v0
    s_sub_u32 s36, s24, s31
    s_and_b32 s36, s36, 3
    s_lshl_b32 s36, s36, 10
    v_cndmask_b32 v188, v183, v184, vcc
    v_add_u32 v187, s36, v187
    v_mov_b32 v216, 0
    v_mov_b32 v217, 0
    v_mov_b32 v218, 0
    v_mov_b32 v219, 0
    v_mov_b32 v220, 0
    v_mov_b32 v221, 0
    v_mov_b32 v222, 0
    v_mov_b32 v223, 0
    v_mov_b32 v224, 0
    v_mov_b32 v225, 0
    v_mov_b32 v226, 0
    v_mov_b32 v227, 0
    v_mov_b32 v228, 0
    v_mov_b32 v229, 0
    v_mov_b32 v230, 0
    v_mov_b32_e64 v231, 0
    s_waitcnt vmcnt(5)
    s_barrier
    ds_read_b64_tr_b16 v[96:97], v111
    ds_read_b64_tr_b16 v[98:99], v111 offset:2560
    ds_read_b64_tr_b16 v[100:101], v112
    ds_read_b64_tr_b16 v[102:103], v112 offset:2560
    ds_read_b64_tr_b16 v[104:105], v113
    ds_read_b64_tr_b16 v[106:107], v113 offset:2560
    s_waitcnt lgkmcnt(4)
    buffer_store_dwordx4 v[96:99], v108, s[16:19], 0 offen sc1
    s_waitcnt lgkmcnt(2)
    buffer_store_dwordx4 v[100:103], v109, s[16:19], 0 offen sc1
    s_waitcnt lgkmcnt(0)
    buffer_store_dwordx4 v[104:107], v110, s[16:19], 0 offen sc1
    global_load_dword v7, v5, s[66:67] sc1
    v_lshrrev_b32 v132, 5, v0
    v_and_b32_e64 v133, 31, v0
    v_mul_u32_u24 v132, 1280, v132
    v_lshl_add_u32 v134, v133, 4, v132
    v_mov_b32 v135, 1073741824
    v_cmp_gt_u32 vcc, 16, v133
    s_mul_i32 s96, s2, 10240
    buffer_load_dwordx4 v[120:123], v134, s[4:7], s96 offen
    v_cndmask_b32_e64 v135, v135, v134, vcc
    buffer_load_dwordx4 v[124:127], v134, s[4:7], s96 offen offset:512
    buffer_load_dwordx4 v[128:131], v135, s[4:7], s96 offen offset:1024
    s_waitcnt vmcnt(4)
    s_waitcnt vmcnt(3)
    v_cmp_gt_u32 vcc, 1, v7
    s_nop 0
    s_and_b64 vcc, vcc, s[50:51]
    s_and_b64 vcc, vcc, 1
    s_cbranch_scc1 ps_11
pc_13:
    s_barrier
    v_lshlrev_b32 v2, 3, v4
    v_mov_b32 v5, 1
    v_cndmask_b32 v2, v4, v2, s[50:51]
    buffer_atomic_add v5, v2, s[16:19], s86 offen offset:0 sc1
    ds_read_b64_tr_b16 v[172:173], v166
    ds_read_b64_tr_b16 v[174:175], v166 offset:640
    ds_read_b64_tr_b16 v[176:177], v165 offset:128
    ds_read_b64_tr_b16 v[178:179], v165 offset:768
    s_waitcnt lgkmcnt(2)
    buffer_store_dwordx4 v[172:175], v167, s[16:19], 0 offen sc1
    s_waitcnt lgkmcnt(0)
    buffer_store_dwordx4 v[176:179], v168, s[16:19], 0 offen sc1
    ds_read_b64_tr_b16 v[192:193], v186
    ds_read_b64_tr_b16 v[194:195], v186 offset:640
    ds_read_b64_tr_b16 v[196:197], v185 offset:128
    ds_read_b64_tr_b16 v[198:199], v185 offset:768
    s_waitcnt lgkmcnt(2)
    buffer_store_dwordx4 v[192:195], v187, s[16:19], 0 offen sc1
    s_waitcnt lgkmcnt(0)
    buffer_store_dwordx4 v[196:199], v188, s[16:19], 0 offen sc1
    v_mov_b32 v134, 0x3f803f80
    v_mov_b32 v132, 0
    v_mov_b32 v133, 0
    s_waitcnt vmcnt(7)
    v_dot2c_f32_bf16 v132, v120, v134
    v_dot2c_f32_bf16 v133, v120, v120
    v_dot2c_f32_bf16 v132, v121, v134
    v_dot2c_f32_bf16 v133, v121, v121
    v_dot2c_f32_bf16 v132, v122, v134
    v_dot2c_f32_bf16 v133, v122, v122
    v_dot2c_f32_bf16 v132, v123, v134
    v_dot2c_f32_bf16 v133, v123, v123
    s_waitcnt vmcnt(6)
    v_dot2c_f32_bf16 v132, v124, v134
    v_dot2c_f32_bf16 v133, v124, v124
    v_dot2c_f32_bf16 v132, v125, v134
    v_dot2c_f32_bf16 v133, v125, v125
    v_dot2c_f32_bf16 v132, v126, v134
    v_dot2c_f32_bf16 v133, v126, v126
    v_dot2c_f32_bf16 v132, v127, v134
    v_dot2c_f32_bf16 v133, v127, v127
    s_waitcnt vmcnt(5)
    v_dot2c_f32_bf16 v132, v128, v134
    v_dot2c_f32_bf16 v133, v128, v128
    v_dot2c_f32_bf16 v132, v129, v134
    v_dot2c_f32_bf16 v133, v129, v129
    v_dot2c_f32_bf16 v132, v130, v134
    v_dot2c_f32_bf16 v133, v130, v130
    v_dot2c_f32_bf16 v132, v131, v134
    v_dot2c_f32_bf16 v133, v131, v131
    v_lshrrev_b32 v135, 5, v0
    v_and_b32 v121, 3, v135
    v_lshrrev_b32 v135, 2, v135
    v_add_f32_dpp v132, v132, v132 row_shr:1 row_mask:0xf bank_mask:0xf bound_ctrl:0
    v_add_f32_dpp v133, v133, v133 row_shr:1 row_mask:0xf bank_mask:0xf bound_ctrl:0
    v_lshlrev_b32_e64 v135, 3, v135
    v_add_f32_dpp v132, v132, v132 row_shr:2 row_mask:0xf bank_mask:0xf bound_ctrl:0
    v_add_f32_dpp v133, v133, v133 row_shr:2 row_mask:0xf bank_mask:0xf bound_ctrl:0
    v_lshl_add_u32 v135, v121, 12, v135
    v_add_f32_dpp v132, v132, v132 row_shr:4 row_mask:0xf bank_mask:0xf bound_ctrl:0
    v_add_f32_dpp v133, v133, v133 row_shr:4 row_mask:0xf bank_mask:0xf bound_ctrl:0
    v_and_b32_e64 v121, 31, v0
    v_add_f32_dpp v132, v132, v132 row_shr:8 row_mask:0xf bank_mask:0xf bound_ctrl:0
    v_add_f32_dpp v133, v133, v133 row_shr:8 row_mask:0xf bank_mask:0xf bound_ctrl:0
    v_cmp_eq_u32_e64 vcc, 31, v121
    v_add_f32_dpp v132, v132, v132 row_bcast:15 row_mask:0xa bank_mask:0xf
    v_add_f32_dpp v133, v133, v133 row_bcast:15 row_mask:0xa bank_mask:0xf
    v_mov_b32 v121, 1073741824
    v_cndmask_b32_e64 v120, v121, v135, vcc
    s_lshl_b32 s96, s2, 4
    s_add_u32 s96, s96, 3440640
    v_mul_f32 v135, 0x3acccccd, v132
    v_mul_f32 v133, 0x3acccccd, v133
    v_fma_f32 v133, -v135, v135, v133
    v_max_f32 v133, 0, v133
    v_add_f32 v133, 0x3727c5ac, v133
    v_rsq_f32_e64 v132, v133
    s_nop 0
    v_mul_f32 v133, -v135, v132
    buffer_store_dwordx2 v[132:133], v120, s[16:19], s96 offen sc1
    s_add_u32 m0, s92, 36352
    s_nop 0
    s_nop 0
    buffer_load_dwordx4 v73, s[4:7], s99 offen offset:0  lds
    buffer_load_dwordx4 v74, s[4:7], s99 offen offset:1088  lds
    buffer_load_dwordx4 v75, s[4:7], s99 offen offset:2176  lds
    buffer_load_dwordx4 v76, s[4:7], s99 offen offset:3264  lds
    s_add_u32 m0, s93, 53760
    s_add_u32 s99, s99, 256
    s_mov_b64 exec, s[80:81]
    buffer_load_dwordx4 v77, s[4:7], s100 offen  lds
    s_mov_b64 exec, -1
    s_add_u32 s100, s100, 256
    s_add_u32 m0, s92, 55936
    s_nop 0
    s_nop 0
    buffer_load_dwordx4 v73, s[4:7], s99 offen offset:0  lds
    buffer_load_dwordx4 v74, s[4:7], s99 offen offset:1088  lds
    buffer_load_dwordx4 v75, s[4:7], s99 offen offset:2176  lds
    buffer_load_dwordx4 v76, s[4:7], s99 offen offset:3264  lds
    s_add_u32 m0, s93, 73344
    s_add_u32 s99, s99, 256
    s_mov_b64 exec, s[80:81]
    buffer_load_dwordx4 v77, s[4:7], s100 offen  lds
    s_mov_b64 exec, -1
    s_add_u32 s100, s100, 256
    v_mov_b32 v140, 1073741824
    v_lshlrev_b32 v141, 2, v0
    v_cmp_gt_u32 vcc, 64, v0
    s_nop 1
    v_cndmask_b32 v141, v140, v141, vcc
    v_mov_b32_e64 v140, 0
    s_lshl_b32 s97, s2, 8
    s_add_u32 s97, s97, 3473408
    buffer_store_dword v140, v141, s[16:19], s97 offen sc1
    v_mov_b32 v142, 1073741824
    v_lshlrev_b32 v143, 2, v0
    v_cmp_gt_u32 vcc, 16, v0
    s_nop 1
    v_cndmask_b32 v143, v142, v143, vcc
    v_mov_b32_e64 v142, -1
    s_lshl_b32 s97, s2, 6
    s_add_u32 s97, s97, 3457024
    buffer_store_dword v142, v143, s[16:19], s97 offen sc1
    v_mov_b32 v144, -1
    v_mov_b32 v145, -1
    v_mov_b32 v146, -1
    v_mov_b32 v147, -1
    v_lshlrev_b32 v148, 4, v0
    s_sub_u32 s88, s2, 0
    s_mul_i32 s88, s88, 20480
    s_min_u32 s88, s88, 5222400
    s_add_u32 s88, s88, 4194304
    buffer_store_dwordx4 v[144:147], v148, s[16:19], s88 offen sc1
    s_add_u32 s88, s88, 4096
    buffer_store_dwordx4 v[144:147], v148, s[16:19], s88 offen sc1
    s_add_u32 s88, s88, 4096
    buffer_store_dwordx4 v[144:147], v148, s[16:19], s88 offen sc1
    s_add_u32 s88, s88, 4096
    buffer_store_dwordx4 v[144:147], v148, s[16:19], s88 offen sc1
    s_add_u32 s88, s88, 4096
    buffer_store_dwordx4 v[144:147], v148, s[16:19], s88 offen sc1
    s_add_u32 m0, s92, 75520
    s_nop 0
    s_nop 0
    buffer_load_dwordx4 v73, s[4:7], s99 offen offset:0  lds
    buffer_load_dwordx4 v74, s[4:7], s99 offen offset:1088  lds
    buffer_load_dwordx4 v75, s[4:7], s99 offen offset:2176  lds
    buffer_load_dwordx4 v76, s[4:7], s99 offen offset:3264  lds
    s_add_u32 m0, s93, 92928
    s_add_u32 s99, s99, 256
    s_mov_b64 exec, s[80:81]
    buffer_load_dwordx4 v77, s[4:7], s100 offen  lds
    s_mov_b64 exec, -1
    s_add_u32 s100, s100, 256
    s_add_u32 m0, s92, 95104
    s_nop 0
    s_nop 0
    buffer_load_dwordx4 v73, s[4:7], s99 offen offset:0  lds
    buffer_load_dwordx4 v74, s[4:7], s99 offen offset:1088  lds
    buffer_load_dwordx4 v75, s[4:7], s99 offen offset:2176  lds
    buffer_load_dwordx4 v76, s[4:7], s99 offen offset:3264  lds
    s_add_u32 m0, s93, 112512
    s_add_u32 s99, s99, 256
    s_mov_b64 exec, s[80:81]
    buffer_load_dwordx4 v77, s[4:7], s100 offen  lds
    s_mov_b64 exec, -1
    s_add_u32 s100, s100, 256
    s_add_u32 m0, s92, 114688
    s_nop 0
    s_nop 0
    buffer_load_dwordx4 v73, s[4:7], s99 offen offset:0  lds
    buffer_load_dwordx4 v74, s[4:7], s99 offen offset:1088  lds
    buffer_load_dwordx4 v75, s[4:7], s99 offen offset:2176  lds
    buffer_load_dwordx4 v76, s[4:7], s99 offen offset:3264  lds
    s_add_u32 m0, s93, 132096
    s_add_u32 s99, s99, 256
    s_mov_b64 exec, s[80:81]
    buffer_load_dwordx4 v77, s[4:7], s100 offen  lds
    s_mov_b64 exec, -1
    s_add_u32 s100, s100, 256
    s_waitcnt vmcnt(15)
    buffer_load_dword v7, v4, s[16:19], s87 offen offset:0 sc1
    s_waitcnt vmcnt(0)
    v_cmp_gt_u32_e64 vcc, 32, v7
    s_nop 0
    s_and_b64 vcc, vcc, s[50:51]
    s_cbranch_scc1 ps_14
pc_16:
    s_barrier
    buffer_load_dwordx4 a[0:3], v200, s[16:19], s101 offen offset:0 sc1
    buffer_load_dwordx4 a[4:7], v200, s[16:19], s101 offen offset:1024 sc1
    buffer_load_dwordx4 a[8:11], v200, s[16:19], s101 offen offset:2048 sc1
    buffer_load_dwordx4 a[12:15], v200, s[16:19], s101 offen offset:3072 sc1
    s_add_u32 s101, s101, 4096
    buffer_load_dwordx4 a[16:19], v200, s[16:19], s101 offen offset:0 sc1
    buffer_load_dwordx4 a[20:23], v200, s[16:19], s101 offen offset:1024 sc1
    buffer_load_dwordx4 a[24:27], v200, s[16:19], s101 offen offset:2048 sc1
    buffer_load_dwordx4 a[28:31], v200, s[16:19], s101 offen offset:3072 sc1
    s_add_u32 s101, s101, 4096
    buffer_load_dwordx4 a[32:35], v200, s[16:19], s101 offen offset:0 sc1
    buffer_load_dwordx4 a[36:39], v200, s[16:19], s101 offen offset:1024 sc1
    buffer_load_dwordx4 a[40:43], v200, s[16:19], s101 offen offset:2048 sc1
    buffer_load_dwordx4 a[44:47], v200, s[16:19], s101 offen offset:3072 sc1
    s_add_u32 s101, s101, 4096
    buffer_load_dwordx4 a[48:51], v200, s[16:19], s101 offen offset:0 sc1
    buffer_load_dwordx4 a[52:55], v200, s[16:19], s101 offen offset:1024 sc1
ec_4:
    v_add_u32 v196, 36352, v78
    v_mov_b32 v198, v79
    v_xor_b32 v197, 32, v196
    s_waitcnt vmcnt(34)
    s_barrier
    s_add_u32 s82, s86, 16384
    v_lshlrev_b32 v2, 3, v4
    v_mov_b32 v5, 1
    v_cndmask_b32 v2, v4, v2, s[50:51]
    buffer_atomic_add v5, v2, s[16:19], s82 offen offset:8 sc1
    ds_read_b128 v[160:163], v198 offset:0
    ds_read_b128 v[164:167], v196 offset:0
    ds_read_b128 v[168:171], v196 offset:8704
    ds_read_b128 v[172:175], v198 offset:32
    ds_read_b128 v[176:179], v197 offset:0
    ds_read_b128 v[180:183], v197 offset:8704
    s_waitcnt lgkmcnt(3)
    s_waitcnt vmcnt(14)
    v_mfma_f32_16x16x32_bf16 v[112:115], a[0:3], v[160:163], 0
    ds_read_b128 v[184:187], v198 offset:64
    v_mfma_f32_32x32x16_bf16 v[80:95], a[0:3], v[164:167], 0
    ds_read_b128 v[188:191], v196 offset:64
    v_mov_b32 v208, 0
    v_mov_b32 v209, 0
    v_lshrrev_b32_e64 v210, 5, v0
    v_mul_u32_u24 v210, 1600, v210
    v_mfma_f32_32x32x16_bf16 v[96:111], a[0:3], v[168:171], 0
    ds_read_b128 v[192:195], v196 offset:8768
    buffer_load_dwordx4 a[56:59], v200, s[16:19], s101 offen offset:2048 sc1
    v_and_b32 v211, 31, v0
    v_min_u32 v211, 19, v211
    s_waitcnt lgkmcnt(3)
    s_waitcnt vmcnt(14)
    v_mfma_f32_16x16x32_bf16 v[112:115], a[4:7], v[172:175], v[112:115]
    ds_read_b128 v[160:163], v198 offset:96
    v_mfma_f32_32x32x16_bf16 v[80:95], a[4:7], v[176:179], v[80:95]
    ds_read_b128 v[164:167], v197 offset:64
    v_lshl_add_u32 v210, v211, 3, v210
    v_add_u32 v210, 6400, v210
    ds_write_b64 v210, v[208:209]
    s_mul_i32 s33, s24, 4160
    v_mfma_f32_32x32x16_bf16 v[96:111], a[4:7], v[180:183], v[96:111]
    ds_read_b128 v[168:171], v197 offset:8768
    buffer_load_dwordx4 a[60:63], v200, s[16:19], s101 offen offset:3072 sc1
    s_add_u32 s33, s33, 134272
    v_and_b32_e64 v250, 31, v1
    s_waitcnt lgkmcnt(4)
    s_waitcnt vmcnt(14)
    v_mfma_f32_16x16x32_bf16 v[112:115], a[8:11], v[184:187], v[112:115]
    ds_read_b128 v[172:175], v198 offset:128
    v_mfma_f32_32x32x16_bf16 v[80:95], a[8:11], v[188:191], v[80:95]
    ds_read_b128 v[176:179], v196 offset:128
    v_lshl_add_u32 v250, v250, 4, s33
    v_lshrrev_b32_e64 v253, 5, v1
    v_lshl_add_u32 v251, v253, 3, v250
    v_lshl_add_u32 v252, v253, 9, v250
    v_mfma_f32_32x32x16_bf16 v[96:111], a[8:11], v[192:195], v[96:111]
    ds_read_b128 v[180:183], v196 offset:8832
    s_add_u32 s101, s101, 4096
    buffer_load_dwordx4 a[64:67], v200, s[16:19], s101 offen offset:0 sc1
    v_lshl_add_u32 v250, v253, 10, v250
    s_waitcnt lgkmcnt(3)
    s_waitcnt vmcnt(14)
    v_mfma_f32_16x16x32_bf16 v[112:115], a[12:15], v[160:163], v[112:115]
    ds_read_b128 v[184:187], v198 offset:160
    v_mfma_f32_32x32x16_bf16 v[80:95], a[12:15], v[164:167], v[80:95]
    ds_read_b128 v[188:191], v197 offset:128
    v_cmp_eq_u32 vcc, 0, v1
    v_lshlrev_b32 v254, 16, v241
    v_min_u32 v253, 15, v1
    v_cndmask_b32 v254, 0, v254, vcc
    v_mfma_f32_32x32x16_bf16 v[96:111], a[12:15], v[168:171], v[96:111]
    ds_read_b128 v[192:195], v197 offset:8832
    buffer_load_dwordx4 a[68:71], v200, s[16:19], s101 offen offset:1024 sc1
    v_lshl_add_u32 v253, v253, 2, s33
    v_add_f32_e64 v216, v216, v254
    s_waitcnt lgkmcnt(3)
    s_waitcnt vmcnt(14)
    v_mfma_f32_16x16x32_bf16 v[112:115], a[16:19], v[172:175], v[112:115]
    ds_read_b128 v[160:163], v198 offset:192
    v_mfma_f32_32x32x16_bf16 v[80:95], a[16:19], v[176:179], v[80:95]
    ds_read_b128 v[164:167], v196 offset:192
    v_and_b32 v254, 1, v1
    v_cmp_eq_u32 vcc, 1, v254
    v_mov_b32_e64 v254, 0
    v_cvt_pk_bf16_f32 v242, v216, v217
    v_mfma_f32_32x32x16_bf16 v[96:111], a[16:19], v[180:183], v[96:111]
    ds_read_b128 v[168:171], v196 offset:8896
    buffer_load_dwordx4 a[72:75], v200, s[16:19], s101 offen offset:2048 sc1
    v_cvt_pk_bf16_f32 v243, v218, v219
    v_cvt_pk_bf16_f32 v244, v220, v220
    s_waitcnt lgkmcnt(3)
    s_waitcnt vmcnt(14)
    v_mfma_f32_16x16x32_bf16 v[112:115], a[20:23], v[184:187], v[112:115]
    ds_read_b128 v[172:175], v198 offset:224
    v_mfma_f32_32x32x16_bf16 v[80:95], a[20:23], v[188:191], v[80:95]
    ds_read_b128 v[176:179], v197 offset:192
    v_cvt_pk_bf16_f32 v245, v221, v222
    v_cvt_pk_bf16_f32 v246, v224, v224
    v_cvt_pk_bf16_f32 v247, v224, v225
    v_cvt_pk_bf16_f32 v248, v225, v225
    v_mfma_f32_32x32x16_bf16 v[96:111], a[20:23], v[192:195], v[96:111]
    ds_read_b128 v[180:183], v197 offset:8896
    buffer_load_dwordx4 a[76:79], v200, s[16:19], s101 offen offset:3072 sc1
    v_cvt_pk_bf16_f32 v249, v226, v226
    ds_write_b32 v253, v254
    s_barrier
    s_waitcnt lgkmcnt(4)
    s_waitcnt vmcnt(14)
    v_mfma_f32_16x16x32_bf16 v[112:115], a[24:27], v[160:163], v[112:115]
    v_add_u32 v198, v49, v198
    v_mfma_f32_32x32x16_bf16 v[80:95], a[24:27], v[164:167], v[80:95]
    v_add_u32 v196, 19584, v196
    v_add_u32 v197, 19584, v197
    ds_read_b128 v[184:187], v198 offset:0
    ds_write_b64 v251, v[242:243] offset:64
    ds_write_b64 v251, v[244:245] offset:576
    v_mfma_f32_32x32x16_bf16 v[96:111], a[24:27], v[168:171], v[96:111]
    ds_read_b128 v[188:191], v196 offset:0
    ds_read_b128 v[192:195], v196 offset:8704
    s_add_u32 s101, s101, 4096
    buffer_load_dwordx4 a[80:83], v200, s[16:19], s101 offen offset:0 sc1
    s_waitcnt lgkmcnt(6)
    s_waitcnt vmcnt(14)
    v_mfma_f32_16x16x32_bf16 v[112:115], a[28:31], v[172:175], v[112:115]
    ds_read_b128 v[160:163], v198 offset:32
    v_mfma_f32_32x32x16_bf16 v[80:95], a[28:31], v[176:179], v[80:95]
    ds_read_b128 v[164:167], v197 offset:0
    ds_write_b128 v252, v[246:249] offset:1088
    v_cndmask_b32 v255, v228, v229, vcc
    v_cvt_pk_bf16_f32 v216, v228, v228
    v_mov_b32 v217, v216
    v_mfma_f32_32x32x16_bf16 v[96:111], a[28:31], v[180:183], v[96:111]
    ds_read_b128 v[168:171], v197 offset:8704
    buffer_load_dwordx4 a[84:87], v200, s[16:19], s101 offen offset:1024 sc1
    v_cvt_pk_bf16_f32 v218, v255, v229
    v_cvt_pk_bf16_f32 v219, v229, v229
    s_waitcnt lgkmcnt(4)
    s_waitcnt vmcnt(14)
    v_mfma_f32_16x16x32_bf16 v[112:115], a[32:35], v[184:187], v[112:115]
    ds_read_b128 v[172:175], v198 offset:64
    v_mfma_f32_32x32x16_bf16 v[80:95], a[32:35], v[188:191], v[80:95]
    ds_read_b128 v[176:179], v196 offset:64
    ds_write_b128 v250, v[216:219] offset:2112
    v_cndmask_b32 v255, v230, v231, vcc
    v_cvt_pk_bf16_f32 v220, v230, v230
    v_mov_b32 v221, v220
    v_mfma_f32_32x32x16_bf16 v[96:111], a[32:35], v[192:195], v[96:111]
    ds_read_b128 v[180:183], v196 offset:8768
    buffer_load_dwordx4 a[88:91], v200, s[16:19], s101 offen offset:2048 sc1
    v_cvt_pk_bf16_f32 v222, v255, v231
    v_cvt_pk_bf16_f32 v223, v231, v231
    s_waitcnt lgkmcnt(4)
    s_waitcnt vmcnt(14)
    v_mfma_f32_16x16x32_bf16 v[112:115], a[36:39], v[160:163], v[112:115]
    ds_read_b128 v[184:187], v198 offset:96
    v_mfma_f32_32x32x16_bf16 v[80:95], a[36:39], v[164:167], v[80:95]
    ds_read_b128 v[188:191], v197 offset:64
    ds_write_b128 v250, v[220:223] offset:2624
    v_mfma_f32_32x32x16_bf16 v[96:111], a[36:39], v[168:171], v[96:111]
    ds_read_b128 v[192:195], v197 offset:8768
    buffer_load_dwordx4 a[92:95], v200, s[16:19], s101 offen offset:3072 sc1
    s_waitcnt lgkmcnt(4)
    s_waitcnt vmcnt(14)
    v_mfma_f32_16x16x32_bf16 v[112:115], a[40:43], v[172:175], v[112:115]
    ds_read_b128 v[160:163], v198 offset:128
    v_mfma_f32_32x32x16_bf16 v[80:95], a[40:43], v[176:179], v[80:95]
    ds_read_b128 v[164:167], v196 offset:128
    v_mfma_f32_32x32x16_bf16 v[96:111], a[40:43], v[180:183], v[96:111]
    ds_read_b128 v[168:171], v196 offset:8832
    s_add_u32 s101, s101, 4096
    buffer_load_dwordx4 a[96:99], v200, s[16:19], s101 offen offset:0 sc1
    s_waitcnt lgkmcnt(3)
    s_waitcnt vmcnt(14)
    v_mfma_f32_16x16x32_bf16 v[112:115], a[44:47], v[184:187], v[112:115]
    ds_read_b128 v[172:175], v198 offset:160
    v_mfma_f32_32x32x16_bf16 v[80:95], a[44:47], v[188:191], v[80:95]
    ds_read_b128 v[176:179], v197 offset:128
    v_mfma_f32_32x32x16_bf16 v[96:111], a[44:47], v[192:195], v[96:111]
    ds_read_b128 v[180:183], v197 offset:8832
    buffer_load_dwordx4 a[100:103], v200, s[16:19], s101 offen offset:1024 sc1
    s_waitcnt lgkmcnt(3)
    s_waitcnt vmcnt(14)
    v_mfma_f32_16x16x32_bf16 v[112:115], a[48:51], v[160:163], v[112:115]
    ds_read_b128 v[184:187], v198 offset:192
    v_mfma_f32_32x32x16_bf16 v[80:95], a[48:51], v[164:167], v[80:95]
    ds_read_b128 v[188:191], v196 offset:192
    v_mfma_f32_32x32x16_bf16 v[96:111], a[48:51], v[168:171], v[96:111]
    ds_read_b128 v[192:195], v196 offset:8896
    buffer_load_dwordx4 a[104:107], v200, s[16:19], s101 offen offset:2048 sc1
    s_waitcnt lgkmcnt(3)
    s_waitcnt vmcnt(14)
    v_mfma_f32_16x16x32_bf16 v[112:115], a[52:55], v[172:175], v[112:115]
    ds_read_b128 v[160:163], v198 offset:224
    v_mfma_f32_32x32x16_bf16 v[80:95], a[52:55], v[176:179], v[80:95]
    ds_read_b128 v[164:167], v197 offset:192
    v_mfma_f32_32x32x16_bf16 v[96:111], a[52:55], v[180:183], v[96:111]
    ds_read_b128 v[168:171], v197 offset:8896
    buffer_load_dwordx4 a[108:111], v200, s[16:19], s101 offen offset:3072 sc1
    s_barrier
    s_waitcnt lgkmcnt(3)
    s_waitcnt vmcnt(13)
    v_mfma_f32_16x16x32_bf16 v[112:115], a[56:59], v[184:187], v[112:115]
    v_add_u32 v198, v49, v198
    v_mfma_f32_32x32x16_bf16 v[80:95], a[56:59], v[188:191], v[80:95]
    v_add_u32 v196, 19584, v196
    v_add_u32 v197, 19584, v197
    ds_read_b128 v[172:175], v198 offset:0
    v_mfma_f32_32x32x16_bf16 v[96:111], a[56:59], v[192:195], v[96:111]
    ds_read_b128 v[176:179], v196 offset:0
    ds_read_b128 v[180:183], v196 offset:8704
    s_add_u32 s101, s101, 4096
    buffer_load_dwordx4 a[112:115], v200, s[16:19], s101 offen offset:0 sc1
    s_waitcnt lgkmcnt(3)
    s_waitcnt vmcnt(13)
    v_mfma_f32_16x16x32_bf16 v[112:115], a[60:63], v[160:163], v[112:115]
    ds_read_b128 v[184:187], v198 offset:32
    v_mfma_f32_32x32x16_bf16 v[80:95], a[60:63], v[164:167], v[80:95]
    ds_read_b128 v[188:191], v197 offset:0
    v_mfma_f32_32x32x16_bf16 v[96:111], a[60:63], v[168:171], v[96:111]
    ds_read_b128 v[192:195], v197 offset:8704
    buffer_load_dwordx4 a[116:119], v200, s[16:19], s101 offen offset:1024 sc1
    s_waitcnt lgkmcnt(3)
    s_waitcnt vmcnt(13)
    v_mfma_f32_16x16x32_bf16 v[112:115], a[64:67], v[172:175], v[112:115]
    ds_read_b128 v[160:163], v198 offset:64
    v_mfma_f32_32x32x16_bf16 v[80:95], a[64:67], v[176:179], v[80:95]
    ds_read_b128 v[164:167], v196 offset:64
    v_mfma_f32_32x32x16_bf16 v[96:111], a[64:67], v[180:183], v[96:111]
    ds_read_b128 v[168:171], v196 offset:8768
    buffer_load_dwordx4 a[120:123], v200, s[16:19], s101 offen offset:2048 sc1
    s_waitcnt lgkmcnt(3)
    s_waitcnt vmcnt(13)
    v_mfma_f32_16x16x32_bf16 v[112:115], a[68:71], v[184:187], v[112:115]
    ds_read_b128 v[172:175], v198 offset:96
    v_mfma_f32_32x32x16_bf16 v[80:95], a[68:71], v[188:191], v[80:95]
    ds_read_b128 v[176:179], v197 offset:64
    v_mfma_f32_32x32x16_bf16 v[96:111], a[68:71], v[192:195], v[96:111]
    ds_read_b128 v[180:183], v197 offset:8768
    buffer_load_dwordx4 a[124:127], v200, s[16:19], s101 offen offset:3072 sc1
    s_waitcnt lgkmcnt(3)
    s_waitcnt vmcnt(13)
    v_mfma_f32_16x16x32_bf16 v[112:115], a[72:75], v[160:163], v[112:115]
    ds_read_b128 v[184:187], v198 offset:128
    v_mfma_f32_32x32x16_bf16 v[80:95], a[72:75], v[164:167], v[80:95]
    ds_read_b128 v[188:191], v196 offset:128
    v_mfma_f32_32x32x16_bf16 v[96:111], a[72:75], v[168:171], v[96:111]
    ds_read_b128 v[192:195], v196 offset:8832
    s_add_u32 s101, s101, 4096
    buffer_load_dwordx4 a[128:131], v200, s[16:19], s101 offen offset:0 sc1
    s_waitcnt lgkmcnt(3)
    s_waitcnt vmcnt(13)
    v_mfma_f32_16x16x32_bf16 v[112:115], a[76:79], v[172:175], v[112:115]
    ds_read_b128 v[160:163], v198 offset:160
    v_mfma_f32_32x32x16_bf16 v[80:95], a[76:79], v[176:179], v[80:95]
    ds_read_b128 v[164:167], v197 offset:128
    v_mfma_f32_32x32x16_bf16 v[96:111], a[76:79], v[180:183], v[96:111]
    ds_read_b128 v[168:171], v197 offset:8832
    buffer_load_dwordx4 a[132:135], v200, s[16:19], s101 offen offset:1024 sc1
    s_waitcnt lgkmcnt(3)
    s_waitcnt vmcnt(13)
    v_mfma_f32_16x16x32_bf16 v[112:115], a[80:83], v[184:187], v[112:115]
    ds_read_b128 v[172:175], v198 offset:192
    v_mfma_f32_32x32x16_bf16 v[80:95], a[80:83], v[188:191], v[80:95]
    ds_read_b128 v[176:179], v196 offset:192
    v_mfma_f32_32x32x16_bf16 v[96:111], a[80:83], v[192:195], v[96:111]
    ds_read_b128 v[180:183], v196 offset:8896
    buffer_load_dwordx4 a[136:139], v200, s[16:19], s101 offen offset:2048 sc1
    s_waitcnt lgkmcnt(3)
    s_waitcnt vmcnt(13)
    v_mfma_f32_16x16x32_bf16 v[112:115], a[84:87], v[160:163], v[112:115]
    ds_read_b128 v[184:187], v198 offset:224
    v_mfma_f32_32x32x16_bf16 v[80:95], a[84:87], v[164:167], v[80:95]
    ds_read_b128 v[188:191], v197 offset:192
    v_mfma_f32_32x32x16_bf16 v[96:111], a[84:87], v[168:171], v[96:111]
    ds_read_b128 v[192:195], v197 offset:8896
    buffer_load_dwordx4 a[140:143], v200, s[16:19], s101 offen offset:3072 sc1
    s_barrier
    s_waitcnt lgkmcnt(3)
    s_waitcnt vmcnt(13)
    v_mfma_f32_16x16x32_bf16 v[112:115], a[88:91], v[172:175], v[112:115]
    v_add_u32 v198, v49, v198
    v_mfma_f32_32x32x16_bf16 v[80:95], a[88:91], v[176:179], v[80:95]
    v_add_u32 v196, 19584, v196
    v_add_u32 v197, 19584, v197
    ds_read_b128 v[160:163], v198 offset:0
    v_mfma_f32_32x32x16_bf16 v[96:111], a[88:91], v[180:183], v[96:111]
    ds_read_b128 v[164:167], v196 offset:0
    ds_read_b128 v[168:171], v196 offset:8704
    s_add_u32 s101, s101, 4096
    buffer_load_dword v7, v4, s[16:19], s89 offen offset:8 sc1
    s_waitcnt lgkmcnt(3)
    s_waitcnt vmcnt(13)
    v_mfma_f32_16x16x32_bf16 v[112:115], a[92:95], v[184:187], v[112:115]
    ds_read_b128 v[172:175], v198 offset:32
    v_mfma_f32_32x32x16_bf16 v[80:95], a[92:95], v[188:191], v[80:95]
    ds_read_b128 v[176:179], v197 offset:0
    v_mfma_f32_32x32x16_bf16 v[96:111], a[92:95], v[192:195], v[96:111]
    ds_read_b128 v[180:183], v197 offset:8704
    buffer_load_dwordx4 a[144:147], v200, s[16:19], s101 offen offset:0 sc1
    s_waitcnt lgkmcnt(3)
    s_waitcnt vmcnt(13)
    v_mfma_f32_16x16x32_bf16 v[112:115], a[96:99], v[160:163], v[112:115]
    ds_read_b128 v[184:187], v198 offset:64
    v_mfma_f32_32x32x16_bf16 v[80:95], a[96:99], v[164:167], v[80:95]
    ds_read_b128 v[188:191], v196 offset:64
    v_mfma_f32_32x32x16_bf16 v[96:111], a[96:99], v[168:171], v[96:111]
    ds_read_b128 v[192:195], v196 offset:8768
    buffer_load_dwordx4 a[148:151], v200, s[16:19], s101 offen offset:1024 sc1
    s_waitcnt lgkmcnt(3)
    s_waitcnt vmcnt(13)
    v_mfma_f32_16x16x32_bf16 v[112:115], a[100:103], v[172:175], v[112:115]
    ds_read_b128 v[160:163], v198 offset:96
    v_mfma_f32_32x32x16_bf16 v[80:95], a[100:103], v[176:179], v[80:95]
    ds_read_b128 v[164:167], v197 offset:64
    v_mfma_f32_32x32x16_bf16 v[96:111], a[100:103], v[180:183], v[96:111]
    ds_read_b128 v[168:171], v197 offset:8768
    buffer_load_dwordx4 a[152:155], v200, s[16:19], s101 offen offset:2048 sc1
    s_waitcnt lgkmcnt(3)
    s_waitcnt vmcnt(13)
    v_mfma_f32_16x16x32_bf16 v[112:115], a[104:107], v[184:187], v[112:115]
    ds_read_b128 v[172:175], v198 offset:128
    v_mfma_f32_32x32x16_bf16 v[80:95], a[104:107], v[188:191], v[80:95]
    ds_read_b128 v[176:179], v196 offset:128
    v_mfma_f32_32x32x16_bf16 v[96:111], a[104:107], v[192:195], v[96:111]
    ds_read_b128 v[180:183], v196 offset:8832
    buffer_load_dwordx4 a[156:159], v200, s[16:19], s101 offen offset:3072 sc1
    s_waitcnt lgkmcnt(3)
    s_waitcnt vmcnt(13)
    v_mfma_f32_16x16x32_bf16 v[112:115], a[108:111], v[160:163], v[112:115]
    ds_read_b128 v[184:187], v198 offset:160
    v_mfma_f32_32x32x16_bf16 v[80:95], a[108:111], v[164:167], v[80:95]
    ds_read_b128 v[188:191], v197 offset:128
    v_mfma_f32_32x32x16_bf16 v[96:111], a[108:111], v[168:171], v[96:111]
    ds_read_b128 v[192:195], v197 offset:8832
    s_add_u32 s101, s101, 4096
    s_lshl_b32 s25, s72, 5
    s_add_u32 s25, s25, 256
    s_sub_u32 s26, s25, 4
    s_max_i32 s26, s26, 0
    s_mul_i32 s27, s71, 1280
    s_mul_i32 s99, s25, 5120
    s_mul_i32 s100, s26, 5120
    s_mul_i32 s92, s24, 4352
    s_mul_i32 s93, s24, 544
    s_add_u32 s99, s99, s27
    s_add_u32 s100, s100, s27
    s_waitcnt lgkmcnt(3)
    s_waitcnt vmcnt(12)
    v_mfma_f32_16x16x32_bf16 v[112:115], a[112:115], v[172:175], v[112:115]
    ds_read_b128 v[160:163], v198 offset:192
    v_mfma_f32_32x32x16_bf16 v[80:95], a[112:115], v[176:179], v[80:95]
    ds_read_b128 v[164:167], v196 offset:192
    v_mfma_f32_32x32x16_bf16 v[96:111], a[112:115], v[180:183], v[96:111]
    ds_read_b128 v[168:171], v196 offset:8896
    s_waitcnt lgkmcnt(3)
    s_waitcnt vmcnt(11)
    v_mfma_f32_16x16x32_bf16 v[112:115], a[116:119], v[184:187], v[112:115]
    ds_read_b128 v[172:175], v198 offset:224
    v_mfma_f32_32x32x16_bf16 v[80:95], a[116:119], v[188:191], v[80:95]
    ds_read_b128 v[176:179], v197 offset:192
    v_mfma_f32_32x32x16_bf16 v[96:111], a[116:119], v[192:195], v[96:111]
    ds_read_b128 v[180:183], v197 offset:8896
    s_waitcnt vmcnt(4)
    v_cmp_gt_u32 vcc, 32, v7
    s_nop 0
    s_and_b64 vcc, vcc, s[50:51]
    s_cbranch_scc1 ps_17
pc_19:
    s_barrier
    s_waitcnt lgkmcnt(3)
    v_mfma_f32_16x16x32_bf16 v[112:115], a[120:123], v[160:163], v[112:115]
    v_add_u32_e64 v198, v49, v198
    v_mfma_f32_32x32x16_bf16 v[80:95], a[120:123], v[164:167], v[80:95]
    v_add_u32 v196, 19584, v196
    v_add_u32 v197, 19584, v197
    s_lshl_b32 s31, s24, 7
    s_add_u32 s31, s31, 159744
    v_bfe_u32 v132, v1, 3, 1
    v_mfma_f32_32x32x16_bf16 v[96:111], a[120:123], v[168:171], v[96:111]
    ds_read_b128 v[184:187], v198 offset:0
    ds_read_b128 v[188:191], v196 offset:0
    s_lshl_b32 s98, s72, 5
    s_add_u32 s98, s98, 0
    s_sub_u32 s95, s98, 4
    s_max_i32 s95, s95, 0
    s_lshl_b32 s94, s98, 3
    s_lshl_b32 s95, s95, 3
    s_add_u32 s94, s94, 3440640
    s_add_u32 s95, s95, 3440640
    s_add_u32 s96, s94, 8192
    buffer_load_dwordx2 v[152:153], v47, s[16:19], s94 offen sc1
    v_lshrrev_b32 v133, 4, v1
    v_lshl_add_u32 v132, v132, 2, v133
    s_waitcnt lgkmcnt(2)
    v_mfma_f32_16x16x32_bf16 v[112:115], a[124:127], v[172:175], v[112:115]
    ds_read_b128 v[192:195], v198 offset:32
    v_mfma_f32_32x32x16_bf16 v[80:95], a[124:127], v[176:179], v[80:95]
    ds_read_b128 v[160:163], v197 offset:0
    v_lshl_add_u32 v132, v132, 4, s31
    v_lshrrev_b32 v133, 5, v1
    v_lshl_add_u32 v133, v133, 4, s31
    v_mfma_f32_32x32x16_bf16 v[96:111], a[124:127], v[180:183], v[96:111]
    buffer_load_dwordx2 v[154:155], v47, s[16:19], s96 offen sc1
    s_waitcnt lgkmcnt(2)
    v_mfma_f32_16x16x32_bf16 v[112:115], a[128:131], v[184:187], v[112:115]
    ds_read_b128 v[164:167], v198 offset:64
    v_mfma_f32_32x32x16_bf16 v[80:95], a[128:131], v[188:191], v[80:95]
    ds_read_b128 v[168:171], v196 offset:64
    s_waitcnt lgkmcnt(2)
    v_mfma_f32_16x16x32_bf16 v[112:115], a[132:135], v[192:195], v[112:115]
    ds_read_b128 v[172:175], v198 offset:96
    v_mfma_f32_32x32x16_bf16 v[80:95], a[132:135], v[160:163], v[80:95]
    ds_read_b128 v[176:179], v197 offset:64
    buffer_load_dwordx2 v[156:157], v48, s[16:19], s95 offen sc1
    s_waitcnt lgkmcnt(2)
    v_mfma_f32_16x16x32_bf16 v[112:115], a[136:139], v[164:167], v[112:115]
    ds_read_b128 v[180:183], v198 offset:128
    v_mfma_f32_32x32x16_bf16 v[80:95], a[136:139], v[168:171], v[80:95]
    ds_read_b128 v[184:187], v196 offset:128
    s_waitcnt lgkmcnt(2)
    v_mfma_f32_16x16x32_bf16 v[112:115], a[140:143], v[172:175], v[112:115]
    ds_read_b128 v[188:191], v198 offset:160
    v_mfma_f32_32x32x16_bf16 v[80:95], a[140:143], v[176:179], v[80:95]
    ds_read_b128 v[192:195], v197 offset:128
    s_add_u32 m0, s92, 36352
    s_nop 0
    buffer_load_dwordx4 v73, s[4:7], s99 offen offset:0  lds
    s_waitcnt lgkmcnt(2)
    s_waitcnt vmcnt(7)
    v_mfma_f32_16x16x32_bf16 v[112:115], a[144:147], v[180:183], v[112:115]
    ds_read_b128 v[160:163], v198 offset:192
    v_mfma_f32_32x32x16_bf16 v[80:95], a[144:147], v[184:187], v[80:95]
    ds_read_b128 v[164:167], v196 offset:192
    s_waitcnt lgkmcnt(2)
    s_waitcnt vmcnt(6)
    v_mfma_f32_16x16x32_bf16 v[112:115], a[148:151], v[188:191], v[112:115]
    ds_read_b128 v[168:171], v198 offset:224
    v_mfma_f32_32x32x16_bf16 v[80:95], a[148:151], v[192:195], v[80:95]
    ds_read_b128 v[172:175], v197 offset:192
    buffer_load_dwordx4 v74, s[4:7], s99 offen offset:1088  lds
    s_waitcnt lgkmcnt(2)
    s_waitcnt vmcnt(6)
    v_mfma_f32_16x16x32_bf16 v[112:115], a[152:155], v[160:163], v[112:115]
    ds_read_b128 v[176:179], v196 offset:8704
    v_mfma_f32_32x32x16_bf16 v[80:95], a[152:155], v[164:167], v[80:95]
    ds_read_b128 v[180:183], v197 offset:8704
    s_waitcnt lgkmcnt(2)
    s_waitcnt vmcnt(5)
    v_mfma_f32_16x16x32_bf16 v[112:115], a[156:159], v[168:171], v[112:115]
    ds_read_b128 v[184:187], v196 offset:8768
    v_mfma_f32_32x32x16_bf16 v[80:95], a[156:159], v[172:175], v[80:95]
    ds_read_b128 v[188:191], v197 offset:8768
    buffer_load_dwordx4 v75, s[4:7], s99 offen offset:2176  lds
    s_waitcnt lgkmcnt(2)
    v_mfma_f32_32x32x16_bf16 v[96:111], a[128:131], v[176:179], v[96:111]
    ds_read_b128 v[192:195], v196 offset:8832
    v_mfma_f32_32x32x16_bf16 v[96:111], a[132:135], v[180:183], v[96:111]
    ds_read_b128 v[160:163], v197 offset:8832
    buffer_load_dwordx4 v76, s[4:7], s99 offen offset:3264  lds
    s_mov_b32 exec_lo, 0x01010101
    s_mov_b32 exec_hi, 0x01010101
    ds_write_b128 v132, v[112:115]
    s_mov_b64 exec, -1
    s_waitcnt lgkmcnt(3)
    v_mfma_f32_32x32x16_bf16 v[96:111], a[136:139], v[184:187], v[96:111]
    ds_read_b128 v[164:167], v196 offset:8896
    ds_read_b128 v[24:27], v132
    ds_read_b128 v[8:11], v133 offset:0
    ds_read_b128 v[12:15], v133 offset:32
    ds_read_b128 v[16:19], v133 offset:64
    v_mfma_f32_32x32x16_bf16 v[96:111], a[140:143], v[188:191], v[96:111]
    ds_read_b128 v[168:171], v197 offset:8896
    s_add_u32 m0, s93, 53760
    s_add_u32 s99, s99, 256
    s_mov_b64 exec, s[80:81]
    buffer_load_dwordx4 v77, s[4:7], s100 offen  lds
    s_mov_b64 exec, -1
    s_add_u32 s100, s100, 256
    ds_read_b128 v[20:23], v133 offset:96
    s_waitcnt vmcnt(5) lgkmcnt(5)
    v_mul_f32 v148, v24, v157
    v_mfma_f32_32x32x16_bf16 v[96:111], a[144:147], v[192:195], v[96:111]
    v_mul_f32 v149, v25, v157
    v_mul_f32 v150, v26, v157
    v_mul_f32 v151, v27, v157
    s_waitcnt lgkmcnt(4)
    v_mul_f32 v116, v8, v153
    v_mul_f32 v117, v9, v153
    v_mfma_f32_32x32x16_bf16 v[96:111], a[148:151], v[160:163], v[96:111]
    v_mul_f32 v118, v10, v153
    v_mul_f32 v119, v11, v153
    s_waitcnt lgkmcnt(3)
    v_mul_f32 v120, v12, v153
    v_mul_f32 v121, v13, v153
    s_waitcnt lgkmcnt(1)
    v_mfma_f32_32x32x16_bf16 v[96:111], a[152:155], v[164:167], v[96:111]
    v_mul_f32 v122, v14, v153
    v_mul_f32 v123, v15, v153
    v_mul_f32 v124, v16, v153
    v_mul_f32 v125, v17, v153
    v_mul_f32_e64 v126, v18, v153
    v_mfma_f32_32x32x16_bf16 v[96:111], a[156:159], v[168:171], v[96:111]
    s_add_u32 m0, s92, 55936
    s_nop 0
    buffer_load_dwordx4 v73, s[4:7], s99 offen offset:0  lds
    v_mul_f32 v127, v19, v153
    s_waitcnt lgkmcnt(0)
    v_mul_f32 v128, v20, v153
    v_mul_f32 v129, v21, v153
    v_mul_f32 v130, v22, v153
    v_mul_f32_e64 v131, v23, v153
    v_fma_f32 v112, v112, v156, v148
    v_fma_f32 v113, v113, v156, v149
    v_fma_f32 v114, v114, v156, v150
    v_fma_f32 v115, v115, v156, v151
    v_cvt_pk_bf16_f32 v112, v112, v113
    v_cvt_pk_bf16_f32 v113, v114, v115
    v_fma_f32 v80, v80, v152, v116
    v_fma_f32 v81, v81, v152, v117
    v_fma_f32 v82, v82, v152, v118
    v_fma_f32 v83, v83, v152, v119
    v_cvt_pk_bf16_f32 v80, v80, v81
    v_cvt_pk_bf16_f32 v81, v82, v83
    ds_write_b64 v40, v[112:113] offset:0
    ds_write_b64 v38, v[80:81] offset:0
    v_fma_f32 v84, v84, v152, v120
    v_fma_f32 v85, v85, v152, v121
    v_fma_f32 v86, v86, v152, v122
    v_fma_f32 v87, v87, v152, v123
    v_cvt_pk_bf16_f32 v84, v84, v85
    v_cvt_pk_bf16_f32 v85, v86, v87
    v_fma_f32 v88, v88, v152, v124
    v_fma_f32 v89, v89, v152, v125
    v_fma_f32 v90, v90, v152, v126
    v_fma_f32 v91, v91, v152, v127
    v_cvt_pk_bf16_f32 v88, v88, v89
    v_cvt_pk_bf16_f32 v89, v90, v91
    ds_write_b64 v38, v[84:85] offset:6400
    ds_write_b64 v38, v[88:89] offset:12800
    v_fma_f32 v92, v92, v152, v128
    v_fma_f32 v93, v93, v152, v129
    v_fma_f32 v94, v94, v152, v130
    v_fma_f32 v95, v95, v152, v131
    v_cvt_pk_bf16_f32 v92, v92, v93
    v_cvt_pk_bf16_f32 v93, v94, v95
    ds_write_b64 v39, v[92:93] offset:0
    v_mul_f32 v132, v8, v155
    v_mul_f32 v133, v9, v155
    v_mul_f32 v134, v10, v155
    v_mul_f32 v135, v11, v155
    v_mul_f32 v136, v12, v155
    v_mul_f32 v137, v13, v155
    v_mul_f32 v138, v14, v155
    v_mul_f32 v139, v15, v155
    v_mul_f32 v140, v16, v155
    v_mul_f32 v141, v17, v155
    v_mul_f32 v142, v18, v155
    v_mul_f32 v143, v19, v155
    v_mul_f32 v144, v20, v155
    v_mul_f32 v145, v21, v155
    v_mul_f32 v146, v22, v155
    v_mul_f32 v147, v23, v155
    v_pk_fma_f32 v[96:97], v[96:97], v[154:155], v[132:133] op_sel_hi:[1,0,1]
    v_pk_fma_f32 v[98:99], v[98:99], v[154:155], v[134:135] op_sel_hi:[1,0,1]
    v_cvt_pk_bf16_f32 v96, v96, v97
    v_cvt_pk_bf16_f32 v97, v98, v99
    v_pk_fma_f32 v[100:101], v[100:101], v[154:155], v[136:137] op_sel_hi:[1,0,1]
    v_pk_fma_f32 v[102:103], v[102:103], v[154:155], v[138:139] op_sel_hi:[1,0,1]
    v_cvt_pk_bf16_f32 v100, v100, v101
    v_cvt_pk_bf16_f32 v101, v102, v103
    ds_write_b64 v38, v[96:97] offset:1600
    ds_write_b64 v38, v[100:101] offset:8000
    v_pk_fma_f32 v[104:105], v[104:105], v[154:155], v[140:141] op_sel_hi:[1,0,1]
    v_pk_fma_f32 v[106:107], v[106:107], v[154:155], v[142:143] op_sel_hi:[1,0,1]
    v_cvt_pk_bf16_f32 v104, v104, v105
    v_cvt_pk_bf16_f32 v105, v106, v107
    v_pk_fma_f32 v[108:109], v[108:109], v[154:155], v[144:145] op_sel_hi:[1,0,1]
    v_pk_fma_f32 v[110:111], v[110:111], v[154:155], v[146:147] op_sel_hi:[1,0,1]
    v_cvt_pk_bf16_f32 v108, v108, v109
    v_cvt_pk_bf16_f32 v109, v110, v111
    ds_write_b64 v38, v[104:105] offset:14400
    ds_write_b64 v39, v[108:109] offset:1600
    s_waitcnt lgkmcnt(0)
    s_barrier
    v_mov_b32 v94, 0
    v_mov_b32 v95, 0
    v_mov_b32 v98, 0
    v_mov_b32 v99, 0
    s_mov_b64 exec, 0xffff
    ds_read_b64 v[94:95], v42 offset:320
    ds_read_b64 v[98:99], v42 offset:640
    s_mov_b64 exec, -1
    s_nop 0
    ds_read_b64 v[92:93], v41 offset:320
    ds_read_b64 v[96:97], v41 offset:640
    ds_read_b64 v[84:85], v41 offset:6720
    ds_read_b64 v[86:87], v42 offset:6720
    ds_read_b64 v[80:81], v41 offset:6400
    ds_read_b64 v[82:83], v42 offset:6400
    ds_read_b64 v[88:89], v41 offset:7040
    ds_read_b64 v[90:91], v42 offset:7040
    ds_read_b64_tr_b16 v[106:107], v44 offset:0
    ds_read_b64_tr_b16 v[100:101], v43 offset:0
    ds_read_b64_tr_b16 v[108:109], v44 offset:320
    ds_read_b64_tr_b16 v[102:103], v43 offset:320
    buffer_load_dwordx4 v74, s[4:7], s99 offen offset:1088  lds
    ds_read_b64_tr_b16 v[110:111], v44 offset:640
    ds_read_b64_tr_b16 v[104:105], v43 offset:640
    v_mov_b32 v156, 0xf149f2ca
    v_cndmask_b32 v152, v32, v156, s[90:91]
    v_cndmask_b32 v153, v33, v156, s[90:91]
    v_cndmask_b32 v154, v34, v156, s[90:91]
    v_cndmask_b32 v155, v35, v156, s[90:91]
    s_mov_b32 s82, 0x3ea52b5c
    buffer_load_dwordx4 v75, s[4:7], s99 offen offset:2176  lds
    s_lshl_b32 s25, s98, 4
    s_add_u32 s25, s25, 4194304
    s_lshl_b32 s26, s98, 3
    s_add_u32 s26, s26, 4194304
    s_waitcnt lgkmcnt(10)
    v_mfma_f32_16x16x32_bf16 v[116:119], v[84:87], v[92:95], v[28:31]
    v_mfma_f32_16x16x32_bf16 v[120:123], v[84:87], v[96:99], v[32:35]
    s_waitcnt lgkmcnt(8)
    v_mfma_f32_16x16x32_bf16 v[112:115], v[80:83], v[92:95], v[152:155]
    s_waitcnt lgkmcnt(6)
    v_mfma_f32_16x16x32_bf16 v[124:127], v[88:91], v[96:99], v[28:31]
    buffer_load_dwordx4 v76, s[4:7], s99 offen offset:3264  lds
    s_nop 4
    v_max_f32 v112, v112, v116
    v_max_f32 v113, v113, v117
    v_max_f32 v114, v114, v118
    v_max_f32 v115, v115, v119
    v_max3_f32 v156, v112, v113, v114
    v_max_f32 v156, v156, v115
    v_max_f32 v120, v120, v124
    v_max_f32_e64 v121, v121, v125
    s_add_u32 m0, s93, 73344
    s_add_u32 s99, s99, 256
    s_mov_b64 exec, s[80:81]
    buffer_load_dwordx4 v77, s[4:7], s100 offen  lds
    s_mov_b64 exec, -1
    s_add_u32 s100, s100, 256
    v_max_f32 v122, v122, v126
    v_max_f32 v123, v123, v127
    v_max3_f32 v157, v120, v121, v122
    v_max_f32 v157, v157, v123
    s_nop 1
    v_permlane16_swap_b32 v156, v157
    v_max_f32 v156, v156, v157
    v_mov_b32 v157, v156
    s_nop 1
    v_permlane32_swap_b32 v156, v157
    s_add_u32 m0, s92, 75520
    s_nop 0
    buffer_load_dwordx4 v73, s[4:7], s99 offen offset:0  lds
    v_max_f32 v156, v156, v157
    v_mul_f32 v156, s82, v156
    v_mov_b32 v157, v156
    s_nop 1
    v_permlane16_swap_b32_e64 v156, v157
    v_fma_f32 v112, v112, s82, -v156
    v_fma_f32 v113, v113, s82, -v156
    v_fma_f32 v114, v114, s82, -v156
    v_fma_f32 v115, v115, s82, -v156
    buffer_load_dwordx4 v74, s[4:7], s99 offen offset:1088  lds
    v_exp_f32 v112, v112
    v_exp_f32 v113, v113
    v_exp_f32 v114, v114
    v_exp_f32 v115, v115
    v_cvt_pk_bf16_f32 v116, v112, v113
    v_cvt_pk_bf16_f32 v117, v114, v115
    v_bfi_b32 v128, v36, 0, v116
    v_and_b32_e64 v130, v36, v116
    buffer_load_dwordx4 v75, s[4:7], s99 offen offset:2176  lds
    v_bfi_b32 v129, v37, 0, v117
    v_and_b32 v131, v37, v117
    s_waitcnt lgkmcnt(3)
    s_nop 0
    v_mfma_f32_16x16x32_bf16 v[144:147], v[106:109], v[128:131], 0
    s_waitcnt lgkmcnt(2)
    v_mfma_f32_16x16x32_bf16 v[136:139], v[100:103], v[128:131], 0
    v_fma_f32 v120, v120, s82, -v157
    v_fma_f32 v121, v121, s82, -v157
    v_fma_f32 v122, v122, s82, -v157
    v_fma_f32 v123, v123, s82, -v157
    buffer_load_dwordx4 v76, s[4:7], s99 offen offset:3264  lds
    v_exp_f32 v120, v120
    v_exp_f32 v121, v121
    v_exp_f32 v122, v122
    v_exp_f32 v123, v123
    v_cvt_pk_bf16_f32 v124, v120, v121
    v_cvt_pk_bf16_f32 v125, v122, v123
    v_bfi_b32 v132, v36, 0, v124
    v_and_b32_e64 v134, v36, v124
    s_add_u32 m0, s93, 92928
    s_add_u32 s99, s99, 256
    s_mov_b64 exec, s[80:81]
    buffer_load_dwordx4 v77, s[4:7], s100 offen  lds
    s_mov_b64 exec, -1
    s_add_u32 s100, s100, 256
    v_bfi_b32 v133, v37, 0, v125
    v_and_b32 v135, v37, v125
    s_waitcnt lgkmcnt(1)
    s_nop 0
    v_mfma_f32_16x16x32_bf16 v[148:151], v[108:111], v[132:135], 0
    s_waitcnt lgkmcnt(0)
    v_mfma_f32_16x16x32_bf16 v[140:143], v[102:105], v[132:135], 0
    v_mov_b32 v158, v144
    s_nop 1
    v_permlane16_swap_b32 v144, v158
    v_rcp_f32 v158, v158
    s_nop 0
    v_pk_mul_f32 v[136:137], v[136:137], v[158:159] op_sel_hi:[1,0]
    s_lshl_b32 s97, s73, 2
    s_add_u32 s97, s97, s24
    s_nop 0
    s_mul_i32 s97, s97, 25600
    s_add_u32 s97, s97, 2621440
    buffer_load_dwordx4 a[160:163], v58, s[16:19], s97 offen offset:0 sc1
    v_pk_mul_f32 v[138:139], v[138:139], v[158:159] op_sel_hi:[1,0]
    v_pk_mul_f32 v[144:145], v[144:145], v[158:159] op_sel_hi:[1,0]
    v_pk_mul_f32 v[146:147], v[146:147], v[158:159] op_sel_hi:[1,0]
    v_cvt_pk_bf16_f32 v112, v136, v137
    v_cvt_pk_bf16_f32 v116, v144, v145
    v_cvt_pk_bf16_f32 v113, v138, v139
    v_cvt_pk_bf16_f32 v117, v146, v147
    v_mov_b32 v160, v148
    buffer_load_dwordx4 a[164:167], v58, s[16:19], s97 offen offset:1024 sc1
    s_nop 0
    v_permlane16_swap_b32 v148, v160
    v_rcp_f32_e64 v160, v160
    s_nop 0
    v_pk_mul_f32 v[140:141], v[140:141], v[160:161] op_sel_hi:[1,0]
    v_pk_mul_f32 v[142:143], v[142:143], v[160:161] op_sel_hi:[1,0]
    v_pk_mul_f32 v[148:149], v[148:149], v[160:161] op_sel_hi:[1,0]
    v_pk_mul_f32 v[150:151], v[150:151], v[160:161] op_sel_hi:[1,0]
    v_cvt_pk_bf16_f32 v114, v140, v141
    v_cvt_pk_bf16_f32 v118, v148, v149
    buffer_load_dwordx4 a[168:171], v58, s[16:19], s97 offen offset:2048 sc1
    v_cvt_pk_bf16_f32 v115, v142, v143
    v_cvt_pk_bf16_f32 v119, v150, v151
    v_permlane16_swap_b32 v112, v114
    v_permlane16_swap_b32 v113, v115
    v_permlane16_swap_b32 v116, v118
    v_permlane16_swap_b32 v117, v119
    buffer_store_dwordx4 v[112:115], v45, s[16:19], s25 offen sc1
    s_mov_b64 exec, s[80:81]
    buffer_store_dwordx2 v[116:117], v46, s[16:19], s26 offen sc1
    s_mov_b64 exec, -1
    buffer_load_dwordx4 a[172:175], v58, s[16:19], s97 offen offset:3072 sc1
    s_add_u32 s97, s97, 4096
    buffer_load_dwordx4 a[176:179], v58, s[16:19], s97 offen offset:0 sc1
    v_add_u32 v196, 36352, v78
    v_mov_b32 v198, v79
    v_xor_b32 v197, 32, v196
    s_waitcnt vmcnt(17)
    s_barrier
    ds_read_b128 v[160:163], v198 offset:0
    ds_read_b128 v[164:167], v196 offset:0
    ds_read_b128 v[168:171], v196 offset:8704
    ds_read_b128 v[172:175], v198 offset:32
    ds_read_b128 v[176:179], v197 offset:0
    ds_read_b128 v[180:183], v197 offset:8704
    s_waitcnt lgkmcnt(3)
    v_mfma_f32_16x16x32_bf16 v[112:115], a[0:3], v[160:163], 0
    ds_read_b128 v[184:187], v198 offset:64
    v_mfma_f32_32x32x16_bf16 v[80:95], a[0:3], v[164:167], 0
    ds_read_b128 v[188:191], v196 offset:64
    v_mfma_f32_32x32x16_bf16 v[96:111], a[0:3], v[168:171], 0
    ds_read_b128 v[192:195], v196 offset:8768
    s_add_u32 m0, s92, 95104
    s_nop 0
    buffer_load_dwordx4 v73, s[4:7], s99 offen offset:0  lds
    s_waitcnt lgkmcnt(3)
    v_mfma_f32_16x16x32_bf16 v[112:115], a[4:7], v[172:175], v[112:115]
    ds_read_b128 v[160:163], v198 offset:96
    v_mfma_f32_32x32x16_bf16 v[80:95], a[4:7], v[176:179], v[80:95]
    ds_read_b128 v[164:167], v197 offset:64
    v_mfma_f32_32x32x16_bf16 v[96:111], a[4:7], v[180:183], v[96:111]
    ds_read_b128 v[168:171], v197 offset:8768
    buffer_load_dwordx4 v74, s[4:7], s99 offen offset:1088  lds
    s_waitcnt lgkmcnt(3)
    v_mfma_f32_16x16x32_bf16 v[112:115], a[8:11], v[184:187], v[112:115]
    ds_read_b128 v[172:175], v198 offset:128
    v_mfma_f32_32x32x16_bf16 v[80:95], a[8:11], v[188:191], v[80:95]
    ds_read_b128 v[176:179], v196 offset:128
    v_mfma_f32_32x32x16_bf16 v[96:111], a[8:11], v[192:195], v[96:111]
    ds_read_b128 v[180:183], v196 offset:8832
    buffer_load_dwordx4 v75, s[4:7], s99 offen offset:2176  lds
    s_waitcnt lgkmcnt(3)
    v_mfma_f32_16x16x32_bf16 v[112:115], a[12:15], v[160:163], v[112:115]
    ds_read_b128 v[184:187], v198 offset:160
    v_mfma_f32_32x32x16_bf16 v[80:95], a[12:15], v[164:167], v[80:95]
    ds_read_b128 v[188:191], v197 offset:128
    v_mfma_f32_32x32x16_bf16 v[96:111], a[12:15], v[168:171], v[96:111]
    ds_read_b128 v[192:195], v197 offset:8832
    buffer_load_dwordx4 v76, s[4:7], s99 offen offset:3264  lds
    s_waitcnt lgkmcnt(3)
    v_mfma_f32_16x16x32_bf16 v[112:115], a[16:19], v[172:175], v[112:115]
    ds_read_b128 v[160:163], v198 offset:192
    v_mfma_f32_32x32x16_bf16 v[80:95], a[16:19], v[176:179], v[80:95]
    ds_read_b128 v[164:167], v196 offset:192
    v_mfma_f32_32x32x16_bf16 v[96:111], a[16:19], v[180:183], v[96:111]
    ds_read_b128 v[168:171], v196 offset:8896
    s_add_u32 m0, s93, 112512
    s_add_u32 s99, s99, 256
    s_mov_b64 exec, s[80:81]
    buffer_load_dwordx4 v77, s[4:7], s100 offen  lds
    s_mov_b64 exec, -1
    s_add_u32 s100, s100, 256
    s_waitcnt lgkmcnt(3)
    v_mfma_f32_16x16x32_bf16 v[112:115], a[20:23], v[184:187], v[112:115]
    ds_read_b128 v[172:175], v198 offset:224
    v_mfma_f32_32x32x16_bf16 v[80:95], a[20:23], v[188:191], v[80:95]
    ds_read_b128 v[176:179], v197 offset:192
    v_mfma_f32_32x32x16_bf16 v[96:111], a[20:23], v[192:195], v[96:111]
    ds_read_b128 v[180:183], v197 offset:8896
    s_add_u32 m0, s92, 114688
    s_nop 0
    buffer_load_dwordx4 v73, s[4:7], s99 offen offset:0  lds
    s_waitcnt vmcnt(18)
    s_barrier
    s_waitcnt lgkmcnt(3)
    v_mfma_f32_16x16x32_bf16 v[112:115], a[24:27], v[160:163], v[112:115]
    v_add_u32 v198, v49, v198
    v_mfma_f32_32x32x16_bf16 v[80:95], a[24:27], v[164:167], v[80:95]
    v_add_u32 v196, 19584, v196
    v_add_u32 v197, 19584, v197
    ds_read_b128 v[184:187], v198 offset:0
    v_mfma_f32_32x32x16_bf16 v[96:111], a[24:27], v[168:171], v[96:111]
    ds_read_b128 v[188:191], v196 offset:0
    ds_read_b128 v[192:195], v196 offset:8704
    buffer_load_dwordx4 v74, s[4:7], s99 offen offset:1088  lds
    s_waitcnt lgkmcnt(3)
    v_mfma_f32_16x16x32_bf16 v[112:115], a[28:31], v[172:175], v[112:115]
    ds_read_b128 v[160:163], v198 offset:32
    v_mfma_f32_32x32x16_bf16 v[80:95], a[28:31], v[176:179], v[80:95]
    ds_read_b128 v[164:167], v197 offset:0
    v_mfma_f32_32x32x16_bf16 v[96:111], a[28:31], v[180:183], v[96:111]
    ds_read_b128 v[168:171], v197 offset:8704
    buffer_load_dwordx4 v75, s[4:7], s99 offen offset:2176  lds
    s_waitcnt lgkmcnt(3)
    v_mfma_f32_16x16x32_bf16 v[112:115], a[32:35], v[184:187], v[112:115]
    ds_read_b128 v[172:175], v198 offset:64
    v_mfma_f32_32x32x16_bf16 v[80:95], a[32:35], v[188:191], v[80:95]
    ds_read_b128 v[176:179], v196 offset:64
    v_mfma_f32_32x32x16_bf16 v[96:111], a[32:35], v[192:195], v[96:111]
    ds_read_b128 v[180:183], v196 offset:8768
    buffer_load_dwordx4 v76, s[4:7], s99 offen offset:3264  lds
    s_waitcnt lgkmcnt(3)
    v_mfma_f32_16x16x32_bf16 v[112:115], a[36:39], v[160:163], v[112:115]
    ds_read_b128 v[184:187], v198 offset:96
    v_mfma_f32_32x32x16_bf16 v[80:95], a[36:39], v[164:167], v[80:95]
    ds_read_b128 v[188:191], v197 offset:64
    v_mfma_f32_32x32x16_bf16 v[96:111], a[36:39], v[168:171], v[96:111]
    ds_read_b128 v[192:195], v197 offset:8768
    s_add_u32 m0, s93, 132096
    s_add_u32 s99, s99, 256
    s_mov_b64 exec, s[80:81]
    buffer_load_dwordx4 v77, s[4:7], s100 offen  lds
    s_mov_b64 exec, -1
    s_add_u32 s100, s100, 256
    s_waitcnt lgkmcnt(3)
    v_mfma_f32_16x16x32_bf16 v[112:115], a[40:43], v[172:175], v[112:115]
    ds_read_b128 v[160:163], v198 offset:128
    v_mfma_f32_32x32x16_bf16 v[80:95], a[40:43], v[176:179], v[80:95]
    ds_read_b128 v[164:167], v196 offset:128
    s_lshl_b32 s25, s24, 6
    s_and_b32 s35, s74, 3
    s_lshl_b32 s35, s35, 13
    s_add_u32 s35, s35, s25
    v_mfma_f32_32x32x16_bf16 v[96:111], a[40:43], v[180:183], v[96:111]
    ds_read_b128 v[168:171], v196 offset:8832
    s_lshl_b32 s98, s72, 5
    s_add_u32 s98, s98, 256
    s_sub_u32 s95, s98, 4
    s_max_i32 s95, s95, 0
    s_lshl_b32 s94, s98, 3
    s_lshl_b32 s95, s95, 3
    s_add_u32 s94, s94, 3440640
    s_add_u32 s95, s95, 3440640
    s_add_u32 s96, s94, 8192
    buffer_load_dwordx2 v[152:153], v47, s[16:19], s94 offen sc1
    s_waitcnt lgkmcnt(3)
    v_mfma_f32_16x16x32_bf16 v[112:115], a[44:47], v[184:187], v[112:115]
    ds_read_b128 v[172:175], v198 offset:160
    v_mfma_f32_32x32x16_bf16 v[80:95], a[44:47], v[188:191], v[80:95]
    ds_read_b128 v[176:179], v197 offset:128
    s_lshr_b32 s25, s74, 4
    s_lshl_b32 s25, s25, 11
    s_add_u32 s35, s35, s25
    s_and_b32 s25, s74, 12
    v_mfma_f32_32x32x16_bf16 v[96:111], a[44:47], v[192:195], v[96:111]
    ds_read_b128 v[180:183], v197 offset:8832
    buffer_load_dwordx2 v[154:155], v47, s[16:19], s96 offen sc1
    s_lshl_b32 s25, s25, 6
    s_add_u32 s35, s35, s25
    s_waitcnt lgkmcnt(3)
    v_mfma_f32_16x16x32_bf16 v[112:115], a[48:51], v[160:163], v[112:115]
    ds_read_b128 v[184:187], v198 offset:192
    v_mfma_f32_32x32x16_bf16 v[80:95], a[48:51], v[164:167], v[80:95]
    ds_read_b128 v[188:191], v196 offset:192
    s_mul_i32 s36, s73, 20
    s_add_u32 s36, s36, s24
    s_add_u32 s36, s36, 16
    s_lshl_b32 s36, s36, 14
    v_mfma_f32_32x32x16_bf16 v[96:111], a[48:51], v[168:171], v[96:111]
    ds_read_b128 v[192:195], v196 offset:8896
    buffer_load_dwordx2 v[156:157], v48, s[16:19], s95 offen sc1
    v_add_u32 v199, 36352, v58
    s_lshl_b32 s32, s24, 11
    s_waitcnt lgkmcnt(3)
    v_mfma_f32_16x16x32_bf16 v[112:115], a[52:55], v[172:175], v[112:115]
    ds_read_b128 v[160:163], v198 offset:224
    v_mfma_f32_32x32x16_bf16 v[80:95], a[52:55], v[176:179], v[80:95]
    ds_read_b128 v[164:167], v197 offset:192
    v_add_u32 v203, s32, v199
    s_add_u32 s32, s24, 1
    s_and_b32 s32, s32, 3
    s_mul_i32 s32, s32, 6144
    v_mfma_f32_32x32x16_bf16 v[96:111], a[52:55], v[180:183], v[96:111]
    ds_read_b128 v[168:171], v197 offset:8896
    buffer_load_dwordx4 a[180:183], v58, s[16:19], s97 offen offset:1024 sc1
    v_add_u32 v200, s32, v199
    s_add_u32 s32, s24, 2
    s_waitcnt vmcnt(21)
    s_barrier
    s_waitcnt lgkmcnt(3)
    v_mfma_f32_16x16x32_bf16 v[112:115], a[56:59], v[184:187], v[112:115]
    v_add_u32 v198, v49, v198
    v_mfma_f32_32x32x16_bf16 v[80:95], a[56:59], v[188:191], v[80:95]
    v_add_u32 v196, 19584, v196
    v_add_u32 v197, 19584, v197
    ds_read_b128 v[172:175], v198 offset:0
    s_and_b32 s32, s32, 3
    s_mul_i32 s32, s32, 6144
    v_mfma_f32_32x32x16_bf16 v[96:111], a[56:59], v[192:195], v[96:111]
    ds_read_b128 v[176:179], v196 offset:0
    ds_read_b128 v[180:183], v196 offset:8704
    buffer_load_dwordx4 a[184:187], v58, s[16:19], s97 offen offset:2048 sc1
    v_add_u32_e64 v201, s32, v199
    s_waitcnt lgkmcnt(3)
    v_mfma_f32_16x16x32_bf16 v[112:115], a[60:63], v[160:163], v[112:115]
    ds_read_b128 v[184:187], v198 offset:32
    v_mfma_f32_32x32x16_bf16 v[80:95], a[60:63], v[164:167], v[80:95]
    ds_read_b128 v[188:191], v197 offset:0
    s_add_u32 s32, s24, 3
    s_and_b32 s32, s32, 3
    s_mul_i32 s32, s32, 6144
    v_add_u32_e64 v202, s32, v199
    v_mfma_f32_32x32x16_bf16 v[96:111], a[60:63], v[168:171], v[96:111]
    ds_read_b128 v[192:195], v197 offset:8704
    buffer_load_dwordx4 a[188:191], v58, s[16:19], s97 offen offset:3072 sc1
    s_mul_i32 s32, s24, 6144
    v_add_u32 v204, s32, v199
    s_waitcnt lgkmcnt(3)
    v_mfma_f32_16x16x32_bf16 v[112:115], a[64:67], v[172:175], v[112:115]
    ds_read_b128 v[160:163], v198 offset:64
    v_mfma_f32_32x32x16_bf16 v[80:95], a[64:67], v[176:179], v[80:95]
    ds_read_b128 v[164:167], v196 offset:64
    s_lshl_b32 s32, s24, 8
    s_add_u32 s32, s32, 36352
    v_and_b32 v214, 15, v1
    v_lshl_add_u32 v206, v214, 4, s32
    v_mfma_f32_32x32x16_bf16 v[96:111], a[64:67], v[180:183], v[96:111]
    ds_read_b128 v[168:171], v196 offset:8768
    s_add_u32 s97, s97, 4096
    buffer_load_dwordx4 a[192:195], v58, s[16:19], s97 offen offset:0 sc1
    v_lshrrev_b32 v215, 5, v1
    s_waitcnt lgkmcnt(3)
    v_mfma_f32_16x16x32_bf16 v[112:115], a[68:71], v[184:187], v[112:115]
    ds_read_b128 v[172:175], v198 offset:96
    v_mfma_f32_32x32x16_bf16 v[80:95], a[68:71], v[188:191], v[80:95]
    ds_read_b128 v[176:179], v197 offset:64
    v_lshl_add_u32 v205, v215, 10, v206
    v_bfe_u32 v215, v1, 4, 1
    v_lshl_add_u32 v205, v215, 3, v205
    v_lshlrev_b32_e64 v214, 2, v214
    v_mfma_f32_32x32x16_bf16 v[96:111], a[68:71], v[192:195], v[96:111]
    ds_read_b128 v[180:183], v197 offset:8768
    buffer_load_dwordx4 a[196:199], v58, s[16:19], s97 offen offset:1024 sc1
    v_lshl_add_u32 v214, v215, 10, v214
    s_lshl_b32 s32, s24, 6
    s_waitcnt lgkmcnt(3)
    v_mfma_f32_16x16x32_bf16 v[112:115], a[72:75], v[160:163], v[112:115]
    ds_read_b128 v[184:187], v198 offset:128
    v_mfma_f32_32x32x16_bf16 v[80:95], a[72:75], v[164:167], v[80:95]
    ds_read_b128 v[188:191], v196 offset:128
    v_lshl_add_u32 v207, v215, 3, s32
    v_and_b32 v215, 12, v1
    v_lshl_add_u32 v207, v215, 2, v207
    v_and_b32 v215, 2, v1
    v_mfma_f32_32x32x16_bf16 v[96:111], a[72:75], v[168:171], v[96:111]
    ds_read_b128 v[192:195], v196 offset:8832
    buffer_load_dwordx4 a[200:203], v58, s[16:19], s97 offen offset:2048 sc1
    v_lshl_add_u32 v207, v215, 1, v207
    v_add_u32 v207, 69120, v207
    s_waitcnt lgkmcnt(3)
    v_mfma_f32_16x16x32_bf16 v[112:115], a[76:79], v[172:175], v[112:115]
    ds_read_b128 v[160:163], v198 offset:160
    v_mfma_f32_32x32x16_bf16 v[80:95], a[76:79], v[176:179], v[80:95]
    ds_read_b128 v[164:167], v197 offset:128
    v_lshrrev_b32 v215, 4, v1
    v_lshl_add_u32 v206, v215, 2, v206
    v_mov_b32 v215, 0x3f803f80
    v_mfma_f32_32x32x16_bf16 v[96:111], a[76:79], v[180:183], v[96:111]
    ds_read_b128 v[168:171], v197 offset:8832
    buffer_load_dwordx4 a[204:207], v58, s[16:19], s97 offen offset:3072 sc1
    s_waitcnt lgkmcnt(3)
    v_mfma_f32_16x16x32_bf16 v[112:115], a[80:83], v[184:187], v[112:115]
    ds_read_b128 v[172:175], v198 offset:192
    v_mfma_f32_32x32x16_bf16 v[80:95], a[80:83], v[188:191], v[80:95]
    ds_read_b128 v[176:179], v196 offset:192
    v_mfma_f32_32x32x16_bf16 v[96:111], a[80:83], v[192:195], v[96:111]
    ds_read_b128 v[180:183], v196 offset:8896
    s_add_u32 s97, s97, 4096
    buffer_load_dwordx4 a[208:211], v58, s[16:19], s97 offen offset:0 sc1
    s_waitcnt lgkmcnt(3)
    v_mfma_f32_16x16x32_bf16 v[112:115], a[84:87], v[160:163], v[112:115]
    ds_read_b128 v[184:187], v198 offset:224
    v_mfma_f32_32x32x16_bf16 v[80:95], a[84:87], v[164:167], v[80:95]
    ds_read_b128 v[188:191], v197 offset:192
    v_mfma_f32_32x32x16_bf16 v[96:111], a[84:87], v[168:171], v[96:111]
    ds_read_b128 v[192:195], v197 offset:8896
    buffer_load_dwordx4 a[212:215], v58, s[16:19], s97 offen offset:1024 sc1
    s_waitcnt vmcnt(17)
    s_barrier
    s_waitcnt lgkmcnt(3)
    v_mfma_f32_16x16x32_bf16 v[112:115], a[88:91], v[172:175], v[112:115]
    v_add_u32 v198, v49, v198
    v_mfma_f32_32x32x16_bf16 v[80:95], a[88:91], v[176:179], v[80:95]
    v_add_u32 v196, 19584, v196
    v_add_u32 v197, 19584, v197
    ds_read_b128 v[160:163], v198 offset:0
    v_mfma_f32_32x32x16_bf16 v[96:111], a[88:91], v[180:183], v[96:111]
    ds_read_b128 v[164:167], v196 offset:0
    ds_read_b128 v[168:171], v196 offset:8704
    buffer_load_dwordx4 a[216:219], v58, s[16:19], s97 offen offset:2048 sc1
    s_waitcnt lgkmcnt(3)
    v_mfma_f32_16x16x32_bf16 v[112:115], a[92:95], v[184:187], v[112:115]
    ds_read_b128 v[172:175], v198 offset:32
    v_mfma_f32_32x32x16_bf16 v[80:95], a[92:95], v[188:191], v[80:95]
    ds_read_b128 v[176:179], v197 offset:0
    v_mfma_f32_32x32x16_bf16 v[96:111], a[92:95], v[192:195], v[96:111]
    ds_read_b128 v[180:183], v197 offset:8704
    buffer_load_dwordx4 a[220:223], v58, s[16:19], s97 offen offset:3072 sc1
    s_waitcnt lgkmcnt(3)
    v_mfma_f32_16x16x32_bf16 v[112:115], a[96:99], v[160:163], v[112:115]
    ds_read_b128 v[184:187], v198 offset:64
    v_mfma_f32_32x32x16_bf16 v[80:95], a[96:99], v[164:167], v[80:95]
    ds_read_b128 v[188:191], v196 offset:64
    v_mfma_f32_32x32x16_bf16 v[96:111], a[96:99], v[168:171], v[96:111]
    ds_read_b128 v[192:195], v196 offset:8768
    s_add_u32 s97, s97, 4096
    buffer_load_dwordx4 a[224:227], v58, s[16:19], s97 offen offset:0 sc1
    s_waitcnt lgkmcnt(3)
    v_mfma_f32_16x16x32_bf16 v[112:115], a[100:103], v[172:175], v[112:115]
    ds_read_b128 v[160:163], v198 offset:96
    v_mfma_f32_32x32x16_bf16 v[80:95], a[100:103], v[176:179], v[80:95]
    ds_read_b128 v[164:167], v197 offset:64
    v_mfma_f32_32x32x16_bf16 v[96:111], a[100:103], v[180:183], v[96:111]
    ds_read_b128 v[168:171], v197 offset:8768
    buffer_load_dwordx4 a[228:231], v58, s[16:19], s97 offen offset:1024 sc1
    s_waitcnt lgkmcnt(3)
    v_mfma_f32_16x16x32_bf16 v[112:115], a[104:107], v[184:187], v[112:115]
    ds_read_b128 v[172:175], v198 offset:128
    v_mfma_f32_32x32x16_bf16 v[80:95], a[104:107], v[188:191], v[80:95]
    ds_read_b128 v[176:179], v196 offset:128
    v_mfma_f32_32x32x16_bf16 v[96:111], a[104:107], v[192:195], v[96:111]
    ds_read_b128 v[180:183], v196 offset:8832
    buffer_load_dwordx4 a[232:235], v58, s[16:19], s97 offen offset:2048 sc1
    s_waitcnt lgkmcnt(3)
    v_mfma_f32_16x16x32_bf16 v[112:115], a[108:111], v[160:163], v[112:115]
    ds_read_b128 v[184:187], v198 offset:160
    v_mfma_f32_32x32x16_bf16 v[80:95], a[108:111], v[164:167], v[80:95]
    ds_read_b128 v[188:191], v197 offset:128
    v_mfma_f32_32x32x16_bf16 v[96:111], a[108:111], v[168:171], v[96:111]
    ds_read_b128 v[192:195], v197 offset:8832
    buffer_load_dwordx4 a[236:239], v58, s[16:19], s97 offen offset:3072 sc1
    s_waitcnt lgkmcnt(3)
    v_mfma_f32_16x16x32_bf16 v[112:115], a[112:115], v[172:175], v[112:115]
    ds_read_b128 v[160:163], v198 offset:192
    v_mfma_f32_32x32x16_bf16 v[80:95], a[112:115], v[176:179], v[80:95]
    ds_read_b128 v[164:167], v196 offset:192
    v_mfma_f32_32x32x16_bf16 v[96:111], a[112:115], v[180:183], v[96:111]
    ds_read_b128 v[168:171], v196 offset:8896
    s_add_u32 s97, s97, 4096
    buffer_load_dwordx4 a[240:243], v58, s[16:19], s97 offen offset:0 sc1
    s_waitcnt lgkmcnt(3)
    v_mfma_f32_16x16x32_bf16 v[112:115], a[116:119], v[184:187], v[112:115]
    ds_read_b128 v[172:175], v198 offset:224
    v_mfma_f32_32x32x16_bf16 v[80:95], a[116:119], v[188:191], v[80:95]
    ds_read_b128 v[176:179], v197 offset:192
    v_mfma_f32_32x32x16_bf16 v[96:111], a[116:119], v[192:195], v[96:111]
    ds_read_b128 v[180:183], v197 offset:8896
    buffer_load_dwordx4 a[244:247], v58, s[16:19], s97 offen offset:1024 sc1
    s_waitcnt vmcnt(20)
    s_barrier
    s_waitcnt lgkmcnt(3)
    v_mfma_f32_16x16x32_bf16 v[112:115], a[120:123], v[160:163], v[112:115]
    v_add_u32_e64 v198, v49, v198
    v_mfma_f32_32x32x16_bf16 v[80:95], a[120:123], v[164:167], v[80:95]
    v_add_u32 v196, 19584, v196
    v_add_u32 v197, 19584, v197
    s_waitcnt vmcnt(17)
    v_mul_f32 v148, v24, v157
    v_mul_f32 v149, v25, v157
    v_mul_f32 v150, v26, v157
    v_mfma_f32_32x32x16_bf16 v[96:111], a[120:123], v[168:171], v[96:111]
    ds_read_b128 v[184:187], v198 offset:0
    ds_read_b128 v[188:191], v196 offset:0
    buffer_load_dwordx4 a[248:251], v58, s[16:19], s97 offen offset:2048 sc1
    v_mul_f32 v151, v27, v157
    v_mul_f32_e64 v116, v8, v153
    s_waitcnt lgkmcnt(2)
    v_mfma_f32_16x16x32_bf16 v[112:115], a[124:127], v[172:175], v[112:115]
    ds_read_b128 v[192:195], v198 offset:32
    v_mfma_f32_32x32x16_bf16 v[80:95], a[124:127], v[176:179], v[80:95]
    ds_read_b128 v[160:163], v197 offset:0
    v_mul_f32 v117, v9, v153
    v_mul_f32 v118, v10, v153
    v_mul_f32 v119, v11, v153
    v_mul_f32 v120, v12, v153
    v_mfma_f32_32x32x16_bf16 v[96:111], a[124:127], v[180:183], v[96:111]
    buffer_load_dwordx4 a[252:255], v58, s[16:19], s97 offen offset:3072 sc1
    v_mul_f32 v121, v13, v153
    v_mul_f32 v122, v14, v153
    v_mul_f32 v123, v15, v153
    s_waitcnt lgkmcnt(2)
    v_mfma_f32_16x16x32_bf16 v[112:115], a[128:131], v[184:187], v[112:115]
    ds_read_b128 v[164:167], v198 offset:64
    v_mfma_f32_32x32x16_bf16 v[80:95], a[128:131], v[188:191], v[80:95]
    ds_read_b128 v[168:171], v196 offset:64
    v_mul_f32 v124, v16, v153
    v_mul_f32 v125, v17, v153
    v_mul_f32 v126, v18, v153
    s_waitcnt lgkmcnt(2)
    v_mfma_f32_16x16x32_bf16 v[112:115], a[132:135], v[192:195], v[112:115]
    ds_read_b128 v[172:175], v198 offset:96
    v_mfma_f32_32x32x16_bf16 v[80:95], a[132:135], v[160:163], v[80:95]
    ds_read_b128 v[176:179], v197 offset:64
    s_add_u32 s97, s97, 4096
    buffer_load_dwordx4 v[52:55], v58, s[16:19], s97 offen offset:0 sc1
    v_mul_f32 v127, v19, v153
    v_mul_f32_e64 v128, v20, v153
    s_waitcnt lgkmcnt(2)
    v_mfma_f32_16x16x32_bf16 v[112:115], a[136:139], v[164:167], v[112:115]
    ds_read_b128 v[180:183], v198 offset:128
    v_mfma_f32_32x32x16_bf16 v[80:95], a[136:139], v[168:171], v[80:95]
    ds_read_b128 v[184:187], v196 offset:128
    v_mul_f32 v129, v21, v153
    v_mul_f32 v130, v22, v153
    v_mul_f32 v131, v23, v153
    s_waitcnt lgkmcnt(2)
    v_mfma_f32_16x16x32_bf16 v[112:115], a[140:143], v[172:175], v[112:115]
    ds_read_b128 v[188:191], v198 offset:160
    v_mfma_f32_32x32x16_bf16 v[80:95], a[140:143], v[176:179], v[80:95]
    ds_read_b128 v[192:195], v197 offset:128
    s_mov_b32 s96, 4194304
    buffer_load_dwordx4 v[216:219], v56, s[16:19], s96 offen offset:0 sc1
    v_mul_f32 v132, v8, v155
    v_mul_f32_e64 v133, v9, v155
    s_waitcnt lgkmcnt(2)
    v_mfma_f32_16x16x32_bf16 v[112:115], a[144:147], v[180:183], v[112:115]
    ds_read_b128 v[160:163], v198 offset:192
    v_mfma_f32_32x32x16_bf16 v[80:95], a[144:147], v[184:187], v[80:95]
    ds_read_b128 v[164:167], v196 offset:192
    v_mul_f32 v134, v10, v155
    v_mul_f32 v135, v11, v155
    v_mul_f32 v136, v12, v155
    s_waitcnt lgkmcnt(2)
    v_mfma_f32_16x16x32_bf16 v[112:115], a[148:151], v[188:191], v[112:115]
    ds_read_b128 v[168:171], v198 offset:224
    v_mfma_f32_32x32x16_bf16 v[80:95], a[148:151], v[192:195], v[80:95]
    ds_read_b128 v[172:175], v197 offset:192
    buffer_load_dwordx4 v[220:223], v56, s[16:19], s96 offen offset:256 sc1
    v_mul_f32 v137, v13, v155
    v_mul_f32_e64 v138, v14, v155
    s_waitcnt lgkmcnt(2)
    v_mfma_f32_16x16x32_bf16 v[112:115], a[152:155], v[160:163], v[112:115]
    ds_read_b128 v[176:179], v196 offset:8704
    v_mfma_f32_32x32x16_bf16 v[80:95], a[152:155], v[164:167], v[80:95]
    ds_read_b128 v[180:183], v197 offset:8704
    v_mul_f32 v139, v15, v155
    v_mul_f32 v140, v16, v155
    v_mul_f32 v141, v17, v155
    s_waitcnt lgkmcnt(2)
    v_mfma_f32_16x16x32_bf16 v[112:115], a[156:159], v[168:171], v[112:115]
    ds_read_b128 v[184:187], v196 offset:8768
    v_mfma_f32_32x32x16_bf16 v[80:95], a[156:159], v[172:175], v[80:95]
    ds_read_b128 v[188:191], v197 offset:8768
    s_mov_b32 s96, 4227072
    buffer_load_dwordx4 v[224:227], v56, s[16:19], s96 offen offset:0 sc1
    v_mul_f32 v142, v18, v155
    v_mul_f32 v143, v19, v155
    v_mul_f32 v144, v20, v155
    v_mul_f32 v145, v21, v155
    v_mul_f32 v146, v22, v155
    v_mul_f32_e64 v147, v23, v155
    s_waitcnt lgkmcnt(2)
    v_mfma_f32_32x32x16_bf16 v[96:111], a[128:131], v[176:179], v[96:111]
    ds_read_b128 v[192:195], v196 offset:8832
    v_mfma_f32_32x32x16_bf16 v[96:111], a[132:135], v[180:183], v[96:111]
    ds_read_b128 v[160:163], v197 offset:8832
    buffer_load_dwordx4 v[228:231], v56, s[16:19], s96 offen offset:256 sc1
    v_fma_f32 v112, v112, v156, v148
    v_fma_f32 v113, v113, v156, v149
    s_waitcnt lgkmcnt(2)
    v_mfma_f32_32x32x16_bf16 v[96:111], a[136:139], v[184:187], v[96:111]
    ds_read_b128 v[164:167], v196 offset:8896
    v_fma_f32 v114, v114, v156, v150
    v_fma_f32 v115, v115, v156, v151
    v_cvt_pk_bf16_f32 v112, v112, v113
    v_cvt_pk_bf16_f32 v113, v114, v115
    v_mfma_f32_32x32x16_bf16 v[96:111], a[140:143], v[188:191], v[96:111]
    ds_read_b128 v[168:171], v197 offset:8896
    s_mov_b32 s96, 4259840
    buffer_load_dwordx4 v[232:235], v56, s[16:19], s96 offen offset:0 sc1
    v_fma_f32 v80, v80, v152, v116
    v_fma_f32 v81, v81, v152, v117
    s_waitcnt lgkmcnt(2)
    v_mfma_f32_32x32x16_bf16 v[96:111], a[144:147], v[192:195], v[96:111]
    v_fma_f32 v82, v82, v152, v118
    v_fma_f32 v83, v83, v152, v119
    v_cvt_pk_bf16_f32 v80, v80, v81
    v_cvt_pk_bf16_f32 v81, v82, v83
    ds_write_b64 v40, v[112:113] offset:0
    v_mfma_f32_32x32x16_bf16 v[96:111], a[148:151], v[160:163], v[96:111]
    ds_write_b64 v38, v[80:81] offset:0
    v_fma_f32 v84, v84, v152, v120
    v_fma_f32 v85, v85, v152, v121
    v_fma_f32 v86, v86, v152, v122
    s_waitcnt lgkmcnt(2)
    v_mfma_f32_32x32x16_bf16 v[96:111], a[152:155], v[164:167], v[96:111]
    v_fma_f32 v87, v87, v152, v123
    v_cvt_pk_bf16_f32 v84, v84, v85
    v_cvt_pk_bf16_f32 v85, v86, v87
    v_fma_f32 v88, v88, v152, v124
    v_fma_f32 v89, v89, v152, v125
    v_mfma_f32_32x32x16_bf16 v[96:111], a[156:159], v[168:171], v[96:111]
    buffer_load_dwordx4 v[236:239], v56, s[16:19], s96 offen offset:256 sc1
    v_fma_f32 v90, v90, v152, v126
    v_fma_f32 v91, v91, v152, v127
    v_cvt_pk_bf16_f32 v88, v88, v89
    v_cvt_pk_bf16_f32 v89, v90, v91
    ds_write_b64 v38, v[84:85] offset:6400
    ds_write_b64 v38, v[88:89] offset:12800
    v_fma_f32 v92, v92, v152, v128
    v_fma_f32 v93, v93, v152, v129
    v_fma_f32 v94, v94, v152, v130
    v_fma_f32 v95, v95, v152, v131
    v_cvt_pk_bf16_f32 v92, v92, v93
    v_cvt_pk_bf16_f32 v93, v94, v95
    ds_write_b64 v39, v[92:93] offset:0
    v_pk_fma_f32 v[96:97], v[96:97], v[154:155], v[132:133] op_sel_hi:[1,0,1]
    v_pk_fma_f32 v[98:99], v[98:99], v[154:155], v[134:135] op_sel_hi:[1,0,1]
    v_cvt_pk_bf16_f32 v96, v96, v97
    v_cvt_pk_bf16_f32 v97, v98, v99
    v_pk_fma_f32 v[100:101], v[100:101], v[154:155], v[136:137] op_sel_hi:[1,0,1]
    v_pk_fma_f32 v[102:103], v[102:103], v[154:155], v[138:139] op_sel_hi:[1,0,1]
    v_cvt_pk_bf16_f32 v100, v100, v101
    v_cvt_pk_bf16_f32 v101, v102, v103
    ds_write_b64 v38, v[96:97] offset:1600
    ds_write_b64 v38, v[100:101] offset:8000
    v_pk_fma_f32 v[104:105], v[104:105], v[154:155], v[140:141] op_sel_hi:[1,0,1]
    v_pk_fma_f32 v[106:107], v[106:107], v[154:155], v[142:143] op_sel_hi:[1,0,1]
    v_cvt_pk_bf16_f32 v104, v104, v105
    v_cvt_pk_bf16_f32 v105, v106, v107
    v_pk_fma_f32 v[108:109], v[108:109], v[154:155], v[144:145] op_sel_hi:[1,0,1]
    v_pk_fma_f32 v[110:111], v[110:111], v[154:155], v[146:147] op_sel_hi:[1,0,1]
    v_cvt_pk_bf16_f32 v108, v108, v109
    v_cvt_pk_bf16_f32 v109, v110, v111
    ds_write_b64 v38, v[104:105] offset:14400
    ds_write_b64 v39, v[108:109] offset:1600
    s_waitcnt lgkmcnt(0)
    s_barrier
    v_mov_b32 v94, 0
    v_mov_b32 v95, 0
    v_mov_b32 v98, 0
    v_mov_b32_e64 v99, 0
    s_mov_b64 exec, 0xffff
    ds_read_b64 v[94:95], v42 offset:320
    ds_read_b64 v[98:99], v42 offset:640
    s_mov_b64 exec, -1
    s_nop 0
    ds_read_b64 v[92:93], v41 offset:320
    ds_read_b64 v[96:97], v41 offset:640
    ds_read_b64 v[84:85], v41 offset:6720
    ds_read_b64 v[86:87], v42 offset:6720
    ds_read_b64 v[80:81], v41 offset:6400
    ds_read_b64 v[82:83], v42 offset:6400
    ds_read_b64 v[88:89], v41 offset:7040
    ds_read_b64 v[90:91], v42 offset:7040
    ds_read_b64_tr_b16 v[106:107], v44 offset:0
    ds_read_b64_tr_b16 v[100:101], v43 offset:0
    ds_read_b64_tr_b16 v[108:109], v44 offset:320
    ds_read_b64_tr_b16 v[102:103], v43 offset:320
    s_mov_b32 s96, 4292608
    buffer_load_dwordx4 v[240:243], v56, s[16:19], s96 offen offset:0 sc1
    ds_read_b64_tr_b16 v[110:111], v44 offset:640
    ds_read_b64_tr_b16 v[104:105], v43 offset:640
    s_mov_b32 s82, 0x3ea52b5c
    s_lshl_b32 s25, s98, 4
    s_add_u32 s25, s25, 4194304
    s_lshl_b32 s26, s98, 3
    s_add_u32 s26, s26, 4194304
    s_waitcnt lgkmcnt(10)
    v_mfma_f32_16x16x32_bf16 v[116:119], v[84:87], v[92:95], v[28:31]
    buffer_load_dwordx4 v[244:247], v56, s[16:19], s96 offen offset:256 sc1
    v_mfma_f32_16x16x32_bf16 v[120:123], v[84:87], v[96:99], v[32:35]
    s_waitcnt lgkmcnt(8)
    v_mfma_f32_16x16x32_bf16 v[112:115], v[80:83], v[92:95], v[32:35]
    s_waitcnt lgkmcnt(6)
    v_mfma_f32_16x16x32_bf16 v[124:127], v[88:91], v[96:99], v[28:31]
    s_nop 5
    v_max_f32 v112, v112, v116
    v_max_f32 v113, v113, v117
    v_max_f32 v114, v114, v118
    v_max_f32 v115, v115, v119
    v_max3_f32 v156, v112, v113, v114
    s_mov_b32 s96, 4194304
    buffer_load_dwordx2 v[248:249], v57, s[16:19], s96 offen offset:0 sc1
    v_max_f32 v156, v156, v115
    v_max_f32 v120, v120, v124
    v_max_f32 v121, v121, v125
    v_max_f32 v122, v122, v126
    v_max_f32 v123, v123, v127
    v_max3_f32 v157, v120, v121, v122
    v_max_f32 v157, v157, v123
    s_nop 1
    v_permlane16_swap_b32 v156, v157
    buffer_load_dwordx2 v[252:253], v57, s[16:19], s96 offen offset:128 sc1
    v_max_f32 v156, v156, v157
    v_mov_b32 v157, v156
    s_nop 1
    v_permlane32_swap_b32 v156, v157
    v_max_f32 v156, v156, v157
    v_mul_f32 v156, s82, v156
    v_mov_b32 v157, v156
    s_nop 1
    v_permlane16_swap_b32_e64 v156, v157
    v_fma_f32 v112, v112, s82, -v156
    s_mov_b32 s96, 4210688
    buffer_load_dwordx2 v[250:251], v57, s[16:19], s96 offen offset:0 sc1
    v_fma_f32 v113, v113, s82, -v156
    v_fma_f32 v114, v114, s82, -v156
    v_fma_f32 v115, v115, s82, -v156
    v_exp_f32 v112, v112
    v_exp_f32 v113, v113
    v_exp_f32 v114, v114
    v_exp_f32 v115, v115
    v_cvt_pk_bf16_f32 v116, v112, v113
    buffer_load_dwordx2 v[254:255], v57, s[16:19], s96 offen offset:128 sc1
    v_cvt_pk_bf16_f32 v117, v114, v115
    v_bfi_b32 v128, v36, 0, v116
    v_and_b32 v130, v36, v116
    v_bfi_b32 v129, v37, 0, v117
    v_and_b32 v131, v37, v117
    s_waitcnt lgkmcnt(3)
    s_nop 0
    v_mfma_f32_16x16x32_bf16 v[144:147], v[106:109], v[128:131], 0
    s_waitcnt lgkmcnt(2)
    v_mfma_f32_16x16x32_bf16 v[136:139], v[100:103], v[128:131], 0
    v_fma_f32 v120, v120, s82, -v157
    s_mov_b32 s96, 0
    s_mov_b32 s97, 5120
    buffer_load_dwordx2 v[208:209], v60, s[4:7], s96 offen
    v_fma_f32 v121, v121, s82, -v157
    v_fma_f32 v122, v122, s82, -v157
    v_fma_f32 v123, v123, s82, -v157
    v_exp_f32 v120, v120
    v_exp_f32 v121, v121
    v_exp_f32 v122, v122
    v_exp_f32 v123, v123
    v_cvt_pk_bf16_f32 v124, v120, v121
    buffer_load_dwordx2 v[210:211], v60, s[4:7], s97 offen
    v_cvt_pk_bf16_f32 v125, v122, v123
    v_bfi_b32 v132, v36, 0, v124
    v_and_b32 v134, v36, v124
    v_bfi_b32 v133, v37, 0, v125
    v_and_b32 v135, v37, v125
    s_waitcnt lgkmcnt(1)
    s_nop 0
    v_mfma_f32_16x16x32_bf16 v[148:151], v[108:111], v[132:135], 0
    s_waitcnt lgkmcnt(0)
    v_mfma_f32_16x16x32_bf16 v[140:143], v[102:105], v[132:135], 0
    v_mov_b32 v158, v144
    v_lshrrev_b32_e64 v212, 5, v1
    v_mul_u32_u24 v212, 5104, v212
    v_bfe_u32 v213, v1, 4, 1
    v_lshlrev_b32 v213, 2, v213
    v_sub_u32 v212, v212, v213
    v_add_u32 v212, v212, v60
    s_mul_i32 s97, s24, 24
    s_sub_u32 s97, 128, s97
    buffer_load_dword v212, v212, s[4:7], s97 offen
    v_permlane16_swap_b32 v144, v158
    v_rcp_f32_e64 v158, v158
    s_nop 0
    v_pk_mul_f32 v[136:137], v[136:137], v[158:159] op_sel_hi:[1,0]
    v_pk_mul_f32 v[138:139], v[138:139], v[158:159] op_sel_hi:[1,0]
    v_pk_mul_f32 v[144:145], v[144:145], v[158:159] op_sel_hi:[1,0]
    v_pk_mul_f32 v[146:147], v[146:147], v[158:159] op_sel_hi:[1,0]
    v_cvt_pk_bf16_f32 v112, v136, v137
    v_cvt_pk_bf16_f32 v116, v144, v145
    v_cvt_pk_bf16_f32 v113, v138, v139
    v_cvt_pk_bf16_f32 v117, v146, v147
    v_mov_b32 v160, v148
    s_nop 1
    v_permlane16_swap_b32 v148, v160
    v_rcp_f32_e64 v160, v160
    s_nop 0
    v_pk_mul_f32 v[140:141], v[140:141], v[160:161] op_sel_hi:[1,0]
    v_pk_mul_f32 v[142:143], v[142:143], v[160:161] op_sel_hi:[1,0]
    v_pk_mul_f32 v[148:149], v[148:149], v[160:161] op_sel_hi:[1,0]
    v_pk_mul_f32 v[150:151], v[150:151], v[160:161] op_sel_hi:[1,0]
    v_cvt_pk_bf16_f32 v114, v140, v141
    v_cvt_pk_bf16_f32 v118, v148, v149
    v_cvt_pk_bf16_f32 v115, v142, v143
    v_cvt_pk_bf16_f32 v119, v150, v151
    v_permlane16_swap_b32 v112, v114
    v_permlane16_swap_b32 v113, v115
    v_permlane16_swap_b32 v116, v118
    v_permlane16_swap_b32 v117, v119
    buffer_store_dwordx4 v[112:115], v45, s[16:19], s25 offen sc1
    s_mov_b64 exec, s[80:81]
    buffer_store_dwordx2 v[116:117], v46, s[16:19], s26 offen sc1
    s_mov_b64 exec, -1
oe_20:
    s_waitcnt vmcnt(16)
    v_mfma_f32_16x16x32_bf16 v[112:115], a[176:179], v[216:219], 0
    v_mov_b32 v136, 0
    v_mov_b32 v137, 0
    s_waitcnt vmcnt(15)
    v_mfma_f32_16x16x32_bf16 v[116:119], a[176:179], v[220:223], 0
    v_mov_b32 v138, 0
    v_mov_b32 v139, 0
    s_waitcnt vmcnt(14)
    v_mfma_f32_16x16x32_bf16 v[112:115], a[196:199], v[224:227], v[112:115]
    v_mov_b32 v140, 0
    v_mov_b32 v141, 0
    s_waitcnt vmcnt(13)
    v_mfma_f32_16x16x32_bf16 v[116:119], a[196:199], v[228:231], v[116:119]
    s_mov_b32 s25, 6815744
    s_add_u32 s26, s36, 6815744
    s_waitcnt vmcnt(12)
    v_mfma_f32_16x16x32_bf16 v[112:115], a[216:219], v[232:235], v[112:115]
    s_add_u32 s27, s35, 3473408
    s_mov_b32 s28, 0x99999999
    s_waitcnt vmcnt(11)
    v_mfma_f32_16x16x32_bf16 v[116:119], a[216:219], v[236:239], v[116:119]
    s_mov_b32 s29, 0x99999999
    s_waitcnt vmcnt(10)
    v_mfma_f32_16x16x32_bf16 v[112:115], a[236:239], v[240:243], v[112:115]
    s_waitcnt vmcnt(9)
    v_mfma_f32_16x16x32_bf16 v[116:119], a[236:239], v[244:247], v[116:119]
    s_waitcnt vmcnt(6)
    v_mfma_f32_16x16x32_bf16 v[112:115], v[52:55], v[248:251], v[112:115]
    s_waitcnt vmcnt(5)
    v_mfma_f32_16x16x32_bf16 v[116:119], v[52:55], v[252:255], v[116:119]
    v_mfma_f32_16x16x32_bf16 v[88:91], a[164:167], v[216:219], 0
    v_mfma_f32_16x16x32_bf16 v[92:95], a[164:167], v[220:223], 0
    v_mfma_f32_16x16x32_bf16 v[88:91], a[184:187], v[224:227], v[88:91]
    v_mfma_f32_16x16x32_bf16 v[92:95], a[184:187], v[228:231], v[92:95]
    v_mfma_f32_16x16x32_bf16 v[88:91], a[204:207], v[232:235], v[88:91]
    v_mfma_f32_16x16x32_bf16 v[92:95], a[204:207], v[236:239], v[92:95]
    s_nop 1
    v_cmp_u_f32 vcc, v112, v116
    s_nop 0
    s_cbranch_vccnz rd_21
rc_22:
    v_mfma_f32_16x16x32_bf16 v[88:91], a[224:227], v[240:243], v[88:91]
    ds_write_b128 v203, v[112:115] offset:24576
    v_mfma_f32_16x16x32_bf16 v[92:95], a[224:227], v[244:247], v[92:95]
    v_mfma_f32_16x16x32_bf16 v[88:91], a[244:247], v[248:251], v[88:91]
    ds_write_b128 v203, v[116:119] offset:25600
    v_mfma_f32_16x16x32_bf16 v[92:95], a[244:247], v[252:255], v[92:95]
    v_mfma_f32_16x16x32_bf16 v[96:99], a[168:171], v[216:219], 0
    s_waitcnt vmcnt(4)
    v_lshlrev_b32 v120, 16, v208
    v_and_b32 v121, 0xffff0000, v208
    v_mfma_f32_16x16x32_bf16 v[100:103], a[168:171], v[220:223], 0
    v_lshlrev_b32_e64 v122, 16, v209
    v_and_b32 v123, 0xffff0000, v209
    v_mfma_f32_16x16x32_bf16 v[96:99], a[188:191], v[224:227], v[96:99]
    s_waitcnt vmcnt(3)
    v_lshlrev_b32 v124, 16, v210
    v_and_b32 v125, 0xffff0000, v210
    v_mfma_f32_16x16x32_bf16 v[100:103], a[188:191], v[228:231], v[100:103]
    v_lshlrev_b32_e64 v126, 16, v211
    v_and_b32 v127, 0xffff0000, v211
    v_mfma_f32_16x16x32_bf16 v[96:99], a[208:211], v[232:235], v[96:99]
    s_waitcnt vmcnt(2)
    v_lshlrev_b32 v128, 16, v212
    v_and_b32 v129, 0xffff0000, v212
    v_mfma_f32_16x16x32_bf16 v[100:103], a[208:211], v[236:239], v[100:103]
    v_mfma_f32_16x16x32_bf16 v[96:99], a[228:231], v[240:243], v[96:99]
    ds_write_b128 v200, v[88:91] offset:0
    v_mfma_f32_16x16x32_bf16 v[100:103], a[228:231], v[244:247], v[100:103]
    v_mfma_f32_16x16x32_bf16 v[96:99], a[248:251], v[248:251], v[96:99]
    ds_write_b128 v200, v[92:95] offset:1024
    v_mfma_f32_16x16x32_bf16 v[100:103], a[248:251], v[252:255], v[100:103]
    v_mfma_f32_16x16x32_bf16 v[104:107], a[172:175], v[216:219], 0
    v_mfma_f32_16x16x32_bf16 v[108:111], a[172:175], v[220:223], 0
    v_mfma_f32_16x16x32_bf16 v[104:107], a[192:195], v[224:227], v[104:107]
    v_mfma_f32_16x16x32_bf16 v[108:111], a[192:195], v[228:231], v[108:111]
    v_mfma_f32_16x16x32_bf16 v[104:107], a[212:215], v[232:235], v[104:107]
    v_mfma_f32_16x16x32_bf16 v[108:111], a[212:215], v[236:239], v[108:111]
    v_mfma_f32_16x16x32_bf16 v[104:107], a[232:235], v[240:243], v[104:107]
    ds_write_b128 v201, v[96:99] offset:2048
    v_mfma_f32_16x16x32_bf16 v[108:111], a[232:235], v[244:247], v[108:111]
    v_mfma_f32_16x16x32_bf16 v[104:107], a[252:255], v[248:251], v[104:107]
    ds_write_b128 v201, v[100:103] offset:3072
    v_mfma_f32_16x16x32_bf16 v[108:111], a[252:255], v[252:255], v[108:111]
    v_mfma_f32_16x16x32_bf16 v[80:83], a[160:163], v[216:219], v[120:123]
    v_mfma_f32_16x16x32_bf16 v[84:87], a[160:163], v[220:223], v[124:127]
    v_mfma_f32_16x16x32_bf16 v[80:83], a[180:183], v[224:227], v[80:83]
    v_mfma_f32_16x16x32_bf16 v[84:87], a[180:183], v[228:231], v[84:87]
    v_mfma_f32_16x16x32_bf16 v[80:83], a[200:203], v[232:235], v[80:83]
    s_nop 0
    ds_write_b128 v202, v[104:107] offset:4096
    v_mfma_f32_16x16x32_bf16 v[84:87], a[200:203], v[236:239], v[84:87]
    ds_write_b128 v202, v[108:111] offset:5120
    v_mfma_f32_16x16x32_bf16 v[80:83], a[220:223], v[240:243], v[80:83]
    v_mfma_f32_16x16x32_bf16 v[84:87], a[220:223], v[244:247], v[84:87]
    v_mfma_f32_16x16x32_bf16 v[80:83], a[240:243], v[248:251], v[80:83]
    v_mfma_f32_16x16x32_bf16 v[84:87], a[240:243], v[252:255], v[84:87]
    s_waitcnt lgkmcnt(0)
    s_barrier
    s_nop 0
    ds_read_b128 v[88:91], v204 offset:0
    ds_read_b128 v[92:95], v204 offset:1024
    ds_read_b128 v[96:99], v204 offset:2048
    ds_read_b128 v[100:103], v204 offset:3072
    ds_read_b128 v[104:107], v204 offset:4096
    ds_read_b128 v[108:111], v204 offset:5120
    ds_read_b64 v[112:113], v205 offset:24576
    ds_read_b64 v[114:115], v205 offset:26624
    ds_read_b64 v[116:117], v205 offset:28672
    ds_read_b64 v[118:119], v205 offset:30720
    s_mov_b32 s96, 4198400
    buffer_load_dwordx4 v[216:219], v56, s[16:19], s96 offen offset:0 sc1
    buffer_load_dwordx4 v[220:223], v56, s[16:19], s96 offen offset:256 sc1
    s_mov_b32 s96, 4231168
    buffer_load_dwordx4 v[224:227], v56, s[16:19], s96 offen offset:0 sc1
    buffer_load_dwordx4 v[228:231], v56, s[16:19], s96 offen offset:256 sc1
    s_mov_b32 s96, 4263936
    buffer_load_dwordx4 v[232:235], v56, s[16:19], s96 offen offset:0 sc1
    buffer_load_dwordx4 v[236:239], v56, s[16:19], s96 offen offset:256 sc1
    s_waitcnt lgkmcnt(9)
    v_pk_add_f32 v[80:81], v[80:81], v[88:89]
    v_pk_add_f32 v[82:83], v[82:83], v[90:91]
    s_waitcnt lgkmcnt(8)
    v_pk_add_f32 v[84:85], v[84:85], v[92:93]
    v_pk_add_f32 v[86:87], v[86:87], v[94:95]
    s_waitcnt lgkmcnt(7)
    v_pk_add_f32 v[80:81], v[80:81], v[96:97]
    v_pk_add_f32 v[82:83], v[82:83], v[98:99]
    s_waitcnt lgkmcnt(6)
    v_pk_add_f32 v[84:85], v[84:85], v[100:101]
    v_pk_add_f32 v[86:87], v[86:87], v[102:103]
    s_waitcnt lgkmcnt(5)
    v_pk_add_f32 v[80:81], v[80:81], v[104:105]
    v_pk_add_f32 v[82:83], v[82:83], v[106:107]
    s_waitcnt lgkmcnt(4)
    v_pk_add_f32 v[84:85], v[84:85], v[108:109]
    v_pk_add_f32 v[86:87], v[86:87], v[110:111]
    v_cvt_pk_bf16_f32 v132, v80, v81
    v_cvt_pk_bf16_f32 v133, v82, v83
    v_cvt_pk_bf16_f32 v134, v84, v85
    v_cvt_pk_bf16_f32 v135, v86, v87
    s_waitcnt lgkmcnt(3)
    v_pk_add_f32 v[128:129], v[128:129], v[112:113]
    s_waitcnt lgkmcnt(2)
    v_pk_add_f32 v[128:129], v[128:129], v[114:115]
    s_waitcnt lgkmcnt(1)
    v_pk_add_f32 v[128:129], v[128:129], v[116:117]
    s_waitcnt lgkmcnt(0)
    v_pk_add_f32 v[128:129], v[128:129], v[118:119]
    v_cvt_pk_bf16_f32 v130, v128, v129
    buffer_store_dwordx4 v[132:135], v59, s[16:19], s25 offen sc1
    buffer_store_dword v130, v61, s[16:19], s26 offen sc1
    v_dot2c_f32_bf16 v136, v132, v215
    v_dot2c_f32_bf16 v137, v132, v132
    v_dot2c_f32_bf16 v136, v133, v215
    v_dot2c_f32_bf16 v137, v133, v133
    v_dot2c_f32_bf16 v138, v134, v215
    v_dot2c_f32_bf16 v139, v134, v134
    v_dot2c_f32_bf16 v138, v135, v215
    v_dot2c_f32_bf16 v139, v135, v135
    v_dot2c_f32_bf16 v140, v130, v215
    v_dot2c_f32_bf16 v141, v130, v130
    v_permlane32_swap_b32 v136, v138
    v_permlane32_swap_b32 v137, v139
    v_pk_add_f32 v[136:137], v[136:137], v[138:139]
    v_pk_add_f32 v[136:137], v[136:137], v[140:141]
    s_nop 1
    v_permlane16_swap_b32 v136, v137
    v_add_f32_e64 v136, v136, v137
    ds_write_b32 v206, v136 offset:32768
    s_mov_b32 s96, 4296704
    buffer_load_dwordx4 v[240:243], v56, s[16:19], s96 offen offset:0 sc1
    buffer_load_dwordx4 v[244:247], v56, s[16:19], s96 offen offset:256 sc1
    s_mov_b32 s96, 4196352
    buffer_load_dwordx2 v[248:249], v57, s[16:19], s96 offen offset:0 sc1
    buffer_load_dwordx2 v[252:253], v57, s[16:19], s96 offen offset:128 sc1
    s_mov_b32 s96, 4212736
    buffer_load_dwordx2 v[250:251], v57, s[16:19], s96 offen offset:0 sc1
    buffer_load_dwordx2 v[254:255], v57, s[16:19], s96 offen offset:128 sc1
    s_mov_b32 s96, 1310720
    s_mov_b32 s97, 1315840
    buffer_load_dwordx2 v[208:209], v60, s[4:7], s96 offen
    buffer_load_dwordx2 v[210:211], v60, s[4:7], s97 offen
    v_lshrrev_b32_e64 v212, 5, v1
    v_mul_u32_u24 v212, 5104, v212
    v_bfe_u32 v213, v1, 4, 1
    v_lshlrev_b32 v213, 2, v213
    v_sub_u32 v212, v212, v213
    v_add_u32 v212, v212, v60
    s_mul_i32 s97, s24, 24
    s_sub_u32 s97, 1310848, s97
    buffer_load_dword v212, v212, s[4:7], s97 offen
    s_waitcnt lgkmcnt(0)
    s_barrier
    ds_read2st64_b32 v[136:137], v207 offset0:0 offset1:1
    ds_read2st64_b32 v[138:139], v207 offset0:2 offset1:3
    ds_read_b64_tr_b16 v[144:145], v65 offset:32
    ds_read_b64_tr_b16 v[146:147], v65 offset:0
    ds_read_b64_tr_b16 v[148:149], v65 offset:160
    ds_read_b64_tr_b16 v[150:151], v65 offset:128
    ds_read_b64_tr_b16 v[152:153], v65 offset:288
    ds_read_b64_tr_b16 v[154:155], v65 offset:256
    ds_read_b64_tr_b16 v[156:157], v65 offset:416
    ds_read_b64_tr_b16 v[158:159], v65 offset:384
    ds_read_b64_tr_b16 v[160:161], v65 offset:544
    ds_read_b64_tr_b16 v[162:163], v65 offset:512
    ds_read_b64_tr_b16 v[164:165], v65 offset:672
    ds_read_b64_tr_b16 v[166:167], v65 offset:640
    ds_read_b64_tr_b16 v[168:169], v65 offset:800
    ds_read_b64_tr_b16 v[170:171], v65 offset:768
    ds_read_b64_tr_b16 v[172:173], v65 offset:928
    ds_read_b64_tr_b16 v[174:175], v65 offset:896
    s_waitcnt lgkmcnt(15)
    v_pk_add_f32 v[136:137], v[136:137], v[138:139]
    v_add_f32 v136, v136, v137
    v_cndmask_b32 v136, v136, 1.0, s[28:29]
    s_mov_b64 exec, s[80:81]
    buffer_atomic_add_f32 v136, v214, s[16:19], s27 offen
    s_mov_b64 exec, -1
    v_lshrrev_b32 v176, 4, v0
    v_mul_u32_u24 v176, 1216, v176
    v_and_b32 v177, 15, v0
    v_lshl_add_u32 v176, v177, 3, v176
    v_add_u32 v176, 64, v176
    v_mov_b32 v178, 0
    v_mov_b32 v179, 0
    ds_write_b64 v176, v[178:179]
    v_mov_b32 v70, 0
    v_mov_b32 v71, 0
    v_mov_b32 v72, 0
    s_lshl_b32 s25, s24, 17
    v_lshrrev_b32 v176, 5, v1
    v_lshl_add_u32 v176, v176, 14, s25
    v_bfe_u32 v177, v1, 4, 1
    v_lshl_add_u32 v176, v177, 13, v176
    v_and_b32_e64 v177, 15, v1
    v_lshl_add_u32 v73, v177, 4, v176
    v_bfe_u32 v176, v1, 2, 3
    v_lshl_add_u32 v176, v176, 14, s25
    v_bfe_u32 v177, v1, 1, 1
    v_lshl_add_u32 v176, v177, 13, v176
    v_and_b32 v177, 1, v1
    v_lshl_add_u32 v77, v177, 4, v176
    v_lshrrev_b32 v177, 5, v1
    v_and_b32 v176, 31, v1
    v_lshlrev_b32 v176, 3, v176
    v_lshl_add_u32 v78, v177, 10, v176
    v_and_b32 v176, 7, v1
    v_lshlrev_b32 v176, 3, v176
    v_lshl_add_u32 v178, v177, 7, v176
    v_add_u32 v74, 31744, v73
    v_add_u32 v75, 63488, v73
    v_add_u32 v76, 95232, v73
    v_add_u32 v178, 53760, v178
    v_and_b32 v176, 31, v1
    v_cmp_eq_u32 vcc, 0, v176
    v_cmp_eq_u32 s[82:83], 24, v176
    s_nop 0
    s_or_b64 vcc, vcc, s[82:83]
    v_mov_b32 v176, 155648
    v_mov_b32 v177, 157696
    v_cndmask_b32 v176, v176, v177, vcc
    v_cndmask_b32 v79, v176, v178, s[78:79]
oe_23:
    s_waitcnt vmcnt(17)
    v_mfma_f32_16x16x32_bf16 v[112:115], a[176:179], v[216:219], 0
    v_mov_b32 v136, 0
    v_mov_b32 v137, 0
    s_waitcnt vmcnt(16)
    v_mfma_f32_16x16x32_bf16 v[116:119], a[176:179], v[220:223], 0
    v_mov_b32 v138, 0
    v_mov_b32 v139, 0
    s_waitcnt vmcnt(15)
    v_mfma_f32_16x16x32_bf16 v[112:115], a[196:199], v[224:227], v[112:115]
    v_mov_b32 v140, 0
    v_mov_b32_e64 v141, 0
    s_waitcnt vmcnt(14)
    v_mfma_f32_16x16x32_bf16 v[116:119], a[196:199], v[228:231], v[116:119]
    s_mov_b32 s25, 6817792
    s_add_u32 s26, s36, 6817792
    s_waitcnt vmcnt(13)
    v_mfma_f32_16x16x32_bf16 v[112:115], a[216:219], v[232:235], v[112:115]
    s_add_u32 s27, s35, 3477504
    s_mov_b32 s28, 0x99999999
    s_waitcnt vmcnt(12)
    v_mfma_f32_16x16x32_bf16 v[116:119], a[216:219], v[236:239], v[116:119]
    s_mov_b32 s29, 0x99999999
    s_waitcnt vmcnt(9)
    v_mfma_f32_16x16x32_bf16 v[112:115], a[236:239], v[240:243], v[112:115]
    s_waitcnt vmcnt(8)
    v_mfma_f32_16x16x32_bf16 v[116:119], a[236:239], v[244:247], v[116:119]
    s_waitcnt vmcnt(5)
    v_mfma_f32_16x16x32_bf16 v[112:115], v[52:55], v[248:251], v[112:115]
    s_waitcnt vmcnt(4)
    v_mfma_f32_16x16x32_bf16 v[116:119], v[52:55], v[252:255], v[116:119]
    v_mfma_f32_16x16x32_bf16 v[88:91], a[164:167], v[216:219], 0
    v_mfma_f32_16x16x32_bf16 v[92:95], a[164:167], v[220:223], 0
    v_mfma_f32_16x16x32_bf16 v[88:91], a[184:187], v[224:227], v[88:91]
    v_mfma_f32_16x16x32_bf16 v[92:95], a[184:187], v[228:231], v[92:95]
    v_mfma_f32_16x16x32_bf16 v[88:91], a[204:207], v[232:235], v[88:91]
    v_mfma_f32_16x16x32_bf16 v[92:95], a[204:207], v[236:239], v[92:95]
    s_nop 1
    v_cmp_u_f32 vcc, v112, v116
    s_nop 0
    s_cbranch_vccnz rd_24
rc_25:
    v_mfma_f32_16x16x32_bf16 v[88:91], a[224:227], v[240:243], v[88:91]
    ds_write_b128 v203, v[112:115] offset:24576
    v_mfma_f32_16x16x32_bf16 v[92:95], a[224:227], v[244:247], v[92:95]
    v_mfma_f32_16x16x32_bf16 v[88:91], a[244:247], v[248:251], v[88:91]
    ds_write_b128 v203, v[116:119] offset:25600
    v_mfma_f32_16x16x32_bf16 v[92:95], a[244:247], v[252:255], v[92:95]
    v_mfma_f32_16x16x32_bf16 v[96:99], a[168:171], v[216:219], 0
    s_waitcnt vmcnt(3)
    v_lshlrev_b32 v120, 16, v208
    v_and_b32 v121, 0xffff0000, v208
    v_mfma_f32_16x16x32_bf16 v[100:103], a[168:171], v[220:223], 0
    v_lshlrev_b32_e64 v122, 16, v209
    v_and_b32 v123, 0xffff0000, v209
    v_mfma_f32_16x16x32_bf16 v[96:99], a[188:191], v[224:227], v[96:99]
    s_waitcnt vmcnt(2)
    v_lshlrev_b32 v124, 16, v210
    v_and_b32 v125, 0xffff0000, v210
    v_mfma_f32_16x16x32_bf16 v[100:103], a[188:191], v[228:231], v[100:103]
    v_lshlrev_b32_e64 v126, 16, v211
    v_and_b32 v127, 0xffff0000, v211
    v_mfma_f32_16x16x32_bf16 v[96:99], a[208:211], v[232:235], v[96:99]
    s_waitcnt vmcnt(1)
    v_lshlrev_b32 v128, 16, v212
    v_and_b32 v129, 0xffff0000, v212
    v_mfma_f32_16x16x32_bf16 v[100:103], a[208:211], v[236:239], v[100:103]
    v_mfma_f32_16x16x32_bf16 v[96:99], a[228:231], v[240:243], v[96:99]
    ds_write_b128 v200, v[88:91] offset:0
    v_mfma_f32_16x16x32_bf16 v[100:103], a[228:231], v[244:247], v[100:103]
    v_mfma_f32_16x16x32_bf16 v[96:99], a[248:251], v[248:251], v[96:99]
    ds_write_b128 v200, v[92:95] offset:1024
    v_mfma_f32_16x16x32_bf16 v[100:103], a[248:251], v[252:255], v[100:103]
    v_mfma_f32_16x16x32_bf16 v[104:107], a[172:175], v[216:219], 0
    v_mfma_f32_16x16x32_bf16 v[108:111], a[172:175], v[220:223], 0
    v_mfma_f32_16x16x32_bf16 v[104:107], a[192:195], v[224:227], v[104:107]
    v_mfma_f32_16x16x32_bf16 v[108:111], a[192:195], v[228:231], v[108:111]
    v_mfma_f32_16x16x32_bf16 v[104:107], a[212:215], v[232:235], v[104:107]
    v_mfma_f32_16x16x32_bf16 v[108:111], a[212:215], v[236:239], v[108:111]
    v_mfma_f32_16x16x32_bf16 v[104:107], a[232:235], v[240:243], v[104:107]
    ds_write_b128 v201, v[96:99] offset:2048
    v_mfma_f32_16x16x32_bf16 v[108:111], a[232:235], v[244:247], v[108:111]
    v_mfma_f32_16x16x32_bf16 v[104:107], a[252:255], v[248:251], v[104:107]
    ds_write_b128 v201, v[100:103] offset:3072
    v_mfma_f32_16x16x32_bf16 v[108:111], a[252:255], v[252:255], v[108:111]
    v_mfma_f32_16x16x32_bf16 v[80:83], a[160:163], v[216:219], v[120:123]
    v_mfma_f32_16x16x32_bf16 v[84:87], a[160:163], v[220:223], v[124:127]
    v_mfma_f32_16x16x32_bf16 v[80:83], a[180:183], v[224:227], v[80:83]
    v_mfma_f32_16x16x32_bf16 v[84:87], a[180:183], v[228:231], v[84:87]
    v_mfma_f32_16x16x32_bf16 v[80:83], a[200:203], v[232:235], v[80:83]
    s_nop 0
    ds_write_b128 v202, v[104:107] offset:4096
    v_mfma_f32_16x16x32_bf16 v[84:87], a[200:203], v[236:239], v[84:87]
    ds_write_b128 v202, v[108:111] offset:5120
    v_mfma_f32_16x16x32_bf16 v[80:83], a[220:223], v[240:243], v[80:83]
    v_mfma_f32_16x16x32_bf16 v[84:87], a[220:223], v[244:247], v[84:87]
    v_mfma_f32_16x16x32_bf16 v[80:83], a[240:243], v[248:251], v[80:83]
    v_mfma_f32_16x16x32_bf16 v[84:87], a[240:243], v[252:255], v[84:87]
    s_waitcnt lgkmcnt(0)
    s_barrier
    s_nop 0
    ds_read_b128 v[88:91], v204 offset:0
    ds_read_b128 v[92:95], v204 offset:1024
    ds_read_b128 v[96:99], v204 offset:2048
    ds_read_b128 v[100:103], v204 offset:3072
    ds_read_b128 v[104:107], v204 offset:4096
    ds_read_b128 v[108:111], v204 offset:5120
    ds_read_b64 v[112:113], v205 offset:24576
    ds_read_b64 v[114:115], v205 offset:26624
    ds_read_b64 v[116:117], v205 offset:28672
    ds_read_b64 v[118:119], v205 offset:30720
    s_lshl_b32 s96, s75, 14
    s_add_u32 s96, s96, 6815744
    s_lshl_b32 s97, s24, 12
    s_add_u32 s97, s97, 3473408
    buffer_load_dwordx4 v[176:179], v62, s[16:19], s96 offen offset:0 sc1
    buffer_load_dwordx4 v[180:183], v62, s[16:19], s96 offen offset:1024 sc1
    buffer_load_dwordx4 v[184:187], v62, s[16:19], s97 offen offset:0 sc1
    buffer_load_dwordx4 v[188:191], v62, s[16:19], s97 offen offset:1024 sc1
    buffer_load_dwordx4 v[192:195], v62, s[16:19], s97 offen offset:2048 sc1
    buffer_load_dwordx4 v[196:199], v62, s[16:19], s97 offen offset:3072 sc1
    s_waitcnt lgkmcnt(9)
    v_pk_add_f32 v[80:81], v[80:81], v[88:89]
    v_pk_add_f32 v[82:83], v[82:83], v[90:91]
    s_waitcnt lgkmcnt(8)
    v_pk_add_f32 v[84:85], v[84:85], v[92:93]
    v_pk_add_f32 v[86:87], v[86:87], v[94:95]
    s_waitcnt lgkmcnt(7)
    v_pk_add_f32 v[80:81], v[80:81], v[96:97]
    v_pk_add_f32 v[82:83], v[82:83], v[98:99]
    s_waitcnt lgkmcnt(6)
    v_pk_add_f32 v[84:85], v[84:85], v[100:101]
    v_pk_add_f32 v[86:87], v[86:87], v[102:103]
    s_waitcnt lgkmcnt(5)
    v_pk_add_f32 v[80:81], v[80:81], v[104:105]
    v_pk_add_f32 v[82:83], v[82:83], v[106:107]
    s_waitcnt lgkmcnt(4)
    v_pk_add_f32 v[84:85], v[84:85], v[108:109]
    v_pk_add_f32 v[86:87], v[86:87], v[110:111]
    v_cvt_pk_bf16_f32 v132, v80, v81
    v_cvt_pk_bf16_f32 v133, v82, v83
    v_cvt_pk_bf16_f32 v134, v84, v85
    v_cvt_pk_bf16_f32 v135, v86, v87
    s_waitcnt lgkmcnt(3)
    v_pk_add_f32 v[128:129], v[128:129], v[112:113]
    s_waitcnt lgkmcnt(2)
    v_pk_add_f32 v[128:129], v[128:129], v[114:115]
    s_waitcnt lgkmcnt(1)
    v_pk_add_f32 v[128:129], v[128:129], v[116:117]
    s_waitcnt lgkmcnt(0)
    v_pk_add_f32 v[128:129], v[128:129], v[118:119]
    v_cvt_pk_bf16_f32 v130, v128, v129
    buffer_store_dwordx4 v[132:135], v59, s[16:19], s25 offen sc1
    buffer_store_dword v130, v61, s[16:19], s26 offen sc1
    v_dot2c_f32_bf16 v136, v132, v215
    v_dot2c_f32_bf16 v137, v132, v132
    v_dot2c_f32_bf16 v136, v133, v215
    v_dot2c_f32_bf16 v137, v133, v133
    v_dot2c_f32_bf16 v138, v134, v215
    v_dot2c_f32_bf16 v139, v134, v134
    v_dot2c_f32_bf16 v138, v135, v215
    v_dot2c_f32_bf16 v139, v135, v135
    v_dot2c_f32_bf16 v140, v130, v215
    v_dot2c_f32_bf16 v141, v130, v130
    v_permlane32_swap_b32 v136, v138
    v_permlane32_swap_b32 v137, v139
    v_pk_add_f32 v[136:137], v[136:137], v[138:139]
    v_pk_add_f32 v[136:137], v[136:137], v[140:141]
    s_nop 1
    v_permlane16_swap_b32 v136, v137
    v_add_f32 v136, v136, v137
    ds_write_b32 v206, v136 offset:32768
    s_waitcnt lgkmcnt(0)
    s_barrier
    ds_read2st64_b32 v[136:137], v207 offset0:0 offset1:1
    ds_read2st64_b32 v[138:139], v207 offset0:2 offset1:3
    s_waitcnt lgkmcnt(0)
    v_pk_add_f32 v[136:137], v[136:137], v[138:139]
    v_add_f32 v136, v136, v137
    v_cndmask_b32 v136, v136, 1.0, s[28:29]
    s_mov_b64 exec, s[80:81]
    buffer_atomic_add_f32 v136, v214, s[16:19], s27 offen
    s_mov_b64 exec, -1
    s_cmp_ge_u32 s2, 160
    s_cbranch_scc1 nc_26
    s_waitcnt vmcnt(3)
ce_28:
    v_max3_u32 v208, v176, v177, v178
    v_max3_u32 v208, v208, v179, v180
    v_max3_u32 v208, v208, v181, v182
    v_max_u32 v208, v208, v183
    v_cmp_eq_u32 s[82:83], -1, v208
    v_min3_f32 v209, v184, v187, v188
    v_min3_f32 v209, v209, v191, v192
    v_min3_f32 v209, v209, v195, v196
    v_min_f32 v209, v209, v199
    v_cmp_neq_f32 vcc, 0x41000000, v209
    s_nop 0
    s_or_b64 vcc, vcc, s[82:83]
    s_cbranch_vccnz rd_29
rc_30:
    v_mul_f32 v208, 0x3acccccd, v185
    v_mul_f32 v209, 0x3acccccd, v189
    v_mul_f32 v186, 0x3acccccd, v186
    v_mul_f32 v190, 0x3acccccd, v190
    v_fma_f32 v186, -v208, v208, v186
    v_fma_f32 v190, -v209, v209, v190
    v_max_f32 v186, 0, v186
    v_max_f32 v190, 0, v190
    v_add_f32 v186, 0x3727c5ac, v186
    v_add_f32 v190, 0x3727c5ac, v190
    v_rsq_f32 v185, v186
    v_rsq_f32 v189, v190
    v_mul_f32 v186, -v208, v185
    v_mul_f32 v190, -v209, v189
    v_lshlrev_b32 v80, 16, v176
    v_and_b32 v82, 0xffff0000, v176
    v_lshlrev_b32 v84, 16, v177
    v_and_b32 v86, 0xffff0000, v177
    v_lshlrev_b32 v81, 16, v178
    v_and_b32 v83, 0xffff0000, v178
    v_lshlrev_b32 v85, 16, v179
    v_and_b32 v87, 0xffff0000, v179
    v_fma_f32 v208, v80, v185, v186
    v_fma_f32 v209, v81, v189, v190
    v_cvt_pk_bf16_f32 v176, v208, v209
    v_fma_f32 v208, v82, v185, v186
    v_fma_f32 v209, v83, v189, v190
    v_cvt_pk_bf16_f32 v177, v208, v209
    v_fma_f32 v208, v84, v185, v186
    v_fma_f32 v209, v85, v189, v190
    v_cvt_pk_bf16_f32 v178, v208, v209
    v_fma_f32 v208, v86, v185, v186
    v_fma_f32 v209, v87, v189, v190
    v_cvt_pk_bf16_f32 v179, v208, v209
    ds_write_b32 v63, v176 offset:0
    ds_write_b32 v63, v177 offset:4864
    ds_write_b32 v63, v178 offset:9728
    ds_write_b32 v63, v179 offset:14592
    v_mul_f32 v208, 0x3acccccd, v193
    v_mul_f32 v209, 0x3acccccd, v197
    v_mul_f32 v194, 0x3acccccd, v194
    v_mul_f32 v198, 0x3acccccd, v198
    v_fma_f32 v194, -v208, v208, v194
    v_fma_f32 v198, -v209, v209, v198
    v_max_f32 v194, 0, v194
    v_max_f32 v198, 0, v198
    v_add_f32 v194, 0x3727c5ac, v194
    v_add_f32 v198, 0x3727c5ac, v198
    v_rsq_f32 v193, v194
    v_rsq_f32 v197, v198
    v_mul_f32 v194, -v208, v193
    v_mul_f32 v198, -v209, v197
    v_lshlrev_b32 v88, 16, v180
    v_and_b32 v90, 0xffff0000, v180
    v_lshlrev_b32 v92, 16, v181
    v_and_b32 v94, 0xffff0000, v181
    v_lshlrev_b32 v89, 16, v182
    v_and_b32 v91, 0xffff0000, v182
    v_lshlrev_b32 v93, 16, v183
    v_and_b32 v95, 0xffff0000, v183
    v_fma_f32 v208, v88, v193, v194
    v_fma_f32 v209, v89, v197, v198
    v_cvt_pk_bf16_f32 v180, v208, v209
    v_fma_f32 v208, v90, v193, v194
    v_fma_f32 v209, v91, v197, v198
    v_cvt_pk_bf16_f32 v181, v208, v209
    v_fma_f32 v208, v92, v193, v194
    v_fma_f32 v209, v93, v197, v198
    v_cvt_pk_bf16_f32 v182, v208, v209
    v_fma_f32 v208, v94, v193, v194
    v_fma_f32 v209, v95, v197, v198
    v_cvt_pk_bf16_f32 v183, v208, v209
    ds_write_b32 v63, v180 offset:256
    ds_write_b32 v63, v181 offset:5120
    ds_write_b32 v63, v182 offset:9984
    ds_write_b32 v63, v183 offset:14848
    s_waitcnt lgkmcnt(0)
    s_barrier
    ds_read_b128 v[212:215], v64 offset:96
    ds_read_b128 v[216:219], v64 offset:64
    ds_read_b128 v[220:223], v64 offset:32
    ds_read_b128 v[224:227], v64 offset:0
    s_waitcnt lgkmcnt(3)
    v_mfma_f32_32x32x16_bf16 v[96:111], v[212:215], v[144:147], 0
    ds_read_b128 v[228:231], v64 offset:224
    ds_read_b64_tr_b16 v[176:177], v65 offset:1056
    ds_read_b64_tr_b16 v[178:179], v65 offset:1024
    ds_read_b64_tr_b16 v[180:181], v65 offset:1184
    ds_read_b64_tr_b16 v[182:183], v65 offset:1152
    s_waitcnt lgkmcnt(7)
    v_mfma_f32_32x32x16_bf16 v[96:111], v[216:219], v[148:151], v[96:111]
    ds_read_b128 v[232:235], v64 offset:192
    ds_read_b64_tr_b16 v[184:185], v65 offset:1312
    ds_read_b64_tr_b16 v[186:187], v65 offset:1280
    ds_read_b64_tr_b16 v[188:189], v65 offset:1440
    ds_read_b64_tr_b16 v[190:191], v65 offset:1408
    s_waitcnt lgkmcnt(11)
    v_mfma_f32_32x32x16_bf16 v[96:111], v[220:223], v[152:155], v[96:111]
    ds_read_b128 v[236:239], v64 offset:160
    ds_read_b64_tr_b16 v[192:193], v65 offset:1568
    ds_read_b64_tr_b16 v[194:195], v65 offset:1536
    ds_read_b64_tr_b16 v[196:197], v65 offset:1696
    ds_read_b64_tr_b16 v[198:199], v65 offset:1664
    s_waitcnt lgkmcnt(15)
    v_mfma_f32_32x32x16_bf16 v[96:111], v[224:227], v[156:159], v[96:111]
    ds_read_b128 v[240:243], v64 offset:128
    ds_read_b64_tr_b16 v[200:201], v65 offset:1824
    ds_read_b64_tr_b16 v[202:203], v65 offset:1792
    ds_read_b64_tr_b16 v[204:205], v65 offset:1952
    ds_read_b64_tr_b16 v[206:207], v65 offset:1920
    s_waitcnt lgkmcnt(15)
    v_mfma_f32_32x32x16_bf16 v[112:127], v[228:231], v[144:147], 0
    v_mov_b32 v248, -1
    v_mov_b32 v249, -1
    v_mov_b32 v250, -1
    v_mov_b32 v251, -1
    s_lshl_b32 s88, s75, 14
    s_add_u32 s88, s88, 9437184
    buffer_store_dwordx4 v[248:251], v62, s[16:19], s88 offen offset:0 sc1
    s_waitcnt lgkmcnt(14)
    v_mfma_f32_32x32x16_bf16 v[112:127], v[232:235], v[148:151], v[112:127]
    v_cndmask_b32 v208, v99, v72, s[76:77]
    v_cndmask_b32 v209, v103, v99, s[76:77]
    v_cndmask_b32 v210, v107, v103, s[76:77]
    v_cndmask_b32 v211, v111, v107, s[76:77]
    v_mov_b32_e64 v72, v111
    s_waitcnt lgkmcnt(9)
    v_mfma_f32_32x32x16_bf16 v[112:127], v[236:239], v[152:155], v[112:127]
    v_add_f32_dpp v98, v208, v98 wave_ror:1 row_mask:0xf bank_mask:0xf
    v_add_f32_dpp v102, v209, v102 wave_ror:1 row_mask:0xf bank_mask:0xf
    v_add_f32_dpp v106, v210, v106 wave_ror:1 row_mask:0xf bank_mask:0xf
    v_add_f32_dpp v110, v211, v110 wave_ror:1 row_mask:0xf bank_mask:0xf
    v_cndmask_b32 v208, v98, v71, s[76:77]
    s_waitcnt lgkmcnt(4)
    v_mfma_f32_32x32x16_bf16 v[112:127], v[240:243], v[156:159], v[112:127]
    v_cndmask_b32 v209, v102, v98, s[76:77]
    v_cndmask_b32 v210, v106, v102, s[76:77]
    v_cndmask_b32 v211, v110, v106, s[76:77]
    v_mov_b32 v71, v110
    v_add_f32_dpp v97, v208, v97 wave_ror:1 row_mask:0xf bank_mask:0xf
    v_add_f32_dpp v101, v209, v101 wave_ror:1 row_mask:0xf bank_mask:0xf
    v_mfma_f32_32x32x16_bf16 v[112:127], v[212:215], v[160:163], v[112:127]
    ds_read_b128 v[244:247], v64 offset:352
    v_add_f32_dpp v105, v210, v105 wave_ror:1 row_mask:0xf bank_mask:0xf
    v_add_f32_dpp v109, v211, v109 wave_ror:1 row_mask:0xf bank_mask:0xf
    v_cndmask_b32 v208, v97, v70, s[76:77]
    v_cndmask_b32 v209, v101, v97, s[76:77]
    v_cndmask_b32 v210, v105, v101, s[76:77]
    v_mfma_f32_32x32x16_bf16 v[112:127], v[216:219], v[164:167], v[112:127]
    ds_read_b128 v[216:219], v64 offset:320
    v_cndmask_b32 v211, v109, v105, s[76:77]
    v_mov_b32_e64 v70, v109
    v_add_f32_dpp v96, v208, v96 wave_ror:1 row_mask:0xf bank_mask:0xf
    v_add_f32_dpp v100, v209, v100 wave_ror:1 row_mask:0xf bank_mask:0xf
    v_add_f32_dpp v104, v210, v104 wave_ror:1 row_mask:0xf bank_mask:0xf
    v_mfma_f32_32x32x16_bf16 v[112:127], v[220:223], v[168:171], v[112:127]
    ds_read_b128 v[220:223], v64 offset:288
    buffer_store_dwordx4 v[248:251], v62, s[16:19], s88 offen offset:1024 sc1
    v_add_f32_dpp v108, v211, v108 wave_ror:1 row_mask:0xf bank_mask:0xf
    v_mfma_f32_32x32x16_bf16 v[112:127], v[224:227], v[172:175], v[112:127]
    ds_read_b128 v[224:227], v64 offset:256
    ds_write_b32 v66, v96 offset:0
    ds_write_b32 v66, v100 offset:64
    s_waitcnt lgkmcnt(5)
    v_mfma_f32_32x32x16_bf16 v[128:143], v[244:247], v[144:147], 0
    ds_write_b32 v66, v104 offset:128
    ds_write_b32 v66, v108 offset:192
    s_nop 0
    s_waitcnt lgkmcnt(6)
    v_mfma_f32_32x32x16_bf16 v[128:143], v[216:219], v[148:151], v[128:143]
    s_nop 3
    v_cndmask_b32 v208, v115, v72, s[76:77]
    s_waitcnt lgkmcnt(5)
    v_mfma_f32_32x32x16_bf16 v[128:143], v[220:223], v[152:155], v[128:143]
    v_cndmask_b32 v209, v119, v115, s[76:77]
    v_cndmask_b32 v210, v123, v119, s[76:77]
    v_cndmask_b32 v211, v127, v123, s[76:77]
    v_mov_b32 v72, v127
    v_add_f32_dpp v114, v208, v114 wave_ror:1 row_mask:0xf bank_mask:0xf
    s_waitcnt lgkmcnt(4)
    v_mfma_f32_32x32x16_bf16 v[128:143], v[224:227], v[156:159], v[128:143]
    v_add_f32_dpp v118, v209, v118 wave_ror:1 row_mask:0xf bank_mask:0xf
    v_add_f32_dpp v122, v210, v122 wave_ror:1 row_mask:0xf bank_mask:0xf
    v_add_f32_dpp v126, v211, v126 wave_ror:1 row_mask:0xf bank_mask:0xf
    v_cndmask_b32 v208, v114, v71, s[76:77]
    v_cndmask_b32 v209, v118, v114, s[76:77]
    v_cndmask_b32 v210, v122, v118, s[76:77]
    v_mfma_f32_32x32x16_bf16 v[128:143], v[228:231], v[160:163], v[128:143]
    buffer_store_dwordx4 v[248:251], v62, s[16:19], s88 offen offset:2048 sc1
    v_cndmask_b32 v211, v126, v122, s[76:77]
    v_mov_b32 v71, v126
    v_add_f32_dpp v113, v208, v113 wave_ror:1 row_mask:0xf bank_mask:0xf
    v_add_f32_dpp v117, v209, v117 wave_ror:1 row_mask:0xf bank_mask:0xf
    v_add_f32_dpp v121, v210, v121 wave_ror:1 row_mask:0xf bank_mask:0xf
    v_mfma_f32_32x32x16_bf16 v[128:143], v[232:235], v[164:167], v[128:143]
    ds_read_b128 v[232:235], v64 offset:64
    v_add_f32_dpp v125, v211, v125 wave_ror:1 row_mask:0xf bank_mask:0xf
    v_cndmask_b32 v208, v113, v70, s[76:77]
    v_cndmask_b32 v209, v117, v113, s[76:77]
    v_cndmask_b32 v210, v121, v117, s[76:77]
    v_cndmask_b32 v211, v125, v121, s[76:77]
    v_mfma_f32_32x32x16_bf16 v[128:143], v[236:239], v[168:171], v[128:143]
    ds_read_b128 v[236:239], v64 offset:32
    v_mov_b32_e64 v70, v125
    v_add_f32_dpp v112, v208, v112 wave_ror:1 row_mask:0xf bank_mask:0xf
    v_add_f32_dpp v116, v209, v116 wave_ror:1 row_mask:0xf bank_mask:0xf
    v_add_f32_dpp v120, v210, v120 wave_ror:1 row_mask:0xf bank_mask:0xf
    v_add_f32_dpp v124, v211, v124 wave_ror:1 row_mask:0xf bank_mask:0xf
    v_mfma_f32_32x32x16_bf16 v[128:143], v[240:243], v[172:175], v[128:143]
    ds_read_b128 v[240:243], v64 offset:0
    ds_write_b32 v66, v112 offset:256
    ds_write_b32 v66, v116 offset:320
    v_mfma_f32_32x32x16_bf16 v[128:143], v[212:215], v[176:179], v[128:143]
    ds_read_b128 v[212:215], v64 offset:480
    ds_write_b32 v66, v120 offset:384
    ds_write_b32 v66, v124 offset:448
    s_waitcnt lgkmcnt(7)
    v_mfma_f32_32x32x16_bf16 v[128:143], v[232:235], v[180:183], v[128:143]
    ds_read_b128 v[232:235], v64 offset:448
    s_waitcnt lgkmcnt(7)
    v_mfma_f32_32x32x16_bf16 v[128:143], v[236:239], v[184:187], v[128:143]
    ds_read_b128 v[236:239], v64 offset:416
    buffer_store_dwordx4 v[248:251], v62, s[16:19], s88 offen offset:3072 sc1
    s_waitcnt lgkmcnt(7)
    v_mfma_f32_32x32x16_bf16 v[128:143], v[240:243], v[188:191], v[128:143]
    ds_read_b128 v[240:243], v64 offset:384
    s_nop 3
    s_waitcnt lgkmcnt(5)
    v_mfma_f32_32x32x16_bf16 v[112:127], v[212:215], v[144:147], 0
    s_nop 4
    s_waitcnt lgkmcnt(2)
    v_mfma_f32_32x32x16_bf16 v[112:127], v[232:235], v[148:151], v[112:127]
    v_cndmask_b32 v208, v131, v72, s[76:77]
    v_cndmask_b32 v209, v135, v131, s[76:77]
    v_cndmask_b32 v210, v139, v135, s[76:77]
    v_cndmask_b32 v211, v143, v139, s[76:77]
    v_mov_b32_e64 v72, v143
    s_waitcnt lgkmcnt(1)
    v_mfma_f32_32x32x16_bf16 v[112:127], v[236:239], v[152:155], v[112:127]
    v_add_f32_dpp v130, v208, v130 wave_ror:1 row_mask:0xf bank_mask:0xf
    v_add_f32_dpp v134, v209, v134 wave_ror:1 row_mask:0xf bank_mask:0xf
    v_add_f32_dpp v138, v210, v138 wave_ror:1 row_mask:0xf bank_mask:0xf
    v_add_f32_dpp v142, v211, v142 wave_ror:1 row_mask:0xf bank_mask:0xf
    v_cndmask_b32 v208, v130, v71, s[76:77]
    s_waitcnt lgkmcnt(0)
    v_mfma_f32_32x32x16_bf16 v[112:127], v[240:243], v[156:159], v[112:127]
    v_cndmask_b32 v209, v134, v130, s[76:77]
    v_cndmask_b32 v210, v138, v134, s[76:77]
    v_cndmask_b32 v211, v142, v138, s[76:77]
    v_mov_b32 v71, v142
    v_add_f32_dpp v129, v208, v129 wave_ror:1 row_mask:0xf bank_mask:0xf
    v_add_f32_dpp v133, v209, v133 wave_ror:1 row_mask:0xf bank_mask:0xf
    v_mfma_f32_32x32x16_bf16 v[112:127], v[244:247], v[160:163], v[112:127]
    v_add_f32_dpp v137, v210, v137 wave_ror:1 row_mask:0xf bank_mask:0xf
    v_add_f32_dpp v141, v211, v141 wave_ror:1 row_mask:0xf bank_mask:0xf
    v_cndmask_b32 v208, v129, v70, s[76:77]
    v_cndmask_b32 v209, v133, v129, s[76:77]
    v_cndmask_b32 v210, v137, v133, s[76:77]
    v_cndmask_b32 v211, v141, v137, s[76:77]
    v_mfma_f32_32x32x16_bf16 v[112:127], v[216:219], v[164:167], v[112:127]
    ds_read_b128 v[240:243], v64 offset:192
    v_mov_b32_e64 v70, v141
    v_add_f32_dpp v128, v208, v128 wave_ror:1 row_mask:0xf bank_mask:0xf
    v_add_f32_dpp v132, v209, v132 wave_ror:1 row_mask:0xf bank_mask:0xf
    v_add_f32_dpp v136, v210, v136 wave_ror:1 row_mask:0xf bank_mask:0xf
    v_add_f32_dpp v140, v211, v140 wave_ror:1 row_mask:0xf bank_mask:0xf
    v_mfma_f32_32x32x16_bf16 v[112:127], v[220:223], v[168:171], v[112:127]
    ds_read_b128 v[220:223], v64 offset:160
    ds_write_b32 v66, v128 offset:512
    ds_write_b32 v66, v132 offset:576
    v_mfma_f32_32x32x16_bf16 v[112:127], v[224:227], v[172:175], v[112:127]
    ds_read_b128 v[224:227], v64 offset:128
    ds_write_b32 v66, v136 offset:640
    ds_write_b32 v66, v140 offset:704
    v_mfma_f32_32x32x16_bf16 v[112:127], v[228:231], v[176:179], v[112:127]
    ds_read_b128 v[236:239], v64 offset:96
    s_waitcnt lgkmcnt(7)
    v_mfma_f32_32x32x16_bf16 v[112:127], v[240:243], v[180:183], v[112:127]
    ds_read_b128 v[240:243], v64 offset:64
    s_waitcnt lgkmcnt(7)
    v_mfma_f32_32x32x16_bf16 v[112:127], v[220:223], v[184:187], v[112:127]
    ds_read_b128 v[220:223], v64 offset:32
    s_waitcnt lgkmcnt(5)
    v_mfma_f32_32x32x16_bf16 v[112:127], v[224:227], v[188:191], v[112:127]
    ds_read_b128 v[224:227], v64 offset:0
    s_waitcnt lgkmcnt(3)
    v_mfma_f32_32x32x16_bf16 v[112:127], v[236:239], v[192:195], v[112:127]
    ds_read_b64_tr_b16 v[216:217], v65 offset:544
    ds_read_b64_tr_b16 v[218:219], v65 offset:512
    s_waitcnt lgkmcnt(4)
    v_mfma_f32_32x32x16_bf16 v[112:127], v[240:243], v[196:199], v[112:127]
    ds_read_b64_tr_b16 v[240:241], v65 offset:1056
    ds_read_b64_tr_b16 v[242:243], v65 offset:1024
    s_waitcnt lgkmcnt(5)
    v_mfma_f32_32x32x16_bf16 v[112:127], v[220:223], v[200:203], v[112:127]
    s_waitcnt lgkmcnt(4)
    v_mfma_f32_32x32x16_bf16 v[112:127], v[224:227], v[204:207], v[112:127]
    ds_read_b64_tr_b16 v[224:225], v65 offset:1568
    ds_read_b64_tr_b16 v[226:227], v65 offset:1536
    s_lshl_b32 s96, s75, 14
    s_add_u32 s96, s96, 6815744
    s_lshl_b32 s97, s24, 12
    s_add_u32 s97, s97, 3477504
    buffer_load_dwordx4 v[248:251], v62, s[16:19], s96 offen offset:2048 sc1
    s_waitcnt lgkmcnt(4)
    v_mfma_f32_32x32x16_bf16 v[144:159], v[212:215], v[216:219], 0
    s_nop 3
    v_cndmask_b32 v208, v115, v72, s[76:77]
    s_waitcnt lgkmcnt(2)
    v_mfma_f32_32x32x16_bf16 v[144:159], v[244:247], v[240:243], v[144:159]
    buffer_load_dwordx4 v[252:255], v62, s[16:19], s96 offen offset:3072 sc1
    v_cndmask_b32 v209, v119, v115, s[76:77]
    v_cndmask_b32 v210, v123, v119, s[76:77]
    v_cndmask_b32 v211, v127, v123, s[76:77]
    v_mov_b32_e64 v72, v127
    v_add_f32_dpp v114, v208, v114 wave_ror:1 row_mask:0xf bank_mask:0xf
    v_mfma_f32_32x32x16_bf16 v[160:175], v[212:215], v[240:243], 0
    ds_read_b64_tr_b16 v[216:217], v65 offset:2080
    ds_read_b64_tr_b16 v[218:219], v65 offset:2048
    v_add_f32_dpp v118, v209, v118 wave_ror:1 row_mask:0xf bank_mask:0xf
    v_add_f32_dpp v122, v210, v122 wave_ror:1 row_mask:0xf bank_mask:0xf
    v_add_f32_dpp v126, v211, v126 wave_ror:1 row_mask:0xf bank_mask:0xf
    s_waitcnt lgkmcnt(2)
    v_mfma_f32_32x32x16_bf16 v[144:159], v[228:231], v[224:227], v[144:159]
    buffer_load_dwordx4 v[96:99], v62, s[16:19], s97 offen offset:0 sc1
    v_cndmask_b32 v208, v114, v71, s[76:77]
    v_cndmask_b32 v209, v118, v114, s[76:77]
    v_cndmask_b32 v210, v122, v118, s[76:77]
    v_cndmask_b32 v211, v126, v122, s[76:77]
    v_mov_b32 v71, v126
    v_mfma_f32_32x32x16_bf16 v[160:175], v[244:247], v[224:227], v[160:175]
    v_add_f32_dpp v113, v208, v113 wave_ror:1 row_mask:0xf bank_mask:0xf
    v_add_f32_dpp v117, v209, v117 wave_ror:1 row_mask:0xf bank_mask:0xf
    v_add_f32_dpp v121, v210, v121 wave_ror:1 row_mask:0xf bank_mask:0xf
    v_add_f32_dpp v125, v211, v125 wave_ror:1 row_mask:0xf bank_mask:0xf
    v_cndmask_b32 v208, v113, v70, s[76:77]
    v_cndmask_b32 v209, v117, v113, s[76:77]
    v_mfma_f32_32x32x16_bf16 v[176:191], v[212:215], v[224:227], 0
    buffer_load_dwordx4 v[100:103], v62, s[16:19], s97 offen offset:1024 sc1
    v_cndmask_b32 v210, v121, v117, s[76:77]
    v_cndmask_b32 v211, v125, v121, s[76:77]
    v_mov_b32 v70, v125
    v_add_f32_dpp v112, v208, v112 wave_ror:1 row_mask:0xf bank_mask:0xf
    s_waitcnt lgkmcnt(0)
    v_mfma_f32_32x32x16_bf16 v[144:159], v[236:239], v[216:219], v[144:159]
    ds_read_b64_tr_b16 v[240:241], v65 offset:2592
    ds_read_b64_tr_b16 v[242:243], v65 offset:2560
    v_add_f32_dpp v116, v209, v116 wave_ror:1 row_mask:0xf bank_mask:0xf
    v_add_f32_dpp v120, v210, v120 wave_ror:1 row_mask:0xf bank_mask:0xf
    v_add_f32_dpp v124, v211, v124 wave_ror:1 row_mask:0xf bank_mask:0xf
    v_mfma_f32_32x32x16_bf16 v[160:175], v[228:231], v[216:219], v[160:175]
    buffer_load_dwordx4 v[104:107], v62, s[16:19], s97 offen offset:2048 sc1
    ds_write_b32 v66, v112 offset:768
    ds_write_b32 v66, v116 offset:832
    v_mfma_f32_32x32x16_bf16 v[176:191], v[244:247], v[216:219], v[176:191]
    ds_write_b32 v66, v120 offset:896
    ds_write_b32 v66, v124 offset:960
    v_mfma_f32_32x32x16_bf16 v[192:207], v[212:215], v[216:219], 0
    ds_read_b64_tr_b16 v[212:213], v65 offset:3104
    ds_read_b64_tr_b16 v[214:215], v65 offset:3072
    buffer_load_dwordx4 v[108:111], v62, s[16:19], s97 offen offset:3072 sc1
    s_waitcnt lgkmcnt(6)
    v_mfma_f32_32x32x16_bf16 v[160:175], v[236:239], v[240:243], v[160:175]
    v_mfma_f32_32x32x16_bf16 v[176:191], v[228:231], v[240:243], v[176:191]
    ds_read_b64_tr_b16 v[224:225], v65 offset:3616
    ds_read_b64_tr_b16 v[226:227], v65 offset:3584
    s_waitcnt vmcnt(6) lgkmcnt(4)
    s_barrier
    v_mfma_f32_32x32x16_bf16 v[192:207], v[244:247], v[240:243], v[192:207]
    ds_read_b64_tr_b16 v[244:245], v65 offset:672
    ds_read_b64_tr_b16 v[246:247], v65 offset:640
    ds_read_b64 v[112:113], v67 offset:0
    ds_read_b64 v[114:115], v67 offset:4224
    ds_read_b64 v[116:117], v67 offset:8448
    s_waitcnt lgkmcnt(7)
    v_mfma_f32_32x32x16_bf16 v[176:191], v[236:239], v[212:215], v[176:191]
    ds_read_b128 v[216:219], v64 offset:320
    ds_read_b64_tr_b16 v[240:241], v65 offset:1184
    ds_read_b64_tr_b16 v[242:243], v65 offset:1152
    ds_read_b64 v[118:119], v67 offset:12672
    ds_read_b64 v[120:121], v67 offset:512
    ds_read_b64 v[122:123], v67 offset:4736
    v_mfma_f32_32x32x16_bf16 v[192:207], v[228:231], v[212:215], v[192:207]
    ds_read_b64 v[124:125], v67 offset:8960
    ds_read_b64 v[126:127], v67 offset:13184
    s_lshl_b32 s25, s75, 14
    s_add_u32 s25, s25, 9437184
    s_waitcnt lgkmcnt(13)
    v_mfma_f32_32x32x16_bf16 v[192:207], v[236:239], v[224:227], v[192:207]
    ds_read_b128 v[228:231], v64 offset:192
    ds_read_b64_tr_b16 v[236:237], v65 offset:1696
    ds_read_b64_tr_b16 v[238:239], v65 offset:1664
    s_waitcnt lgkmcnt(14)
    v_mfma_f32_32x32x16_bf16 v[144:159], v[232:235], v[244:247], v[144:159]
    v_mov_b32 v5, 1
    s_add_u32 s82, s86, 24576
    buffer_atomic_add v5, v6, s[16:19], s82 offen offset:0 sc0 sc1
    s_waitcnt lgkmcnt(8)
    v_mfma_f32_32x32x16_bf16 v[144:159], v[216:219], v[240:243], v[144:159]
    v_mfma_f32_32x32x16_bf16 v[160:175], v[232:235], v[240:243], v[160:175]
    ds_read_b128 v[212:215], v64 offset:64
    ds_read_b64_tr_b16 v[224:225], v65 offset:2208
    ds_read_b64_tr_b16 v[226:227], v65 offset:2176
    s_waitcnt lgkmcnt(3)
    v_mfma_f32_32x32x16_bf16 v[144:159], v[228:231], v[236:239], v[144:159]
    v_mfma_f32_32x32x16_bf16 v[160:175], v[216:219], v[236:239], v[160:175]
    v_add_f32 v112, v112, v80
    v_add_f32 v113, v113, v81
    v_add_f32 v114, v114, v82
    v_add_f32 v115, v115, v83
    v_add_f32 v116, v116, v84
    v_mfma_f32_32x32x16_bf16 v[176:191], v[232:235], v[236:239], v[176:191]
    v_add_f32 v117, v117, v85
    v_add_f32 v118, v118, v86
    v_add_f32 v119, v119, v87
    v_cvt_pk_bf16_f32 v128, v112, v114
    v_cvt_pk_bf16_f32 v129, v116, v118
    s_waitcnt lgkmcnt(0)
    v_mfma_f32_32x32x16_bf16 v[144:159], v[212:215], v[224:227], v[144:159]
    ds_read_b64_tr_b16 v[244:245], v65 offset:2720
    ds_read_b64_tr_b16 v[246:247], v65 offset:2688
    v_cvt_pk_bf16_f32 v130, v113, v115
    v_cvt_pk_bf16_f32 v131, v117, v119
    v_mfma_f32_32x32x16_bf16 v[160:175], v[228:231], v[224:227], v[160:175]
    buffer_store_dwordx4 v[128:131], v62, s[16:19], s25 offen offset:0 sc1
    v_add_f32 v120, v120, v88
    v_add_f32 v121, v121, v89
    v_add_f32 v122, v122, v90
    v_add_f32 v123, v123, v91
    v_add_f32 v124, v124, v92
    v_mfma_f32_32x32x16_bf16 v[176:191], v[216:219], v[224:227], v[176:191]
    v_add_f32 v125, v125, v93
    v_add_f32 v126, v126, v94
    v_add_f32_e64 v127, v127, v95
    v_cvt_pk_bf16_f32 v132, v120, v122
    v_cvt_pk_bf16_f32 v133, v124, v126
    v_cvt_pk_bf16_f32 v134, v121, v123
    v_mfma_f32_32x32x16_bf16 v[192:207], v[232:235], v[224:227], v[192:207]
    ds_read_b64_tr_b16 v[232:233], v65 offset:3232
    ds_read_b64_tr_b16 v[234:235], v65 offset:3200
    v_cvt_pk_bf16_f32 v135, v125, v127
    s_waitcnt lgkmcnt(2)
    v_mfma_f32_32x32x16_bf16 v[160:175], v[212:215], v[244:247], v[160:175]
    buffer_store_dwordx4 v[132:135], v62, s[16:19], s25 offen offset:1024 sc1
    ds_read_b64_tr_b16 v[112:113], v65 offset:32
    ds_read_b64_tr_b16 v[114:115], v65 offset:0
    ds_read_b64_tr_b16 v[116:117], v65 offset:160
    ds_read_b64_tr_b16 v[118:119], v65 offset:128
    ds_read_b64_tr_b16 v[120:121], v65 offset:288
    v_mfma_f32_32x32x16_bf16 v[176:191], v[228:231], v[244:247], v[176:191]
    ds_read_b64_tr_b16 v[240:241], v65 offset:3744
    ds_read_b64_tr_b16 v[242:243], v65 offset:3712
    ds_read_b64_tr_b16 v[122:123], v65 offset:256
    ds_read_b64_tr_b16 v[124:125], v65 offset:416
    ds_read_b64_tr_b16 v[126:127], v65 offset:384
    ds_read_b64_tr_b16 v[128:129], v65 offset:544
    v_mfma_f32_32x32x16_bf16 v[192:207], v[216:219], v[244:247], v[192:207]
    ds_read_b128 v[216:219], v64 offset:416
    ds_read_b64_tr_b16 v[236:237], v65 offset:800
    ds_read_b64_tr_b16 v[238:239], v65 offset:768
    ds_read_b64_tr_b16 v[130:131], v65 offset:512
    ds_read_b64_tr_b16 v[132:133], v65 offset:672
    s_waitcnt lgkmcnt(15)
    v_mfma_f32_32x32x16_bf16 v[176:191], v[212:215], v[232:235], v[176:191]
    ds_read_b128 v[224:227], v64 offset:288
    ds_read_b64_tr_b16 v[244:245], v65 offset:1312
    ds_read_b64_tr_b16 v[246:247], v65 offset:1280
    ds_read_b64_tr_b16 v[134:135], v65 offset:640
    ds_read_b64_tr_b16 v[136:137], v65 offset:800
    ds_read_b64_tr_b16 v[138:139], v65 offset:768
    v_mfma_f32_32x32x16_bf16 v[192:207], v[228:231], v[232:235], v[192:207]
    ds_read_b64_tr_b16 v[140:141], v65 offset:928
    ds_read_b64_tr_b16 v[142:143], v65 offset:896
    s_waitcnt lgkmcnt(15)
    v_mfma_f32_32x32x16_bf16 v[192:207], v[212:215], v[240:243], v[192:207]
    ds_read_b128 v[228:231], v64 offset:160
    ds_read_b64_tr_b16 v[212:213], v65 offset:1824
    ds_read_b64_tr_b16 v[214:215], v65 offset:1792
    s_waitcnt vmcnt(3)
ce_31:
    v_max3_u32 v208, v248, v249, v250
    v_max3_u32 v208, v208, v251, v252
    v_max3_u32 v208, v208, v253, v254
    v_max_u32_e64 v208, v208, v255
    v_cmp_eq_u32 s[82:83], -1, v208
    v_min3_f32 v209, v96, v99, v100
    v_min3_f32 v209, v209, v103, v104
    v_min3_f32 v209, v209, v107, v108
    v_min_f32 v209, v209, v111
    v_cmp_neq_f32 vcc, 0x41000000, v209
    s_nop 0
    s_or_b64 vcc, vcc, s[82:83]
    s_cbranch_vccnz rd_32
rc_33:
    s_waitcnt lgkmcnt(13)
    v_mfma_f32_32x32x16_bf16 v[144:159], v[216:219], v[236:239], v[144:159]
    v_mul_f32 v208, 0x3acccccd, v97
    v_mul_f32 v209, 0x3acccccd, v101
    v_mul_f32 v98, 0x3acccccd, v98
    v_mul_f32 v102, 0x3acccccd, v102
    v_fma_f32 v98, -v208, v208, v98
    s_waitcnt lgkmcnt(8)
    v_mfma_f32_32x32x16_bf16 v[144:159], v[224:227], v[244:247], v[144:159]
    v_fma_f32 v102, -v209, v209, v102
    v_max_f32 v98, 0, v98
    v_max_f32 v102, 0, v102
    v_add_f32 v98, 0x3727c5ac, v98
    v_add_f32 v102, 0x3727c5ac, v102
    v_mfma_f32_32x32x16_bf16 v[160:175], v[216:219], v[244:247], v[160:175]
    ds_read_b64_tr_b16 v[232:233], v65 offset:2336
    ds_read_b64_tr_b16 v[234:235], v65 offset:2304
    v_rsq_f32 v97, v98
    s_waitcnt lgkmcnt(2)
    v_mfma_f32_32x32x16_bf16 v[144:159], v[228:231], v[212:215], v[144:159]
    v_rsq_f32_e64 v101, v102
    v_mul_f32 v98, -v208, v97
    v_mul_f32 v102, -v209, v101
    v_lshlrev_b32_e64 v80, 16, v248
    v_and_b32 v82, 0xffff0000, v248
    v_mfma_f32_32x32x16_bf16 v[160:175], v[224:227], v[212:215], v[160:175]
    v_lshlrev_b32 v84, 16, v249
    v_and_b32 v86, 0xffff0000, v249
    v_lshlrev_b32 v81, 16, v250
    v_and_b32 v83, 0xffff0000, v250
    v_lshlrev_b32_e64 v85, 16, v251
    v_and_b32 v87, 0xffff0000, v251
    v_mfma_f32_32x32x16_bf16 v[176:191], v[216:219], v[212:215], v[176:191]
    v_fma_f32 v208, v80, v97, v98
    v_fma_f32 v209, v81, v101, v102
    v_cvt_pk_bf16_f32 v248, v208, v209
    v_fma_f32 v208, v82, v97, v98
    v_fma_f32 v209, v83, v101, v102
    s_waitcnt lgkmcnt(0)
    v_mfma_f32_32x32x16_bf16 v[144:159], v[220:223], v[232:235], v[144:159]
    ds_read_b64_tr_b16 v[240:241], v65 offset:2848
    ds_read_b64_tr_b16 v[242:243], v65 offset:2816
    v_cvt_pk_bf16_f32 v249, v208, v209
    v_fma_f32 v208, v84, v97, v98
    v_fma_f32 v209, v85, v101, v102
    v_cvt_pk_bf16_f32 v250, v208, v209
    v_mfma_f32_32x32x16_bf16 v[160:175], v[228:231], v[232:235], v[160:175]
    v_fma_f32 v208, v86, v97, v98
    v_fma_f32 v209, v87, v101, v102
    v_cvt_pk_bf16_f32 v251, v208, v209
    v_mfma_f32_32x32x16_bf16 v[176:191], v[224:227], v[232:235], v[176:191]
    ds_write_b32 v63, v248 offset:512
    ds_write_b32 v63, v249 offset:5376
    ds_write_b32 v63, v250 offset:10240
    v_mfma_f32_32x32x16_bf16 v[192:207], v[216:219], v[232:235], v[192:207]
    ds_read_b64_tr_b16 v[216:217], v65 offset:3360
    ds_read_b64_tr_b16 v[218:219], v65 offset:3328
    ds_write_b32 v63, v251 offset:15104
    v_mul_f32 v208, 0x3acccccd, v105
    s_waitcnt lgkmcnt(6)
    v_mfma_f32_32x32x16_bf16 v[160:175], v[220:223], v[240:243], v[160:175]
    v_mul_f32 v209, 0x3acccccd, v109
    v_mul_f32 v106, 0x3acccccd, v106
    v_mul_f32 v110, 0x3acccccd, v110
    v_fma_f32 v106, -v208, v208, v106
    v_fma_f32 v110, -v209, v209, v110
    v_max_f32_e64 v106, 0, v106
    v_mfma_f32_32x32x16_bf16 v[176:191], v[228:231], v[240:243], v[176:191]
    ds_read_b64_tr_b16 v[236:237], v65 offset:3872
    ds_read_b64_tr_b16 v[238:239], v65 offset:3840
    v_max_f32_e64 v110, 0, v110
    v_add_f32 v106, 0x3727c5ac, v106
    v_add_f32 v110, 0x3727c5ac, v110
    v_mfma_f32_32x32x16_bf16 v[192:207], v[224:227], v[240:243], v[192:207]
    ds_read_b128 v[224:227], v64 offset:384
    ds_read_b64_tr_b16 v[244:245], v65 offset:928
    ds_read_b64_tr_b16 v[246:247], v65 offset:896
    v_rsq_f32 v105, v106
    s_waitcnt lgkmcnt(6)
    v_mfma_f32_32x32x16_bf16 v[176:191], v[220:223], v[216:219], v[176:191]
    ds_read_b128 v[212:215], v64 offset:256
    ds_read_b64_tr_b16 v[232:233], v65 offset:1440
    ds_read_b64_tr_b16 v[234:235], v65 offset:1408
    v_rsq_f32_e64 v109, v110
    v_mul_f32 v106, -v208, v105
    v_mfma_f32_32x32x16_bf16 v[192:207], v[228:231], v[216:219], v[192:207]
    v_mul_f32 v110, -v209, v109
    v_lshlrev_b32 v88, 16, v252
    v_and_b32 v90, 0xffff0000, v252
    v_lshlrev_b32 v92, 16, v253
    v_and_b32 v94, 0xffff0000, v253
    s_waitcnt lgkmcnt(6)
    v_mfma_f32_32x32x16_bf16 v[192:207], v[220:223], v[236:239], v[192:207]
    ds_read_b128 v[220:223], v64 offset:128
    ds_read_b64_tr_b16 v[228:229], v65 offset:1952
    ds_read_b64_tr_b16 v[230:231], v65 offset:1920
    v_lshlrev_b32 v89, 16, v254
    v_and_b32 v91, 0xffff0000, v254
    s_waitcnt lgkmcnt(6)
    v_mfma_f32_32x32x16_bf16 v[144:159], v[224:227], v[244:247], v[144:159]
    v_lshlrev_b32 v93, 16, v255
    v_and_b32 v95, 0xffff0000, v255
    v_fma_f32 v208, v88, v105, v106
    v_fma_f32 v209, v89, v109, v110
    v_cvt_pk_bf16_f32 v252, v208, v209
    s_waitcnt lgkmcnt(3)
    v_mfma_f32_32x32x16_bf16 v[144:159], v[212:215], v[232:235], v[144:159]
    v_fma_f32 v208, v90, v105, v106
    v_fma_f32 v209, v91, v109, v110
    v_cvt_pk_bf16_f32 v253, v208, v209
    v_fma_f32 v208, v92, v105, v106
    v_fma_f32 v209, v93, v109, v110
    v_cvt_pk_bf16_f32 v254, v208, v209
    v_mfma_f32_32x32x16_bf16 v[160:175], v[224:227], v[232:235], v[160:175]
    ds_read_b128 v[240:243], v64 offset:0
    ds_read_b64_tr_b16 v[216:217], v65 offset:2464
    ds_read_b64_tr_b16 v[218:219], v65 offset:2432
    v_fma_f32 v208, v94, v105, v106
    v_fma_f32 v209, v95, v109, v110
    s_waitcnt lgkmcnt(3)
    v_mfma_f32_32x32x16_bf16 v[144:159], v[220:223], v[228:231], v[144:159]
    v_cvt_pk_bf16_f32 v255, v208, v209
    ds_write_b32 v63, v252 offset:768
    v_mfma_f32_32x32x16_bf16 v[160:175], v[212:215], v[228:231], v[160:175]
    ds_write_b32 v63, v253 offset:5632
    ds_write_b32 v63, v254 offset:10496
    ds_write_b32 v63, v255 offset:15360
    v_mfma_f32_32x32x16_bf16 v[176:191], v[224:227], v[228:231], v[176:191]
    s_waitcnt vmcnt(2)
    v_cmp_eq_u32 vcc, 19, v5
    s_nop 0
    s_cbranch_vccnz gl_34
gc_35:
    s_lshl_b32 s25, s72, 5
    s_add_u32 s25, s25, 0
    s_sub_u32 s26, s25, 4
    s_waitcnt lgkmcnt(4)
    v_mfma_f32_32x32x16_bf16 v[144:159], v[240:243], v[216:219], v[144:159]
    ds_read_b64_tr_b16 v[236:237], v65 offset:2976
    ds_read_b64_tr_b16 v[238:239], v65 offset:2944
    s_max_i32 s26, s26, 0
    s_lshl_b32 s27, s71, 12
    s_add_u32 s27, s27, 9437184
    s_lshl_b32 s99, s25, 3
    v_mfma_f32_32x32x16_bf16 v[160:175], v[220:223], v[216:219], v[160:175]
    s_lshl_b32 s100, s26, 3
    s_lshl_b32 s92, s24, 12
    s_lshl_b32 s93, s24, 9
    s_add_u32 s99, s99, s27
    s_add_u32 s100, s100, s27
    v_mfma_f32_32x32x16_bf16 v[176:191], v[212:215], v[216:219], v[176:191]
    v_mfma_f32_32x32x16_bf16 v[192:207], v[224:227], v[216:219], v[192:207]
    ds_read_b64_tr_b16 v[224:225], v65 offset:3488
    ds_read_b64_tr_b16 v[226:227], v65 offset:3456
    s_waitcnt lgkmcnt(2)
    v_mfma_f32_32x32x16_bf16 v[160:175], v[240:243], v[236:239], v[160:175]
    v_mfma_f32_32x32x16_bf16 v[176:191], v[220:223], v[236:239], v[176:191]
    ds_read_b64_tr_b16 v[244:245], v65 offset:4000
    ds_read_b64_tr_b16 v[246:247], v65 offset:3968
    v_mfma_f32_32x32x16_bf16 v[192:207], v[212:215], v[236:239], v[192:207]
    s_waitcnt lgkmcnt(2)
    v_mfma_f32_32x32x16_bf16 v[176:191], v[240:243], v[224:227], v[176:191]
    v_mfma_f32_32x32x16_bf16 v[192:207], v[220:223], v[224:227], v[192:207]
    s_waitcnt lgkmcnt(0)
    v_mfma_f32_32x32x16_bf16 v[192:207], v[240:243], v[244:247], v[192:207]
    s_waitcnt lgkmcnt(0)
    s_barrier
    ds_read_b128 v[212:215], v64 offset:608
    ds_read_b128 v[216:219], v64 offset:576
    ds_read_b128 v[220:223], v64 offset:544
    ds_read_b128 v[224:227], v64 offset:512
    s_waitcnt lgkmcnt(3)
    v_mfma_f32_32x32x16_bf16 v[144:159], v[212:215], v[112:115], v[144:159]
    ds_read_b128 v[228:231], v64 offset:736
    s_waitcnt lgkmcnt(3)
    v_mfma_f32_32x32x16_bf16 v[144:159], v[216:219], v[116:119], v[144:159]
    ds_read_b128 v[232:235], v64 offset:704
    s_waitcnt lgkmcnt(3)
    v_mfma_f32_32x32x16_bf16 v[144:159], v[220:223], v[120:123], v[144:159]
    ds_read_b128 v[236:239], v64 offset:672
    s_waitcnt lgkmcnt(3)
    v_mfma_f32_32x32x16_bf16 v[144:159], v[224:227], v[124:127], v[144:159]
    ds_read_b128 v[240:243], v64 offset:640
    s_nop 3
    s_waitcnt lgkmcnt(3)
    v_mfma_f32_32x32x16_bf16 v[160:175], v[228:231], v[112:115], v[160:175]
    s_nop 4
    s_waitcnt lgkmcnt(2)
    v_mfma_f32_32x32x16_bf16 v[160:175], v[232:235], v[116:119], v[160:175]
    v_cndmask_b32 v208, v147, v72, s[76:77]
    v_cndmask_b32 v209, v151, v147, s[76:77]
    v_cndmask_b32 v210, v155, v151, s[76:77]
    v_cndmask_b32 v211, v159, v155, s[76:77]
    v_mov_b32_e64 v72, v159
    s_waitcnt lgkmcnt(1)
    v_mfma_f32_32x32x16_bf16 v[160:175], v[236:239], v[120:123], v[160:175]
    v_add_f32_dpp v146, v208, v146 wave_ror:1 row_mask:0xf bank_mask:0xf
    v_add_f32_dpp v150, v209, v150 wave_ror:1 row_mask:0xf bank_mask:0xf
    v_add_f32_dpp v154, v210, v154 wave_ror:1 row_mask:0xf bank_mask:0xf
    v_add_f32_dpp v158, v211, v158 wave_ror:1 row_mask:0xf bank_mask:0xf
    v_cndmask_b32 v208, v146, v71, s[76:77]
    s_waitcnt lgkmcnt(0)
    v_mfma_f32_32x32x16_bf16 v[160:175], v[240:243], v[124:127], v[160:175]
    v_cndmask_b32 v209, v150, v146, s[76:77]
    v_cndmask_b32 v210, v154, v150, s[76:77]
    v_cndmask_b32 v211, v158, v154, s[76:77]
    v_mov_b32 v71, v158
    v_add_f32_dpp v145, v208, v145 wave_ror:1 row_mask:0xf bank_mask:0xf
    v_add_f32_dpp v149, v209, v149 wave_ror:1 row_mask:0xf bank_mask:0xf
    v_mfma_f32_32x32x16_bf16 v[160:175], v[212:215], v[128:131], v[160:175]
    ds_read_b128 v[244:247], v64 offset:864
    v_add_f32_dpp v153, v210, v153 wave_ror:1 row_mask:0xf bank_mask:0xf
    v_add_f32_dpp v157, v211, v157 wave_ror:1 row_mask:0xf bank_mask:0xf
    v_cndmask_b32 v208, v145, v70, s[76:77]
    v_cndmask_b32 v209, v149, v145, s[76:77]
    v_cndmask_b32 v210, v153, v149, s[76:77]
    v_mfma_f32_32x32x16_bf16 v[160:175], v[216:219], v[132:135], v[160:175]
    ds_read_b128 v[248:251], v64 offset:832
    v_cndmask_b32 v211, v157, v153, s[76:77]
    v_mov_b32_e64 v70, v157
    v_add_f32_dpp v144, v208, v144 wave_ror:1 row_mask:0xf bank_mask:0xf
    v_add_f32_dpp v148, v209, v148 wave_ror:1 row_mask:0xf bank_mask:0xf
    v_add_f32_dpp v152, v210, v152 wave_ror:1 row_mask:0xf bank_mask:0xf
    v_mfma_f32_32x32x16_bf16 v[160:175], v[220:223], v[136:139], v[160:175]
    ds_read_b128 v[252:255], v64 offset:800
    v_add_f32_dpp v156, v211, v156 wave_ror:1 row_mask:0xf bank_mask:0xf
    ds_write_b32 v66, v144 offset:0
    v_mfma_f32_32x32x16_bf16 v[160:175], v[224:227], v[140:143], v[160:175]
    ds_read_b128 v[224:227], v64 offset:768
    ds_write_b32 v66, v148 offset:64
    ds_write_b32 v66, v152 offset:128
    s_waitcnt lgkmcnt(6)
    v_mfma_f32_32x32x16_bf16 v[176:191], v[244:247], v[112:115], v[176:191]
    ds_write_b32 v66, v156 offset:192
    buffer_load_dword v7, v4, s[16:19], s89 offen offset:0 sc1
    s_nop 1
    s_waitcnt lgkmcnt(6)
    v_mfma_f32_32x32x16_bf16 v[176:191], v[248:251], v[116:119], v[176:191]
    s_nop 2
    v_cndmask_b32 v208, v163, v72, s[76:77]
    v_cndmask_b32 v209, v167, v163, s[76:77]
    s_waitcnt lgkmcnt(5)
    v_mfma_f32_32x32x16_bf16 v[176:191], v[252:255], v[120:123], v[176:191]
    v_cndmask_b32 v210, v171, v167, s[76:77]
    v_cndmask_b32 v211, v175, v171, s[76:77]
    v_mov_b32 v72, v175
    v_add_f32_dpp v162, v208, v162 wave_ror:1 row_mask:0xf bank_mask:0xf
    v_add_f32_dpp v166, v209, v166 wave_ror:1 row_mask:0xf bank_mask:0xf
    s_waitcnt lgkmcnt(3)
    v_mfma_f32_32x32x16_bf16 v[176:191], v[224:227], v[124:127], v[176:191]
    v_add_f32_dpp v170, v210, v170 wave_ror:1 row_mask:0xf bank_mask:0xf
    v_add_f32_dpp v174, v211, v174 wave_ror:1 row_mask:0xf bank_mask:0xf
    v_cndmask_b32 v208, v162, v71, s[76:77]
    v_cndmask_b32 v209, v166, v162, s[76:77]
    v_cndmask_b32 v210, v170, v166, s[76:77]
    v_cndmask_b32 v211, v174, v170, s[76:77]
    v_mfma_f32_32x32x16_bf16 v[176:191], v[228:231], v[128:131], v[176:191]
    ds_read_b64_tr_b16 v[228:229], v65 offset:1056
    ds_read_b64_tr_b16 v[230:231], v65 offset:1024
    v_mov_b32 v71, v174
    v_add_f32_dpp v161, v208, v161 wave_ror:1 row_mask:0xf bank_mask:0xf
    v_add_f32_dpp v165, v209, v165 wave_ror:1 row_mask:0xf bank_mask:0xf
    v_add_f32_dpp v169, v210, v169 wave_ror:1 row_mask:0xf bank_mask:0xf
    v_mfma_f32_32x32x16_bf16 v[176:191], v[232:235], v[132:135], v[176:191]
    ds_read_b64_tr_b16 v[232:233], v65 offset:1184
    ds_read_b64_tr_b16 v[234:235], v65 offset:1152
    v_add_f32_dpp v173, v211, v173 wave_ror:1 row_mask:0xf bank_mask:0xf
    v_cndmask_b32 v208, v161, v70, s[76:77]
    v_cndmask_b32 v209, v165, v161, s[76:77]
    v_cndmask_b32 v210, v169, v165, s[76:77]
    v_mfma_f32_32x32x16_bf16 v[176:191], v[236:239], v[136:139], v[176:191]
    ds_read_b64_tr_b16 v[236:237], v65 offset:1312
    ds_read_b64_tr_b16 v[238:239], v65 offset:1280
    v_cndmask_b32 v211, v173, v169, s[76:77]
    v_mov_b32_e64 v70, v173
    v_add_f32_dpp v160, v208, v160 wave_ror:1 row_mask:0xf bank_mask:0xf
    v_add_f32_dpp v164, v209, v164 wave_ror:1 row_mask:0xf bank_mask:0xf
    v_mfma_f32_32x32x16_bf16 v[176:191], v[240:243], v[140:143], v[176:191]
    ds_read_b128 v[240:243], v64 offset:512
    ds_read_b64_tr_b16 v[224:225], v65 offset:1440
    ds_read_b64_tr_b16 v[226:227], v65 offset:1408
    v_add_f32_dpp v168, v210, v168 wave_ror:1 row_mask:0xf bank_mask:0xf
    v_add_f32_dpp v172, v211, v172 wave_ror:1 row_mask:0xf bank_mask:0xf
    s_waitcnt lgkmcnt(7)
    v_mfma_f32_32x32x16_bf16 v[176:191], v[212:215], v[228:231], v[176:191]
    ds_read_b128 v[212:215], v64 offset:992
    ds_write_b32 v66, v160 offset:256
    ds_write_b32 v66, v164 offset:320
    s_waitcnt lgkmcnt(8)
    v_mfma_f32_32x32x16_bf16 v[176:191], v[216:219], v[232:235], v[176:191]
    ds_read_b128 v[216:219], v64 offset:960
    ds_write_b32 v66, v168 offset:384
    ds_write_b32 v66, v172 offset:448
    s_waitcnt lgkmcnt(9)
    v_mfma_f32_32x32x16_bf16 v[176:191], v[220:223], v[236:239], v[176:191]
    ds_read_b128 v[220:223], v64 offset:928
    s_waitcnt lgkmcnt(7)
    v_mfma_f32_32x32x16_bf16 v[176:191], v[240:243], v[224:227], v[176:191]
    ds_read_b128 v[240:243], v64 offset:896
    s_waitcnt lgkmcnt(2)
    s_waitcnt vmcnt(0)
    v_cmp_gt_u32_e64 vcc, 1, v7
    s_nop 0
    s_and_b64 vcc, vcc, s[50:51]
    s_cbranch_scc1 ps_36
pc_38:
    s_barrier
    v_mfma_f32_32x32x16_bf16 v[192:207], v[212:215], v[112:115], v[192:207]
    ds_read_b64 v[144:145], v67 offset:0
    ds_read_b64 v[146:147], v67 offset:4224
    ds_read_b64 v[148:149], v67 offset:8448
    ds_read_b64 v[150:151], v67 offset:12672
    s_lshl_b32 s25, s75, 14
    v_mfma_f32_32x32x16_bf16 v[192:207], v[216:219], v[116:119], v[192:207]
    s_add_u32 s25, s25, 9437184
    s_add_u32 m0, s92, 36352
    s_nop 0
    buffer_load_dwordx4 v73, s[16:19], s99 offen offset:0 sc1 lds
    buffer_load_dwordx4 v74, s[16:19], s99 offen offset:1024 sc1 lds
    buffer_load_dwordx4 v75, s[16:19], s99 offen offset:2048 sc1 lds
    s_waitcnt lgkmcnt(5)
    v_mfma_f32_32x32x16_bf16 v[192:207], v[220:223], v[120:123], v[192:207]
    buffer_load_dwordx4 v76, s[16:19], s99 offen offset:3072 sc1 lds
    s_waitcnt lgkmcnt(4)
    v_mfma_f32_32x32x16_bf16 v[192:207], v[240:243], v[124:127], v[192:207]
    ds_read_b128 v[212:215], v64 offset:768
    s_add_u32 m0, s93, 53760
    s_add_u32 s99, s99, 524288
    s_mov_b64 exec, s[80:81]
    buffer_load_dwordx4 v77, s[16:19], s100 offen sc1 lds
    s_mov_b64 exec, -1
    s_add_u32 s100, s100, 524288
    v_mfma_f32_32x32x16_bf16 v[192:207], v[244:247], v[128:131], v[192:207]
    ds_read_b128 v[244:247], v64 offset:736
    v_cndmask_b32 v208, v179, v72, s[76:77]
    v_cndmask_b32 v209, v183, v179, s[76:77]
    v_cndmask_b32 v210, v187, v183, s[76:77]
    v_cndmask_b32 v211, v191, v187, s[76:77]
    v_mov_b32_e64 v72, v191
    v_mfma_f32_32x32x16_bf16 v[192:207], v[248:251], v[132:135], v[192:207]
    ds_read_b128 v[248:251], v64 offset:704
    v_add_f32_dpp v178, v208, v178 wave_ror:1 row_mask:0xf bank_mask:0xf
    v_add_f32_dpp v182, v209, v182 wave_ror:1 row_mask:0xf bank_mask:0xf
    v_add_f32_dpp v186, v210, v186 wave_ror:1 row_mask:0xf bank_mask:0xf
    v_add_f32_dpp v190, v211, v190 wave_ror:1 row_mask:0xf bank_mask:0xf
    v_cndmask_b32 v208, v178, v71, s[76:77]
    v_mfma_f32_32x32x16_bf16 v[192:207], v[252:255], v[136:139], v[192:207]
    ds_read_b128 v[252:255], v64 offset:672
    v_cndmask_b32 v209, v182, v178, s[76:77]
    v_cndmask_b32 v210, v186, v182, s[76:77]
    v_cndmask_b32 v211, v190, v186, s[76:77]
    v_mov_b32 v71, v190
    s_waitcnt lgkmcnt(3)
    v_mfma_f32_32x32x16_bf16 v[192:207], v[212:215], v[140:143], v[192:207]
    ds_read_b128 v[216:219], v64 offset:640
    v_add_f32_dpp v177, v208, v177 wave_ror:1 row_mask:0xf bank_mask:0xf
    v_add_f32_dpp v181, v209, v181 wave_ror:1 row_mask:0xf bank_mask:0xf
    v_add_f32_dpp v185, v210, v185 wave_ror:1 row_mask:0xf bank_mask:0xf
    v_add_f32_dpp v189, v211, v189 wave_ror:1 row_mask:0xf bank_mask:0xf
    s_waitcnt lgkmcnt(3)
    v_mfma_f32_32x32x16_bf16 v[192:207], v[244:247], v[228:231], v[192:207]
    ds_read_b128 v[228:231], v64 offset:608
    ds_read_b64_tr_b16 v[220:221], v65 offset:1568
    ds_read_b64_tr_b16 v[222:223], v65 offset:1536
    v_cndmask_b32 v208, v177, v70, s[76:77]
    v_cndmask_b32 v209, v181, v177, s[76:77]
    s_waitcnt lgkmcnt(5)
    v_mfma_f32_32x32x16_bf16 v[192:207], v[248:251], v[232:235], v[192:207]
    ds_read_b128 v[232:235], v64 offset:576
    ds_read_b64_tr_b16 v[240:241], v65 offset:1696
    ds_read_b64_tr_b16 v[242:243], v65 offset:1664
    v_cndmask_b32 v210, v185, v181, s[76:77]
    v_cndmask_b32 v211, v189, v185, s[76:77]
    s_waitcnt lgkmcnt(7)
    v_mfma_f32_32x32x16_bf16 v[192:207], v[252:255], v[236:239], v[192:207]
    ds_read_b128 v[236:239], v64 offset:544
    ds_read_b64_tr_b16 v[212:213], v65 offset:1824
    ds_read_b64_tr_b16 v[214:215], v65 offset:1792
    v_mov_b32 v70, v189
    v_add_f32_dpp v176, v208, v176 wave_ror:1 row_mask:0xf bank_mask:0xf
    s_waitcnt lgkmcnt(9)
    v_mfma_f32_32x32x16_bf16 v[192:207], v[216:219], v[224:227], v[192:207]
    ds_read_b128 v[224:227], v64 offset:512
    ds_read_b64_tr_b16 v[244:245], v65 offset:1952
    ds_read_b64_tr_b16 v[246:247], v65 offset:1920
    v_add_f32_dpp v180, v209, v180 wave_ror:1 row_mask:0xf bank_mask:0xf
    v_add_f32_dpp v184, v210, v184 wave_ror:1 row_mask:0xf bank_mask:0xf
    s_waitcnt lgkmcnt(9)
    v_mfma_f32_32x32x16_bf16 v[192:207], v[228:231], v[220:223], v[192:207]
    v_add_f32_dpp v188, v211, v188 wave_ror:1 row_mask:0xf bank_mask:0xf
    ds_write_b32 v66, v176 offset:512
    s_waitcnt lgkmcnt(7)
    v_mfma_f32_32x32x16_bf16 v[192:207], v[232:235], v[240:243], v[192:207]
    ds_write_b32 v66, v180 offset:576
    ds_write_b32 v66, v184 offset:640
    s_waitcnt lgkmcnt(6)
    v_mfma_f32_32x32x16_bf16 v[192:207], v[236:239], v[212:215], v[192:207]
    ds_write_b32 v66, v188 offset:704
    v_add_f32 v144, v144, v80
    v_add_f32 v145, v145, v81
    s_waitcnt lgkmcnt(4)
    v_mfma_f32_32x32x16_bf16 v[192:207], v[224:227], v[244:247], v[192:207]
    v_add_f32 v146, v146, v82
    v_add_f32 v147, v147, v83
    v_add_f32 v148, v148, v84
    v_add_f32 v149, v149, v85
    v_add_f32 v150, v150, v86
    v_add_f32_e64 v151, v151, v87
    v_cvt_pk_bf16_f32 v160, v144, v146
    v_cvt_pk_bf16_f32 v161, v148, v150
    v_cvt_pk_bf16_f32 v162, v145, v147
    v_cvt_pk_bf16_f32 v163, v149, v151
    buffer_store_dwordx4 v[160:163], v62, s[16:19], s25 offen offset:2048 sc1
    s_add_u32 m0, s92, 55936
    s_nop 0
    s_nop 0
    buffer_load_dwordx4 v73, s[16:19], s99 offen offset:0 sc1 lds
    buffer_load_dwordx4 v74, s[16:19], s99 offen offset:1024 sc1 lds
    buffer_load_dwordx4 v75, s[16:19], s99 offen offset:2048 sc1 lds
    buffer_load_dwordx4 v76, s[16:19], s99 offen offset:3072 sc1 lds
    s_add_u32 m0, s93, 73344
    s_add_u32 s99, s99, 524288
    s_mov_b64 exec, s[80:81]
    buffer_load_dwordx4 v77, s[16:19], s100 offen sc1 lds
    s_mov_b64 exec, -1
    s_add_u32 s100, s100, 524288
    s_add_u32 m0, s92, 75520
    s_nop 0
    s_nop 0
    buffer_load_dwordx4 v73, s[16:19], s99 offen offset:0 sc1 lds
    buffer_load_dwordx4 v74, s[16:19], s99 offen offset:1024 sc1 lds
    buffer_load_dwordx4 v75, s[16:19], s99 offen offset:2048 sc1 lds
    buffer_load_dwordx4 v76, s[16:19], s99 offen offset:3072 sc1 lds
    s_add_u32 m0, s93, 92928
    s_add_u32 s99, s99, 524288
    s_mov_b64 exec, s[80:81]
    buffer_load_dwordx4 v77, s[16:19], s100 offen sc1 lds
    s_mov_b64 exec, -1
    s_add_u32 s100, s100, 524288
    v_cndmask_b32 v208, v195, v72, s[76:77]
    v_cndmask_b32 v209, v199, v195, s[76:77]
    v_cndmask_b32 v210, v203, v199, s[76:77]
    v_cndmask_b32 v211, v207, v203, s[76:77]
    v_mov_b32_e64 v72, v207
    v_add_f32_dpp v194, v208, v194 wave_ror:1 row_mask:0xf bank_mask:0xf
    v_add_f32_dpp v198, v209, v198 wave_ror:1 row_mask:0xf bank_mask:0xf
    v_add_f32_dpp v202, v210, v202 wave_ror:1 row_mask:0xf bank_mask:0xf
    v_add_f32_dpp v206, v211, v206 wave_ror:1 row_mask:0xf bank_mask:0xf
    v_cndmask_b32 v208, v194, v71, s[76:77]
    v_cndmask_b32 v209, v198, v194, s[76:77]
    v_cndmask_b32 v210, v202, v198, s[76:77]
    v_cndmask_b32 v211, v206, v202, s[76:77]
    v_mov_b32_e64 v71, v206
    v_add_f32_dpp v193, v208, v193 wave_ror:1 row_mask:0xf bank_mask:0xf
    v_add_f32_dpp v197, v209, v197 wave_ror:1 row_mask:0xf bank_mask:0xf
    v_add_f32_dpp v201, v210, v201 wave_ror:1 row_mask:0xf bank_mask:0xf
    v_add_f32_dpp v205, v211, v205 wave_ror:1 row_mask:0xf bank_mask:0xf
    v_cndmask_b32 v208, v193, v70, s[76:77]
    v_cndmask_b32 v209, v197, v193, s[76:77]
    v_cndmask_b32 v210, v201, v197, s[76:77]
    v_cndmask_b32 v211, v205, v201, s[76:77]
    v_mov_b32_e64 v70, v205
    v_add_f32_dpp v192, v208, v192 wave_ror:1 row_mask:0xf bank_mask:0xf
    v_add_f32_dpp v196, v209, v196 wave_ror:1 row_mask:0xf bank_mask:0xf
    v_add_f32_dpp v200, v210, v200 wave_ror:1 row_mask:0xf bank_mask:0xf
    v_add_f32_dpp v204, v211, v204 wave_ror:1 row_mask:0xf bank_mask:0xf
    ds_write_b32 v66, v192 offset:768
    ds_write_b32 v66, v196 offset:832
    ds_write_b32 v66, v200 offset:896
    ds_write_b32 v66, v204 offset:960
    s_waitcnt lgkmcnt(0)
    s_barrier
    ds_read_b64 v[152:153], v67 offset:512
    ds_read_b64 v[154:155], v67 offset:4736
    ds_read_b64 v[156:157], v67 offset:8960
    ds_read_b64 v[158:159], v67 offset:13184
    s_lshl_b32 s25, s75, 14
    s_add_u32 s25, s25, 9437184
    s_waitcnt lgkmcnt(0)
    v_add_f32 v152, v152, v88
    v_add_f32 v153, v153, v89
    v_add_f32 v154, v154, v90
    v_add_f32 v155, v155, v91
    v_add_f32 v156, v156, v92
    v_add_f32 v157, v157, v93
    v_add_f32 v158, v158, v94
    v_add_f32 v159, v159, v95
    v_cvt_pk_bf16_f32 v164, v152, v154
    v_cvt_pk_bf16_f32 v165, v156, v158
    v_cvt_pk_bf16_f32 v166, v153, v155
    v_cvt_pk_bf16_f32 v167, v157, v159
    buffer_store_dwordx4 v[164:167], v62, s[16:19], s25 offen offset:3072 sc1
    v_mov_b32_e64 v5, 1
    s_add_u32 s82, s86, 24576
    buffer_atomic_add v5, v6, s[16:19], s82 offen offset:4 sc0 sc1
    s_branch ec_27
nc_26:
    v_lshlrev_b32 v2, 3, v4
    v_mov_b32_e64 v5, 1
    v_cndmask_b32 v2, v4, v2, s[50:51]
    buffer_atomic_add v5, v2, s[16:19], s86 offen offset:8 sc1
    buffer_load_dword v7, v4, s[16:19], s87 offen offset:8 sc1
    s_waitcnt vmcnt(0)
    v_cmp_gt_u32 vcc, 12, v7
    s_nop 0
    s_and_b64 vcc, vcc, s[50:51]
    s_cbranch_scc1 ps_39
pc_41:
    v_mov_b32 v100, -1
    v_mov_b32 v101, -1
    v_mov_b32 v102, -1
    v_mov_b32 v103, -1
    v_lshlrev_b32 v104, 4, v0
    s_sub_u32 s88, s2, 160
    s_mul_i32 s88, s88, 57344
    s_min_u32 s88, s88, 5185536
    s_add_u32 s88, s88, 12058624
    buffer_store_dwordx4 v[100:103], v104, s[16:19], s88 offen sc1
    s_add_u32 s88, s88, 4096
    buffer_store_dwordx4 v[100:103], v104, s[16:19], s88 offen sc1
    s_add_u32 s88, s88, 4096
    buffer_store_dwordx4 v[100:103], v104, s[16:19], s88 offen sc1
    s_add_u32 s88, s88, 4096
    buffer_store_dwordx4 v[100:103], v104, s[16:19], s88 offen sc1
    s_add_u32 s88, s88, 4096
    buffer_store_dwordx4 v[100:103], v104, s[16:19], s88 offen sc1
    s_add_u32 s88, s88, 4096
    buffer_store_dwordx4 v[100:103], v104, s[16:19], s88 offen sc1
    s_add_u32 s88, s88, 4096
    buffer_store_dwordx4 v[100:103], v104, s[16:19], s88 offen sc1
    s_add_u32 s88, s88, 4096
    buffer_store_dwordx4 v[100:103], v104, s[16:19], s88 offen sc1
    s_add_u32 s88, s88, 4096
    buffer_store_dwordx4 v[100:103], v104, s[16:19], s88 offen sc1
    s_add_u32 s88, s88, 4096
    buffer_store_dwordx4 v[100:103], v104, s[16:19], s88 offen sc1
    s_add_u32 s88, s88, 4096
    buffer_store_dwordx4 v[100:103], v104, s[16:19], s88 offen sc1
    s_add_u32 s88, s88, 4096
    buffer_store_dwordx4 v[100:103], v104, s[16:19], s88 offen sc1
    s_add_u32 s88, s88, 4096
    buffer_store_dwordx4 v[100:103], v104, s[16:19], s88 offen sc1
    s_add_u32 s88, s88, 4096
    buffer_store_dwordx4 v[100:103], v104, s[16:19], s88 offen sc1
    s_waitcnt vmcnt(0)
    s_barrier
    v_mov_b32_e64 v5, 1
    s_add_u32 s82, s86, 8192
    buffer_atomic_add v5, v6, s[16:19], s82 offen offset:12 sc0 sc1
    s_waitcnt vmcnt(0)
    v_cmp_eq_u32 vcc, 11, v5
    s_nop 0
    s_cbranch_vccnz gl_42
gc_43:
    buffer_load_dword v7, v4, s[16:19], s89 offen offset:0 sc1
    s_waitcnt vmcnt(0)
    v_cmp_gt_u32 vcc, 1, v7
    s_nop 0
    s_and_b64 vcc, vcc, s[50:51]
    s_cbranch_scc1 ps_44
pc_46:
    s_barrier
    s_sub_u32 s3, s2, 160
    s_and_b32 s3, s3, 63
    s_add_u32 s3, s3, 0
    s_and_b32 s25, s3, 3
    s_lshl_b32 s25, s25, 12
    s_lshr_b32 s26, s3, 2
    s_lshl_b32 s26, s26, 7
    s_add_u32 s3, s25, s26
    v_lshrrev_b32 v236, 3, v0
    v_and_b32 v237, 7, v0
    v_lshlrev_b32 v237, 4, v237
    v_lshl_add_u32 v236, v236, 14, v237
    s_sub_u32 s25, s2, 160
    s_cmp_lt_u32 s25, 64
    s_cselect_b32 s25, 0, 1073741824
    v_add_u32_e64 v236, s25, v236
    s_add_u32 s26, s3, 9437184
    buffer_load_dwordx4 v[216:219], v236, s[16:19], s26 offen sc1
    s_add_u32 s26, s26, 524288
    buffer_load_dwordx4 v[220:223], v236, s[16:19], s26 offen sc1
    s_add_u32 s26, s26, 524288
    buffer_load_dwordx4 v[224:227], v236, s[16:19], s26 offen sc1
    s_add_u32 s26, s26, 524288
    buffer_load_dwordx4 v[228:231], v236, s[16:19], s26 offen sc1
    s_add_u32 s26, s26, 524288
    buffer_load_dwordx4 v[232:235], v236, s[16:19], s26 offen sc1
    s_lshl_b32 s25, s72, 5
    s_add_u32 s25, s25, 0
    s_sub_u32 s26, s25, 4
    s_max_i32 s26, s26, 0
    s_lshl_b32 s27, s71, 12
    s_add_u32 s27, s27, 9437184
    s_lshl_b32 s99, s25, 3
    s_lshl_b32 s100, s26, 3
    s_lshl_b32 s92, s24, 12
    s_lshl_b32 s93, s24, 9
    s_add_u32 s99, s99, s27
    s_add_u32 s100, s100, s27
    s_add_u32 m0, s92, 36352
    s_nop 0
    buffer_load_dwordx4 v73, s[16:19], s99 offen offset:0 sc1 lds
    buffer_load_dwordx4 v74, s[16:19], s99 offen offset:1024 sc1 lds
    buffer_load_dwordx4 v75, s[16:19], s99 offen offset:2048 sc1 lds
    buffer_load_dwordx4 v76, s[16:19], s99 offen offset:3072 sc1 lds
    s_add_u32 m0, s93, 53760
    s_add_u32 s99, s99, 524288
    s_mov_b64 exec, s[80:81]
    buffer_load_dwordx4 v77, s[16:19], s100 offen sc1 lds
    s_mov_b64 exec, -1
    s_add_u32 s100, s100, 524288
    s_add_u32 m0, s92, 55936
    s_nop 0
    s_nop 0
    buffer_load_dwordx4 v73, s[16:19], s99 offen offset:0 sc1 lds
    buffer_load_dwordx4 v74, s[16:19], s99 offen offset:1024 sc1 lds
    buffer_load_dwordx4 v75, s[16:19], s99 offen offset:2048 sc1 lds
    buffer_load_dwordx4 v76, s[16:19], s99 offen offset:3072 sc1 lds
    s_add_u32 m0, s93, 73344
    s_add_u32 s99, s99, 524288
    s_mov_b64 exec, s[80:81]
    buffer_load_dwordx4 v77, s[16:19], s100 offen sc1 lds
    s_mov_b64 exec, -1
    s_add_u32 s100, s100, 524288
    s_sub_u32 s85, s2, 160
    s_cmp_ge_u32 s85, 64
    s_cbranch_scc1 s2_47
    v_mov_b32 v238, 0x3f803f80
    s_lshl_b32 s25, s24, 7
    s_add_u32 s25, s25, 134272
    v_lshrrev_b32 v239, 4, v1
    v_lshl_add_u32 v237, v239, 2, v237
    v_add_u32 v237, s25, v237
se_48:
    v_mov_b32 v240, 0
    v_mov_b32 v241, 0
    v_mov_b32 v242, 0
    v_mov_b32 v243, 0
    s_waitcnt vmcnt(14)
    v_dot2c_f32_bf16 v240, v216, v238
    v_dot2c_f32_bf16 v241, v216, v216
    v_dot2c_f32_bf16 v240, v217, v238
    v_dot2c_f32_bf16 v241, v217, v217
    v_dot2c_f32_bf16 v242, v218, v238
    v_dot2c_f32_bf16 v243, v218, v218
    v_dot2c_f32_bf16 v242, v219, v238
    v_dot2c_f32_bf16 v243, v219, v219
    s_waitcnt vmcnt(13)
    v_dot2c_f32_bf16 v240, v220, v238
    v_dot2c_f32_bf16 v241, v220, v220
    v_dot2c_f32_bf16 v240, v221, v238
    v_dot2c_f32_bf16 v241, v221, v221
    v_dot2c_f32_bf16 v242, v222, v238
    v_dot2c_f32_bf16 v243, v222, v222
    v_dot2c_f32_bf16 v242, v223, v238
    v_dot2c_f32_bf16 v243, v223, v223
    s_waitcnt vmcnt(12)
    v_dot2c_f32_bf16 v240, v224, v238
    v_dot2c_f32_bf16 v241, v224, v224
    v_dot2c_f32_bf16 v240, v225, v238
    v_dot2c_f32_bf16 v241, v225, v225
    v_dot2c_f32_bf16 v242, v226, v238
    v_dot2c_f32_bf16 v243, v226, v226
    v_dot2c_f32_bf16 v242, v227, v238
    v_dot2c_f32_bf16 v243, v227, v227
    s_waitcnt vmcnt(11)
    v_dot2c_f32_bf16 v240, v228, v238
    v_dot2c_f32_bf16 v241, v228, v228
    v_dot2c_f32_bf16 v240, v229, v238
    v_dot2c_f32_bf16 v241, v229, v229
    v_dot2c_f32_bf16 v242, v230, v238
    v_dot2c_f32_bf16 v243, v230, v230
    v_dot2c_f32_bf16 v242, v231, v238
    v_dot2c_f32_bf16 v243, v231, v231
    s_waitcnt vmcnt(10)
    v_dot2c_f32_bf16 v240, v232, v238
    v_dot2c_f32_bf16 v241, v232, v232
    v_dot2c_f32_bf16 v240, v233, v238
    v_dot2c_f32_bf16 v241, v233, v233
    v_dot2c_f32_bf16 v242, v234, v238
    v_dot2c_f32_bf16 v243, v234, v234
    v_dot2c_f32_bf16 v242, v235, v238
    v_dot2c_f32_bf16 v243, v235, v235
    s_nop 2
    v_cmp_u_f32 vcc, v241, v243
    s_nop 0
    s_cbranch_vccnz rd_49
rc_50:
    v_permlane32_swap_b32 v240, v242
    v_permlane32_swap_b32 v241, v243
    v_pk_add_f32 v[240:241], v[240:241], v[242:243]
    s_nop 1
    v_permlane16_swap_b32 v240, v241
    v_add_f32 v240, v240, v241
    s_nop 1
    v_add_f32_dpp v240, v240, v240 row_ror:8 row_mask:0xf bank_mask:0xf
    ds_write_b32 v237, v240
    v_and_b32 v236, 15, v0
    v_lshlrev_b32 v236, 3, v236
    v_add_u32 v237, 134272, v236
    v_mov_b32 v239, 1073741824
    v_cmp_gt_u32 vcc, 16, v0
    s_nop 1
    v_cndmask_b32 v236, v239, v236, vcc
    s_add_u32 s25, s3, 3457024
    s_waitcnt lgkmcnt(0)
    s_barrier
    ds_read_b64 v[216:217], v237 offset:0
    ds_read_b64 v[218:219], v237 offset:128
    ds_read_b64 v[220:221], v237 offset:256
    ds_read_b64 v[222:223], v237 offset:384
    s_waitcnt lgkmcnt(2)
    v_pk_add_f32 v[216:217], v[216:217], v[218:219]
    s_waitcnt lgkmcnt(0)
    v_pk_add_f32 v[220:221], v[220:221], v[222:223]
    v_pk_add_f32 v[216:217], v[216:217], v[220:221]
    v_mul_f32 v239, 0x3acccccd, v216
    v_mul_f32 v217, 0x3acccccd, v217
    v_fma_f32 v217, -v239, v239, v217
    v_max_f32 v217, 0, v217
    v_add_f32 v217, 0x3727c5ac, v217
    v_rsq_f32_e64 v216, v217
    s_nop 0
    v_mul_f32 v217, -v239, v216
    buffer_store_dwordx2 v[216:217], v236, s[16:19], s25 offen sc1
s2_47:
    s_add_u32 m0, s92, 75520
    s_nop 0
    s_nop 0
    buffer_load_dwordx4 v73, s[16:19], s99 offen offset:0 sc1 lds
    buffer_load_dwordx4 v74, s[16:19], s99 offen offset:1024 sc1 lds
    buffer_load_dwordx4 v75, s[16:19], s99 offen offset:2048 sc1 lds
    buffer_load_dwordx4 v76, s[16:19], s99 offen offset:3072 sc1 lds
    s_add_u32 m0, s93, 92928
    s_add_u32 s99, s99, 524288
    s_mov_b64 exec, s[80:81]
    buffer_load_dwordx4 v77, s[16:19], s100 offen sc1 lds
    s_mov_b64 exec, -1
    s_add_u32 s100, s100, 524288
ec_27:
ge_51:
    v_add_u32 v196, 36352, v78
    v_mov_b32_e64 v198, v79
    s_waitcnt vmcnt(10)
    s_barrier
    ds_read_b64 v[160:161], v198 offset:0
    ds_read_b64 v[162:163], v198 offset:64
    ds_read_b64 v[164:165], v196 offset:0
    ds_read_b64 v[166:167], v196 offset:512
    ds_read_b64 v[168:169], v196 offset:256
    ds_read_b64 v[170:171], v196 offset:768
    ds_read_b64 v[172:173], v198 offset:256
    ds_read_b64 v[174:175], v198 offset:320
    ds_read_b64 v[176:177], v196 offset:2048
    ds_read_b64 v[178:179], v196 offset:2560
    ds_read_b64 v[180:181], v196 offset:2304
    ds_read_b64 v[182:183], v196 offset:2816
    s_waitcnt lgkmcnt(6)
    v_mfma_f32_16x16x32_bf16 v[112:115], a[0:3], v[160:163], 0
    ds_read_b64 v[184:185], v198 offset:512
    v_mfma_f32_32x32x16_bf16 v[80:95], a[0:3], v[164:167], 0
    ds_read_b64 v[186:187], v198 offset:576
    ds_read_b64 v[188:189], v196 offset:4096
    ds_read_b64 v[190:191], v196 offset:4608
    v_mov_b32 v208, 0
    v_mov_b32_e64 v209, 0
    v_mfma_f32_32x32x16_bf16 v[96:111], a[0:3], v[168:171], 0
    ds_read_b64 v[192:193], v196 offset:4352
    ds_read_b64 v[194:195], v196 offset:4864
    buffer_load_dword v7, v4, s[16:19], s87 offen offset:12 sc1
    s_waitcnt lgkmcnt(6)
    v_mfma_f32_16x16x32_bf16 v[112:115], a[4:7], v[172:175], v[112:115]
    ds_read_b64 v[160:161], v198 offset:768
    v_mfma_f32_32x32x16_bf16 v[80:95], a[4:7], v[176:179], v[80:95]
    ds_read_b64 v[162:163], v198 offset:832
    ds_read_b64 v[164:165], v196 offset:6144
    ds_read_b64 v[166:167], v196 offset:6656
    v_lshrrev_b32 v210, 5, v0
    v_mul_u32_u24 v210, 1600, v210
    v_mfma_f32_32x32x16_bf16 v[96:111], a[4:7], v[180:183], v[96:111]
    ds_read_b64 v[168:169], v196 offset:6400
    ds_read_b64 v[170:171], v196 offset:6912
    s_add_u32 m0, s92, 95104
    s_nop 0
    buffer_load_dwordx4 v73, s[16:19], s99 offen offset:0 sc1 lds
    s_waitcnt lgkmcnt(6)
    v_mfma_f32_16x16x32_bf16 v[112:115], a[8:11], v[184:187], v[112:115]
    ds_read_b64 v[172:173], v198 offset:1024
    v_mfma_f32_32x32x16_bf16 v[80:95], a[8:11], v[188:191], v[80:95]
    ds_read_b64 v[174:175], v198 offset:1088
    ds_read_b64 v[176:177], v196 offset:8192
    ds_read_b64 v[178:179], v196 offset:8704
    v_and_b32 v211, 31, v0
    v_min_u32 v211, 19, v211
    v_mfma_f32_32x32x16_bf16 v[96:111], a[8:11], v[192:195], v[96:111]
    ds_read_b64 v[180:181], v196 offset:8448
    ds_read_b64 v[182:183], v196 offset:8960
    buffer_load_dwordx4 v74, s[16:19], s99 offen offset:1024 sc1 lds
    v_lshl_add_u32 v210, v211, 3, v210
    s_waitcnt lgkmcnt(6)
    v_mfma_f32_16x16x32_bf16 v[112:115], a[12:15], v[160:163], v[112:115]
    ds_read_b64 v[184:185], v198 offset:1280
    v_mfma_f32_32x32x16_bf16 v[80:95], a[12:15], v[164:167], v[80:95]
    ds_read_b64 v[186:187], v198 offset:1344
    ds_read_b64 v[188:189], v196 offset:10240
    ds_read_b64 v[190:191], v196 offset:10752
    v_add_u32 v210, 6400, v210
    ds_write_b64 v210, v[208:209]
    v_mfma_f32_32x32x16_bf16 v[96:111], a[12:15], v[168:171], v[96:111]
    ds_read_b64 v[192:193], v196 offset:10496
    ds_read_b64 v[194:195], v196 offset:11008
    buffer_load_dwordx4 v75, s[16:19], s99 offen offset:2048 sc1 lds
    s_waitcnt lgkmcnt(7)
    v_mfma_f32_16x16x32_bf16 v[112:115], a[16:19], v[172:175], v[112:115]
    ds_read_b64 v[160:161], v198 offset:1536
    v_mfma_f32_32x32x16_bf16 v[80:95], a[16:19], v[176:179], v[80:95]
    ds_read_b64 v[162:163], v198 offset:1600
    ds_read_b64 v[164:165], v196 offset:12288
    ds_read_b64 v[166:167], v196 offset:12800
    v_mfma_f32_32x32x16_bf16 v[96:111], a[16:19], v[180:183], v[96:111]
    ds_read_b64 v[168:169], v196 offset:12544
    ds_read_b64 v[170:171], v196 offset:13056
    buffer_load_dwordx4 v76, s[16:19], s99 offen offset:3072 sc1 lds
    s_waitcnt lgkmcnt(6)
    v_mfma_f32_16x16x32_bf16 v[112:115], a[20:23], v[184:187], v[112:115]
    ds_read_b64 v[172:173], v198 offset:1792
    v_mfma_f32_32x32x16_bf16 v[80:95], a[20:23], v[188:191], v[80:95]
    ds_read_b64 v[174:175], v198 offset:1856
    ds_read_b64 v[176:177], v196 offset:14336
    ds_read_b64 v[178:179], v196 offset:14848
    v_mfma_f32_32x32x16_bf16 v[96:111], a[20:23], v[192:195], v[96:111]
    ds_read_b64 v[180:181], v196 offset:14592
    ds_read_b64 v[182:183], v196 offset:15104
    s_add_u32 m0, s93, 112512
    s_add_u32 s99, s99, 524288
    s_mov_b64 exec, s[80:81]
    buffer_load_dwordx4 v77, s[16:19], s100 offen sc1 lds
    s_mov_b64 exec, -1
    s_add_u32 s100, s100, 524288
    s_waitcnt vmcnt(6)
    v_cmp_eq_u32 vcc, 19, v5
    s_nop 0
    s_cbranch_vccnz gl_52
gc_53:
    s_barrier
    s_waitcnt lgkmcnt(6)
    v_mfma_f32_16x16x32_bf16 v[112:115], a[24:27], v[160:163], v[112:115]
    v_add_u32 v198, v49, v198
    v_mfma_f32_32x32x16_bf16 v[80:95], a[24:27], v[164:167], v[80:95]
    v_add_u32 v196, 19584, v196
    ds_read_b64 v[184:185], v198 offset:0
    ds_read_b64 v[186:187], v198 offset:64
    ds_read_b64 v[188:189], v196 offset:0
    v_mfma_f32_32x32x16_bf16 v[96:111], a[24:27], v[168:171], v[96:111]
    ds_read_b64 v[190:191], v196 offset:512
    ds_read_b64 v[192:193], v196 offset:256
    ds_read_b64 v[194:195], v196 offset:768
    s_add_u32 m0, s92, 114688
    s_nop 0
    buffer_load_dwordx4 v73, s[16:19], s99 offen offset:0 sc1 lds
    s_waitcnt lgkmcnt(6)
    v_mfma_f32_16x16x32_bf16 v[112:115], a[28:31], v[172:175], v[112:115]
    ds_read_b64 v[160:161], v198 offset:256
    v_mfma_f32_32x32x16_bf16 v[80:95], a[28:31], v[176:179], v[80:95]
    ds_read_b64 v[162:163], v198 offset:320
    ds_read_b64 v[164:165], v196 offset:2048
    ds_read_b64 v[166:167], v196 offset:2560
    v_mfma_f32_32x32x16_bf16 v[96:111], a[28:31], v[180:183], v[96:111]
    ds_read_b64 v[168:169], v196 offset:2304
    ds_read_b64 v[170:171], v196 offset:2816
    buffer_load_dwordx4 v74, s[16:19], s99 offen offset:1024 sc1 lds
    s_waitcnt lgkmcnt(6)
    v_mfma_f32_16x16x32_bf16 v[112:115], a[32:35], v[184:187], v[112:115]
    ds_read_b64 v[172:173], v198 offset:512
    v_mfma_f32_32x32x16_bf16 v[80:95], a[32:35], v[188:191], v[80:95]
    ds_read_b64 v[174:175], v198 offset:576
    ds_read_b64 v[176:177], v196 offset:4096
    ds_read_b64 v[178:179], v196 offset:4608
    v_mfma_f32_32x32x16_bf16 v[96:111], a[32:35], v[192:195], v[96:111]
    ds_read_b64 v[180:181], v196 offset:4352
    ds_read_b64 v[182:183], v196 offset:4864
    buffer_load_dwordx4 v75, s[16:19], s99 offen offset:2048 sc1 lds
    s_waitcnt lgkmcnt(6)
    v_mfma_f32_16x16x32_bf16 v[112:115], a[36:39], v[160:163], v[112:115]
    ds_read_b64 v[184:185], v198 offset:768
    v_mfma_f32_32x32x16_bf16 v[80:95], a[36:39], v[164:167], v[80:95]
    ds_read_b64 v[186:187], v198 offset:832
    ds_read_b64 v[188:189], v196 offset:6144
    ds_read_b64 v[190:191], v196 offset:6656
    v_mfma_f32_32x32x16_bf16 v[96:111], a[36:39], v[168:171], v[96:111]
    ds_read_b64 v[192:193], v196 offset:6400
    ds_read_b64 v[194:195], v196 offset:6912
    buffer_load_dwordx4 v76, s[16:19], s99 offen offset:3072 sc1 lds
    s_waitcnt lgkmcnt(6)
    v_mfma_f32_16x16x32_bf16 v[112:115], a[40:43], v[172:175], v[112:115]
    ds_read_b64 v[160:161], v198 offset:1024
    v_mfma_f32_32x32x16_bf16 v[80:95], a[40:43], v[176:179], v[80:95]
    ds_read_b64 v[162:163], v198 offset:1088
    ds_read_b64 v[164:165], v196 offset:8192
    ds_read_b64 v[166:167], v196 offset:8704
    v_mfma_f32_32x32x16_bf16 v[96:111], a[40:43], v[180:183], v[96:111]
    ds_read_b64 v[168:169], v196 offset:8448
    ds_read_b64 v[170:171], v196 offset:8960
    s_add_u32 m0, s93, 132096
    s_add_u32 s99, s99, 524288
    s_mov_b64 exec, s[80:81]
    buffer_load_dwordx4 v77, s[16:19], s100 offen sc1 lds
    s_mov_b64 exec, -1
    s_add_u32 s100, s100, 524288
    s_waitcnt lgkmcnt(6)
    v_mfma_f32_16x16x32_bf16 v[112:115], a[44:47], v[184:187], v[112:115]
    ds_read_b64 v[172:173], v198 offset:1280
    v_mfma_f32_32x32x16_bf16 v[80:95], a[44:47], v[188:191], v[80:95]
    ds_read_b64 v[174:175], v198 offset:1344
    ds_read_b64 v[176:177], v196 offset:10240
    ds_read_b64 v[178:179], v196 offset:10752
    v_mfma_f32_32x32x16_bf16 v[96:111], a[44:47], v[192:195], v[96:111]
    ds_read_b64 v[180:181], v196 offset:10496
    ds_read_b64 v[182:183], v196 offset:11008
    s_lshl_b32 s25, s72, 5
    s_add_u32 s25, s25, 256
    s_sub_u32 s26, s25, 4
    s_max_i32 s26, s26, 0
    s_lshl_b32 s27, s71, 12
    s_add_u32 s27, s27, 9437184
    s_lshl_b32 s99, s25, 3
    s_lshl_b32 s100, s26, 3
    s_lshl_b32 s92, s24, 12
    s_lshl_b32 s93, s24, 9
    s_add_u32 s99, s99, s27
    s_add_u32 s100, s100, s27
    s_waitcnt lgkmcnt(6)
    v_mfma_f32_16x16x32_bf16 v[112:115], a[48:51], v[160:163], v[112:115]
    ds_read_b64 v[184:185], v198 offset:1536
    v_mfma_f32_32x32x16_bf16 v[80:95], a[48:51], v[164:167], v[80:95]
    ds_read_b64 v[186:187], v198 offset:1600
    ds_read_b64 v[188:189], v196 offset:12288
    ds_read_b64 v[190:191], v196 offset:12800
    v_mfma_f32_32x32x16_bf16 v[96:111], a[48:51], v[168:171], v[96:111]
    ds_read_b64 v[192:193], v196 offset:12544
    ds_read_b64 v[194:195], v196 offset:13056
    s_waitcnt lgkmcnt(6)
    v_mfma_f32_16x16x32_bf16 v[112:115], a[52:55], v[172:175], v[112:115]
    ds_read_b64 v[160:161], v198 offset:1792
    v_mfma_f32_32x32x16_bf16 v[80:95], a[52:55], v[176:179], v[80:95]
    ds_read_b64 v[162:163], v198 offset:1856
    ds_read_b64 v[164:165], v196 offset:14336
    ds_read_b64 v[166:167], v196 offset:14848
    v_mfma_f32_32x32x16_bf16 v[96:111], a[52:55], v[180:183], v[96:111]
    ds_read_b64 v[168:169], v196 offset:14592
    ds_read_b64 v[170:171], v196 offset:15104
    s_waitcnt vmcnt(10)
    v_cmp_gt_u32 vcc, 1, v7
    s_nop 0
    s_and_b64 vcc, vcc, s[50:51]
    s_cbranch_scc1 ps_54
pc_56:
    s_barrier
    s_waitcnt lgkmcnt(6)
    v_mfma_f32_16x16x32_bf16 v[112:115], a[56:59], v[184:187], v[112:115]
    v_add_u32 v198, v49, v198
    v_mfma_f32_32x32x16_bf16 v[80:95], a[56:59], v[188:191], v[80:95]
    v_add_u32 v196, 19584, v196
    ds_read_b64 v[172:173], v198 offset:0
    ds_read_b64 v[174:175], v198 offset:64
    ds_read_b64 v[176:177], v196 offset:0
    v_mfma_f32_32x32x16_bf16 v[96:111], a[56:59], v[192:195], v[96:111]
    ds_read_b64 v[178:179], v196 offset:512
    ds_read_b64 v[180:181], v196 offset:256
    ds_read_b64 v[182:183], v196 offset:768
    s_waitcnt lgkmcnt(6)
    v_mfma_f32_16x16x32_bf16 v[112:115], a[60:63], v[160:163], v[112:115]
    ds_read_b64 v[184:185], v198 offset:256
    v_mfma_f32_32x32x16_bf16 v[80:95], a[60:63], v[164:167], v[80:95]
    ds_read_b64 v[186:187], v198 offset:320
    ds_read_b64 v[188:189], v196 offset:2048
    ds_read_b64 v[190:191], v196 offset:2560
    v_mfma_f32_32x32x16_bf16 v[96:111], a[60:63], v[168:171], v[96:111]
    ds_read_b64 v[192:193], v196 offset:2304
    ds_read_b64 v[194:195], v196 offset:2816
    s_waitcnt lgkmcnt(6)
    v_mfma_f32_16x16x32_bf16 v[112:115], a[64:67], v[172:175], v[112:115]
    ds_read_b64 v[160:161], v198 offset:512
    v_mfma_f32_32x32x16_bf16 v[80:95], a[64:67], v[176:179], v[80:95]
    ds_read_b64 v[162:163], v198 offset:576
    ds_read_b64 v[164:165], v196 offset:4096
    ds_read_b64 v[166:167], v196 offset:4608
    v_mfma_f32_32x32x16_bf16 v[96:111], a[64:67], v[180:183], v[96:111]
    ds_read_b64 v[168:169], v196 offset:4352
    ds_read_b64 v[170:171], v196 offset:4864
    s_waitcnt lgkmcnt(6)
    v_mfma_f32_16x16x32_bf16 v[112:115], a[68:71], v[184:187], v[112:115]
    ds_read_b64 v[172:173], v198 offset:768
    v_mfma_f32_32x32x16_bf16 v[80:95], a[68:71], v[188:191], v[80:95]
    ds_read_b64 v[174:175], v198 offset:832
    ds_read_b64 v[176:177], v196 offset:6144
    ds_read_b64 v[178:179], v196 offset:6656
    v_mfma_f32_32x32x16_bf16 v[96:111], a[68:71], v[192:195], v[96:111]
    ds_read_b64 v[180:181], v196 offset:6400
    ds_read_b64 v[182:183], v196 offset:6912
    s_waitcnt lgkmcnt(6)
    v_mfma_f32_16x16x32_bf16 v[112:115], a[72:75], v[160:163], v[112:115]
    ds_read_b64 v[184:185], v198 offset:1024
    v_mfma_f32_32x32x16_bf16 v[80:95], a[72:75], v[164:167], v[80:95]
    ds_read_b64 v[186:187], v198 offset:1088
    ds_read_b64 v[188:189], v196 offset:8192
    ds_read_b64 v[190:191], v196 offset:8704
    v_mfma_f32_32x32x16_bf16 v[96:111], a[72:75], v[168:171], v[96:111]
    ds_read_b64 v[192:193], v196 offset:8448
    ds_read_b64 v[194:195], v196 offset:8960
    s_waitcnt lgkmcnt(6)
    v_mfma_f32_16x16x32_bf16 v[112:115], a[76:79], v[172:175], v[112:115]
    ds_read_b64 v[160:161], v198 offset:1280
    v_mfma_f32_32x32x16_bf16 v[80:95], a[76:79], v[176:179], v[80:95]
    ds_read_b64 v[162:163], v198 offset:1344
    ds_read_b64 v[164:165], v196 offset:10240
    ds_read_b64 v[166:167], v196 offset:10752
    v_mfma_f32_32x32x16_bf16 v[96:111], a[76:79], v[180:183], v[96:111]
    ds_read_b64 v[168:169], v196 offset:10496
    ds_read_b64 v[170:171], v196 offset:11008
    s_waitcnt lgkmcnt(6)
    v_mfma_f32_16x16x32_bf16 v[112:115], a[80:83], v[184:187], v[112:115]
    ds_read_b64 v[172:173], v198 offset:1536
    v_mfma_f32_32x32x16_bf16 v[80:95], a[80:83], v[188:191], v[80:95]
    ds_read_b64 v[174:175], v198 offset:1600
    ds_read_b64 v[176:177], v196 offset:12288
    ds_read_b64 v[178:179], v196 offset:12800
    v_mfma_f32_32x32x16_bf16 v[96:111], a[80:83], v[192:195], v[96:111]
    ds_read_b64 v[180:181], v196 offset:12544
    ds_read_b64 v[182:183], v196 offset:13056
    s_lshl_b32 s98, s72, 5
    s_add_u32 s98, s98, 0
    s_sub_u32 s95, s98, 4
    s_max_i32 s95, s95, 0
    s_lshl_b32 s94, s98, 3
    s_lshl_b32 s95, s95, 3
    s_add_u32 s94, s94, 3457024
    s_add_u32 s95, s95, 3457024
    s_add_u32 s96, s94, 8192
    buffer_load_dwordx2 v[152:153], v47, s[16:19], s94 offen sc1
    s_waitcnt lgkmcnt(6)
    v_mfma_f32_16x16x32_bf16 v[112:115], a[84:87], v[160:163], v[112:115]
    ds_read_b64 v[184:185], v198 offset:1792
    v_mfma_f32_32x32x16_bf16 v[80:95], a[84:87], v[164:167], v[80:95]
    ds_read_b64 v[186:187], v198 offset:1856
    ds_read_b64 v[188:189], v196 offset:14336
    ds_read_b64 v[190:191], v196 offset:14848
    v_mfma_f32_32x32x16_bf16 v[96:111], a[84:87], v[168:171], v[96:111]
    ds_read_b64 v[192:193], v196 offset:14592
    ds_read_b64 v[194:195], v196 offset:15104
    buffer_load_dwordx2 v[154:155], v47, s[16:19], s96 offen sc1
    s_waitcnt vmcnt(7)
    s_barrier
    s_waitcnt lgkmcnt(6)
    v_mfma_f32_16x16x32_bf16 v[112:115], a[88:91], v[172:175], v[112:115]
    v_add_u32_e64 v198, v49, v198
    v_mfma_f32_32x32x16_bf16 v[80:95], a[88:91], v[176:179], v[80:95]
    v_add_u32 v196, 19584, v196
    ds_read_b64 v[160:161], v198 offset:0
    ds_read_b64 v[162:163], v198 offset:64
    ds_read_b64 v[164:165], v196 offset:0
    v_mfma_f32_32x32x16_bf16 v[96:111], a[88:91], v[180:183], v[96:111]
    ds_read_b64 v[166:167], v196 offset:512
    ds_read_b64 v[168:169], v196 offset:256
    ds_read_b64 v[170:171], v196 offset:768
    buffer_load_dwordx2 v[156:157], v48, s[16:19], s95 offen sc1
    s_waitcnt lgkmcnt(6)
    v_mfma_f32_16x16x32_bf16 v[112:115], a[92:95], v[184:187], v[112:115]
    ds_read_b64 v[172:173], v198 offset:256
    v_mfma_f32_32x32x16_bf16 v[80:95], a[92:95], v[188:191], v[80:95]
    ds_read_b64 v[174:175], v198 offset:320
    ds_read_b64 v[176:177], v196 offset:2048
    ds_read_b64 v[178:179], v196 offset:2560
    v_mfma_f32_32x32x16_bf16 v[96:111], a[92:95], v[192:195], v[96:111]
    ds_read_b64 v[180:181], v196 offset:2304
    ds_read_b64 v[182:183], v196 offset:2816
    buffer_load_dword v7, v4, s[16:19], s89 offen offset:4 sc1
    s_waitcnt lgkmcnt(6)
    v_mfma_f32_16x16x32_bf16 v[112:115], a[96:99], v[160:163], v[112:115]
    ds_read_b64 v[184:185], v198 offset:512
    v_mfma_f32_32x32x16_bf16 v[80:95], a[96:99], v[164:167], v[80:95]
    ds_read_b64 v[186:187], v198 offset:576
    ds_read_b64 v[188:189], v196 offset:4096
    ds_read_b64 v[190:191], v196 offset:4608
    v_mfma_f32_32x32x16_bf16 v[96:111], a[96:99], v[168:171], v[96:111]
    ds_read_b64 v[192:193], v196 offset:4352
    ds_read_b64 v[194:195], v196 offset:4864
    s_waitcnt lgkmcnt(6)
    v_mfma_f32_16x16x32_bf16 v[112:115], a[100:103], v[172:175], v[112:115]
    ds_read_b64 v[160:161], v198 offset:768
    v_mfma_f32_32x32x16_bf16 v[80:95], a[100:103], v[176:179], v[80:95]
    ds_read_b64 v[162:163], v198 offset:832
    ds_read_b64 v[164:165], v196 offset:6144
    ds_read_b64 v[166:167], v196 offset:6656
    v_mfma_f32_32x32x16_bf16 v[96:111], a[100:103], v[180:183], v[96:111]
    ds_read_b64 v[168:169], v196 offset:6400
    ds_read_b64 v[170:171], v196 offset:6912
    s_waitcnt lgkmcnt(6)
    v_mfma_f32_16x16x32_bf16 v[112:115], a[104:107], v[184:187], v[112:115]
    ds_read_b64 v[172:173], v198 offset:1024
    v_mfma_f32_32x32x16_bf16 v[80:95], a[104:107], v[188:191], v[80:95]
    ds_read_b64 v[174:175], v198 offset:1088
    ds_read_b64 v[176:177], v196 offset:8192
    ds_read_b64 v[178:179], v196 offset:8704
    v_mfma_f32_32x32x16_bf16 v[96:111], a[104:107], v[192:195], v[96:111]
    ds_read_b64 v[180:181], v196 offset:8448
    ds_read_b64 v[182:183], v196 offset:8960
    s_waitcnt lgkmcnt(6)
    v_mfma_f32_16x16x32_bf16 v[112:115], a[108:111], v[160:163], v[112:115]
    ds_read_b64 v[184:185], v198 offset:1280
    v_mfma_f32_32x32x16_bf16 v[80:95], a[108:111], v[164:167], v[80:95]
    ds_read_b64 v[186:187], v198 offset:1344
    ds_read_b64 v[188:189], v196 offset:10240
    ds_read_b64 v[190:191], v196 offset:10752
    v_mfma_f32_32x32x16_bf16 v[96:111], a[108:111], v[168:171], v[96:111]
    ds_read_b64 v[192:193], v196 offset:10496
    ds_read_b64 v[194:195], v196 offset:11008
    s_waitcnt lgkmcnt(6)
    v_mfma_f32_16x16x32_bf16 v[112:115], a[112:115], v[172:175], v[112:115]
    ds_read_b64 v[160:161], v198 offset:1536
    v_mfma_f32_32x32x16_bf16 v[80:95], a[112:115], v[176:179], v[80:95]
    ds_read_b64 v[162:163], v198 offset:1600
    ds_read_b64 v[164:165], v196 offset:12288
    ds_read_b64 v[166:167], v196 offset:12800
    v_mfma_f32_32x32x16_bf16 v[96:111], a[112:115], v[180:183], v[96:111]
    ds_read_b64 v[168:169], v196 offset:12544
    ds_read_b64 v[170:171], v196 offset:13056
    s_waitcnt lgkmcnt(6)
    v_mfma_f32_16x16x32_bf16 v[112:115], a[116:119], v[184:187], v[112:115]
    ds_read_b64 v[172:173], v198 offset:1792
    v_mfma_f32_32x32x16_bf16 v[80:95], a[116:119], v[188:191], v[80:95]
    ds_read_b64 v[174:175], v198 offset:1856
    ds_read_b64 v[176:177], v196 offset:14336
    ds_read_b64 v[178:179], v196 offset:14848
    v_mfma_f32_32x32x16_bf16 v[96:111], a[116:119], v[192:195], v[96:111]
    ds_read_b64 v[180:181], v196 offset:14592
    ds_read_b64 v[182:183], v196 offset:15104
sl_57:
    s_waitcnt vmcnt(2)
    v_max3_u32 v2, v152, v153, v154
    s_waitcnt vmcnt(1)
    v_max3_u32 v2, v2, v155, v156
    v_max_u32 v2, v2, v157
    v_cmp_eq_u32 vcc, -1, v2
    s_nop 0
    s_cbranch_vccnz rd_58
rc_59:
    s_waitcnt vmcnt(0)
    v_cmp_gt_u32 vcc, 1, v7
    s_nop 0
    s_and_b64 vcc, vcc, s[50:51]
    s_cbranch_scc1 ps_60
pc_62:
    s_barrier
    s_waitcnt lgkmcnt(6)
    v_mfma_f32_16x16x32_bf16 v[112:115], a[120:123], v[160:163], v[112:115]
    v_add_u32_e64 v198, v49, v198
    v_mfma_f32_32x32x16_bf16 v[80:95], a[120:123], v[164:167], v[80:95]
    v_add_u32 v196, 19584, v196
    ds_read_b64 v[184:185], v198 offset:0
    ds_read_b64 v[186:187], v198 offset:64
    v_mul_f32 v148, v24, v157
    v_mul_f32 v149, v25, v157
    v_mfma_f32_32x32x16_bf16 v[96:111], a[120:123], v[168:171], v[96:111]
    ds_read_b64 v[188:189], v196 offset:0
    ds_read_b64 v[190:191], v196 offset:512
    s_sub_u32 s3, s2, 160
    s_and_b32 s3, s3, 63
    s_add_u32 s3, s3, 64
    s_and_b32 s25, s3, 3
    s_lshl_b32 s25, s25, 12
    s_lshr_b32 s26, s3, 2
    s_lshl_b32 s26, s26, 7
    s_add_u32 s3, s25, s26
    v_lshrrev_b32 v236, 3, v0
    v_and_b32 v237, 7, v0
    v_lshlrev_b32 v237, 4, v237
    v_lshl_add_u32 v236, v236, 14, v237
    s_sub_u32 s25, s2, 160
    s_cmp_lt_u32 s25, 64
    s_cselect_b32 s25, 0, 1073741824
    v_add_u32_e64 v236, s25, v236
    s_add_u32 s26, s3, 9437184
    buffer_load_dwordx4 v[216:219], v236, s[16:19], s26 offen sc1
    v_mul_f32 v150, v26, v157
    v_mul_f32_e64 v151, v27, v157
    s_waitcnt lgkmcnt(4)
    v_mfma_f32_16x16x32_bf16 v[112:115], a[124:127], v[172:175], v[112:115]
    ds_read_b64 v[192:193], v198 offset:256
    v_mfma_f32_32x32x16_bf16 v[80:95], a[124:127], v[176:179], v[80:95]
    ds_read_b64 v[194:195], v198 offset:320
    ds_read_b64 v[160:161], v196 offset:2048
    v_mul_f32 v116, v8, v153
    v_mul_f32 v117, v9, v153
    v_mul_f32_e64 v118, v10, v153
    v_mfma_f32_32x32x16_bf16 v[96:111], a[124:127], v[180:183], v[96:111]
    ds_read_b64 v[162:163], v196 offset:2560
    s_add_u32 s26, s26, 524288
    buffer_load_dwordx4 v[220:223], v236, s[16:19], s26 offen sc1
    v_mul_f32 v119, v11, v153
    v_mul_f32_e64 v120, v12, v153
    s_waitcnt lgkmcnt(4)
    v_mfma_f32_16x16x32_bf16 v[112:115], a[128:131], v[184:187], v[112:115]
    ds_read_b64 v[164:165], v198 offset:512
    v_mfma_f32_32x32x16_bf16 v[80:95], a[128:131], v[188:191], v[80:95]
    ds_read_b64 v[166:167], v198 offset:576
    ds_read_b64 v[168:169], v196 offset:4096
    ds_read_b64 v[170:171], v196 offset:4608
    v_mul_f32 v121, v13, v153
    v_mul_f32_e64 v122, v14, v153
    s_waitcnt lgkmcnt(4)
    v_mfma_f32_16x16x32_bf16 v[112:115], a[132:135], v[192:195], v[112:115]
    ds_read_b64 v[172:173], v198 offset:768
    v_mfma_f32_32x32x16_bf16 v[80:95], a[132:135], v[160:163], v[80:95]
    ds_read_b64 v[174:175], v198 offset:832
    ds_read_b64 v[176:177], v196 offset:6144
    ds_read_b64 v[178:179], v196 offset:6656
    s_add_u32 s26, s26, 524288
    buffer_load_dwordx4 v[224:227], v236, s[16:19], s26 offen sc1
    v_mul_f32 v123, v15, v153
    v_mul_f32_e64 v124, v16, v153
    s_waitcnt lgkmcnt(4)
    v_mfma_f32_16x16x32_bf16 v[112:115], a[136:139], v[164:167], v[112:115]
    ds_read_b64 v[180:181], v198 offset:1024
    v_mfma_f32_32x32x16_bf16 v[80:95], a[136:139], v[168:171], v[80:95]
    ds_read_b64 v[182:183], v198 offset:1088
    ds_read_b64 v[184:185], v196 offset:8192
    ds_read_b64 v[186:187], v196 offset:8704
    v_mul_f32 v125, v17, v153
    v_mul_f32_e64 v126, v18, v153
    s_waitcnt lgkmcnt(4)
    v_mfma_f32_16x16x32_bf16 v[112:115], a[140:143], v[172:175], v[112:115]
    ds_read_b64 v[188:189], v198 offset:1280
    v_mfma_f32_32x32x16_bf16 v[80:95], a[140:143], v[176:179], v[80:95]
    ds_read_b64 v[190:191], v198 offset:1344
    ds_read_b64 v[192:193], v196 offset:10240
    ds_read_b64 v[194:195], v196 offset:10752
    s_add_u32 s26, s26, 524288
    buffer_load_dwordx4 v[228:231], v236, s[16:19], s26 offen sc1
    v_mul_f32 v127, v19, v153
    v_mul_f32_e64 v128, v20, v153
    s_waitcnt lgkmcnt(4)
    v_mfma_f32_16x16x32_bf16 v[112:115], a[144:147], v[180:183], v[112:115]
    ds_read_b64 v[160:161], v198 offset:1536
    v_mfma_f32_32x32x16_bf16 v[80:95], a[144:147], v[184:187], v[80:95]
    ds_read_b64 v[162:163], v198 offset:1600
    ds_read_b64 v[164:165], v196 offset:12288
    ds_read_b64 v[166:167], v196 offset:12800
    v_mul_f32 v129, v21, v153
    v_mul_f32_e64 v130, v22, v153
    s_waitcnt lgkmcnt(4)
    v_mfma_f32_16x16x32_bf16 v[112:115], a[148:151], v[188:191], v[112:115]
    ds_read_b64 v[168:169], v198 offset:1792
    v_mfma_f32_32x32x16_bf16 v[80:95], a[148:151], v[192:195], v[80:95]
    ds_read_b64 v[170:171], v198 offset:1856
    ds_read_b64 v[172:173], v196 offset:14336
    ds_read_b64 v[174:175], v196 offset:14848
    s_add_u32 s26, s26, 524288
    buffer_load_dwordx4 v[232:235], v236, s[16:19], s26 offen sc1
    v_mul_f32 v131, v23, v153
    v_mul_f32_e64 v132, v8, v155
    s_waitcnt lgkmcnt(4)
    v_mfma_f32_16x16x32_bf16 v[112:115], a[152:155], v[160:163], v[112:115]
    ds_read_b64 v[176:177], v196 offset:256
    v_mfma_f32_32x32x16_bf16 v[80:95], a[152:155], v[164:167], v[80:95]
    ds_read_b64 v[178:179], v196 offset:768
    ds_read_b64 v[180:181], v196 offset:2304
    ds_read_b64 v[182:183], v196 offset:2816
    v_mul_f32 v133, v9, v155
    v_mul_f32_e64 v134, v10, v155
    s_waitcnt lgkmcnt(4)
    v_mfma_f32_16x16x32_bf16 v[112:115], a[156:159], v[168:171], v[112:115]
    ds_read_b64 v[184:185], v196 offset:4352
    v_mfma_f32_32x32x16_bf16 v[80:95], a[156:159], v[172:175], v[80:95]
    ds_read_b64 v[186:187], v196 offset:4864
    ds_read_b64 v[188:189], v196 offset:6400
    ds_read_b64 v[190:191], v196 offset:6912
    s_add_u32 m0, s92, 36352
    s_nop 0
    buffer_load_dwordx4 v73, s[16:19], s99 offen offset:0 sc1 lds
    v_mul_f32 v135, v11, v155
    v_mul_f32 v136, v12, v155
    v_mul_f32 v137, v13, v155
    v_mul_f32 v138, v14, v155
    v_mul_f32 v139, v15, v155
    v_mul_f32 v140, v16, v155
    v_mul_f32 v141, v17, v155
    v_mul_f32 v142, v18, v155
    v_mul_f32 v143, v19, v155
    v_mul_f32 v144, v20, v155
    v_mul_f32 v145, v21, v155
    v_mul_f32 v146, v22, v155
    v_mul_f32_e64 v147, v23, v155
    s_waitcnt lgkmcnt(4)
    v_mfma_f32_32x32x16_bf16 v[96:111], a[128:131], v[176:179], v[96:111]
    ds_read_b64 v[192:193], v196 offset:8448
    ds_read_b64 v[194:195], v196 offset:8960
    v_mfma_f32_32x32x16_bf16 v[96:111], a[132:135], v[180:183], v[96:111]
    ds_read_b64 v[160:161], v196 offset:10496
    ds_read_b64 v[162:163], v196 offset:11008
    buffer_load_dwordx4 v74, s[16:19], s99 offen offset:1024 sc1 lds
    v_fma_f32 v112, v112, v156, v148
    v_fma_f32 v113, v113, v156, v149
    s_waitcnt lgkmcnt(4)
    v_mfma_f32_32x32x16_bf16 v[96:111], a[136:139], v[184:187], v[96:111]
    ds_read_b64 v[164:165], v196 offset:12544
    ds_read_b64 v[166:167], v196 offset:13056
    v_fma_f32 v114, v114, v156, v150
    v_fma_f32 v115, v115, v156, v151
    v_cvt_pk_bf16_f32 v112, v112, v113
    v_mfma_f32_32x32x16_bf16 v[96:111], a[140:143], v[188:191], v[96:111]
    ds_read_b64 v[168:169], v196 offset:14592
    ds_read_b64 v[170:171], v196 offset:15104
    buffer_load_dwordx4 v75, s[16:19], s99 offen offset:2048 sc1 lds
    v_cvt_pk_bf16_f32 v113, v114, v115
    v_fma_f32 v80, v80, v152, v116
    s_waitcnt lgkmcnt(4)
    v_mfma_f32_32x32x16_bf16 v[96:111], a[144:147], v[192:195], v[96:111]
    v_fma_f32 v81, v81, v152, v117
    v_fma_f32 v82, v82, v152, v118
    v_fma_f32 v83, v83, v152, v119
    v_cvt_pk_bf16_f32 v80, v80, v81
    v_cvt_pk_bf16_f32 v81, v82, v83
    v_mfma_f32_32x32x16_bf16 v[96:111], a[148:151], v[160:163], v[96:111]
    ds_write_b64 v40, v[112:113] offset:0
    ds_write_b64 v38, v[80:81] offset:0
    v_fma_f32 v84, v84, v152, v120
    v_fma_f32 v85, v85, v152, v121
    s_waitcnt lgkmcnt(2)
    v_mfma_f32_32x32x16_bf16 v[96:111], a[152:155], v[164:167], v[96:111]
    v_fma_f32 v86, v86, v152, v122
    v_fma_f32 v87, v87, v152, v123
    v_cvt_pk_bf16_f32 v84, v84, v85
    v_cvt_pk_bf16_f32 v85, v86, v87
    v_fma_f32 v88, v88, v152, v124
    v_mfma_f32_32x32x16_bf16 v[96:111], a[156:159], v[168:171], v[96:111]
    buffer_load_dwordx4 v76, s[16:19], s99 offen offset:3072 sc1 lds
    v_fma_f32 v89, v89, v152, v125
    v_fma_f32 v90, v90, v152, v126
    v_fma_f32 v91, v91, v152, v127
    v_cvt_pk_bf16_f32 v88, v88, v89
    v_cvt_pk_bf16_f32 v89, v90, v91
    ds_write_b64 v38, v[84:85] offset:6400
    ds_write_b64 v38, v[88:89] offset:12800
    v_fma_f32 v92, v92, v152, v128
    v_fma_f32 v93, v93, v152, v129
    v_fma_f32 v94, v94, v152, v130
    v_fma_f32 v95, v95, v152, v131
    v_cvt_pk_bf16_f32 v92, v92, v93
    v_cvt_pk_bf16_f32 v93, v94, v95
    ds_write_b64 v39, v[92:93] offset:0
    v_pk_fma_f32 v[96:97], v[96:97], v[154:155], v[132:133] op_sel_hi:[1,0,1]
    v_pk_fma_f32 v[98:99], v[98:99], v[154:155], v[134:135] op_sel_hi:[1,0,1]
    v_cvt_pk_bf16_f32 v96, v96, v97
    v_cvt_pk_bf16_f32 v97, v98, v99
    v_pk_fma_f32 v[100:101], v[100:101], v[154:155], v[136:137] op_sel_hi:[1,0,1]
    v_pk_fma_f32 v[102:103], v[102:103], v[154:155], v[138:139] op_sel_hi:[1,0,1]
    v_cvt_pk_bf16_f32 v100, v100, v101
    v_cvt_pk_bf16_f32 v101, v102, v103
    ds_write_b64 v38, v[96:97] offset:1600
    ds_write_b64 v38, v[100:101] offset:8000
    v_pk_fma_f32 v[104:105], v[104:105], v[154:155], v[140:141] op_sel_hi:[1,0,1]
    v_pk_fma_f32 v[106:107], v[106:107], v[154:155], v[142:143] op_sel_hi:[1,0,1]
    v_cvt_pk_bf16_f32 v104, v104, v105
    v_cvt_pk_bf16_f32 v105, v106, v107
    v_pk_fma_f32 v[108:109], v[108:109], v[154:155], v[144:145] op_sel_hi:[1,0,1]
    v_pk_fma_f32 v[110:111], v[110:111], v[154:155], v[146:147] op_sel_hi:[1,0,1]
    v_cvt_pk_bf16_f32 v108, v108, v109
    v_cvt_pk_bf16_f32 v109, v110, v111
    ds_write_b64 v38, v[104:105] offset:14400
    ds_write_b64 v39, v[108:109] offset:1600
    v_cmp_u_f32 vcc, v82, v114
    v_cmp_u_f32 s[82:83], v98, v98
    s_lshl_b32 s25, s24, 2
    s_add_u32 s25, s25, 160256
    s_or_b64 vcc, vcc, s[82:83]
    s_cselect_b32 s26, 1, 0
    v_mov_b32 v196, s25
    v_mov_b32 v197, s26
    ds_write_b32 v196, v197
    s_waitcnt lgkmcnt(0)
    s_barrier
    s_sub_u32 s85, s2, 160
    s_cmp_ge_u32 s85, 64
    s_cbranch_scc1 s2_63
    v_mov_b32 v238, 0x3f803f80
    s_lshl_b32 s25, s24, 7
    s_add_u32 s25, s25, 134272
    v_lshrrev_b32 v239, 4, v1
    v_lshl_add_u32 v237, v239, 2, v237
    v_add_u32 v237, s25, v237
se_64:
    v_mov_b32 v240, 0
    v_mov_b32 v241, 0
    v_mov_b32 v242, 0
    v_mov_b32 v243, 0
    s_waitcnt vmcnt(8)
    v_dot2c_f32_bf16 v240, v216, v238
    v_dot2c_f32_bf16 v241, v216, v216
    v_dot2c_f32_bf16 v240, v217, v238
    v_dot2c_f32_bf16 v241, v217, v217
    v_dot2c_f32_bf16 v242, v218, v238
    v_dot2c_f32_bf16 v243, v218, v218
    v_dot2c_f32_bf16 v242, v219, v238
    v_dot2c_f32_bf16 v243, v219, v219
    s_waitcnt vmcnt(7)
    v_dot2c_f32_bf16 v240, v220, v238
    v_dot2c_f32_bf16 v241, v220, v220
    v_dot2c_f32_bf16 v240, v221, v238
    v_dot2c_f32_bf16 v241, v221, v221
    v_dot2c_f32_bf16 v242, v222, v238
    v_dot2c_f32_bf16 v243, v222, v222
    v_dot2c_f32_bf16 v242, v223, v238
    v_dot2c_f32_bf16 v243, v223, v223
    s_waitcnt vmcnt(6)
    v_dot2c_f32_bf16 v240, v224, v238
    v_dot2c_f32_bf16 v241, v224, v224
    v_dot2c_f32_bf16 v240, v225, v238
    v_dot2c_f32_bf16 v241, v225, v225
    v_dot2c_f32_bf16 v242, v226, v238
    v_dot2c_f32_bf16 v243, v226, v226
    v_dot2c_f32_bf16 v242, v227, v238
    v_dot2c_f32_bf16 v243, v227, v227
    s_waitcnt vmcnt(5)
    v_dot2c_f32_bf16 v240, v228, v238
    v_dot2c_f32_bf16 v241, v228, v228
    v_dot2c_f32_bf16 v240, v229, v238
    v_dot2c_f32_bf16 v241, v229, v229
    v_dot2c_f32_bf16 v242, v230, v238
    v_dot2c_f32_bf16 v243, v230, v230
    v_dot2c_f32_bf16 v242, v231, v238
    v_dot2c_f32_bf16 v243, v231, v231
    s_waitcnt vmcnt(4)
    v_dot2c_f32_bf16 v240, v232, v238
    v_dot2c_f32_bf16 v241, v232, v232
    v_dot2c_f32_bf16 v240, v233, v238
    v_dot2c_f32_bf16 v241, v233, v233
    v_dot2c_f32_bf16 v242, v234, v238
    v_dot2c_f32_bf16 v243, v234, v234
    v_dot2c_f32_bf16 v242, v235, v238
    v_dot2c_f32_bf16 v243, v235, v235
    s_nop 2
    v_cmp_u_f32 vcc, v241, v243
    s_nop 0
    s_cbranch_vccnz rd_65
rc_66:
    v_permlane32_swap_b32 v240, v242
    v_permlane32_swap_b32 v241, v243
    v_pk_add_f32 v[240:241], v[240:241], v[242:243]
    s_nop 1
    v_permlane16_swap_b32 v240, v241
    v_add_f32_e64 v240, v240, v241
    s_nop 1
    v_add_f32_dpp v240, v240, v240 row_ror:8 row_mask:0xf bank_mask:0xf
    ds_write_b32 v237, v240
    v_and_b32 v236, 15, v0
    v_lshlrev_b32 v236, 3, v236
    v_add_u32 v237, 134272, v236
    v_mov_b32 v239, 1073741824
    v_cmp_gt_u32 vcc, 16, v0
    s_nop 1
    v_cndmask_b32 v236, v239, v236, vcc
    s_add_u32 s25, s3, 3457024
    s_waitcnt lgkmcnt(0)
    s_barrier
    ds_read_b64 v[216:217], v237 offset:0
    ds_read_b64 v[218:219], v237 offset:128
    ds_read_b64 v[220:221], v237 offset:256
    ds_read_b64 v[222:223], v237 offset:384
    s_waitcnt lgkmcnt(2)
    v_pk_add_f32 v[216:217], v[216:217], v[218:219]
    s_waitcnt lgkmcnt(0)
    v_pk_add_f32 v[220:221], v[220:221], v[222:223]
    v_pk_add_f32 v[216:217], v[216:217], v[220:221]
    v_mul_f32 v239, 0x3acccccd, v216
    v_mul_f32 v217, 0x3acccccd, v217
    v_fma_f32 v217, -v239, v239, v217
    v_max_f32 v217, 0, v217
    v_add_f32 v217, 0x3727c5ac, v217
    v_rsq_f32_e64 v216, v217
    s_nop 0
    v_mul_f32 v217, -v239, v216
    buffer_store_dwordx2 v[216:217], v236, s[16:19], s25 offen sc1
s2_63:
    v_mov_b32 v158, 160256
    ds_read_b128 v[128:131], v158
    v_mov_b32 v94, 0
    v_mov_b32 v95, 0
    v_mov_b32 v98, 0
    v_mov_b32 v99, 0
    s_mov_b64 exec, 0xffff
    ds_read_b64 v[94:95], v42 offset:320
    ds_read_b64 v[98:99], v42 offset:640
    s_mov_b64 exec, -1
    s_nop 0
    ds_read_b64 v[92:93], v41 offset:320
    ds_read_b64 v[96:97], v41 offset:640
    ds_read_b64 v[84:85], v41 offset:6720
    ds_read_b64 v[86:87], v42 offset:6720
    ds_read_b64 v[80:81], v41 offset:6400
    ds_read_b64 v[82:83], v42 offset:6400
    ds_read_b64 v[88:89], v41 offset:7040
    ds_read_b64 v[90:91], v42 offset:7040
    ds_read_b64_tr_b16 v[106:107], v44 offset:0
    ds_read_b64_tr_b16 v[100:101], v43 offset:0
    s_add_u32 m0, s93, 53760
    s_add_u32 s99, s99, 524288
    s_mov_b64 exec, s[80:81]
    buffer_load_dwordx4 v77, s[16:19], s100 offen sc1 lds
    s_mov_b64 exec, -1
    s_add_u32 s100, s100, 524288
    ds_read_b64_tr_b16 v[108:109], v44 offset:320
    ds_read_b64_tr_b16 v[102:103], v43 offset:320
    ds_read_b64_tr_b16 v[110:111], v44 offset:640
    ds_read_b64_tr_b16 v[104:105], v43 offset:640
    v_mov_b32 v156, 0xf149f2ca
    v_cndmask_b32 v152, v32, v156, s[90:91]
    v_cndmask_b32 v153, v33, v156, s[90:91]
    v_cndmask_b32 v154, v34, v156, s[90:91]
    s_add_u32 m0, s92, 55936
    s_nop 0
    buffer_load_dwordx4 v73, s[16:19], s99 offen offset:0 sc1 lds
    v_cndmask_b32 v155, v35, v156, s[90:91]
    s_mov_b32 s82, 0x3ea52b5c
    s_lshl_b32 s25, s98, 4
    s_add_u32 s25, s25, 12058624
    s_lshl_b32 s26, s98, 3
    s_add_u32 s26, s26, 12058624
    s_waitcnt lgkmcnt(15)
    v_or3_b32 v128, v128, v129, v130
    v_or_b32 v128, v128, v131
    buffer_load_dwordx4 v74, s[16:19], s99 offen offset:1024 sc1 lds
    v_cmp_ne_u32_e64 vcc, 0, v128
    s_nop 0
    s_cbranch_vccnz rd_67
rc_68:
    s_waitcnt lgkmcnt(10)
    v_mfma_f32_16x16x32_bf16 v[116:119], v[84:87], v[92:95], v[28:31]
    v_mfma_f32_16x16x32_bf16 v[120:123], v[84:87], v[96:99], v[32:35]
    s_waitcnt lgkmcnt(8)
    v_mfma_f32_16x16x32_bf16 v[112:115], v[80:83], v[92:95], v[152:155]
    s_waitcnt lgkmcnt(6)
    v_mfma_f32_16x16x32_bf16 v[124:127], v[88:91], v[96:99], v[28:31]
    s_nop 5
    v_max_f32 v112, v112, v116
    v_max_f32 v113, v113, v117
    v_max_f32 v114, v114, v118
    buffer_load_dwordx4 v75, s[16:19], s99 offen offset:2048 sc1 lds
    v_max_f32 v115, v115, v119
    v_max3_f32 v156, v112, v113, v114
    v_max_f32 v156, v156, v115
    v_max_f32 v120, v120, v124
    v_max_f32 v121, v121, v125
    v_max_f32 v122, v122, v126
    v_max_f32 v123, v123, v127
    v_max3_f32 v157, v120, v121, v122
    buffer_load_dwordx4 v76, s[16:19], s99 offen offset:3072 sc1 lds
    v_max_f32 v157, v157, v123
    s_nop 1
    v_permlane16_swap_b32 v156, v157
    v_max_f32 v156, v156, v157
    v_mov_b32 v157, v156
    s_nop 1
    v_permlane32_swap_b32 v156, v157
    v_max_f32 v156, v156, v157
    v_mul_f32 v156, s82, v156
    v_mov_b32 v157, v156
    s_add_u32 m0, s93, 73344
    s_add_u32 s99, s99, 524288
    s_mov_b64 exec, s[80:81]
    buffer_load_dwordx4 v77, s[16:19], s100 offen sc1 lds
    s_mov_b64 exec, -1
    s_add_u32 s100, s100, 524288
    v_permlane16_swap_b32_e64 v156, v157
    v_fma_f32 v112, v112, s82, -v156
    v_fma_f32 v113, v113, s82, -v156
    v_fma_f32 v114, v114, s82, -v156
    v_fma_f32 v115, v115, s82, -v156
    v_exp_f32 v112, v112
    v_exp_f32 v113, v113
    v_exp_f32 v114, v114
    s_add_u32 m0, s92, 75520
    s_nop 0
    buffer_load_dwordx4 v73, s[16:19], s99 offen offset:0 sc1 lds
    v_exp_f32_e64 v115, v115
    v_cvt_pk_bf16_f32 v116, v112, v113
    v_cvt_pk_bf16_f32 v117, v114, v115
    v_bfi_b32 v128, v36, 0, v116
    v_and_b32 v130, v36, v116
    v_bfi_b32 v129, v37, 0, v117
    v_and_b32 v131, v37, v117
    s_waitcnt lgkmcnt(3)
    s_nop 0
    v_mfma_f32_16x16x32_bf16 v[144:147], v[106:109], v[128:131], 0
    buffer_load_dwordx4 v74, s[16:19], s99 offen offset:1024 sc1 lds
    s_waitcnt lgkmcnt(2)
    v_mfma_f32_16x16x32_bf16 v[136:139], v[100:103], v[128:131], 0
    v_fma_f32 v120, v120, s82, -v157
    v_fma_f32 v121, v121, s82, -v157
    v_fma_f32 v122, v122, s82, -v157
    v_fma_f32 v123, v123, s82, -v157
    v_exp_f32 v120, v120
    v_exp_f32 v121, v121
    v_exp_f32 v122, v122
    buffer_load_dwordx4 v75, s[16:19], s99 offen offset:2048 sc1 lds
    v_exp_f32_e64 v123, v123
    v_cvt_pk_bf16_f32 v124, v120, v121
    v_cvt_pk_bf16_f32 v125, v122, v123
    v_bfi_b32 v132, v36, 0, v124
    v_and_b32 v134, v36, v124
    v_bfi_b32 v133, v37, 0, v125
    v_and_b32 v135, v37, v125
    s_waitcnt lgkmcnt(1)
    s_nop 0
    v_mfma_f32_16x16x32_bf16 v[148:151], v[108:111], v[132:135], 0
    buffer_load_dwordx4 v76, s[16:19], s99 offen offset:3072 sc1 lds
    s_waitcnt lgkmcnt(0)
    v_mfma_f32_16x16x32_bf16 v[140:143], v[102:105], v[132:135], 0
    v_mov_b32 v158, v144
    s_nop 1
    v_permlane16_swap_b32 v144, v158
    v_rcp_f32 v158, v158
    s_nop 0
    v_pk_mul_f32 v[136:137], v[136:137], v[158:159] op_sel_hi:[1,0]
    v_pk_mul_f32 v[138:139], v[138:139], v[158:159] op_sel_hi:[1,0]
    v_pk_mul_f32 v[144:145], v[144:145], v[158:159] op_sel_hi:[1,0]
    v_pk_mul_f32 v[146:147], v[146:147], v[158:159] op_sel_hi:[1,0]
    s_add_u32 m0, s93, 92928
    s_add_u32 s99, s99, 524288
    s_mov_b64 exec, s[80:81]
    buffer_load_dwordx4 v77, s[16:19], s100 offen sc1 lds
    s_mov_b64 exec, -1
    s_add_u32 s100, s100, 524288
    v_cvt_pk_bf16_f32 v112, v136, v137
    v_cvt_pk_bf16_f32 v116, v144, v145
    v_cvt_pk_bf16_f32 v113, v138, v139
    v_cvt_pk_bf16_f32 v117, v146, v147
    v_mov_b32 v160, v148
    s_nop 1
    v_permlane16_swap_b32 v148, v160
    v_rcp_f32_e64 v160, v160
    s_nop 0
    v_pk_mul_f32 v[140:141], v[140:141], v[160:161] op_sel_hi:[1,0]
    v_pk_mul_f32 v[142:143], v[142:143], v[160:161] op_sel_hi:[1,0]
    v_pk_mul_f32 v[148:149], v[148:149], v[160:161] op_sel_hi:[1,0]
    v_pk_mul_f32 v[150:151], v[150:151], v[160:161] op_sel_hi:[1,0]
    v_cvt_pk_bf16_f32 v114, v140, v141
    v_cvt_pk_bf16_f32 v118, v148, v149
    v_cvt_pk_bf16_f32 v115, v142, v143
    v_cvt_pk_bf16_f32 v119, v150, v151
    v_permlane16_swap_b32 v112, v114
    v_permlane16_swap_b32 v113, v115
    v_permlane16_swap_b32 v116, v118
    v_permlane16_swap_b32 v117, v119
    buffer_store_dwordx4 v[112:115], v45, s[16:19], s25 offen sc1
    s_mov_b64 exec, s[80:81]
    buffer_store_dwordx2 v[116:117], v46, s[16:19], s26 offen sc1
    s_mov_b64 exec, -1
ge_69:
    v_add_u32 v196, 36352, v78
    v_mov_b32_e64 v198, v79
    s_waitcnt vmcnt(12)
    s_barrier
    ds_read_b64 v[160:161], v198 offset:0
    ds_read_b64 v[162:163], v198 offset:64
    ds_read_b64 v[164:165], v196 offset:0
    ds_read_b64 v[166:167], v196 offset:512
    ds_read_b64 v[168:169], v196 offset:256
    ds_read_b64 v[170:171], v196 offset:768
    ds_read_b64 v[172:173], v198 offset:256
    ds_read_b64 v[174:175], v198 offset:320
    ds_read_b64 v[176:177], v196 offset:2048
    ds_read_b64 v[178:179], v196 offset:2560
    ds_read_b64 v[180:181], v196 offset:2304
    ds_read_b64 v[182:183], v196 offset:2816
    s_waitcnt lgkmcnt(6)
    v_mfma_f32_16x16x32_bf16 v[112:115], a[0:3], v[160:163], 0
    ds_read_b64 v[184:185], v198 offset:512
    v_mfma_f32_32x32x16_bf16 v[80:95], a[0:3], v[164:167], 0
    ds_read_b64 v[186:187], v198 offset:576
    ds_read_b64 v[188:189], v196 offset:4096
    ds_read_b64 v[190:191], v196 offset:4608
    v_mfma_f32_32x32x16_bf16 v[96:111], a[0:3], v[168:171], 0
    ds_read_b64 v[192:193], v196 offset:4352
    ds_read_b64 v[194:195], v196 offset:4864
    s_add_u32 m0, s92, 95104
    s_nop 0
    buffer_load_dwordx4 v73, s[16:19], s99 offen offset:0 sc1 lds
    s_waitcnt lgkmcnt(6)
    v_mfma_f32_16x16x32_bf16 v[112:115], a[4:7], v[172:175], v[112:115]
    ds_read_b64 v[160:161], v198 offset:768
    v_mfma_f32_32x32x16_bf16 v[80:95], a[4:7], v[176:179], v[80:95]
    ds_read_b64 v[162:163], v198 offset:832
    ds_read_b64 v[164:165], v196 offset:6144
    ds_read_b64 v[166:167], v196 offset:6656
    v_mfma_f32_32x32x16_bf16 v[96:111], a[4:7], v[180:183], v[96:111]
    ds_read_b64 v[168:169], v196 offset:6400
    ds_read_b64 v[170:171], v196 offset:6912
    buffer_load_dwordx4 v74, s[16:19], s99 offen offset:1024 sc1 lds
    s_waitcnt lgkmcnt(6)
    v_mfma_f32_16x16x32_bf16 v[112:115], a[8:11], v[184:187], v[112:115]
    ds_read_b64 v[172:173], v198 offset:1024
    v_mfma_f32_32x32x16_bf16 v[80:95], a[8:11], v[188:191], v[80:95]
    ds_read_b64 v[174:175], v198 offset:1088
    ds_read_b64 v[176:177], v196 offset:8192
    ds_read_b64 v[178:179], v196 offset:8704
    v_mfma_f32_32x32x16_bf16 v[96:111], a[8:11], v[192:195], v[96:111]
    ds_read_b64 v[180:181], v196 offset:8448
    ds_read_b64 v[182:183], v196 offset:8960
    buffer_load_dwordx4 v75, s[16:19], s99 offen offset:2048 sc1 lds
    s_waitcnt lgkmcnt(6)
    v_mfma_f32_16x16x32_bf16 v[112:115], a[12:15], v[160:163], v[112:115]
    ds_read_b64 v[184:185], v198 offset:1280
    v_mfma_f32_32x32x16_bf16 v[80:95], a[12:15], v[164:167], v[80:95]
    ds_read_b64 v[186:187], v198 offset:1344
    ds_read_b64 v[188:189], v196 offset:10240
    ds_read_b64 v[190:191], v196 offset:10752
    v_mfma_f32_32x32x16_bf16 v[96:111], a[12:15], v[168:171], v[96:111]
    ds_read_b64 v[192:193], v196 offset:10496
    ds_read_b64 v[194:195], v196 offset:11008
    buffer_load_dwordx4 v76, s[16:19], s99 offen offset:3072 sc1 lds
    s_waitcnt lgkmcnt(6)
    v_mfma_f32_16x16x32_bf16 v[112:115], a[16:19], v[172:175], v[112:115]
    ds_read_b64 v[160:161], v198 offset:1536
    v_mfma_f32_32x32x16_bf16 v[80:95], a[16:19], v[176:179], v[80:95]
    ds_read_b64 v[162:163], v198 offset:1600
    ds_read_b64 v[164:165], v196 offset:12288
    ds_read_b64 v[166:167], v196 offset:12800
    v_mfma_f32_32x32x16_bf16 v[96:111], a[16:19], v[180:183], v[96:111]
    ds_read_b64 v[168:169], v196 offset:12544
    ds_read_b64 v[170:171], v196 offset:13056
    s_add_u32 m0, s93, 112512
    s_add_u32 s99, s99, 524288
    s_mov_b64 exec, s[80:81]
    buffer_load_dwordx4 v77, s[16:19], s100 offen sc1 lds
    s_mov_b64 exec, -1
    s_add_u32 s100, s100, 524288
    s_waitcnt lgkmcnt(6)
    v_mfma_f32_16x16x32_bf16 v[112:115], a[20:23], v[184:187], v[112:115]
    ds_read_b64 v[172:173], v198 offset:1792
    v_mfma_f32_32x32x16_bf16 v[80:95], a[20:23], v[188:191], v[80:95]
    ds_read_b64 v[174:175], v198 offset:1856
    ds_read_b64 v[176:177], v196 offset:14336
    ds_read_b64 v[178:179], v196 offset:14848
    v_mfma_f32_32x32x16_bf16 v[96:111], a[20:23], v[192:195], v[96:111]
    ds_read_b64 v[180:181], v196 offset:14592
    ds_read_b64 v[182:183], v196 offset:15104
    s_add_u32 m0, s92, 114688
    s_nop 0
    buffer_load_dwordx4 v73, s[16:19], s99 offen offset:0 sc1 lds
    s_waitcnt vmcnt(13)
    s_barrier
    s_waitcnt lgkmcnt(6)
    v_mfma_f32_16x16x32_bf16 v[112:115], a[24:27], v[160:163], v[112:115]
    v_add_u32 v198, v49, v198
    v_mfma_f32_32x32x16_bf16 v[80:95], a[24:27], v[164:167], v[80:95]
    v_add_u32 v196, 19584, v196
    ds_read_b64 v[184:185], v198 offset:0
    ds_read_b64 v[186:187], v198 offset:64
    ds_read_b64 v[188:189], v196 offset:0
    v_mfma_f32_32x32x16_bf16 v[96:111], a[24:27], v[168:171], v[96:111]
    ds_read_b64 v[190:191], v196 offset:512
    ds_read_b64 v[192:193], v196 offset:256
    ds_read_b64 v[194:195], v196 offset:768
    buffer_load_dwordx4 v74, s[16:19], s99 offen offset:1024 sc1 lds
    s_waitcnt lgkmcnt(6)
    v_mfma_f32_16x16x32_bf16 v[112:115], a[28:31], v[172:175], v[112:115]
    ds_read_b64 v[160:161], v198 offset:256
    v_mfma_f32_32x32x16_bf16 v[80:95], a[28:31], v[176:179], v[80:95]
    ds_read_b64 v[162:163], v198 offset:320
    ds_read_b64 v[164:165], v196 offset:2048
    ds_read_b64 v[166:167], v196 offset:2560
    v_mfma_f32_32x32x16_bf16 v[96:111], a[28:31], v[180:183], v[96:111]
    ds_read_b64 v[168:169], v196 offset:2304
    ds_read_b64 v[170:171], v196 offset:2816
    buffer_load_dwordx4 v75, s[16:19], s99 offen offset:2048 sc1 lds
    s_waitcnt lgkmcnt(6)
    v_mfma_f32_16x16x32_bf16 v[112:115], a[32:35], v[184:187], v[112:115]
    ds_read_b64 v[172:173], v198 offset:512
    v_mfma_f32_32x32x16_bf16 v[80:95], a[32:35], v[188:191], v[80:95]
    ds_read_b64 v[174:175], v198 offset:576
    ds_read_b64 v[176:177], v196 offset:4096
    ds_read_b64 v[178:179], v196 offset:4608
    v_mfma_f32_32x32x16_bf16 v[96:111], a[32:35], v[192:195], v[96:111]
    ds_read_b64 v[180:181], v196 offset:4352
    ds_read_b64 v[182:183], v196 offset:4864
    buffer_load_dwordx4 v76, s[16:19], s99 offen offset:3072 sc1 lds
    s_waitcnt lgkmcnt(6)
    v_mfma_f32_16x16x32_bf16 v[112:115], a[36:39], v[160:163], v[112:115]
    ds_read_b64 v[184:185], v198 offset:768
    v_mfma_f32_32x32x16_bf16 v[80:95], a[36:39], v[164:167], v[80:95]
    ds_read_b64 v[186:187], v198 offset:832
    ds_read_b64 v[188:189], v196 offset:6144
    ds_read_b64 v[190:191], v196 offset:6656
    v_mfma_f32_32x32x16_bf16 v[96:111], a[36:39], v[168:171], v[96:111]
    ds_read_b64 v[192:193], v196 offset:6400
    ds_read_b64 v[194:195], v196 offset:6912
    s_add_u32 m0, s93, 132096
    s_add_u32 s99, s99, 524288
    s_mov_b64 exec, s[80:81]
    buffer_load_dwordx4 v77, s[16:19], s100 offen sc1 lds
    s_mov_b64 exec, -1
    s_add_u32 s100, s100, 524288
    s_waitcnt lgkmcnt(6)
    v_mfma_f32_16x16x32_bf16 v[112:115], a[40:43], v[172:175], v[112:115]
    ds_read_b64 v[160:161], v198 offset:1024
    v_mfma_f32_32x32x16_bf16 v[80:95], a[40:43], v[176:179], v[80:95]
    ds_read_b64 v[162:163], v198 offset:1088
    ds_read_b64 v[164:165], v196 offset:8192
    ds_read_b64 v[166:167], v196 offset:8704
    v_add_u32 v199, 36352, v58
    s_lshl_b32 s32, s24, 11
    v_mfma_f32_32x32x16_bf16 v[96:111], a[40:43], v[180:183], v[96:111]
    ds_read_b64 v[168:169], v196 offset:8448
    ds_read_b64 v[170:171], v196 offset:8960
    v_add_u32 v203, s32, v199
    s_add_u32 s32, s24, 1
    s_waitcnt lgkmcnt(6)
    v_mfma_f32_16x16x32_bf16 v[112:115], a[44:47], v[184:187], v[112:115]
    ds_read_b64 v[172:173], v198 offset:1280
    v_mfma_f32_32x32x16_bf16 v[80:95], a[44:47], v[188:191], v[80:95]
    ds_read_b64 v[174:175], v198 offset:1344
    ds_read_b64 v[176:177], v196 offset:10240
    ds_read_b64 v[178:179], v196 offset:10752
    s_and_b32 s32, s32, 3
    s_mul_i32 s32, s32, 6144
    v_mfma_f32_32x32x16_bf16 v[96:111], a[44:47], v[192:195], v[96:111]
    ds_read_b64 v[180:181], v196 offset:10496
    ds_read_b64 v[182:183], v196 offset:11008
    v_add_u32 v200, s32, v199
    s_add_u32 s32, s24, 2
    s_waitcnt lgkmcnt(6)
    v_mfma_f32_16x16x32_bf16 v[112:115], a[48:51], v[160:163], v[112:115]
    ds_read_b64 v[184:185], v198 offset:1536
    v_mfma_f32_32x32x16_bf16 v[80:95], a[48:51], v[164:167], v[80:95]
    ds_read_b64 v[186:187], v198 offset:1600
    ds_read_b64 v[188:189], v196 offset:12288
    ds_read_b64 v[190:191], v196 offset:12800
    s_and_b32 s32, s32, 3
    s_mul_i32 s32, s32, 6144
    v_mfma_f32_32x32x16_bf16 v[96:111], a[48:51], v[168:171], v[96:111]
    ds_read_b64 v[192:193], v196 offset:12544
    ds_read_b64 v[194:195], v196 offset:13056
    v_add_u32 v201, s32, v199
    s_add_u32 s32, s24, 3
    s_waitcnt lgkmcnt(6)
    v_mfma_f32_16x16x32_bf16 v[112:115], a[52:55], v[172:175], v[112:115]
    ds_read_b64 v[160:161], v198 offset:1792
    v_mfma_f32_32x32x16_bf16 v[80:95], a[52:55], v[176:179], v[80:95]
    ds_read_b64 v[162:163], v198 offset:1856
    ds_read_b64 v[164:165], v196 offset:14336
    ds_read_b64 v[166:167], v196 offset:14848
    s_and_b32 s32, s32, 3
    s_mul_i32 s32, s32, 6144
    v_mfma_f32_32x32x16_bf16 v[96:111], a[52:55], v[180:183], v[96:111]
    ds_read_b64 v[168:169], v196 offset:14592
    ds_read_b64 v[170:171], v196 offset:15104
    v_add_u32 v202, s32, v199
    s_mul_i32 s32, s24, 6144
    s_waitcnt vmcnt(12)
    s_barrier
    s_waitcnt lgkmcnt(6)
    v_mfma_f32_16x16x32_bf16 v[112:115], a[56:59], v[184:187], v[112:115]
    v_add_u32 v198, v49, v198
    v_mfma_f32_32x32x16_bf16 v[80:95], a[56:59], v[188:191], v[80:95]
    v_add_u32 v196, 19584, v196
    ds_read_b64 v[172:173], v198 offset:0
    ds_read_b64 v[174:175], v198 offset:64
    ds_read_b64 v[176:177], v196 offset:0
    v_add_u32_e64 v204, s32, v199
    v_mfma_f32_32x32x16_bf16 v[96:111], a[56:59], v[192:195], v[96:111]
    ds_read_b64 v[178:179], v196 offset:512
    ds_read_b64 v[180:181], v196 offset:256
    ds_read_b64 v[182:183], v196 offset:768
    s_lshl_b32 s32, s24, 8
    s_waitcnt lgkmcnt(6)
    v_mfma_f32_16x16x32_bf16 v[112:115], a[60:63], v[160:163], v[112:115]
    ds_read_b64 v[184:185], v198 offset:256
    v_mfma_f32_32x32x16_bf16 v[80:95], a[60:63], v[164:167], v[80:95]
    ds_read_b64 v[186:187], v198 offset:320
    ds_read_b64 v[188:189], v196 offset:2048
    ds_read_b64 v[190:191], v196 offset:2560
    s_add_u32 s32, s32, 36352
    v_and_b32_e64 v214, 15, v1
    v_mfma_f32_32x32x16_bf16 v[96:111], a[60:63], v[168:171], v[96:111]
    ds_read_b64 v[192:193], v196 offset:2304
    ds_read_b64 v[194:195], v196 offset:2816
    v_lshl_add_u32 v206, v214, 4, s32
    v_lshrrev_b32 v215, 5, v1
    s_waitcnt lgkmcnt(6)
    v_mfma_f32_16x16x32_bf16 v[112:115], a[64:67], v[172:175], v[112:115]
    ds_read_b64 v[160:161], v198 offset:512
    v_mfma_f32_32x32x16_bf16 v[80:95], a[64:67], v[176:179], v[80:95]
    ds_read_b64 v[162:163], v198 offset:576
    ds_read_b64 v[164:165], v196 offset:4096
    ds_read_b64 v[166:167], v196 offset:4608
    v_lshl_add_u32 v205, v215, 10, v206
    v_bfe_u32 v215, v1, 4, 1
    v_mfma_f32_32x32x16_bf16 v[96:111], a[64:67], v[180:183], v[96:111]
    ds_read_b64 v[168:169], v196 offset:4352
    ds_read_b64 v[170:171], v196 offset:4864
    v_lshl_add_u32 v205, v215, 3, v205
    v_lshlrev_b32 v214, 2, v214
    s_waitcnt lgkmcnt(6)
    v_mfma_f32_16x16x32_bf16 v[112:115], a[68:71], v[184:187], v[112:115]
    ds_read_b64 v[172:173], v198 offset:768
    v_mfma_f32_32x32x16_bf16 v[80:95], a[68:71], v[188:191], v[80:95]
    ds_read_b64 v[174:175], v198 offset:832
    ds_read_b64 v[176:177], v196 offset:6144
    ds_read_b64 v[178:179], v196 offset:6656
    v_lshl_add_u32 v214, v215, 10, v214
    s_lshl_b32 s32, s24, 6
    v_mfma_f32_32x32x16_bf16 v[96:111], a[68:71], v[192:195], v[96:111]
    ds_read_b64 v[180:181], v196 offset:6400
    ds_read_b64 v[182:183], v196 offset:6912
    v_lshl_add_u32 v207, v215, 3, s32
    v_and_b32_e64 v215, 12, v1
    s_waitcnt lgkmcnt(6)
    v_mfma_f32_16x16x32_bf16 v[112:115], a[72:75], v[160:163], v[112:115]
    ds_read_b64 v[184:185], v198 offset:1024
    v_mfma_f32_32x32x16_bf16 v[80:95], a[72:75], v[164:167], v[80:95]
    ds_read_b64 v[186:187], v198 offset:1088
    ds_read_b64 v[188:189], v196 offset:8192
    ds_read_b64 v[190:191], v196 offset:8704
    v_lshl_add_u32 v207, v215, 2, v207
    v_and_b32_e64 v215, 2, v1
    v_mfma_f32_32x32x16_bf16 v[96:111], a[72:75], v[168:171], v[96:111]
    ds_read_b64 v[192:193], v196 offset:8448
    ds_read_b64 v[194:195], v196 offset:8960
    s_lshl_b32 s98, s72, 5
    s_add_u32 s98, s98, 256
    s_sub_u32 s95, s98, 4
    s_max_i32 s95, s95, 0
    s_lshl_b32 s94, s98, 3
    s_lshl_b32 s95, s95, 3
    s_add_u32 s94, s94, 3457024
    s_add_u32 s95, s95, 3457024
    s_add_u32 s96, s94, 8192
    buffer_load_dwordx2 v[152:153], v47, s[16:19], s94 offen sc1
    s_waitcnt lgkmcnt(6)
    v_mfma_f32_16x16x32_bf16 v[112:115], a[76:79], v[172:175], v[112:115]
    ds_read_b64 v[160:161], v198 offset:1280
    v_mfma_f32_32x32x16_bf16 v[80:95], a[76:79], v[176:179], v[80:95]
    ds_read_b64 v[162:163], v198 offset:1344
    ds_read_b64 v[164:165], v196 offset:10240
    ds_read_b64 v[166:167], v196 offset:10752
    v_lshl_add_u32 v207, v215, 1, v207
    v_add_u32 v207, 69120, v207
    v_mfma_f32_32x32x16_bf16 v[96:111], a[76:79], v[180:183], v[96:111]
    ds_read_b64 v[168:169], v196 offset:10496
    ds_read_b64 v[170:171], v196 offset:11008
    buffer_load_dwordx2 v[154:155], v47, s[16:19], s96 offen sc1
    v_lshrrev_b32 v215, 4, v1
    s_waitcnt lgkmcnt(6)
    v_mfma_f32_16x16x32_bf16 v[112:115], a[80:83], v[184:187], v[112:115]
    ds_read_b64 v[172:173], v198 offset:1536
    v_mfma_f32_32x32x16_bf16 v[80:95], a[80:83], v[188:191], v[80:95]
    ds_read_b64 v[174:175], v198 offset:1600
    ds_read_b64 v[176:177], v196 offset:12288
    ds_read_b64 v[178:179], v196 offset:12800
    v_lshl_add_u32 v206, v215, 2, v206
    v_mov_b32 v215, 0x3f803f80
    v_mfma_f32_32x32x16_bf16 v[96:111], a[80:83], v[192:195], v[96:111]
    ds_read_b64 v[180:181], v196 offset:12544
    ds_read_b64 v[182:183], v196 offset:13056
    buffer_load_dwordx2 v[156:157], v48, s[16:19], s95 offen sc1
    s_waitcnt lgkmcnt(6)
    v_mfma_f32_16x16x32_bf16 v[112:115], a[84:87], v[160:163], v[112:115]
    ds_read_b64 v[184:185], v198 offset:1792
    v_mfma_f32_32x32x16_bf16 v[80:95], a[84:87], v[164:167], v[80:95]
    ds_read_b64 v[186:187], v198 offset:1856
    ds_read_b64 v[188:189], v196 offset:14336
    ds_read_b64 v[190:191], v196 offset:14848
    v_mfma_f32_32x32x16_bf16 v[96:111], a[84:87], v[168:171], v[96:111]
    ds_read_b64 v[192:193], v196 offset:14592
    ds_read_b64 v[194:195], v196 offset:15104
    s_waitcnt vmcnt(8)
    s_barrier
    s_waitcnt lgkmcnt(6)
    v_mfma_f32_16x16x32_bf16 v[112:115], a[88:91], v[172:175], v[112:115]
    v_add_u32_e64 v198, v49, v198
    v_mfma_f32_32x32x16_bf16 v[80:95], a[88:91], v[176:179], v[80:95]
    v_add_u32 v196, 19584, v196
    ds_read_b64 v[160:161], v198 offset:0
    ds_read_b64 v[162:163], v198 offset:64
    ds_read_b64 v[164:165], v196 offset:0
    v_mfma_f32_32x32x16_bf16 v[96:111], a[88:91], v[180:183], v[96:111]
    ds_read_b64 v[166:167], v196 offset:512
    ds_read_b64 v[168:169], v196 offset:256
    ds_read_b64 v[170:171], v196 offset:768
    s_waitcnt lgkmcnt(6)
    v_mfma_f32_16x16x32_bf16 v[112:115], a[92:95], v[184:187], v[112:115]
    ds_read_b64 v[172:173], v198 offset:256
    v_mfma_f32_32x32x16_bf16 v[80:95], a[92:95], v[188:191], v[80:95]
    ds_read_b64 v[174:175], v198 offset:320
    ds_read_b64 v[176:177], v196 offset:2048
    ds_read_b64 v[178:179], v196 offset:2560
    v_mfma_f32_32x32x16_bf16 v[96:111], a[92:95], v[192:195], v[96:111]
    ds_read_b64 v[180:181], v196 offset:2304
    ds_read_b64 v[182:183], v196 offset:2816
    s_waitcnt lgkmcnt(6)
    v_mfma_f32_16x16x32_bf16 v[112:115], a[96:99], v[160:163], v[112:115]
    ds_read_b64 v[184:185], v198 offset:512
    v_mfma_f32_32x32x16_bf16 v[80:95], a[96:99], v[164:167], v[80:95]
    ds_read_b64 v[186:187], v198 offset:576
    ds_read_b64 v[188:189], v196 offset:4096
    ds_read_b64 v[190:191], v196 offset:4608
    v_mfma_f32_32x32x16_bf16 v[96:111], a[96:99], v[168:171], v[96:111]
    ds_read_b64 v[192:193], v196 offset:4352
    ds_read_b64 v[194:195], v196 offset:4864
    s_waitcnt lgkmcnt(6)
    v_mfma_f32_16x16x32_bf16 v[112:115], a[100:103], v[172:175], v[112:115]
    ds_read_b64 v[160:161], v198 offset:768
    v_mfma_f32_32x32x16_bf16 v[80:95], a[100:103], v[176:179], v[80:95]
    ds_read_b64 v[162:163], v198 offset:832
    ds_read_b64 v[164:165], v196 offset:6144
    ds_read_b64 v[166:167], v196 offset:6656
    v_mfma_f32_32x32x16_bf16 v[96:111], a[100:103], v[180:183], v[96:111]
    ds_read_b64 v[168:169], v196 offset:6400
    ds_read_b64 v[170:171], v196 offset:6912
    s_waitcnt lgkmcnt(6)
    v_mfma_f32_16x16x32_bf16 v[112:115], a[104:107], v[184:187], v[112:115]
    ds_read_b64 v[172:173], v198 offset:1024
    v_mfma_f32_32x32x16_bf16 v[80:95], a[104:107], v[188:191], v[80:95]
    ds_read_b64 v[174:175], v198 offset:1088
    ds_read_b64 v[176:177], v196 offset:8192
    ds_read_b64 v[178:179], v196 offset:8704
    v_mfma_f32_32x32x16_bf16 v[96:111], a[104:107], v[192:195], v[96:111]
    ds_read_b64 v[180:181], v196 offset:8448
    ds_read_b64 v[182:183], v196 offset:8960
    s_waitcnt lgkmcnt(6)
    v_mfma_f32_16x16x32_bf16 v[112:115], a[108:111], v[160:163], v[112:115]
    ds_read_b64 v[184:185], v198 offset:1280
    v_mfma_f32_32x32x16_bf16 v[80:95], a[108:111], v[164:167], v[80:95]
    ds_read_b64 v[186:187], v198 offset:1344
    ds_read_b64 v[188:189], v196 offset:10240
    ds_read_b64 v[190:191], v196 offset:10752
    v_mfma_f32_32x32x16_bf16 v[96:111], a[108:111], v[168:171], v[96:111]
    ds_read_b64 v[192:193], v196 offset:10496
    ds_read_b64 v[194:195], v196 offset:11008
    s_waitcnt lgkmcnt(6)
    v_mfma_f32_16x16x32_bf16 v[112:115], a[112:115], v[172:175], v[112:115]
    ds_read_b64 v[160:161], v198 offset:1536
    v_mfma_f32_32x32x16_bf16 v[80:95], a[112:115], v[176:179], v[80:95]
    ds_read_b64 v[162:163], v198 offset:1600
    ds_read_b64 v[164:165], v196 offset:12288
    ds_read_b64 v[166:167], v196 offset:12800
    v_mfma_f32_32x32x16_bf16 v[96:111], a[112:115], v[180:183], v[96:111]
    ds_read_b64 v[168:169], v196 offset:12544
    ds_read_b64 v[170:171], v196 offset:13056
    s_waitcnt lgkmcnt(6)
    v_mfma_f32_16x16x32_bf16 v[112:115], a[116:119], v[184:187], v[112:115]
    ds_read_b64 v[172:173], v198 offset:1792
    v_mfma_f32_32x32x16_bf16 v[80:95], a[116:119], v[188:191], v[80:95]
    ds_read_b64 v[174:175], v198 offset:1856
    ds_read_b64 v[176:177], v196 offset:14336
    ds_read_b64 v[178:179], v196 offset:14848
    v_mfma_f32_32x32x16_bf16 v[96:111], a[116:119], v[192:195], v[96:111]
    ds_read_b64 v[180:181], v196 offset:14592
    ds_read_b64 v[182:183], v196 offset:15104
sl_70:
    s_waitcnt vmcnt(1)
    v_max3_u32 v2, v152, v153, v154
    s_waitcnt vmcnt(0)
    v_max3_u32 v2, v2, v155, v156
    v_max_u32 v2, v2, v157
    v_cmp_eq_u32 vcc, -1, v2
    s_nop 0
    s_cbranch_vccnz rd_71
rc_72:
    s_barrier
    s_waitcnt lgkmcnt(6)
    v_mfma_f32_16x16x32_bf16 v[112:115], a[120:123], v[160:163], v[112:115]
    v_add_u32 v198, v49, v198
    v_mfma_f32_32x32x16_bf16 v[80:95], a[120:123], v[164:167], v[80:95]
    v_add_u32 v196, 19584, v196
    ds_read_b64 v[184:185], v198 offset:0
    ds_read_b64 v[186:187], v198 offset:64
    v_mul_f32 v148, v24, v157
    v_mul_f32 v149, v25, v157
    v_mfma_f32_32x32x16_bf16 v[96:111], a[120:123], v[168:171], v[96:111]
    ds_read_b64 v[188:189], v196 offset:0
    ds_read_b64 v[190:191], v196 offset:512
    s_mov_b32 s96, 12058624
    buffer_load_dwordx4 v[216:219], v56, s[16:19], s96 offen offset:0 sc1
    v_mul_f32 v150, v26, v157
    v_mul_f32_e64 v151, v27, v157
    s_waitcnt lgkmcnt(4)
    v_mfma_f32_16x16x32_bf16 v[112:115], a[124:127], v[172:175], v[112:115]
    ds_read_b64 v[192:193], v198 offset:256
    v_mfma_f32_32x32x16_bf16 v[80:95], a[124:127], v[176:179], v[80:95]
    ds_read_b64 v[194:195], v198 offset:320
    ds_read_b64 v[160:161], v196 offset:2048
    v_mul_f32 v116, v8, v153
    v_mul_f32 v117, v9, v153
    v_mul_f32_e64 v118, v10, v153
    v_mfma_f32_32x32x16_bf16 v[96:111], a[124:127], v[180:183], v[96:111]
    ds_read_b64 v[162:163], v196 offset:2560
    buffer_load_dwordx4 v[220:223], v56, s[16:19], s96 offen offset:256 sc1
    v_mul_f32 v119, v11, v153
    v_mul_f32_e64 v120, v12, v153
    s_waitcnt lgkmcnt(4)
    v_mfma_f32_16x16x32_bf16 v[112:115], a[128:131], v[184:187], v[112:115]
    ds_read_b64 v[164:165], v198 offset:512
    v_mfma_f32_32x32x16_bf16 v[80:95], a[128:131], v[188:191], v[80:95]
    ds_read_b64 v[166:167], v198 offset:576
    ds_read_b64 v[168:169], v196 offset:4096
    ds_read_b64 v[170:171], v196 offset:4608
    v_mul_f32 v121, v13, v153
    v_mul_f32_e64 v122, v14, v153
    s_waitcnt lgkmcnt(4)
    v_mfma_f32_16x16x32_bf16 v[112:115], a[132:135], v[192:195], v[112:115]
    ds_read_b64 v[172:173], v198 offset:768
    v_mfma_f32_32x32x16_bf16 v[80:95], a[132:135], v[160:163], v[80:95]
    ds_read_b64 v[174:175], v198 offset:832
    ds_read_b64 v[176:177], v196 offset:6144
    ds_read_b64 v[178:179], v196 offset:6656
    s_mov_b32 s96, 12091392
    buffer_load_dwordx4 v[224:227], v56, s[16:19], s96 offen offset:0 sc1
    v_mul_f32 v123, v15, v153
    v_mul_f32_e64 v124, v16, v153
    s_waitcnt lgkmcnt(4)
    v_mfma_f32_16x16x32_bf16 v[112:115], a[136:139], v[164:167], v[112:115]
    ds_read_b64 v[180:181], v198 offset:1024
    v_mfma_f32_32x32x16_bf16 v[80:95], a[136:139], v[168:171], v[80:95]
    ds_read_b64 v[182:183], v198 offset:1088
    ds_read_b64 v[184:185], v196 offset:8192
    ds_read_b64 v[186:187], v196 offset:8704
    v_mul_f32 v125, v17, v153
    v_mul_f32_e64 v126, v18, v153
    s_waitcnt lgkmcnt(4)
    v_mfma_f32_16x16x32_bf16 v[112:115], a[140:143], v[172:175], v[112:115]
    ds_read_b64 v[188:189], v198 offset:1280
    v_mfma_f32_32x32x16_bf16 v[80:95], a[140:143], v[176:179], v[80:95]
    ds_read_b64 v[190:191], v198 offset:1344
    ds_read_b64 v[192:193], v196 offset:10240
    ds_read_b64 v[194:195], v196 offset:10752
    buffer_load_dwordx4 v[228:231], v56, s[16:19], s96 offen offset:256 sc1
    v_mul_f32 v127, v19, v153
    v_mul_f32_e64 v128, v20, v153
    s_waitcnt lgkmcnt(4)
    v_mfma_f32_16x16x32_bf16 v[112:115], a[144:147], v[180:183], v[112:115]
    ds_read_b64 v[160:161], v198 offset:1536
    v_mfma_f32_32x32x16_bf16 v[80:95], a[144:147], v[184:187], v[80:95]
    ds_read_b64 v[162:163], v198 offset:1600
    ds_read_b64 v[164:165], v196 offset:12288
    ds_read_b64 v[166:167], v196 offset:12800
    v_mul_f32 v129, v21, v153
    v_mul_f32_e64 v130, v22, v153
    s_waitcnt lgkmcnt(4)
    v_mfma_f32_16x16x32_bf16 v[112:115], a[148:151], v[188:191], v[112:115]
    ds_read_b64 v[168:169], v198 offset:1792
    v_mfma_f32_32x32x16_bf16 v[80:95], a[148:151], v[192:195], v[80:95]
    ds_read_b64 v[170:171], v198 offset:1856
    ds_read_b64 v[172:173], v196 offset:14336
    ds_read_b64 v[174:175], v196 offset:14848
    s_mov_b32 s96, 12124160
    buffer_load_dwordx4 v[232:235], v56, s[16:19], s96 offen offset:0 sc1
    v_mul_f32 v131, v23, v153
    v_mul_f32_e64 v132, v8, v155
    s_waitcnt lgkmcnt(4)
    v_mfma_f32_16x16x32_bf16 v[112:115], a[152:155], v[160:163], v[112:115]
    ds_read_b64 v[176:177], v196 offset:256
    v_mfma_f32_32x32x16_bf16 v[80:95], a[152:155], v[164:167], v[80:95]
    ds_read_b64 v[178:179], v196 offset:768
    ds_read_b64 v[180:181], v196 offset:2304
    ds_read_b64 v[182:183], v196 offset:2816
    v_mul_f32 v133, v9, v155
    v_mul_f32_e64 v134, v10, v155
    s_waitcnt lgkmcnt(4)
    v_mfma_f32_16x16x32_bf16 v[112:115], a[156:159], v[168:171], v[112:115]
    ds_read_b64 v[184:185], v196 offset:4352
    v_mfma_f32_32x32x16_bf16 v[80:95], a[156:159], v[172:175], v[80:95]
    ds_read_b64 v[186:187], v196 offset:4864
    ds_read_b64 v[188:189], v196 offset:6400
    ds_read_b64 v[190:191], v196 offset:6912
    buffer_load_dwordx4 v[236:239], v56, s[16:19], s96 offen offset:256 sc1
    v_mul_f32 v135, v11, v155
    v_mul_f32 v136, v12, v155
    v_mul_f32 v137, v13, v155
    v_mul_f32 v138, v14, v155
    v_mul_f32 v139, v15, v155
    v_mul_f32 v140, v16, v155
    v_mul_f32 v141, v17, v155
    v_mul_f32 v142, v18, v155
    v_mul_f32 v143, v19, v155
    v_mul_f32 v144, v20, v155
    v_mul_f32 v145, v21, v155
    v_mul_f32 v146, v22, v155
    v_mul_f32 v147, v23, v155
    s_waitcnt lgkmcnt(4)
    v_mfma_f32_32x32x16_bf16 v[96:111], a[128:131], v[176:179], v[96:111]
    ds_read_b64 v[192:193], v196 offset:8448
    ds_read_b64 v[194:195], v196 offset:8960
    v_mfma_f32_32x32x16_bf16 v[96:111], a[132:135], v[180:183], v[96:111]
    ds_read_b64 v[160:161], v196 offset:10496
    ds_read_b64 v[162:163], v196 offset:11008
    s_mov_b32 s96, 12156928
    buffer_load_dwordx4 v[240:243], v56, s[16:19], s96 offen offset:0 sc1
    v_fma_f32 v112, v112, v156, v148
    v_fma_f32 v113, v113, v156, v149
    s_waitcnt lgkmcnt(4)
    v_mfma_f32_32x32x16_bf16 v[96:111], a[136:139], v[184:187], v[96:111]
    ds_read_b64 v[164:165], v196 offset:12544
    ds_read_b64 v[166:167], v196 offset:13056
    v_fma_f32 v114, v114, v156, v150
    v_fma_f32 v115, v115, v156, v151
    v_cvt_pk_bf16_f32 v112, v112, v113
    v_mfma_f32_32x32x16_bf16 v[96:111], a[140:143], v[188:191], v[96:111]
    ds_read_b64 v[168:169], v196 offset:14592
    ds_read_b64 v[170:171], v196 offset:15104
    buffer_load_dwordx4 v[244:247], v56, s[16:19], s96 offen offset:256 sc1
    v_cvt_pk_bf16_f32 v113, v114, v115
    v_fma_f32 v80, v80, v152, v116
    s_waitcnt lgkmcnt(4)
    v_mfma_f32_32x32x16_bf16 v[96:111], a[144:147], v[192:195], v[96:111]
    v_fma_f32 v81, v81, v152, v117
    v_fma_f32 v82, v82, v152, v118
    v_fma_f32 v83, v83, v152, v119
    v_cvt_pk_bf16_f32 v80, v80, v81
    v_cvt_pk_bf16_f32 v81, v82, v83
    v_mfma_f32_32x32x16_bf16 v[96:111], a[148:151], v[160:163], v[96:111]
    ds_write_b64 v40, v[112:113] offset:0
    ds_write_b64 v38, v[80:81] offset:0
    v_fma_f32 v84, v84, v152, v120
    v_fma_f32 v85, v85, v152, v121
    s_waitcnt lgkmcnt(2)
    v_mfma_f32_32x32x16_bf16 v[96:111], a[152:155], v[164:167], v[96:111]
    v_fma_f32 v86, v86, v152, v122
    v_fma_f32 v87, v87, v152, v123
    v_cvt_pk_bf16_f32 v84, v84, v85
    v_cvt_pk_bf16_f32 v85, v86, v87
    v_fma_f32 v88, v88, v152, v124
    v_mfma_f32_32x32x16_bf16 v[96:111], a[156:159], v[168:171], v[96:111]
    s_mov_b32 s96, 12058624
    buffer_load_dwordx2 v[248:249], v57, s[16:19], s96 offen offset:0 sc1
    v_fma_f32 v89, v89, v152, v125
    v_fma_f32 v90, v90, v152, v126
    v_fma_f32 v91, v91, v152, v127
    v_cvt_pk_bf16_f32 v88, v88, v89
    v_cvt_pk_bf16_f32 v89, v90, v91
    ds_write_b64 v38, v[84:85] offset:6400
    ds_write_b64 v38, v[88:89] offset:12800
    v_fma_f32 v92, v92, v152, v128
    v_fma_f32 v93, v93, v152, v129
    v_fma_f32 v94, v94, v152, v130
    v_fma_f32 v95, v95, v152, v131
    v_cvt_pk_bf16_f32 v92, v92, v93
    v_cvt_pk_bf16_f32 v93, v94, v95
    ds_write_b64 v39, v[92:93] offset:0
    v_pk_fma_f32 v[96:97], v[96:97], v[154:155], v[132:133] op_sel_hi:[1,0,1]
    v_pk_fma_f32 v[98:99], v[98:99], v[154:155], v[134:135] op_sel_hi:[1,0,1]
    v_cvt_pk_bf16_f32 v96, v96, v97
    v_cvt_pk_bf16_f32 v97, v98, v99
    v_pk_fma_f32 v[100:101], v[100:101], v[154:155], v[136:137] op_sel_hi:[1,0,1]
    v_pk_fma_f32 v[102:103], v[102:103], v[154:155], v[138:139] op_sel_hi:[1,0,1]
    v_cvt_pk_bf16_f32 v100, v100, v101
    v_cvt_pk_bf16_f32 v101, v102, v103
    ds_write_b64 v38, v[96:97] offset:1600
    ds_write_b64 v38, v[100:101] offset:8000
    v_pk_fma_f32 v[104:105], v[104:105], v[154:155], v[140:141] op_sel_hi:[1,0,1]
    v_pk_fma_f32 v[106:107], v[106:107], v[154:155], v[142:143] op_sel_hi:[1,0,1]
    v_cvt_pk_bf16_f32 v104, v104, v105
    v_cvt_pk_bf16_f32 v105, v106, v107
    v_pk_fma_f32 v[108:109], v[108:109], v[154:155], v[144:145] op_sel_hi:[1,0,1]
    v_pk_fma_f32 v[110:111], v[110:111], v[154:155], v[146:147] op_sel_hi:[1,0,1]
    v_cvt_pk_bf16_f32 v108, v108, v109
    v_cvt_pk_bf16_f32 v109, v110, v111
    ds_write_b64 v38, v[104:105] offset:14400
    ds_write_b64 v39, v[108:109] offset:1600
    v_cmp_u_f32 vcc, v82, v114
    v_cmp_u_f32 s[82:83], v98, v98
    s_lshl_b32 s25, s24, 2
    s_add_u32 s25, s25, 160256
    s_or_b64 vcc, vcc, s[82:83]
    s_cselect_b32 s26, 1, 0
    v_mov_b32 v196, s25
    v_mov_b32 v197, s26
    ds_write_b32 v196, v197
    s_waitcnt lgkmcnt(0)
    s_barrier
    v_mov_b32 v158, 160256
    ds_read_b128 v[128:131], v158
    v_mov_b32 v94, 0
    v_mov_b32 v95, 0
    v_mov_b32 v98, 0
    v_mov_b32_e64 v99, 0
    s_mov_b64 exec, 0xffff
    ds_read_b64 v[94:95], v42 offset:320
    ds_read_b64 v[98:99], v42 offset:640
    s_mov_b64 exec, -1
    s_nop 0
    ds_read_b64 v[92:93], v41 offset:320
    ds_read_b64 v[96:97], v41 offset:640
    ds_read_b64 v[84:85], v41 offset:6720
    ds_read_b64 v[86:87], v42 offset:6720
    ds_read_b64 v[80:81], v41 offset:6400
    ds_read_b64 v[82:83], v42 offset:6400
    ds_read_b64 v[88:89], v41 offset:7040
    ds_read_b64 v[90:91], v42 offset:7040
    ds_read_b64_tr_b16 v[106:107], v44 offset:0
    ds_read_b64_tr_b16 v[100:101], v43 offset:0
    buffer_load_dwordx2 v[252:253], v57, s[16:19], s96 offen offset:128 sc1
    ds_read_b64_tr_b16 v[108:109], v44 offset:320
    ds_read_b64_tr_b16 v[102:103], v43 offset:320
    ds_read_b64_tr_b16 v[110:111], v44 offset:640
    ds_read_b64_tr_b16 v[104:105], v43 offset:640
    s_mov_b32 s82, 0x3ea52b5c
    s_lshl_b32 s25, s98, 4
    s_add_u32 s25, s25, 12058624
    s_lshl_b32 s26, s98, 3
    s_mov_b32 s96, 12075008
    buffer_load_dwordx2 v[250:251], v57, s[16:19], s96 offen offset:0 sc1
    s_add_u32 s26, s26, 12058624
    s_waitcnt lgkmcnt(15)
    v_or3_b32 v128, v128, v129, v130
    v_or_b32 v128, v128, v131
    v_cmp_ne_u32 vcc, 0, v128
    s_nop 0
    s_cbranch_vccnz rd_73
rc_74:
    s_waitcnt lgkmcnt(10)
    v_mfma_f32_16x16x32_bf16 v[116:119], v[84:87], v[92:95], v[28:31]
    v_mfma_f32_16x16x32_bf16 v[120:123], v[84:87], v[96:99], v[32:35]
    s_waitcnt lgkmcnt(8)
    v_mfma_f32_16x16x32_bf16 v[112:115], v[80:83], v[92:95], v[32:35]
    s_waitcnt lgkmcnt(6)
    v_mfma_f32_16x16x32_bf16 v[124:127], v[88:91], v[96:99], v[28:31]
    buffer_load_dwordx2 v[254:255], v57, s[16:19], s96 offen offset:128 sc1
    s_nop 4
    v_max_f32 v112, v112, v116
    v_max_f32 v113, v113, v117
    v_max_f32 v114, v114, v118
    v_max_f32 v115, v115, v119
    v_max3_f32 v156, v112, v113, v114
    v_max_f32 v156, v156, v115
    v_max_f32 v120, v120, v124
    v_max_f32 v121, v121, v125
    s_mov_b32 s96, 9437184
    buffer_load_dwordx4 v[208:211], v59, s[16:19], s96 offen sc1
    v_max_f32 v122, v122, v126
    v_max_f32 v123, v123, v127
    v_max3_f32 v157, v120, v121, v122
    v_max_f32 v157, v157, v123
    s_nop 1
    v_permlane16_swap_b32 v156, v157
    v_max_f32 v156, v156, v157
    v_mov_b32 v157, v156
    s_nop 1
    v_permlane32_swap_b32_e64 v156, v157
    s_add_u32 s97, s36, 9437184
    buffer_load_dword v212, v61, s[16:19], s97 offen sc1
    v_max_f32 v156, v156, v157
    v_mul_f32 v156, s82, v156
    v_mov_b32 v157, v156
    s_nop 1
    v_permlane16_swap_b32_e64 v156, v157
    v_fma_f32 v112, v112, s82, -v156
    v_fma_f32 v113, v113, s82, -v156
    v_fma_f32 v114, v114, s82, -v156
    v_fma_f32 v115, v115, s82, -v156
    v_exp_f32 v112, v112
    v_exp_f32 v113, v113
    v_exp_f32 v114, v114
    v_exp_f32 v115, v115
    v_cvt_pk_bf16_f32 v116, v112, v113
    v_cvt_pk_bf16_f32 v117, v114, v115
    v_bfi_b32 v128, v36, 0, v116
    v_and_b32 v130, v36, v116
    v_bfi_b32 v129, v37, 0, v117
    v_and_b32 v131, v37, v117
    s_waitcnt lgkmcnt(3)
    s_nop 0
    v_mfma_f32_16x16x32_bf16 v[144:147], v[106:109], v[128:131], 0
    s_waitcnt lgkmcnt(2)
    v_mfma_f32_16x16x32_bf16 v[136:139], v[100:103], v[128:131], 0
    v_fma_f32 v120, v120, s82, -v157
    v_fma_f32 v121, v121, s82, -v157
    v_fma_f32 v122, v122, s82, -v157
    v_fma_f32 v123, v123, s82, -v157
    v_exp_f32 v120, v120
    v_exp_f32 v121, v121
    v_exp_f32 v122, v122
    v_exp_f32_e64 v123, v123
    v_cvt_pk_bf16_f32 v124, v120, v121
    v_cvt_pk_bf16_f32 v125, v122, v123
    v_bfi_b32 v132, v36, 0, v124
    v_and_b32 v134, v36, v124
    v_bfi_b32 v133, v37, 0, v125
    v_and_b32 v135, v37, v125
    s_waitcnt lgkmcnt(1)
    s_nop 0
    v_mfma_f32_16x16x32_bf16 v[148:151], v[108:111], v[132:135], 0
    s_waitcnt lgkmcnt(0)
    v_mfma_f32_16x16x32_bf16 v[140:143], v[102:105], v[132:135], 0
    v_mov_b32 v158, v144
    s_nop 1
    v_permlane16_swap_b32 v144, v158
    v_rcp_f32 v158, v158
    s_nop 0
    v_pk_mul_f32 v[136:137], v[136:137], v[158:159] op_sel_hi:[1,0]
    v_pk_mul_f32 v[138:139], v[138:139], v[158:159] op_sel_hi:[1,0]
    v_pk_mul_f32 v[144:145], v[144:145], v[158:159] op_sel_hi:[1,0]
    v_pk_mul_f32 v[146:147], v[146:147], v[158:159] op_sel_hi:[1,0]
    v_cvt_pk_bf16_f32 v112, v136, v137
    v_cvt_pk_bf16_f32 v116, v144, v145
    v_cvt_pk_bf16_f32 v113, v138, v139
    v_cvt_pk_bf16_f32 v117, v146, v147
    v_mov_b32 v160, v148
    s_nop 1
    v_permlane16_swap_b32 v148, v160
    v_rcp_f32_e64 v160, v160
    s_nop 0
    v_pk_mul_f32 v[140:141], v[140:141], v[160:161] op_sel_hi:[1,0]
    v_pk_mul_f32 v[142:143], v[142:143], v[160:161] op_sel_hi:[1,0]
    v_pk_mul_f32 v[148:149], v[148:149], v[160:161] op_sel_hi:[1,0]
    v_pk_mul_f32 v[150:151], v[150:151], v[160:161] op_sel_hi:[1,0]
    v_cvt_pk_bf16_f32 v114, v140, v141
    v_cvt_pk_bf16_f32 v118, v148, v149
    v_cvt_pk_bf16_f32 v115, v142, v143
    v_cvt_pk_bf16_f32 v119, v150, v151
    v_permlane16_swap_b32 v112, v114
    v_permlane16_swap_b32 v113, v115
    v_permlane16_swap_b32 v116, v118
    v_permlane16_swap_b32 v117, v119
    buffer_store_dwordx4 v[112:115], v45, s[16:19], s25 offen sc1
    s_mov_b64 exec, s[80:81]
    buffer_store_dwordx2 v[116:117], v46, s[16:19], s26 offen sc1
    s_mov_b64 exec, -1
oe_75:
    s_waitcnt vmcnt(15)
    v_mfma_f32_16x16x32_bf16 v[112:115], a[176:179], v[216:219], 0
    v_mov_b32 v136, 0
    v_mov_b32 v137, 0
    s_waitcnt vmcnt(14)
    v_mfma_f32_16x16x32_bf16 v[116:119], a[176:179], v[220:223], 0
    v_mov_b32 v138, 0
    v_mov_b32 v139, 0
    s_waitcnt vmcnt(13)
    v_mfma_f32_16x16x32_bf16 v[112:115], a[196:199], v[224:227], v[112:115]
    v_mov_b32 v140, 0
    v_mov_b32 v141, 0
    s_waitcnt vmcnt(12)
    v_mfma_f32_16x16x32_bf16 v[116:119], a[196:199], v[228:231], v[116:119]
    s_mov_b32 s25, 14680064
    s_add_u32 s26, s36, 14680064
    s_waitcnt vmcnt(11)
    v_mfma_f32_16x16x32_bf16 v[112:115], a[216:219], v[232:235], v[112:115]
    s_add_u32 s27, s35, 3506176
    s_mov_b32 s28, 0x99999999
    s_waitcnt vmcnt(10)
    v_mfma_f32_16x16x32_bf16 v[116:119], a[216:219], v[236:239], v[116:119]
    s_mov_b32 s29, 0x99999999
    s_waitcnt vmcnt(9)
    v_mfma_f32_16x16x32_bf16 v[112:115], a[236:239], v[240:243], v[112:115]
    s_waitcnt vmcnt(8)
    v_mfma_f32_16x16x32_bf16 v[116:119], a[236:239], v[244:247], v[116:119]
    s_waitcnt vmcnt(5)
    v_mfma_f32_16x16x32_bf16 v[112:115], v[52:55], v[248:251], v[112:115]
    s_waitcnt vmcnt(4)
    v_mfma_f32_16x16x32_bf16 v[116:119], v[52:55], v[252:255], v[116:119]
    v_mfma_f32_16x16x32_bf16 v[88:91], a[164:167], v[216:219], 0
    v_mfma_f32_16x16x32_bf16 v[92:95], a[164:167], v[220:223], 0
    v_mfma_f32_16x16x32_bf16 v[88:91], a[184:187], v[224:227], v[88:91]
    s_waitcnt vmcnt(3)
    v_max3_u32 v132, v208, v209, v210
    s_waitcnt vmcnt(2)
    v_max3_u32 v132, v132, v211, v212
    v_mfma_f32_16x16x32_bf16 v[92:95], a[184:187], v[228:231], v[92:95]
    v_cmp_eq_u32 s[82:83], -1, v132
    v_mfma_f32_16x16x32_bf16 v[88:91], a[204:207], v[232:235], v[88:91]
    v_mfma_f32_16x16x32_bf16 v[92:95], a[204:207], v[236:239], v[92:95]
    v_cmp_u_f32 vcc, v112, v116
    s_nop 0
    s_or_b64 vcc, vcc, s[82:83]
    s_cbranch_vccnz rd_76
rc_77:
    v_mfma_f32_16x16x32_bf16 v[88:91], a[224:227], v[240:243], v[88:91]
    ds_write_b128 v203, v[112:115] offset:24576
    v_mfma_f32_16x16x32_bf16 v[92:95], a[224:227], v[244:247], v[92:95]
    v_mfma_f32_16x16x32_bf16 v[88:91], a[244:247], v[248:251], v[88:91]
    ds_write_b128 v203, v[116:119] offset:25600
    v_mfma_f32_16x16x32_bf16 v[92:95], a[244:247], v[252:255], v[92:95]
    v_mfma_f32_16x16x32_bf16 v[96:99], a[168:171], v[216:219], 0
    v_lshlrev_b32_e64 v120, 16, v208
    v_and_b32 v121, 0xffff0000, v208
    v_mfma_f32_16x16x32_bf16 v[100:103], a[168:171], v[220:223], 0
    v_lshlrev_b32_e64 v122, 16, v209
    v_and_b32 v123, 0xffff0000, v209
    v_mfma_f32_16x16x32_bf16 v[96:99], a[188:191], v[224:227], v[96:99]
    v_lshlrev_b32_e64 v124, 16, v210
    v_and_b32 v125, 0xffff0000, v210
    v_mfma_f32_16x16x32_bf16 v[100:103], a[188:191], v[228:231], v[100:103]
    v_lshlrev_b32_e64 v126, 16, v211
    v_and_b32 v127, 0xffff0000, v211
    v_mfma_f32_16x16x32_bf16 v[96:99], a[208:211], v[232:235], v[96:99]
    v_lshlrev_b32_e64 v128, 16, v212
    v_and_b32 v129, 0xffff0000, v212
    v_mfma_f32_16x16x32_bf16 v[100:103], a[208:211], v[236:239], v[100:103]
    v_mfma_f32_16x16x32_bf16 v[96:99], a[228:231], v[240:243], v[96:99]
    ds_write_b128 v200, v[88:91] offset:0
    v_mfma_f32_16x16x32_bf16 v[100:103], a[228:231], v[244:247], v[100:103]
    v_mfma_f32_16x16x32_bf16 v[96:99], a[248:251], v[248:251], v[96:99]
    ds_write_b128 v200, v[92:95] offset:1024
    v_mfma_f32_16x16x32_bf16 v[100:103], a[248:251], v[252:255], v[100:103]
    v_mfma_f32_16x16x32_bf16 v[104:107], a[172:175], v[216:219], 0
    v_mfma_f32_16x16x32_bf16 v[108:111], a[172:175], v[220:223], 0
    v_mfma_f32_16x16x32_bf16 v[104:107], a[192:195], v[224:227], v[104:107]
    v_mfma_f32_16x16x32_bf16 v[108:111], a[192:195], v[228:231], v[108:111]
    v_mfma_f32_16x16x32_bf16 v[104:107], a[212:215], v[232:235], v[104:107]
    v_mfma_f32_16x16x32_bf16 v[108:111], a[212:215], v[236:239], v[108:111]
    v_mfma_f32_16x16x32_bf16 v[104:107], a[232:235], v[240:243], v[104:107]
    ds_write_b128 v201, v[96:99] offset:2048
    v_mfma_f32_16x16x32_bf16 v[108:111], a[232:235], v[244:247], v[108:111]
    v_mfma_f32_16x16x32_bf16 v[104:107], a[252:255], v[248:251], v[104:107]
    ds_write_b128 v201, v[100:103] offset:3072
    v_mfma_f32_16x16x32_bf16 v[108:111], a[252:255], v[252:255], v[108:111]
    v_mfma_f32_16x16x32_bf16 v[80:83], a[160:163], v[216:219], v[120:123]
    v_mfma_f32_16x16x32_bf16 v[84:87], a[160:163], v[220:223], v[124:127]
    v_mfma_f32_16x16x32_bf16 v[80:83], a[180:183], v[224:227], v[80:83]
    v_mfma_f32_16x16x32_bf16 v[84:87], a[180:183], v[228:231], v[84:87]
    v_mfma_f32_16x16x32_bf16 v[80:83], a[200:203], v[232:235], v[80:83]
    s_nop 0
    ds_write_b128 v202, v[104:107] offset:4096
    v_mfma_f32_16x16x32_bf16 v[84:87], a[200:203], v[236:239], v[84:87]
    ds_write_b128 v202, v[108:111] offset:5120
    v_mfma_f32_16x16x32_bf16 v[80:83], a[220:223], v[240:243], v[80:83]
    v_mfma_f32_16x16x32_bf16 v[84:87], a[220:223], v[244:247], v[84:87]
    v_mfma_f32_16x16x32_bf16 v[80:83], a[240:243], v[248:251], v[80:83]
    v_mfma_f32_16x16x32_bf16 v[84:87], a[240:243], v[252:255], v[84:87]
    s_waitcnt lgkmcnt(0)
    s_barrier
    s_nop 0
    ds_read_b128 v[88:91], v204 offset:0
    ds_read_b128 v[92:95], v204 offset:1024
    ds_read_b128 v[96:99], v204 offset:2048
    ds_read_b128 v[100:103], v204 offset:3072
    ds_read_b128 v[104:107], v204 offset:4096
    ds_read_b128 v[108:111], v204 offset:5120
    ds_read_b64 v[112:113], v205 offset:24576
    ds_read_b64 v[114:115], v205 offset:26624
    ds_read_b64 v[116:117], v205 offset:28672
    ds_read_b64 v[118:119], v205 offset:30720
    s_mov_b32 s96, 12062720
    buffer_load_dwordx4 v[216:219], v56, s[16:19], s96 offen offset:0 sc1
    buffer_load_dwordx4 v[220:223], v56, s[16:19], s96 offen offset:256 sc1
    s_mov_b32 s96, 12095488
    buffer_load_dwordx4 v[224:227], v56, s[16:19], s96 offen offset:0 sc1
    buffer_load_dwordx4 v[228:231], v56, s[16:19], s96 offen offset:256 sc1
    s_mov_b32 s96, 12128256
    buffer_load_dwordx4 v[232:235], v56, s[16:19], s96 offen offset:0 sc1
    buffer_load_dwordx4 v[236:239], v56, s[16:19], s96 offen offset:256 sc1
    s_waitcnt lgkmcnt(9)
    v_pk_add_f32 v[80:81], v[80:81], v[88:89]
    v_pk_add_f32 v[82:83], v[82:83], v[90:91]
    s_waitcnt lgkmcnt(8)
    v_pk_add_f32 v[84:85], v[84:85], v[92:93]
    v_pk_add_f32 v[86:87], v[86:87], v[94:95]
    s_waitcnt lgkmcnt(7)
    v_pk_add_f32 v[80:81], v[80:81], v[96:97]
    v_pk_add_f32 v[82:83], v[82:83], v[98:99]
    s_waitcnt lgkmcnt(6)
    v_pk_add_f32 v[84:85], v[84:85], v[100:101]
    v_pk_add_f32 v[86:87], v[86:87], v[102:103]
    s_waitcnt lgkmcnt(5)
    v_pk_add_f32 v[80:81], v[80:81], v[104:105]
    v_pk_add_f32 v[82:83], v[82:83], v[106:107]
    s_waitcnt lgkmcnt(4)
    v_pk_add_f32 v[84:85], v[84:85], v[108:109]
    v_pk_add_f32 v[86:87], v[86:87], v[110:111]
    v_cvt_pk_bf16_f32 v132, v80, v81
    v_cvt_pk_bf16_f32 v133, v82, v83
    v_cvt_pk_bf16_f32 v134, v84, v85
    v_cvt_pk_bf16_f32 v135, v86, v87
    s_waitcnt lgkmcnt(3)
    v_pk_add_f32 v[128:129], v[128:129], v[112:113]
    s_waitcnt lgkmcnt(2)
    v_pk_add_f32 v[128:129], v[128:129], v[114:115]
    s_waitcnt lgkmcnt(1)
    v_pk_add_f32 v[128:129], v[128:129], v[116:117]
    s_waitcnt lgkmcnt(0)
    v_pk_add_f32 v[128:129], v[128:129], v[118:119]
    v_cvt_pk_bf16_f32 v130, v128, v129
    buffer_store_dwordx4 v[132:135], v59, s[16:19], s25 offen sc1
    buffer_store_dword v130, v61, s[16:19], s26 offen sc1
    v_dot2c_f32_bf16 v136, v132, v215
    v_dot2c_f32_bf16 v137, v132, v132
    v_dot2c_f32_bf16 v136, v133, v215
    v_dot2c_f32_bf16 v137, v133, v133
    v_dot2c_f32_bf16 v138, v134, v215
    v_dot2c_f32_bf16 v139, v134, v134
    v_dot2c_f32_bf16 v138, v135, v215
    v_dot2c_f32_bf16 v139, v135, v135
    v_dot2c_f32_bf16 v140, v130, v215
    v_dot2c_f32_bf16 v141, v130, v130
    v_permlane32_swap_b32 v136, v138
    v_permlane32_swap_b32 v137, v139
    v_pk_add_f32 v[136:137], v[136:137], v[138:139]
    v_pk_add_f32 v[136:137], v[136:137], v[140:141]
    s_nop 1
    v_permlane16_swap_b32 v136, v137
    v_add_f32_e64 v136, v136, v137
    ds_write_b32 v206, v136 offset:32768
    s_mov_b32 s96, 12161024
    buffer_load_dwordx4 v[240:243], v56, s[16:19], s96 offen offset:0 sc1
    buffer_load_dwordx4 v[244:247], v56, s[16:19], s96 offen offset:256 sc1
    s_mov_b32 s96, 12060672
    buffer_load_dwordx2 v[248:249], v57, s[16:19], s96 offen offset:0 sc1
    buffer_load_dwordx2 v[252:253], v57, s[16:19], s96 offen offset:128 sc1
    s_mov_b32 s96, 12077056
    buffer_load_dwordx2 v[250:251], v57, s[16:19], s96 offen offset:0 sc1
    buffer_load_dwordx2 v[254:255], v57, s[16:19], s96 offen offset:128 sc1
    s_mov_b32 s96, 9439232
    buffer_load_dwordx4 v[208:211], v59, s[16:19], s96 offen sc1
    s_add_u32 s97, s36, 9439232
    buffer_load_dword v212, v61, s[16:19], s97 offen sc1
    s_waitcnt lgkmcnt(0)
    s_barrier
    ds_read2st64_b32 v[136:137], v207 offset0:0 offset1:1
    ds_read2st64_b32 v[138:139], v207 offset0:2 offset1:3
    ds_read_b64_tr_b16 v[144:145], v65 offset:32
    ds_read_b64_tr_b16 v[146:147], v65 offset:0
    ds_read_b64_tr_b16 v[148:149], v65 offset:160
    ds_read_b64_tr_b16 v[150:151], v65 offset:128
    ds_read_b64_tr_b16 v[152:153], v65 offset:288
    ds_read_b64_tr_b16 v[154:155], v65 offset:256
    ds_read_b64_tr_b16 v[156:157], v65 offset:416
    ds_read_b64_tr_b16 v[158:159], v65 offset:384
    ds_read_b64_tr_b16 v[160:161], v65 offset:544
    ds_read_b64_tr_b16 v[162:163], v65 offset:512
    ds_read_b64_tr_b16 v[164:165], v65 offset:672
    ds_read_b64_tr_b16 v[166:167], v65 offset:640
    ds_read_b64_tr_b16 v[168:169], v65 offset:800
    ds_read_b64_tr_b16 v[170:171], v65 offset:768
    ds_read_b64_tr_b16 v[172:173], v65 offset:928
    ds_read_b64_tr_b16 v[174:175], v65 offset:896
    s_waitcnt lgkmcnt(15)
    v_pk_add_f32 v[136:137], v[136:137], v[138:139]
    v_add_f32 v136, v136, v137
    v_cndmask_b32 v136, v136, 1.0, s[28:29]
    s_mov_b64 exec, s[80:81]
    buffer_atomic_add_f32 v136, v214, s[16:19], s27 offen
    s_mov_b64 exec, -1
    v_lshrrev_b32 v176, 4, v0
    v_mul_u32_u24 v176, 1216, v176
    v_and_b32 v177, 15, v0
    v_lshl_add_u32 v176, v177, 3, v176
    v_add_u32 v176, 64, v176
    v_mov_b32 v178, 0
    v_mov_b32 v179, 0
    ds_write_b64 v176, v[178:179]
    v_mov_b32 v70, 0
    v_mov_b32 v71, 0
    v_mov_b32 v72, 0
oe_78:
    s_waitcnt vmcnt(16)
    v_mfma_f32_16x16x32_bf16 v[112:115], a[176:179], v[216:219], 0
    v_mov_b32 v136, 0
    v_mov_b32 v137, 0
    s_waitcnt vmcnt(15)
    v_mfma_f32_16x16x32_bf16 v[116:119], a[176:179], v[220:223], 0
    v_mov_b32 v138, 0
    v_mov_b32 v139, 0
    s_waitcnt vmcnt(14)
    v_mfma_f32_16x16x32_bf16 v[112:115], a[196:199], v[224:227], v[112:115]
    v_mov_b32 v140, 0
    v_mov_b32 v141, 0
    s_waitcnt vmcnt(13)
    v_mfma_f32_16x16x32_bf16 v[116:119], a[196:199], v[228:231], v[116:119]
    s_mov_b32 s25, 14682112
    s_add_u32 s26, s36, 14682112
    s_waitcnt vmcnt(12)
    v_mfma_f32_16x16x32_bf16 v[112:115], a[216:219], v[232:235], v[112:115]
    s_add_u32 s27, s35, 3510272
    s_mov_b32 s28, 0x99999999
    s_waitcnt vmcnt(11)
    v_mfma_f32_16x16x32_bf16 v[116:119], a[216:219], v[236:239], v[116:119]
    s_mov_b32 s29, 0x99999999
    s_waitcnt vmcnt(8)
    v_mfma_f32_16x16x32_bf16 v[112:115], a[236:239], v[240:243], v[112:115]
    s_waitcnt vmcnt(7)
    v_mfma_f32_16x16x32_bf16 v[116:119], a[236:239], v[244:247], v[116:119]
    s_waitcnt vmcnt(4)
    v_mfma_f32_16x16x32_bf16 v[112:115], v[52:55], v[248:251], v[112:115]
    s_waitcnt vmcnt(3)
    v_mfma_f32_16x16x32_bf16 v[116:119], v[52:55], v[252:255], v[116:119]
    v_mfma_f32_16x16x32_bf16 v[88:91], a[164:167], v[216:219], 0
    v_mfma_f32_16x16x32_bf16 v[92:95], a[164:167], v[220:223], 0
    v_mfma_f32_16x16x32_bf16 v[88:91], a[184:187], v[224:227], v[88:91]
    s_waitcnt vmcnt(2)
    v_max3_u32 v132, v208, v209, v210
    s_waitcnt vmcnt(1)
    v_max3_u32 v132, v132, v211, v212
    v_mfma_f32_16x16x32_bf16 v[92:95], a[184:187], v[228:231], v[92:95]
    v_cmp_eq_u32 s[82:83], -1, v132
    v_mfma_f32_16x16x32_bf16 v[88:91], a[204:207], v[232:235], v[88:91]
    v_mfma_f32_16x16x32_bf16 v[92:95], a[204:207], v[236:239], v[92:95]
    v_cmp_u_f32 vcc, v112, v116
    s_nop 0
    s_or_b64 vcc, vcc, s[82:83]
    s_cbranch_vccnz rd_79
rc_80:
    v_mfma_f32_16x16x32_bf16 v[88:91], a[224:227], v[240:243], v[88:91]
    ds_write_b128 v203, v[112:115] offset:24576
    v_mfma_f32_16x16x32_bf16 v[92:95], a[224:227], v[244:247], v[92:95]
    v_mfma_f32_16x16x32_bf16 v[88:91], a[244:247], v[248:251], v[88:91]
    ds_write_b128 v203, v[116:119] offset:25600
    v_mfma_f32_16x16x32_bf16 v[92:95], a[244:247], v[252:255], v[92:95]
    v_mfma_f32_16x16x32_bf16 v[96:99], a[168:171], v[216:219], 0
    v_lshlrev_b32_e64 v120, 16, v208
    v_and_b32 v121, 0xffff0000, v208
    v_mfma_f32_16x16x32_bf16 v[100:103], a[168:171], v[220:223], 0
    v_lshlrev_b32_e64 v122, 16, v209
    v_and_b32 v123, 0xffff0000, v209
    v_mfma_f32_16x16x32_bf16 v[96:99], a[188:191], v[224:227], v[96:99]
    v_lshlrev_b32_e64 v124, 16, v210
    v_and_b32 v125, 0xffff0000, v210
    v_mfma_f32_16x16x32_bf16 v[100:103], a[188:191], v[228:231], v[100:103]
    v_lshlrev_b32_e64 v126, 16, v211
    v_and_b32 v127, 0xffff0000, v211
    v_mfma_f32_16x16x32_bf16 v[96:99], a[208:211], v[232:235], v[96:99]
    v_lshlrev_b32_e64 v128, 16, v212
    v_and_b32 v129, 0xffff0000, v212
    v_mfma_f32_16x16x32_bf16 v[100:103], a[208:211], v[236:239], v[100:103]
    v_mfma_f32_16x16x32_bf16 v[96:99], a[228:231], v[240:243], v[96:99]
    ds_write_b128 v200, v[88:91] offset:0
    v_mfma_f32_16x16x32_bf16 v[100:103], a[228:231], v[244:247], v[100:103]
    v_mfma_f32_16x16x32_bf16 v[96:99], a[248:251], v[248:251], v[96:99]
    ds_write_b128 v200, v[92:95] offset:1024
    v_mfma_f32_16x16x32_bf16 v[100:103], a[248:251], v[252:255], v[100:103]
    v_mfma_f32_16x16x32_bf16 v[104:107], a[172:175], v[216:219], 0
    v_mfma_f32_16x16x32_bf16 v[108:111], a[172:175], v[220:223], 0
    v_mfma_f32_16x16x32_bf16 v[104:107], a[192:195], v[224:227], v[104:107]
    v_mfma_f32_16x16x32_bf16 v[108:111], a[192:195], v[228:231], v[108:111]
    v_mfma_f32_16x16x32_bf16 v[104:107], a[212:215], v[232:235], v[104:107]
    v_mfma_f32_16x16x32_bf16 v[108:111], a[212:215], v[236:239], v[108:111]
    v_mfma_f32_16x16x32_bf16 v[104:107], a[232:235], v[240:243], v[104:107]
    ds_write_b128 v201, v[96:99] offset:2048
    v_mfma_f32_16x16x32_bf16 v[108:111], a[232:235], v[244:247], v[108:111]
    v_mfma_f32_16x16x32_bf16 v[104:107], a[252:255], v[248:251], v[104:107]
    ds_write_b128 v201, v[100:103] offset:3072
    v_mfma_f32_16x16x32_bf16 v[108:111], a[252:255], v[252:255], v[108:111]
    v_mfma_f32_16x16x32_bf16 v[80:83], a[160:163], v[216:219], v[120:123]
    v_mfma_f32_16x16x32_bf16 v[84:87], a[160:163], v[220:223], v[124:127]
    v_mfma_f32_16x16x32_bf16 v[80:83], a[180:183], v[224:227], v[80:83]
    v_mfma_f32_16x16x32_bf16 v[84:87], a[180:183], v[228:231], v[84:87]
    v_mfma_f32_16x16x32_bf16 v[80:83], a[200:203], v[232:235], v[80:83]
    s_nop 0
    ds_write_b128 v202, v[104:107] offset:4096
    v_mfma_f32_16x16x32_bf16 v[84:87], a[200:203], v[236:239], v[84:87]
    ds_write_b128 v202, v[108:111] offset:5120
    v_mfma_f32_16x16x32_bf16 v[80:83], a[220:223], v[240:243], v[80:83]
    v_mfma_f32_16x16x32_bf16 v[84:87], a[220:223], v[244:247], v[84:87]
    v_mfma_f32_16x16x32_bf16 v[80:83], a[240:243], v[248:251], v[80:83]
    v_mfma_f32_16x16x32_bf16 v[84:87], a[240:243], v[252:255], v[84:87]
    s_waitcnt lgkmcnt(0)
    s_barrier
    s_nop 0
    ds_read_b128 v[88:91], v204 offset:0
    ds_read_b128 v[92:95], v204 offset:1024
    ds_read_b128 v[96:99], v204 offset:2048
    ds_read_b128 v[100:103], v204 offset:3072
    ds_read_b128 v[104:107], v204 offset:4096
    ds_read_b128 v[108:111], v204 offset:5120
    ds_read_b64 v[112:113], v205 offset:24576
    ds_read_b64 v[114:115], v205 offset:26624
    ds_read_b64 v[116:117], v205 offset:28672
    ds_read_b64 v[118:119], v205 offset:30720
    s_lshl_b32 s96, s75, 14
    s_add_u32 s96, s96, 14680064
    s_lshl_b32 s97, s24, 12
    s_add_u32 s97, s97, 3506176
    buffer_load_dwordx4 v[176:179], v62, s[16:19], s96 offen offset:0 sc1
    buffer_load_dwordx4 v[180:183], v62, s[16:19], s96 offen offset:1024 sc1
    buffer_load_dwordx4 v[184:187], v62, s[16:19], s97 offen offset:0 sc1
    buffer_load_dwordx4 v[188:191], v62, s[16:19], s97 offen offset:1024 sc1
    buffer_load_dwordx4 v[192:195], v62, s[16:19], s97 offen offset:2048 sc1
    buffer_load_dwordx4 v[196:199], v62, s[16:19], s97 offen offset:3072 sc1
    s_waitcnt lgkmcnt(9)
    v_pk_add_f32 v[80:81], v[80:81], v[88:89]
    v_pk_add_f32 v[82:83], v[82:83], v[90:91]
    s_waitcnt lgkmcnt(8)
    v_pk_add_f32 v[84:85], v[84:85], v[92:93]
    v_pk_add_f32 v[86:87], v[86:87], v[94:95]
    s_waitcnt lgkmcnt(7)
    v_pk_add_f32 v[80:81], v[80:81], v[96:97]
    v_pk_add_f32 v[82:83], v[82:83], v[98:99]
    s_waitcnt lgkmcnt(6)
    v_pk_add_f32 v[84:85], v[84:85], v[100:101]
    v_pk_add_f32 v[86:87], v[86:87], v[102:103]
    s_waitcnt lgkmcnt(5)
    v_pk_add_f32 v[80:81], v[80:81], v[104:105]
    v_pk_add_f32 v[82:83], v[82:83], v[106:107]
    s_waitcnt lgkmcnt(4)
    v_pk_add_f32 v[84:85], v[84:85], v[108:109]
    v_pk_add_f32 v[86:87], v[86:87], v[110:111]
    v_cvt_pk_bf16_f32 v132, v80, v81
    v_cvt_pk_bf16_f32 v133, v82, v83
    v_cvt_pk_bf16_f32 v134, v84, v85
    v_cvt_pk_bf16_f32 v135, v86, v87
    s_waitcnt lgkmcnt(3)
    v_pk_add_f32 v[128:129], v[128:129], v[112:113]
    s_waitcnt lgkmcnt(2)
    v_pk_add_f32 v[128:129], v[128:129], v[114:115]
    s_waitcnt lgkmcnt(1)
    v_pk_add_f32 v[128:129], v[128:129], v[116:117]
    s_waitcnt lgkmcnt(0)
    v_pk_add_f32 v[128:129], v[128:129], v[118:119]
    v_cvt_pk_bf16_f32 v130, v128, v129
    buffer_store_dwordx4 v[132:135], v59, s[16:19], s25 offen sc1
    buffer_store_dword v130, v61, s[16:19], s26 offen sc1
    v_dot2c_f32_bf16 v136, v132, v215
    v_dot2c_f32_bf16 v137, v132, v132
    v_dot2c_f32_bf16 v136, v133, v215
    v_dot2c_f32_bf16 v137, v133, v133
    v_dot2c_f32_bf16 v138, v134, v215
    v_dot2c_f32_bf16 v139, v134, v134
    v_dot2c_f32_bf16 v138, v135, v215
    v_dot2c_f32_bf16 v139, v135, v135
    v_dot2c_f32_bf16 v140, v130, v215
    v_dot2c_f32_bf16 v141, v130, v130
    v_permlane32_swap_b32 v136, v138
    v_permlane32_swap_b32 v137, v139
    v_pk_add_f32 v[136:137], v[136:137], v[138:139]
    v_pk_add_f32 v[136:137], v[136:137], v[140:141]
    s_nop 1
    v_permlane16_swap_b32 v136, v137
    v_add_f32 v136, v136, v137
    ds_write_b32 v206, v136 offset:32768
    s_waitcnt lgkmcnt(0)
    s_barrier
    ds_read2st64_b32 v[136:137], v207 offset0:0 offset1:1
    ds_read2st64_b32 v[138:139], v207 offset0:2 offset1:3
    s_waitcnt lgkmcnt(0)
    v_pk_add_f32 v[136:137], v[136:137], v[138:139]
    v_add_f32 v136, v136, v137
    v_cndmask_b32 v136, v136, 1.0, s[28:29]
    s_mov_b64 exec, s[80:81]
    buffer_atomic_add_f32 v136, v214, s[16:19], s27 offen
    s_mov_b64 exec, -1
    s_cmp_ge_u32 s2, 160
    s_cbranch_scc1 nc_81
    s_waitcnt vmcnt(3)
ce_83:
    v_max3_u32 v208, v176, v177, v178
    v_max3_u32 v208, v208, v179, v180
    v_max3_u32 v208, v208, v181, v182
    v_max_u32 v208, v208, v183
    v_cmp_eq_u32 s[82:83], -1, v208
    v_min3_f32 v209, v184, v187, v188
    v_min3_f32 v209, v209, v191, v192
    v_min3_f32 v209, v209, v195, v196
    v_min_f32 v209, v209, v199
    v_cmp_neq_f32 vcc, 0x41000000, v209
    s_nop 0
    s_or_b64 vcc, vcc, s[82:83]
    s_cbranch_vccnz rd_84
rc_85:
    v_mul_f32 v208, 0x3acccccd, v185
    v_mul_f32 v209, 0x3acccccd, v189
    v_mul_f32 v186, 0x3acccccd, v186
    v_mul_f32 v190, 0x3acccccd, v190
    v_fma_f32 v186, -v208, v208, v186
    v_fma_f32 v190, -v209, v209, v190
    v_max_f32 v186, 0, v186
    v_max_f32 v190, 0, v190
    v_add_f32 v186, 0x3727c5ac, v186
    v_add_f32 v190, 0x3727c5ac, v190
    v_rsq_f32 v185, v186
    v_rsq_f32 v189, v190
    v_mul_f32 v186, -v208, v185
    v_mul_f32 v190, -v209, v189
    v_lshlrev_b32 v80, 16, v176
    v_and_b32 v82, 0xffff0000, v176
    v_lshlrev_b32 v84, 16, v177
    v_and_b32 v86, 0xffff0000, v177
    v_lshlrev_b32 v81, 16, v178
    v_and_b32 v83, 0xffff0000, v178
    v_lshlrev_b32 v85, 16, v179
    v_and_b32 v87, 0xffff0000, v179
    v_fma_f32 v208, v80, v185, v186
    v_fma_f32 v209, v81, v189, v190
    v_cvt_pk_bf16_f32 v176, v208, v209
    v_fma_f32 v208, v82, v185, v186
    v_fma_f32 v209, v83, v189, v190
    v_cvt_pk_bf16_f32 v177, v208, v209
    v_fma_f32 v208, v84, v185, v186
    v_fma_f32 v209, v85, v189, v190
    v_cvt_pk_bf16_f32 v178, v208, v209
    v_fma_f32 v208, v86, v185, v186
    v_fma_f32 v209, v87, v189, v190
    v_cvt_pk_bf16_f32 v179, v208, v209
    ds_write_b32 v63, v176 offset:0
    ds_write_b32 v63, v177 offset:4864
    ds_write_b32 v63, v178 offset:9728
    ds_write_b32 v63, v179 offset:14592
    v_mul_f32 v208, 0x3acccccd, v193
    v_mul_f32 v209, 0x3acccccd, v197
    v_mul_f32 v194, 0x3acccccd, v194
    v_mul_f32 v198, 0x3acccccd, v198
    v_fma_f32 v194, -v208, v208, v194
    v_fma_f32 v198, -v209, v209, v198
    v_max_f32 v194, 0, v194
    v_max_f32 v198, 0, v198
    v_add_f32 v194, 0x3727c5ac, v194
    v_add_f32 v198, 0x3727c5ac, v198
    v_rsq_f32 v193, v194
    v_rsq_f32 v197, v198
    v_mul_f32 v194, -v208, v193
    v_mul_f32 v198, -v209, v197
    v_lshlrev_b32 v88, 16, v180
    v_and_b32 v90, 0xffff0000, v180
    v_lshlrev_b32 v92, 16, v181
    v_and_b32 v94, 0xffff0000, v181
    v_lshlrev_b32 v89, 16, v182
    v_and_b32 v91, 0xffff0000, v182
    v_lshlrev_b32 v93, 16, v183
    v_and_b32 v95, 0xffff0000, v183
    v_fma_f32 v208, v88, v193, v194
    v_fma_f32 v209, v89, v197, v198
    v_cvt_pk_bf16_f32 v180, v208, v209
    v_fma_f32 v208, v90, v193, v194
    v_fma_f32 v209, v91, v197, v198
    v_cvt_pk_bf16_f32 v181, v208, v209
    v_fma_f32 v208, v92, v193, v194
    v_fma_f32 v209, v93, v197, v198
    v_cvt_pk_bf16_f32 v182, v208, v209
    v_fma_f32 v208, v94, v193, v194
    v_fma_f32 v209, v95, v197, v198
    v_cvt_pk_bf16_f32 v183, v208, v209
    ds_write_b32 v63, v180 offset:256
    ds_write_b32 v63, v181 offset:5120
    ds_write_b32 v63, v182 offset:9984
    ds_write_b32 v63, v183 offset:14848
    s_waitcnt lgkmcnt(0)
    s_barrier
    ds_read_b128 v[212:215], v64 offset:96
    ds_read_b128 v[216:219], v64 offset:64
    ds_read_b128 v[220:223], v64 offset:32
    ds_read_b128 v[224:227], v64 offset:0
    s_waitcnt lgkmcnt(3)
    v_mfma_f32_32x32x16_bf16 v[96:111], v[212:215], v[144:147], 0
    ds_read_b128 v[228:231], v64 offset:224
    ds_read_b64_tr_b16 v[176:177], v65 offset:1056
    ds_read_b64_tr_b16 v[178:179], v65 offset:1024
    ds_read_b64_tr_b16 v[180:181], v65 offset:1184
    ds_read_b64_tr_b16 v[182:183], v65 offset:1152
    s_waitcnt lgkmcnt(7)
    v_mfma_f32_32x32x16_bf16 v[96:111], v[216:219], v[148:151], v[96:111]
    ds_read_b128 v[232:235], v64 offset:192
    ds_read_b64_tr_b16 v[184:185], v65 offset:1312
    ds_read_b64_tr_b16 v[186:187], v65 offset:1280
    ds_read_b64_tr_b16 v[188:189], v65 offset:1440
    ds_read_b64_tr_b16 v[190:191], v65 offset:1408
    s_waitcnt lgkmcnt(11)
    v_mfma_f32_32x32x16_bf16 v[96:111], v[220:223], v[152:155], v[96:111]
    ds_read_b128 v[236:239], v64 offset:160
    ds_read_b64_tr_b16 v[192:193], v65 offset:1568
    ds_read_b64_tr_b16 v[194:195], v65 offset:1536
    ds_read_b64_tr_b16 v[196:197], v65 offset:1696
    ds_read_b64_tr_b16 v[198:199], v65 offset:1664
    s_waitcnt lgkmcnt(15)
    v_mfma_f32_32x32x16_bf16 v[96:111], v[224:227], v[156:159], v[96:111]
    ds_read_b128 v[240:243], v64 offset:128
    ds_read_b64_tr_b16 v[200:201], v65 offset:1824
    ds_read_b64_tr_b16 v[202:203], v65 offset:1792
    ds_read_b64_tr_b16 v[204:205], v65 offset:1952
    ds_read_b64_tr_b16 v[206:207], v65 offset:1920
    s_waitcnt lgkmcnt(15)
    v_mfma_f32_32x32x16_bf16 v[112:127], v[228:231], v[144:147], 0
    s_nop 4
    s_waitcnt lgkmcnt(14)
    v_mfma_f32_32x32x16_bf16 v[112:127], v[232:235], v[148:151], v[112:127]
    v_cndmask_b32 v208, v99, v72, s[76:77]
    v_cndmask_b32 v209, v103, v99, s[76:77]
    v_cndmask_b32 v210, v107, v103, s[76:77]
    v_cndmask_b32 v211, v111, v107, s[76:77]
    v_mov_b32_e64 v72, v111
    s_waitcnt lgkmcnt(9)
    v_mfma_f32_32x32x16_bf16 v[112:127], v[236:239], v[152:155], v[112:127]
    v_add_f32_dpp v98, v208, v98 wave_ror:1 row_mask:0xf bank_mask:0xf
    v_add_f32_dpp v102, v209, v102 wave_ror:1 row_mask:0xf bank_mask:0xf
    v_add_f32_dpp v106, v210, v106 wave_ror:1 row_mask:0xf bank_mask:0xf
    v_add_f32_dpp v110, v211, v110 wave_ror:1 row_mask:0xf bank_mask:0xf
    v_cndmask_b32 v208, v98, v71, s[76:77]
    s_waitcnt lgkmcnt(4)
    v_mfma_f32_32x32x16_bf16 v[112:127], v[240:243], v[156:159], v[112:127]
    v_cndmask_b32 v209, v102, v98, s[76:77]
    v_cndmask_b32 v210, v106, v102, s[76:77]
    v_cndmask_b32 v211, v110, v106, s[76:77]
    v_mov_b32 v71, v110
    v_add_f32_dpp v97, v208, v97 wave_ror:1 row_mask:0xf bank_mask:0xf
    v_add_f32_dpp v101, v209, v101 wave_ror:1 row_mask:0xf bank_mask:0xf
    v_mfma_f32_32x32x16_bf16 v[112:127], v[212:215], v[160:163], v[112:127]
    ds_read_b128 v[244:247], v64 offset:352
    v_add_f32_dpp v105, v210, v105 wave_ror:1 row_mask:0xf bank_mask:0xf
    v_add_f32_dpp v109, v211, v109 wave_ror:1 row_mask:0xf bank_mask:0xf
    v_cndmask_b32 v208, v97, v70, s[76:77]
    v_cndmask_b32 v209, v101, v97, s[76:77]
    v_cndmask_b32 v210, v105, v101, s[76:77]
    v_mfma_f32_32x32x16_bf16 v[112:127], v[216:219], v[164:167], v[112:127]
    ds_read_b128 v[216:219], v64 offset:320
    v_cndmask_b32 v211, v109, v105, s[76:77]
    v_mov_b32_e64 v70, v109
    v_add_f32_dpp v96, v208, v96 wave_ror:1 row_mask:0xf bank_mask:0xf
    v_add_f32_dpp v100, v209, v100 wave_ror:1 row_mask:0xf bank_mask:0xf
    v_add_f32_dpp v104, v210, v104 wave_ror:1 row_mask:0xf bank_mask:0xf
    v_mfma_f32_32x32x16_bf16 v[112:127], v[220:223], v[168:171], v[112:127]
    ds_read_b128 v[220:223], v64 offset:288
    v_add_f32_dpp v108, v211, v108 wave_ror:1 row_mask:0xf bank_mask:0xf
    ds_write_b32 v66, v96 offset:0
    v_mfma_f32_32x32x16_bf16 v[112:127], v[224:227], v[172:175], v[112:127]
    ds_read_b128 v[224:227], v64 offset:256
    ds_write_b32 v66, v100 offset:64
    ds_write_b32 v66, v104 offset:128
    s_waitcnt lgkmcnt(6)
    v_mfma_f32_32x32x16_bf16 v[128:143], v[244:247], v[144:147], 0
    ds_write_b32 v66, v108 offset:192
    s_nop 2
    s_waitcnt lgkmcnt(6)
    v_mfma_f32_32x32x16_bf16 v[128:143], v[216:219], v[148:151], v[128:143]
    s_nop 2
    v_cndmask_b32 v208, v115, v72, s[76:77]
    v_cndmask_b32 v209, v119, v115, s[76:77]
    s_waitcnt lgkmcnt(5)
    v_mfma_f32_32x32x16_bf16 v[128:143], v[220:223], v[152:155], v[128:143]
    v_cndmask_b32 v210, v123, v119, s[76:77]
    v_cndmask_b32 v211, v127, v123, s[76:77]
    v_mov_b32 v72, v127
    v_add_f32_dpp v114, v208, v114 wave_ror:1 row_mask:0xf bank_mask:0xf
    v_add_f32_dpp v118, v209, v118 wave_ror:1 row_mask:0xf bank_mask:0xf
    s_waitcnt lgkmcnt(3)
    v_mfma_f32_32x32x16_bf16 v[128:143], v[224:227], v[156:159], v[128:143]
    v_add_f32_dpp v122, v210, v122 wave_ror:1 row_mask:0xf bank_mask:0xf
    v_add_f32_dpp v126, v211, v126 wave_ror:1 row_mask:0xf bank_mask:0xf
    v_cndmask_b32 v208, v114, v71, s[76:77]
    v_cndmask_b32 v209, v118, v114, s[76:77]
    v_cndmask_b32 v210, v122, v118, s[76:77]
    v_cndmask_b32 v211, v126, v122, s[76:77]
    v_mfma_f32_32x32x16_bf16 v[128:143], v[228:231], v[160:163], v[128:143]
    v_mov_b32 v71, v126
    v_add_f32_dpp v113, v208, v113 wave_ror:1 row_mask:0xf bank_mask:0xf
    v_add_f32_dpp v117, v209, v117 wave_ror:1 row_mask:0xf bank_mask:0xf
    v_add_f32_dpp v121, v210, v121 wave_ror:1 row_mask:0xf bank_mask:0xf
    v_add_f32_dpp v125, v211, v125 wave_ror:1 row_mask:0xf bank_mask:0xf
    v_cndmask_b32 v208, v113, v70, s[76:77]
    v_mfma_f32_32x32x16_bf16 v[128:143], v[232:235], v[164:167], v[128:143]
    ds_read_b128 v[232:235], v64 offset:64
    v_cndmask_b32 v209, v117, v113, s[76:77]
    v_cndmask_b32 v210, v121, v117, s[76:77]
    v_cndmask_b32 v211, v125, v121, s[76:77]
    v_mov_b32_e64 v70, v125
    v_add_f32_dpp v112, v208, v112 wave_ror:1 row_mask:0xf bank_mask:0xf
    v_mfma_f32_32x32x16_bf16 v[128:143], v[236:239], v[168:171], v[128:143]
    ds_read_b128 v[236:239], v64 offset:32
    v_add_f32_dpp v116, v209, v116 wave_ror:1 row_mask:0xf bank_mask:0xf
    v_add_f32_dpp v120, v210, v120 wave_ror:1 row_mask:0xf bank_mask:0xf
    v_add_f32_dpp v124, v211, v124 wave_ror:1 row_mask:0xf bank_mask:0xf
    v_mfma_f32_32x32x16_bf16 v[128:143], v[240:243], v[172:175], v[128:143]
    ds_read_b128 v[240:243], v64 offset:0
    ds_write_b32 v66, v112 offset:256
    ds_write_b32 v66, v116 offset:320
    v_mfma_f32_32x32x16_bf16 v[128:143], v[212:215], v[176:179], v[128:143]
    ds_read_b128 v[212:215], v64 offset:480
    ds_write_b32 v66, v120 offset:384
    ds_write_b32 v66, v124 offset:448
    s_waitcnt lgkmcnt(7)
    v_mfma_f32_32x32x16_bf16 v[128:143], v[232:235], v[180:183], v[128:143]
    ds_read_b128 v[232:235], v64 offset:448
    s_waitcnt lgkmcnt(7)
    v_mfma_f32_32x32x16_bf16 v[128:143], v[236:239], v[184:187], v[128:143]
    ds_read_b128 v[236:239], v64 offset:416
    s_waitcnt lgkmcnt(7)
    v_mfma_f32_32x32x16_bf16 v[128:143], v[240:243], v[188:191], v[128:143]
    ds_read_b128 v[240:243], v64 offset:384
    s_nop 3
    s_waitcnt lgkmcnt(5)
    v_mfma_f32_32x32x16_bf16 v[112:127], v[212:215], v[144:147], 0
    s_nop 4
    s_waitcnt lgkmcnt(2)
    v_mfma_f32_32x32x16_bf16 v[112:127], v[232:235], v[148:151], v[112:127]
    v_cndmask_b32 v208, v131, v72, s[76:77]
    v_cndmask_b32 v209, v135, v131, s[76:77]
    v_cndmask_b32 v210, v139, v135, s[76:77]
    v_cndmask_b32 v211, v143, v139, s[76:77]
    v_mov_b32_e64 v72, v143
    s_waitcnt lgkmcnt(1)
    v_mfma_f32_32x32x16_bf16 v[112:127], v[236:239], v[152:155], v[112:127]
    v_add_f32_dpp v130, v208, v130 wave_ror:1 row_mask:0xf bank_mask:0xf
    v_add_f32_dpp v134, v209, v134 wave_ror:1 row_mask:0xf bank_mask:0xf
    v_add_f32_dpp v138, v210, v138 wave_ror:1 row_mask:0xf bank_mask:0xf
    v_add_f32_dpp v142, v211, v142 wave_ror:1 row_mask:0xf bank_mask:0xf
    v_cndmask_b32 v208, v130, v71, s[76:77]
    s_waitcnt lgkmcnt(0)
    v_mfma_f32_32x32x16_bf16 v[112:127], v[240:243], v[156:159], v[112:127]
    v_cndmask_b32 v209, v134, v130, s[76:77]
    v_cndmask_b32 v210, v138, v134, s[76:77]
    v_cndmask_b32 v211, v142, v138, s[76:77]
    v_mov_b32 v71, v142
    v_add_f32_dpp v129, v208, v129 wave_ror:1 row_mask:0xf bank_mask:0xf
    v_add_f32_dpp v133, v209, v133 wave_ror:1 row_mask:0xf bank_mask:0xf
    v_mfma_f32_32x32x16_bf16 v[112:127], v[244:247], v[160:163], v[112:127]
    v_add_f32_dpp v137, v210, v137 wave_ror:1 row_mask:0xf bank_mask:0xf
    v_add_f32_dpp v141, v211, v141 wave_ror:1 row_mask:0xf bank_mask:0xf
    v_cndmask_b32 v208, v129, v70, s[76:77]
    v_cndmask_b32 v209, v133, v129, s[76:77]
    v_cndmask_b32 v210, v137, v133, s[76:77]
    v_cndmask_b32 v211, v141, v137, s[76:77]
    v_mfma_f32_32x32x16_bf16 v[112:127], v[216:219], v[164:167], v[112:127]
    ds_read_b128 v[240:243], v64 offset:192
    v_mov_b32_e64 v70, v141
    v_add_f32_dpp v128, v208, v128 wave_ror:1 row_mask:0xf bank_mask:0xf
    v_add_f32_dpp v132, v209, v132 wave_ror:1 row_mask:0xf bank_mask:0xf
    v_add_f32_dpp v136, v210, v136 wave_ror:1 row_mask:0xf bank_mask:0xf
    v_add_f32_dpp v140, v211, v140 wave_ror:1 row_mask:0xf bank_mask:0xf
    v_mfma_f32_32x32x16_bf16 v[112:127], v[220:223], v[168:171], v[112:127]
    ds_read_b128 v[220:223], v64 offset:160
    ds_write_b32 v66, v128 offset:512
    ds_write_b32 v66, v132 offset:576
    v_mfma_f32_32x32x16_bf16 v[112:127], v[224:227], v[172:175], v[112:127]
    ds_read_b128 v[224:227], v64 offset:128
    ds_write_b32 v66, v136 offset:640
    ds_write_b32 v66, v140 offset:704
    v_mfma_f32_32x32x16_bf16 v[112:127], v[228:231], v[176:179], v[112:127]
    ds_read_b128 v[236:239], v64 offset:96
    s_waitcnt lgkmcnt(7)
    v_mfma_f32_32x32x16_bf16 v[112:127], v[240:243], v[180:183], v[112:127]
    ds_read_b128 v[240:243], v64 offset:64
    s_waitcnt lgkmcnt(7)
    v_mfma_f32_32x32x16_bf16 v[112:127], v[220:223], v[184:187], v[112:127]
    ds_read_b128 v[220:223], v64 offset:32
    s_waitcnt lgkmcnt(5)
    v_mfma_f32_32x32x16_bf16 v[112:127], v[224:227], v[188:191], v[112:127]
    ds_read_b128 v[224:227], v64 offset:0
    s_waitcnt lgkmcnt(3)
    v_mfma_f32_32x32x16_bf16 v[112:127], v[236:239], v[192:195], v[112:127]
    ds_read_b64_tr_b16 v[216:217], v65 offset:544
    ds_read_b64_tr_b16 v[218:219], v65 offset:512
    s_waitcnt lgkmcnt(4)
    v_mfma_f32_32x32x16_bf16 v[112:127], v[240:243], v[196:199], v[112:127]
    ds_read_b64_tr_b16 v[240:241], v65 offset:1056
    ds_read_b64_tr_b16 v[242:243], v65 offset:1024
    s_waitcnt lgkmcnt(5)
    v_mfma_f32_32x32x16_bf16 v[112:127], v[220:223], v[200:203], v[112:127]
    s_waitcnt lgkmcnt(4)
    v_mfma_f32_32x32x16_bf16 v[112:127], v[224:227], v[204:207], v[112:127]
    ds_read_b64_tr_b16 v[224:225], v65 offset:1568
    ds_read_b64_tr_b16 v[226:227], v65 offset:1536
    s_lshl_b32 s96, s75, 14
    s_add_u32 s96, s96, 14680064
    s_lshl_b32 s97, s24, 12
    s_add_u32 s97, s97, 3510272
    buffer_load_dwordx4 v[248:251], v62, s[16:19], s96 offen offset:2048 sc1
    s_waitcnt lgkmcnt(4)
    v_mfma_f32_32x32x16_bf16 v[144:159], v[212:215], v[216:219], 0
    s_nop 3
    v_cndmask_b32 v208, v115, v72, s[76:77]
    s_waitcnt lgkmcnt(2)
    v_mfma_f32_32x32x16_bf16 v[144:159], v[244:247], v[240:243], v[144:159]
    buffer_load_dwordx4 v[252:255], v62, s[16:19], s96 offen offset:3072 sc1
    v_cndmask_b32 v209, v119, v115, s[76:77]
    v_cndmask_b32 v210, v123, v119, s[76:77]
    v_cndmask_b32 v211, v127, v123, s[76:77]
    v_mov_b32_e64 v72, v127
    v_add_f32_dpp v114, v208, v114 wave_ror:1 row_mask:0xf bank_mask:0xf
    v_mfma_f32_32x32x16_bf16 v[160:175], v[212:215], v[240:243], 0
    ds_read_b64_tr_b16 v[216:217], v65 offset:2080
    ds_read_b64_tr_b16 v[218:219], v65 offset:2048
    v_add_f32_dpp v118, v209, v118 wave_ror:1 row_mask:0xf bank_mask:0xf
    v_add_f32_dpp v122, v210, v122 wave_ror:1 row_mask:0xf bank_mask:0xf
    v_add_f32_dpp v126, v211, v126 wave_ror:1 row_mask:0xf bank_mask:0xf
    s_waitcnt lgkmcnt(2)
    v_mfma_f32_32x32x16_bf16 v[144:159], v[228:231], v[224:227], v[144:159]
    buffer_load_dwordx4 v[96:99], v62, s[16:19], s97 offen offset:0 sc1
    v_cndmask_b32 v208, v114, v71, s[76:77]
    v_cndmask_b32 v209, v118, v114, s[76:77]
    v_cndmask_b32 v210, v122, v118, s[76:77]
    v_cndmask_b32 v211, v126, v122, s[76:77]
    v_mov_b32 v71, v126
    v_mfma_f32_32x32x16_bf16 v[160:175], v[244:247], v[224:227], v[160:175]
    v_add_f32_dpp v113, v208, v113 wave_ror:1 row_mask:0xf bank_mask:0xf
    v_add_f32_dpp v117, v209, v117 wave_ror:1 row_mask:0xf bank_mask:0xf
    v_add_f32_dpp v121, v210, v121 wave_ror:1 row_mask:0xf bank_mask:0xf
    v_add_f32_dpp v125, v211, v125 wave_ror:1 row_mask:0xf bank_mask:0xf
    v_cndmask_b32 v208, v113, v70, s[76:77]
    v_cndmask_b32 v209, v117, v113, s[76:77]
    v_mfma_f32_32x32x16_bf16 v[176:191], v[212:215], v[224:227], 0
    buffer_load_dwordx4 v[100:103], v62, s[16:19], s97 offen offset:1024 sc1
    v_cndmask_b32 v210, v121, v117, s[76:77]
    v_cndmask_b32 v211, v125, v121, s[76:77]
    v_mov_b32 v70, v125
    v_add_f32_dpp v112, v208, v112 wave_ror:1 row_mask:0xf bank_mask:0xf
    s_waitcnt lgkmcnt(0)
    v_mfma_f32_32x32x16_bf16 v[144:159], v[236:239], v[216:219], v[144:159]
    ds_read_b64_tr_b16 v[240:241], v65 offset:2592
    ds_read_b64_tr_b16 v[242:243], v65 offset:2560
    v_add_f32_dpp v116, v209, v116 wave_ror:1 row_mask:0xf bank_mask:0xf
    v_add_f32_dpp v120, v210, v120 wave_ror:1 row_mask:0xf bank_mask:0xf
    v_add_f32_dpp v124, v211, v124 wave_ror:1 row_mask:0xf bank_mask:0xf
    v_mfma_f32_32x32x16_bf16 v[160:175], v[228:231], v[216:219], v[160:175]
    buffer_load_dwordx4 v[104:107], v62, s[16:19], s97 offen offset:2048 sc1
    ds_write_b32 v66, v112 offset:768
    ds_write_b32 v66, v116 offset:832
    v_mfma_f32_32x32x16_bf16 v[176:191], v[244:247], v[216:219], v[176:191]
    ds_write_b32 v66, v120 offset:896
    ds_write_b32 v66, v124 offset:960
    v_mfma_f32_32x32x16_bf16 v[192:207], v[212:215], v[216:219], 0
    ds_read_b64_tr_b16 v[212:213], v65 offset:3104
    ds_read_b64_tr_b16 v[214:215], v65 offset:3072
    buffer_load_dwordx4 v[108:111], v62, s[16:19], s97 offen offset:3072 sc1
    s_waitcnt lgkmcnt(6)
    v_mfma_f32_32x32x16_bf16 v[160:175], v[236:239], v[240:243], v[160:175]
    v_mfma_f32_32x32x16_bf16 v[176:191], v[228:231], v[240:243], v[176:191]
    ds_read_b64_tr_b16 v[224:225], v65 offset:3616
    ds_read_b64_tr_b16 v[226:227], v65 offset:3584
    s_waitcnt lgkmcnt(4)
    s_barrier
    v_mfma_f32_32x32x16_bf16 v[192:207], v[244:247], v[240:243], v[192:207]
    ds_read_b64_tr_b16 v[244:245], v65 offset:672
    ds_read_b64_tr_b16 v[246:247], v65 offset:640
    ds_read_b64 v[112:113], v67 offset:0
    ds_read_b64 v[114:115], v67 offset:4224
    ds_read_b64 v[116:117], v67 offset:8448
    s_waitcnt lgkmcnt(7)
    v_mfma_f32_32x32x16_bf16 v[176:191], v[236:239], v[212:215], v[176:191]
    ds_read_b128 v[216:219], v64 offset:320
    ds_read_b64_tr_b16 v[240:241], v65 offset:1184
    ds_read_b64_tr_b16 v[242:243], v65 offset:1152
    ds_read_b64 v[118:119], v67 offset:12672
    ds_read_b64 v[120:121], v67 offset:512
    ds_read_b64 v[122:123], v67 offset:4736
    v_mfma_f32_32x32x16_bf16 v[192:207], v[228:231], v[212:215], v[192:207]
    ds_read_b64 v[124:125], v67 offset:8960
    ds_read_b64 v[126:127], v67 offset:13184
    s_waitcnt lgkmcnt(13)
    v_mfma_f32_32x32x16_bf16 v[192:207], v[236:239], v[224:227], v[192:207]
    ds_read_b128 v[228:231], v64 offset:192
    ds_read_b64_tr_b16 v[236:237], v65 offset:1696
    ds_read_b64_tr_b16 v[238:239], v65 offset:1664
    s_waitcnt lgkmcnt(14)
    v_mfma_f32_32x32x16_bf16 v[144:159], v[232:235], v[244:247], v[144:159]
    s_waitcnt lgkmcnt(8)
    v_mfma_f32_32x32x16_bf16 v[144:159], v[216:219], v[240:243], v[144:159]
    v_mfma_f32_32x32x16_bf16 v[160:175], v[232:235], v[240:243], v[160:175]
    ds_read_b128 v[212:215], v64 offset:64
    ds_read_b64_tr_b16 v[224:225], v65 offset:2208
    ds_read_b64_tr_b16 v[226:227], v65 offset:2176
    s_waitcnt lgkmcnt(6)
    v_add_f32 v112, v112, v80
    s_waitcnt lgkmcnt(3)
    v_mfma_f32_32x32x16_bf16 v[144:159], v[228:231], v[236:239], v[144:159]
    v_add_f32 v113, v113, v81
    v_add_f32 v114, v114, v82
    v_add_f32 v115, v115, v83
    v_add_f32 v116, v116, v84
    v_add_f32 v117, v117, v85
    v_add_f32 v118, v118, v86
    v_mfma_f32_32x32x16_bf16 v[160:175], v[216:219], v[236:239], v[160:175]
    v_add_f32_e64 v119, v119, v87
    v_cvt_pk_bf16_f32 v128, v112, v114
    v_cvt_pk_bf16_f32 v129, v116, v118
    v_cvt_pk_bf16_f32 v130, v113, v115
    v_cvt_pk_bf16_f32 v131, v117, v119
    s_mov_b32 s25, 0
    v_mfma_f32_32x32x16_bf16 v[176:191], v[232:235], v[236:239], v[176:191]
    buffer_store_dwordx2 v[128:129], v68, s[20:23], s25 offen
    s_mov_b32 s25, 5120
    buffer_store_dwordx2 v[130:131], v68, s[20:23], s25 offen
    v_add_f32 v120, v120, v88
    v_add_f32 v121, v121, v89
    s_waitcnt lgkmcnt(0)
    v_mfma_f32_32x32x16_bf16 v[144:159], v[212:215], v[224:227], v[144:159]
    ds_read_b64_tr_b16 v[244:245], v65 offset:2720
    ds_read_b64_tr_b16 v[246:247], v65 offset:2688
    v_add_f32 v122, v122, v90
    v_add_f32 v123, v123, v91
    v_add_f32 v124, v124, v92
    v_add_f32 v125, v125, v93
    v_mfma_f32_32x32x16_bf16 v[160:175], v[228:231], v[224:227], v[160:175]
    v_add_f32 v126, v126, v94
    v_add_f32 v127, v127, v95
    v_cvt_pk_bf16_f32 v132, v120, v122
    v_cvt_pk_bf16_f32 v133, v124, v126
    v_cvt_pk_bf16_f32 v134, v121, v123
    v_cvt_pk_bf16_f32 v135, v125, v127
    v_mfma_f32_32x32x16_bf16 v[176:191], v[216:219], v[224:227], v[176:191]
    s_mov_b32 s25, 655360
    buffer_store_dwordx2 v[132:133], v68, s[20:23], s25 offen
    s_mov_b32 s25, 660480
    buffer_store_dwordx2 v[134:135], v68, s[20:23], s25 offen
    ds_read_b64_tr_b16 v[112:113], v65 offset:32
    ds_read_b64_tr_b16 v[114:115], v65 offset:0
    v_mfma_f32_32x32x16_bf16 v[192:207], v[232:235], v[224:227], v[192:207]
    ds_read_b64_tr_b16 v[232:233], v65 offset:3232
    ds_read_b64_tr_b16 v[234:235], v65 offset:3200
    ds_read_b64_tr_b16 v[116:117], v65 offset:160
    ds_read_b64_tr_b16 v[118:119], v65 offset:128
    ds_read_b64_tr_b16 v[120:121], v65 offset:288
    s_waitcnt lgkmcnt(7)
    v_mfma_f32_32x32x16_bf16 v[160:175], v[212:215], v[244:247], v[160:175]
    ds_read_b64_tr_b16 v[122:123], v65 offset:256
    ds_read_b64_tr_b16 v[124:125], v65 offset:416
    ds_read_b64_tr_b16 v[126:127], v65 offset:384
    ds_read_b64_tr_b16 v[128:129], v65 offset:544
    ds_read_b64_tr_b16 v[130:131], v65 offset:512
    ds_read_b64_tr_b16 v[132:133], v65 offset:672
    v_mfma_f32_32x32x16_bf16 v[176:191], v[228:231], v[244:247], v[176:191]
    ds_read_b64_tr_b16 v[240:241], v65 offset:3744
    ds_read_b64_tr_b16 v[242:243], v65 offset:3712
    ds_read_b64_tr_b16 v[134:135], v65 offset:640
    ds_read_b64_tr_b16 v[136:137], v65 offset:800
    ds_read_b64_tr_b16 v[138:139], v65 offset:768
    ds_read_b64_tr_b16 v[140:141], v65 offset:928
    v_mfma_f32_32x32x16_bf16 v[192:207], v[216:219], v[244:247], v[192:207]
    ds_read_b128 v[216:219], v64 offset:416
    ds_read_b64_tr_b16 v[236:237], v65 offset:800
    ds_read_b64_tr_b16 v[238:239], v65 offset:768
    ds_read_b64_tr_b16 v[142:143], v65 offset:896
    s_waitcnt lgkmcnt(15)
    v_mfma_f32_32x32x16_bf16 v[176:191], v[212:215], v[232:235], v[176:191]
    ds_read_b128 v[224:227], v64 offset:288
    ds_read_b64_tr_b16 v[244:245], v65 offset:1312
    ds_read_b64_tr_b16 v[246:247], v65 offset:1280
    s_waitcnt vmcnt(4)
ce_86:
    v_max3_u32 v208, v248, v249, v250
    v_max3_u32 v208, v208, v251, v252
    v_max3_u32 v208, v208, v253, v254
    v_max_u32 v208, v208, v255
    v_cmp_eq_u32 s[82:83], -1, v208
    v_min3_f32 v209, v96, v99, v100
    v_min3_f32 v209, v209, v103, v104
    v_min3_f32 v209, v209, v107, v108
    v_min_f32 v209, v209, v111
    v_cmp_neq_f32 vcc, 0x41000000, v209
    s_nop 0
    s_or_b64 vcc, vcc, s[82:83]
    s_cbranch_vccnz rd_87
rc_88:
    v_mfma_f32_32x32x16_bf16 v[192:207], v[228:231], v[232:235], v[192:207]
    v_mul_f32 v208, 0x3acccccd, v97
    v_mul_f32 v209, 0x3acccccd, v101
    v_mul_f32 v98, 0x3acccccd, v98
    v_mul_f32 v102, 0x3acccccd, v102
    v_fma_f32 v98, -v208, v208, v98
    s_waitcnt lgkmcnt(11)
    v_mfma_f32_32x32x16_bf16 v[192:207], v[212:215], v[240:243], v[192:207]
    ds_read_b128 v[228:231], v64 offset:160
    ds_read_b64_tr_b16 v[212:213], v65 offset:1824
    ds_read_b64_tr_b16 v[214:215], v65 offset:1792
    v_fma_f32 v102, -v209, v209, v102
    v_max_f32 v98, 0, v98
    s_waitcnt lgkmcnt(7)
    v_mfma_f32_32x32x16_bf16 v[144:159], v[216:219], v[236:239], v[144:159]
    v_max_f32 v102, 0, v102
    v_add_f32 v98, 0x3727c5ac, v98
    v_add_f32 v102, 0x3727c5ac, v102
    v_rsq_f32 v97, v98
    s_waitcnt lgkmcnt(3)
    v_mfma_f32_32x32x16_bf16 v[144:159], v[224:227], v[244:247], v[144:159]
    v_rsq_f32_e64 v101, v102
    v_mul_f32 v98, -v208, v97
    v_mul_f32 v102, -v209, v101
    v_lshlrev_b32_e64 v80, 16, v248
    v_and_b32 v82, 0xffff0000, v248
    v_mfma_f32_32x32x16_bf16 v[160:175], v[216:219], v[244:247], v[160:175]
    ds_read_b64_tr_b16 v[232:233], v65 offset:2336
    ds_read_b64_tr_b16 v[234:235], v65 offset:2304
    v_lshlrev_b32 v84, 16, v249
    v_and_b32 v86, 0xffff0000, v249
    v_lshlrev_b32_e64 v81, 16, v250
    s_waitcnt lgkmcnt(2)
    v_mfma_f32_32x32x16_bf16 v[144:159], v[228:231], v[212:215], v[144:159]
    v_and_b32 v83, 0xffff0000, v250
    v_lshlrev_b32_e64 v85, 16, v251
    v_and_b32 v87, 0xffff0000, v251
    v_fma_f32 v208, v80, v97, v98
    v_fma_f32 v209, v81, v101, v102
    v_cvt_pk_bf16_f32 v248, v208, v209
    v_mfma_f32_32x32x16_bf16 v[160:175], v[224:227], v[212:215], v[160:175]
    v_fma_f32 v208, v82, v97, v98
    v_fma_f32 v209, v83, v101, v102
    v_cvt_pk_bf16_f32 v249, v208, v209
    v_fma_f32 v208, v84, v97, v98
    v_fma_f32 v209, v85, v101, v102
    v_cvt_pk_bf16_f32 v250, v208, v209
    v_mfma_f32_32x32x16_bf16 v[176:191], v[216:219], v[212:215], v[176:191]
    v_fma_f32 v208, v86, v97, v98
    v_fma_f32 v209, v87, v101, v102
    v_cvt_pk_bf16_f32 v251, v208, v209
    s_waitcnt lgkmcnt(0)
    v_mfma_f32_32x32x16_bf16 v[144:159], v[220:223], v[232:235], v[144:159]
    ds_read_b64_tr_b16 v[240:241], v65 offset:2848
    ds_read_b64_tr_b16 v[242:243], v65 offset:2816
    ds_write_b32 v63, v248 offset:512
    ds_write_b32 v63, v249 offset:5376
    v_mfma_f32_32x32x16_bf16 v[160:175], v[228:231], v[232:235], v[160:175]
    ds_write_b32 v63, v250 offset:10240
    ds_write_b32 v63, v251 offset:15104
    v_mul_f32 v208, 0x3acccccd, v105
    v_mul_f32 v209, 0x3acccccd, v109
    v_mfma_f32_32x32x16_bf16 v[176:191], v[224:227], v[232:235], v[176:191]
    v_mul_f32 v106, 0x3acccccd, v106
    v_mul_f32 v110, 0x3acccccd, v110
    v_fma_f32 v106, -v208, v208, v106
    v_fma_f32 v110, -v209, v209, v110
    v_max_f32 v106, 0, v106
    v_max_f32_e64 v110, 0, v110
    v_mfma_f32_32x32x16_bf16 v[192:207], v[216:219], v[232:235], v[192:207]
    ds_read_b64_tr_b16 v[216:217], v65 offset:3360
    ds_read_b64_tr_b16 v[218:219], v65 offset:3328
    v_add_f32 v106, 0x3727c5ac, v106
    v_add_f32 v110, 0x3727c5ac, v110
    s_waitcnt lgkmcnt(6)
    v_mfma_f32_32x32x16_bf16 v[160:175], v[220:223], v[240:243], v[160:175]
    v_rsq_f32 v105, v106
    v_rsq_f32_e64 v109, v110
    v_mul_f32 v106, -v208, v105
    v_mul_f32 v110, -v209, v109
    v_mfma_f32_32x32x16_bf16 v[176:191], v[228:231], v[240:243], v[176:191]
    ds_read_b64_tr_b16 v[236:237], v65 offset:3872
    ds_read_b64_tr_b16 v[238:239], v65 offset:3840
    v_lshlrev_b32 v88, 16, v252
    v_and_b32 v90, 0xffff0000, v252
    v_lshlrev_b32 v92, 16, v253
    v_and_b32 v94, 0xffff0000, v253
    v_mfma_f32_32x32x16_bf16 v[192:207], v[224:227], v[240:243], v[192:207]
    ds_read_b128 v[224:227], v64 offset:384
    ds_read_b64_tr_b16 v[244:245], v65 offset:928
    ds_read_b64_tr_b16 v[246:247], v65 offset:896
    v_lshlrev_b32 v89, 16, v254
    v_and_b32 v91, 0xffff0000, v254
    s_waitcnt lgkmcnt(5)
    v_mfma_f32_32x32x16_bf16 v[176:191], v[220:223], v[216:219], v[176:191]
    ds_read_b128 v[212:215], v64 offset:256
    ds_read_b64_tr_b16 v[232:233], v65 offset:1440
    ds_read_b64_tr_b16 v[234:235], v65 offset:1408
    v_lshlrev_b32_e64 v93, 16, v255
    v_and_b32 v95, 0xffff0000, v255
    v_fma_f32 v208, v88, v105, v106
    v_mfma_f32_32x32x16_bf16 v[192:207], v[228:231], v[216:219], v[192:207]
    v_fma_f32 v209, v89, v109, v110
    v_cvt_pk_bf16_f32 v252, v208, v209
    v_fma_f32 v208, v90, v105, v106
    v_fma_f32 v209, v91, v109, v110
    v_cvt_pk_bf16_f32 v253, v208, v209
    s_waitcnt lgkmcnt(6)
    v_mfma_f32_32x32x16_bf16 v[192:207], v[220:223], v[236:239], v[192:207]
    ds_read_b128 v[220:223], v64 offset:128
    ds_read_b64_tr_b16 v[228:229], v65 offset:1952
    ds_read_b64_tr_b16 v[230:231], v65 offset:1920
    v_fma_f32 v208, v92, v105, v106
    v_fma_f32 v209, v93, v109, v110
    s_waitcnt lgkmcnt(6)
    v_mfma_f32_32x32x16_bf16 v[144:159], v[224:227], v[244:247], v[144:159]
    v_cvt_pk_bf16_f32 v254, v208, v209
    v_fma_f32 v208, v94, v105, v106
    v_fma_f32 v209, v95, v109, v110
    v_cvt_pk_bf16_f32 v255, v208, v209
    s_waitcnt lgkmcnt(3)
    v_mfma_f32_32x32x16_bf16 v[144:159], v[212:215], v[232:235], v[144:159]
    ds_write_b32 v63, v252 offset:768
    ds_write_b32 v63, v253 offset:5632
    ds_write_b32 v63, v254 offset:10496
    v_mfma_f32_32x32x16_bf16 v[160:175], v[224:227], v[232:235], v[160:175]
    ds_read_b128 v[240:243], v64 offset:0
    ds_read_b64_tr_b16 v[216:217], v65 offset:2464
    ds_read_b64_tr_b16 v[218:219], v65 offset:2432
    ds_write_b32 v63, v255 offset:15360
    s_waitcnt lgkmcnt(7)
    v_mfma_f32_32x32x16_bf16 v[144:159], v[220:223], v[228:231], v[144:159]
    v_mfma_f32_32x32x16_bf16 v[160:175], v[212:215], v[228:231], v[160:175]
    v_mfma_f32_32x32x16_bf16 v[176:191], v[224:227], v[228:231], v[176:191]
    s_waitcnt lgkmcnt(1)
    v_mfma_f32_32x32x16_bf16 v[144:159], v[240:243], v[216:219], v[144:159]
    ds_read_b64_tr_b16 v[236:237], v65 offset:2976
    ds_read_b64_tr_b16 v[238:239], v65 offset:2944
    v_mfma_f32_32x32x16_bf16 v[160:175], v[220:223], v[216:219], v[160:175]
    v_mfma_f32_32x32x16_bf16 v[176:191], v[212:215], v[216:219], v[176:191]
    v_mfma_f32_32x32x16_bf16 v[192:207], v[224:227], v[216:219], v[192:207]
    ds_read_b64_tr_b16 v[224:225], v65 offset:3488
    ds_read_b64_tr_b16 v[226:227], v65 offset:3456
    s_waitcnt lgkmcnt(2)
    v_mfma_f32_32x32x16_bf16 v[160:175], v[240:243], v[236:239], v[160:175]
    v_mfma_f32_32x32x16_bf16 v[176:191], v[220:223], v[236:239], v[176:191]
    ds_read_b64_tr_b16 v[244:245], v65 offset:4000
    ds_read_b64_tr_b16 v[246:247], v65 offset:3968
    v_mfma_f32_32x32x16_bf16 v[192:207], v[212:215], v[236:239], v[192:207]
    s_waitcnt lgkmcnt(2)
    v_mfma_f32_32x32x16_bf16 v[176:191], v[240:243], v[224:227], v[176:191]
    v_mfma_f32_32x32x16_bf16 v[192:207], v[220:223], v[224:227], v[192:207]
    s_waitcnt lgkmcnt(0)
    v_mfma_f32_32x32x16_bf16 v[192:207], v[240:243], v[244:247], v[192:207]
    s_waitcnt lgkmcnt(0)
    s_barrier
    ds_read_b128 v[212:215], v64 offset:608
    ds_read_b128 v[216:219], v64 offset:576
    ds_read_b128 v[220:223], v64 offset:544
    ds_read_b128 v[224:227], v64 offset:512
    s_waitcnt lgkmcnt(3)
    v_mfma_f32_32x32x16_bf16 v[144:159], v[212:215], v[112:115], v[144:159]
    ds_read_b128 v[228:231], v64 offset:736
    s_waitcnt lgkmcnt(3)
    v_mfma_f32_32x32x16_bf16 v[144:159], v[216:219], v[116:119], v[144:159]
    ds_read_b128 v[232:235], v64 offset:704
    s_waitcnt lgkmcnt(3)
    v_mfma_f32_32x32x16_bf16 v[144:159], v[220:223], v[120:123], v[144:159]
    ds_read_b128 v[236:239], v64 offset:672
    s_waitcnt lgkmcnt(3)
    v_mfma_f32_32x32x16_bf16 v[144:159], v[224:227], v[124:127], v[144:159]
    ds_read_b128 v[240:243], v64 offset:640
    s_nop 3
    s_waitcnt lgkmcnt(3)
    v_mfma_f32_32x32x16_bf16 v[160:175], v[228:231], v[112:115], v[160:175]
    s_nop 4
    s_waitcnt lgkmcnt(2)
    v_mfma_f32_32x32x16_bf16 v[160:175], v[232:235], v[116:119], v[160:175]
    v_cndmask_b32 v208, v147, v72, s[76:77]
    v_cndmask_b32 v209, v151, v147, s[76:77]
    v_cndmask_b32 v210, v155, v151, s[76:77]
    v_cndmask_b32 v211, v159, v155, s[76:77]
    v_mov_b32 v72, v159
    s_waitcnt lgkmcnt(1)
    v_mfma_f32_32x32x16_bf16 v[160:175], v[236:239], v[120:123], v[160:175]
    v_add_f32_dpp v146, v208, v146 wave_ror:1 row_mask:0xf bank_mask:0xf
    v_add_f32_dpp v150, v209, v150 wave_ror:1 row_mask:0xf bank_mask:0xf
    v_add_f32_dpp v154, v210, v154 wave_ror:1 row_mask:0xf bank_mask:0xf
    v_add_f32_dpp v158, v211, v158 wave_ror:1 row_mask:0xf bank_mask:0xf
    v_cndmask_b32 v208, v146, v71, s[76:77]
    s_waitcnt lgkmcnt(0)
    v_mfma_f32_32x32x16_bf16 v[160:175], v[240:243], v[124:127], v[160:175]
    v_cndmask_b32 v209, v150, v146, s[76:77]
    v_cndmask_b32 v210, v154, v150, s[76:77]
    v_cndmask_b32 v211, v158, v154, s[76:77]
    v_mov_b32 v71, v158
    v_add_f32_dpp v145, v208, v145 wave_ror:1 row_mask:0xf bank_mask:0xf
    v_add_f32_dpp v149, v209, v149 wave_ror:1 row_mask:0xf bank_mask:0xf
    v_mfma_f32_32x32x16_bf16 v[160:175], v[212:215], v[128:131], v[160:175]
    ds_read_b128 v[244:247], v64 offset:864
    v_add_f32_dpp v153, v210, v153 wave_ror:1 row_mask:0xf bank_mask:0xf
    v_add_f32_dpp v157, v211, v157 wave_ror:1 row_mask:0xf bank_mask:0xf
    v_cndmask_b32 v208, v145, v70, s[76:77]
    v_cndmask_b32 v209, v149, v145, s[76:77]
    v_cndmask_b32 v210, v153, v149, s[76:77]
    v_mfma_f32_32x32x16_bf16 v[160:175], v[216:219], v[132:135], v[160:175]
    ds_read_b128 v[248:251], v64 offset:832
    v_cndmask_b32 v211, v157, v153, s[76:77]
    v_mov_b32_e64 v70, v157
    v_add_f32_dpp v144, v208, v144 wave_ror:1 row_mask:0xf bank_mask:0xf
    v_add_f32_dpp v148, v209, v148 wave_ror:1 row_mask:0xf bank_mask:0xf
    v_add_f32_dpp v152, v210, v152 wave_ror:1 row_mask:0xf bank_mask:0xf
    v_mfma_f32_32x32x16_bf16 v[160:175], v[220:223], v[136:139], v[160:175]
    ds_read_b128 v[252:255], v64 offset:800
    v_add_f32_dpp v156, v211, v156 wave_ror:1 row_mask:0xf bank_mask:0xf
    ds_write_b32 v66, v144 offset:0
    v_mfma_f32_32x32x16_bf16 v[160:175], v[224:227], v[140:143], v[160:175]
    ds_read_b128 v[224:227], v64 offset:768
    ds_write_b32 v66, v148 offset:64
    ds_write_b32 v66, v152 offset:128
    s_waitcnt lgkmcnt(6)
    v_mfma_f32_32x32x16_bf16 v[176:191], v[244:247], v[112:115], v[176:191]
    ds_write_b32 v66, v156 offset:192
    s_nop 2
    s_waitcnt lgkmcnt(6)
    v_mfma_f32_32x32x16_bf16 v[176:191], v[248:251], v[116:119], v[176:191]
    s_nop 2
    v_cndmask_b32 v208, v163, v72, s[76:77]
    v_cndmask_b32 v209, v167, v163, s[76:77]
    s_waitcnt lgkmcnt(5)
    v_mfma_f32_32x32x16_bf16 v[176:191], v[252:255], v[120:123], v[176:191]
    v_cndmask_b32 v210, v171, v167, s[76:77]
    v_cndmask_b32 v211, v175, v171, s[76:77]
    v_mov_b32 v72, v175
    v_add_f32_dpp v162, v208, v162 wave_ror:1 row_mask:0xf bank_mask:0xf
    v_add_f32_dpp v166, v209, v166 wave_ror:1 row_mask:0xf bank_mask:0xf
    s_waitcnt lgkmcnt(3)
    v_mfma_f32_32x32x16_bf16 v[176:191], v[224:227], v[124:127], v[176:191]
    v_add_f32_dpp v170, v210, v170 wave_ror:1 row_mask:0xf bank_mask:0xf
    v_add_f32_dpp v174, v211, v174 wave_ror:1 row_mask:0xf bank_mask:0xf
    v_cndmask_b32 v208, v162, v71, s[76:77]
    v_cndmask_b32 v209, v166, v162, s[76:77]
    v_cndmask_b32 v210, v170, v166, s[76:77]
    v_cndmask_b32 v211, v174, v170, s[76:77]
    v_mfma_f32_32x32x16_bf16 v[176:191], v[228:231], v[128:131], v[176:191]
    ds_read_b64_tr_b16 v[228:229], v65 offset:1056
    ds_read_b64_tr_b16 v[230:231], v65 offset:1024
    v_mov_b32 v71, v174
    v_add_f32_dpp v161, v208, v161 wave_ror:1 row_mask:0xf bank_mask:0xf
    v_add_f32_dpp v165, v209, v165 wave_ror:1 row_mask:0xf bank_mask:0xf
    v_add_f32_dpp v169, v210, v169 wave_ror:1 row_mask:0xf bank_mask:0xf
    v_mfma_f32_32x32x16_bf16 v[176:191], v[232:235], v[132:135], v[176:191]
    ds_read_b64_tr_b16 v[232:233], v65 offset:1184
    ds_read_b64_tr_b16 v[234:235], v65 offset:1152
    v_add_f32_dpp v173, v211, v173 wave_ror:1 row_mask:0xf bank_mask:0xf
    v_cndmask_b32 v208, v161, v70, s[76:77]
    v_cndmask_b32 v209, v165, v161, s[76:77]
    v_cndmask_b32 v210, v169, v165, s[76:77]
    v_mfma_f32_32x32x16_bf16 v[176:191], v[236:239], v[136:139], v[176:191]
    ds_read_b64_tr_b16 v[236:237], v65 offset:1312
    ds_read_b64_tr_b16 v[238:239], v65 offset:1280
    v_cndmask_b32 v211, v173, v169, s[76:77]
    v_mov_b32_e64 v70, v173
    v_add_f32_dpp v160, v208, v160 wave_ror:1 row_mask:0xf bank_mask:0xf
    v_add_f32_dpp v164, v209, v164 wave_ror:1 row_mask:0xf bank_mask:0xf
    v_mfma_f32_32x32x16_bf16 v[176:191], v[240:243], v[140:143], v[176:191]
    ds_read_b128 v[240:243], v64 offset:512
    ds_read_b64_tr_b16 v[224:225], v65 offset:1440
    ds_read_b64_tr_b16 v[226:227], v65 offset:1408
    v_add_f32_dpp v168, v210, v168 wave_ror:1 row_mask:0xf bank_mask:0xf
    v_add_f32_dpp v172, v211, v172 wave_ror:1 row_mask:0xf bank_mask:0xf
    s_waitcnt lgkmcnt(7)
    v_mfma_f32_32x32x16_bf16 v[176:191], v[212:215], v[228:231], v[176:191]
    ds_read_b128 v[212:215], v64 offset:992
    ds_write_b32 v66, v160 offset:256
    ds_write_b32 v66, v164 offset:320
    s_waitcnt lgkmcnt(8)
    v_mfma_f32_32x32x16_bf16 v[176:191], v[216:219], v[232:235], v[176:191]
    ds_read_b128 v[216:219], v64 offset:960
    ds_write_b32 v66, v168 offset:384
    ds_write_b32 v66, v172 offset:448
    s_waitcnt lgkmcnt(9)
    v_mfma_f32_32x32x16_bf16 v[176:191], v[220:223], v[236:239], v[176:191]
    ds_read_b128 v[220:223], v64 offset:928
    s_waitcnt lgkmcnt(7)
    v_mfma_f32_32x32x16_bf16 v[176:191], v[240:243], v[224:227], v[176:191]
    ds_read_b128 v[240:243], v64 offset:896
    s_waitcnt lgkmcnt(2)
    s_barrier
    v_mfma_f32_32x32x16_bf16 v[192:207], v[212:215], v[112:115], v[192:207]
    ds_read_b64 v[144:145], v67 offset:0
    ds_read_b64 v[146:147], v67 offset:4224
    ds_read_b64 v[148:149], v67 offset:8448
    ds_read_b64 v[150:151], v67 offset:12672
    s_nop 0
    v_mfma_f32_32x32x16_bf16 v[192:207], v[216:219], v[116:119], v[192:207]
    s_nop 2
    v_cndmask_b32 v208, v179, v72, s[76:77]
    v_cndmask_b32 v209, v183, v179, s[76:77]
    s_waitcnt lgkmcnt(5)
    v_mfma_f32_32x32x16_bf16 v[192:207], v[220:223], v[120:123], v[192:207]
    v_cndmask_b32 v210, v187, v183, s[76:77]
    v_cndmask_b32 v211, v191, v187, s[76:77]
    v_mov_b32 v72, v191
    v_add_f32_dpp v178, v208, v178 wave_ror:1 row_mask:0xf bank_mask:0xf
    v_add_f32_dpp v182, v209, v182 wave_ror:1 row_mask:0xf bank_mask:0xf
    s_waitcnt lgkmcnt(4)
    v_mfma_f32_32x32x16_bf16 v[192:207], v[240:243], v[124:127], v[192:207]
    ds_read_b128 v[212:215], v64 offset:768
    v_add_f32_dpp v186, v210, v186 wave_ror:1 row_mask:0xf bank_mask:0xf
    v_add_f32_dpp v190, v211, v190 wave_ror:1 row_mask:0xf bank_mask:0xf
    v_cndmask_b32 v208, v178, v71, s[76:77]
    v_cndmask_b32 v209, v182, v178, s[76:77]
    v_cndmask_b32 v210, v186, v182, s[76:77]
    v_mfma_f32_32x32x16_bf16 v[192:207], v[244:247], v[128:131], v[192:207]
    ds_read_b128 v[244:247], v64 offset:736
    v_cndmask_b32 v211, v190, v186, s[76:77]
    v_mov_b32 v71, v190
    v_add_f32_dpp v177, v208, v177 wave_ror:1 row_mask:0xf bank_mask:0xf
    v_add_f32_dpp v181, v209, v181 wave_ror:1 row_mask:0xf bank_mask:0xf
    v_add_f32_dpp v185, v210, v185 wave_ror:1 row_mask:0xf bank_mask:0xf
    v_mfma_f32_32x32x16_bf16 v[192:207], v[248:251], v[132:135], v[192:207]
    ds_read_b128 v[248:251], v64 offset:704
    v_add_f32_dpp v189, v211, v189 wave_ror:1 row_mask:0xf bank_mask:0xf
    v_cndmask_b32 v208, v177, v70, s[76:77]
    v_cndmask_b32 v209, v181, v177, s[76:77]
    v_cndmask_b32 v210, v185, v181, s[76:77]
    v_cndmask_b32 v211, v189, v185, s[76:77]
    v_mfma_f32_32x32x16_bf16 v[192:207], v[252:255], v[136:139], v[192:207]
    ds_read_b128 v[252:255], v64 offset:672
    v_mov_b32_e64 v70, v189
    v_add_f32_dpp v176, v208, v176 wave_ror:1 row_mask:0xf bank_mask:0xf
    v_add_f32_dpp v180, v209, v180 wave_ror:1 row_mask:0xf bank_mask:0xf
    v_add_f32_dpp v184, v210, v184 wave_ror:1 row_mask:0xf bank_mask:0xf
    s_waitcnt lgkmcnt(3)
    v_mfma_f32_32x32x16_bf16 v[192:207], v[212:215], v[140:143], v[192:207]
    ds_read_b128 v[216:219], v64 offset:640
    v_add_f32_dpp v188, v211, v188 wave_ror:1 row_mask:0xf bank_mask:0xf
    s_waitcnt lgkmcnt(3)
    v_mfma_f32_32x32x16_bf16 v[192:207], v[244:247], v[228:231], v[192:207]
    ds_read_b128 v[228:231], v64 offset:608
    ds_read_b64_tr_b16 v[220:221], v65 offset:1568
    ds_read_b64_tr_b16 v[222:223], v65 offset:1536
    ds_write_b32 v66, v176 offset:512
    s_waitcnt lgkmcnt(6)
    v_mfma_f32_32x32x16_bf16 v[192:207], v[248:251], v[232:235], v[192:207]
    ds_read_b128 v[232:235], v64 offset:576
    ds_read_b64_tr_b16 v[240:241], v65 offset:1696
    ds_read_b64_tr_b16 v[242:243], v65 offset:1664
    ds_write_b32 v66, v180 offset:576
    s_waitcnt lgkmcnt(9)
    v_mfma_f32_32x32x16_bf16 v[192:207], v[252:255], v[236:239], v[192:207]
    ds_read_b128 v[236:239], v64 offset:544
    ds_read_b64_tr_b16 v[212:213], v65 offset:1824
    ds_read_b64_tr_b16 v[214:215], v65 offset:1792
    ds_write_b32 v66, v184 offset:640
    s_waitcnt lgkmcnt(12)
    v_mfma_f32_32x32x16_bf16 v[192:207], v[216:219], v[224:227], v[192:207]
    ds_read_b128 v[224:227], v64 offset:512
    ds_read_b64_tr_b16 v[244:245], v65 offset:1952
    ds_read_b64_tr_b16 v[246:247], v65 offset:1920
    ds_write_b32 v66, v188 offset:704
    s_waitcnt lgkmcnt(13)
    v_mfma_f32_32x32x16_bf16 v[192:207], v[228:231], v[220:223], v[192:207]
    v_add_f32 v144, v144, v80
    v_add_f32 v145, v145, v81
    v_add_f32 v146, v146, v82
    v_add_f32 v147, v147, v83
    s_waitcnt lgkmcnt(9)
    v_mfma_f32_32x32x16_bf16 v[192:207], v[232:235], v[240:243], v[192:207]
    v_add_f32 v148, v148, v84
    v_add_f32 v149, v149, v85
    v_add_f32 v150, v150, v86
    v_add_f32 v151, v151, v87
    v_cvt_pk_bf16_f32 v160, v144, v146
    s_waitcnt lgkmcnt(5)
    v_mfma_f32_32x32x16_bf16 v[192:207], v[236:239], v[212:215], v[192:207]
    v_cvt_pk_bf16_f32 v161, v148, v150
    v_cvt_pk_bf16_f32 v162, v145, v147
    v_cvt_pk_bf16_f32 v163, v149, v151
    s_mov_b32 s25, 1310720
    s_waitcnt lgkmcnt(1)
    v_mfma_f32_32x32x16_bf16 v[192:207], v[224:227], v[244:247], v[192:207]
    buffer_store_dwordx2 v[160:161], v68, s[20:23], s25 offen
    s_mov_b32 s25, 1315840
    buffer_store_dwordx2 v[162:163], v68, s[20:23], s25 offen
    s_nop 8
    v_cndmask_b32 v208, v195, v72, s[76:77]
    v_cndmask_b32 v209, v199, v195, s[76:77]
    v_cndmask_b32 v210, v203, v199, s[76:77]
    v_cndmask_b32 v211, v207, v203, s[76:77]
    v_mov_b32_e64 v72, v207
    v_add_f32_dpp v194, v208, v194 wave_ror:1 row_mask:0xf bank_mask:0xf
    v_add_f32_dpp v198, v209, v198 wave_ror:1 row_mask:0xf bank_mask:0xf
    v_add_f32_dpp v202, v210, v202 wave_ror:1 row_mask:0xf bank_mask:0xf
    v_add_f32_dpp v206, v211, v206 wave_ror:1 row_mask:0xf bank_mask:0xf
    v_cndmask_b32 v208, v194, v71, s[76:77]
    v_cndmask_b32 v209, v198, v194, s[76:77]
    v_cndmask_b32 v210, v202, v198, s[76:77]
    v_cndmask_b32 v211, v206, v202, s[76:77]
    v_mov_b32_e64 v71, v206
    v_add_f32_dpp v193, v208, v193 wave_ror:1 row_mask:0xf bank_mask:0xf
    v_add_f32_dpp v197, v209, v197 wave_ror:1 row_mask:0xf bank_mask:0xf
    v_add_f32_dpp v201, v210, v201 wave_ror:1 row_mask:0xf bank_mask:0xf
    v_add_f32_dpp v205, v211, v205 wave_ror:1 row_mask:0xf bank_mask:0xf
    v_cndmask_b32 v208, v193, v70, s[76:77]
    v_cndmask_b32 v209, v197, v193, s[76:77]
    v_cndmask_b32 v210, v201, v197, s[76:77]
    v_cndmask_b32 v211, v205, v201, s[76:77]
    v_mov_b32_e64 v70, v205
    v_add_f32_dpp v192, v208, v192 wave_ror:1 row_mask:0xf bank_mask:0xf
    v_add_f32_dpp v196, v209, v196 wave_ror:1 row_mask:0xf bank_mask:0xf
    v_add_f32_dpp v200, v210, v200 wave_ror:1 row_mask:0xf bank_mask:0xf
    v_add_f32_dpp v204, v211, v204 wave_ror:1 row_mask:0xf bank_mask:0xf
    ds_write_b32 v66, v192 offset:768
    ds_write_b32 v66, v196 offset:832
    ds_write_b32 v66, v200 offset:896
    ds_write_b32 v66, v204 offset:960
    s_waitcnt lgkmcnt(0)
    s_barrier
    ds_read_b64 v[152:153], v67 offset:512
    ds_read_b64 v[154:155], v67 offset:4736
    ds_read_b64 v[156:157], v67 offset:8960
    ds_read_b64 v[158:159], v67 offset:13184
    s_waitcnt lgkmcnt(0)
    v_add_f32 v152, v152, v88
    v_add_f32 v153, v153, v89
    v_add_f32 v154, v154, v90
    v_add_f32 v155, v155, v91
    v_add_f32 v156, v156, v92
    v_add_f32 v157, v157, v93
    v_add_f32 v158, v158, v94
    v_add_f32_e64 v159, v159, v95
    v_cvt_pk_bf16_f32 v164, v152, v154
    v_cvt_pk_bf16_f32 v165, v156, v158
    v_cvt_pk_bf16_f32 v166, v153, v155
    v_cvt_pk_bf16_f32 v167, v157, v159
    s_mov_b32 s25, 1966080
    buffer_store_dwordx2 v[164:165], v68, s[20:23], s25 offen
    s_mov_b32 s25, 1971200
    buffer_store_dwordx2 v[166:167], v68, s[20:23], s25 offen
    s_branch ec_82
nc_81:
ec_82:
L_end:
    s_endpgm
ps_5:
    s_mov_b32 s84, 1048576
pl_6:
    global_load_dword v7, v5, s[66:67] sc1
    s_waitcnt vmcnt(0)
    s_sub_u32 s84, s84, 1
    s_cbranch_scc1 pc_7
    v_cmp_gt_u32_e64 vcc, 1, v7
    s_nop 0
    s_and_b64 vcc, vcc, s[50:51]
    s_and_b64 vcc, vcc, 1
    s_cbranch_scc1 pl_6
    s_branch pc_7
ps_8:
    s_mov_b32 s84, 1048576
pl_9:
    buffer_load_dword v7, v4, s[16:19], s87 offen offset:0 sc1
    s_waitcnt vmcnt(0)
    s_sub_u32 s84, s84, 1
    s_cbranch_scc1 pc_10
    v_cmp_gt_u32 vcc, 32, v7
    s_nop 0
    s_and_b64 vcc, vcc, s[50:51]
    s_cbranch_scc1 pl_9
    s_branch pc_10
ps_11:
    s_mov_b32 s84, 1048576
pl_12:
    global_load_dword v7, v5, s[66:67] sc1
    s_waitcnt vmcnt(0)
    s_sub_u32 s84, s84, 1
    s_cbranch_scc1 pc_13
    v_cmp_gt_u32_e64 vcc, 1, v7
    s_nop 0
    s_and_b64 vcc, vcc, s[50:51]
    s_and_b64 vcc, vcc, 1
    s_cbranch_scc1 pl_12
    s_branch pc_13
ps_14:
    s_mov_b32 s84, 1048576
pl_15:
    buffer_load_dword v7, v4, s[16:19], s87 offen offset:0 sc1
    s_waitcnt vmcnt(0)
    s_sub_u32 s84, s84, 1
    s_cbranch_scc1 pc_16
    v_cmp_gt_u32 vcc, 32, v7
    s_nop 0
    s_and_b64 vcc, vcc, s[50:51]
    s_cbranch_scc1 pl_15
    s_branch pc_16
ps_17:
    s_mov_b32 s84, 1048576
pl_18:
    buffer_load_dword v7, v4, s[16:19], s89 offen offset:8 sc1
    s_waitcnt vmcnt(0)
    s_sub_u32 s84, s84, 1
    s_cbranch_scc1 pc_19
    v_cmp_gt_u32_e64 vcc, 32, v7
    s_nop 0
    s_and_b64 vcc, vcc, s[50:51]
    s_cbranch_scc1 pl_18
    s_branch pc_19
rd_21:
    s_cmp_eq_u32 s38, 0
    s_cbranch_scc1 rc_22
    s_sub_u32 s38, s38, 1
    s_nop 7
    s_nop 7
    s_sleep 4
    s_mov_b64 exec, vcc
    s_mov_b32 s96, 4194304
    buffer_load_dwordx4 v[216:219], v56, s[16:19], s96 offen offset:0 sc1
    buffer_load_dwordx4 v[220:223], v56, s[16:19], s96 offen offset:256 sc1
    s_mov_b32 s96, 4227072
    buffer_load_dwordx4 v[224:227], v56, s[16:19], s96 offen offset:0 sc1
    buffer_load_dwordx4 v[228:231], v56, s[16:19], s96 offen offset:256 sc1
    s_mov_b32 s96, 4259840
    buffer_load_dwordx4 v[232:235], v56, s[16:19], s96 offen offset:0 sc1
    buffer_load_dwordx4 v[236:239], v56, s[16:19], s96 offen offset:256 sc1
    s_mov_b32 s96, 4292608
    buffer_load_dwordx4 v[240:243], v56, s[16:19], s96 offen offset:0 sc1
    buffer_load_dwordx4 v[244:247], v56, s[16:19], s96 offen offset:256 sc1
    s_mov_b32 s96, 4194304
    buffer_load_dwordx2 v[248:249], v57, s[16:19], s96 offen offset:0 sc1
    buffer_load_dwordx2 v[252:253], v57, s[16:19], s96 offen offset:128 sc1
    s_mov_b32 s96, 4210688
    buffer_load_dwordx2 v[250:251], v57, s[16:19], s96 offen offset:0 sc1
    buffer_load_dwordx2 v[254:255], v57, s[16:19], s96 offen offset:128 sc1
    s_mov_b32 s96, 0
    s_mov_b32 s97, 5120
    s_waitcnt vmcnt(16)
    buffer_load_dwordx2 v[208:209], v60, s[4:7], s96 offen
    s_waitcnt vmcnt(16)
    buffer_load_dwordx2 v[210:211], v60, s[4:7], s97 offen
    s_waitcnt vmcnt(16)
    v_lshrrev_b32_e64 v212, 5, v1
    v_mul_u32_u24 v212, 5104, v212
    v_bfe_u32 v213, v1, 4, 1
    v_lshlrev_b32 v213, 2, v213
    v_sub_u32 v212, v212, v213
    v_add_u32 v212, v212, v60
    s_mul_i32 s97, s24, 24
    s_sub_u32 s97, 128, s97
    buffer_load_dword v212, v212, s[4:7], s97 offen
    s_mov_b64 exec, -1
    s_waitcnt vmcnt(0) lgkmcnt(0)
    s_branch oe_20
rd_24:
    s_cmp_eq_u32 s38, 0
    s_cbranch_scc1 rc_25
    s_sub_u32 s38, s38, 1
    s_nop 7
    s_nop 7
    s_sleep 4
    s_mov_b64 exec, vcc
    s_mov_b32 s96, 4198400
    buffer_load_dwordx4 v[216:219], v56, s[16:19], s96 offen offset:0 sc1
    buffer_load_dwordx4 v[220:223], v56, s[16:19], s96 offen offset:256 sc1
    s_mov_b32 s96, 4231168
    buffer_load_dwordx4 v[224:227], v56, s[16:19], s96 offen offset:0 sc1
    buffer_load_dwordx4 v[228:231], v56, s[16:19], s96 offen offset:256 sc1
    s_mov_b32 s96, 4263936
    buffer_load_dwordx4 v[232:235], v56, s[16:19], s96 offen offset:0 sc1
    buffer_load_dwordx4 v[236:239], v56, s[16:19], s96 offen offset:256 sc1
    s_mov_b32 s96, 4296704
    buffer_load_dwordx4 v[240:243], v56, s[16:19], s96 offen offset:0 sc1
    buffer_load_dwordx4 v[244:247], v56, s[16:19], s96 offen offset:256 sc1
    s_mov_b32 s96, 4196352
    buffer_load_dwordx2 v[248:249], v57, s[16:19], s96 offen offset:0 sc1
    buffer_load_dwordx2 v[252:253], v57, s[16:19], s96 offen offset:128 sc1
    s_mov_b32 s96, 4212736
    buffer_load_dwordx2 v[250:251], v57, s[16:19], s96 offen offset:0 sc1
    buffer_load_dwordx2 v[254:255], v57, s[16:19], s96 offen offset:128 sc1
    s_mov_b32 s96, 1310720
    s_mov_b32 s97, 1315840
    s_waitcnt vmcnt(15)
    buffer_load_dwordx2 v[208:209], v60, s[4:7], s96 offen
    s_waitcnt vmcnt(15)
    buffer_load_dwordx2 v[210:211], v60, s[4:7], s97 offen
    s_waitcnt vmcnt(15)
    v_lshrrev_b32 v212, 5, v1
    v_mul_u32_u24 v212, 5104, v212
    v_bfe_u32 v213, v1, 4, 1
    v_lshlrev_b32 v213, 2, v213
    v_sub_u32 v212, v212, v213
    v_add_u32 v212, v212, v60
    s_mul_i32 s97, s24, 24
    s_sub_u32 s97, 1310848, s97
    buffer_load_dword v212, v212, s[4:7], s97 offen
    s_mov_b64 exec, -1
    s_waitcnt vmcnt(0) lgkmcnt(0)
    s_branch oe_23
rd_29:
    s_cmp_eq_u32 s38, 0
    s_cbranch_scc1 rc_30
    s_sub_u32 s38, s38, 1
    s_nop 7
    s_nop 7
    s_sleep 4
    s_mov_b64 exec, vcc
    s_lshl_b32 s96, s75, 14
    s_add_u32 s96, s96, 6815744
    s_lshl_b32 s97, s24, 12
    s_add_u32 s97, s97, 3473408
    buffer_load_dwordx4 v[176:179], v62, s[16:19], s96 offen offset:0 sc1
    buffer_load_dwordx4 v[180:183], v62, s[16:19], s96 offen offset:1024 sc1
    buffer_load_dwordx4 v[184:187], v62, s[16:19], s97 offen offset:0 sc1
    buffer_load_dwordx4 v[188:191], v62, s[16:19], s97 offen offset:1024 sc1
    buffer_load_dwordx4 v[192:195], v62, s[16:19], s97 offen offset:2048 sc1
    buffer_load_dwordx4 v[196:199], v62, s[16:19], s97 offen offset:3072 sc1
    s_mov_b64 exec, -1
    s_waitcnt vmcnt(0) lgkmcnt(0)
    s_branch ce_28
rd_32:
    s_cmp_eq_u32 s38, 0
    s_cbranch_scc1 rc_33
    s_sub_u32 s38, s38, 1
    s_nop 7
    s_nop 7
    s_sleep 4
    s_mov_b64 exec, vcc
    s_lshl_b32 s96, s75, 14
    s_add_u32 s96, s96, 6815744
    s_lshl_b32 s97, s24, 12
    s_add_u32 s97, s97, 3477504
    buffer_load_dwordx4 v[248:251], v62, s[16:19], s96 offen offset:2048 sc1
    buffer_load_dwordx4 v[252:255], v62, s[16:19], s96 offen offset:3072 sc1
    buffer_load_dwordx4 v[96:99], v62, s[16:19], s97 offen offset:0 sc1
    buffer_load_dwordx4 v[100:103], v62, s[16:19], s97 offen offset:1024 sc1
    buffer_load_dwordx4 v[104:107], v62, s[16:19], s97 offen offset:2048 sc1
    buffer_load_dwordx4 v[108:111], v62, s[16:19], s97 offen offset:3072 sc1
    s_mov_b64 exec, -1
    s_waitcnt vmcnt(0) lgkmcnt(0)
    s_branch ce_31
gl_34:
    s_add_u32 s82, s86, 16384
    v_lshlrev_b32 v2, 10, v1
    v_mov_b32_e64 v5, 1
    s_mov_b64 exec, 255
    buffer_store_dword v5, v2, s[16:19], s82 offen offset:0 sc1
    s_mov_b64 exec, -1
    s_branch gc_35
ps_36:
    s_mov_b32 s84, 1048576
pl_37:
    buffer_load_dword v7, v4, s[16:19], s89 offen offset:0 sc1
    s_waitcnt vmcnt(0)
    s_sub_u32 s84, s84, 1
    s_cbranch_scc1 pc_38
    v_cmp_gt_u32 vcc, 1, v7
    s_nop 0
    s_and_b64 vcc, vcc, s[50:51]
    s_cbranch_scc1 pl_37
    s_branch pc_38
ps_39:
    s_mov_b32 s84, 1048576
pl_40:
    buffer_load_dword v7, v4, s[16:19], s87 offen offset:8 sc1
    s_waitcnt vmcnt(0)
    s_sub_u32 s84, s84, 1
    s_cbranch_scc1 pc_41
    v_cmp_gt_u32 vcc, 12, v7
    s_nop 0
    s_and_b64 vcc, vcc, s[50:51]
    s_cbranch_scc1 pl_40
    s_branch pc_41
gl_42:
    s_add_u32 s82, s86, 0
    v_lshlrev_b32 v2, 10, v1
    v_mov_b32_e64 v5, 1
    s_mov_b64 exec, 255
    buffer_store_dword v5, v2, s[16:19], s82 offen offset:12 sc1
    s_mov_b64 exec, -1
    s_branch gc_43
ps_44:
    s_mov_b32 s84, 1048576
pl_45:
    buffer_load_dword v7, v4, s[16:19], s89 offen offset:0 sc1
    s_waitcnt vmcnt(0)
    s_sub_u32 s84, s84, 1
    s_cbranch_scc1 pc_46
    v_cmp_gt_u32_e64 vcc, 1, v7
    s_nop 0
    s_and_b64 vcc, vcc, s[50:51]
    s_cbranch_scc1 pl_45
    s_branch pc_46
rd_49:
    s_cmp_eq_u32 s38, 0
    s_cbranch_scc1 rc_50
    s_sub_u32 s38, s38, 1
    s_nop 7
    s_nop 7
    s_sleep 4
    s_mov_b64 exec, vcc
    s_add_u32 s26, s3, 9437184
    buffer_load_dwordx4 v[216:219], v236, s[16:19], s26 offen sc1
    s_add_u32 s26, s26, 524288
    buffer_load_dwordx4 v[220:223], v236, s[16:19], s26 offen sc1
    s_add_u32 s26, s26, 524288
    buffer_load_dwordx4 v[224:227], v236, s[16:19], s26 offen sc1
    s_add_u32 s26, s26, 524288
    buffer_load_dwordx4 v[228:231], v236, s[16:19], s26 offen sc1
    s_add_u32 s26, s26, 524288
    buffer_load_dwordx4 v[232:235], v236, s[16:19], s26 offen sc1
    s_mov_b64 exec, -1
    s_waitcnt vmcnt(0) lgkmcnt(0)
    s_branch se_48
gl_52:
    s_add_u32 s82, s86, 16384
    v_lshlrev_b32 v2, 10, v1
    v_mov_b32_e64 v5, 1
    s_mov_b64 exec, 255
    buffer_store_dword v5, v2, s[16:19], s82 offen offset:4 sc1
    s_mov_b64 exec, -1
    s_branch gc_53
ps_54:
    s_mov_b32 s84, 1048576
pl_55:
    buffer_load_dword v7, v4, s[16:19], s87 offen offset:12 sc1
    s_waitcnt vmcnt(0)
    s_sub_u32 s84, s84, 1
    s_cbranch_scc1 pc_56
    v_cmp_gt_u32_e64 vcc, 1, v7
    s_nop 0
    s_and_b64 vcc, vcc, s[50:51]
    s_cbranch_scc1 pl_55
    s_branch pc_56
rd_58:
    s_cmp_eq_u32 s38, 0
    s_cbranch_scc1 rc_59
    s_sub_u32 s38, s38, 1
    s_nop 7
    s_nop 7
    s_sleep 4
    s_mov_b64 exec, vcc
    s_lshl_b32 s98, s72, 5
    s_add_u32 s98, s98, 0
    s_sub_u32 s95, s98, 4
    s_max_i32 s95, s95, 0
    s_lshl_b32 s94, s98, 3
    s_lshl_b32 s95, s95, 3
    s_add_u32 s94, s94, 3457024
    s_add_u32 s95, s95, 3457024
    s_add_u32 s96, s94, 8192
    buffer_load_dwordx2 v[152:153], v47, s[16:19], s94 offen sc1
    buffer_load_dwordx2 v[154:155], v47, s[16:19], s96 offen sc1
    buffer_load_dwordx2 v[156:157], v48, s[16:19], s95 offen sc1
    s_mov_b64 exec, -1
    s_waitcnt vmcnt(0) lgkmcnt(0)
    s_branch sl_57
ps_60:
    s_mov_b32 s84, 1048576
pl_61:
    buffer_load_dword v7, v4, s[16:19], s89 offen offset:4 sc1
    s_waitcnt vmcnt(0)
    s_sub_u32 s84, s84, 1
    s_cbranch_scc1 pc_62
    v_cmp_gt_u32 vcc, 1, v7
    s_nop 0
    s_and_b64 vcc, vcc, s[50:51]
    s_cbranch_scc1 pl_61
    s_branch pc_62
rd_65:
    s_cmp_eq_u32 s38, 0
    s_cbranch_scc1 rc_66
    s_sub_u32 s38, s38, 1
    s_nop 7
    s_nop 7
    s_sleep 4
    s_mov_b64 exec, vcc
    s_add_u32 s26, s3, 9437184
    buffer_load_dwordx4 v[216:219], v236, s[16:19], s26 offen sc1
    s_add_u32 s26, s26, 524288
    buffer_load_dwordx4 v[220:223], v236, s[16:19], s26 offen sc1
    s_add_u32 s26, s26, 524288
    buffer_load_dwordx4 v[224:227], v236, s[16:19], s26 offen sc1
    s_add_u32 s26, s26, 524288
    buffer_load_dwordx4 v[228:231], v236, s[16:19], s26 offen sc1
    s_add_u32 s26, s26, 524288
    buffer_load_dwordx4 v[232:235], v236, s[16:19], s26 offen sc1
    s_mov_b64 exec, -1
    s_waitcnt vmcnt(0) lgkmcnt(0)
    s_branch se_64
rd_67:
    s_cmp_eq_u32 s39, 0
    s_cbranch_scc1 rc_68
    s_sub_u32 s39, s39, 1
    s_nop 7
    s_nop 7
    s_waitcnt vmcnt(0) lgkmcnt(0)
    s_barrier
    s_lshl_b32 s25, s72, 5
    s_add_u32 s25, s25, 0
    s_sub_u32 s26, s25, 4
    s_max_i32 s26, s26, 0
    s_lshl_b32 s27, s71, 12
    s_add_u32 s27, s27, 9437184
    s_lshl_b32 s99, s25, 3
    s_lshl_b32 s100, s26, 3
    s_lshl_b32 s92, s24, 12
    s_lshl_b32 s93, s24, 9
    s_add_u32 s99, s99, s27
    s_add_u32 s100, s100, s27
    s_add_u32 m0, s92, 36352
    s_nop 0
    buffer_load_dwordx4 v73, s[16:19], s99 offen offset:0 sc1 lds
    buffer_load_dwordx4 v74, s[16:19], s99 offen offset:1024 sc1 lds
    buffer_load_dwordx4 v75, s[16:19], s99 offen offset:2048 sc1 lds
    buffer_load_dwordx4 v76, s[16:19], s99 offen offset:3072 sc1 lds
    s_add_u32 m0, s93, 53760
    s_add_u32 s99, s99, 524288
    s_mov_b64 exec, s[80:81]
    buffer_load_dwordx4 v77, s[16:19], s100 offen sc1 lds
    s_mov_b64 exec, -1
    s_add_u32 s100, s100, 524288
    s_add_u32 m0, s92, 55936
    s_nop 0
    s_nop 0
    buffer_load_dwordx4 v73, s[16:19], s99 offen offset:0 sc1 lds
    buffer_load_dwordx4 v74, s[16:19], s99 offen offset:1024 sc1 lds
    buffer_load_dwordx4 v75, s[16:19], s99 offen offset:2048 sc1 lds
    buffer_load_dwordx4 v76, s[16:19], s99 offen offset:3072 sc1 lds
    s_add_u32 m0, s93, 73344
    s_add_u32 s99, s99, 524288
    s_mov_b64 exec, s[80:81]
    buffer_load_dwordx4 v77, s[16:19], s100 offen sc1 lds
    s_mov_b64 exec, -1
    s_add_u32 s100, s100, 524288
    s_add_u32 m0, s92, 75520
    s_nop 0
    s_nop 0
    buffer_load_dwordx4 v73, s[16:19], s99 offen offset:0 sc1 lds
    buffer_load_dwordx4 v74, s[16:19], s99 offen offset:1024 sc1 lds
    buffer_load_dwordx4 v75, s[16:19], s99 offen offset:2048 sc1 lds
    buffer_load_dwordx4 v76, s[16:19], s99 offen offset:3072 sc1 lds
    s_add_u32 m0, s93, 92928
    s_add_u32 s99, s99, 524288
    s_mov_b64 exec, s[80:81]
    buffer_load_dwordx4 v77, s[16:19], s100 offen sc1 lds
    s_mov_b64 exec, -1
    s_add_u32 s100, s100, 524288
    s_mov_b64 exec, -1
    s_waitcnt vmcnt(0) lgkmcnt(0)
    s_branch ge_51
rd_71:
    s_cmp_eq_u32 s38, 0
    s_cbranch_scc1 rc_72
    s_sub_u32 s38, s38, 1
    s_nop 7
    s_nop 7
    s_sleep 4
    s_mov_b64 exec, vcc
    s_lshl_b32 s98, s72, 5
    s_add_u32 s98, s98, 256
    s_sub_u32 s95, s98, 4
    s_max_i32 s95, s95, 0
    s_lshl_b32 s94, s98, 3
    s_lshl_b32 s95, s95, 3
    s_nop 0
    s_add_u32 s94, s94, 3457024
    s_add_u32 s95, s95, 3457024
    s_add_u32 s96, s94, 8192
    buffer_load_dwordx2 v[152:153], v47, s[16:19], s94 offen sc1
    buffer_load_dwordx2 v[154:155], v47, s[16:19], s96 offen sc1
    buffer_load_dwordx2 v[156:157], v48, s[16:19], s95 offen sc1
    s_mov_b64 exec, -1
    s_waitcnt vmcnt(0) lgkmcnt(0)
    s_branch sl_70
rd_73:
    s_cmp_eq_u32 s39, 0
    s_cbranch_scc1 rc_74
    s_sub_u32 s39, s39, 1
    s_nop 7
    s_nop 7
    s_waitcnt vmcnt(0) lgkmcnt(0)
    s_barrier
    s_lshl_b32 s25, s72, 5
    s_add_u32 s25, s25, 256
    s_sub_u32 s26, s25, 4
    s_max_i32 s26, s26, 0
    s_lshl_b32 s27, s71, 12
    s_add_u32 s27, s27, 9437184
    s_lshl_b32 s99, s25, 3
    s_lshl_b32 s100, s26, 3
    s_lshl_b32 s92, s24, 12
    s_lshl_b32 s93, s24, 9
    s_add_u32 s99, s99, s27
    s_add_u32 s100, s100, s27
    s_add_u32 m0, s92, 36352
    s_nop 0
    s_nop 0
    buffer_load_dwordx4 v73, s[16:19], s99 offen offset:0 sc1 lds
    buffer_load_dwordx4 v74, s[16:19], s99 offen offset:1024 sc1 lds
    buffer_load_dwordx4 v75, s[16:19], s99 offen offset:2048 sc1 lds
    buffer_load_dwordx4 v76, s[16:19], s99 offen offset:3072 sc1 lds
    s_add_u32 m0, s93, 53760
    s_add_u32 s99, s99, 524288
    s_mov_b64 exec, s[80:81]
    buffer_load_dwordx4 v77, s[16:19], s100 offen sc1 lds
    s_mov_b64 exec, -1
    s_add_u32 s100, s100, 524288
    s_add_u32 m0, s92, 55936
    s_nop 0
    s_nop 0
    buffer_load_dwordx4 v73, s[16:19], s99 offen offset:0 sc1 lds
    buffer_load_dwordx4 v74, s[16:19], s99 offen offset:1024 sc1 lds
    buffer_load_dwordx4 v75, s[16:19], s99 offen offset:2048 sc1 lds
    buffer_load_dwordx4 v76, s[16:19], s99 offen offset:3072 sc1 lds
    s_add_u32 m0, s93, 73344
    s_add_u32 s99, s99, 524288
    s_mov_b64 exec, s[80:81]
    buffer_load_dwordx4 v77, s[16:19], s100 offen sc1 lds
    s_mov_b64 exec, -1
    s_add_u32 s100, s100, 524288
    s_add_u32 m0, s92, 75520
    s_nop 0
    s_nop 0
    buffer_load_dwordx4 v73, s[16:19], s99 offen offset:0 sc1 lds
    buffer_load_dwordx4 v74, s[16:19], s99 offen offset:1024 sc1 lds
    buffer_load_dwordx4 v75, s[16:19], s99 offen offset:2048 sc1 lds
    buffer_load_dwordx4 v76, s[16:19], s99 offen offset:3072 sc1 lds
    s_add_u32 m0, s93, 92928
    s_add_u32 s99, s99, 524288
    s_mov_b64 exec, s[80:81]
    buffer_load_dwordx4 v77, s[16:19], s100 offen sc1 lds
    s_mov_b64 exec, -1
    s_add_u32 s100, s100, 524288
    s_mov_b64 exec, -1
    s_waitcnt vmcnt(0) lgkmcnt(0)
    s_branch ge_69
rd_76:
    s_cmp_eq_u32 s38, 0
    s_cbranch_scc1 rc_77
    s_sub_u32 s38, s38, 1
    s_nop 7
    s_nop 7
    s_sleep 4
    s_mov_b64 exec, vcc
    s_mov_b32 s96, 12058624
    buffer_load_dwordx4 v[216:219], v56, s[16:19], s96 offen offset:0 sc1
    buffer_load_dwordx4 v[220:223], v56, s[16:19], s96 offen offset:256 sc1
    s_mov_b32 s96, 12091392
    buffer_load_dwordx4 v[224:227], v56, s[16:19], s96 offen offset:0 sc1
    buffer_load_dwordx4 v[228:231], v56, s[16:19], s96 offen offset:256 sc1
    s_mov_b32 s96, 12124160
    buffer_load_dwordx4 v[232:235], v56, s[16:19], s96 offen offset:0 sc1
    buffer_load_dwordx4 v[236:239], v56, s[16:19], s96 offen offset:256 sc1
    s_mov_b32 s96, 12156928
    buffer_load_dwordx4 v[240:243], v56, s[16:19], s96 offen offset:0 sc1
    buffer_load_dwordx4 v[244:247], v56, s[16:19], s96 offen offset:256 sc1
    s_mov_b32 s96, 12058624
    buffer_load_dwordx2 v[248:249], v57, s[16:19], s96 offen offset:0 sc1
    buffer_load_dwordx2 v[252:253], v57, s[16:19], s96 offen offset:128 sc1
    s_mov_b32 s96, 12075008
    buffer_load_dwordx2 v[250:251], v57, s[16:19], s96 offen offset:0 sc1
    buffer_load_dwordx2 v[254:255], v57, s[16:19], s96 offen offset:128 sc1
    s_mov_b32 s96, 9437184
    buffer_load_dwordx4 v[208:211], v59, s[16:19], s96 offen sc1
    s_add_u32 s97, s36, 9437184
    buffer_load_dword v212, v61, s[16:19], s97 offen sc1
    s_mov_b64 exec, -1
    s_waitcnt vmcnt(0) lgkmcnt(0)
    s_branch oe_75
rd_79:
    s_cmp_eq_u32 s38, 0
    s_cbranch_scc1 rc_80
    s_sub_u32 s38, s38, 1
    s_nop 7
    s_nop 7
    s_sleep 4
    s_mov_b64 exec, vcc
    s_mov_b32 s96, 12062720
    buffer_load_dwordx4 v[216:219], v56, s[16:19], s96 offen offset:0 sc1
    buffer_load_dwordx4 v[220:223], v56, s[16:19], s96 offen offset:256 sc1
    s_mov_b32 s96, 12095488
    buffer_load_dwordx4 v[224:227], v56, s[16:19], s96 offen offset:0 sc1
    buffer_load_dwordx4 v[228:231], v56, s[16:19], s96 offen offset:256 sc1
    s_mov_b32 s96, 12128256
    buffer_load_dwordx4 v[232:235], v56, s[16:19], s96 offen offset:0 sc1
    buffer_load_dwordx4 v[236:239], v56, s[16:19], s96 offen offset:256 sc1
    s_mov_b32 s96, 12161024
    buffer_load_dwordx4 v[240:243], v56, s[16:19], s96 offen offset:0 sc1
    buffer_load_dwordx4 v[244:247], v56, s[16:19], s96 offen offset:256 sc1
    s_mov_b32 s96, 12060672
    buffer_load_dwordx2 v[248:249], v57, s[16:19], s96 offen offset:0 sc1
    buffer_load_dwordx2 v[252:253], v57, s[16:19], s96 offen offset:128 sc1
    s_mov_b32 s96, 12077056
    buffer_load_dwordx2 v[250:251], v57, s[16:19], s96 offen offset:0 sc1
    buffer_load_dwordx2 v[254:255], v57, s[16:19], s96 offen offset:128 sc1
    s_mov_b32 s96, 9439232
    buffer_load_dwordx4 v[208:211], v59, s[16:19], s96 offen sc1
    s_add_u32 s97, s36, 9439232
    buffer_load_dword v212, v61, s[16:19], s97 offen sc1
    s_mov_b64 exec, -1
    s_waitcnt vmcnt(0) lgkmcnt(0)
    s_branch oe_78
rd_84:
    s_cmp_eq_u32 s38, 0
    s_cbranch_scc1 rc_85
    s_sub_u32 s38, s38, 1
    s_nop 7
    s_nop 7
    s_sleep 4
    s_mov_b64 exec, vcc
    s_lshl_b32 s96, s75, 14
    s_add_u32 s96, s96, 14680064
    s_lshl_b32 s97, s24, 12
    s_add_u32 s97, s97, 3506176
    buffer_load_dwordx4 v[176:179], v62, s[16:19], s96 offen offset:0 sc1
    buffer_load_dwordx4 v[180:183], v62, s[16:19], s96 offen offset:1024 sc1
    buffer_load_dwordx4 v[184:187], v62, s[16:19], s97 offen offset:0 sc1
    buffer_load_dwordx4 v[188:191], v62, s[16:19], s97 offen offset:1024 sc1
    buffer_load_dwordx4 v[192:195], v62, s[16:19], s97 offen offset:2048 sc1
    buffer_load_dwordx4 v[196:199], v62, s[16:19], s97 offen offset:3072 sc1
    s_mov_b64 exec, -1
    s_waitcnt vmcnt(0) lgkmcnt(0)
    s_branch ce_83
rd_87:
    s_cmp_eq_u32 s38, 0
    s_cbranch_scc1 rc_88
    s_sub_u32 s38, s38, 1
    s_nop 7
    s_nop 7
    s_sleep 4
    s_mov_b64 exec, vcc
    s_lshl_b32 s96, s75, 14
    s_add_u32 s96, s96, 14680064
    s_lshl_b32 s97, s24, 12
    s_add_u32 s97, s97, 3510272
    buffer_load_dwordx4 v[248:251], v62, s[16:19], s96 offen offset:2048 sc1
    buffer_load_dwordx4 v[252:255], v62, s[16:19], s96 offen offset:3072 sc1
    buffer_load_dwordx4 v[96:99], v62, s[16:19], s97 offen offset:0 sc1
    buffer_load_dwordx4 v[100:103], v62, s[16:19], s97 offen offset:1024 sc1
    buffer_load_dwordx4 v[104:107], v62, s[16:19], s97 offen offset:2048 sc1
    buffer_load_dwordx4 v[108:111], v62, s[16:19], s97 offen offset:3072 sc1
    s_mov_b64 exec, -1
    s_waitcnt vmcnt(0) lgkmcnt(0)
    s_branch ce_86
L_last:
    s_endpgm
.section .rodata,"a"
.p2align 6
.amdhsa_kernel interleave_layers__sliding_local_dilated__ssm_conv_s4d__prompt_kernel
  .amdhsa_next_free_vgpr 512
  .amdhsa_next_free_sgpr 102
  .amdhsa_accum_offset 256
  .amdhsa_group_segment_fixed_size 0
  .amdhsa_kernarg_size 104
  .amdhsa_user_sgpr_count 2
  .amdhsa_user_sgpr_kernarg_segment_ptr 1
  .amdhsa_system_sgpr_workgroup_id_x 1
.end_amdhsa_kernel
```

```asm
; @launch grid=(256,1,1) block=(256,1,1) lds=163840
.amdgcn_target "amdgcn-amd-amdhsa--gfx950"
.text
.globl interleave_layers__sliding_local_dilated__ssm_conv_s4d__prompt_kernel
.p2align 8
.type interleave_layers__sliding_local_dilated__ssm_conv_s4d__prompt_kernel,@function
interleave_layers__sliding_local_dilated__ssm_conv_s4d__prompt_kernel:
    s_getpc_b64 s[42:43]
L_start:
    s_cmp_ge_u32 s2, 256
    s_cbranch_scc1 L_end
    s_load_dwordx16 s[44:59], s[0:1], 0
    s_load_dwordx8 s[60:67], s[0:1], 64
    s_load_dwordx2 s[68:69], s[0:1], 96
    v_and_b32 v1, 63, v0
    v_lshrrev_b32 v2, 6, v0
    s_nop 0
    v_readfirstlane_b32 s24, v2
    s_bfe_u32 s82, s2, 0x40003
    s_lshl_b32 s82, s82, 13
    v_lshrrev_b32 v159, 2, v0
    v_lshl_add_u32 v159, v159, 7, s82
    v_min_u32 v159, L_last-L_start, v159
    global_load_dword v159, v159, s[42:43]
    s_and_b32 s25, s2, 7
    s_lshr_b32 s26, s2, 3
    s_and_b32 s27, s26, 3
    s_lshr_b32 s28, s26, 4
    s_lshl_b32 s28, s28, 2
    s_add_u32 s3, s27, s28
    s_lshl_b32 s27, s3, 2
    s_lshr_b32 s70, 0x75206431, s27
    s_and_b32 s70, s70, 7
    s_and_b32 s27, s25, 1
    s_lshl_b32 s27, s27, 3
    s_add_u32 s70, s70, s27
    s_bfe_u32 s71, s26, 0x10002
    s_bfe_u32 s28, s26, 0x10003
    s_and_b32 s72, s25, 6
    s_add_u32 s72, s72, s28
    s_and_b32 s73, s26, 7
    s_lshr_b32 s28, s26, 3
    s_lshl_b32 s74, s25, 2
    s_add_u32 s74, s74, s28
    s_mul_i32 s75, s25, 20
    s_add_u32 s75, s75, s26
    s_min_u32 s27, s2, 239
    s_mul_i32 s25, s27, 10923
    s_lshr_b32 s25, s25, 16
    s_mul_i32 s26, s25, 6
    s_sub_u32 s26, s27, s26
    s_mul_i32 s27, s25, 61440
    s_mul_i32 s28, s26, 640
    s_add_u32 s27, s27, s28
    s_lshl_b32 s28, s24, 10
    v_add_u32 v85, 0, v0
    v_mul_u32_u24 v84, 1639, v85
    v_lshrrev_b32 v84, 16, v84
    v_mul_u32_u24 v84, 3200, v84
    v_lshl_add_u32 v85, v85, 4, v84
    v_add_u32 v86, 256, v0
    v_mul_u32_u24 v84, 1639, v86
    v_lshrrev_b32_e64 v84, 16, v84
    v_mul_u32_u24 v84, 3200, v84
    v_lshl_add_u32 v86, v86, 4, v84
    v_add_u32 v87, 512, v0
    v_min_u32 v87, 639, v87
    v_mul_u32_u24 v84, 1639, v87
    v_lshrrev_b32_e64 v84, 16, v84
    v_mul_u32_u24 v84, 3200, v84
    v_lshl_add_u32 v87, v87, 4, v84
    s_mov_b32 s76, 0
    s_mov_b32 s77, 0x80000000
    s_mov_b32 s80, -1
    s_mov_b32 s81, 0
    s_nop 0
    s_mov_b32 s78, 0xfe0000fe
    s_mov_b32 s79, 0xfe0000fe
    s_mov_b32 s6, 2621440
    s_mov_b32 s7, 0x20000
    s_mov_b32 s10, 2457600
    s_mov_b32 s11, 0x20000
    s_mov_b32 s14, 819200
    s_mov_b32 s15, 0x20000
    s_mov_b32 s18, 22061056
    s_mov_b32 s19, 0x20000
    s_mov_b32 s22, 2621440
    s_mov_b32 s23, 0x20000
    s_waitcnt lgkmcnt(0)
    s_mov_b32 s4, s44
    s_and_b32 s5, s45, 0xffff
    s_mov_b32 s8, s46
    s_and_b32 s9, s47, 0xffff
    s_mov_b32 s12, s48
    s_and_b32 s13, s49, 0xffff
    s_mov_b32 s16, s68
    s_and_b32 s17, s69, 0xffff
    s_mov_b32 s20, s64
    s_and_b32 s21, s65, 0xffff
    s_cmp_lg_u32 s2, 255
    s_cbranch_scc1 fz_1
    v_mov_b32 v120, 0
    v_mov_b32 v121, 0
    v_mov_b32 v122, 0
    v_mov_b32 v123, 0
    v_lshlrev_b32 v124, 4, v0
    s_mov_b32 s88, 3538944
    buffer_store_dwordx4 v[120:123], v124, s[16:19], s88 offen sc1
    s_mov_b32 s88, 3543040
    buffer_store_dwordx4 v[120:123], v124, s[16:19], s88 offen sc1
    s_mov_b32 s88, 3547136
    buffer_store_dwordx4 v[120:123], v124, s[16:19], s88 offen sc1
    s_mov_b32 s88, 3555328
    buffer_store_dwordx4 v[120:123], v124, s[16:19], s88 offen sc1
    s_mov_b32 s88, 3559424
    buffer_store_dwordx4 v[120:123], v124, s[16:19], s88 offen sc1
    s_mov_b32 s88, 3563520
    buffer_store_dwordx4 v[120:123], v124, s[16:19], s88 offen sc1
fz_1:
    s_min_u32 s96, s75, 159
    s_lshl_b32 s96, s96, 2
    s_add_u32 s96, s96, s24
    s_mul_i32 s97, s96, 384
    s_lshl_b32 s96, s96, 1
    v_lshl_add_u32 v2, v1, 2, s97
    v_mov_b32 v241, s96
    global_load_dword v232, v2, s[52:53]
    global_load_dword v233, v2, s[54:55]
    global_load_dword v234, v2, s[56:57]
    global_load_dword v235, v2, s[58:59]
    global_load_ushort v240, v241, s[60:61]
    s_add_u32 m0, s28, 134272
    s_nop 0
    buffer_load_dwordx4 v85, s[8:11], s27 offen lds
    s_add_u32 m0, s28, 138368
    s_nop 0
    buffer_load_dwordx4 v86, s[8:11], s27 offen lds
    s_add_u32 m0, s28, 142464
    s_nop 0
    buffer_load_dwordx4 v87, s[8:11], s27 offen lds
    s_lshr_b32 s29, s26, 1
    s_and_b32 s30, s26, 1
    s_lshl_b32 s30, s30, 3
    s_lshl_b32 s31, s25, 10
    s_add_u32 s31, s31, 0
    s_cmp_ge_u32 s2, 240
    s_cselect_b32 s31, 1073741824, s31
    v_bfe_u32 v93, v0, 2, 2
    v_bfe_u32 v92, v0, 1, 1
    v_lshl_add_u32 v92, v92, 3, v93
    v_mul_u32_u24 v92, 640, v92
    v_and_b32 v93, 1, v0
    v_mul_u32_u24 v93, 40, v93
    v_add_u32 v91, v92, v93
    v_add_u32 v91, 134272, v91
    v_lshrrev_b32 v88, 4, v0
    v_add_u32 v88, 0, v88
    v_cmp_gt_u32 vcc, 40, v88
    v_min_u32 v88, 39, v88
    v_mul_u32_u24 v89, 13108, v88
    v_lshrrev_b32 v89, 16, v89
    v_mul_u32_u24 v90, 5, v89
    v_sub_u32_e64 v90, v88, v90
    v_mul_u32_u24 v92, 80, v89
    v_lshl_add_u32 v92, v90, 3, v92
    v_add_u32 v111, v92, v91
    v_add_u32 v89, s30, v89
    v_cmp_eq_u32 s[82:83], 4, v90
    v_mov_b32 v92, s29
    s_nop 0
    v_cndmask_b32 v93, v90, v92, s[82:83]
    v_cndmask_b32 v92, v92, 3, s[82:83]
    v_lshl_add_u32 v89, v89, 2, v93
    v_mul_u32_u24 v89, 40960, v89
    v_lshl_add_u32 v89, v92, 8, v89
    v_and_b32 v92, 15, v0
    v_lshl_add_u32 v89, v92, 4, v89
    v_mov_b32 v92, 1073741824
    v_cndmask_b32 v89, v92, v89, vcc
    v_add_u32 v108, s31, v89
    v_lshrrev_b32 v88, 4, v0
    v_add_u32 v88, 16, v88
    v_cmp_gt_u32 vcc, 40, v88
    v_min_u32 v88, 39, v88
    v_mul_u32_u24 v89, 13108, v88
    v_lshrrev_b32 v89, 16, v89
    v_mul_u32_u24 v90, 5, v89
    v_sub_u32_e64 v90, v88, v90
    v_mul_u32_u24 v92, 80, v89
    v_lshl_add_u32 v92, v90, 3, v92
    v_add_u32 v112, v92, v91
    v_add_u32 v89, s30, v89
    v_cmp_eq_u32 s[82:83], 4, v90
    v_mov_b32 v92, s29
    s_nop 0
    v_cndmask_b32 v93, v90, v92, s[82:83]
    v_cndmask_b32 v92, v92, 3, s[82:83]
    v_lshl_add_u32 v89, v89, 2, v93
    v_mul_u32_u24 v89, 40960, v89
    v_lshl_add_u32 v89, v92, 8, v89
    v_and_b32 v92, 15, v0
    v_lshl_add_u32 v89, v92, 4, v89
    v_mov_b32 v92, 1073741824
    v_cndmask_b32 v89, v92, v89, vcc
    v_add_u32 v109, s31, v89
    v_lshrrev_b32 v88, 4, v0
    v_add_u32 v88, 32, v88
    v_cmp_gt_u32 vcc, 40, v88
    v_min_u32 v88, 39, v88
    v_mul_u32_u24 v89, 13108, v88
    v_lshrrev_b32 v89, 16, v89
    v_mul_u32_u24 v90, 5, v89
    v_sub_u32_e64 v90, v88, v90
    v_mul_u32_u24 v92, 80, v89
    v_lshl_add_u32 v92, v90, 3, v92
    v_add_u32 v113, v92, v91
    v_add_u32 v89, s30, v89
    v_cmp_eq_u32 s[82:83], 4, v90
    v_mov_b32 v92, s29
    s_nop 0
    v_cndmask_b32 v93, v90, v92, s[82:83]
    v_cndmask_b32 v92, v92, 3, s[82:83]
    v_lshl_add_u32 v89, v89, 2, v93
    v_mul_u32_u24 v89, 40960, v89
    v_lshl_add_u32 v89, v92, 8, v89
    v_and_b32 v92, 15, v0
    v_lshl_add_u32 v89, v92, 4, v89
    v_mov_b32 v92, 1073741824
    v_cndmask_b32 v89, v92, v89, vcc
    v_add_u32 v110, s31, v89
    s_mul_i32 s25, s3, 18
    s_lshl_b32 s26, s72, 7
    s_add_u32 s25, s25, s26
    s_add_u32 s25, s25, s71
    s_add_u32 s25, s25, -16
    s_max_i32 s25, s25, 0
    s_mul_i32 s25, s25, 1280
    v_lshrrev_b32_e64 v204, 1, v0
    v_min_u32 v204, 89, v204
    v_mul_u32_u24 v205, 6554, v204
    v_lshrrev_b32_e64 v205, 16, v205
    v_mul_u32_u24 v205, 1280, v205
    v_lshl_add_u32 v204, v204, 7, v205
    buffer_load_dword v204, v204, s[4:7], s25 offen
    s_and_b32 s25, s2, 7
    s_lshl_b32 s86, s25, 7
    s_add_u32 s86, s86, 3538944
    s_lshl_b32 s87, s25, 10
    s_add_u32 s87, s87, 3538944
    s_add_u32 s89, s87, 16384
    v_cmp_gt_u32 s[50:51], 8, v0
    v_cmp_eq_u32 vcc, 0, v0
    v_lshlrev_b32 v4, 7, v1
    v_mov_b32 v6, 1073741824
    v_cndmask_b32 v4, v6, v4, s[50:51]
    v_cndmask_b32 v6, v6, 0, vcc
    v_mov_b32 v5, 0
    s_cmp_lg_u32 s2, 255
    s_cbranch_scc1 fr_2
    v_mov_b32 v2, 1
    s_waitcnt vmcnt(9)
    s_barrier
    s_mov_b64 exec, 1
    global_store_dword v5, v2, s[66:67] sc1
    s_mov_b64 exec, -1
fr_2:
    v_mov_b32 v140, 0
    v_mov_b32_e64 v141, 0
    v_mov_b32 v142, 0x3f803f80
    v_mov_b32 v143, 0x3f803f80
    v_lshlrev_b32_e64 v144, 3, v0
    v_add_u32 v144, 155648, v144
    ds_write_b64 v144, v[140:141]
    ds_write_b64 v144, v[142:143] offset:2048
    v_and_b32 v50, 31, v1
    v_lshrrev_b32 v51, 5, v1
    v_mul_u32_u24 v52, 40, v50
    v_mul_u32_u24 v53, 3200, v51
    v_add_u32 v53, v52, v53
    s_lshl_b32 s25, s24, 3
    s_add_u32 s25, s25, 320
    v_add_u32 v38, s25, v53
    s_mul_i32 s25, s24, 6400
    s_add_u32 s25, s25, 352
    v_add_u32 v39, s25, v53
    s_lshl_b32 s31, s71, 12
    v_lshl_add_u32 v47, v50, 3, s31
    v_bfe_u32 v52, v1, 2, 1
    v_and_b32 v53, 3, v1
    v_lshlrev_b32 v54, 13, v52
    v_lshl_add_u32 v54, v53, 3, v54
    v_add_u32_e64 v48, s31, v54
    v_bfe_u32 v54, v1, 4, 1
    v_lshl_add_u32 v52, v54, 1, v52
    v_mul_u32_u24 v52, 40, v52
    v_add_u32 v52, v52, v53
    v_mul_u32_u24_e64 v52, 40, v52
    v_bfe_u32 v53, v1, 3, 1
    v_cmp_eq_u32 s[82:83], v53, v54
    v_lshl_add_u32 v53, v53, 1, v51
    v_cmp_eq_u32 vcc, 3, v53
    v_mov_b32 v54, s24
    s_nop 0
    v_cndmask_b32 v53, v53, v54, vcc
    v_cndmask_b32 v54, v54, 4, vcc
    v_mul_u32_u24 v53, 6400, v53
    v_lshl_add_u32 v52, v54, 3, v52
    v_add_u32_e64 v52, v52, v53
    v_add_u32 v40, 160, v52
    v_mov_b32 v52, 19584
    v_cndmask_b32 v49, 0, v52, s[78:79]
    v_and_b32 v50, 15, v1
    v_lshrrev_b32 v51, 4, v1
    s_and_b32 s25, s24, 1
    s_and_b32 s26, s24, 2
    s_mul_i32 s27, s25, 3200
    s_mul_i32 s28, s26, 320
    s_add_u32 s27, s27, s28
    s_add_u32 s27, s27, 0
    v_and_b32 v52, 1, v1
    v_mul_u32_u24 v52, 1600, v52
    v_lshrrev_b32 v53, 1, v50
    v_mul_u32_u24_e64 v54, 40, v53
    v_add3_u32 v52, v52, v54, s27
    v_lshl_add_u32 v41, v51, 3, v52
    v_add_u32_e64 v42, 32, v52
    v_bfe_u32 v52, v1, 2, 1
    v_mul_u32_u24 v52, 1600, v52
    v_lshrrev_b32 v54, 3, v1
    v_mul_u32_u24 v54, 40, v54
    v_add3_u32 v52, v52, v54, s27
    v_add_u32 v52, 12800, v52
    v_and_b32 v54, 3, v1
    v_lshl_add_u32 v43, v54, 3, v52
    v_add_u32 v52, 32, v52
    v_cmp_eq_u32 vcc, 0, v54
    v_mov_b32 v54, 157696
    s_nop 0
    v_cndmask_b32 v44, v54, v52, vcc
    v_and_b32 v52, 1, v51
    v_add_u32 v52, s26, v52
    v_lshrrev_b32 v54, 2, v50
    v_lshl_add_u32 v52, v52, 2, v54
    v_and_b32 v53, 1, v53
    v_lshl_add_u32 v52, v53, 4, v52
    v_and_b32 v53, 1, v50
    v_lshl_add_u32 v52, v53, 10, v52
    s_lshl_b32 s30, s70, 1
    s_add_u32 s30, s30, s25
    s_lshl_b32 s29, s30, 3
    s_add_u32 s29, s29, s71
    s_lshl_b32 s29, s29, 13
    v_lshrrev_b32 v53, 1, v51
    v_lshlrev_b32 v53, 15, v53
    v_lshl_add_u32 v53, v52, 4, v53
    v_add_u32_e64 v45, s29, v53
    s_lshl_b32 s29, s30, 2
    s_add_u32 s29, s29, s71
    s_lshl_b32 s29, s29, 12
    s_add_u32 s29, s29, 2097152
    v_lshl_add_u32 v46, v52, 3, s29
    s_or_b32 s29, s26, s72
    s_cmp_eq_u32 s29, 0
    s_cselect_b64 s[90:91], -1, 0
    v_lshlrev_b32 v52, 2, v51
    v_sub_u32 v52, v50, v52
    v_mov_b32 v55, 0xf149f2ca
    v_subrev_u32 v53, 0, v52
    v_cmp_lt_u32 vcc, 7, v53
    s_nop 1
    v_cndmask_b32 v28, 0, v55, vcc
    v_cmp_lt_i32 vcc, -9, v53
    s_nop 1
    v_cndmask_b32 v32, 0, v55, vcc
    v_cmp_le_i32 vcc, 0, v53
    v_mov_b32 v54, 0xffff
    s_nop 0
    v_cndmask_b32 v54, 0, v54, vcc
    v_mov_b32 v36, v54
    v_subrev_u32 v53, 1, v52
    v_cmp_lt_u32 vcc, 7, v53
    s_nop 1
    v_cndmask_b32 v29, 0, v55, vcc
    v_cmp_lt_i32 vcc, -9, v53
    s_nop 1
    v_cndmask_b32 v33, 0, v55, vcc
    v_cmp_le_i32 vcc, 0, v53
    v_mov_b32 v54, 0xffff0000
    s_nop 0
    v_cndmask_b32 v54, 0, v54, vcc
    v_or_b32 v36, v36, v54
    v_subrev_u32 v53, 2, v52
    v_cmp_lt_u32 vcc, 7, v53
    s_nop 1
    v_cndmask_b32 v30, 0, v55, vcc
    v_cmp_lt_i32 vcc, -9, v53
    s_nop 1
    v_cndmask_b32 v34, 0, v55, vcc
    v_cmp_le_i32 vcc, 0, v53
    v_mov_b32 v54, 0xffff
    s_nop 0
    v_cndmask_b32 v54, 0, v54, vcc
    v_mov_b32 v37, v54
    v_subrev_u32 v53, 3, v52
    v_cmp_lt_u32 vcc, 7, v53
    s_nop 1
    v_cndmask_b32 v31, 0, v55, vcc
    v_cmp_lt_i32 vcc, -9, v53
    s_nop 1
    v_cndmask_b32 v35, 0, v55, vcc
    v_cmp_le_i32 vcc, 0, v53
    v_mov_b32 v54, 0xffff0000
    s_nop 0
    v_cndmask_b32 v54, 0, v54, vcc
    v_or_b32 v37, v37, v54
    v_and_b32 v62, 15, v1
    v_lshrrev_b32 v63, 4, v1
    s_and_b32 s25, s74, 3
    s_lshr_b32 s26, s74, 2
    s_lshl_b32 s27, s24, 6
    s_add_u32 s27, s27, s25
    s_lshl_b32 s27, s27, 13
    s_lshl_b32 s28, s26, 9
    s_add_u32 s27, s27, s28
    v_lshl_add_u32 v64, v63, 17, s27
    v_lshl_add_u32 v56, v62, 4, v64
    s_lshl_b32 s27, s24, 5
    s_add_u32 s27, s27, s25
    s_lshl_b32 s27, s27, 12
    s_lshl_b32 s28, s26, 8
    s_add_u32 s27, s27, s28
    s_add_u32 s27, s27, 2097152
    v_lshl_add_u32 v64, v63, 15, s27
    v_lshl_add_u32 v57, v62, 3, v64
    v_lshlrev_b32 v58, 4, v1
    s_lshl_b32 s29, s25, 12
    s_add_u32 s29, s29, s28
    v_lshl_add_u32 v64, v62, 4, s29
    v_lshl_add_u32 v61, v63, 2, v64
    s_mul_i32 s30, s73, 20
    s_lshl_b32 s31, s24, 2
    s_add_u32 s30, s30, s31
    s_lshl_b32 s31, s30, 14
    v_lshl_add_u32 v64, v63, 14, v64
    v_add_u32 v59, s31, v64
    s_lshl_b32 s31, s26, 7
    s_add_u32 s31, s31, s25
    s_mul_i32 s31, s31, 1280
    s_lshl_b32 s30, s30, 3
    s_add_u32 s31, s31, s30
    v_mul_u32_u24 v64, 10240, v62
    v_lshl_add_u32 v64, v63, 3, v64
    v_add_u32_e64 v60, s31, v64
    s_lshl_b32 s25, s24, 12
    v_lshl_add_u32 v62, v1, 4, s25
    s_mul_i32 s25, s24, 1216
    s_add_u32 s25, s25, 192
    v_lshl_add_u32 v63, v1, 2, s25
    s_mul_i32 s25, s24, 4864
    s_add_u32 s25, s25, 80
    v_and_b32_e64 v70, 3, v1
    v_mul_u32_u24 v70, 1216, v70
    v_bfe_u32 v71, v1, 2, 3
    v_lshl_add_u32 v70, v71, 4, v70
    v_lshrrev_b32 v71, 5, v1
    v_lshl_add_u32 v70, v71, 4, v70
    v_add_u32 v64, s25, v70
    s_mul_i32 s25, s24, 4160
    s_add_u32 s25, s25, 134368
    v_lshlrev_b32 v71, 6, v71
    v_sub_u32 v71, s25, v71
    v_bfe_u32 v70, v1, 4, 1
    v_lshl_add_u32 v71, v70, 5, v71
    v_and_b32_e64 v70, 3, v1
    v_lshl_add_u32 v71, v70, 3, v71
    v_bfe_u32 v70, v1, 2, 2
    v_lshlrev_b32 v70, 3, v70
    v_sub_u32 v65, v71, v70
    s_mul_i32 s25, s24, 4224
    s_add_u32 s25, s25, 19456
    v_and_b32 v70, 3, v1
    v_mul_u32_u24 v70, 1056, v70
    v_and_b32 v71, 60, v1
    v_add3_u32 v66, v70, v71, s25
    s_mul_i32 s25, s24, 1056
    s_add_u32 s25, s25, 19456
    v_lshl_add_u32 v67, v1, 3, s25
    s_mul_i32 s25, s24, 1280
    s_lshl_b32 s26, s75, 3
    s_add_u32 s25, s25, s26
    v_mul_u32_u24 v70, 10240, v1
    v_add_u32 v68, s25, v70
    s_and_b32 s25, s24, 1
    s_lshl_b32 s25, s25, 6
    s_and_b32 s26, s24, 2
    s_add_u32 s25, s25, s26
    s_mul_i32 s25, s25, 1280
    v_lshrrev_b32 v140, 4, v1
    v_and_b32 v141, 15, v1
    v_xor_b32 v141, v140, v141
    v_lshlrev_b32_e64 v141, 4, v141
    v_mul_u32_u24 v142, 5120, v140
    v_add3_u32 v73, v141, v142, s25
    s_and_b32 s25, s24, 1
    s_lshl_b32 s25, s25, 3
    s_add_u32 s25, s25, s26
    s_mul_i32 s25, s25, 1280
    v_add3_u32 v77, v141, v142, s25
    v_lshrrev_b32 v141, 5, v1
    v_and_b32 v140, 3, v1
    v_xor_b32 v142, v140, v141
    v_lshlrev_b32_e64 v142, 4, v142
    v_lshl_add_u32 v142, v140, 8, v142
    v_bfe_u32 v140, v1, 2, 3
    v_mul_u32_u24 v140, 1088, v140
    v_add_u32 v78, v140, v142
    v_and_b32 v140, 1, v1
    v_xor_b32 v142, v140, v141
    v_lshlrev_b32 v142, 4, v142
    v_lshl_add_u32 v142, v140, 8, v142
    v_bfe_u32 v140, v1, 1, 2
    v_mul_u32_u24 v140, 544, v140
    v_add_u32_e64 v142, v140, v142
    v_add_u32 v74, 19392, v73
    v_add_u32 v75, 38784, v73
    v_add_u32 v76, 58176, v73
    v_add_u32 v142, 53760, v142
    v_and_b32 v140, 31, v1
    v_cmp_eq_u32 vcc, 0, v140
    v_cmp_eq_u32 s[82:83], 24, v140
    s_nop 0
    s_or_b64 vcc, vcc, s[82:83]
    v_mov_b32 v140, 155648
    v_mov_b32 v141, 157696
    v_cndmask_b32_e64 v140, v140, v141, vcc
    v_cndmask_b32 v79, v140, v142, s[78:79]
    v_bfe_u32 v201, v1, 3, 2
    v_and_b32 v202, s24, v201
    v_cmp_eq_u32 vcc, 3, v202
    v_lshrrev_b32 v202, 5, v1
    v_lshl_add_u32 v201, v201, 1, v202
    v_and_b32 v202, 7, v1
    v_lshl_add_u32 v201, v201, 3, v202
    v_lshlrev_b32 v200, 4, v201
    v_mov_b32 v201, 1073741824
    v_cndmask_b32 v200, v200, v201, vcc
    s_lshl_b32 s101, s70, 2
    s_add_u32 s101, s101, s24
    s_mul_i32 s101, s101, 40960
    s_add_u32 s101, s101, 0
    s_lshl_b32 s25, s72, 5
    s_add_u32 s25, s25, 0
    s_sub_u32 s26, s25, 4
    s_max_i32 s26, s26, 0
    s_mul_i32 s27, s71, 1280
    s_mul_i32 s99, s25, 5120
    s_mul_i32 s100, s26, 5120
    s_mul_i32 s92, s24, 4352
    s_mul_i32 s93, s24, 544
    s_add_u32 s99, s99, s27
    s_add_u32 s100, s100, s27
    s_mov_b32 s38, 0x10000
    s_mov_b32 s39, 0x1000
    s_cmp_ge_u32 s2, 160
    s_cbranch_scc1 nc_3
    s_mul_i32 s37, s24, 8704
    s_add_u32 s25, s37, 0
    s_add_u32 s37, s37, 0
    s_mov_b32 m0, s37
    v_and_b32 v199, 31, v1
    v_mul_u32_u24 v199, 272, v199
    v_lshrrev_b32 v215, 5, v1
    v_lshl_add_u32 v199, v215, 4, v199
    v_add_u32 v252, s25, v199
    s_waitcnt vmcnt(4)
    v_lshlrev_b32 v253, 16, v240
    v_mul_f32 v253, 0x3fb8aa3b, v253
    v_exp_f32 v253, v253
    s_nop 0
    v_cvt_pk_bf16_f32 v253, v253, v253
    v_lshlrev_b32 v253, 16, v253
    v_lshlrev_b32 v199, 16, v232
    v_mul_f32 v199, 0x3fb8aa3b, v199
    v_exp_f32 v199, v199
    v_lshlrev_b32 v255, 16, v233
    v_mul_f32 v255, v255, v253
    v_mul_f32 v255, 0x3e22f983, v255
    v_cvt_pk_bf16_f32 v199, v199, v199
    v_lshlrev_b32 v199, 16, v199
    v_mul_f32_e64 v254, v199, v253
    v_mul_f32 v254, 0xbfb8aa3b, v254
    v_mul_f32 v182, 0x41000000, v254
    v_mul_f32 v185, 0x41000000, v255
    v_mul_f32 v184, 0x43800000, v254
    v_mul_f32 v189, 0x43800000, v255
    v_fract_f32 v185, v185
    v_fract_f32 v188, v255
    s_waitcnt vmcnt(1)
    s_barrier
    ds_read_b64_tr_b16 v[96:97], v111
    ds_read_b64_tr_b16 v[98:99], v111 offset:2560
    ds_read_b64_tr_b16 v[100:101], v112
    ds_read_b64_tr_b16 v[102:103], v112 offset:2560
    ds_read_b64_tr_b16 v[104:105], v113
    ds_read_b64_tr_b16 v[106:107], v113 offset:2560
    s_waitcnt lgkmcnt(4)
    buffer_store_dwordx4 v[96:99], v108, s[16:19], 0 offen sc1
    s_waitcnt lgkmcnt(2)
    buffer_store_dwordx4 v[100:103], v109, s[16:19], 0 offen sc1
    s_waitcnt lgkmcnt(0)
    buffer_store_dwordx4 v[104:107], v110, s[16:19], 0 offen sc1
    global_load_dword v7, v5, s[66:67] sc1
    v_fract_f32 v189, v189
    v_exp_f32 v182, v182
    v_exp_f32 v183, v254
    v_exp_f32 v184, v184
    v_cos_f32 v186, v185
    v_sin_f32 v187, v185
    v_cos_f32 v180, v188
    v_sin_f32 v181, v188
    v_cos_f32 v190, v189
    v_sin_f32 v191, v189
    v_lshlrev_b32 v192, 16, v234
    v_lshlrev_b32 v193, 16, v235
    v_add_f32 v199, v253, v253
    v_mul_f32 v192, v192, v199
    v_mul_f32 v193, v193, v199
    v_mul_f32 v186, v186, v182
    v_mul_f32 v187, v187, v182
    v_mul_f32 v180, v180, v183
    v_mul_f32 v181, v181, v183
    v_mul_f32 v190, v190, v184
    v_mul_f32 v191, v191, v184
    v_mov_b32 v242, 0x3f80
    v_cvt_pk_bf16_f32 v243, v186, v187
    v_pk_mul_f32 v[194:195], v[186:187], v[186:187] op_sel:[0,0] op_sel_hi:[0,1]
    v_pk_fma_f32 v[172:173], v[186:187], v[186:187], v[194:195] op_sel:[1,1,0] op_sel_hi:[1,0,1] neg_lo:[0,1,0]
    v_cvt_pk_bf16_f32 v244, v172, v173
    v_pk_mul_f32 v[194:195], v[172:173], v[186:187] op_sel:[0,0] op_sel_hi:[0,1]
    v_pk_fma_f32 v[174:175], v[172:173], v[186:187], v[194:195] op_sel:[1,1,0] op_sel_hi:[1,0,1] neg_lo:[0,1,0]
    v_cvt_pk_bf16_f32 v245, v174, v175
    v_pk_mul_f32 v[194:195], v[174:175], v[186:187] op_sel:[0,0] op_sel_hi:[0,1]
    v_pk_fma_f32 v[172:173], v[174:175], v[186:187], v[194:195] op_sel:[1,1,0] op_sel_hi:[1,0,1] neg_lo:[0,1,0]
    v_cvt_pk_bf16_f32 v246, v172, v173
    v_pk_mul_f32 v[194:195], v[172:173], v[186:187] op_sel:[0,0] op_sel_hi:[0,1]
    v_pk_fma_f32 v[174:175], v[172:173], v[186:187], v[194:195] op_sel:[1,1,0] op_sel_hi:[1,0,1] neg_lo:[0,1,0]
    v_cvt_pk_bf16_f32 v247, v174, v175
    v_pk_mul_f32 v[194:195], v[174:175], v[186:187] op_sel:[0,0] op_sel_hi:[0,1]
    v_pk_fma_f32 v[172:173], v[174:175], v[186:187], v[194:195] op_sel:[1,1,0] op_sel_hi:[1,0,1] neg_lo:[0,1,0]
    v_cvt_pk_bf16_f32 v248, v172, v173
    v_pk_mul_f32 v[194:195], v[172:173], v[186:187] op_sel:[0,0] op_sel_hi:[0,1]
    v_pk_fma_f32 v[174:175], v[172:173], v[186:187], v[194:195] op_sel:[1,1,0] op_sel_hi:[1,0,1] neg_lo:[0,1,0]
    s_min_u32 s96, s75, 159
    s_lshl_b32 s96, s96, 2
    s_add_u32 s96, s96, s24
    s_mul_i32 s97, s96, 384
    s_lshl_b32 s96, s96, 1
    v_lshl_add_u32 v2, v1, 1, s97
    v_mov_b32 v241, s96
    global_load_ushort v236, v2, s[52:53] offset:256
    global_load_ushort v237, v2, s[54:55] offset:256
    global_load_ushort v238, v2, s[56:57] offset:256
    global_load_ushort v239, v2, s[58:59] offset:256
    global_load_ushort v241, v241, s[62:63]
    v_cvt_pk_bf16_f32 v249, v174, v175
    v_pk_mul_f32 v[194:195], v[174:175], v[186:187] op_sel:[0,0] op_sel_hi:[0,1]
    v_pk_fma_f32 v[172:173], v[174:175], v[186:187], v[194:195] op_sel:[1,1,0] op_sel_hi:[1,0,1] neg_lo:[0,1,0]
    v_cvt_pk_bf16_f32 v250, v172, v173
    v_pk_mul_f32 v[194:195], v[172:173], v[186:187] op_sel:[0,0] op_sel_hi:[0,1]
    v_pk_fma_f32 v[174:175], v[172:173], v[186:187], v[194:195] op_sel:[1,1,0] op_sel_hi:[1,0,1] neg_lo:[0,1,0]
    v_cvt_pk_bf16_f32 v251, v174, v175
    ds_write_addtid_b32 v242 offset:0
    ds_write_addtid_b32 v243 offset:272
    ds_write_addtid_b32 v244 offset:544
    ds_write_addtid_b32 v245 offset:816
    ds_write_addtid_b32 v246 offset:1088
    ds_write_addtid_b32 v247 offset:1360
    ds_write_addtid_b32 v248 offset:1632
    ds_write_addtid_b32 v249 offset:1904
    ds_write_addtid_b32 v250 offset:2176
    ds_write_addtid_b32 v251 offset:2448
    v_pk_mul_f32 v[194:195], v[174:175], v[186:187] op_sel:[0,0] op_sel_hi:[0,1]
    v_pk_fma_f32 v[172:173], v[174:175], v[186:187], v[194:195] op_sel:[1,1,0] op_sel_hi:[1,0,1] neg_lo:[0,1,0]
    v_cvt_pk_bf16_f32 v242, v172, v173
    v_pk_mul_f32 v[194:195], v[172:173], v[186:187] op_sel:[0,0] op_sel_hi:[0,1]
    v_pk_fma_f32 v[174:175], v[172:173], v[186:187], v[194:195] op_sel:[1,1,0] op_sel_hi:[1,0,1] neg_lo:[0,1,0]
    v_cvt_pk_bf16_f32 v243, v174, v175
    v_pk_mul_f32 v[194:195], v[174:175], v[186:187] op_sel:[0,0] op_sel_hi:[0,1]
    v_pk_fma_f32 v[172:173], v[174:175], v[186:187], v[194:195] op_sel:[1,1,0] op_sel_hi:[1,0,1] neg_lo:[0,1,0]
    v_cvt_pk_bf16_f32 v244, v172, v173
    v_pk_mul_f32 v[194:195], v[172:173], v[186:187] op_sel:[0,0] op_sel_hi:[0,1]
    v_pk_fma_f32 v[174:175], v[172:173], v[186:187], v[194:195] op_sel:[1,1,0] op_sel_hi:[1,0,1] neg_lo:[0,1,0]
    v_cvt_pk_bf16_f32 v245, v174, v175
    v_pk_mul_f32 v[194:195], v[174:175], v[186:187] op_sel:[0,0] op_sel_hi:[0,1]
    v_pk_fma_f32 v[172:173], v[174:175], v[186:187], v[194:195] op_sel:[1,1,0] op_sel_hi:[1,0,1] neg_lo:[0,1,0]
    v_cvt_pk_bf16_f32 v246, v172, v173
    v_pk_mul_f32 v[194:195], v[172:173], v[186:187] op_sel:[0,0] op_sel_hi:[0,1]
    v_pk_fma_f32 v[174:175], v[172:173], v[186:187], v[194:195] op_sel:[1,1,0] op_sel_hi:[1,0,1] neg_lo:[0,1,0]
    v_cvt_pk_bf16_f32 v247, v174, v175
    v_pk_mul_f32 v[194:195], v[174:175], v[186:187] op_sel:[0,0] op_sel_hi:[0,1]
    v_pk_fma_f32 v[172:173], v[174:175], v[186:187], v[194:195] op_sel:[1,1,0] op_sel_hi:[1,0,1] neg_lo:[0,1,0]
    v_cvt_pk_bf16_f32 v248, v172, v173
    v_pk_mul_f32 v[194:195], v[172:173], v[186:187] op_sel:[0,0] op_sel_hi:[0,1]
    v_pk_fma_f32 v[174:175], v[172:173], v[186:187], v[194:195] op_sel:[1,1,0] op_sel_hi:[1,0,1] neg_lo:[0,1,0]
    v_lshrrev_b32 v132, 5, v0
    v_and_b32 v133, 31, v0
    v_mul_u32_u24 v132, 1280, v132
    v_lshl_add_u32 v134, v133, 4, v132
    v_mov_b32 v135, 1073741824
    v_cmp_gt_u32 vcc, 16, v133
    s_mul_i32 s96, s2, 10240
    buffer_load_dwordx4 v[120:123], v134, s[4:7], s96 offen
    v_cndmask_b32_e64 v135, v135, v134, vcc
    buffer_load_dwordx4 v[124:127], v134, s[4:7], s96 offen offset:512
    buffer_load_dwordx4 v[128:131], v135, s[4:7], s96 offen offset:1024
    v_cvt_pk_bf16_f32 v249, v174, v175
    v_pk_mul_f32 v[194:195], v[174:175], v[186:187] op_sel:[0,0] op_sel_hi:[0,1]
    v_pk_fma_f32 v[172:173], v[174:175], v[186:187], v[194:195] op_sel:[1,1,0] op_sel_hi:[1,0,1] neg_lo:[0,1,0]
    v_cvt_pk_bf16_f32 v250, v172, v173
    v_pk_mul_f32 v[194:195], v[172:173], v[186:187] op_sel:[0,0] op_sel_hi:[0,1]
    v_pk_fma_f32 v[174:175], v[172:173], v[186:187], v[194:195] op_sel:[1,1,0] op_sel_hi:[1,0,1] neg_lo:[0,1,0]
    v_cvt_pk_bf16_f32 v251, v174, v175
    ds_write_addtid_b32 v242 offset:2720
    ds_write_addtid_b32 v243 offset:2992
    ds_write_addtid_b32 v244 offset:3264
    ds_write_addtid_b32 v245 offset:3536
    ds_write_addtid_b32 v246 offset:3808
    ds_write_addtid_b32 v247 offset:4080
    ds_write_addtid_b32 v248 offset:4352
    ds_write_addtid_b32 v249 offset:4624
    ds_write_addtid_b32 v250 offset:4896
    ds_write_addtid_b32 v251 offset:5168
    v_pk_mul_f32 v[194:195], v[174:175], v[186:187] op_sel:[0,0] op_sel_hi:[0,1]
    v_pk_fma_f32 v[172:173], v[174:175], v[186:187], v[194:195] op_sel:[1,1,0] op_sel_hi:[1,0,1] neg_lo:[0,1,0]
    v_cvt_pk_bf16_f32 v242, v172, v173
    v_pk_mul_f32 v[194:195], v[172:173], v[186:187] op_sel:[0,0] op_sel_hi:[0,1]
    v_pk_fma_f32 v[174:175], v[172:173], v[186:187], v[194:195] op_sel:[1,1,0] op_sel_hi:[1,0,1] neg_lo:[0,1,0]
    v_cvt_pk_bf16_f32 v243, v174, v175
    v_pk_mul_f32 v[194:195], v[174:175], v[186:187] op_sel:[0,0] op_sel_hi:[0,1]
    v_pk_fma_f32 v[172:173], v[174:175], v[186:187], v[194:195] op_sel:[1,1,0] op_sel_hi:[1,0,1] neg_lo:[0,1,0]
    v_cvt_pk_bf16_f32 v244, v172, v173
    v_pk_mul_f32 v[194:195], v[172:173], v[186:187] op_sel:[0,0] op_sel_hi:[0,1]
    v_pk_fma_f32 v[174:175], v[172:173], v[186:187], v[194:195] op_sel:[1,1,0] op_sel_hi:[1,0,1] neg_lo:[0,1,0]
    v_cvt_pk_bf16_f32 v245, v174, v175
    v_pk_mul_f32 v[194:195], v[174:175], v[186:187] op_sel:[0,0] op_sel_hi:[0,1]
    v_pk_fma_f32 v[172:173], v[174:175], v[186:187], v[194:195] op_sel:[1,1,0] op_sel_hi:[1,0,1] neg_lo:[0,1,0]
    v_cvt_pk_bf16_f32 v246, v172, v173
    v_pk_mul_f32 v[194:195], v[172:173], v[186:187] op_sel:[0,0] op_sel_hi:[0,1]
    v_pk_fma_f32 v[174:175], v[172:173], v[186:187], v[194:195] op_sel:[1,1,0] op_sel_hi:[1,0,1] neg_lo:[0,1,0]
    v_cvt_pk_bf16_f32 v247, v174, v175
    v_pk_mul_f32 v[194:195], v[174:175], v[186:187] op_sel:[0,0] op_sel_hi:[0,1]
    v_pk_fma_f32 v[172:173], v[174:175], v[186:187], v[194:195] op_sel:[1,1,0] op_sel_hi:[1,0,1] neg_lo:[0,1,0]
    v_cvt_pk_bf16_f32 v248, v172, v173
    v_pk_mul_f32 v[194:195], v[172:173], v[186:187] op_sel:[0,0] op_sel_hi:[0,1]
    v_pk_fma_f32 v[174:175], v[172:173], v[186:187], v[194:195] op_sel:[1,1,0] op_sel_hi:[1,0,1] neg_lo:[0,1,0]
    v_mov_b32 v140, 1073741824
    v_lshlrev_b32 v141, 2, v0
    v_cmp_gt_u32 vcc, 64, v0
    s_nop 1
    v_cndmask_b32 v141, v140, v141, vcc
    v_mov_b32_e64 v140, 0
    s_lshl_b32 s97, s2, 8
    s_add_u32 s97, s97, 3473408
    buffer_store_dword v140, v141, s[16:19], s97 offen sc1
    v_cvt_pk_bf16_f32 v249, v174, v175
    v_pk_mul_f32 v[194:195], v[174:175], v[186:187] op_sel:[0,0] op_sel_hi:[0,1]
    v_pk_fma_f32 v[172:173], v[174:175], v[186:187], v[194:195] op_sel:[1,1,0] op_sel_hi:[1,0,1] neg_lo:[0,1,0]
    v_cvt_pk_bf16_f32 v250, v172, v173
    v_pk_mul_f32 v[194:195], v[172:173], v[186:187] op_sel:[0,0] op_sel_hi:[0,1]
    v_pk_fma_f32 v[174:175], v[172:173], v[186:187], v[194:195] op_sel:[1,1,0] op_sel_hi:[1,0,1] neg_lo:[0,1,0]
    v_cvt_pk_bf16_f32 v251, v174, v175
    ds_write_addtid_b32 v242 offset:5440
    ds_write_addtid_b32 v243 offset:5712
    ds_write_addtid_b32 v244 offset:5984
    ds_write_addtid_b32 v245 offset:6256
    ds_write_addtid_b32 v246 offset:6528
    ds_write_addtid_b32 v247 offset:6800
    ds_write_addtid_b32 v248 offset:7072
    ds_write_addtid_b32 v249 offset:7344
    ds_write_addtid_b32 v250 offset:7616
    ds_write_addtid_b32 v251 offset:7888
    v_pk_mul_f32 v[194:195], v[174:175], v[186:187] op_sel:[0,0] op_sel_hi:[0,1]
    v_pk_fma_f32 v[172:173], v[174:175], v[186:187], v[194:195] op_sel:[1,1,0] op_sel_hi:[1,0,1] neg_lo:[0,1,0]
    v_cvt_pk_bf16_f32 v242, v172, v173
    v_pk_mul_f32 v[194:195], v[172:173], v[186:187] op_sel:[0,0] op_sel_hi:[0,1]
    v_pk_fma_f32 v[174:175], v[172:173], v[186:187], v[194:195] op_sel:[1,1,0] op_sel_hi:[1,0,1] neg_lo:[0,1,0]
    v_cvt_pk_bf16_f32 v243, v174, v175
    ds_write_addtid_b32 v242 offset:8160
    ds_write_addtid_b32 v243 offset:8432
    ds_read_b128 a[160:163], v252 offset:0
    ds_read_b128 a[164:167], v252 offset:32
    ds_read_b128 a[168:171], v252 offset:64
    ds_read_b128 a[172:175], v252 offset:96
    ds_read_b128 a[176:179], v252 offset:128
    ds_read_b128 a[180:183], v252 offset:160
    ds_read_b128 a[184:187], v252 offset:192
    ds_read_b128 a[188:191], v252 offset:224
    v_pk_mul_f32 v[194:195], v[180:181], v[180:181] op_sel:[0,0] op_sel_hi:[0,1]
    v_pk_fma_f32 v[182:183], v[180:181], v[180:181], v[194:195] op_sel:[1,1,0] op_sel_hi:[1,0,1] neg_lo:[0,1,0]
    v_pk_mul_f32 v[194:195], v[182:183], v[182:183] op_sel:[0,0] op_sel_hi:[0,1]
    v_pk_fma_f32 v[184:185], v[182:183], v[182:183], v[194:195] op_sel:[1,1,0] op_sel_hi:[1,0,1] neg_lo:[0,1,0]
    v_cvt_pk_bf16_f32 v242, v192, -v193
    v_pk_mul_f32 v[194:195], v[192:193], v[180:181] op_sel:[0,0] op_sel_hi:[0,1]
    v_pk_fma_f32 v[174:175], v[192:193], v[180:181], v[194:195] op_sel:[1,1,0] op_sel_hi:[1,0,1] neg_lo:[0,1,0]
    v_mov_b32 v142, 1073741824
    v_lshlrev_b32 v143, 2, v0
    v_cmp_gt_u32 vcc, 16, v0
    s_nop 1
    v_cndmask_b32 v143, v142, v143, vcc
    v_mov_b32_e64 v142, -1
    s_lshl_b32 s97, s2, 6
    s_add_u32 s97, s97, 3457024
    buffer_store_dword v142, v143, s[16:19], s97 offen sc1
    v_cvt_pk_bf16_f32 v243, v174, -v175
    v_pk_mul_f32 v[194:195], v[174:175], v[180:181] op_sel:[0,0] op_sel_hi:[0,1]
    v_pk_fma_f32 v[172:173], v[174:175], v[180:181], v[194:195] op_sel:[1,1,0] op_sel_hi:[1,0,1] neg_lo:[0,1,0]
    v_cvt_pk_bf16_f32 v244, v172, -v173
    v_pk_mul_f32 v[194:195], v[172:173], v[180:181] op_sel:[0,0] op_sel_hi:[0,1]
    v_pk_fma_f32 v[174:175], v[172:173], v[180:181], v[194:195] op_sel:[1,1,0] op_sel_hi:[1,0,1] neg_lo:[0,1,0]
    v_cvt_pk_bf16_f32 v245, v174, -v175
    v_pk_mul_f32 v[194:195], v[174:175], v[180:181] op_sel:[0,0] op_sel_hi:[0,1]
    v_pk_fma_f32 v[172:173], v[174:175], v[180:181], v[194:195] op_sel:[1,1,0] op_sel_hi:[1,0,1] neg_lo:[0,1,0]
    v_cvt_pk_bf16_f32 v246, v172, -v173
    v_pk_mul_f32 v[194:195], v[172:173], v[180:181] op_sel:[0,0] op_sel_hi:[0,1]
    v_pk_fma_f32 v[174:175], v[172:173], v[180:181], v[194:195] op_sel:[1,1,0] op_sel_hi:[1,0,1] neg_lo:[0,1,0]
    v_cvt_pk_bf16_f32 v247, v174, -v175
    v_pk_mul_f32 v[194:195], v[174:175], v[180:181] op_sel:[0,0] op_sel_hi:[0,1]
    v_pk_fma_f32 v[172:173], v[174:175], v[180:181], v[194:195] op_sel:[1,1,0] op_sel_hi:[1,0,1] neg_lo:[0,1,0]
    v_cvt_pk_bf16_f32 v248, v172, -v173
    v_pk_mul_f32 v[194:195], v[172:173], v[180:181] op_sel:[0,0] op_sel_hi:[0,1]
    v_pk_fma_f32 v[174:175], v[172:173], v[180:181], v[194:195] op_sel:[1,1,0] op_sel_hi:[1,0,1] neg_lo:[0,1,0]
    v_cvt_pk_bf16_f32 v249, v174, -v175
    v_pk_mul_f32 v[194:195], v[192:193], v[190:191] op_sel:[0,0] op_sel_hi:[0,1]
    v_pk_fma_f32 v[176:177], v[192:193], v[190:191], v[194:195] op_sel:[1,1,0] op_sel_hi:[1,0,1] neg_lo:[0,1,0]
    v_cvt_pk_bf16_f32 v250, v176, -v177
    v_pk_mul_f32 v[194:195], v[176:177], v[182:183] op_sel:[0,0] op_sel_hi:[0,1]
    v_pk_fma_f32 v[174:175], v[176:177], v[182:183], v[194:195] op_sel:[1,1,0] op_sel_hi:[1,0,1] neg_lo:[0,1,0]
    v_cvt_pk_bf16_f32 v251, v174, -v175
    ds_write_addtid_b32 v242 offset:0
    ds_write_addtid_b32 v243 offset:272
    ds_write_addtid_b32 v244 offset:544
    ds_write_addtid_b32 v245 offset:816
    ds_write_addtid_b32 v246 offset:1088
    ds_write_addtid_b32 v247 offset:1360
    ds_write_addtid_b32 v248 offset:1632
    ds_write_addtid_b32 v249 offset:1904
    ds_write_addtid_b32 v250 offset:2176
    ds_write_addtid_b32 v251 offset:2448
    v_pk_mul_f32 v[194:195], v[174:175], v[182:183] op_sel:[0,0] op_sel_hi:[0,1]
    v_pk_fma_f32 v[172:173], v[174:175], v[182:183], v[194:195] op_sel:[1,1,0] op_sel_hi:[1,0,1] neg_lo:[0,1,0]
    v_cvt_pk_bf16_f32 v242, v172, -v173
    v_pk_mul_f32 v[194:195], v[172:173], v[182:183] op_sel:[0,0] op_sel_hi:[0,1]
    v_pk_fma_f32 v[174:175], v[172:173], v[182:183], v[194:195] op_sel:[1,1,0] op_sel_hi:[1,0,1] neg_lo:[0,1,0]
    s_waitcnt vmcnt(11)
    s_waitcnt vmcnt(10)
    v_cmp_gt_u32 vcc, 1, v7
    s_nop 0
    s_and_b64 vcc, vcc, s[50:51]
    s_and_b64 vcc, vcc, 1
    s_cbranch_scc1 ps_5
pc_7:
    s_barrier
    v_lshlrev_b32 v2, 3, v4
    v_mov_b32 v5, 1
    v_cndmask_b32 v2, v4, v2, s[50:51]
    buffer_atomic_add v5, v2, s[16:19], s86 offen offset:0 sc1
    v_cvt_pk_bf16_f32 v243, v174, -v175
    v_pk_mul_f32 v[194:195], v[174:175], v[182:183] op_sel:[0,0] op_sel_hi:[0,1]
    v_pk_fma_f32 v[172:173], v[174:175], v[182:183], v[194:195] op_sel:[1,1,0] op_sel_hi:[1,0,1] neg_lo:[0,1,0]
    v_cvt_pk_bf16_f32 v244, v172, -v173
    v_pk_mul_f32 v[194:195], v[176:177], v[190:191] op_sel:[0,0] op_sel_hi:[0,1]
    v_pk_fma_f32 v[178:179], v[176:177], v[190:191], v[194:195] op_sel:[1,1,0] op_sel_hi:[1,0,1] neg_lo:[0,1,0]
    v_cvt_pk_bf16_f32 v245, v178, -v179
    v_pk_mul_f32 v[194:195], v[178:179], v[184:185] op_sel:[0,0] op_sel_hi:[0,1]
    v_pk_fma_f32 v[174:175], v[178:179], v[184:185], v[194:195] op_sel:[1,1,0] op_sel_hi:[1,0,1] neg_lo:[0,1,0]
    v_cvt_pk_bf16_f32 v246, v174, -v175
    v_pk_mul_f32 v[194:195], v[174:175], v[184:185] op_sel:[0,0] op_sel_hi:[0,1]
    v_pk_fma_f32 v[172:173], v[174:175], v[184:185], v[194:195] op_sel:[1,1,0] op_sel_hi:[1,0,1] neg_lo:[0,1,0]
    v_cvt_pk_bf16_f32 v247, v172, -v173
    v_pk_mul_f32 v[194:195], v[178:179], v[190:191] op_sel:[0,0] op_sel_hi:[0,1]
    v_pk_fma_f32 v[176:177], v[178:179], v[190:191], v[194:195] op_sel:[1,1,0] op_sel_hi:[1,0,1] neg_lo:[0,1,0]
    v_cvt_pk_bf16_f32 v248, v176, -v177
    v_pk_mul_f32 v[194:195], v[176:177], v[184:185] op_sel:[0,0] op_sel_hi:[0,1]
    v_pk_fma_f32 v[174:175], v[176:177], v[184:185], v[194:195] op_sel:[1,1,0] op_sel_hi:[1,0,1] neg_lo:[0,1,0]
    v_cvt_pk_bf16_f32 v249, v174, -v175
    v_pk_mul_f32 v[194:195], v[174:175], v[184:185] op_sel:[0,0] op_sel_hi:[0,1]
    v_pk_fma_f32 v[172:173], v[174:175], v[184:185], v[194:195] op_sel:[1,1,0] op_sel_hi:[1,0,1] neg_lo:[0,1,0]
    v_cvt_pk_bf16_f32 v250, v172, -v173
    v_pk_mul_f32 v[194:195], v[176:177], v[190:191] op_sel:[0,0] op_sel_hi:[0,1]
    v_pk_fma_f32 v[178:179], v[176:177], v[190:191], v[194:195] op_sel:[1,1,0] op_sel_hi:[1,0,1] neg_lo:[0,1,0]
    v_cvt_pk_bf16_f32 v251, v178, -v179
    ds_write_addtid_b32 v242 offset:2720
    ds_write_addtid_b32 v242 offset:3264
    ds_write_addtid_b32 v243 offset:3536
    ds_write_addtid_b32 v244 offset:3808
    ds_write_addtid_b32 v245 offset:4352
    ds_write_addtid_b32 v246 offset:4624
    ds_write_addtid_b32 v247 offset:4896
    ds_write_addtid_b32 v248 offset:5440
    ds_write_addtid_b32 v249 offset:5712
    ds_write_addtid_b32 v250 offset:5984
    v_mov_b32 v144, -1
    v_mov_b32 v145, -1
    v_mov_b32 v146, -1
    v_mov_b32 v147, -1
    v_lshlrev_b32 v148, 4, v0
    s_sub_u32 s88, s2, 0
    s_mul_i32 s88, s88, 20480
    s_min_u32 s88, s88, 5222400
    s_add_u32 s88, s88, 4194304
    buffer_store_dwordx4 v[144:147], v148, s[16:19], s88 offen sc1
    ds_write_addtid_b32 v251 offset:6528
    v_pk_mul_f32 v[194:195], v[178:179], v[186:187] op_sel:[0,0] op_sel_hi:[0,1]
    v_pk_fma_f32 v[174:175], v[178:179], v[186:187], v[194:195] op_sel:[1,1,0] op_sel_hi:[1,0,1] neg_lo:[0,1,0]
    v_cvt_pk_bf16_f32 v242, v174, -v175
    v_pk_mul_f32 v[194:195], v[178:179], v[190:191] op_sel:[0,0] op_sel_hi:[0,1]
    v_pk_fma_f32 v[176:177], v[178:179], v[190:191], v[194:195] op_sel:[1,1,0] op_sel_hi:[1,0,1] neg_lo:[0,1,0]
    v_cvt_pk_bf16_f32 v243, v176, -v177
    v_pk_mul_f32 v[194:195], v[176:177], v[186:187] op_sel:[0,0] op_sel_hi:[0,1]
    v_pk_fma_f32 v[174:175], v[176:177], v[186:187], v[194:195] op_sel:[1,1,0] op_sel_hi:[1,0,1] neg_lo:[0,1,0]
    v_cvt_pk_bf16_f32 v244, v174, -v175
    v_pk_mul_f32 v[194:195], v[176:177], v[190:191] op_sel:[0,0] op_sel_hi:[0,1]
    v_pk_fma_f32 v[178:179], v[176:177], v[190:191], v[194:195] op_sel:[1,1,0] op_sel_hi:[1,0,1] neg_lo:[0,1,0]
    v_cvt_pk_bf16_f32 v245, v178, -v179
    v_pk_mul_f32 v[194:195], v[178:179], v[186:187] op_sel:[0,0] op_sel_hi:[0,1]
    v_pk_fma_f32 v[174:175], v[178:179], v[186:187], v[194:195] op_sel:[1,1,0] op_sel_hi:[1,0,1] neg_lo:[0,1,0]
    v_cvt_pk_bf16_f32 v246, v174, -v175
    v_pk_mul_f32 v[194:195], v[178:179], v[190:191] op_sel:[0,0] op_sel_hi:[0,1]
    v_pk_fma_f32 v[176:177], v[178:179], v[190:191], v[194:195] op_sel:[1,1,0] op_sel_hi:[1,0,1] neg_lo:[0,1,0]
    v_cvt_pk_bf16_f32 v247, v176, -v177
    v_pk_mul_f32 v[194:195], v[176:177], v[186:187] op_sel:[0,0] op_sel_hi:[0,1]
    v_pk_fma_f32 v[174:175], v[176:177], v[186:187], v[194:195] op_sel:[1,1,0] op_sel_hi:[1,0,1] neg_lo:[0,1,0]
    v_cvt_pk_bf16_f32 v248, v174, -v175
    ds_write_addtid_b32 v242 offset:6800
    ds_write_addtid_b32 v243 offset:7072
    ds_write_addtid_b32 v244 offset:7344
    ds_write_addtid_b32 v245 offset:7616
    ds_write_addtid_b32 v246 offset:7888
    ds_write_addtid_b32 v247 offset:8160
    ds_write_addtid_b32 v248 offset:8432
    ds_read_b128 a[192:195], v252 offset:0
    ds_read_b128 a[196:199], v252 offset:32
    ds_read_b128 a[200:203], v252 offset:64
    ds_read_b128 a[204:207], v252 offset:96
    ds_read_b128 a[208:211], v252 offset:128
    ds_read_b128 a[212:215], v252 offset:160
    s_add_u32 s88, s88, 4096
    buffer_store_dwordx4 v[144:147], v148, s[16:19], s88 offen sc1
    ds_read_b128 a[216:219], v252 offset:192
    ds_read_b128 a[220:223], v252 offset:224
    v_and_b32 v199, 0xffff0000, v232
    v_mul_f32 v199, 0x3fb8aa3b, v199
    v_exp_f32 v199, v199
    v_and_b32 v255, 0xffff0000, v233
    v_mul_f32 v255, v255, v253
    v_mul_f32 v255, 0x3e22f983, v255
    v_cvt_pk_bf16_f32 v199, v199, v199
    v_lshlrev_b32 v199, 16, v199
    v_mul_f32 v254, v199, v253
    v_mul_f32 v254, 0xbfb8aa3b, v254
    s_waitcnt lgkmcnt(7)
    v_mfma_f32_32x32x16_bf16 v[216:231], a[192:195], a[160:163], 0
    v_mul_f32 v182, 0x41000000, v254
    v_mul_f32 v185, 0x41000000, v255
    v_mul_f32 v184, 0x43800000, v254
    v_mul_f32 v189, 0x43800000, v255
    s_waitcnt lgkmcnt(6)
    v_mfma_f32_32x32x16_bf16 v[216:231], a[196:199], a[164:167], v[216:231]
    v_fract_f32 v185, v185
    v_fract_f32 v188, v255
    v_fract_f32 v189, v189
    v_exp_f32 v182, v182
    s_waitcnt lgkmcnt(5)
    v_mfma_f32_32x32x16_bf16 v[216:231], a[200:203], a[168:171], v[216:231]
    v_exp_f32 v183, v254
    v_exp_f32 v184, v184
    v_cos_f32 v186, v185
    v_sin_f32 v187, v185
    s_waitcnt lgkmcnt(4)
    v_mfma_f32_32x32x16_bf16 v[216:231], a[204:207], a[172:175], v[216:231]
    v_cos_f32 v180, v188
    v_sin_f32 v181, v188
    v_cos_f32 v190, v189
    v_sin_f32 v191, v189
    s_waitcnt lgkmcnt(3)
    v_mfma_f32_32x32x16_bf16 v[216:231], a[208:211], a[176:179], v[216:231]
    v_and_b32 v192, 0xffff0000, v234
    v_and_b32 v193, 0xffff0000, v235
    s_add_u32 s88, s88, 4096
    buffer_store_dwordx4 v[144:147], v148, s[16:19], s88 offen sc1
    v_add_f32 v199, v253, v253
    v_mul_f32 v192, v192, v199
    s_waitcnt lgkmcnt(2)
    v_mfma_f32_32x32x16_bf16 v[216:231], a[212:215], a[180:183], v[216:231]
    v_mul_f32 v193, v193, v199
    v_mul_f32 v186, v186, v182
    v_mul_f32 v187, v187, v182
    v_mul_f32 v180, v180, v183
    s_waitcnt lgkmcnt(1)
    v_mfma_f32_32x32x16_bf16 v[216:231], a[216:219], a[184:187], v[216:231]
    v_mul_f32 v181, v181, v183
    v_mul_f32 v190, v190, v184
    v_mul_f32 v191, v191, v184
    s_waitcnt lgkmcnt(0)
    v_mfma_f32_32x32x16_bf16 v[216:231], a[220:223], a[188:191], v[216:231]
    v_mov_b32 v242, 0x3f80
    v_cvt_pk_bf16_f32 v243, v186, v187
    v_pk_mul_f32 v[194:195], v[186:187], v[186:187] op_sel:[0,0] op_sel_hi:[0,1]
    v_pk_fma_f32 v[172:173], v[186:187], v[186:187], v[194:195] op_sel:[1,1,0] op_sel_hi:[1,0,1] neg_lo:[0,1,0]
    v_cvt_pk_bf16_f32 v244, v172, v173
    v_pk_mul_f32 v[194:195], v[172:173], v[186:187] op_sel:[0,0] op_sel_hi:[0,1]
    v_pk_fma_f32 v[174:175], v[172:173], v[186:187], v[194:195] op_sel:[1,1,0] op_sel_hi:[1,0,1] neg_lo:[0,1,0]
    v_cvt_pk_bf16_f32 v245, v174, v175
    v_pk_mul_f32 v[194:195], v[174:175], v[186:187] op_sel:[0,0] op_sel_hi:[0,1]
    v_pk_fma_f32 v[172:173], v[174:175], v[186:187], v[194:195] op_sel:[1,1,0] op_sel_hi:[1,0,1] neg_lo:[0,1,0]
    v_cvt_pk_bf16_f32 v246, v172, v173
    v_pk_mul_f32 v[194:195], v[172:173], v[186:187] op_sel:[0,0] op_sel_hi:[0,1]
    v_pk_fma_f32 v[174:175], v[172:173], v[186:187], v[194:195] op_sel:[1,1,0] op_sel_hi:[1,0,1] neg_lo:[0,1,0]
    v_cvt_pk_bf16_f32 v247, v174, v175
    v_pk_mul_f32 v[194:195], v[174:175], v[186:187] op_sel:[0,0] op_sel_hi:[0,1]
    v_pk_fma_f32 v[172:173], v[174:175], v[186:187], v[194:195] op_sel:[1,1,0] op_sel_hi:[1,0,1] neg_lo:[0,1,0]
    v_cvt_pk_bf16_f32 v248, v172, v173
    v_pk_mul_f32 v[194:195], v[172:173], v[186:187] op_sel:[0,0] op_sel_hi:[0,1]
    v_pk_fma_f32 v[174:175], v[172:173], v[186:187], v[194:195] op_sel:[1,1,0] op_sel_hi:[1,0,1] neg_lo:[0,1,0]
    v_cvt_pk_bf16_f32 v249, v174, v175
    v_pk_mul_f32 v[194:195], v[174:175], v[186:187] op_sel:[0,0] op_sel_hi:[0,1]
    v_pk_fma_f32 v[172:173], v[174:175], v[186:187], v[194:195] op_sel:[1,1,0] op_sel_hi:[1,0,1] neg_lo:[0,1,0]
    v_cvt_pk_bf16_f32 v250, v172, v173
    s_add_u32 s88, s88, 4096
    buffer_store_dwordx4 v[144:147], v148, s[16:19], s88 offen sc1
    v_pk_mul_f32 v[194:195], v[172:173], v[186:187] op_sel:[0,0] op_sel_hi:[0,1]
    v_pk_fma_f32 v[174:175], v[172:173], v[186:187], v[194:195] op_sel:[1,1,0] op_sel_hi:[1,0,1] neg_lo:[0,1,0]
    v_cvt_pk_bf16_f32 v251, v174, v175
    ds_write_addtid_b32 v242 offset:0
    ds_write_addtid_b32 v243 offset:272
    ds_write_addtid_b32 v244 offset:544
    ds_write_addtid_b32 v245 offset:816
    ds_write_addtid_b32 v246 offset:1088
    ds_write_addtid_b32 v247 offset:1360
    ds_write_addtid_b32 v248 offset:1632
    ds_write_addtid_b32 v249 offset:1904
    ds_write_addtid_b32 v250 offset:2176
    ds_write_addtid_b32 v251 offset:2448
    v_pk_mul_f32 v[194:195], v[174:175], v[186:187] op_sel:[0,0] op_sel_hi:[0,1]
    v_pk_fma_f32 v[172:173], v[174:175], v[186:187], v[194:195] op_sel:[1,1,0] op_sel_hi:[1,0,1] neg_lo:[0,1,0]
    v_cvt_pk_bf16_f32 v242, v172, v173
    v_pk_mul_f32 v[194:195], v[172:173], v[186:187] op_sel:[0,0] op_sel_hi:[0,1]
    v_pk_fma_f32 v[174:175], v[172:173], v[186:187], v[194:195] op_sel:[1,1,0] op_sel_hi:[1,0,1] neg_lo:[0,1,0]
    v_cvt_pk_bf16_f32 v243, v174, v175
    v_pk_mul_f32 v[194:195], v[174:175], v[186:187] op_sel:[0,0] op_sel_hi:[0,1]
    v_pk_fma_f32 v[172:173], v[174:175], v[186:187], v[194:195] op_sel:[1,1,0] op_sel_hi:[1,0,1] neg_lo:[0,1,0]
    v_cvt_pk_bf16_f32 v244, v172, v173
    v_pk_mul_f32 v[194:195], v[172:173], v[186:187] op_sel:[0,0] op_sel_hi:[0,1]
    v_pk_fma_f32 v[174:175], v[172:173], v[186:187], v[194:195] op_sel:[1,1,0] op_sel_hi:[1,0,1] neg_lo:[0,1,0]
    v_cvt_pk_bf16_f32 v245, v174, v175
    v_pk_mul_f32 v[194:195], v[174:175], v[186:187] op_sel:[0,0] op_sel_hi:[0,1]
    v_pk_fma_f32 v[172:173], v[174:175], v[186:187], v[194:195] op_sel:[1,1,0] op_sel_hi:[1,0,1] neg_lo:[0,1,0]
    v_cvt_pk_bf16_f32 v246, v172, v173
    v_pk_mul_f32 v[194:195], v[172:173], v[186:187] op_sel:[0,0] op_sel_hi:[0,1]
    v_pk_fma_f32 v[174:175], v[172:173], v[186:187], v[194:195] op_sel:[1,1,0] op_sel_hi:[1,0,1] neg_lo:[0,1,0]
    v_cvt_pk_bf16_f32 v247, v174, v175
    v_pk_mul_f32 v[194:195], v[174:175], v[186:187] op_sel:[0,0] op_sel_hi:[0,1]
    v_pk_fma_f32 v[172:173], v[174:175], v[186:187], v[194:195] op_sel:[1,1,0] op_sel_hi:[1,0,1] neg_lo:[0,1,0]
    v_cvt_pk_bf16_f32 v248, v172, v173
    v_pk_mul_f32 v[194:195], v[172:173], v[186:187] op_sel:[0,0] op_sel_hi:[0,1]
    s_add_u32 s88, s88, 4096
    buffer_store_dwordx4 v[144:147], v148, s[16:19], s88 offen sc1
    v_pk_fma_f32 v[174:175], v[172:173], v[186:187], v[194:195] op_sel:[1,1,0] op_sel_hi:[1,0,1] neg_lo:[0,1,0]
    v_cvt_pk_bf16_f32 v249, v174, v175
    v_pk_mul_f32 v[194:195], v[174:175], v[186:187] op_sel:[0,0] op_sel_hi:[0,1]
    v_pk_fma_f32 v[172:173], v[174:175], v[186:187], v[194:195] op_sel:[1,1,0] op_sel_hi:[1,0,1] neg_lo:[0,1,0]
    v_cvt_pk_bf16_f32 v250, v172, v173
    v_pk_mul_f32 v[194:195], v[172:173], v[186:187] op_sel:[0,0] op_sel_hi:[0,1]
    v_pk_fma_f32 v[174:175], v[172:173], v[186:187], v[194:195] op_sel:[1,1,0] op_sel_hi:[1,0,1] neg_lo:[0,1,0]
    v_cvt_pk_bf16_f32 v251, v174, v175
    ds_write_addtid_b32 v242 offset:2720
    ds_write_addtid_b32 v243 offset:2992
    ds_write_addtid_b32 v244 offset:3264
    ds_write_addtid_b32 v245 offset:3536
    ds_write_addtid_b32 v246 offset:3808
    ds_write_addtid_b32 v247 offset:4080
    ds_write_addtid_b32 v248 offset:4352
    ds_write_addtid_b32 v249 offset:4624
    ds_write_addtid_b32 v250 offset:4896
    ds_write_addtid_b32 v251 offset:5168
    v_pk_mul_f32 v[194:195], v[174:175], v[186:187] op_sel:[0,0] op_sel_hi:[0,1]
    v_pk_fma_f32 v[172:173], v[174:175], v[186:187], v[194:195] op_sel:[1,1,0] op_sel_hi:[1,0,1] neg_lo:[0,1,0]
    v_cvt_pk_bf16_f32 v242, v172, v173
    v_pk_mul_f32 v[194:195], v[172:173], v[186:187] op_sel:[0,0] op_sel_hi:[0,1]
    v_pk_fma_f32 v[174:175], v[172:173], v[186:187], v[194:195] op_sel:[1,1,0] op_sel_hi:[1,0,1] neg_lo:[0,1,0]
    v_cvt_pk_bf16_f32 v243, v174, v175
    v_pk_mul_f32 v[194:195], v[174:175], v[186:187] op_sel:[0,0] op_sel_hi:[0,1]
    v_pk_fma_f32 v[172:173], v[174:175], v[186:187], v[194:195] op_sel:[1,1,0] op_sel_hi:[1,0,1] neg_lo:[0,1,0]
    v_cvt_pk_bf16_f32 v244, v172, v173
    v_pk_mul_f32 v[194:195], v[172:173], v[186:187] op_sel:[0,0] op_sel_hi:[0,1]
    v_pk_fma_f32 v[174:175], v[172:173], v[186:187], v[194:195] op_sel:[1,1,0] op_sel_hi:[1,0,1] neg_lo:[0,1,0]
    v_cvt_pk_bf16_f32 v245, v174, v175
    v_pk_mul_f32 v[194:195], v[174:175], v[186:187] op_sel:[0,0] op_sel_hi:[0,1]
    v_pk_fma_f32 v[172:173], v[174:175], v[186:187], v[194:195] op_sel:[1,1,0] op_sel_hi:[1,0,1] neg_lo:[0,1,0]
    v_cvt_pk_bf16_f32 v246, v172, v173
    v_pk_mul_f32 v[194:195], v[172:173], v[186:187] op_sel:[0,0] op_sel_hi:[0,1]
    v_pk_fma_f32 v[174:175], v[172:173], v[186:187], v[194:195] op_sel:[1,1,0] op_sel_hi:[1,0,1] neg_lo:[0,1,0]
    v_mov_b32 v134, 0x3f803f80
    v_mov_b32 v132, 0
    v_mov_b32 v133, 0
    s_waitcnt vmcnt(10)
    v_dot2c_f32_bf16 v132, v120, v134
    v_dot2c_f32_bf16 v133, v120, v120
    v_dot2c_f32_bf16 v132, v121, v134
    v_dot2c_f32_bf16 v133, v121, v121
    v_dot2c_f32_bf16 v132, v122, v134
    v_dot2c_f32_bf16 v133, v122, v122
    v_dot2c_f32_bf16 v132, v123, v134
    v_dot2c_f32_bf16 v133, v123, v123
    s_waitcnt vmcnt(9)
    v_dot2c_f32_bf16 v132, v124, v134
    v_dot2c_f32_bf16 v133, v124, v124
    v_dot2c_f32_bf16 v132, v125, v134
    v_dot2c_f32_bf16 v133, v125, v125
    v_dot2c_f32_bf16 v132, v126, v134
    v_dot2c_f32_bf16 v133, v126, v126
    v_dot2c_f32_bf16 v132, v127, v134
    v_dot2c_f32_bf16 v133, v127, v127
    s_waitcnt vmcnt(8)
    v_dot2c_f32_bf16 v132, v128, v134
    v_dot2c_f32_bf16 v133, v128, v128
    v_dot2c_f32_bf16 v132, v129, v134
    v_dot2c_f32_bf16 v133, v129, v129
    v_dot2c_f32_bf16 v132, v130, v134
    v_dot2c_f32_bf16 v133, v130, v130
    v_dot2c_f32_bf16 v132, v131, v134
    v_dot2c_f32_bf16 v133, v131, v131
    v_lshrrev_b32 v135, 5, v0
    v_and_b32 v121, 3, v135
    v_lshrrev_b32 v135, 2, v135
    v_add_f32_dpp v132, v132, v132 row_shr:1 row_mask:0xf bank_mask:0xf bound_ctrl:0
    v_add_f32_dpp v133, v133, v133 row_shr:1 row_mask:0xf bank_mask:0xf bound_ctrl:0
    v_lshlrev_b32_e64 v135, 3, v135
    v_add_f32_dpp v132, v132, v132 row_shr:2 row_mask:0xf bank_mask:0xf bound_ctrl:0
    v_add_f32_dpp v133, v133, v133 row_shr:2 row_mask:0xf bank_mask:0xf bound_ctrl:0
    v_lshl_add_u32 v135, v121, 12, v135
    v_add_f32_dpp v132, v132, v132 row_shr:4 row_mask:0xf bank_mask:0xf bound_ctrl:0
    v_add_f32_dpp v133, v133, v133 row_shr:4 row_mask:0xf bank_mask:0xf bound_ctrl:0
    v_and_b32_e64 v121, 31, v0
    v_add_f32_dpp v132, v132, v132 row_shr:8 row_mask:0xf bank_mask:0xf bound_ctrl:0
    v_add_f32_dpp v133, v133, v133 row_shr:8 row_mask:0xf bank_mask:0xf bound_ctrl:0
    v_cmp_eq_u32_e64 vcc, 31, v121
    v_add_f32_dpp v132, v132, v132 row_bcast:15 row_mask:0xa bank_mask:0xf
    v_add_f32_dpp v133, v133, v133 row_bcast:15 row_mask:0xa bank_mask:0xf
    v_mov_b32 v121, 1073741824
    v_cndmask_b32_e64 v120, v121, v135, vcc
    s_lshl_b32 s96, s2, 4
    s_add_u32 s96, s96, 3440640
    v_mul_f32 v135, 0x3acccccd, v132
    v_mul_f32 v133, 0x3acccccd, v133
    v_fma_f32 v133, -v135, v135, v133
    v_max_f32 v133, 0, v133
    v_add_f32 v133, 0x3727c5ac, v133
    v_rsq_f32_e64 v132, v133
    s_nop 0
    v_mul_f32 v133, -v135, v132
    buffer_store_dwordx2 v[132:133], v120, s[16:19], s96 offen sc1
    v_cvt_pk_bf16_f32 v247, v174, v175
    v_pk_mul_f32 v[194:195], v[174:175], v[186:187] op_sel:[0,0] op_sel_hi:[0,1]
    v_pk_fma_f32 v[172:173], v[174:175], v[186:187], v[194:195] op_sel:[1,1,0] op_sel_hi:[1,0,1] neg_lo:[0,1,0]
    v_cvt_pk_bf16_f32 v248, v172, v173
    v_pk_mul_f32 v[194:195], v[172:173], v[186:187] op_sel:[0,0] op_sel_hi:[0,1]
    v_pk_fma_f32 v[174:175], v[172:173], v[186:187], v[194:195] op_sel:[1,1,0] op_sel_hi:[1,0,1] neg_lo:[0,1,0]
    v_cvt_pk_bf16_f32 v249, v174, v175
    v_pk_mul_f32 v[194:195], v[174:175], v[186:187] op_sel:[0,0] op_sel_hi:[0,1]
    v_pk_fma_f32 v[172:173], v[174:175], v[186:187], v[194:195] op_sel:[1,1,0] op_sel_hi:[1,0,1] neg_lo:[0,1,0]
    v_cvt_pk_bf16_f32 v250, v172, v173
    v_pk_mul_f32 v[194:195], v[172:173], v[186:187] op_sel:[0,0] op_sel_hi:[0,1]
    v_pk_fma_f32 v[174:175], v[172:173], v[186:187], v[194:195] op_sel:[1,1,0] op_sel_hi:[1,0,1] neg_lo:[0,1,0]
    v_cvt_pk_bf16_f32 v251, v174, v175
    ds_write_addtid_b32 v242 offset:5440
    ds_write_addtid_b32 v243 offset:5712
    ds_write_addtid_b32 v244 offset:5984
    ds_write_addtid_b32 v245 offset:6256
    ds_write_addtid_b32 v246 offset:6528
    ds_write_addtid_b32 v247 offset:6800
    ds_write_addtid_b32 v248 offset:7072
    ds_write_addtid_b32 v249 offset:7344
    ds_write_addtid_b32 v250 offset:7616
    ds_write_addtid_b32 v251 offset:7888
    v_pk_mul_f32 v[194:195], v[174:175], v[186:187] op_sel:[0,0] op_sel_hi:[0,1]
    v_pk_fma_f32 v[172:173], v[174:175], v[186:187], v[194:195] op_sel:[1,1,0] op_sel_hi:[1,0,1] neg_lo:[0,1,0]
    v_cvt_pk_bf16_f32 v242, v172, v173
    v_pk_mul_f32 v[194:195], v[172:173], v[186:187] op_sel:[0,0] op_sel_hi:[0,1]
    v_pk_fma_f32 v[174:175], v[172:173], v[186:187], v[194:195] op_sel:[1,1,0] op_sel_hi:[1,0,1] neg_lo:[0,1,0]
    v_cvt_pk_bf16_f32 v243, v174, v175
    ds_write_addtid_b32 v242 offset:8160
    ds_write_addtid_b32 v243 offset:8432
    ds_read_b128 a[160:163], v252 offset:0
    ds_read_b128 a[164:167], v252 offset:32
    ds_read_b128 a[168:171], v252 offset:64
    ds_read_b128 a[172:175], v252 offset:96
    ds_read_b128 a[176:179], v252 offset:128
    ds_read_b128 a[180:183], v252 offset:160
    ds_read_b128 a[184:187], v252 offset:192
    ds_read_b128 a[188:191], v252 offset:224
    v_pk_mul_f32 v[194:195], v[180:181], v[180:181] op_sel:[0,0] op_sel_hi:[0,1]
    v_pk_fma_f32 v[182:183], v[180:181], v[180:181], v[194:195] op_sel:[1,1,0] op_sel_hi:[1,0,1] neg_lo:[0,1,0]
    v_pk_mul_f32 v[194:195], v[182:183], v[182:183] op_sel:[0,0] op_sel_hi:[0,1]
    v_pk_fma_f32 v[184:185], v[182:183], v[182:183], v[194:195] op_sel:[1,1,0] op_sel_hi:[1,0,1] neg_lo:[0,1,0]
    v_cvt_pk_bf16_f32 v242, v192, -v193
    v_pk_mul_f32 v[194:195], v[192:193], v[180:181] op_sel:[0,0] op_sel_hi:[0,1]
    v_pk_fma_f32 v[174:175], v[192:193], v[180:181], v[194:195] op_sel:[1,1,0] op_sel_hi:[1,0,1] neg_lo:[0,1,0]
    v_cvt_pk_bf16_f32 v243, v174, -v175
    v_pk_mul_f32 v[194:195], v[174:175], v[180:181] op_sel:[0,0] op_sel_hi:[0,1]
    v_pk_fma_f32 v[172:173], v[174:175], v[180:181], v[194:195] op_sel:[1,1,0] op_sel_hi:[1,0,1] neg_lo:[0,1,0]
    v_cvt_pk_bf16_f32 v244, v172, -v173
    v_pk_mul_f32 v[194:195], v[172:173], v[180:181] op_sel:[0,0] op_sel_hi:[0,1]
    v_pk_fma_f32 v[174:175], v[172:173], v[180:181], v[194:195] op_sel:[1,1,0] op_sel_hi:[1,0,1] neg_lo:[0,1,0]
    v_cvt_pk_bf16_f32 v245, v174, -v175
    v_pk_mul_f32 v[194:195], v[174:175], v[180:181] op_sel:[0,0] op_sel_hi:[0,1]
    v_pk_fma_f32 v[172:173], v[174:175], v[180:181], v[194:195] op_sel:[1,1,0] op_sel_hi:[1,0,1] neg_lo:[0,1,0]
    v_cvt_pk_bf16_f32 v246, v172, -v173
    v_pk_mul_f32 v[194:195], v[172:173], v[180:181] op_sel:[0,0] op_sel_hi:[0,1]
    v_pk_fma_f32 v[174:175], v[172:173], v[180:181], v[194:195] op_sel:[1,1,0] op_sel_hi:[1,0,1] neg_lo:[0,1,0]
    v_cvt_pk_bf16_f32 v247, v174, -v175
    v_pk_mul_f32 v[194:195], v[174:175], v[180:181] op_sel:[0,0] op_sel_hi:[0,1]
    buffer_load_dword v7, v4, s[16:19], s87 offen offset:0 sc1
    v_pk_fma_f32 v[172:173], v[174:175], v[180:181], v[194:195] op_sel:[1,1,0] op_sel_hi:[1,0,1] neg_lo:[0,1,0]
    v_cvt_pk_bf16_f32 v248, v172, -v173
    v_pk_mul_f32 v[194:195], v[172:173], v[180:181] op_sel:[0,0] op_sel_hi:[0,1]
    v_pk_fma_f32 v[174:175], v[172:173], v[180:181], v[194:195] op_sel:[1,1,0] op_sel_hi:[1,0,1] neg_lo:[0,1,0]
    v_cvt_pk_bf16_f32 v249, v174, -v175
    v_pk_mul_f32 v[194:195], v[192:193], v[190:191] op_sel:[0,0] op_sel_hi:[0,1]
    v_pk_fma_f32 v[176:177], v[192:193], v[190:191], v[194:195] op_sel:[1,1,0] op_sel_hi:[1,0,1] neg_lo:[0,1,0]
    v_cvt_pk_bf16_f32 v250, v176, -v177
    v_pk_mul_f32 v[194:195], v[176:177], v[182:183] op_sel:[0,0] op_sel_hi:[0,1]
    v_pk_fma_f32 v[174:175], v[176:177], v[182:183], v[194:195] op_sel:[1,1,0] op_sel_hi:[1,0,1] neg_lo:[0,1,0]
    v_cvt_pk_bf16_f32 v251, v174, -v175
    ds_write_addtid_b32 v242 offset:0
    ds_write_addtid_b32 v243 offset:272
    ds_write_addtid_b32 v244 offset:544
    ds_write_addtid_b32 v245 offset:816
    ds_write_addtid_b32 v246 offset:1088
    ds_write_addtid_b32 v247 offset:1360
    ds_write_addtid_b32 v248 offset:1632
    ds_write_addtid_b32 v249 offset:1904
    ds_write_addtid_b32 v250 offset:2176
    ds_write_addtid_b32 v251 offset:2448
    v_pk_mul_f32 v[194:195], v[174:175], v[182:183] op_sel:[0,0] op_sel_hi:[0,1]
    v_pk_fma_f32 v[172:173], v[174:175], v[182:183], v[194:195] op_sel:[1,1,0] op_sel_hi:[1,0,1] neg_lo:[0,1,0]
    v_cvt_pk_bf16_f32 v242, v172, -v173
    v_pk_mul_f32 v[194:195], v[172:173], v[182:183] op_sel:[0,0] op_sel_hi:[0,1]
    v_pk_fma_f32 v[174:175], v[172:173], v[182:183], v[194:195] op_sel:[1,1,0] op_sel_hi:[1,0,1] neg_lo:[0,1,0]
    v_cvt_pk_bf16_f32 v243, v174, -v175
    v_pk_mul_f32 v[194:195], v[174:175], v[182:183] op_sel:[0,0] op_sel_hi:[0,1]
    v_pk_fma_f32 v[172:173], v[174:175], v[182:183], v[194:195] op_sel:[1,1,0] op_sel_hi:[1,0,1] neg_lo:[0,1,0]
    v_cvt_pk_bf16_f32 v244, v172, -v173
    v_pk_mul_f32 v[194:195], v[176:177], v[190:191] op_sel:[0,0] op_sel_hi:[0,1]
    v_pk_fma_f32 v[178:179], v[176:177], v[190:191], v[194:195] op_sel:[1,1,0] op_sel_hi:[1,0,1] neg_lo:[0,1,0]
    v_cvt_pk_bf16_f32 v245, v178, -v179
    v_pk_mul_f32 v[194:195], v[178:179], v[184:185] op_sel:[0,0] op_sel_hi:[0,1]
    v_pk_fma_f32 v[174:175], v[178:179], v[184:185], v[194:195] op_sel:[1,1,0] op_sel_hi:[1,0,1] neg_lo:[0,1,0]
    v_cvt_pk_bf16_f32 v246, v174, -v175
    v_pk_mul_f32 v[194:195], v[174:175], v[184:185] op_sel:[0,0] op_sel_hi:[0,1]
    v_pk_fma_f32 v[172:173], v[174:175], v[184:185], v[194:195] op_sel:[1,1,0] op_sel_hi:[1,0,1] neg_lo:[0,1,0]
    v_cvt_pk_bf16_f32 v247, v172, -v173
    v_pk_mul_f32 v[194:195], v[178:179], v[190:191] op_sel:[0,0] op_sel_hi:[0,1]
    v_pk_fma_f32 v[176:177], v[178:179], v[190:191], v[194:195] op_sel:[1,1,0] op_sel_hi:[1,0,1] neg_lo:[0,1,0]
    v_cvt_pk_bf16_f32 v248, v176, -v177
    v_pk_mul_f32 v[194:195], v[176:177], v[184:185] op_sel:[0,0] op_sel_hi:[0,1]
    v_pk_fma_f32 v[174:175], v[176:177], v[184:185], v[194:195] op_sel:[1,1,0] op_sel_hi:[1,0,1] neg_lo:[0,1,0]
    v_cvt_pk_bf16_f32 v249, v174, -v175
    v_pk_mul_f32 v[194:195], v[174:175], v[184:185] op_sel:[0,0] op_sel_hi:[0,1]
    v_pk_fma_f32 v[172:173], v[174:175], v[184:185], v[194:195] op_sel:[1,1,0] op_sel_hi:[1,0,1] neg_lo:[0,1,0]
    v_cvt_pk_bf16_f32 v250, v172, -v173
    v_pk_mul_f32 v[194:195], v[176:177], v[190:191] op_sel:[0,0] op_sel_hi:[0,1]
    v_pk_fma_f32 v[178:179], v[176:177], v[190:191], v[194:195] op_sel:[1,1,0] op_sel_hi:[1,0,1] neg_lo:[0,1,0]
    v_cvt_pk_bf16_f32 v251, v178, -v179
    ds_write_addtid_b32 v242 offset:2720
    ds_write_addtid_b32 v242 offset:3264
    ds_write_addtid_b32 v243 offset:3536
    ds_write_addtid_b32 v244 offset:3808
    ds_write_addtid_b32 v245 offset:4352
    ds_write_addtid_b32 v246 offset:4624
    ds_write_addtid_b32 v247 offset:4896
    ds_write_addtid_b32 v248 offset:5440
    ds_write_addtid_b32 v249 offset:5712
    ds_write_addtid_b32 v250 offset:5984
    ds_write_addtid_b32 v251 offset:6528
    v_pk_mul_f32 v[194:195], v[178:179], v[186:187] op_sel:[0,0] op_sel_hi:[0,1]
    v_pk_fma_f32 v[174:175], v[178:179], v[186:187], v[194:195] op_sel:[1,1,0] op_sel_hi:[1,0,1] neg_lo:[0,1,0]
    v_cvt_pk_bf16_f32 v242, v174, -v175
    v_pk_mul_f32 v[194:195], v[178:179], v[190:191] op_sel:[0,0] op_sel_hi:[0,1]
    v_pk_fma_f32 v[176:177], v[178:179], v[190:191], v[194:195] op_sel:[1,1,0] op_sel_hi:[1,0,1] neg_lo:[0,1,0]
    v_cvt_pk_bf16_f32 v243, v176, -v177
    v_pk_mul_f32 v[194:195], v[176:177], v[186:187] op_sel:[0,0] op_sel_hi:[0,1]
    v_pk_fma_f32 v[174:175], v[176:177], v[186:187], v[194:195] op_sel:[1,1,0] op_sel_hi:[1,0,1] neg_lo:[0,1,0]
    v_cvt_pk_bf16_f32 v244, v174, -v175
    v_pk_mul_f32 v[194:195], v[176:177], v[190:191] op_sel:[0,0] op_sel_hi:[0,1]
    v_pk_fma_f32 v[178:179], v[176:177], v[190:191], v[194:195] op_sel:[1,1,0] op_sel_hi:[1,0,1] neg_lo:[0,1,0]
    v_cvt_pk_bf16_f32 v245, v178, -v179
    v_pk_mul_f32 v[194:195], v[178:179], v[186:187] op_sel:[0,0] op_sel_hi:[0,1]
    v_pk_fma_f32 v[174:175], v[178:179], v[186:187], v[194:195] op_sel:[1,1,0] op_sel_hi:[1,0,1] neg_lo:[0,1,0]
    v_cvt_pk_bf16_f32 v246, v174, -v175
    v_pk_mul_f32 v[194:195], v[178:179], v[190:191] op_sel:[0,0] op_sel_hi:[0,1]
    v_pk_fma_f32 v[176:177], v[178:179], v[190:191], v[194:195] op_sel:[1,1,0] op_sel_hi:[1,0,1] neg_lo:[0,1,0]
    v_cvt_pk_bf16_f32 v247, v176, -v177
    v_pk_mul_f32 v[194:195], v[176:177], v[186:187] op_sel:[0,0] op_sel_hi:[0,1]
    v_pk_fma_f32 v[174:175], v[176:177], v[186:187], v[194:195] op_sel:[1,1,0] op_sel_hi:[1,0,1] neg_lo:[0,1,0]
    v_cvt_pk_bf16_f32 v248, v174, -v175
    ds_write_addtid_b32 v242 offset:6800
    ds_write_addtid_b32 v243 offset:7072
    ds_write_addtid_b32 v244 offset:7344
    ds_write_addtid_b32 v245 offset:7616
    ds_write_addtid_b32 v246 offset:7888
    ds_write_addtid_b32 v247 offset:8160
    ds_write_addtid_b32 v248 offset:8432
    ds_read_b128 a[192:195], v252 offset:0
    ds_read_b128 a[196:199], v252 offset:32
    ds_read_b128 a[200:203], v252 offset:64
    ds_read_b128 a[204:207], v252 offset:96
    ds_read_b128 a[208:211], v252 offset:128
    ds_read_b128 a[212:215], v252 offset:160
    ds_read_b128 a[216:219], v252 offset:192
    ds_read_b128 a[220:223], v252 offset:224
    s_add_u32 m0, s92, 36352
    s_nop 0
    buffer_load_dwordx4 v73, s[4:7], s99 offen offset:0  lds
    v_lshlrev_b32 v199, 16, v236
    v_mul_f32 v199, 0x3fb8aa3b, v199
    v_exp_f32 v199, v199
    v_lshlrev_b32 v255, 16, v237
    v_mul_f32 v255, v255, v253
    v_mul_f32 v255, 0x3e22f983, v255
    v_cvt_pk_bf16_f32 v199, v199, v199
    v_lshlrev_b32 v199, 16, v199
    v_mul_f32 v254, v199, v253
    v_mul_f32 v254, 0xbfb8aa3b, v254
    s_waitcnt lgkmcnt(7)
    v_mfma_f32_32x32x16_bf16 v[216:231], a[192:195], a[160:163], v[216:231]
    s_add_u32 m0, s92, 36352
    s_nop 0
    buffer_load_dwordx4 v74, s[4:7], s99 offen offset:1088  lds
    v_mul_f32 v182, 0x41000000, v254
    v_mul_f32 v185, 0x41000000, v255
    v_mul_f32 v184, 0x43800000, v254
    v_mul_f32 v189, 0x43800000, v255
    s_waitcnt lgkmcnt(6)
    v_mfma_f32_32x32x16_bf16 v[216:231], a[196:199], a[164:167], v[216:231]
    s_add_u32 m0, s92, 36352
    s_nop 0
    buffer_load_dwordx4 v75, s[4:7], s99 offen offset:2176  lds
    v_fract_f32 v185, v185
    v_fract_f32 v188, v255
    v_fract_f32 v189, v189
    v_exp_f32_e64 v182, v182
    s_waitcnt lgkmcnt(5)
    v_mfma_f32_32x32x16_bf16 v[216:231], a[200:203], a[168:171], v[216:231]
    s_add_u32 m0, s92, 36352
    s_nop 0
    buffer_load_dwordx4 v76, s[4:7], s99 offen offset:3264  lds
    v_exp_f32 v183, v254
    v_exp_f32 v184, v184
    v_cos_f32 v186, v185
    v_sin_f32 v187, v185
    s_waitcnt lgkmcnt(4)
    v_mfma_f32_32x32x16_bf16 v[216:231], a[204:207], a[172:175], v[216:231]
    s_add_u32 m0, s93, 53760
    s_add_u32 s99, s99, 256
    s_mov_b64 exec, s[80:81]
    buffer_load_dwordx4 v77, s[4:7], s100 offen  lds
    s_mov_b64 exec, -1
    s_add_u32 s100, s100, 256
    v_cos_f32 v180, v188
    v_sin_f32 v181, v188
    v_cos_f32 v190, v189
    v_sin_f32_e64 v191, v189
    s_waitcnt lgkmcnt(3)
    v_mfma_f32_32x32x16_bf16 v[216:231], a[208:211], a[176:179], v[216:231]
    s_add_u32 m0, s92, 55936
    s_nop 0
    buffer_load_dwordx4 v73, s[4:7], s99 offen offset:0  lds
    v_lshlrev_b32 v192, 16, v238
    v_lshlrev_b32 v193, 16, v239
    v_add_f32 v199, v253, v253
    v_mul_f32 v192, v192, v199
    s_waitcnt lgkmcnt(2)
    v_mfma_f32_32x32x16_bf16 v[216:231], a[212:215], a[180:183], v[216:231]
    s_add_u32 m0, s92, 55936
    s_nop 0
    buffer_load_dwordx4 v74, s[4:7], s99 offen offset:1088  lds
    v_mul_f32 v193, v193, v199
    v_mul_f32 v186, v186, v182
    v_mul_f32 v187, v187, v182
    v_mul_f32 v180, v180, v183
    s_waitcnt lgkmcnt(1)
    v_mfma_f32_32x32x16_bf16 v[216:231], a[216:219], a[184:187], v[216:231]
    s_add_u32 m0, s92, 55936
    s_nop 0
    buffer_load_dwordx4 v75, s[4:7], s99 offen offset:2176  lds
    v_mul_f32 v181, v181, v183
    v_mul_f32 v190, v190, v184
    v_mul_f32_e64 v191, v191, v184
    s_waitcnt lgkmcnt(0)
    v_mfma_f32_32x32x16_bf16 v[216:231], a[220:223], a[188:191], v[216:231]
    s_add_u32 m0, s92, 55936
    s_nop 0
    buffer_load_dwordx4 v76, s[4:7], s99 offen offset:3264  lds
    s_add_u32 m0, s93, 73344
    s_add_u32 s99, s99, 256
    s_mov_b64 exec, s[80:81]
    buffer_load_dwordx4 v77, s[4:7], s100 offen  lds
    s_mov_b64 exec, -1
    s_add_u32 s100, s100, 256
    s_add_u32 m0, s92, 75520
    s_nop 0
    buffer_load_dwordx4 v73, s[4:7], s99 offen offset:0  lds
    s_add_u32 m0, s92, 75520
    s_nop 0
    buffer_load_dwordx4 v74, s[4:7], s99 offen offset:1088  lds
    s_mov_b32 m0, s37
    v_mov_b32 v242, 0x3f80
    v_cvt_pk_bf16_f32 v243, v186, v187
    v_pk_mul_f32 v[194:195], v[186:187], v[186:187] op_sel:[0,0] op_sel_hi:[0,1]
    v_pk_fma_f32 v[172:173], v[186:187], v[186:187], v[194:195] op_sel:[1,1,0] op_sel_hi:[1,0,1] neg_lo:[0,1,0]
    v_cvt_pk_bf16_f32 v244, v172, v173
    v_pk_mul_f32 v[194:195], v[172:173], v[186:187] op_sel:[0,0] op_sel_hi:[0,1]
    v_pk_fma_f32 v[174:175], v[172:173], v[186:187], v[194:195] op_sel:[1,1,0] op_sel_hi:[1,0,1] neg_lo:[0,1,0]
    v_cvt_pk_bf16_f32 v245, v174, v175
    v_pk_mul_f32 v[194:195], v[174:175], v[186:187] op_sel:[0,0] op_sel_hi:[0,1]
    v_pk_fma_f32 v[172:173], v[174:175], v[186:187], v[194:195] op_sel:[1,1,0] op_sel_hi:[1,0,1] neg_lo:[0,1,0]
    v_cvt_pk_bf16_f32 v246, v172, v173
    v_pk_mul_f32 v[194:195], v[172:173], v[186:187] op_sel:[0,0] op_sel_hi:[0,1]
    v_pk_fma_f32 v[174:175], v[172:173], v[186:187], v[194:195] op_sel:[1,1,0] op_sel_hi:[1,0,1] neg_lo:[0,1,0]
    v_cvt_pk_bf16_f32 v247, v174, v175
    v_pk_mul_f32 v[194:195], v[174:175], v[186:187] op_sel:[0,0] op_sel_hi:[0,1]
    v_pk_fma_f32 v[172:173], v[174:175], v[186:187], v[194:195] op_sel:[1,1,0] op_sel_hi:[1,0,1] neg_lo:[0,1,0]
    v_cvt_pk_bf16_f32 v248, v172, v173
    v_pk_mul_f32 v[194:195], v[172:173], v[186:187] op_sel:[0,0] op_sel_hi:[0,1]
    v_pk_fma_f32 v[174:175], v[172:173], v[186:187], v[194:195] op_sel:[1,1,0] op_sel_hi:[1,0,1] neg_lo:[0,1,0]
    v_cvt_pk_bf16_f32 v249, v174, v175
    v_pk_mul_f32 v[194:195], v[174:175], v[186:187] op_sel:[0,0] op_sel_hi:[0,1]
    v_pk_fma_f32 v[172:173], v[174:175], v[186:187], v[194:195] op_sel:[1,1,0] op_sel_hi:[1,0,1] neg_lo:[0,1,0]
    v_cvt_pk_bf16_f32 v250, v172, v173
    v_pk_mul_f32 v[194:195], v[172:173], v[186:187] op_sel:[0,0] op_sel_hi:[0,1]
    s_waitcnt vmcnt(12)
    v_cmp_gt_u32 vcc, 32, v7
    s_nop 0
    s_and_b64 vcc, vcc, s[50:51]
    s_cbranch_scc1 ps_8
pc_10:
    s_barrier
    v_pk_fma_f32 v[174:175], v[172:173], v[186:187], v[194:195] op_sel:[1,1,0] op_sel_hi:[1,0,1] neg_lo:[0,1,0]
    v_cvt_pk_bf16_f32 v251, v174, v175
    ds_write_addtid_b32 v242 offset:0
    ds_write_addtid_b32 v243 offset:272
    ds_write_addtid_b32 v244 offset:544
    ds_write_addtid_b32 v245 offset:816
    ds_write_addtid_b32 v246 offset:1088
    ds_write_addtid_b32 v247 offset:1360
    ds_write_addtid_b32 v248 offset:1632
    ds_write_addtid_b32 v249 offset:1904
    ds_write_addtid_b32 v250 offset:2176
    ds_write_addtid_b32 v251 offset:2448
    v_pk_mul_f32 v[194:195], v[174:175], v[186:187] op_sel:[0,0] op_sel_hi:[0,1]
    v_pk_fma_f32 v[172:173], v[174:175], v[186:187], v[194:195] op_sel:[1,1,0] op_sel_hi:[1,0,1] neg_lo:[0,1,0]
    v_cvt_pk_bf16_f32 v242, v172, v173
    v_pk_mul_f32 v[194:195], v[172:173], v[186:187] op_sel:[0,0] op_sel_hi:[0,1]
    v_pk_fma_f32 v[174:175], v[172:173], v[186:187], v[194:195] op_sel:[1,1,0] op_sel_hi:[1,0,1] neg_lo:[0,1,0]
    v_cvt_pk_bf16_f32 v243, v174, v175
    buffer_load_dwordx4 a[0:3], v200, s[16:19], s101 offen offset:0 sc1
    v_pk_mul_f32 v[194:195], v[174:175], v[186:187] op_sel:[0,0] op_sel_hi:[0,1]
    v_pk_fma_f32 v[172:173], v[174:175], v[186:187], v[194:195] op_sel:[1,1,0] op_sel_hi:[1,0,1] neg_lo:[0,1,0]
    v_cvt_pk_bf16_f32 v244, v172, v173
    v_pk_mul_f32 v[194:195], v[172:173], v[186:187] op_sel:[0,0] op_sel_hi:[0,1]
    v_pk_fma_f32 v[174:175], v[172:173], v[186:187], v[194:195] op_sel:[1,1,0] op_sel_hi:[1,0,1] neg_lo:[0,1,0]
    v_cvt_pk_bf16_f32 v245, v174, v175
    v_pk_mul_f32 v[194:195], v[174:175], v[186:187] op_sel:[0,0] op_sel_hi:[0,1]
    v_pk_fma_f32 v[172:173], v[174:175], v[186:187], v[194:195] op_sel:[1,1,0] op_sel_hi:[1,0,1] neg_lo:[0,1,0]
    v_cvt_pk_bf16_f32 v246, v172, v173
    v_pk_mul_f32 v[194:195], v[172:173], v[186:187] op_sel:[0,0] op_sel_hi:[0,1]
    v_pk_fma_f32 v[174:175], v[172:173], v[186:187], v[194:195] op_sel:[1,1,0] op_sel_hi:[1,0,1] neg_lo:[0,1,0]
    v_cvt_pk_bf16_f32 v247, v174, v175
    v_pk_mul_f32 v[194:195], v[174:175], v[186:187] op_sel:[0,0] op_sel_hi:[0,1]
    v_pk_fma_f32 v[172:173], v[174:175], v[186:187], v[194:195] op_sel:[1,1,0] op_sel_hi:[1,0,1] neg_lo:[0,1,0]
    v_cvt_pk_bf16_f32 v248, v172, v173
    v_pk_mul_f32 v[194:195], v[172:173], v[186:187] op_sel:[0,0] op_sel_hi:[0,1]
    v_pk_fma_f32 v[174:175], v[172:173], v[186:187], v[194:195] op_sel:[1,1,0] op_sel_hi:[1,0,1] neg_lo:[0,1,0]
    v_cvt_pk_bf16_f32 v249, v174, v175
    buffer_load_dwordx4 a[4:7], v200, s[16:19], s101 offen offset:1024 sc1
    v_pk_mul_f32 v[194:195], v[174:175], v[186:187] op_sel:[0,0] op_sel_hi:[0,1]
    v_pk_fma_f32 v[172:173], v[174:175], v[186:187], v[194:195] op_sel:[1,1,0] op_sel_hi:[1,0,1] neg_lo:[0,1,0]
    v_cvt_pk_bf16_f32 v250, v172, v173
    v_pk_mul_f32 v[194:195], v[172:173], v[186:187] op_sel:[0,0] op_sel_hi:[0,1]
    v_pk_fma_f32 v[174:175], v[172:173], v[186:187], v[194:195] op_sel:[1,1,0] op_sel_hi:[1,0,1] neg_lo:[0,1,0]
    v_cvt_pk_bf16_f32 v251, v174, v175
    ds_write_addtid_b32 v242 offset:2720
    ds_write_addtid_b32 v243 offset:2992
    ds_write_addtid_b32 v244 offset:3264
    ds_write_addtid_b32 v245 offset:3536
    ds_write_addtid_b32 v246 offset:3808
    ds_write_addtid_b32 v247 offset:4080
    ds_write_addtid_b32 v248 offset:4352
    ds_write_addtid_b32 v249 offset:4624
    ds_write_addtid_b32 v250 offset:4896
    ds_write_addtid_b32 v251 offset:5168
    v_pk_mul_f32 v[194:195], v[174:175], v[186:187] op_sel:[0,0] op_sel_hi:[0,1]
    v_pk_fma_f32 v[172:173], v[174:175], v[186:187], v[194:195] op_sel:[1,1,0] op_sel_hi:[1,0,1] neg_lo:[0,1,0]
    buffer_load_dwordx4 a[8:11], v200, s[16:19], s101 offen offset:2048 sc1
    v_cvt_pk_bf16_f32 v242, v172, v173
    v_pk_mul_f32 v[194:195], v[172:173], v[186:187] op_sel:[0,0] op_sel_hi:[0,1]
    v_pk_fma_f32 v[174:175], v[172:173], v[186:187], v[194:195] op_sel:[1,1,0] op_sel_hi:[1,0,1] neg_lo:[0,1,0]
    v_cvt_pk_bf16_f32 v243, v174, v175
    v_pk_mul_f32 v[194:195], v[174:175], v[186:187] op_sel:[0,0] op_sel_hi:[0,1]
    v_pk_fma_f32 v[172:173], v[174:175], v[186:187], v[194:195] op_sel:[1,1,0] op_sel_hi:[1,0,1] neg_lo:[0,1,0]
    v_cvt_pk_bf16_f32 v244, v172, v173
    v_pk_mul_f32 v[194:195], v[172:173], v[186:187] op_sel:[0,0] op_sel_hi:[0,1]
    v_pk_fma_f32 v[174:175], v[172:173], v[186:187], v[194:195] op_sel:[1,1,0] op_sel_hi:[1,0,1] neg_lo:[0,1,0]
    v_cvt_pk_bf16_f32 v245, v174, v175
    v_pk_mul_f32 v[194:195], v[174:175], v[186:187] op_sel:[0,0] op_sel_hi:[0,1]
    v_pk_fma_f32 v[172:173], v[174:175], v[186:187], v[194:195] op_sel:[1,1,0] op_sel_hi:[1,0,1] neg_lo:[0,1,0]
    v_cvt_pk_bf16_f32 v246, v172, v173
    v_pk_mul_f32 v[194:195], v[172:173], v[186:187] op_sel:[0,0] op_sel_hi:[0,1]
    v_pk_fma_f32 v[174:175], v[172:173], v[186:187], v[194:195] op_sel:[1,1,0] op_sel_hi:[1,0,1] neg_lo:[0,1,0]
    v_cvt_pk_bf16_f32 v247, v174, v175
    v_pk_mul_f32 v[194:195], v[174:175], v[186:187] op_sel:[0,0] op_sel_hi:[0,1]
    v_pk_fma_f32 v[172:173], v[174:175], v[186:187], v[194:195] op_sel:[1,1,0] op_sel_hi:[1,0,1] neg_lo:[0,1,0]
    buffer_load_dwordx4 a[12:15], v200, s[16:19], s101 offen offset:3072 sc1
    v_cvt_pk_bf16_f32 v248, v172, v173
    v_pk_mul_f32 v[194:195], v[172:173], v[186:187] op_sel:[0,0] op_sel_hi:[0,1]
    v_pk_fma_f32 v[174:175], v[172:173], v[186:187], v[194:195] op_sel:[1,1,0] op_sel_hi:[1,0,1] neg_lo:[0,1,0]
    v_cvt_pk_bf16_f32 v249, v174, v175
    v_pk_mul_f32 v[194:195], v[174:175], v[186:187] op_sel:[0,0] op_sel_hi:[0,1]
    v_pk_fma_f32 v[172:173], v[174:175], v[186:187], v[194:195] op_sel:[1,1,0] op_sel_hi:[1,0,1] neg_lo:[0,1,0]
    v_cvt_pk_bf16_f32 v250, v172, v173
    v_pk_mul_f32 v[194:195], v[172:173], v[186:187] op_sel:[0,0] op_sel_hi:[0,1]
    v_pk_fma_f32 v[174:175], v[172:173], v[186:187], v[194:195] op_sel:[1,1,0] op_sel_hi:[1,0,1] neg_lo:[0,1,0]
    v_cvt_pk_bf16_f32 v251, v174, v175
    ds_write_addtid_b32 v242 offset:5440
    ds_write_addtid_b32 v243 offset:5712
    ds_write_addtid_b32 v244 offset:5984
    ds_write_addtid_b32 v245 offset:6256
    ds_write_addtid_b32 v246 offset:6528
    ds_write_addtid_b32 v247 offset:6800
    ds_write_addtid_b32 v248 offset:7072
    ds_write_addtid_b32 v249 offset:7344
    s_add_u32 s101, s101, 4096
    buffer_load_dwordx4 a[16:19], v200, s[16:19], s101 offen offset:0 sc1
    ds_write_addtid_b32 v250 offset:7616
    ds_write_addtid_b32 v251 offset:7888
    v_pk_mul_f32 v[194:195], v[174:175], v[186:187] op_sel:[0,0] op_sel_hi:[0,1]
    v_pk_fma_f32 v[172:173], v[174:175], v[186:187], v[194:195] op_sel:[1,1,0] op_sel_hi:[1,0,1] neg_lo:[0,1,0]
    v_cvt_pk_bf16_f32 v242, v172, v173
    v_pk_mul_f32 v[194:195], v[172:173], v[186:187] op_sel:[0,0] op_sel_hi:[0,1]
    v_pk_fma_f32 v[174:175], v[172:173], v[186:187], v[194:195] op_sel:[1,1,0] op_sel_hi:[1,0,1] neg_lo:[0,1,0]
    v_cvt_pk_bf16_f32 v243, v174, v175
    ds_write_addtid_b32 v242 offset:8160
    ds_write_addtid_b32 v243 offset:8432
    ds_read_b128 a[160:163], v252 offset:0
    ds_read_b128 a[164:167], v252 offset:32
    ds_read_b128 a[168:171], v252 offset:64
    ds_read_b128 a[172:175], v252 offset:96
    ds_read_b128 a[176:179], v252 offset:128
    ds_read_b128 a[180:183], v252 offset:160
    ds_read_b128 a[184:187], v252 offset:192
    ds_read_b128 a[188:191], v252 offset:224
    buffer_load_dwordx4 a[20:23], v200, s[16:19], s101 offen offset:1024 sc1
    v_pk_mul_f32 v[194:195], v[180:181], v[180:181] op_sel:[0,0] op_sel_hi:[0,1]
    v_pk_fma_f32 v[182:183], v[180:181], v[180:181], v[194:195] op_sel:[1,1,0] op_sel_hi:[1,0,1] neg_lo:[0,1,0]
    v_pk_mul_f32 v[194:195], v[182:183], v[182:183] op_sel:[0,0] op_sel_hi:[0,1]
    v_pk_fma_f32 v[184:185], v[182:183], v[182:183], v[194:195] op_sel:[1,1,0] op_sel_hi:[1,0,1] neg_lo:[0,1,0]
    v_cvt_pk_bf16_f32 v242, v192, -v193
    v_pk_mul_f32 v[194:195], v[192:193], v[180:181] op_sel:[0,0] op_sel_hi:[0,1]
    v_pk_fma_f32 v[174:175], v[192:193], v[180:181], v[194:195] op_sel:[1,1,0] op_sel_hi:[1,0,1] neg_lo:[0,1,0]
    v_cvt_pk_bf16_f32 v243, v174, -v175
    v_pk_mul_f32 v[194:195], v[174:175], v[180:181] op_sel:[0,0] op_sel_hi:[0,1]
    v_pk_fma_f32 v[172:173], v[174:175], v[180:181], v[194:195] op_sel:[1,1,0] op_sel_hi:[1,0,1] neg_lo:[0,1,0]
    v_cvt_pk_bf16_f32 v244, v172, -v173
    v_pk_mul_f32 v[194:195], v[172:173], v[180:181] op_sel:[0,0] op_sel_hi:[0,1]
    v_pk_fma_f32 v[174:175], v[172:173], v[180:181], v[194:195] op_sel:[1,1,0] op_sel_hi:[1,0,1] neg_lo:[0,1,0]
    v_cvt_pk_bf16_f32 v245, v174, -v175
    v_pk_mul_f32 v[194:195], v[174:175], v[180:181] op_sel:[0,0] op_sel_hi:[0,1]
    v_pk_fma_f32 v[172:173], v[174:175], v[180:181], v[194:195] op_sel:[1,1,0] op_sel_hi:[1,0,1] neg_lo:[0,1,0]
    v_cvt_pk_bf16_f32 v246, v172, -v173
    v_pk_mul_f32 v[194:195], v[172:173], v[180:181] op_sel:[0,0] op_sel_hi:[0,1]
    buffer_load_dwordx4 a[24:27], v200, s[16:19], s101 offen offset:2048 sc1
    v_pk_fma_f32 v[174:175], v[172:173], v[180:181], v[194:195] op_sel:[1,1,0] op_sel_hi:[1,0,1] neg_lo:[0,1,0]
    v_cvt_pk_bf16_f32 v247, v174, -v175
    v_pk_mul_f32 v[194:195], v[174:175], v[180:181] op_sel:[0,0] op_sel_hi:[0,1]
    v_pk_fma_f32 v[172:173], v[174:175], v[180:181], v[194:195] op_sel:[1,1,0] op_sel_hi:[1,0,1] neg_lo:[0,1,0]
    v_cvt_pk_bf16_f32 v248, v172, -v173
    v_pk_mul_f32 v[194:195], v[172:173], v[180:181] op_sel:[0,0] op_sel_hi:[0,1]
    v_pk_fma_f32 v[174:175], v[172:173], v[180:181], v[194:195] op_sel:[1,1,0] op_sel_hi:[1,0,1] neg_lo:[0,1,0]
    v_cvt_pk_bf16_f32 v249, v174, -v175
    v_pk_mul_f32 v[194:195], v[192:193], v[190:191] op_sel:[0,0] op_sel_hi:[0,1]
    v_pk_fma_f32 v[176:177], v[192:193], v[190:191], v[194:195] op_sel:[1,1,0] op_sel_hi:[1,0,1] neg_lo:[0,1,0]
    v_cvt_pk_bf16_f32 v250, v176, -v177
    v_pk_mul_f32 v[194:195], v[176:177], v[182:183] op_sel:[0,0] op_sel_hi:[0,1]
    v_pk_fma_f32 v[174:175], v[176:177], v[182:183], v[194:195] op_sel:[1,1,0] op_sel_hi:[1,0,1] neg_lo:[0,1,0]
    v_cvt_pk_bf16_f32 v251, v174, -v175
    ds_write_addtid_b32 v242 offset:0
    ds_write_addtid_b32 v243 offset:272
    ds_write_addtid_b32 v244 offset:544
    ds_write_addtid_b32 v245 offset:816
    buffer_load_dwordx4 a[28:31], v200, s[16:19], s101 offen offset:3072 sc1
    ds_write_addtid_b32 v246 offset:1088
    ds_write_addtid_b32 v247 offset:1360
    ds_write_addtid_b32 v248 offset:1632
    ds_write_addtid_b32 v249 offset:1904
    ds_write_addtid_b32 v250 offset:2176
    ds_write_addtid_b32 v251 offset:2448
    v_pk_mul_f32 v[194:195], v[174:175], v[182:183] op_sel:[0,0] op_sel_hi:[0,1]
    v_pk_fma_f32 v[172:173], v[174:175], v[182:183], v[194:195] op_sel:[1,1,0] op_sel_hi:[1,0,1] neg_lo:[0,1,0]
    v_cvt_pk_bf16_f32 v242, v172, -v173
    v_pk_mul_f32 v[194:195], v[172:173], v[182:183] op_sel:[0,0] op_sel_hi:[0,1]
    v_pk_fma_f32 v[174:175], v[172:173], v[182:183], v[194:195] op_sel:[1,1,0] op_sel_hi:[1,0,1] neg_lo:[0,1,0]
    v_cvt_pk_bf16_f32 v243, v174, -v175
    v_pk_mul_f32 v[194:195], v[174:175], v[182:183] op_sel:[0,0] op_sel_hi:[0,1]
    v_pk_fma_f32 v[172:173], v[174:175], v[182:183], v[194:195] op_sel:[1,1,0] op_sel_hi:[1,0,1] neg_lo:[0,1,0]
    v_cvt_pk_bf16_f32 v244, v172, -v173
    v_pk_mul_f32 v[194:195], v[176:177], v[190:191] op_sel:[0,0] op_sel_hi:[0,1]
    v_pk_fma_f32 v[178:179], v[176:177], v[190:191], v[194:195] op_sel:[1,1,0] op_sel_hi:[1,0,1] neg_lo:[0,1,0]
    v_cvt_pk_bf16_f32 v245, v178, -v179
    s_add_u32 s101, s101, 4096
    buffer_load_dwordx4 a[32:35], v200, s[16:19], s101 offen offset:0 sc1
    v_pk_mul_f32 v[194:195], v[178:179], v[184:185] op_sel:[0,0] op_sel_hi:[0,1]
    v_pk_fma_f32 v[174:175], v[178:179], v[184:185], v[194:195] op_sel:[1,1,0] op_sel_hi:[1,0,1] neg_lo:[0,1,0]
    v_cvt_pk_bf16_f32 v246, v174, -v175
    v_pk_mul_f32 v[194:195], v[174:175], v[184:185] op_sel:[0,0] op_sel_hi:[0,1]
    v_pk_fma_f32 v[172:173], v[174:175], v[184:185], v[194:195] op_sel:[1,1,0] op_sel_hi:[1,0,1] neg_lo:[0,1,0]
    v_cvt_pk_bf16_f32 v247, v172, -v173
    v_pk_mul_f32 v[194:195], v[178:179], v[190:191] op_sel:[0,0] op_sel_hi:[0,1]
    v_pk_fma_f32 v[176:177], v[178:179], v[190:191], v[194:195] op_sel:[1,1,0] op_sel_hi:[1,0,1] neg_lo:[0,1,0]
    v_cvt_pk_bf16_f32 v248, v176, -v177
    v_pk_mul_f32 v[194:195], v[176:177], v[184:185] op_sel:[0,0] op_sel_hi:[0,1]
    v_pk_fma_f32 v[174:175], v[176:177], v[184:185], v[194:195] op_sel:[1,1,0] op_sel_hi:[1,0,1] neg_lo:[0,1,0]
    v_cvt_pk_bf16_f32 v249, v174, -v175
    v_pk_mul_f32 v[194:195], v[174:175], v[184:185] op_sel:[0,0] op_sel_hi:[0,1]
    v_pk_fma_f32 v[172:173], v[174:175], v[184:185], v[194:195] op_sel:[1,1,0] op_sel_hi:[1,0,1] neg_lo:[0,1,0]
    v_cvt_pk_bf16_f32 v250, v172, -v173
    v_pk_mul_f32 v[194:195], v[176:177], v[190:191] op_sel:[0,0] op_sel_hi:[0,1]
    v_pk_fma_f32 v[178:179], v[176:177], v[190:191], v[194:195] op_sel:[1,1,0] op_sel_hi:[1,0,1] neg_lo:[0,1,0]
    v_cvt_pk_bf16_f32 v251, v178, -v179
    buffer_load_dwordx4 a[36:39], v200, s[16:19], s101 offen offset:1024 sc1
    ds_write_addtid_b32 v242 offset:2720
    ds_write_addtid_b32 v242 offset:3264
    ds_write_addtid_b32 v243 offset:3536
    ds_write_addtid_b32 v244 offset:3808
    ds_write_addtid_b32 v245 offset:4352
    ds_write_addtid_b32 v246 offset:4624
    ds_write_addtid_b32 v247 offset:4896
    ds_write_addtid_b32 v248 offset:5440
    ds_write_addtid_b32 v249 offset:5712
    ds_write_addtid_b32 v250 offset:5984
    ds_write_addtid_b32 v251 offset:6528
    v_pk_mul_f32 v[194:195], v[178:179], v[186:187] op_sel:[0,0] op_sel_hi:[0,1]
    v_pk_fma_f32 v[174:175], v[178:179], v[186:187], v[194:195] op_sel:[1,1,0] op_sel_hi:[1,0,1] neg_lo:[0,1,0]
    v_cvt_pk_bf16_f32 v242, v174, -v175
    v_pk_mul_f32 v[194:195], v[178:179], v[190:191] op_sel:[0,0] op_sel_hi:[0,1]
    v_pk_fma_f32 v[176:177], v[178:179], v[190:191], v[194:195] op_sel:[1,1,0] op_sel_hi:[1,0,1] neg_lo:[0,1,0]
    v_cvt_pk_bf16_f32 v243, v176, -v177
    v_pk_mul_f32 v[194:195], v[176:177], v[186:187] op_sel:[0,0] op_sel_hi:[0,1]
    buffer_load_dwordx4 a[40:43], v200, s[16:19], s101 offen offset:2048 sc1
    v_pk_fma_f32 v[174:175], v[176:177], v[186:187], v[194:195] op_sel:[1,1,0] op_sel_hi:[1,0,1] neg_lo:[0,1,0]
    v_cvt_pk_bf16_f32 v244, v174, -v175
    v_pk_mul_f32 v[194:195], v[176:177], v[190:191] op_sel:[0,0] op_sel_hi:[0,1]
    v_pk_fma_f32 v[178:179], v[176:177], v[190:191], v[194:195] op_sel:[1,1,0] op_sel_hi:[1,0,1] neg_lo:[0,1,0]
    v_cvt_pk_bf16_f32 v245, v178, -v179
    v_pk_mul_f32 v[194:195], v[178:179], v[186:187] op_sel:[0,0] op_sel_hi:[0,1]
    v_pk_fma_f32 v[174:175], v[178:179], v[186:187], v[194:195] op_sel:[1,1,0] op_sel_hi:[1,0,1] neg_lo:[0,1,0]
    v_cvt_pk_bf16_f32 v246, v174, -v175
    v_pk_mul_f32 v[194:195], v[178:179], v[190:191] op_sel:[0,0] op_sel_hi:[0,1]
    v_pk_fma_f32 v[176:177], v[178:179], v[190:191], v[194:195] op_sel:[1,1,0] op_sel_hi:[1,0,1] neg_lo:[0,1,0]
    v_cvt_pk_bf16_f32 v247, v176, -v177
    v_pk_mul_f32 v[194:195], v[176:177], v[186:187] op_sel:[0,0] op_sel_hi:[0,1]
    v_pk_fma_f32 v[174:175], v[176:177], v[186:187], v[194:195] op_sel:[1,1,0] op_sel_hi:[1,0,1] neg_lo:[0,1,0]
    v_cvt_pk_bf16_f32 v248, v174, -v175
    ds_write_addtid_b32 v242 offset:6800
    ds_write_addtid_b32 v243 offset:7072
    ds_write_addtid_b32 v244 offset:7344
    ds_write_addtid_b32 v245 offset:7616
    buffer_load_dwordx4 a[44:47], v200, s[16:19], s101 offen offset:3072 sc1
    ds_write_addtid_b32 v246 offset:7888
    ds_write_addtid_b32 v247 offset:8160
    ds_write_addtid_b32 v248 offset:8432
    ds_read_b128 a[192:195], v252 offset:0
    ds_read_b128 a[196:199], v252 offset:32
    ds_read_b128 a[200:203], v252 offset:64
    ds_read_b128 a[204:207], v252 offset:96
    ds_read_b128 a[208:211], v252 offset:128
    ds_read_b128 a[212:215], v252 offset:160
    ds_read_b128 a[216:219], v252 offset:192
    ds_read_b128 a[220:223], v252 offset:224
    s_add_u32 m0, s92, 75520
    s_nop 0
    buffer_load_dwordx4 v75, s[4:7], s99 offen offset:2176  lds
    s_waitcnt lgkmcnt(7)
    v_mfma_f32_32x32x16_bf16 v[216:231], a[192:195], a[160:163], v[216:231]
    s_add_u32 m0, s92, 75520
    s_nop 0
    buffer_load_dwordx4 v76, s[4:7], s99 offen offset:3264  lds
    s_waitcnt lgkmcnt(6)
    v_mfma_f32_32x32x16_bf16 v[216:231], a[196:199], a[164:167], v[216:231]
    s_add_u32 m0, s93, 92928
    s_add_u32 s101, s101, 4096
    buffer_load_dwordx4 a[48:51], v200, s[16:19], s101 offen offset:0 sc1
    s_add_u32 s99, s99, 256
    s_mov_b64 exec, s[80:81]
    buffer_load_dwordx4 v77, s[4:7], s100 offen  lds
    s_mov_b64 exec, -1
    s_add_u32 s100, s100, 256
    s_waitcnt lgkmcnt(5)
    v_mfma_f32_32x32x16_bf16 v[216:231], a[200:203], a[168:171], v[216:231]
    s_add_u32 m0, s92, 95104
    s_nop 0
    buffer_load_dwordx4 v73, s[4:7], s99 offen offset:0  lds
    s_waitcnt lgkmcnt(4)
    v_mfma_f32_32x32x16_bf16 v[216:231], a[204:207], a[172:175], v[216:231]
    s_add_u32 m0, s92, 95104
    s_nop 0
    buffer_load_dwordx4 v74, s[4:7], s99 offen offset:1088  lds
    s_waitcnt lgkmcnt(3)
    v_mfma_f32_32x32x16_bf16 v[216:231], a[208:211], a[176:179], v[216:231]
    s_add_u32 m0, s92, 95104
    s_nop 0
    buffer_load_dwordx4 v75, s[4:7], s99 offen offset:2176  lds
    s_waitcnt lgkmcnt(2)
    v_mfma_f32_32x32x16_bf16 v[216:231], a[212:215], a[180:183], v[216:231]
    s_add_u32 m0, s92, 95104
    s_nop 0
    buffer_load_dwordx4 v76, s[4:7], s99 offen offset:3264  lds
    s_waitcnt lgkmcnt(1)
    v_mfma_f32_32x32x16_bf16 v[216:231], a[216:219], a[184:187], v[216:231]
    buffer_load_dwordx4 a[52:55], v200, s[16:19], s101 offen offset:1024 sc1
    s_add_u32 m0, s93, 112512
    s_add_u32 s99, s99, 256
    s_mov_b64 exec, s[80:81]
    buffer_load_dwordx4 v77, s[4:7], s100 offen  lds
    s_mov_b64 exec, -1
    s_add_u32 s100, s100, 256
    s_waitcnt lgkmcnt(0)
    v_mfma_f32_32x32x16_bf16 v[216:231], a[220:223], a[188:191], v[216:231]
    s_add_u32 m0, s92, 114688
    s_nop 0
    buffer_load_dwordx4 v73, s[4:7], s99 offen offset:0  lds
    s_add_u32 m0, s92, 114688
    s_nop 0
    buffer_load_dwordx4 v74, s[4:7], s99 offen offset:1088  lds
    s_add_u32 m0, s92, 114688
    s_nop 0
    buffer_load_dwordx4 v75, s[4:7], s99 offen offset:2176  lds
    s_add_u32 m0, s92, 114688
    s_nop 0
    buffer_load_dwordx4 v76, s[4:7], s99 offen offset:3264  lds
    s_add_u32 m0, s93, 132096
    s_add_u32 s99, s99, 256
    s_mov_b64 exec, s[80:81]
    buffer_load_dwordx4 v77, s[4:7], s100 offen  lds
    s_mov_b64 exec, -1
    s_add_u32 s100, s100, 256
    s_mov_b32 m0, s37
    s_branch ec_4
nc_3:
    s_sub_u32 s33, s2, 160
    s_min_u32 s33, s33, 159
    s_mul_i32 s29, s33, 3277
    s_lshr_b32 s29, s29, 16
    s_mul_i32 s30, s29, 20
    s_sub_u32 s30, s33, s30
    s_mul_i32 s31, s30, 13108
    s_lshr_b32 s31, s31, 16
    s_mul_i32 s32, s31, 5
    s_sub_u32 s32, s30, s32
    s_lshl_b32 s28, s24, 10
    s_lshr_b32 s34, s32, 1
    s_mul_i32 s34, s34, 20
    s_and_b32 s35, s32, 1
    s_lshl_b32 s35, s35, 3
    s_add_u32 s34, s34, s35
    s_cmp_eq_u32 s32, 4
    s_cselect_b32 s34, 16, s34
    s_cselect_b32 s35, 20, 4
    s_mul_i32 s36, s31, 160
    s_add_u32 s34, s34, s36
    s_mul_i32 s34, s34, 1280
    s_mul_i32 s36, s29, 160
    s_add_u32 s34, s34, s36
    v_add_u32 v162, 0, v0
    v_mul_u32_u24 v160, 6554, v162
    v_lshrrev_b32 v160, 16, v160
    v_mul_u32_u24 v161, 10, v160
    v_sub_u32 v161, v162, v161
    v_lshrrev_b32 v163, 3, v160
    v_mul_u32_u24 v163, 40, v163
    v_bfe_u32 v164, v160, 2, 1
    v_mul_u32_u24 v164, s35, v164
    v_and_b32_e64 v160, 3, v160
    v_add3_u32 v160, v160, v163, v164
    v_mul_u32_u24 v160, 1280, v160
    v_lshl_add_u32 v162, v161, 4, v160
    s_add_u32 m0, s28, 0
    s_nop 0
    buffer_load_dwordx4 v162, s[12:15], s34 offen lds
    v_add_u32 v162, 256, v0
    v_min_u32 v162, 319, v162
    v_mul_u32_u24 v160, 6554, v162
    v_lshrrev_b32 v160, 16, v160
    v_mul_u32_u24 v161, 10, v160
    v_sub_u32 v161, v162, v161
    v_lshrrev_b32 v163, 3, v160
    v_mul_u32_u24 v163, 40, v163
    v_bfe_u32 v164, v160, 2, 1
    v_mul_u32_u24 v164, s35, v164
    v_and_b32_e64 v160, 3, v160
    v_add3_u32 v160, v160, v163, v164
    v_mul_u32_u24 v160, 1280, v160
    v_lshl_add_u32 v162, v161, 4, v160
    s_add_u32 m0, s28, 4096
    s_nop 0
    buffer_load_dwordx4 v162, s[12:15], s34 offen lds
    v_bfe_u32 v163, v0, 4, 2
    v_bfe_u32 v164, v0, 2, 2
    v_lshl_add_u32 v163, v163, 3, v164
    v_mul_u32_u24 v163, 160, v163
    v_and_b32 v164, 3, v0
    v_lshl_add_u32 v165, v164, 3, v163
    v_add_u32 v165, 0, v165
    s_lshl_b32 s36, s24, 5
    v_add_u32_e64 v166, s36, v165
    s_mul_i32 s33, s33, 5120
    s_add_u32 s33, s33, 2621440
    v_lshl_add_u32 v167, v1, 4, s33
    v_add_u32 v164, 4096, v167
    v_mov_b32 v163, 1073741824
    v_cmp_gt_u32 vcc, 64, v0
    s_sub_u32 s36, s24, s31
    s_and_b32 s36, s36, 3
    s_lshl_b32 s36, s36, 10
    v_cndmask_b32 v168, v163, v164, vcc
    v_add_u32 v167, s36, v167
    s_sub_u32 s33, s2, 64
    s_min_u32 s33, s33, 159
    s_mul_i32 s29, s33, 3277
    s_lshr_b32 s29, s29, 16
    s_mul_i32 s30, s29, 20
    s_sub_u32 s30, s33, s30
    s_mul_i32 s31, s30, 13108
    s_lshr_b32 s31, s31, 16
    s_mul_i32 s32, s31, 5
    s_sub_u32 s32, s30, s32
    s_lshl_b32 s28, s24, 10
    s_lshr_b32 s34, s32, 1
    s_mul_i32 s34, s34, 20
    s_and_b32 s35, s32, 1
    s_lshl_b32 s35, s35, 3
    s_add_u32 s34, s34, s35
    s_cmp_eq_u32 s32, 4
    s_cselect_b32 s34, 16, s34
    s_cselect_b32 s35, 20, 4
    s_mul_i32 s36, s31, 160
    s_add_u32 s34, s34, s36
    s_mul_i32 s34, s34, 1280
    s_mul_i32 s36, s29, 160
    s_add_u32 s34, s34, s36
    v_add_u32 v182, 0, v0
    v_mul_u32_u24 v180, 6554, v182
    v_lshrrev_b32 v180, 16, v180
    v_mul_u32_u24 v181, 10, v180
    v_sub_u32 v181, v182, v181
    v_lshrrev_b32 v183, 3, v180
    v_mul_u32_u24 v183, 40, v183
    v_bfe_u32 v184, v180, 2, 1
    v_mul_u32_u24 v184, s35, v184
    v_and_b32_e64 v180, 3, v180
    v_add3_u32 v180, v180, v183, v184
    v_mul_u32_u24 v180, 1280, v180
    v_lshl_add_u32 v182, v181, 4, v180
    s_add_u32 m0, s28, 8192
    s_nop 0
    buffer_load_dwordx4 v182, s[12:15], s34 offen lds
    v_add_u32 v182, 256, v0
    v_min_u32 v182, 319, v182
    v_mul_u32_u24 v180, 6554, v182
    v_lshrrev_b32 v180, 16, v180
    v_mul_u32_u24 v181, 10, v180
    v_sub_u32 v181, v182, v181
    v_lshrrev_b32 v183, 3, v180
    v_mul_u32_u24 v183, 40, v183
    v_bfe_u32 v184, v180, 2, 1
    v_mul_u32_u24 v184, s35, v184
    v_and_b32 v180, 3, v180
    v_add3_u32 v180, v180, v183, v184
    v_mul_u32_u24 v180, 1280, v180
    v_lshl_add_u32 v182, v181, 4, v180
    s_add_u32 m0, s28, 12288
    s_nop 0
    buffer_load_dwordx4 v182, s[12:15], s34 offen lds
    v_bfe_u32 v183, v0, 4, 2
    v_bfe_u32 v184, v0, 2, 2
    v_lshl_add_u32 v183, v183, 3, v184
    v_mul_u32_u24 v183, 160, v183
    v_and_b32 v184, 3, v0
    v_lshl_add_u32 v185, v184, 3, v183
    v_add_u32 v185, 8192, v185
    s_lshl_b32 s36, s24, 5
    v_add_u32 v186, s36, v185
    s_mul_i32 s33, s33, 5120
    s_add_u32 s33, s33, 2621440
    v_lshl_add_u32 v187, v1, 4, s33
    v_add_u32 v184, 4096, v187
    v_mov_b32 v183, 1073741824
    v_cmp_gt_u32 vcc, 64, v0
    s_sub_u32 s36, s24, s31
    s_and_b32 s36, s36, 3
    s_lshl_b32 s36, s36, 10
    v_cndmask_b32 v188, v183, v184, vcc
    v_add_u32 v187, s36, v187
    v_mov_b32 v216, 0
    v_mov_b32 v217, 0
    v_mov_b32 v218, 0
    v_mov_b32 v219, 0
    v_mov_b32 v220, 0
    v_mov_b32 v221, 0
    v_mov_b32 v222, 0
    v_mov_b32 v223, 0
    v_mov_b32 v224, 0
    v_mov_b32 v225, 0
    v_mov_b32 v226, 0
    v_mov_b32 v227, 0
    v_mov_b32 v228, 0
    v_mov_b32 v229, 0
    v_mov_b32 v230, 0
    v_mov_b32_e64 v231, 0
    s_waitcnt vmcnt(5)
    s_barrier
    ds_read_b64_tr_b16 v[96:97], v111
    ds_read_b64_tr_b16 v[98:99], v111 offset:2560
    ds_read_b64_tr_b16 v[100:101], v112
    ds_read_b64_tr_b16 v[102:103], v112 offset:2560
    ds_read_b64_tr_b16 v[104:105], v113
    ds_read_b64_tr_b16 v[106:107], v113 offset:2560
    s_waitcnt lgkmcnt(4)
    buffer_store_dwordx4 v[96:99], v108, s[16:19], 0 offen sc1
    s_waitcnt lgkmcnt(2)
    buffer_store_dwordx4 v[100:103], v109, s[16:19], 0 offen sc1
    s_waitcnt lgkmcnt(0)
    buffer_store_dwordx4 v[104:107], v110, s[16:19], 0 offen sc1
    global_load_dword v7, v5, s[66:67] sc1
    v_lshrrev_b32 v132, 5, v0
    v_and_b32_e64 v133, 31, v0
    v_mul_u32_u24 v132, 1280, v132
    v_lshl_add_u32 v134, v133, 4, v132
    v_mov_b32 v135, 1073741824
    v_cmp_gt_u32 vcc, 16, v133
    s_mul_i32 s96, s2, 10240
    buffer_load_dwordx4 v[120:123], v134, s[4:7], s96 offen
    v_cndmask_b32_e64 v135, v135, v134, vcc
    buffer_load_dwordx4 v[124:127], v134, s[4:7], s96 offen offset:512
    buffer_load_dwordx4 v[128:131], v135, s[4:7], s96 offen offset:1024
    s_waitcnt vmcnt(4)
    s_waitcnt vmcnt(3)
    v_cmp_gt_u32 vcc, 1, v7
    s_nop 0
    s_and_b64 vcc, vcc, s[50:51]
    s_and_b64 vcc, vcc, 1
    s_cbranch_scc1 ps_11
pc_13:
    s_barrier
    v_lshlrev_b32 v2, 3, v4
    v_mov_b32 v5, 1
    v_cndmask_b32 v2, v4, v2, s[50:51]
    buffer_atomic_add v5, v2, s[16:19], s86 offen offset:0 sc1
    ds_read_b64_tr_b16 v[172:173], v166
    ds_read_b64_tr_b16 v[174:175], v166 offset:640
    ds_read_b64_tr_b16 v[176:177], v165 offset:128
    ds_read_b64_tr_b16 v[178:179], v165 offset:768
    s_waitcnt lgkmcnt(2)
    buffer_store_dwordx4 v[172:175], v167, s[16:19], 0 offen sc1
    s_waitcnt lgkmcnt(0)
    buffer_store_dwordx4 v[176:179], v168, s[16:19], 0 offen sc1
    ds_read_b64_tr_b16 v[192:193], v186
    ds_read_b64_tr_b16 v[194:195], v186 offset:640
    ds_read_b64_tr_b16 v[196:197], v185 offset:128
    ds_read_b64_tr_b16 v[198:199], v185 offset:768
    s_waitcnt lgkmcnt(2)
    buffer_store_dwordx4 v[192:195], v187, s[16:19], 0 offen sc1
    s_waitcnt lgkmcnt(0)
    buffer_store_dwordx4 v[196:199], v188, s[16:19], 0 offen sc1
    v_mov_b32 v134, 0x3f803f80
    v_mov_b32 v132, 0
    v_mov_b32 v133, 0
    s_waitcnt vmcnt(7)
    v_dot2c_f32_bf16 v132, v120, v134
    v_dot2c_f32_bf16 v133, v120, v120
    v_dot2c_f32_bf16 v132, v121, v134
    v_dot2c_f32_bf16 v133, v121, v121
    v_dot2c_f32_bf16 v132, v122, v134
    v_dot2c_f32_bf16 v133, v122, v122
    v_dot2c_f32_bf16 v132, v123, v134
    v_dot2c_f32_bf16 v133, v123, v123
    s_waitcnt vmcnt(6)
    v_dot2c_f32_bf16 v132, v124, v134
    v_dot2c_f32_bf16 v133, v124, v124
    v_dot2c_f32_bf16 v132, v125, v134
    v_dot2c_f32_bf16 v133, v125, v125
    v_dot2c_f32_bf16 v132, v126, v134
    v_dot2c_f32_bf16 v133, v126, v126
    v_dot2c_f32_bf16 v132, v127, v134
    v_dot2c_f32_bf16 v133, v127, v127
    s_waitcnt vmcnt(5)
    v_dot2c_f32_bf16 v132, v128, v134
    v_dot2c_f32_bf16 v133, v128, v128
    v_dot2c_f32_bf16 v132, v129, v134
    v_dot2c_f32_bf16 v133, v129, v129
    v_dot2c_f32_bf16 v132, v130, v134
    v_dot2c_f32_bf16 v133, v130, v130
    v_dot2c_f32_bf16 v132, v131, v134
    v_dot2c_f32_bf16 v133, v131, v131
    v_lshrrev_b32 v135, 5, v0
    v_and_b32 v121, 3, v135
    v_lshrrev_b32 v135, 2, v135
    v_add_f32_dpp v132, v132, v132 row_shr:1 row_mask:0xf bank_mask:0xf bound_ctrl:0
    v_add_f32_dpp v133, v133, v133 row_shr:1 row_mask:0xf bank_mask:0xf bound_ctrl:0
    v_lshlrev_b32_e64 v135, 3, v135
    v_add_f32_dpp v132, v132, v132 row_shr:2 row_mask:0xf bank_mask:0xf bound_ctrl:0
    v_add_f32_dpp v133, v133, v133 row_shr:2 row_mask:0xf bank_mask:0xf bound_ctrl:0
    v_lshl_add_u32 v135, v121, 12, v135
    v_add_f32_dpp v132, v132, v132 row_shr:4 row_mask:0xf bank_mask:0xf bound_ctrl:0
    v_add_f32_dpp v133, v133, v133 row_shr:4 row_mask:0xf bank_mask:0xf bound_ctrl:0
    v_and_b32_e64 v121, 31, v0
    v_add_f32_dpp v132, v132, v132 row_shr:8 row_mask:0xf bank_mask:0xf bound_ctrl:0
    v_add_f32_dpp v133, v133, v133 row_shr:8 row_mask:0xf bank_mask:0xf bound_ctrl:0
    v_cmp_eq_u32_e64 vcc, 31, v121
    v_add_f32_dpp v132, v132, v132 row_bcast:15 row_mask:0xa bank_mask:0xf
    v_add_f32_dpp v133, v133, v133 row_bcast:15 row_mask:0xa bank_mask:0xf
    v_mov_b32 v121, 1073741824
    v_cndmask_b32_e64 v120, v121, v135, vcc
    s_lshl_b32 s96, s2, 4
    s_add_u32 s96, s96, 3440640
    v_mul_f32 v135, 0x3acccccd, v132
    v_mul_f32 v133, 0x3acccccd, v133
    v_fma_f32 v133, -v135, v135, v133
    v_max_f32 v133, 0, v133
    v_add_f32 v133, 0x3727c5ac, v133
    v_rsq_f32_e64 v132, v133
    s_nop 0
    v_mul_f32 v133, -v135, v132
    buffer_store_dwordx2 v[132:133], v120, s[16:19], s96 offen sc1
    s_add_u32 m0, s92, 36352
    s_nop 0
    s_nop 0
    buffer_load_dwordx4 v73, s[4:7], s99 offen offset:0  lds
    buffer_load_dwordx4 v74, s[4:7], s99 offen offset:1088  lds
    buffer_load_dwordx4 v75, s[4:7], s99 offen offset:2176  lds
    buffer_load_dwordx4 v76, s[4:7], s99 offen offset:3264  lds
    s_add_u32 m0, s93, 53760
    s_add_u32 s99, s99, 256
    s_mov_b64 exec, s[80:81]
    buffer_load_dwordx4 v77, s[4:7], s100 offen  lds
    s_mov_b64 exec, -1
    s_add_u32 s100, s100, 256
    s_add_u32 m0, s92, 55936
    s_nop 0
    s_nop 0
    buffer_load_dwordx4 v73, s[4:7], s99 offen offset:0  lds
    buffer_load_dwordx4 v74, s[4:7], s99 offen offset:1088  lds
    buffer_load_dwordx4 v75, s[4:7], s99 offen offset:2176  lds
    buffer_load_dwordx4 v76, s[4:7], s99 offen offset:3264  lds
    s_add_u32 m0, s93, 73344
    s_add_u32 s99, s99, 256
    s_mov_b64 exec, s[80:81]
    buffer_load_dwordx4 v77, s[4:7], s100 offen  lds
    s_mov_b64 exec, -1
    s_add_u32 s100, s100, 256
    v_mov_b32 v140, 1073741824
    v_lshlrev_b32 v141, 2, v0
    v_cmp_gt_u32 vcc, 64, v0
    s_nop 1
    v_cndmask_b32 v141, v140, v141, vcc
    v_mov_b32_e64 v140, 0
    s_lshl_b32 s97, s2, 8
    s_add_u32 s97, s97, 3473408
    buffer_store_dword v140, v141, s[16:19], s97 offen sc1
    v_mov_b32 v142, 1073741824
    v_lshlrev_b32 v143, 2, v0
    v_cmp_gt_u32 vcc, 16, v0
    s_nop 1
    v_cndmask_b32 v143, v142, v143, vcc
    v_mov_b32_e64 v142, -1
    s_lshl_b32 s97, s2, 6
    s_add_u32 s97, s97, 3457024
    buffer_store_dword v142, v143, s[16:19], s97 offen sc1
    v_mov_b32 v144, -1
    v_mov_b32 v145, -1
    v_mov_b32 v146, -1
    v_mov_b32 v147, -1
    v_lshlrev_b32 v148, 4, v0
    s_sub_u32 s88, s2, 0
    s_mul_i32 s88, s88, 20480
    s_min_u32 s88, s88, 5222400
    s_add_u32 s88, s88, 4194304
    buffer_store_dwordx4 v[144:147], v148, s[16:19], s88 offen sc1
    s_add_u32 s88, s88, 4096
    buffer_store_dwordx4 v[144:147], v148, s[16:19], s88 offen sc1
    s_add_u32 s88, s88, 4096
    buffer_store_dwordx4 v[144:147], v148, s[16:19], s88 offen sc1
    s_add_u32 s88, s88, 4096
    buffer_store_dwordx4 v[144:147], v148, s[16:19], s88 offen sc1
    s_add_u32 s88, s88, 4096
    buffer_store_dwordx4 v[144:147], v148, s[16:19], s88 offen sc1
    s_add_u32 m0, s92, 75520
    s_nop 0
    s_nop 0
    buffer_load_dwordx4 v73, s[4:7], s99 offen offset:0  lds
    buffer_load_dwordx4 v74, s[4:7], s99 offen offset:1088  lds
    buffer_load_dwordx4 v75, s[4:7], s99 offen offset:2176  lds
    buffer_load_dwordx4 v76, s[4:7], s99 offen offset:3264  lds
    s_add_u32 m0, s93, 92928
    s_add_u32 s99, s99, 256
    s_mov_b64 exec, s[80:81]
    buffer_load_dwordx4 v77, s[4:7], s100 offen  lds
    s_mov_b64 exec, -1
    s_add_u32 s100, s100, 256
    s_add_u32 m0, s92, 95104
    s_nop 0
    s_nop 0
    buffer_load_dwordx4 v73, s[4:7], s99 offen offset:0  lds
    buffer_load_dwordx4 v74, s[4:7], s99 offen offset:1088  lds
    buffer_load_dwordx4 v75, s[4:7], s99 offen offset:2176  lds
    buffer_load_dwordx4 v76, s[4:7], s99 offen offset:3264  lds
    s_add_u32 m0, s93, 112512
    s_add_u32 s99, s99, 256
    s_mov_b64 exec, s[80:81]
    buffer_load_dwordx4 v77, s[4:7], s100 offen  lds
    s_mov_b64 exec, -1
    s_add_u32 s100, s100, 256
    s_add_u32 m0, s92, 114688
    s_nop 0
    s_nop 0
    buffer_load_dwordx4 v73, s[4:7], s99 offen offset:0  lds
    buffer_load_dwordx4 v74, s[4:7], s99 offen offset:1088  lds
    buffer_load_dwordx4 v75, s[4:7], s99 offen offset:2176  lds
    buffer_load_dwordx4 v76, s[4:7], s99 offen offset:3264  lds
    s_add_u32 m0, s93, 132096
    s_add_u32 s99, s99, 256
    s_mov_b64 exec, s[80:81]
    buffer_load_dwordx4 v77, s[4:7], s100 offen  lds
    s_mov_b64 exec, -1
    s_add_u32 s100, s100, 256
    s_waitcnt vmcnt(15)
    buffer_load_dword v7, v4, s[16:19], s87 offen offset:0 sc1
    s_waitcnt vmcnt(0)
    v_cmp_gt_u32_e64 vcc, 32, v7
    s_nop 0
    s_and_b64 vcc, vcc, s[50:51]
    s_cbranch_scc1 ps_14
pc_16:
    s_barrier
    buffer_load_dwordx4 a[0:3], v200, s[16:19], s101 offen offset:0 sc1
    buffer_load_dwordx4 a[4:7], v200, s[16:19], s101 offen offset:1024 sc1
    buffer_load_dwordx4 a[8:11], v200, s[16:19], s101 offen offset:2048 sc1
    buffer_load_dwordx4 a[12:15], v200, s[16:19], s101 offen offset:3072 sc1
    s_add_u32 s101, s101, 4096
    buffer_load_dwordx4 a[16:19], v200, s[16:19], s101 offen offset:0 sc1
    buffer_load_dwordx4 a[20:23], v200, s[16:19], s101 offen offset:1024 sc1
    buffer_load_dwordx4 a[24:27], v200, s[16:19], s101 offen offset:2048 sc1
    buffer_load_dwordx4 a[28:31], v200, s[16:19], s101 offen offset:3072 sc1
    s_add_u32 s101, s101, 4096
    buffer_load_dwordx4 a[32:35], v200, s[16:19], s101 offen offset:0 sc1
    buffer_load_dwordx4 a[36:39], v200, s[16:19], s101 offen offset:1024 sc1
    buffer_load_dwordx4 a[40:43], v200, s[16:19], s101 offen offset:2048 sc1
    buffer_load_dwordx4 a[44:47], v200, s[16:19], s101 offen offset:3072 sc1
    s_add_u32 s101, s101, 4096
    buffer_load_dwordx4 a[48:51], v200, s[16:19], s101 offen offset:0 sc1
    buffer_load_dwordx4 a[52:55], v200, s[16:19], s101 offen offset:1024 sc1
ec_4:
    v_add_u32 v196, 36352, v78
    v_mov_b32 v198, v79
    v_xor_b32 v197, 32, v196
    s_waitcnt vmcnt(34)
    s_barrier
    s_add_u32 s82, s86, 16384
    v_lshlrev_b32 v2, 3, v4
    v_mov_b32 v5, 1
    v_cndmask_b32 v2, v4, v2, s[50:51]
    buffer_atomic_add v5, v2, s[16:19], s82 offen offset:8 sc1
    ds_read_b128 v[160:163], v198 offset:0
    ds_read_b128 v[164:167], v196 offset:0
    ds_read_b128 v[168:171], v196 offset:8704
    ds_read_b128 v[172:175], v198 offset:32
    ds_read_b128 v[176:179], v197 offset:0
    ds_read_b128 v[180:183], v197 offset:8704
    s_waitcnt lgkmcnt(3)
    s_waitcnt vmcnt(14)
    v_mfma_f32_16x16x32_bf16 v[112:115], a[0:3], v[160:163], 0
    ds_read_b128 v[184:187], v198 offset:64
    v_mfma_f32_32x32x16_bf16 v[80:95], a[0:3], v[164:167], 0
    ds_read_b128 v[188:191], v196 offset:64
    v_mov_b32 v208, 0
    v_mov_b32 v209, 0
    v_lshrrev_b32_e64 v210, 5, v0
    v_mul_u32_u24 v210, 1600, v210
    v_mfma_f32_32x32x16_bf16 v[96:111], a[0:3], v[168:171], 0
    ds_read_b128 v[192:195], v196 offset:8768
    buffer_load_dwordx4 a[56:59], v200, s[16:19], s101 offen offset:2048 sc1
    v_and_b32 v211, 31, v0
    v_min_u32 v211, 19, v211
    s_waitcnt lgkmcnt(3)
    s_waitcnt vmcnt(14)
    v_mfma_f32_16x16x32_bf16 v[112:115], a[4:7], v[172:175], v[112:115]
    ds_read_b128 v[160:163], v198 offset:96
    v_mfma_f32_32x32x16_bf16 v[80:95], a[4:7], v[176:179], v[80:95]
    ds_read_b128 v[164:167], v197 offset:64
    v_lshl_add_u32 v210, v211, 3, v210
    v_add_u32 v210, 6400, v210
    ds_write_b64 v210, v[208:209]
    s_mul_i32 s33, s24, 4160
    v_mfma_f32_32x32x16_bf16 v[96:111], a[4:7], v[180:183], v[96:111]
    ds_read_b128 v[168:171], v197 offset:8768
    buffer_load_dwordx4 a[60:63], v200, s[16:19], s101 offen offset:3072 sc1
    s_add_u32 s33, s33, 134272
    v_and_b32_e64 v250, 31, v1
    s_waitcnt lgkmcnt(4)
    s_waitcnt vmcnt(14)
    v_mfma_f32_16x16x32_bf16 v[112:115], a[8:11], v[184:187], v[112:115]
    ds_read_b128 v[172:175], v198 offset:128
    v_mfma_f32_32x32x16_bf16 v[80:95], a[8:11], v[188:191], v[80:95]
    ds_read_b128 v[176:179], v196 offset:128
    v_lshl_add_u32 v250, v250, 4, s33
    v_lshrrev_b32_e64 v253, 5, v1
    v_lshl_add_u32 v251, v253, 3, v250
    v_lshl_add_u32 v252, v253, 9, v250
    v_mfma_f32_32x32x16_bf16 v[96:111], a[8:11], v[192:195], v[96:111]
    ds_read_b128 v[180:183], v196 offset:8832
    s_add_u32 s101, s101, 4096
    buffer_load_dwordx4 a[64:67], v200, s[16:19], s101 offen offset:0 sc1
    v_lshl_add_u32 v250, v253, 10, v250
    s_waitcnt lgkmcnt(3)
    s_waitcnt vmcnt(14)
    v_mfma_f32_16x16x32_bf16 v[112:115], a[12:15], v[160:163], v[112:115]
    ds_read_b128 v[184:187], v198 offset:160
    v_mfma_f32_32x32x16_bf16 v[80:95], a[12:15], v[164:167], v[80:95]
    ds_read_b128 v[188:191], v197 offset:128
    v_cmp_eq_u32 vcc, 0, v1
    v_lshlrev_b32 v254, 16, v241
    v_min_u32 v253, 15, v1
    v_cndmask_b32 v254, 0, v254, vcc
    v_mfma_f32_32x32x16_bf16 v[96:111], a[12:15], v[168:171], v[96:111]
    ds_read_b128 v[192:195], v197 offset:8832
    buffer_load_dwordx4 a[68:71], v200, s[16:19], s101 offen offset:1024 sc1
    v_lshl_add_u32 v253, v253, 2, s33
    v_add_f32_e64 v216, v216, v254
    s_waitcnt lgkmcnt(3)
    s_waitcnt vmcnt(14)
    v_mfma_f32_16x16x32_bf16 v[112:115], a[16:19], v[172:175], v[112:115]
    ds_read_b128 v[160:163], v198 offset:192
    v_mfma_f32_32x32x16_bf16 v[80:95], a[16:19], v[176:179], v[80:95]
    ds_read_b128 v[164:167], v196 offset:192
    v_and_b32 v254, 1, v1
    v_cmp_eq_u32 vcc, 1, v254
    v_mov_b32_e64 v254, 0
    v_cvt_pk_bf16_f32 v242, v216, v217
    v_mfma_f32_32x32x16_bf16 v[96:111], a[16:19], v[180:183], v[96:111]
    ds_read_b128 v[168:171], v196 offset:8896
    buffer_load_dwordx4 a[72:75], v200, s[16:19], s101 offen offset:2048 sc1
    v_cvt_pk_bf16_f32 v243, v218, v219
    v_cvt_pk_bf16_f32 v244, v220, v220
    s_waitcnt lgkmcnt(3)
    s_waitcnt vmcnt(14)
    v_mfma_f32_16x16x32_bf16 v[112:115], a[20:23], v[184:187], v[112:115]
    ds_read_b128 v[172:175], v198 offset:224
    v_mfma_f32_32x32x16_bf16 v[80:95], a[20:23], v[188:191], v[80:95]
    ds_read_b128 v[176:179], v197 offset:192
    v_cvt_pk_bf16_f32 v245, v221, v222
    v_cvt_pk_bf16_f32 v246, v224, v224
    v_cvt_pk_bf16_f32 v247, v224, v225
    v_cvt_pk_bf16_f32 v248, v225, v225
    v_mfma_f32_32x32x16_bf16 v[96:111], a[20:23], v[192:195], v[96:111]
    ds_read_b128 v[180:183], v197 offset:8896
    buffer_load_dwordx4 a[76:79], v200, s[16:19], s101 offen offset:3072 sc1
    v_cvt_pk_bf16_f32 v249, v226, v226
    ds_write_b32 v253, v254
    s_barrier
    s_waitcnt lgkmcnt(4)
    s_waitcnt vmcnt(14)
    v_mfma_f32_16x16x32_bf16 v[112:115], a[24:27], v[160:163], v[112:115]
    v_add_u32 v198, v49, v198
    v_mfma_f32_32x32x16_bf16 v[80:95], a[24:27], v[164:167], v[80:95]
    v_add_u32 v196, 19584, v196
    v_add_u32 v197, 19584, v197
    ds_read_b128 v[184:187], v198 offset:0
    ds_write_b64 v251, v[242:243] offset:64
    ds_write_b64 v251, v[244:245] offset:576
    v_mfma_f32_32x32x16_bf16 v[96:111], a[24:27], v[168:171], v[96:111]
    ds_read_b128 v[188:191], v196 offset:0
    ds_read_b128 v[192:195], v196 offset:8704
    s_add_u32 s101, s101, 4096
    buffer_load_dwordx4 a[80:83], v200, s[16:19], s101 offen offset:0 sc1
    s_waitcnt lgkmcnt(6)
    s_waitcnt vmcnt(14)
    v_mfma_f32_16x16x32_bf16 v[112:115], a[28:31], v[172:175], v[112:115]
    ds_read_b128 v[160:163], v198 offset:32
    v_mfma_f32_32x32x16_bf16 v[80:95], a[28:31], v[176:179], v[80:95]
    ds_read_b128 v[164:167], v197 offset:0
    ds_write_b128 v252, v[246:249] offset:1088
    v_cndmask_b32 v255, v228, v229, vcc
    v_cvt_pk_bf16_f32 v216, v228, v228
    v_mov_b32 v217, v216
    v_mfma_f32_32x32x16_bf16 v[96:111], a[28:31], v[180:183], v[96:111]
    ds_read_b128 v[168:171], v197 offset:8704
    buffer_load_dwordx4 a[84:87], v200, s[16:19], s101 offen offset:1024 sc1
    v_cvt_pk_bf16_f32 v218, v255, v229
    v_cvt_pk_bf16_f32 v219, v229, v229
    s_waitcnt lgkmcnt(4)
    s_waitcnt vmcnt(14)
    v_mfma_f32_16x16x32_bf16 v[112:115], a[32:35], v[184:187], v[112:115]
    ds_read_b128 v[172:175], v198 offset:64
    v_mfma_f32_32x32x16_bf16 v[80:95], a[32:35], v[188:191], v[80:95]
    ds_read_b128 v[176:179], v196 offset:64
    ds_write_b128 v250, v[216:219] offset:2112
    v_cndmask_b32 v255, v230, v231, vcc
    v_cvt_pk_bf16_f32 v220, v230, v230
    v_mov_b32 v221, v220
    v_mfma_f32_32x32x16_bf16 v[96:111], a[32:35], v[192:195], v[96:111]
    ds_read_b128 v[180:183], v196 offset:8768
    buffer_load_dwordx4 a[88:91], v200, s[16:19], s101 offen offset:2048 sc1
    v_cvt_pk_bf16_f32 v222, v255, v231
    v_cvt_pk_bf16_f32 v223, v231, v231
    s_waitcnt lgkmcnt(4)
    s_waitcnt vmcnt(14)
    v_mfma_f32_16x16x32_bf16 v[112:115], a[36:39], v[160:163], v[112:115]
    ds_read_b128 v[184:187], v198 offset:96
    v_mfma_f32_32x32x16_bf16 v[80:95], a[36:39], v[164:167], v[80:95]
    ds_read_b128 v[188:191], v197 offset:64
    ds_write_b128 v250, v[220:223] offset:2624
    v_mfma_f32_32x32x16_bf16 v[96:111], a[36:39], v[168:171], v[96:111]
    ds_read_b128 v[192:195], v197 offset:8768
    buffer_load_dwordx4 a[92:95], v200, s[16:19], s101 offen offset:3072 sc1
    s_waitcnt lgkmcnt(4)
    s_waitcnt vmcnt(14)
    v_mfma_f32_16x16x32_bf16 v[112:115], a[40:43], v[172:175], v[112:115]
    ds_read_b128 v[160:163], v198 offset:128
    v_mfma_f32_32x32x16_bf16 v[80:95], a[40:43], v[176:179], v[80:95]
    ds_read_b128 v[164:167], v196 offset:128
    v_mfma_f32_32x32x16_bf16 v[96:111], a[40:43], v[180:183], v[96:111]
    ds_read_b128 v[168:171], v196 offset:8832
    s_add_u32 s101, s101, 4096
    buffer_load_dwordx4 a[96:99], v200, s[16:19], s101 offen offset:0 sc1
    s_waitcnt lgkmcnt(3)
    s_waitcnt vmcnt(14)
    v_mfma_f32_16x16x32_bf16 v[112:115], a[44:47], v[184:187], v[112:115]
    ds_read_b128 v[172:175], v198 offset:160
    v_mfma_f32_32x32x16_bf16 v[80:95], a[44:47], v[188:191], v[80:95]
    ds_read_b128 v[176:179], v197 offset:128
    v_mfma_f32_32x32x16_bf16 v[96:111], a[44:47], v[192:195], v[96:111]
    ds_read_b128 v[180:183], v197 offset:8832
    buffer_load_dwordx4 a[100:103], v200, s[16:19], s101 offen offset:1024 sc1
    s_waitcnt lgkmcnt(3)
    s_waitcnt vmcnt(14)
    v_mfma_f32_16x16x32_bf16 v[112:115], a[48:51], v[160:163], v[112:115]
    ds_read_b128 v[184:187], v198 offset:192
    v_mfma_f32_32x32x16_bf16 v[80:95], a[48:51], v[164:167], v[80:95]
    ds_read_b128 v[188:191], v196 offset:192
    v_mfma_f32_32x32x16_bf16 v[96:111], a[48:51], v[168:171], v[96:111]
    ds_read_b128 v[192:195], v196 offset:8896
    buffer_load_dwordx4 a[104:107], v200, s[16:19], s101 offen offset:2048 sc1
    s_waitcnt lgkmcnt(3)
    s_waitcnt vmcnt(14)
    v_mfma_f32_16x16x32_bf16 v[112:115], a[52:55], v[172:175], v[112:115]
    ds_read_b128 v[160:163], v198 offset:224
    v_mfma_f32_32x32x16_bf16 v[80:95], a[52:55], v[176:179], v[80:95]
    ds_read_b128 v[164:167], v197 offset:192
    v_mfma_f32_32x32x16_bf16 v[96:111], a[52:55], v[180:183], v[96:111]
    ds_read_b128 v[168:171], v197 offset:8896
    buffer_load_dwordx4 a[108:111], v200, s[16:19], s101 offen offset:3072 sc1
    s_barrier
    s_waitcnt lgkmcnt(3)
    s_waitcnt vmcnt(13)
    v_mfma_f32_16x16x32_bf16 v[112:115], a[56:59], v[184:187], v[112:115]
    v_add_u32 v198, v49, v198
    v_mfma_f32_32x32x16_bf16 v[80:95], a[56:59], v[188:191], v[80:95]
    v_add_u32 v196, 19584, v196
    v_add_u32 v197, 19584, v197
    ds_read_b128 v[172:175], v198 offset:0
    v_mfma_f32_32x32x16_bf16 v[96:111], a[56:59], v[192:195], v[96:111]
    ds_read_b128 v[176:179], v196 offset:0
    ds_read_b128 v[180:183], v196 offset:8704
    s_add_u32 s101, s101, 4096
    buffer_load_dwordx4 a[112:115], v200, s[16:19], s101 offen offset:0 sc1
    s_waitcnt lgkmcnt(3)
    s_waitcnt vmcnt(13)
    v_mfma_f32_16x16x32_bf16 v[112:115], a[60:63], v[160:163], v[112:115]
    ds_read_b128 v[184:187], v198 offset:32
    v_mfma_f32_32x32x16_bf16 v[80:95], a[60:63], v[164:167], v[80:95]
    ds_read_b128 v[188:191], v197 offset:0
    v_mfma_f32_32x32x16_bf16 v[96:111], a[60:63], v[168:171], v[96:111]
    ds_read_b128 v[192:195], v197 offset:8704
    buffer_load_dwordx4 a[116:119], v200, s[16:19], s101 offen offset:1024 sc1
    s_waitcnt lgkmcnt(3)
    s_waitcnt vmcnt(13)
    v_mfma_f32_16x16x32_bf16 v[112:115], a[64:67], v[172:175], v[112:115]
    ds_read_b128 v[160:163], v198 offset:64
    v_mfma_f32_32x32x16_bf16 v[80:95], a[64:67], v[176:179], v[80:95]
    ds_read_b128 v[164:167], v196 offset:64
    v_mfma_f32_32x32x16_bf16 v[96:111], a[64:67], v[180:183], v[96:111]
    ds_read_b128 v[168:171], v196 offset:8768
    buffer_load_dwordx4 a[120:123], v200, s[16:19], s101 offen offset:2048 sc1
    s_waitcnt lgkmcnt(3)
    s_waitcnt vmcnt(13)
    v_mfma_f32_16x16x32_bf16 v[112:115], a[68:71], v[184:187], v[112:115]
    ds_read_b128 v[172:175], v198 offset:96
    v_mfma_f32_32x32x16_bf16 v[80:95], a[68:71], v[188:191], v[80:95]
    ds_read_b128 v[176:179], v197 offset:64
    v_mfma_f32_32x32x16_bf16 v[96:111], a[68:71], v[192:195], v[96:111]
    ds_read_b128 v[180:183], v197 offset:8768
    buffer_load_dwordx4 a[124:127], v200, s[16:19], s101 offen offset:3072 sc1
    s_waitcnt lgkmcnt(3)
    s_waitcnt vmcnt(13)
    v_mfma_f32_16x16x32_bf16 v[112:115], a[72:75], v[160:163], v[112:115]
    ds_read_b128 v[184:187], v198 offset:128
    v_mfma_f32_32x32x16_bf16 v[80:95], a[72:75], v[164:167], v[80:95]
    ds_read_b128 v[188:191], v196 offset:128
    v_mfma_f32_32x32x16_bf16 v[96:111], a[72:75], v[168:171], v[96:111]
    ds_read_b128 v[192:195], v196 offset:8832
    s_add_u32 s101, s101, 4096
    buffer_load_dwordx4 a[128:131], v200, s[16:19], s101 offen offset:0 sc1
    s_waitcnt lgkmcnt(3)
    s_waitcnt vmcnt(13)
    v_mfma_f32_16x16x32_bf16 v[112:115], a[76:79], v[172:175], v[112:115]
    ds_read_b128 v[160:163], v198 offset:160
    v_mfma_f32_32x32x16_bf16 v[80:95], a[76:79], v[176:179], v[80:95]
    ds_read_b128 v[164:167], v197 offset:128
    v_mfma_f32_32x32x16_bf16 v[96:111], a[76:79], v[180:183], v[96:111]
    ds_read_b128 v[168:171], v197 offset:8832
    buffer_load_dwordx4 a[132:135], v200, s[16:19], s101 offen offset:1024 sc1
    s_waitcnt lgkmcnt(3)
    s_waitcnt vmcnt(13)
    v_mfma_f32_16x16x32_bf16 v[112:115], a[80:83], v[184:187], v[112:115]
    ds_read_b128 v[172:175], v198 offset:192
    v_mfma_f32_32x32x16_bf16 v[80:95], a[80:83], v[188:191], v[80:95]
    ds_read_b128 v[176:179], v196 offset:192
    v_mfma_f32_32x32x16_bf16 v[96:111], a[80:83], v[192:195], v[96:111]
    ds_read_b128 v[180:183], v196 offset:8896
    buffer_load_dwordx4 a[136:139], v200, s[16:19], s101 offen offset:2048 sc1
    s_waitcnt lgkmcnt(3)
    s_waitcnt vmcnt(13)
    v_mfma_f32_16x16x32_bf16 v[112:115], a[84:87], v[160:163], v[112:115]
    ds_read_b128 v[184:187], v198 offset:224
    v_mfma_f32_32x32x16_bf16 v[80:95], a[84:87], v[164:167], v[80:95]
    ds_read_b128 v[188:191], v197 offset:192
    v_mfma_f32_32x32x16_bf16 v[96:111], a[84:87], v[168:171], v[96:111]
    ds_read_b128 v[192:195], v197 offset:8896
    buffer_load_dwordx4 a[140:143], v200, s[16:19], s101 offen offset:3072 sc1
    s_barrier
    s_waitcnt lgkmcnt(3)
    s_waitcnt vmcnt(13)
    v_mfma_f32_16x16x32_bf16 v[112:115], a[88:91], v[172:175], v[112:115]
    v_add_u32 v198, v49, v198
    v_mfma_f32_32x32x16_bf16 v[80:95], a[88:91], v[176:179], v[80:95]
    v_add_u32 v196, 19584, v196
    v_add_u32 v197, 19584, v197
    ds_read_b128 v[160:163], v198 offset:0
    v_mfma_f32_32x32x16_bf16 v[96:111], a[88:91], v[180:183], v[96:111]
    ds_read_b128 v[164:167], v196 offset:0
    ds_read_b128 v[168:171], v196 offset:8704
    s_add_u32 s101, s101, 4096
    buffer_load_dword v7, v4, s[16:19], s89 offen offset:8 sc1
    s_waitcnt lgkmcnt(3)
    s_waitcnt vmcnt(13)
    v_mfma_f32_16x16x32_bf16 v[112:115], a[92:95], v[184:187], v[112:115]
    ds_read_b128 v[172:175], v198 offset:32
    v_mfma_f32_32x32x16_bf16 v[80:95], a[92:95], v[188:191], v[80:95]
    ds_read_b128 v[176:179], v197 offset:0
    v_mfma_f32_32x32x16_bf16 v[96:111], a[92:95], v[192:195], v[96:111]
    ds_read_b128 v[180:183], v197 offset:8704
    buffer_load_dwordx4 a[144:147], v200, s[16:19], s101 offen offset:0 sc1
    s_waitcnt lgkmcnt(3)
    s_waitcnt vmcnt(13)
    v_mfma_f32_16x16x32_bf16 v[112:115], a[96:99], v[160:163], v[112:115]
    ds_read_b128 v[184:187], v198 offset:64
    v_mfma_f32_32x32x16_bf16 v[80:95], a[96:99], v[164:167], v[80:95]
    ds_read_b128 v[188:191], v196 offset:64
    v_mfma_f32_32x32x16_bf16 v[96:111], a[96:99], v[168:171], v[96:111]
    ds_read_b128 v[192:195], v196 offset:8768
    buffer_load_dwordx4 a[148:151], v200, s[16:19], s101 offen offset:1024 sc1
    s_waitcnt lgkmcnt(3)
    s_waitcnt vmcnt(13)
    v_mfma_f32_16x16x32_bf16 v[112:115], a[100:103], v[172:175], v[112:115]
    ds_read_b128 v[160:163], v198 offset:96
    v_mfma_f32_32x32x16_bf16 v[80:95], a[100:103], v[176:179], v[80:95]
    ds_read_b128 v[164:167], v197 offset:64
    v_mfma_f32_32x32x16_bf16 v[96:111], a[100:103], v[180:183], v[96:111]
    ds_read_b128 v[168:171], v197 offset:8768
    buffer_load_dwordx4 a[152:155], v200, s[16:19], s101 offen offset:2048 sc1
    s_waitcnt lgkmcnt(3)
    s_waitcnt vmcnt(13)
    v_mfma_f32_16x16x32_bf16 v[112:115], a[104:107], v[184:187], v[112:115]
    ds_read_b128 v[172:175], v198 offset:128
    v_mfma_f32_32x32x16_bf16 v[80:95], a[104:107], v[188:191], v[80:95]
    ds_read_b128 v[176:179], v196 offset:128
    v_mfma_f32_32x32x16_bf16 v[96:111], a[104:107], v[192:195], v[96:111]
    ds_read_b128 v[180:183], v196 offset:8832
    buffer_load_dwordx4 a[156:159], v200, s[16:19], s101 offen offset:3072 sc1
    s_waitcnt lgkmcnt(3)
    s_waitcnt vmcnt(13)
    v_mfma_f32_16x16x32_bf16 v[112:115], a[108:111], v[160:163], v[112:115]
    ds_read_b128 v[184:187], v198 offset:160
    v_mfma_f32_32x32x16_bf16 v[80:95], a[108:111], v[164:167], v[80:95]
    ds_read_b128 v[188:191], v197 offset:128
    v_mfma_f32_32x32x16_bf16 v[96:111], a[108:111], v[168:171], v[96:111]
    ds_read_b128 v[192:195], v197 offset:8832
    s_add_u32 s101, s101, 4096
    s_lshl_b32 s25, s72, 5
    s_add_u32 s25, s25, 256
    s_sub_u32 s26, s25, 4
    s_max_i32 s26, s26, 0
    s_mul_i32 s27, s71, 1280
    s_mul_i32 s99, s25, 5120
    s_mul_i32 s100, s26, 5120
    s_mul_i32 s92, s24, 4352
    s_mul_i32 s93, s24, 544
    s_add_u32 s99, s99, s27
    s_add_u32 s100, s100, s27
    s_waitcnt lgkmcnt(3)
    s_waitcnt vmcnt(12)
    v_mfma_f32_16x16x32_bf16 v[112:115], a[112:115], v[172:175], v[112:115]
    ds_read_b128 v[160:163], v198 offset:192
    v_mfma_f32_32x32x16_bf16 v[80:95], a[112:115], v[176:179], v[80:95]
    ds_read_b128 v[164:167], v196 offset:192
    v_mfma_f32_32x32x16_bf16 v[96:111], a[112:115], v[180:183], v[96:111]
    ds_read_b128 v[168:171], v196 offset:8896
    s_waitcnt lgkmcnt(3)
    s_waitcnt vmcnt(11)
    v_mfma_f32_16x16x32_bf16 v[112:115], a[116:119], v[184:187], v[112:115]
    ds_read_b128 v[172:175], v198 offset:224
    v_mfma_f32_32x32x16_bf16 v[80:95], a[116:119], v[188:191], v[80:95]
    ds_read_b128 v[176:179], v197 offset:192
    v_mfma_f32_32x32x16_bf16 v[96:111], a[116:119], v[192:195], v[96:111]
    ds_read_b128 v[180:183], v197 offset:8896
    s_waitcnt vmcnt(4)
    v_cmp_gt_u32 vcc, 32, v7
    s_nop 0
    s_and_b64 vcc, vcc, s[50:51]
    s_cbranch_scc1 ps_17
pc_19:
    s_barrier
    s_waitcnt lgkmcnt(3)
    v_mfma_f32_16x16x32_bf16 v[112:115], a[120:123], v[160:163], v[112:115]
    v_add_u32_e64 v198, v49, v198
    v_mfma_f32_32x32x16_bf16 v[80:95], a[120:123], v[164:167], v[80:95]
    v_add_u32 v196, 19584, v196
    v_add_u32 v197, 19584, v197
    s_lshl_b32 s31, s24, 7
    s_add_u32 s31, s31, 159744
    v_bfe_u32 v132, v1, 3, 1
    v_mfma_f32_32x32x16_bf16 v[96:111], a[120:123], v[168:171], v[96:111]
    ds_read_b128 v[184:187], v198 offset:0
    ds_read_b128 v[188:191], v196 offset:0
    s_lshl_b32 s98, s72, 5
    s_add_u32 s98, s98, 0
    s_sub_u32 s95, s98, 4
    s_max_i32 s95, s95, 0
    s_lshl_b32 s94, s98, 3
    s_lshl_b32 s95, s95, 3
    s_add_u32 s94, s94, 3440640
    s_add_u32 s95, s95, 3440640
    s_add_u32 s96, s94, 8192
    buffer_load_dwordx2 v[152:153], v47, s[16:19], s94 offen sc1
    v_lshrrev_b32 v133, 4, v1
    v_lshl_add_u32 v132, v132, 2, v133
    s_waitcnt lgkmcnt(2)
    v_mfma_f32_16x16x32_bf16 v[112:115], a[124:127], v[172:175], v[112:115]
    ds_read_b128 v[192:195], v198 offset:32
    v_mfma_f32_32x32x16_bf16 v[80:95], a[124:127], v[176:179], v[80:95]
    ds_read_b128 v[160:163], v197 offset:0
    v_lshl_add_u32 v132, v132, 4, s31
    v_lshrrev_b32 v133, 5, v1
    v_lshl_add_u32 v133, v133, 4, s31
    v_mfma_f32_32x32x16_bf16 v[96:111], a[124:127], v[180:183], v[96:111]
    buffer_load_dwordx2 v[154:155], v47, s[16:19], s96 offen sc1
    s_waitcnt lgkmcnt(2)
    v_mfma_f32_16x16x32_bf16 v[112:115], a[128:131], v[184:187], v[112:115]
    ds_read_b128 v[164:167], v198 offset:64
    v_mfma_f32_32x32x16_bf16 v[80:95], a[128:131], v[188:191], v[80:95]
    ds_read_b128 v[168:171], v196 offset:64
    s_waitcnt lgkmcnt(2)
    v_mfma_f32_16x16x32_bf16 v[112:115], a[132:135], v[192:195], v[112:115]
    ds_read_b128 v[172:175], v198 offset:96
    v_mfma_f32_32x32x16_bf16 v[80:95], a[132:135], v[160:163], v[80:95]
    ds_read_b128 v[176:179], v197 offset:64
    buffer_load_dwordx2 v[156:157], v48, s[16:19], s95 offen sc1
    s_waitcnt lgkmcnt(2)
    v_mfma_f32_16x16x32_bf16 v[112:115], a[136:139], v[164:167], v[112:115]
    ds_read_b128 v[180:183], v198 offset:128
    v_mfma_f32_32x32x16_bf16 v[80:95], a[136:139], v[168:171], v[80:95]
    ds_read_b128 v[184:187], v196 offset:128
    s_waitcnt lgkmcnt(2)
    v_mfma_f32_16x16x32_bf16 v[112:115], a[140:143], v[172:175], v[112:115]
    ds_read_b128 v[188:191], v198 offset:160
    v_mfma_f32_32x32x16_bf16 v[80:95], a[140:143], v[176:179], v[80:95]
    ds_read_b128 v[192:195], v197 offset:128
    s_add_u32 m0, s92, 36352
    s_nop 0
    buffer_load_dwordx4 v73, s[4:7], s99 offen offset:0  lds
    s_waitcnt lgkmcnt(2)
    s_waitcnt vmcnt(7)
    v_mfma_f32_16x16x32_bf16 v[112:115], a[144:147], v[180:183], v[112:115]
    ds_read_b128 v[160:163], v198 offset:192
    v_mfma_f32_32x32x16_bf16 v[80:95], a[144:147], v[184:187], v[80:95]
    ds_read_b128 v[164:167], v196 offset:192
    s_waitcnt lgkmcnt(2)
    s_waitcnt vmcnt(6)
    v_mfma_f32_16x16x32_bf16 v[112:115], a[148:151], v[188:191], v[112:115]
    ds_read_b128 v[168:171], v198 offset:224
    v_mfma_f32_32x32x16_bf16 v[80:95], a[148:151], v[192:195], v[80:95]
    ds_read_b128 v[172:175], v197 offset:192
    buffer_load_dwordx4 v74, s[4:7], s99 offen offset:1088  lds
    s_waitcnt lgkmcnt(2)
    s_waitcnt vmcnt(6)
    v_mfma_f32_16x16x32_bf16 v[112:115], a[152:155], v[160:163], v[112:115]
    ds_read_b128 v[176:179], v196 offset:8704
    v_mfma_f32_32x32x16_bf16 v[80:95], a[152:155], v[164:167], v[80:95]
    ds_read_b128 v[180:183], v197 offset:8704
    s_waitcnt lgkmcnt(2)
    s_waitcnt vmcnt(5)
    v_mfma_f32_16x16x32_bf16 v[112:115], a[156:159], v[168:171], v[112:115]
    ds_read_b128 v[184:187], v196 offset:8768
    v_mfma_f32_32x32x16_bf16 v[80:95], a[156:159], v[172:175], v[80:95]
    ds_read_b128 v[188:191], v197 offset:8768
    buffer_load_dwordx4 v75, s[4:7], s99 offen offset:2176  lds
    s_waitcnt lgkmcnt(2)
    v_mfma_f32_32x32x16_bf16 v[96:111], a[128:131], v[176:179], v[96:111]
    ds_read_b128 v[192:195], v196 offset:8832
    v_mfma_f32_32x32x16_bf16 v[96:111], a[132:135], v[180:183], v[96:111]
    ds_read_b128 v[160:163], v197 offset:8832
    buffer_load_dwordx4 v76, s[4:7], s99 offen offset:3264  lds
    s_mov_b32 exec_lo, 0x01010101
    s_mov_b32 exec_hi, 0x01010101
    ds_write_b128 v132, v[112:115]
    s_mov_b64 exec, -1
    s_waitcnt lgkmcnt(3)
    v_mfma_f32_32x32x16_bf16 v[96:111], a[136:139], v[184:187], v[96:111]
    ds_read_b128 v[164:167], v196 offset:8896
    ds_read_b128 v[24:27], v132
    ds_read_b128 v[8:11], v133 offset:0
    ds_read_b128 v[12:15], v133 offset:32
    ds_read_b128 v[16:19], v133 offset:64
    v_mfma_f32_32x32x16_bf16 v[96:111], a[140:143], v[188:191], v[96:111]
    ds_read_b128 v[168:171], v197 offset:8896
    s_add_u32 m0, s93, 53760
    s_add_u32 s99, s99, 256
    s_mov_b64 exec, s[80:81]
    buffer_load_dwordx4 v77, s[4:7], s100 offen  lds
    s_mov_b64 exec, -1
    s_add_u32 s100, s100, 256
    ds_read_b128 v[20:23], v133 offset:96
    s_waitcnt vmcnt(5) lgkmcnt(5)
    v_mul_f32 v148, v24, v157
    v_mfma_f32_32x32x16_bf16 v[96:111], a[144:147], v[192:195], v[96:111]
    v_mul_f32 v149, v25, v157
    v_mul_f32 v150, v26, v157
    v_mul_f32 v151, v27, v157
    s_waitcnt lgkmcnt(4)
    v_mul_f32 v116, v8, v153
    v_mul_f32 v117, v9, v153
    v_mfma_f32_32x32x16_bf16 v[96:111], a[148:151], v[160:163], v[96:111]
    v_mul_f32 v118, v10, v153
    v_mul_f32 v119, v11, v153
    s_waitcnt lgkmcnt(3)
    v_mul_f32 v120, v12, v153
    v_mul_f32 v121, v13, v153
    s_waitcnt lgkmcnt(1)
    v_mfma_f32_32x32x16_bf16 v[96:111], a[152:155], v[164:167], v[96:111]
    v_mul_f32 v122, v14, v153
    v_mul_f32 v123, v15, v153
    v_mul_f32 v124, v16, v153
    v_mul_f32 v125, v17, v153
    v_mul_f32_e64 v126, v18, v153
    v_mfma_f32_32x32x16_bf16 v[96:111], a[156:159], v[168:171], v[96:111]
    s_add_u32 m0, s92, 55936
    s_nop 0
    buffer_load_dwordx4 v73, s[4:7], s99 offen offset:0  lds
    v_mul_f32 v127, v19, v153
    s_waitcnt lgkmcnt(0)
    v_mul_f32 v128, v20, v153
    v_mul_f32 v129, v21, v153
    v_mul_f32 v130, v22, v153
    v_mul_f32_e64 v131, v23, v153
    v_fma_f32 v112, v112, v156, v148
    v_fma_f32 v113, v113, v156, v149
    v_fma_f32 v114, v114, v156, v150
    v_fma_f32 v115, v115, v156, v151
    v_cvt_pk_bf16_f32 v112, v112, v113
    v_cvt_pk_bf16_f32 v113, v114, v115
    v_fma_f32 v80, v80, v152, v116
    v_fma_f32 v81, v81, v152, v117
    v_fma_f32 v82, v82, v152, v118
    v_fma_f32 v83, v83, v152, v119
    v_cvt_pk_bf16_f32 v80, v80, v81
    v_cvt_pk_bf16_f32 v81, v82, v83
    ds_write_b64 v40, v[112:113] offset:0
    ds_write_b64 v38, v[80:81] offset:0
    v_fma_f32 v84, v84, v152, v120
    v_fma_f32 v85, v85, v152, v121
    v_fma_f32 v86, v86, v152, v122
    v_fma_f32 v87, v87, v152, v123
    v_cvt_pk_bf16_f32 v84, v84, v85
    v_cvt_pk_bf16_f32 v85, v86, v87
    v_fma_f32 v88, v88, v152, v124
    v_fma_f32 v89, v89, v152, v125
    v_fma_f32 v90, v90, v152, v126
    v_fma_f32 v91, v91, v152, v127
    v_cvt_pk_bf16_f32 v88, v88, v89
    v_cvt_pk_bf16_f32 v89, v90, v91
    ds_write_b64 v38, v[84:85] offset:6400
    ds_write_b64 v38, v[88:89] offset:12800
    v_fma_f32 v92, v92, v152, v128
    v_fma_f32 v93, v93, v152, v129
    v_fma_f32 v94, v94, v152, v130
    v_fma_f32 v95, v95, v152, v131
    v_cvt_pk_bf16_f32 v92, v92, v93
    v_cvt_pk_bf16_f32 v93, v94, v95
    ds_write_b64 v39, v[92:93] offset:0
    v_mul_f32 v132, v8, v155
    v_mul_f32 v133, v9, v155
    v_mul_f32 v134, v10, v155
    v_mul_f32 v135, v11, v155
    v_mul_f32 v136, v12, v155
    v_mul_f32 v137, v13, v155
    v_mul_f32 v138, v14, v155
    v_mul_f32 v139, v15, v155
    v_mul_f32 v140, v16, v155
    v_mul_f32 v141, v17, v155
    v_mul_f32 v142, v18, v155
    v_mul_f32 v143, v19, v155
    v_mul_f32 v144, v20, v155
    v_mul_f32 v145, v21, v155
    v_mul_f32 v146, v22, v155
    v_mul_f32 v147, v23, v155
    v_pk_fma_f32 v[96:97], v[96:97], v[154:155], v[132:133] op_sel_hi:[1,0,1]
    v_pk_fma_f32 v[98:99], v[98:99], v[154:155], v[134:135] op_sel_hi:[1,0,1]
    v_cvt_pk_bf16_f32 v96, v96, v97
    v_cvt_pk_bf16_f32 v97, v98, v99
    v_pk_fma_f32 v[100:101], v[100:101], v[154:155], v[136:137] op_sel_hi:[1,0,1]
    v_pk_fma_f32 v[102:103], v[102:103], v[154:155], v[138:139] op_sel_hi:[1,0,1]
    v_cvt_pk_bf16_f32 v100, v100, v101
    v_cvt_pk_bf16_f32 v101, v102, v103
    ds_write_b64 v38, v[96:97] offset:1600
    ds_write_b64 v38, v[100:101] offset:8000
    v_pk_fma_f32 v[104:105], v[104:105], v[154:155], v[140:141] op_sel_hi:[1,0,1]
    v_pk_fma_f32 v[106:107], v[106:107], v[154:155], v[142:143] op_sel_hi:[1,0,1]
    v_cvt_pk_bf16_f32 v104, v104, v105
    v_cvt_pk_bf16_f32 v105, v106, v107
    v_pk_fma_f32 v[108:109], v[108:109], v[154:155], v[144:145] op_sel_hi:[1,0,1]
    v_pk_fma_f32 v[110:111], v[110:111], v[154:155], v[146:147] op_sel_hi:[1,0,1]
    v_cvt_pk_bf16_f32 v108, v108, v109
    v_cvt_pk_bf16_f32 v109, v110, v111
    ds_write_b64 v38, v[104:105] offset:14400
    ds_write_b64 v39, v[108:109] offset:1600
    s_waitcnt lgkmcnt(0)
    s_barrier
    v_mov_b32 v94, 0
    v_mov_b32 v95, 0
    v_mov_b32 v98, 0
    v_mov_b32 v99, 0
    s_mov_b64 exec, 0xffff
    ds_read_b64 v[94:95], v42 offset:320
    ds_read_b64 v[98:99], v42 offset:640
    s_mov_b64 exec, -1
    s_nop 0
    ds_read_b64 v[92:93], v41 offset:320
    ds_read_b64 v[96:97], v41 offset:640
    ds_read_b64 v[84:85], v41 offset:6720
    ds_read_b64 v[86:87], v42 offset:6720
    ds_read_b64 v[80:81], v41 offset:6400
    ds_read_b64 v[82:83], v42 offset:6400
    ds_read_b64 v[88:89], v41 offset:7040
    ds_read_b64 v[90:91], v42 offset:7040
    ds_read_b64_tr_b16 v[106:107], v44 offset:0
    ds_read_b64_tr_b16 v[100:101], v43 offset:0
    ds_read_b64_tr_b16 v[108:109], v44 offset:320
    ds_read_b64_tr_b16 v[102:103], v43 offset:320
    buffer_load_dwordx4 v74, s[4:7], s99 offen offset:1088  lds
    ds_read_b64_tr_b16 v[110:111], v44 offset:640
    ds_read_b64_tr_b16 v[104:105], v43 offset:640
    v_mov_b32 v156, 0xf149f2ca
    v_cndmask_b32 v152, v32, v156, s[90:91]
    v_cndmask_b32 v153, v33, v156, s[90:91]
    v_cndmask_b32 v154, v34, v156, s[90:91]
    v_cndmask_b32 v155, v35, v156, s[90:91]
    s_mov_b32 s82, 0x3ea52b5c
    buffer_load_dwordx4 v75, s[4:7], s99 offen offset:2176  lds
    s_lshl_b32 s25, s98, 4
    s_add_u32 s25, s25, 4194304
    s_lshl_b32 s26, s98, 3
    s_add_u32 s26, s26, 4194304
    s_waitcnt lgkmcnt(10)
    v_mfma_f32_16x16x32_bf16 v[116:119], v[84:87], v[92:95], v[28:31]
    v_mfma_f32_16x16x32_bf16 v[120:123], v[84:87], v[96:99], v[32:35]
    s_waitcnt lgkmcnt(8)
    v_mfma_f32_16x16x32_bf16 v[112:115], v[80:83], v[92:95], v[152:155]
    s_waitcnt lgkmcnt(6)
    v_mfma_f32_16x16x32_bf16 v[124:127], v[88:91], v[96:99], v[28:31]
    buffer_load_dwordx4 v76, s[4:7], s99 offen offset:3264  lds
    s_nop 4
    v_max_f32 v112, v112, v116
    v_max_f32 v113, v113, v117
    v_max_f32 v114, v114, v118
    v_max_f32 v115, v115, v119
    v_max3_f32 v156, v112, v113, v114
    v_max_f32 v156, v156, v115
    v_max_f32 v120, v120, v124
    v_max_f32_e64 v121, v121, v125
    s_add_u32 m0, s93, 73344
    s_add_u32 s99, s99, 256
    s_mov_b64 exec, s[80:81]
    buffer_load_dwordx4 v77, s[4:7], s100 offen  lds
    s_mov_b64 exec, -1
    s_add_u32 s100, s100, 256
    v_max_f32 v122, v122, v126
    v_max_f32 v123, v123, v127
    v_max3_f32 v157, v120, v121, v122
    v_max_f32 v157, v157, v123
    s_nop 1
    v_permlane16_swap_b32 v156, v157
    v_max_f32 v156, v156, v157
    v_mov_b32 v157, v156
    s_nop 1
    v_permlane32_swap_b32 v156, v157
    s_add_u32 m0, s92, 75520
    s_nop 0
    buffer_load_dwordx4 v73, s[4:7], s99 offen offset:0  lds
    v_max_f32 v156, v156, v157
    v_mul_f32 v156, s82, v156
    v_mov_b32 v157, v156
    s_nop 1
    v_permlane16_swap_b32_e64 v156, v157
    v_fma_f32 v112, v112, s82, -v156
    v_fma_f32 v113, v113, s82, -v156
    v_fma_f32 v114, v114, s82, -v156
    v_fma_f32 v115, v115, s82, -v156
    buffer_load_dwordx4 v74, s[4:7], s99 offen offset:1088  lds
    v_exp_f32 v112, v112
    v_exp_f32 v113, v113
    v_exp_f32 v114, v114
    v_exp_f32 v115, v115
    v_cvt_pk_bf16_f32 v116, v112, v113
    v_cvt_pk_bf16_f32 v117, v114, v115
    v_bfi_b32 v128, v36, 0, v116
    v_and_b32_e64 v130, v36, v116
    buffer_load_dwordx4 v75, s[4:7], s99 offen offset:2176  lds
    v_bfi_b32 v129, v37, 0, v117
    v_and_b32 v131, v37, v117
    s_waitcnt lgkmcnt(3)
    s_nop 0
    v_mfma_f32_16x16x32_bf16 v[144:147], v[106:109], v[128:131], 0
    s_waitcnt lgkmcnt(2)
    v_mfma_f32_16x16x32_bf16 v[136:139], v[100:103], v[128:131], 0
    v_fma_f32 v120, v120, s82, -v157
    v_fma_f32 v121, v121, s82, -v157
    v_fma_f32 v122, v122, s82, -v157
    v_fma_f32 v123, v123, s82, -v157
    buffer_load_dwordx4 v76, s[4:7], s99 offen offset:3264  lds
    v_exp_f32 v120, v120
    v_exp_f32 v121, v121
    v_exp_f32 v122, v122
    v_exp_f32 v123, v123
    v_cvt_pk_bf16_f32 v124, v120, v121
    v_cvt_pk_bf16_f32 v125, v122, v123
    v_bfi_b32 v132, v36, 0, v124
    v_and_b32_e64 v134, v36, v124
    s_add_u32 m0, s93, 92928
    s_add_u32 s99, s99, 256
    s_mov_b64 exec, s[80:81]
    buffer_load_dwordx4 v77, s[4:7], s100 offen  lds
    s_mov_b64 exec, -1
    s_add_u32 s100, s100, 256
    v_bfi_b32 v133, v37, 0, v125
    v_and_b32 v135, v37, v125
    s_waitcnt lgkmcnt(1)
    s_nop 0
    v_mfma_f32_16x16x32_bf16 v[148:151], v[108:111], v[132:135], 0
    s_waitcnt lgkmcnt(0)
    v_mfma_f32_16x16x32_bf16 v[140:143], v[102:105], v[132:135], 0
    v_mov_b32 v158, v144
    s_nop 1
    v_permlane16_swap_b32 v144, v158
    v_rcp_f32 v158, v158
    s_nop 0
    v_pk_mul_f32 v[136:137], v[136:137], v[158:159] op_sel_hi:[1,0]
    s_lshl_b32 s97, s73, 2
    s_add_u32 s97, s97, s24
    s_nop 0
    s_mul_i32 s97, s97, 25600
    s_add_u32 s97, s97, 2621440
    buffer_load_dwordx4 a[160:163], v58, s[16:19], s97 offen offset:0 sc1
    v_pk_mul_f32 v[138:139], v[138:139], v[158:159] op_sel_hi:[1,0]
    v_pk_mul_f32 v[144:145], v[144:145], v[158:159] op_sel_hi:[1,0]
    v_pk_mul_f32 v[146:147], v[146:147], v[158:159] op_sel_hi:[1,0]
    v_cvt_pk_bf16_f32 v112, v136, v137
    v_cvt_pk_bf16_f32 v116, v144, v145
    v_cvt_pk_bf16_f32 v113, v138, v139
    v_cvt_pk_bf16_f32 v117, v146, v147
    v_mov_b32 v160, v148
    buffer_load_dwordx4 a[164:167], v58, s[16:19], s97 offen offset:1024 sc1
    s_nop 0
    v_permlane16_swap_b32 v148, v160
    v_rcp_f32_e64 v160, v160
    s_nop 0
    v_pk_mul_f32 v[140:141], v[140:141], v[160:161] op_sel_hi:[1,0]
    v_pk_mul_f32 v[142:143], v[142:143], v[160:161] op_sel_hi:[1,0]
    v_pk_mul_f32 v[148:149], v[148:149], v[160:161] op_sel_hi:[1,0]
    v_pk_mul_f32 v[150:151], v[150:151], v[160:161] op_sel_hi:[1,0]
    v_cvt_pk_bf16_f32 v114, v140, v141
    v_cvt_pk_bf16_f32 v118, v148, v149
    buffer_load_dwordx4 a[168:171], v58, s[16:19], s97 offen offset:2048 sc1
    v_cvt_pk_bf16_f32 v115, v142, v143
    v_cvt_pk_bf16_f32 v119, v150, v151
    v_permlane16_swap_b32 v112, v114
    v_permlane16_swap_b32 v113, v115
    v_permlane16_swap_b32 v116, v118
    v_permlane16_swap_b32 v117, v119
    buffer_store_dwordx4 v[112:115], v45, s[16:19], s25 offen sc1
    s_mov_b64 exec, s[80:81]
    buffer_store_dwordx2 v[116:117], v46, s[16:19], s26 offen sc1
    s_mov_b64 exec, -1
    buffer_load_dwordx4 a[172:175], v58, s[16:19], s97 offen offset:3072 sc1
    s_add_u32 s97, s97, 4096
    buffer_load_dwordx4 a[176:179], v58, s[16:19], s97 offen offset:0 sc1
    v_add_u32 v196, 36352, v78
    v_mov_b32 v198, v79
    v_xor_b32 v197, 32, v196
    s_waitcnt vmcnt(17)
    s_barrier
    ds_read_b128 v[160:163], v198 offset:0
    ds_read_b128 v[164:167], v196 offset:0
    ds_read_b128 v[168:171], v196 offset:8704
    ds_read_b128 v[172:175], v198 offset:32
    ds_read_b128 v[176:179], v197 offset:0
    ds_read_b128 v[180:183], v197 offset:8704
    s_waitcnt lgkmcnt(3)
    v_mfma_f32_16x16x32_bf16 v[112:115], a[0:3], v[160:163], 0
    ds_read_b128 v[184:187], v198 offset:64
    v_mfma_f32_32x32x16_bf16 v[80:95], a[0:3], v[164:167], 0
    ds_read_b128 v[188:191], v196 offset:64
    v_mfma_f32_32x32x16_bf16 v[96:111], a[0:3], v[168:171], 0
    ds_read_b128 v[192:195], v196 offset:8768
    s_add_u32 m0, s92, 95104
    s_nop 0
    buffer_load_dwordx4 v73, s[4:7], s99 offen offset:0  lds
    s_waitcnt lgkmcnt(3)
    v_mfma_f32_16x16x32_bf16 v[112:115], a[4:7], v[172:175], v[112:115]
    ds_read_b128 v[160:163], v198 offset:96
    v_mfma_f32_32x32x16_bf16 v[80:95], a[4:7], v[176:179], v[80:95]
    ds_read_b128 v[164:167], v197 offset:64
    v_mfma_f32_32x32x16_bf16 v[96:111], a[4:7], v[180:183], v[96:111]
    ds_read_b128 v[168:171], v197 offset:8768
    buffer_load_dwordx4 v74, s[4:7], s99 offen offset:1088  lds
    s_waitcnt lgkmcnt(3)
    v_mfma_f32_16x16x32_bf16 v[112:115], a[8:11], v[184:187], v[112:115]
    ds_read_b128 v[172:175], v198 offset:128
    v_mfma_f32_32x32x16_bf16 v[80:95], a[8:11], v[188:191], v[80:95]
    ds_read_b128 v[176:179], v196 offset:128
    v_mfma_f32_32x32x16_bf16 v[96:111], a[8:11], v[192:195], v[96:111]
    ds_read_b128 v[180:183], v196 offset:8832
    buffer_load_dwordx4 v75, s[4:7], s99 offen offset:2176  lds
    s_waitcnt lgkmcnt(3)
    v_mfma_f32_16x16x32_bf16 v[112:115], a[12:15], v[160:163], v[112:115]
    ds_read_b128 v[184:187], v198 offset:160
    v_mfma_f32_32x32x16_bf16 v[80:95], a[12:15], v[164:167], v[80:95]
    ds_read_b128 v[188:191], v197 offset:128
    v_mfma_f32_32x32x16_bf16 v[96:111], a[12:15], v[168:171], v[96:111]
    ds_read_b128 v[192:195], v197 offset:8832
    buffer_load_dwordx4 v76, s[4:7], s99 offen offset:3264  lds
    s_waitcnt lgkmcnt(3)
    v_mfma_f32_16x16x32_bf16 v[112:115], a[16:19], v[172:175], v[112:115]
    ds_read_b128 v[160:163], v198 offset:192
    v_mfma_f32_32x32x16_bf16 v[80:95], a[16:19], v[176:179], v[80:95]
    ds_read_b128 v[164:167], v196 offset:192
    v_mfma_f32_32x32x16_bf16 v[96:111], a[16:19], v[180:183], v[96:111]
    ds_read_b128 v[168:171], v196 offset:8896
    s_add_u32 m0, s93, 112512
    s_add_u32 s99, s99, 256
    s_mov_b64 exec, s[80:81]
    buffer_load_dwordx4 v77, s[4:7], s100 offen  lds
    s_mov_b64 exec, -1
    s_add_u32 s100, s100, 256
    s_waitcnt lgkmcnt(3)
    v_mfma_f32_16x16x32_bf16 v[112:115], a[20:23], v[184:187], v[112:115]
    ds_read_b128 v[172:175], v198 offset:224
    v_mfma_f32_32x32x16_bf16 v[80:95], a[20:23], v[188:191], v[80:95]
    ds_read_b128 v[176:179], v197 offset:192
    v_mfma_f32_32x32x16_bf16 v[96:111], a[20:23], v[192:195], v[96:111]
    ds_read_b128 v[180:183], v197 offset:8896
    s_add_u32 m0, s92, 114688
    s_nop 0
    buffer_load_dwordx4 v73, s[4:7], s99 offen offset:0  lds
    s_waitcnt vmcnt(18)
    s_barrier
    s_waitcnt lgkmcnt(3)
    v_mfma_f32_16x16x32_bf16 v[112:115], a[24:27], v[160:163], v[112:115]
    v_add_u32 v198, v49, v198
    v_mfma_f32_32x32x16_bf16 v[80:95], a[24:27], v[164:167], v[80:95]
    v_add_u32 v196, 19584, v196
    v_add_u32 v197, 19584, v197
    ds_read_b128 v[184:187], v198 offset:0
    v_mfma_f32_32x32x16_bf16 v[96:111], a[24:27], v[168:171], v[96:111]
    ds_read_b128 v[188:191], v196 offset:0
    ds_read_b128 v[192:195], v196 offset:8704
    buffer_load_dwordx4 v74, s[4:7], s99 offen offset:1088  lds
    s_waitcnt lgkmcnt(3)
    v_mfma_f32_16x16x32_bf16 v[112:115], a[28:31], v[172:175], v[112:115]
    ds_read_b128 v[160:163], v198 offset:32
    v_mfma_f32_32x32x16_bf16 v[80:95], a[28:31], v[176:179], v[80:95]
    ds_read_b128 v[164:167], v197 offset:0
    v_mfma_f32_32x32x16_bf16 v[96:111], a[28:31], v[180:183], v[96:111]
    ds_read_b128 v[168:171], v197 offset:8704
    buffer_load_dwordx4 v75, s[4:7], s99 offen offset:2176  lds
    s_waitcnt lgkmcnt(3)
    v_mfma_f32_16x16x32_bf16 v[112:115], a[32:35], v[184:187], v[112:115]
    ds_read_b128 v[172:175], v198 offset:64
    v_mfma_f32_32x32x16_bf16 v[80:95], a[32:35], v[188:191], v[80:95]
    ds_read_b128 v[176:179], v196 offset:64
    v_mfma_f32_32x32x16_bf16 v[96:111], a[32:35], v[192:195], v[96:111]
    ds_read_b128 v[180:183], v196 offset:8768
    buffer_load_dwordx4 v76, s[4:7], s99 offen offset:3264  lds
    s_waitcnt lgkmcnt(3)
    v_mfma_f32_16x16x32_bf16 v[112:115], a[36:39], v[160:163], v[112:115]
    ds_read_b128 v[184:187], v198 offset:96
    v_mfma_f32_32x32x16_bf16 v[80:95], a[36:39], v[164:167], v[80:95]
    ds_read_b128 v[188:191], v197 offset:64
    v_mfma_f32_32x32x16_bf16 v[96:111], a[36:39], v[168:171], v[96:111]
    ds_read_b128 v[192:195], v197 offset:8768
    s_add_u32 m0, s93, 132096
    s_add_u32 s99, s99, 256
    s_mov_b64 exec, s[80:81]
    buffer_load_dwordx4 v77, s[4:7], s100 offen  lds
    s_mov_b64 exec, -1
    s_add_u32 s100, s100, 256
    s_waitcnt lgkmcnt(3)
    v_mfma_f32_16x16x32_bf16 v[112:115], a[40:43], v[172:175], v[112:115]
    ds_read_b128 v[160:163], v198 offset:128
    v_mfma_f32_32x32x16_bf16 v[80:95], a[40:43], v[176:179], v[80:95]
    ds_read_b128 v[164:167], v196 offset:128
    s_lshl_b32 s25, s24, 6
    s_and_b32 s35, s74, 3
    s_lshl_b32 s35, s35, 13
    s_add_u32 s35, s35, s25
    v_mfma_f32_32x32x16_bf16 v[96:111], a[40:43], v[180:183], v[96:111]
    ds_read_b128 v[168:171], v196 offset:8832
    s_lshl_b32 s98, s72, 5
    s_add_u32 s98, s98, 256
    s_sub_u32 s95, s98, 4
    s_max_i32 s95, s95, 0
    s_lshl_b32 s94, s98, 3
    s_lshl_b32 s95, s95, 3
    s_add_u32 s94, s94, 3440640
    s_add_u32 s95, s95, 3440640
    s_add_u32 s96, s94, 8192
    buffer_load_dwordx2 v[152:153], v47, s[16:19], s94 offen sc1
    s_waitcnt lgkmcnt(3)
    v_mfma_f32_16x16x32_bf16 v[112:115], a[44:47], v[184:187], v[112:115]
    ds_read_b128 v[172:175], v198 offset:160
    v_mfma_f32_32x32x16_bf16 v[80:95], a[44:47], v[188:191], v[80:95]
    ds_read_b128 v[176:179], v197 offset:128
    s_lshr_b32 s25, s74, 4
    s_lshl_b32 s25, s25, 11
    s_add_u32 s35, s35, s25
    s_and_b32 s25, s74, 12
    v_mfma_f32_32x32x16_bf16 v[96:111], a[44:47], v[192:195], v[96:111]
    ds_read_b128 v[180:183], v197 offset:8832
    buffer_load_dwordx2 v[154:155], v47, s[16:19], s96 offen sc1
    s_lshl_b32 s25, s25, 6
    s_add_u32 s35, s35, s25
    s_waitcnt lgkmcnt(3)
    v_mfma_f32_16x16x32_bf16 v[112:115], a[48:51], v[160:163], v[112:115]
    ds_read_b128 v[184:187], v198 offset:192
    v_mfma_f32_32x32x16_bf16 v[80:95], a[48:51], v[164:167], v[80:95]
    ds_read_b128 v[188:191], v196 offset:192
    s_mul_i32 s36, s73, 20
    s_add_u32 s36, s36, s24
    s_add_u32 s36, s36, 16
    s_lshl_b32 s36, s36, 14
    v_mfma_f32_32x32x16_bf16 v[96:111], a[48:51], v[168:171], v[96:111]
    ds_read_b128 v[192:195], v196 offset:8896
    buffer_load_dwordx2 v[156:157], v48, s[16:19], s95 offen sc1
    v_add_u32 v199, 36352, v58
    s_lshl_b32 s32, s24, 11
    s_waitcnt lgkmcnt(3)
    v_mfma_f32_16x16x32_bf16 v[112:115], a[52:55], v[172:175], v[112:115]
    ds_read_b128 v[160:163], v198 offset:224
    v_mfma_f32_32x32x16_bf16 v[80:95], a[52:55], v[176:179], v[80:95]
    ds_read_b128 v[164:167], v197 offset:192
    v_add_u32 v203, s32, v199
    s_add_u32 s32, s24, 1
    s_and_b32 s32, s32, 3
    s_mul_i32 s32, s32, 6144
    v_mfma_f32_32x32x16_bf16 v[96:111], a[52:55], v[180:183], v[96:111]
    ds_read_b128 v[168:171], v197 offset:8896
    buffer_load_dwordx4 a[180:183], v58, s[16:19], s97 offen offset:1024 sc1
    v_add_u32 v200, s32, v199
    s_add_u32 s32, s24, 2
    s_waitcnt vmcnt(21)
    s_barrier
    s_waitcnt lgkmcnt(3)
    v_mfma_f32_16x16x32_bf16 v[112:115], a[56:59], v[184:187], v[112:115]
    v_add_u32 v198, v49, v198
    v_mfma_f32_32x32x16_bf16 v[80:95], a[56:59], v[188:191], v[80:95]
    v_add_u32 v196, 19584, v196
    v_add_u32 v197, 19584, v197
    ds_read_b128 v[172:175], v198 offset:0
    s_and_b32 s32, s32, 3
    s_mul_i32 s32, s32, 6144
    v_mfma_f32_32x32x16_bf16 v[96:111], a[56:59], v[192:195], v[96:111]
    ds_read_b128 v[176:179], v196 offset:0
    ds_read_b128 v[180:183], v196 offset:8704
    buffer_load_dwordx4 a[184:187], v58, s[16:19], s97 offen offset:2048 sc1
    v_add_u32_e64 v201, s32, v199
    s_waitcnt lgkmcnt(3)
    v_mfma_f32_16x16x32_bf16 v[112:115], a[60:63], v[160:163], v[112:115]
    ds_read_b128 v[184:187], v198 offset:32
    v_mfma_f32_32x32x16_bf16 v[80:95], a[60:63], v[164:167], v[80:95]
    ds_read_b128 v[188:191], v197 offset:0
    s_add_u32 s32, s24, 3
    s_and_b32 s32, s32, 3
    s_mul_i32 s32, s32, 6144
    v_add_u32_e64 v202, s32, v199
    v_mfma_f32_32x32x16_bf16 v[96:111], a[60:63], v[168:171], v[96:111]
    ds_read_b128 v[192:195], v197 offset:8704
    buffer_load_dwordx4 a[188:191], v58, s[16:19], s97 offen offset:3072 sc1
    s_mul_i32 s32, s24, 6144
    v_add_u32 v204, s32, v199
    s_waitcnt lgkmcnt(3)
    v_mfma_f32_16x16x32_bf16 v[112:115], a[64:67], v[172:175], v[112:115]
    ds_read_b128 v[160:163], v198 offset:64
    v_mfma_f32_32x32x16_bf16 v[80:95], a[64:67], v[176:179], v[80:95]
    ds_read_b128 v[164:167], v196 offset:64
    s_lshl_b32 s32, s24, 8
    s_add_u32 s32, s32, 36352
    v_and_b32 v214, 15, v1
    v_lshl_add_u32 v206, v214, 4, s32
    v_mfma_f32_32x32x16_bf16 v[96:111], a[64:67], v[180:183], v[96:111]
    ds_read_b128 v[168:171], v196 offset:8768
    s_add_u32 s97, s97, 4096
    buffer_load_dwordx4 a[192:195], v58, s[16:19], s97 offen offset:0 sc1
    v_lshrrev_b32 v215, 5, v1
    s_waitcnt lgkmcnt(3)
    v_mfma_f32_16x16x32_bf16 v[112:115], a[68:71], v[184:187], v[112:115]
    ds_read_b128 v[172:175], v198 offset:96
    v_mfma_f32_32x32x16_bf16 v[80:95], a[68:71], v[188:191], v[80:95]
    ds_read_b128 v[176:179], v197 offset:64
    v_lshl_add_u32 v205, v215, 10, v206
    v_bfe_u32 v215, v1, 4, 1
    v_lshl_add_u32 v205, v215, 3, v205
    v_lshlrev_b32_e64 v214, 2, v214
    v_mfma_f32_32x32x16_bf16 v[96:111], a[68:71], v[192:195], v[96:111]
    ds_read_b128 v[180:183], v197 offset:8768
    buffer_load_dwordx4 a[196:199], v58, s[16:19], s97 offen offset:1024 sc1
    v_lshl_add_u32 v214, v215, 10, v214
    s_lshl_b32 s32, s24, 6
    s_waitcnt lgkmcnt(3)
    v_mfma_f32_16x16x32_bf16 v[112:115], a[72:75], v[160:163], v[112:115]
    ds_read_b128 v[184:187], v198 offset:128
    v_mfma_f32_32x32x16_bf16 v[80:95], a[72:75], v[164:167], v[80:95]
    ds_read_b128 v[188:191], v196 offset:128
    v_lshl_add_u32 v207, v215, 3, s32
    v_and_b32 v215, 12, v1
    v_lshl_add_u32 v207, v215, 2, v207
    v_and_b32 v215, 2, v1
    v_mfma_f32_32x32x16_bf16 v[96:111], a[72:75], v[168:171], v[96:111]
    ds_read_b128 v[192:195], v196 offset:8832
    buffer_load_dwordx4 a[200:203], v58, s[16:19], s97 offen offset:2048 sc1
    v_lshl_add_u32 v207, v215, 1, v207
    v_add_u32 v207, 69120, v207
    s_waitcnt lgkmcnt(3)
    v_mfma_f32_16x16x32_bf16 v[112:115], a[76:79], v[172:175], v[112:115]
    ds_read_b128 v[160:163], v198 offset:160
    v_mfma_f32_32x32x16_bf16 v[80:95], a[76:79], v[176:179], v[80:95]
    ds_read_b128 v[164:167], v197 offset:128
    v_lshrrev_b32 v215, 4, v1
    v_lshl_add_u32 v206, v215, 2, v206
    v_mov_b32 v215, 0x3f803f80
    v_mfma_f32_32x32x16_bf16 v[96:111], a[76:79], v[180:183], v[96:111]
    ds_read_b128 v[168:171], v197 offset:8832
    buffer_load_dwordx4 a[204:207], v58, s[16:19], s97 offen offset:3072 sc1
    s_waitcnt lgkmcnt(3)
    v_mfma_f32_16x16x32_bf16 v[112:115], a[80:83], v[184:187], v[112:115]
    ds_read_b128 v[172:175], v198 offset:192
    v_mfma_f32_32x32x16_bf16 v[80:95], a[80:83], v[188:191], v[80:95]
    ds_read_b128 v[176:179], v196 offset:192
    v_mfma_f32_32x32x16_bf16 v[96:111], a[80:83], v[192:195], v[96:111]
    ds_read_b128 v[180:183], v196 offset:8896
    s_add_u32 s97, s97, 4096
    buffer_load_dwordx4 a[208:211], v58, s[16:19], s97 offen offset:0 sc1
    s_waitcnt lgkmcnt(3)
    v_mfma_f32_16x16x32_bf16 v[112:115], a[84:87], v[160:163], v[112:115]
    ds_read_b128 v[184:187], v198 offset:224
    v_mfma_f32_32x32x16_bf16 v[80:95], a[84:87], v[164:167], v[80:95]
    ds_read_b128 v[188:191], v197 offset:192
    v_mfma_f32_32x32x16_bf16 v[96:111], a[84:87], v[168:171], v[96:111]
    ds_read_b128 v[192:195], v197 offset:8896
    buffer_load_dwordx4 a[212:215], v58, s[16:19], s97 offen offset:1024 sc1
    s_waitcnt vmcnt(17)
    s_barrier
    s_waitcnt lgkmcnt(3)
    v_mfma_f32_16x16x32_bf16 v[112:115], a[88:91], v[172:175], v[112:115]
    v_add_u32 v198, v49, v198
    v_mfma_f32_32x32x16_bf16 v[80:95], a[88:91], v[176:179], v[80:95]
    v_add_u32 v196, 19584, v196
    v_add_u32 v197, 19584, v197
    ds_read_b128 v[160:163], v198 offset:0
    v_mfma_f32_32x32x16_bf16 v[96:111], a[88:91], v[180:183], v[96:111]
    ds_read_b128 v[164:167], v196 offset:0
    ds_read_b128 v[168:171], v196 offset:8704
    buffer_load_dwordx4 a[216:219], v58, s[16:19], s97 offen offset:2048 sc1
    s_waitcnt lgkmcnt(3)
    v_mfma_f32_16x16x32_bf16 v[112:115], a[92:95], v[184:187], v[112:115]
    ds_read_b128 v[172:175], v198 offset:32
    v_mfma_f32_32x32x16_bf16 v[80:95], a[92:95], v[188:191], v[80:95]
    ds_read_b128 v[176:179], v197 offset:0
    v_mfma_f32_32x32x16_bf16 v[96:111], a[92:95], v[192:195], v[96:111]
    ds_read_b128 v[180:183], v197 offset:8704
    buffer_load_dwordx4 a[220:223], v58, s[16:19], s97 offen offset:3072 sc1
    s_waitcnt lgkmcnt(3)
    v_mfma_f32_16x16x32_bf16 v[112:115], a[96:99], v[160:163], v[112:115]
    ds_read_b128 v[184:187], v198 offset:64
    v_mfma_f32_32x32x16_bf16 v[80:95], a[96:99], v[164:167], v[80:95]
    ds_read_b128 v[188:191], v196 offset:64
    v_mfma_f32_32x32x16_bf16 v[96:111], a[96:99], v[168:171], v[96:111]
    ds_read_b128 v[192:195], v196 offset:8768
    s_add_u32 s97, s97, 4096
    buffer_load_dwordx4 a[224:227], v58, s[16:19], s97 offen offset:0 sc1
    s_waitcnt lgkmcnt(3)
    v_mfma_f32_16x16x32_bf16 v[112:115], a[100:103], v[172:175], v[112:115]
    ds_read_b128 v[160:163], v198 offset:96
    v_mfma_f32_32x32x16_bf16 v[80:95], a[100:103], v[176:179], v[80:95]
    ds_read_b128 v[164:167], v197 offset:64
    v_mfma_f32_32x32x16_bf16 v[96:111], a[100:103], v[180:183], v[96:111]
    ds_read_b128 v[168:171], v197 offset:8768
    buffer_load_dwordx4 a[228:231], v58, s[16:19], s97 offen offset:1024 sc1
    s_waitcnt lgkmcnt(3)
    v_mfma_f32_16x16x32_bf16 v[112:115], a[104:107], v[184:187], v[112:115]
    ds_read_b128 v[172:175], v198 offset:128
    v_mfma_f32_32x32x16_bf16 v[80:95], a[104:107], v[188:191], v[80:95]
    ds_read_b128 v[176:179], v196 offset:128
    v_mfma_f32_32x32x16_bf16 v[96:111], a[104:107], v[192:195], v[96:111]
    ds_read_b128 v[180:183], v196 offset:8832
    buffer_load_dwordx4 a[232:235], v58, s[16:19], s97 offen offset:2048 sc1
    s_waitcnt lgkmcnt(3)
    v_mfma_f32_16x16x32_bf16 v[112:115], a[108:111], v[160:163], v[112:115]
    ds_read_b128 v[184:187], v198 offset:160
    v_mfma_f32_32x32x16_bf16 v[80:95], a[108:111], v[164:167], v[80:95]
    ds_read_b128 v[188:191], v197 offset:128
    v_mfma_f32_32x32x16_bf16 v[96:111], a[108:111], v[168:171], v[96:111]
    ds_read_b128 v[192:195], v197 offset:8832
    buffer_load_dwordx4 a[236:239], v58, s[16:19], s97 offen offset:3072 sc1
    s_waitcnt lgkmcnt(3)
    v_mfma_f32_16x16x32_bf16 v[112:115], a[112:115], v[172:175], v[112:115]
    ds_read_b128 v[160:163], v198 offset:192
    v_mfma_f32_32x32x16_bf16 v[80:95], a[112:115], v[176:179], v[80:95]
    ds_read_b128 v[164:167], v196 offset:192
    v_mfma_f32_32x32x16_bf16 v[96:111], a[112:115], v[180:183], v[96:111]
    ds_read_b128 v[168:171], v196 offset:8896
    s_add_u32 s97, s97, 4096
    buffer_load_dwordx4 a[240:243], v58, s[16:19], s97 offen offset:0 sc1
    s_waitcnt lgkmcnt(3)
    v_mfma_f32_16x16x32_bf16 v[112:115], a[116:119], v[184:187], v[112:115]
    ds_read_b128 v[172:175], v198 offset:224
    v_mfma_f32_32x32x16_bf16 v[80:95], a[116:119], v[188:191], v[80:95]
    ds_read_b128 v[176:179], v197 offset:192
    v_mfma_f32_32x32x16_bf16 v[96:111], a[116:119], v[192:195], v[96:111]
    ds_read_b128 v[180:183], v197 offset:8896
    buffer_load_dwordx4 a[244:247], v58, s[16:19], s97 offen offset:1024 sc1
    s_waitcnt vmcnt(20)
    s_barrier
    s_waitcnt lgkmcnt(3)
    v_mfma_f32_16x16x32_bf16 v[112:115], a[120:123], v[160:163], v[112:115]
    v_add_u32_e64 v198, v49, v198
    v_mfma_f32_32x32x16_bf16 v[80:95], a[120:123], v[164:167], v[80:95]
    v_add_u32 v196, 19584, v196
    v_add_u32 v197, 19584, v197
    s_waitcnt vmcnt(17)
    v_mul_f32 v148, v24, v157
    v_mul_f32 v149, v25, v157
    v_mul_f32 v150, v26, v157
    v_mfma_f32_32x32x16_bf16 v[96:111], a[120:123], v[168:171], v[96:111]
    ds_read_b128 v[184:187], v198 offset:0
    ds_read_b128 v[188:191], v196 offset:0
    buffer_load_dwordx4 a[248:251], v58, s[16:19], s97 offen offset:2048 sc1
    v_mul_f32 v151, v27, v157
    v_mul_f32_e64 v116, v8, v153
    s_waitcnt lgkmcnt(2)
    v_mfma_f32_16x16x32_bf16 v[112:115], a[124:127], v[172:175], v[112:115]
    ds_read_b128 v[192:195], v198 offset:32
    v_mfma_f32_32x32x16_bf16 v[80:95], a[124:127], v[176:179], v[80:95]
    ds_read_b128 v[160:163], v197 offset:0
    v_mul_f32 v117, v9, v153
    v_mul_f32 v118, v10, v153
    v_mul_f32 v119, v11, v153
    v_mul_f32 v120, v12, v153
    v_mfma_f32_32x32x16_bf16 v[96:111], a[124:127], v[180:183], v[96:111]
    buffer_load_dwordx4 a[252:255], v58, s[16:19], s97 offen offset:3072 sc1
    v_mul_f32 v121, v13, v153
    v_mul_f32 v122, v14, v153
    v_mul_f32 v123, v15, v153
    s_waitcnt lgkmcnt(2)
    v_mfma_f32_16x16x32_bf16 v[112:115], a[128:131], v[184:187], v[112:115]
    ds_read_b128 v[164:167], v198 offset:64
    v_mfma_f32_32x32x16_bf16 v[80:95], a[128:131], v[188:191], v[80:95]
    ds_read_b128 v[168:171], v196 offset:64
    v_mul_f32 v124, v16, v153
    v_mul_f32 v125, v17, v153
    v_mul_f32 v126, v18, v153
    s_waitcnt lgkmcnt(2)
    v_mfma_f32_16x16x32_bf16 v[112:115], a[132:135], v[192:195], v[112:115]
    ds_read_b128 v[172:175], v198 offset:96
    v_mfma_f32_32x32x16_bf16 v[80:95], a[132:135], v[160:163], v[80:95]
    ds_read_b128 v[176:179], v197 offset:64
    s_add_u32 s97, s97, 4096
    buffer_load_dwordx4 v[52:55], v58, s[16:19], s97 offen offset:0 sc1
    v_mul_f32 v127, v19, v153
    v_mul_f32_e64 v128, v20, v153
    s_waitcnt lgkmcnt(2)
    v_mfma_f32_16x16x32_bf16 v[112:115], a[136:139], v[164:167], v[112:115]
    ds_read_b128 v[180:183], v198 offset:128
    v_mfma_f32_32x32x16_bf16 v[80:95], a[136:139], v[168:171], v[80:95]
    ds_read_b128 v[184:187], v196 offset:128
    v_mul_f32 v129, v21, v153
    v_mul_f32 v130, v22, v153
    v_mul_f32 v131, v23, v153
    s_waitcnt lgkmcnt(2)
    v_mfma_f32_16x16x32_bf16 v[112:115], a[140:143], v[172:175], v[112:115]
    ds_read_b128 v[188:191], v198 offset:160
    v_mfma_f32_32x32x16_bf16 v[80:95], a[140:143], v[176:179], v[80:95]
    ds_read_b128 v[192:195], v197 offset:128
    s_mov_b32 s96, 4194304
    buffer_load_dwordx4 v[216:219], v56, s[16:19], s96 offen offset:0 sc1
    v_mul_f32 v132, v8, v155
    v_mul_f32_e64 v133, v9, v155
    s_waitcnt lgkmcnt(2)
    v_mfma_f32_16x16x32_bf16 v[112:115], a[144:147], v[180:183], v[112:115]
    ds_read_b128 v[160:163], v198 offset:192
    v_mfma_f32_32x32x16_bf16 v[80:95], a[144:147], v[184:187], v[80:95]
    ds_read_b128 v[164:167], v196 offset:192
    v_mul_f32 v134, v10, v155
    v_mul_f32 v135, v11, v155
    v_mul_f32 v136, v12, v155
    s_waitcnt lgkmcnt(2)
    v_mfma_f32_16x16x32_bf16 v[112:115], a[148:151], v[188:191], v[112:115]
    ds_read_b128 v[168:171], v198 offset:224
    v_mfma_f32_32x32x16_bf16 v[80:95], a[148:151], v[192:195], v[80:95]
    ds_read_b128 v[172:175], v197 offset:192
    buffer_load_dwordx4 v[220:223], v56, s[16:19], s96 offen offset:256 sc1
    v_mul_f32 v137, v13, v155
    v_mul_f32_e64 v138, v14, v155
    s_waitcnt lgkmcnt(2)
    v_mfma_f32_16x16x32_bf16 v[112:115], a[152:155], v[160:163], v[112:115]
    ds_read_b128 v[176:179], v196 offset:8704
    v_mfma_f32_32x32x16_bf16 v[80:95], a[152:155], v[164:167], v[80:95]
    ds_read_b128 v[180:183], v197 offset:8704
    v_mul_f32 v139, v15, v155
    v_mul_f32 v140, v16, v155
    v_mul_f32 v141, v17, v155
    s_waitcnt lgkmcnt(2)
    v_mfma_f32_16x16x32_bf16 v[112:115], a[156:159], v[168:171], v[112:115]
    ds_read_b128 v[184:187], v196 offset:8768
    v_mfma_f32_32x32x16_bf16 v[80:95], a[156:159], v[172:175], v[80:95]
    ds_read_b128 v[188:191], v197 offset:8768
    s_mov_b32 s96, 4227072
    buffer_load_dwordx4 v[224:227], v56, s[16:19], s96 offen offset:0 sc1
    v_mul_f32 v142, v18, v155
    v_mul_f32 v143, v19, v155
    v_mul_f32 v144, v20, v155
    v_mul_f32 v145, v21, v155
    v_mul_f32 v146, v22, v155
    v_mul_f32_e64 v147, v23, v155
    s_waitcnt lgkmcnt(2)
    v_mfma_f32_32x32x16_bf16 v[96:111], a[128:131], v[176:179], v[96:111]
    ds_read_b128 v[192:195], v196 offset:8832
    v_mfma_f32_32x32x16_bf16 v[96:111], a[132:135], v[180:183], v[96:111]
    ds_read_b128 v[160:163], v197 offset:8832
    buffer_load_dwordx4 v[228:231], v56, s[16:19], s96 offen offset:256 sc1
    v_fma_f32 v112, v112, v156, v148
    v_fma_f32 v113, v113, v156, v149
    s_waitcnt lgkmcnt(2)
    v_mfma_f32_32x32x16_bf16 v[96:111], a[136:139], v[184:187], v[96:111]
    ds_read_b128 v[164:167], v196 offset:8896
    v_fma_f32 v114, v114, v156, v150
    v_fma_f32 v115, v115, v156, v151
    v_cvt_pk_bf16_f32 v112, v112, v113
    v_cvt_pk_bf16_f32 v113, v114, v115
    v_mfma_f32_32x32x16_bf16 v[96:111], a[140:143], v[188:191], v[96:111]
    ds_read_b128 v[168:171], v197 offset:8896
    s_mov_b32 s96, 4259840
    buffer_load_dwordx4 v[232:235], v56, s[16:19], s96 offen offset:0 sc1
    v_fma_f32 v80, v80, v152, v116
    v_fma_f32 v81, v81, v152, v117
    s_waitcnt lgkmcnt(2)
    v_mfma_f32_32x32x16_bf16 v[96:111], a[144:147], v[192:195], v[96:111]
    v_fma_f32 v82, v82, v152, v118
    v_fma_f32 v83, v83, v152, v119
    v_cvt_pk_bf16_f32 v80, v80, v81
    v_cvt_pk_bf16_f32 v81, v82, v83
    ds_write_b64 v40, v[112:113] offset:0
    v_mfma_f32_32x32x16_bf16 v[96:111], a[148:151], v[160:163], v[96:111]
    ds_write_b64 v38, v[80:81] offset:0
    v_fma_f32 v84, v84, v152, v120
    v_fma_f32 v85, v85, v152, v121
    v_fma_f32 v86, v86, v152, v122
    s_waitcnt lgkmcnt(2)
    v_mfma_f32_32x32x16_bf16 v[96:111], a[152:155], v[164:167], v[96:111]
    v_fma_f32 v87, v87, v152, v123
    v_cvt_pk_bf16_f32 v84, v84, v85
    v_cvt_pk_bf16_f32 v85, v86, v87
    v_fma_f32 v88, v88, v152, v124
    v_fma_f32 v89, v89, v152, v125
    v_mfma_f32_32x32x16_bf16 v[96:111], a[156:159], v[168:171], v[96:111]
    buffer_load_dwordx4 v[236:239], v56, s[16:19], s96 offen offset:256 sc1
    v_fma_f32 v90, v90, v152, v126
    v_fma_f32 v91, v91, v152, v127
    v_cvt_pk_bf16_f32 v88, v88, v89
    v_cvt_pk_bf16_f32 v89, v90, v91
    ds_write_b64 v38, v[84:85] offset:6400
    ds_write_b64 v38, v[88:89] offset:12800
    v_fma_f32 v92, v92, v152, v128
    v_fma_f32 v93, v93, v152, v129
    v_fma_f32 v94, v94, v152, v130
    v_fma_f32 v95, v95, v152, v131
    v_cvt_pk_bf16_f32 v92, v92, v93
    v_cvt_pk_bf16_f32 v93, v94, v95
    ds_write_b64 v39, v[92:93] offset:0
    v_pk_fma_f32 v[96:97], v[96:97], v[154:155], v[132:133] op_sel_hi:[1,0,1]
    v_pk_fma_f32 v[98:99], v[98:99], v[154:155], v[134:135] op_sel_hi:[1,0,1]
    v_cvt_pk_bf16_f32 v96, v96, v97
    v_cvt_pk_bf16_f32 v97, v98, v99
    v_pk_fma_f32 v[100:101], v[100:101], v[154:155], v[136:137] op_sel_hi:[1,0,1]
    v_pk_fma_f32 v[102:103], v[102:103], v[154:155], v[138:139] op_sel_hi:[1,0,1]
    v_cvt_pk_bf16_f32 v100, v100, v101
    v_cvt_pk_bf16_f32 v101, v102, v103
    ds_write_b64 v38, v[96:97] offset:1600
    ds_write_b64 v38, v[100:101] offset:8000
    v_pk_fma_f32 v[104:105], v[104:105], v[154:155], v[140:141] op_sel_hi:[1,0,1]
    v_pk_fma_f32 v[106:107], v[106:107], v[154:155], v[142:143] op_sel_hi:[1,0,1]
    v_cvt_pk_bf16_f32 v104, v104, v105
    v_cvt_pk_bf16_f32 v105, v106, v107
    v_pk_fma_f32 v[108:109], v[108:109], v[154:155], v[144:145] op_sel_hi:[1,0,1]
    v_pk_fma_f32 v[110:111], v[110:111], v[154:155], v[146:147] op_sel_hi:[1,0,1]
    v_cvt_pk_bf16_f32 v108, v108, v109
    v_cvt_pk_bf16_f32 v109, v110, v111
    ds_write_b64 v38, v[104:105] offset:14400
    ds_write_b64 v39, v[108:109] offset:1600
    s_waitcnt lgkmcnt(0)
    s_barrier
    v_mov_b32 v94, 0
    v_mov_b32 v95, 0
    v_mov_b32 v98, 0
    v_mov_b32_e64 v99, 0
    s_mov_b64 exec, 0xffff
    ds_read_b64 v[94:95], v42 offset:320
    ds_read_b64 v[98:99], v42 offset:640
    s_mov_b64 exec, -1
    s_nop 0
    ds_read_b64 v[92:93], v41 offset:320
    ds_read_b64 v[96:97], v41 offset:640
    ds_read_b64 v[84:85], v41 offset:6720
    ds_read_b64 v[86:87], v42 offset:6720
    ds_read_b64 v[80:81], v41 offset:6400
    ds_read_b64 v[82:83], v42 offset:6400
    ds_read_b64 v[88:89], v41 offset:7040
    ds_read_b64 v[90:91], v42 offset:7040
    ds_read_b64_tr_b16 v[106:107], v44 offset:0
    ds_read_b64_tr_b16 v[100:101], v43 offset:0
    ds_read_b64_tr_b16 v[108:109], v44 offset:320
    ds_read_b64_tr_b16 v[102:103], v43 offset:320
    s_mov_b32 s96, 4292608
    buffer_load_dwordx4 v[240:243], v56, s[16:19], s96 offen offset:0 sc1
    ds_read_b64_tr_b16 v[110:111], v44 offset:640
    ds_read_b64_tr_b16 v[104:105], v43 offset:640
    s_mov_b32 s82, 0x3ea52b5c
    s_lshl_b32 s25, s98, 4
    s_add_u32 s25, s25, 4194304
    s_lshl_b32 s26, s98, 3
    s_add_u32 s26, s26, 4194304
    s_waitcnt lgkmcnt(10)
    v_mfma_f32_16x16x32_bf16 v[116:119], v[84:87], v[92:95], v[28:31]
    buffer_load_dwordx4 v[244:247], v56, s[16:19], s96 offen offset:256 sc1
    v_mfma_f32_16x16x32_bf16 v[120:123], v[84:87], v[96:99], v[32:35]
    s_waitcnt lgkmcnt(8)
    v_mfma_f32_16x16x32_bf16 v[112:115], v[80:83], v[92:95], v[32:35]
    s_waitcnt lgkmcnt(6)
    v_mfma_f32_16x16x32_bf16 v[124:127], v[88:91], v[96:99], v[28:31]
    s_nop 5
    v_max_f32 v112, v112, v116
    v_max_f32 v113, v113, v117
    v_max_f32 v114, v114, v118
    v_max_f32 v115, v115, v119
    v_max3_f32 v156, v112, v113, v114
    s_mov_b32 s96, 4194304
    buffer_load_dwordx2 v[248:249], v57, s[16:19], s96 offen offset:0 sc1
    v_max_f32 v156, v156, v115
    v_max_f32 v120, v120, v124
    v_max_f32 v121, v121, v125
    v_max_f32 v122, v122, v126
    v_max_f32 v123, v123, v127
    v_max3_f32 v157, v120, v121, v122
    v_max_f32 v157, v157, v123
    s_nop 1
    v_permlane16_swap_b32 v156, v157
    buffer_load_dwordx2 v[252:253], v57, s[16:19], s96 offen offset:128 sc1
    v_max_f32 v156, v156, v157
    v_mov_b32 v157, v156
    s_nop 1
    v_permlane32_swap_b32 v156, v157
    v_max_f32 v156, v156, v157
    v_mul_f32 v156, s82, v156
    v_mov_b32 v157, v156
    s_nop 1
    v_permlane16_swap_b32_e64 v156, v157
    v_fma_f32 v112, v112, s82, -v156
    s_mov_b32 s96, 4210688
    buffer_load_dwordx2 v[250:251], v57, s[16:19], s96 offen offset:0 sc1
    v_fma_f32 v113, v113, s82, -v156
    v_fma_f32 v114, v114, s82, -v156
    v_fma_f32 v115, v115, s82, -v156
    v_exp_f32 v112, v112
    v_exp_f32 v113, v113
    v_exp_f32 v114, v114
    v_exp_f32 v115, v115
    v_cvt_pk_bf16_f32 v116, v112, v113
    buffer_load_dwordx2 v[254:255], v57, s[16:19], s96 offen offset:128 sc1
    v_cvt_pk_bf16_f32 v117, v114, v115
    v_bfi_b32 v128, v36, 0, v116
    v_and_b32 v130, v36, v116
    v_bfi_b32 v129, v37, 0, v117
    v_and_b32 v131, v37, v117
    s_waitcnt lgkmcnt(3)
    s_nop 0
    v_mfma_f32_16x16x32_bf16 v[144:147], v[106:109], v[128:131], 0
    s_waitcnt lgkmcnt(2)
    v_mfma_f32_16x16x32_bf16 v[136:139], v[100:103], v[128:131], 0
    v_fma_f32 v120, v120, s82, -v157
    s_mov_b32 s96, 0
    s_mov_b32 s97, 5120
    buffer_load_dwordx2 v[208:209], v60, s[4:7], s96 offen
    v_fma_f32 v121, v121, s82, -v157
    v_fma_f32 v122, v122, s82, -v157
    v_fma_f32 v123, v123, s82, -v157
    v_exp_f32 v120, v120
    v_exp_f32 v121, v121
    v_exp_f32 v122, v122
    v_exp_f32 v123, v123
    v_cvt_pk_bf16_f32 v124, v120, v121
    buffer_load_dwordx2 v[210:211], v60, s[4:7], s97 offen
    v_cvt_pk_bf16_f32 v125, v122, v123
    v_bfi_b32 v132, v36, 0, v124
    v_and_b32 v134, v36, v124
    v_bfi_b32 v133, v37, 0, v125
    v_and_b32 v135, v37, v125
    s_waitcnt lgkmcnt(1)
    s_nop 0
    v_mfma_f32_16x16x32_bf16 v[148:151], v[108:111], v[132:135], 0
    s_waitcnt lgkmcnt(0)
    v_mfma_f32_16x16x32_bf16 v[140:143], v[102:105], v[132:135], 0
    v_mov_b32 v158, v144
    v_lshrrev_b32_e64 v212, 5, v1
    v_mul_u32_u24 v212, 5104, v212
    v_bfe_u32 v213, v1, 4, 1
    v_lshlrev_b32 v213, 2, v213
    v_sub_u32 v212, v212, v213
    v_add_u32 v212, v212, v60
    s_mul_i32 s97, s24, 24
    s_sub_u32 s97, 128, s97
    buffer_load_dword v212, v212, s[4:7], s97 offen
    v_permlane16_swap_b32 v144, v158
    v_rcp_f32_e64 v158, v158
    s_nop 0
    v_pk_mul_f32 v[136:137], v[136:137], v[158:159] op_sel_hi:[1,0]
    v_pk_mul_f32 v[138:139], v[138:139], v[158:159] op_sel_hi:[1,0]
    v_pk_mul_f32 v[144:145], v[144:145], v[158:159] op_sel_hi:[1,0]
    v_pk_mul_f32 v[146:147], v[146:147], v[158:159] op_sel_hi:[1,0]
    v_cvt_pk_bf16_f32 v112, v136, v137
    v_cvt_pk_bf16_f32 v116, v144, v145
    v_cvt_pk_bf16_f32 v113, v138, v139
    v_cvt_pk_bf16_f32 v117, v146, v147
    v_mov_b32 v160, v148
    s_nop 1
    v_permlane16_swap_b32 v148, v160
    v_rcp_f32_e64 v160, v160
    s_nop 0
    v_pk_mul_f32 v[140:141], v[140:141], v[160:161] op_sel_hi:[1,0]
    v_pk_mul_f32 v[142:143], v[142:143], v[160:161] op_sel_hi:[1,0]
    v_pk_mul_f32 v[148:149], v[148:149], v[160:161] op_sel_hi:[1,0]
    v_pk_mul_f32 v[150:151], v[150:151], v[160:161] op_sel_hi:[1,0]
    v_cvt_pk_bf16_f32 v114, v140, v141
    v_cvt_pk_bf16_f32 v118, v148, v149
    v_cvt_pk_bf16_f32 v115, v142, v143
    v_cvt_pk_bf16_f32 v119, v150, v151
    v_permlane16_swap_b32 v112, v114
    v_permlane16_swap_b32 v113, v115
    v_permlane16_swap_b32 v116, v118
    v_permlane16_swap_b32 v117, v119
    buffer_store_dwordx4 v[112:115], v45, s[16:19], s25 offen sc1
    s_mov_b64 exec, s[80:81]
    buffer_store_dwordx2 v[116:117], v46, s[16:19], s26 offen sc1
    s_mov_b64 exec, -1
oe_20:
    s_waitcnt vmcnt(16)
    v_mfma_f32_16x16x32_bf16 v[112:115], a[176:179], v[216:219], 0
    v_mov_b32 v136, 0
    v_mov_b32 v137, 0
    s_waitcnt vmcnt(15)
    v_mfma_f32_16x16x32_bf16 v[116:119], a[176:179], v[220:223], 0
    v_mov_b32 v138, 0
    v_mov_b32 v139, 0
    s_waitcnt vmcnt(14)
    v_mfma_f32_16x16x32_bf16 v[112:115], a[196:199], v[224:227], v[112:115]
    v_mov_b32 v140, 0
    v_mov_b32 v141, 0
    s_waitcnt vmcnt(13)
    v_mfma_f32_16x16x32_bf16 v[116:119], a[196:199], v[228:231], v[116:119]
    s_mov_b32 s25, 6815744
    s_add_u32 s26, s36, 6815744
    s_waitcnt vmcnt(12)
    v_mfma_f32_16x16x32_bf16 v[112:115], a[216:219], v[232:235], v[112:115]
    s_add_u32 s27, s35, 3473408
    s_mov_b32 s28, 0x99999999
    s_waitcnt vmcnt(11)
    v_mfma_f32_16x16x32_bf16 v[116:119], a[216:219], v[236:239], v[116:119]
    s_mov_b32 s29, 0x99999999
    s_waitcnt vmcnt(10)
    v_mfma_f32_16x16x32_bf16 v[112:115], a[236:239], v[240:243], v[112:115]
    s_waitcnt vmcnt(9)
    v_mfma_f32_16x16x32_bf16 v[116:119], a[236:239], v[244:247], v[116:119]
    s_waitcnt vmcnt(6)
    v_mfma_f32_16x16x32_bf16 v[112:115], v[52:55], v[248:251], v[112:115]
    s_waitcnt vmcnt(5)
    v_mfma_f32_16x16x32_bf16 v[116:119], v[52:55], v[252:255], v[116:119]
    v_mfma_f32_16x16x32_bf16 v[88:91], a[164:167], v[216:219], 0
    v_mfma_f32_16x16x32_bf16 v[92:95], a[164:167], v[220:223], 0
    v_mfma_f32_16x16x32_bf16 v[88:91], a[184:187], v[224:227], v[88:91]
    v_mfma_f32_16x16x32_bf16 v[92:95], a[184:187], v[228:231], v[92:95]
    v_mfma_f32_16x16x32_bf16 v[88:91], a[204:207], v[232:235], v[88:91]
    v_mfma_f32_16x16x32_bf16 v[92:95], a[204:207], v[236:239], v[92:95]
    s_nop 1
    v_cmp_u_f32 vcc, v112, v116
    s_nop 0
    s_cbranch_vccnz rd_21
rc_22:
    v_mfma_f32_16x16x32_bf16 v[88:91], a[224:227], v[240:243], v[88:91]
    ds_write_b128 v203, v[112:115] offset:24576
    v_mfma_f32_16x16x32_bf16 v[92:95], a[224:227], v[244:247], v[92:95]
    v_mfma_f32_16x16x32_bf16 v[88:91], a[244:247], v[248:251], v[88:91]
    ds_write_b128 v203, v[116:119] offset:25600
    v_mfma_f32_16x16x32_bf16 v[92:95], a[244:247], v[252:255], v[92:95]
    v_mfma_f32_16x16x32_bf16 v[96:99], a[168:171], v[216:219], 0
    s_waitcnt vmcnt(4)
    v_lshlrev_b32 v120, 16, v208
    v_and_b32 v121, 0xffff0000, v208
    v_mfma_f32_16x16x32_bf16 v[100:103], a[168:171], v[220:223], 0
    v_lshlrev_b32_e64 v122, 16, v209
    v_and_b32 v123, 0xffff0000, v209
    v_mfma_f32_16x16x32_bf16 v[96:99], a[188:191], v[224:227], v[96:99]
    s_waitcnt vmcnt(3)
    v_lshlrev_b32 v124, 16, v210
    v_and_b32 v125, 0xffff0000, v210
    v_mfma_f32_16x16x32_bf16 v[100:103], a[188:191], v[228:231], v[100:103]
    v_lshlrev_b32_e64 v126, 16, v211
    v_and_b32 v127, 0xffff0000, v211
    v_mfma_f32_16x16x32_bf16 v[96:99], a[208:211], v[232:235], v[96:99]
    s_waitcnt vmcnt(2)
    v_lshlrev_b32 v128, 16, v212
    v_and_b32 v129, 0xffff0000, v212
    v_mfma_f32_16x16x32_bf16 v[100:103], a[208:211], v[236:239], v[100:103]
    v_mfma_f32_16x16x32_bf16 v[96:99], a[228:231], v[240:243], v[96:99]
    ds_write_b128 v200, v[88:91] offset:0
    v_mfma_f32_16x16x32_bf16 v[100:103], a[228:231], v[244:247], v[100:103]
    v_mfma_f32_16x16x32_bf16 v[96:99], a[248:251], v[248:251], v[96:99]
    ds_write_b128 v200, v[92:95] offset:1024
    v_mfma_f32_16x16x32_bf16 v[100:103], a[248:251], v[252:255], v[100:103]
    v_mfma_f32_16x16x32_bf16 v[104:107], a[172:175], v[216:219], 0
    v_mfma_f32_16x16x32_bf16 v[108:111], a[172:175], v[220:223], 0
    v_mfma_f32_16x16x32_bf16 v[104:107], a[192:195], v[224:227], v[104:107]
    v_mfma_f32_16x16x32_bf16 v[108:111], a[192:195], v[228:231], v[108:111]
    v_mfma_f32_16x16x32_bf16 v[104:107], a[212:215], v[232:235], v[104:107]
    v_mfma_f32_16x16x32_bf16 v[108:111], a[212:215], v[236:239], v[108:111]
    v_mfma_f32_16x16x32_bf16 v[104:107], a[232:235], v[240:243], v[104:107]
    ds_write_b128 v201, v[96:99] offset:2048
    v_mfma_f32_16x16x32_bf16 v[108:111], a[232:235], v[244:247], v[108:111]
    v_mfma_f32_16x16x32_bf16 v[104:107], a[252:255], v[248:251], v[104:107]
    ds_write_b128 v201, v[100:103] offset:3072
    v_mfma_f32_16x16x32_bf16 v[108:111], a[252:255], v[252:255], v[108:111]
    v_mfma_f32_16x16x32_bf16 v[80:83], a[160:163], v[216:219], v[120:123]
    v_mfma_f32_16x16x32_bf16 v[84:87], a[160:163], v[220:223], v[124:127]
    v_mfma_f32_16x16x32_bf16 v[80:83], a[180:183], v[224:227], v[80:83]
    v_mfma_f32_16x16x32_bf16 v[84:87], a[180:183], v[228:231], v[84:87]
    v_mfma_f32_16x16x32_bf16 v[80:83], a[200:203], v[232:235], v[80:83]
    s_nop 0
    ds_write_b128 v202, v[104:107] offset:4096
    v_mfma_f32_16x16x32_bf16 v[84:87], a[200:203], v[236:239], v[84:87]
    ds_write_b128 v202, v[108:111] offset:5120
    v_mfma_f32_16x16x32_bf16 v[80:83], a[220:223], v[240:243], v[80:83]
    v_mfma_f32_16x16x32_bf16 v[84:87], a[220:223], v[244:247], v[84:87]
    v_mfma_f32_16x16x32_bf16 v[80:83], a[240:243], v[248:251], v[80:83]
    v_mfma_f32_16x16x32_bf16 v[84:87], a[240:243], v[252:255], v[84:87]
    s_waitcnt lgkmcnt(0)
    s_barrier
    s_nop 0
    ds_read_b128 v[88:91], v204 offset:0
    ds_read_b128 v[92:95], v204 offset:1024
    ds_read_b128 v[96:99], v204 offset:2048
    ds_read_b128 v[100:103], v204 offset:3072
    ds_read_b128 v[104:107], v204 offset:4096
    ds_read_b128 v[108:111], v204 offset:5120
    ds_read_b64 v[112:113], v205 offset:24576
    ds_read_b64 v[114:115], v205 offset:26624
    ds_read_b64 v[116:117], v205 offset:28672
    ds_read_b64 v[118:119], v205 offset:30720
    s_mov_b32 s96, 4198400
    buffer_load_dwordx4 v[216:219], v56, s[16:19], s96 offen offset:0 sc1
    buffer_load_dwordx4 v[220:223], v56, s[16:19], s96 offen offset:256 sc1
    s_mov_b32 s96, 4231168
    buffer_load_dwordx4 v[224:227], v56, s[16:19], s96 offen offset:0 sc1
    buffer_load_dwordx4 v[228:231], v56, s[16:19], s96 offen offset:256 sc1
    s_mov_b32 s96, 4263936
    buffer_load_dwordx4 v[232:235], v56, s[16:19], s96 offen offset:0 sc1
    buffer_load_dwordx4 v[236:239], v56, s[16:19], s96 offen offset:256 sc1
    s_waitcnt lgkmcnt(9)
    v_pk_add_f32 v[80:81], v[80:81], v[88:89]
    v_pk_add_f32 v[82:83], v[82:83], v[90:91]
    s_waitcnt lgkmcnt(8)
    v_pk_add_f32 v[84:85], v[84:85], v[92:93]
    v_pk_add_f32 v[86:87], v[86:87], v[94:95]
    s_waitcnt lgkmcnt(7)
    v_pk_add_f32 v[80:81], v[80:81], v[96:97]
    v_pk_add_f32 v[82:83], v[82:83], v[98:99]
    s_waitcnt lgkmcnt(6)
    v_pk_add_f32 v[84:85], v[84:85], v[100:101]
    v_pk_add_f32 v[86:87], v[86:87], v[102:103]
    s_waitcnt lgkmcnt(5)
    v_pk_add_f32 v[80:81], v[80:81], v[104:105]
    v_pk_add_f32 v[82:83], v[82:83], v[106:107]
    s_waitcnt lgkmcnt(4)
    v_pk_add_f32 v[84:85], v[84:85], v[108:109]
    v_pk_add_f32 v[86:87], v[86:87], v[110:111]
    v_cvt_pk_bf16_f32 v132, v80, v81
    v_cvt_pk_bf16_f32 v133, v82, v83
    v_cvt_pk_bf16_f32 v134, v84, v85
    v_cvt_pk_bf16_f32 v135, v86, v87
    s_waitcnt lgkmcnt(3)
    v_pk_add_f32 v[128:129], v[128:129], v[112:113]
    s_waitcnt lgkmcnt(2)
    v_pk_add_f32 v[128:129], v[128:129], v[114:115]
    s_waitcnt lgkmcnt(1)
    v_pk_add_f32 v[128:129], v[128:129], v[116:117]
    s_waitcnt lgkmcnt(0)
    v_pk_add_f32 v[128:129], v[128:129], v[118:119]
    v_cvt_pk_bf16_f32 v130, v128, v129
    buffer_store_dwordx4 v[132:135], v59, s[16:19], s25 offen sc1
    buffer_store_dword v130, v61, s[16:19], s26 offen sc1
    v_dot2c_f32_bf16 v136, v132, v215
    v_dot2c_f32_bf16 v137, v132, v132
    v_dot2c_f32_bf16 v136, v133, v215
    v_dot2c_f32_bf16 v137, v133, v133
    v_dot2c_f32_bf16 v138, v134, v215
    v_dot2c_f32_bf16 v139, v134, v134
    v_dot2c_f32_bf16 v138, v135, v215
    v_dot2c_f32_bf16 v139, v135, v135
    v_dot2c_f32_bf16 v140, v130, v215
    v_dot2c_f32_bf16 v141, v130, v130
    v_permlane32_swap_b32 v136, v138
    v_permlane32_swap_b32 v137, v139
    v_pk_add_f32 v[136:137], v[136:137], v[138:139]
    v_pk_add_f32 v[136:137], v[136:137], v[140:141]
    s_nop 1
    v_permlane16_swap_b32 v136, v137
    v_add_f32_e64 v136, v136, v137
    ds_write_b32 v206, v136 offset:32768
    s_mov_b32 s96, 4296704
    buffer_load_dwordx4 v[240:243], v56, s[16:19], s96 offen offset:0 sc1
    buffer_load_dwordx4 v[244:247], v56, s[16:19], s96 offen offset:256 sc1
    s_mov_b32 s96, 4196352
    buffer_load_dwordx2 v[248:249], v57, s[16:19], s96 offen offset:0 sc1
    buffer_load_dwordx2 v[252:253], v57, s[16:19], s96 offen offset:128 sc1
    s_mov_b32 s96, 4212736
    buffer_load_dwordx2 v[250:251], v57, s[16:19], s96 offen offset:0 sc1
    buffer_load_dwordx2 v[254:255], v57, s[16:19], s96 offen offset:128 sc1
    s_mov_b32 s96, 1310720
    s_mov_b32 s97, 1315840
    buffer_load_dwordx2 v[208:209], v60, s[4:7], s96 offen
    buffer_load_dwordx2 v[210:211], v60, s[4:7], s97 offen
    v_lshrrev_b32_e64 v212, 5, v1
    v_mul_u32_u24 v212, 5104, v212
    v_bfe_u32 v213, v1, 4, 1
    v_lshlrev_b32 v213, 2, v213
    v_sub_u32 v212, v212, v213
    v_add_u32 v212, v212, v60
    s_mul_i32 s97, s24, 24
    s_sub_u32 s97, 1310848, s97
    buffer_load_dword v212, v212, s[4:7], s97 offen
    s_waitcnt lgkmcnt(0)
    s_barrier
    ds_read2st64_b32 v[136:137], v207 offset0:0 offset1:1
    ds_read2st64_b32 v[138:139], v207 offset0:2 offset1:3
    ds_read_b64_tr_b16 v[144:145], v65 offset:32
    ds_read_b64_tr_b16 v[146:147], v65 offset:0
    ds_read_b64_tr_b16 v[148:149], v65 offset:160
    ds_read_b64_tr_b16 v[150:151], v65 offset:128
    ds_read_b64_tr_b16 v[152:153], v65 offset:288
    ds_read_b64_tr_b16 v[154:155], v65 offset:256
    ds_read_b64_tr_b16 v[156:157], v65 offset:416
    ds_read_b64_tr_b16 v[158:159], v65 offset:384
    ds_read_b64_tr_b16 v[160:161], v65 offset:544
    ds_read_b64_tr_b16 v[162:163], v65 offset:512
    ds_read_b64_tr_b16 v[164:165], v65 offset:672
    ds_read_b64_tr_b16 v[166:167], v65 offset:640
    ds_read_b64_tr_b16 v[168:169], v65 offset:800
    ds_read_b64_tr_b16 v[170:171], v65 offset:768
    ds_read_b64_tr_b16 v[172:173], v65 offset:928
    ds_read_b64_tr_b16 v[174:175], v65 offset:896
    s_waitcnt lgkmcnt(15)
    v_pk_add_f32 v[136:137], v[136:137], v[138:139]
    v_add_f32 v136, v136, v137
    v_cndmask_b32 v136, v136, 1.0, s[28:29]
    s_mov_b64 exec, s[80:81]
    buffer_atomic_add_f32 v136, v214, s[16:19], s27 offen
    s_mov_b64 exec, -1
    v_lshrrev_b32 v176, 4, v0
    v_mul_u32_u24 v176, 1216, v176
    v_and_b32 v177, 15, v0
    v_lshl_add_u32 v176, v177, 3, v176
    v_add_u32 v176, 64, v176
    v_mov_b32 v178, 0
    v_mov_b32 v179, 0
    ds_write_b64 v176, v[178:179]
    v_mov_b32 v70, 0
    v_mov_b32 v71, 0
    v_mov_b32 v72, 0
    s_lshl_b32 s25, s24, 17
    v_lshrrev_b32 v176, 5, v1
    v_lshl_add_u32 v176, v176, 14, s25
    v_bfe_u32 v177, v1, 4, 1
    v_lshl_add_u32 v176, v177, 13, v176
    v_and_b32_e64 v177, 15, v1
    v_lshl_add_u32 v73, v177, 4, v176
    v_bfe_u32 v176, v1, 2, 3
    v_lshl_add_u32 v176, v176, 14, s25
    v_bfe_u32 v177, v1, 1, 1
    v_lshl_add_u32 v176, v177, 13, v176
    v_and_b32 v177, 1, v1
    v_lshl_add_u32 v77, v177, 4, v176
    v_lshrrev_b32 v177, 5, v1
    v_and_b32 v176, 31, v1
    v_lshlrev_b32 v176, 3, v176
    v_lshl_add_u32 v78, v177, 10, v176
    v_and_b32 v176, 7, v1
    v_lshlrev_b32 v176, 3, v176
    v_lshl_add_u32 v178, v177, 7, v176
    v_add_u32 v74, 31744, v73
    v_add_u32 v75, 63488, v73
    v_add_u32 v76, 95232, v73
    v_add_u32 v178, 53760, v178
    v_and_b32 v176, 31, v1
    v_cmp_eq_u32 vcc, 0, v176
    v_cmp_eq_u32 s[82:83], 24, v176
    s_nop 0
    s_or_b64 vcc, vcc, s[82:83]
    v_mov_b32 v176, 155648
    v_mov_b32 v177, 157696
    v_cndmask_b32 v176, v176, v177, vcc
    v_cndmask_b32 v79, v176, v178, s[78:79]
oe_23:
    s_waitcnt vmcnt(17)
    v_mfma_f32_16x16x32_bf16 v[112:115], a[176:179], v[216:219], 0
    v_mov_b32 v136, 0
    v_mov_b32 v137, 0
    s_waitcnt vmcnt(16)
    v_mfma_f32_16x16x32_bf16 v[116:119], a[176:179], v[220:223], 0
    v_mov_b32 v138, 0
    v_mov_b32 v139, 0
    s_waitcnt vmcnt(15)
    v_mfma_f32_16x16x32_bf16 v[112:115], a[196:199], v[224:227], v[112:115]
    v_mov_b32 v140, 0
    v_mov_b32_e64 v141, 0
    s_waitcnt vmcnt(14)
    v_mfma_f32_16x16x32_bf16 v[116:119], a[196:199], v[228:231], v[116:119]
    s_mov_b32 s25, 6817792
    s_add_u32 s26, s36, 6817792
    s_waitcnt vmcnt(13)
    v_mfma_f32_16x16x32_bf16 v[112:115], a[216:219], v[232:235], v[112:115]
    s_add_u32 s27, s35, 3477504
    s_mov_b32 s28, 0x99999999
    s_waitcnt vmcnt(12)
    v_mfma_f32_16x16x32_bf16 v[116:119], a[216:219], v[236:239], v[116:119]
    s_mov_b32 s29, 0x99999999
    s_waitcnt vmcnt(9)
    v_mfma_f32_16x16x32_bf16 v[112:115], a[236:239], v[240:243], v[112:115]
    s_waitcnt vmcnt(8)
    v_mfma_f32_16x16x32_bf16 v[116:119], a[236:239], v[244:247], v[116:119]
    s_waitcnt vmcnt(5)
    v_mfma_f32_16x16x32_bf16 v[112:115], v[52:55], v[248:251], v[112:115]
    s_waitcnt vmcnt(4)
    v_mfma_f32_16x16x32_bf16 v[116:119], v[52:55], v[252:255], v[116:119]
    v_mfma_f32_16x16x32_bf16 v[88:91], a[164:167], v[216:219], 0
    v_mfma_f32_16x16x32_bf16 v[92:95], a[164:167], v[220:223], 0
    v_mfma_f32_16x16x32_bf16 v[88:91], a[184:187], v[224:227], v[88:91]
    v_mfma_f32_16x16x32_bf16 v[92:95], a[184:187], v[228:231], v[92:95]
    v_mfma_f32_16x16x32_bf16 v[88:91], a[204:207], v[232:235], v[88:91]
    v_mfma_f32_16x16x32_bf16 v[92:95], a[204:207], v[236:239], v[92:95]
    s_nop 1
    v_cmp_u_f32 vcc, v112, v116
    s_nop 0
    s_cbranch_vccnz rd_24
rc_25:
    v_mfma_f32_16x16x32_bf16 v[88:91], a[224:227], v[240:243], v[88:91]
    ds_write_b128 v203, v[112:115] offset:24576
    v_mfma_f32_16x16x32_bf16 v[92:95], a[224:227], v[244:247], v[92:95]
    v_mfma_f32_16x16x32_bf16 v[88:91], a[244:247], v[248:251], v[88:91]
    ds_write_b128 v203, v[116:119] offset:25600
    v_mfma_f32_16x16x32_bf16 v[92:95], a[244:247], v[252:255], v[92:95]
    v_mfma_f32_16x16x32_bf16 v[96:99], a[168:171], v[216:219], 0
    s_waitcnt vmcnt(3)
    v_lshlrev_b32 v120, 16, v208
    v_and_b32 v121, 0xffff0000, v208
    v_mfma_f32_16x16x32_bf16 v[100:103], a[168:171], v[220:223], 0
    v_lshlrev_b32_e64 v122, 16, v209
    v_and_b32 v123, 0xffff0000, v209
    v_mfma_f32_16x16x32_bf16 v[96:99], a[188:191], v[224:227], v[96:99]
    s_waitcnt vmcnt(2)
    v_lshlrev_b32 v124, 16, v210
    v_and_b32 v125, 0xffff0000, v210
    v_mfma_f32_16x16x32_bf16 v[100:103], a[188:191], v[228:231], v[100:103]
    v_lshlrev_b32_e64 v126, 16, v211
    v_and_b32 v127, 0xffff0000, v211
    v_mfma_f32_16x16x32_bf16 v[96:99], a[208:211], v[232:235], v[96:99]
    s_waitcnt vmcnt(1)
    v_lshlrev_b32 v128, 16, v212
    v_and_b32 v129, 0xffff0000, v212
    v_mfma_f32_16x16x32_bf16 v[100:103], a[208:211], v[236:239], v[100:103]
    v_mfma_f32_16x16x32_bf16 v[96:99], a[228:231], v[240:243], v[96:99]
    ds_write_b128 v200, v[88:91] offset:0
    v_mfma_f32_16x16x32_bf16 v[100:103], a[228:231], v[244:247], v[100:103]
    v_mfma_f32_16x16x32_bf16 v[96:99], a[248:251], v[248:251], v[96:99]
    ds_write_b128 v200, v[92:95] offset:1024
    v_mfma_f32_16x16x32_bf16 v[100:103], a[248:251], v[252:255], v[100:103]
    v_mfma_f32_16x16x32_bf16 v[104:107], a[172:175], v[216:219], 0
    v_mfma_f32_16x16x32_bf16 v[108:111], a[172:175], v[220:223], 0
    v_mfma_f32_16x16x32_bf16 v[104:107], a[192:195], v[224:227], v[104:107]
    v_mfma_f32_16x16x32_bf16 v[108:111], a[192:195], v[228:231], v[108:111]
    v_mfma_f32_16x16x32_bf16 v[104:107], a[212:215], v[232:235], v[104:107]
    v_mfma_f32_16x16x32_bf16 v[108:111], a[212:215], v[236:239], v[108:111]
    v_mfma_f32_16x16x32_bf16 v[104:107], a[232:235], v[240:243], v[104:107]
    ds_write_b128 v201, v[96:99] offset:2048
    v_mfma_f32_16x16x32_bf16 v[108:111], a[232:235], v[244:247], v[108:111]
    v_mfma_f32_16x16x32_bf16 v[104:107], a[252:255], v[248:251], v[104:107]
    ds_write_b128 v201, v[100:103] offset:3072
    v_mfma_f32_16x16x32_bf16 v[108:111], a[252:255], v[252:255], v[108:111]
    v_mfma_f32_16x16x32_bf16 v[80:83], a[160:163], v[216:219], v[120:123]
    v_mfma_f32_16x16x32_bf16 v[84:87], a[160:163], v[220:223], v[124:127]
    v_mfma_f32_16x16x32_bf16 v[80:83], a[180:183], v[224:227], v[80:83]
    v_mfma_f32_16x16x32_bf16 v[84:87], a[180:183], v[228:231], v[84:87]
    v_mfma_f32_16x16x32_bf16 v[80:83], a[200:203], v[232:235], v[80:83]
    s_nop 0
    ds_write_b128 v202, v[104:107] offset:4096
    v_mfma_f32_16x16x32_bf16 v[84:87], a[200:203], v[236:239], v[84:87]
    ds_write_b128 v202, v[108:111] offset:5120
    v_mfma_f32_16x16x32_bf16 v[80:83], a[220:223], v[240:243], v[80:83]
    v_mfma_f32_16x16x32_bf16 v[84:87], a[220:223], v[244:247], v[84:87]
    v_mfma_f32_16x16x32_bf16 v[80:83], a[240:243], v[248:251], v[80:83]
    v_mfma_f32_16x16x32_bf16 v[84:87], a[240:243], v[252:255], v[84:87]
    s_waitcnt lgkmcnt(0)
    s_barrier
    s_nop 0
    ds_read_b128 v[88:91], v204 offset:0
    ds_read_b128 v[92:95], v204 offset:1024
    ds_read_b128 v[96:99], v204 offset:2048
    ds_read_b128 v[100:103], v204 offset:3072
    ds_read_b128 v[104:107], v204 offset:4096
    ds_read_b128 v[108:111], v204 offset:5120
    ds_read_b64 v[112:113], v205 offset:24576
    ds_read_b64 v[114:115], v205 offset:26624
    ds_read_b64 v[116:117], v205 offset:28672
    ds_read_b64 v[118:119], v205 offset:30720
    s_lshl_b32 s96, s75, 14
    s_add_u32 s96, s96, 6815744
    s_lshl_b32 s97, s24, 12
    s_add_u32 s97, s97, 3473408
    buffer_load_dwordx4 v[176:179], v62, s[16:19], s96 offen offset:0 sc1
    buffer_load_dwordx4 v[180:183], v62, s[16:19], s96 offen offset:1024 sc1
    buffer_load_dwordx4 v[184:187], v62, s[16:19], s97 offen offset:0 sc1
    buffer_load_dwordx4 v[188:191], v62, s[16:19], s97 offen offset:1024 sc1
    buffer_load_dwordx4 v[192:195], v62, s[16:19], s97 offen offset:2048 sc1
    buffer_load_dwordx4 v[196:199], v62, s[16:19], s97 offen offset:3072 sc1
    s_waitcnt lgkmcnt(9)
    v_pk_add_f32 v[80:81], v[80:81], v[88:89]
    v_pk_add_f32 v[82:83], v[82:83], v[90:91]
    s_waitcnt lgkmcnt(8)
    v_pk_add_f32 v[84:85], v[84:85], v[92:93]
    v_pk_add_f32 v[86:87], v[86:87], v[94:95]
    s_waitcnt lgkmcnt(7)
    v_pk_add_f32 v[80:81], v[80:81], v[96:97]
    v_pk_add_f32 v[82:83], v[82:83], v[98:99]
    s_waitcnt lgkmcnt(6)
    v_pk_add_f32 v[84:85], v[84:85], v[100:101]
    v_pk_add_f32 v[86:87], v[86:87], v[102:103]
    s_waitcnt lgkmcnt(5)
    v_pk_add_f32 v[80:81], v[80:81], v[104:105]
    v_pk_add_f32 v[82:83], v[82:83], v[106:107]
    s_waitcnt lgkmcnt(4)
    v_pk_add_f32 v[84:85], v[84:85], v[108:109]
    v_pk_add_f32 v[86:87], v[86:87], v[110:111]
    v_cvt_pk_bf16_f32 v132, v80, v81
    v_cvt_pk_bf16_f32 v133, v82, v83
    v_cvt_pk_bf16_f32 v134, v84, v85
    v_cvt_pk_bf16_f32 v135, v86, v87
    s_waitcnt lgkmcnt(3)
    v_pk_add_f32 v[128:129], v[128:129], v[112:113]
    s_waitcnt lgkmcnt(2)
    v_pk_add_f32 v[128:129], v[128:129], v[114:115]
    s_waitcnt lgkmcnt(1)
    v_pk_add_f32 v[128:129], v[128:129], v[116:117]
    s_waitcnt lgkmcnt(0)
    v_pk_add_f32 v[128:129], v[128:129], v[118:119]
    v_cvt_pk_bf16_f32 v130, v128, v129
    buffer_store_dwordx4 v[132:135], v59, s[16:19], s25 offen sc1
    buffer_store_dword v130, v61, s[16:19], s26 offen sc1
    v_dot2c_f32_bf16 v136, v132, v215
    v_dot2c_f32_bf16 v137, v132, v132
    v_dot2c_f32_bf16 v136, v133, v215
    v_dot2c_f32_bf16 v137, v133, v133
    v_dot2c_f32_bf16 v138, v134, v215
    v_dot2c_f32_bf16 v139, v134, v134
    v_dot2c_f32_bf16 v138, v135, v215
    v_dot2c_f32_bf16 v139, v135, v135
    v_dot2c_f32_bf16 v140, v130, v215
    v_dot2c_f32_bf16 v141, v130, v130
    v_permlane32_swap_b32 v136, v138
    v_permlane32_swap_b32 v137, v139
    v_pk_add_f32 v[136:137], v[136:137], v[138:139]
    v_pk_add_f32 v[136:137], v[136:137], v[140:141]
    s_nop 1
    v_permlane16_swap_b32 v136, v137
    v_add_f32 v136, v136, v137
    ds_write_b32 v206, v136 offset:32768
    s_waitcnt lgkmcnt(0)
    s_barrier
    ds_read2st64_b32 v[136:137], v207 offset0:0 offset1:1
    ds_read2st64_b32 v[138:139], v207 offset0:2 offset1:3
    s_waitcnt lgkmcnt(0)
    v_pk_add_f32 v[136:137], v[136:137], v[138:139]
    v_add_f32 v136, v136, v137
    v_cndmask_b32 v136, v136, 1.0, s[28:29]
    s_mov_b64 exec, s[80:81]
    buffer_atomic_add_f32 v136, v214, s[16:19], s27 offen
    s_mov_b64 exec, -1
    s_cmp_ge_u32 s2, 160
    s_cbranch_scc1 nc_26
    v_mov_b32 v248, -1
    v_mov_b32 v249, -1
    v_mov_b32 v250, -1
    v_mov_b32_e64 v251, -1
    s_lshl_b32 s88, s75, 14
    s_add_u32 s88, s88, 9437184
    buffer_store_dwordx4 v[248:251], v62, s[16:19], s88 offen offset:0 sc1
    s_waitcnt vmcnt(4)
ce_28:
    v_max3_u32 v208, v176, v177, v178
    v_max3_u32 v208, v208, v179, v180
    v_max3_u32 v208, v208, v181, v182
    v_max_u32 v208, v208, v183
    v_cmp_eq_u32 s[82:83], -1, v208
    v_min3_f32 v209, v184, v187, v188
    v_min3_f32 v209, v209, v191, v192
    v_min3_f32 v209, v209, v195, v196
    v_min_f32 v209, v209, v199
    v_cmp_neq_f32 vcc, 0x41000000, v209
    s_nop 0
    s_or_b64 vcc, vcc, s[82:83]
    s_cbranch_vccnz rd_29
rc_30:
    v_mul_f32 v208, 0x3acccccd, v185
    v_mul_f32 v209, 0x3acccccd, v189
    v_mul_f32 v186, 0x3acccccd, v186
    v_mul_f32 v190, 0x3acccccd, v190
    v_fma_f32 v186, -v208, v208, v186
    v_fma_f32 v190, -v209, v209, v190
    v_max_f32 v186, 0, v186
    v_max_f32 v190, 0, v190
    v_add_f32 v186, 0x3727c5ac, v186
    v_add_f32 v190, 0x3727c5ac, v190
    v_rsq_f32 v185, v186
    v_rsq_f32 v189, v190
    v_mul_f32 v186, -v208, v185
    v_mul_f32 v190, -v209, v189
    v_lshlrev_b32 v80, 16, v176
    v_and_b32 v82, 0xffff0000, v176
    v_lshlrev_b32 v84, 16, v177
    v_and_b32 v86, 0xffff0000, v177
    v_lshlrev_b32 v81, 16, v178
    v_and_b32 v83, 0xffff0000, v178
    v_lshlrev_b32 v85, 16, v179
    v_and_b32 v87, 0xffff0000, v179
    v_fma_f32 v208, v80, v185, v186
    v_fma_f32 v209, v81, v189, v190
    v_cvt_pk_bf16_f32 v176, v208, v209
    v_fma_f32 v208, v82, v185, v186
    v_fma_f32 v209, v83, v189, v190
    v_cvt_pk_bf16_f32 v177, v208, v209
    v_fma_f32 v208, v84, v185, v186
    v_fma_f32 v209, v85, v189, v190
    v_cvt_pk_bf16_f32 v178, v208, v209
    v_fma_f32 v208, v86, v185, v186
    v_fma_f32 v209, v87, v189, v190
    v_cvt_pk_bf16_f32 v179, v208, v209
    ds_write_b32 v63, v176 offset:0
    ds_write_b32 v63, v177 offset:4864
    ds_write_b32 v63, v178 offset:9728
    ds_write_b32 v63, v179 offset:14592
    v_mul_f32 v208, 0x3acccccd, v193
    v_mul_f32 v209, 0x3acccccd, v197
    v_mul_f32 v194, 0x3acccccd, v194
    v_mul_f32 v198, 0x3acccccd, v198
    v_fma_f32 v194, -v208, v208, v194
    v_fma_f32 v198, -v209, v209, v198
    v_max_f32 v194, 0, v194
    v_max_f32 v198, 0, v198
    v_add_f32 v194, 0x3727c5ac, v194
    v_add_f32 v198, 0x3727c5ac, v198
    v_rsq_f32 v193, v194
    v_rsq_f32 v197, v198
    v_mul_f32 v194, -v208, v193
    v_mul_f32 v198, -v209, v197
    v_lshlrev_b32 v88, 16, v180
    v_and_b32 v90, 0xffff0000, v180
    v_lshlrev_b32 v92, 16, v181
    v_and_b32 v94, 0xffff0000, v181
    v_lshlrev_b32 v89, 16, v182
    v_and_b32 v91, 0xffff0000, v182
    v_lshlrev_b32 v93, 16, v183
    v_and_b32 v95, 0xffff0000, v183
    v_fma_f32 v208, v88, v193, v194
    v_fma_f32 v209, v89, v197, v198
    v_cvt_pk_bf16_f32 v180, v208, v209
    v_fma_f32 v208, v90, v193, v194
    v_fma_f32 v209, v91, v197, v198
    v_cvt_pk_bf16_f32 v181, v208, v209
    v_fma_f32 v208, v92, v193, v194
    v_fma_f32 v209, v93, v197, v198
    v_cvt_pk_bf16_f32 v182, v208, v209
    v_fma_f32 v208, v94, v193, v194
    v_fma_f32 v209, v95, v197, v198
    v_cvt_pk_bf16_f32 v183, v208, v209
    ds_write_b32 v63, v180 offset:256
    ds_write_b32 v63, v181 offset:5120
    ds_write_b32 v63, v182 offset:9984
    ds_write_b32 v63, v183 offset:14848
    s_waitcnt lgkmcnt(0)
    s_barrier
    ds_read_b128 v[212:215], v64 offset:96
    ds_read_b128 v[216:219], v64 offset:64
    ds_read_b128 v[220:223], v64 offset:32
    ds_read_b128 v[224:227], v64 offset:0
    s_waitcnt lgkmcnt(3)
    v_mfma_f32_32x32x16_bf16 v[96:111], v[212:215], v[144:147], 0
    ds_read_b128 v[228:231], v64 offset:224
    ds_read_b64_tr_b16 v[176:177], v65 offset:1056
    ds_read_b64_tr_b16 v[178:179], v65 offset:1024
    ds_read_b64_tr_b16 v[180:181], v65 offset:1184
    ds_read_b64_tr_b16 v[182:183], v65 offset:1152
    s_waitcnt lgkmcnt(7)
    v_mfma_f32_32x32x16_bf16 v[96:111], v[216:219], v[148:151], v[96:111]
    ds_read_b128 v[232:235], v64 offset:192
    ds_read_b64_tr_b16 v[184:185], v65 offset:1312
    ds_read_b64_tr_b16 v[186:187], v65 offset:1280
    ds_read_b64_tr_b16 v[188:189], v65 offset:1440
    ds_read_b64_tr_b16 v[190:191], v65 offset:1408
    s_waitcnt lgkmcnt(11)
    v_mfma_f32_32x32x16_bf16 v[96:111], v[220:223], v[152:155], v[96:111]
    ds_read_b128 v[236:239], v64 offset:160
    ds_read_b64_tr_b16 v[192:193], v65 offset:1568
    ds_read_b64_tr_b16 v[194:195], v65 offset:1536
    ds_read_b64_tr_b16 v[196:197], v65 offset:1696
    ds_read_b64_tr_b16 v[198:199], v65 offset:1664
    s_waitcnt lgkmcnt(15)
    v_mfma_f32_32x32x16_bf16 v[96:111], v[224:227], v[156:159], v[96:111]
    ds_read_b128 v[240:243], v64 offset:128
    ds_read_b64_tr_b16 v[200:201], v65 offset:1824
    ds_read_b64_tr_b16 v[202:203], v65 offset:1792
    ds_read_b64_tr_b16 v[204:205], v65 offset:1952
    ds_read_b64_tr_b16 v[206:207], v65 offset:1920
    s_waitcnt lgkmcnt(15)
    v_mfma_f32_32x32x16_bf16 v[112:127], v[228:231], v[144:147], 0
    buffer_store_dwordx4 v[248:251], v62, s[16:19], s88 offen offset:1024 sc1
    s_nop 3
    s_waitcnt lgkmcnt(14)
    v_mfma_f32_32x32x16_bf16 v[112:127], v[232:235], v[148:151], v[112:127]
    v_cndmask_b32 v208, v99, v72, s[76:77]
    v_cndmask_b32 v209, v103, v99, s[76:77]
    v_cndmask_b32 v210, v107, v103, s[76:77]
    v_cndmask_b32 v211, v111, v107, s[76:77]
    v_mov_b32_e64 v72, v111
    s_waitcnt lgkmcnt(9)
    v_mfma_f32_32x32x16_bf16 v[112:127], v[236:239], v[152:155], v[112:127]
    v_add_f32_dpp v98, v208, v98 wave_ror:1 row_mask:0xf bank_mask:0xf
    v_add_f32_dpp v102, v209, v102 wave_ror:1 row_mask:0xf bank_mask:0xf
    v_add_f32_dpp v106, v210, v106 wave_ror:1 row_mask:0xf bank_mask:0xf
    v_add_f32_dpp v110, v211, v110 wave_ror:1 row_mask:0xf bank_mask:0xf
    v_cndmask_b32 v208, v98, v71, s[76:77]
    s_waitcnt lgkmcnt(4)
    v_mfma_f32_32x32x16_bf16 v[112:127], v[240:243], v[156:159], v[112:127]
    v_cndmask_b32 v209, v102, v98, s[76:77]
    v_cndmask_b32 v210, v106, v102, s[76:77]
    v_cndmask_b32 v211, v110, v106, s[76:77]
    v_mov_b32 v71, v110
    v_add_f32_dpp v97, v208, v97 wave_ror:1 row_mask:0xf bank_mask:0xf
    v_add_f32_dpp v101, v209, v101 wave_ror:1 row_mask:0xf bank_mask:0xf
    v_mfma_f32_32x32x16_bf16 v[112:127], v[212:215], v[160:163], v[112:127]
    ds_read_b128 v[244:247], v64 offset:352
    v_add_f32_dpp v105, v210, v105 wave_ror:1 row_mask:0xf bank_mask:0xf
    v_add_f32_dpp v109, v211, v109 wave_ror:1 row_mask:0xf bank_mask:0xf
    v_cndmask_b32 v208, v97, v70, s[76:77]
    v_cndmask_b32 v209, v101, v97, s[76:77]
    v_cndmask_b32 v210, v105, v101, s[76:77]
    v_mfma_f32_32x32x16_bf16 v[112:127], v[216:219], v[164:167], v[112:127]
    ds_read_b128 v[216:219], v64 offset:320
    v_cndmask_b32 v211, v109, v105, s[76:77]
    v_mov_b32_e64 v70, v109
    v_add_f32_dpp v96, v208, v96 wave_ror:1 row_mask:0xf bank_mask:0xf
    v_add_f32_dpp v100, v209, v100 wave_ror:1 row_mask:0xf bank_mask:0xf
    v_add_f32_dpp v104, v210, v104 wave_ror:1 row_mask:0xf bank_mask:0xf
    v_mfma_f32_32x32x16_bf16 v[112:127], v[220:223], v[168:171], v[112:127]
    ds_read_b128 v[220:223], v64 offset:288
    buffer_store_dwordx4 v[248:251], v62, s[16:19], s88 offen offset:2048 sc1
    v_add_f32_dpp v108, v211, v108 wave_ror:1 row_mask:0xf bank_mask:0xf
    v_mfma_f32_32x32x16_bf16 v[112:127], v[224:227], v[172:175], v[112:127]
    ds_read_b128 v[224:227], v64 offset:256
    ds_write_b32 v66, v96 offset:0
    ds_write_b32 v66, v100 offset:64
    s_waitcnt lgkmcnt(5)
    v_mfma_f32_32x32x16_bf16 v[128:143], v[244:247], v[144:147], 0
    ds_write_b32 v66, v104 offset:128
    ds_write_b32 v66, v108 offset:192
    s_nop 0
    s_waitcnt lgkmcnt(6)
    v_mfma_f32_32x32x16_bf16 v[128:143], v[216:219], v[148:151], v[128:143]
    s_nop 3
    v_cndmask_b32 v208, v115, v72, s[76:77]
    s_waitcnt lgkmcnt(5)
    v_mfma_f32_32x32x16_bf16 v[128:143], v[220:223], v[152:155], v[128:143]
    v_cndmask_b32 v209, v119, v115, s[76:77]
    v_cndmask_b32 v210, v123, v119, s[76:77]
    v_cndmask_b32 v211, v127, v123, s[76:77]
    v_mov_b32 v72, v127
    v_add_f32_dpp v114, v208, v114 wave_ror:1 row_mask:0xf bank_mask:0xf
    s_waitcnt lgkmcnt(4)
    v_mfma_f32_32x32x16_bf16 v[128:143], v[224:227], v[156:159], v[128:143]
    v_add_f32_dpp v118, v209, v118 wave_ror:1 row_mask:0xf bank_mask:0xf
    v_add_f32_dpp v122, v210, v122 wave_ror:1 row_mask:0xf bank_mask:0xf
    v_add_f32_dpp v126, v211, v126 wave_ror:1 row_mask:0xf bank_mask:0xf
    v_cndmask_b32 v208, v114, v71, s[76:77]
    v_cndmask_b32 v209, v118, v114, s[76:77]
    v_cndmask_b32 v210, v122, v118, s[76:77]
    v_mfma_f32_32x32x16_bf16 v[128:143], v[228:231], v[160:163], v[128:143]
    buffer_store_dwordx4 v[248:251], v62, s[16:19], s88 offen offset:3072 sc1
    v_cndmask_b32 v211, v126, v122, s[76:77]
    v_mov_b32 v71, v126
    v_add_f32_dpp v113, v208, v113 wave_ror:1 row_mask:0xf bank_mask:0xf
    v_add_f32_dpp v117, v209, v117 wave_ror:1 row_mask:0xf bank_mask:0xf
    v_add_f32_dpp v121, v210, v121 wave_ror:1 row_mask:0xf bank_mask:0xf
    v_mfma_f32_32x32x16_bf16 v[128:143], v[232:235], v[164:167], v[128:143]
    ds_read_b128 v[232:235], v64 offset:64
    v_add_f32_dpp v125, v211, v125 wave_ror:1 row_mask:0xf bank_mask:0xf
    v_cndmask_b32 v208, v113, v70, s[76:77]
    v_cndmask_b32 v209, v117, v113, s[76:77]
    v_cndmask_b32 v210, v121, v117, s[76:77]
    v_cndmask_b32 v211, v125, v121, s[76:77]
    v_mfma_f32_32x32x16_bf16 v[128:143], v[236:239], v[168:171], v[128:143]
    ds_read_b128 v[236:239], v64 offset:32
    v_mov_b32_e64 v70, v125
    v_add_f32_dpp v112, v208, v112 wave_ror:1 row_mask:0xf bank_mask:0xf
    v_add_f32_dpp v116, v209, v116 wave_ror:1 row_mask:0xf bank_mask:0xf
    v_add_f32_dpp v120, v210, v120 wave_ror:1 row_mask:0xf bank_mask:0xf
    v_add_f32_dpp v124, v211, v124 wave_ror:1 row_mask:0xf bank_mask:0xf
    v_mfma_f32_32x32x16_bf16 v[128:143], v[240:243], v[172:175], v[128:143]
    ds_read_b128 v[240:243], v64 offset:0
    ds_write_b32 v66, v112 offset:256
    ds_write_b32 v66, v116 offset:320
    v_mfma_f32_32x32x16_bf16 v[128:143], v[212:215], v[176:179], v[128:143]
    ds_read_b128 v[212:215], v64 offset:480
    ds_write_b32 v66, v120 offset:384
    ds_write_b32 v66, v124 offset:448
    s_waitcnt lgkmcnt(7)
    v_mfma_f32_32x32x16_bf16 v[128:143], v[232:235], v[180:183], v[128:143]
    ds_read_b128 v[232:235], v64 offset:448
    s_waitcnt lgkmcnt(7)
    v_mfma_f32_32x32x16_bf16 v[128:143], v[236:239], v[184:187], v[128:143]
    ds_read_b128 v[236:239], v64 offset:416
    s_waitcnt lgkmcnt(7)
    v_mfma_f32_32x32x16_bf16 v[128:143], v[240:243], v[188:191], v[128:143]
    ds_read_b128 v[240:243], v64 offset:384
    s_nop 3
    s_waitcnt lgkmcnt(5)
    v_mfma_f32_32x32x16_bf16 v[112:127], v[212:215], v[144:147], 0
    s_nop 4
    s_waitcnt lgkmcnt(2)
    v_mfma_f32_32x32x16_bf16 v[112:127], v[232:235], v[148:151], v[112:127]
    v_cndmask_b32 v208, v131, v72, s[76:77]
    v_cndmask_b32 v209, v135, v131, s[76:77]
    v_cndmask_b32 v210, v139, v135, s[76:77]
    v_cndmask_b32 v211, v143, v139, s[76:77]
    v_mov_b32_e64 v72, v143
    s_waitcnt lgkmcnt(1)
    v_mfma_f32_32x32x16_bf16 v[112:127], v[236:239], v[152:155], v[112:127]
    v_add_f32_dpp v130, v208, v130 wave_ror:1 row_mask:0xf bank_mask:0xf
    v_add_f32_dpp v134, v209, v134 wave_ror:1 row_mask:0xf bank_mask:0xf
    v_add_f32_dpp v138, v210, v138 wave_ror:1 row_mask:0xf bank_mask:0xf
    v_add_f32_dpp v142, v211, v142 wave_ror:1 row_mask:0xf bank_mask:0xf
    v_cndmask_b32 v208, v130, v71, s[76:77]
    s_waitcnt lgkmcnt(0)
    v_mfma_f32_32x32x16_bf16 v[112:127], v[240:243], v[156:159], v[112:127]
    v_cndmask_b32 v209, v134, v130, s[76:77]
    v_cndmask_b32 v210, v138, v134, s[76:77]
    v_cndmask_b32 v211, v142, v138, s[76:77]
    v_mov_b32 v71, v142
    v_add_f32_dpp v129, v208, v129 wave_ror:1 row_mask:0xf bank_mask:0xf
    v_add_f32_dpp v133, v209, v133 wave_ror:1 row_mask:0xf bank_mask:0xf
    v_mfma_f32_32x32x16_bf16 v[112:127], v[244:247], v[160:163], v[112:127]
    v_add_f32_dpp v137, v210, v137 wave_ror:1 row_mask:0xf bank_mask:0xf
    v_add_f32_dpp v141, v211, v141 wave_ror:1 row_mask:0xf bank_mask:0xf
    v_cndmask_b32 v208, v129, v70, s[76:77]
    v_cndmask_b32 v209, v133, v129, s[76:77]
    v_cndmask_b32 v210, v137, v133, s[76:77]
    v_cndmask_b32 v211, v141, v137, s[76:77]
    v_mfma_f32_32x32x16_bf16 v[112:127], v[216:219], v[164:167], v[112:127]
    ds_read_b128 v[240:243], v64 offset:192
    v_mov_b32_e64 v70, v141
    v_add_f32_dpp v128, v208, v128 wave_ror:1 row_mask:0xf bank_mask:0xf
    v_add_f32_dpp v132, v209, v132 wave_ror:1 row_mask:0xf bank_mask:0xf
    v_add_f32_dpp v136, v210, v136 wave_ror:1 row_mask:0xf bank_mask:0xf
    v_add_f32_dpp v140, v211, v140 wave_ror:1 row_mask:0xf bank_mask:0xf
    v_mfma_f32_32x32x16_bf16 v[112:127], v[220:223], v[168:171], v[112:127]
    ds_read_b128 v[220:223], v64 offset:160
    ds_write_b32 v66, v128 offset:512
    ds_write_b32 v66, v132 offset:576
    v_mfma_f32_32x32x16_bf16 v[112:127], v[224:227], v[172:175], v[112:127]
    ds_read_b128 v[224:227], v64 offset:128
    ds_write_b32 v66, v136 offset:640
    ds_write_b32 v66, v140 offset:704
    v_mfma_f32_32x32x16_bf16 v[112:127], v[228:231], v[176:179], v[112:127]
    ds_read_b128 v[236:239], v64 offset:96
    s_waitcnt lgkmcnt(7)
    v_mfma_f32_32x32x16_bf16 v[112:127], v[240:243], v[180:183], v[112:127]
    ds_read_b128 v[240:243], v64 offset:64
    s_waitcnt lgkmcnt(7)
    v_mfma_f32_32x32x16_bf16 v[112:127], v[220:223], v[184:187], v[112:127]
    ds_read_b128 v[220:223], v64 offset:32
    s_waitcnt lgkmcnt(5)
    v_mfma_f32_32x32x16_bf16 v[112:127], v[224:227], v[188:191], v[112:127]
    ds_read_b128 v[224:227], v64 offset:0
    s_waitcnt lgkmcnt(3)
    v_mfma_f32_32x32x16_bf16 v[112:127], v[236:239], v[192:195], v[112:127]
    ds_read_b64_tr_b16 v[216:217], v65 offset:544
    ds_read_b64_tr_b16 v[218:219], v65 offset:512
    s_waitcnt lgkmcnt(4)
    v_mfma_f32_32x32x16_bf16 v[112:127], v[240:243], v[196:199], v[112:127]
    ds_read_b64_tr_b16 v[240:241], v65 offset:1056
    ds_read_b64_tr_b16 v[242:243], v65 offset:1024
    s_waitcnt lgkmcnt(5)
    v_mfma_f32_32x32x16_bf16 v[112:127], v[220:223], v[200:203], v[112:127]
    s_waitcnt lgkmcnt(4)
    v_mfma_f32_32x32x16_bf16 v[112:127], v[224:227], v[204:207], v[112:127]
    ds_read_b64_tr_b16 v[224:225], v65 offset:1568
    ds_read_b64_tr_b16 v[226:227], v65 offset:1536
    s_lshl_b32 s96, s75, 14
    s_add_u32 s96, s96, 6815744
    s_lshl_b32 s97, s24, 12
    s_add_u32 s97, s97, 3477504
    buffer_load_dwordx4 v[248:251], v62, s[16:19], s96 offen offset:2048 sc1
    s_waitcnt lgkmcnt(4)
    v_mfma_f32_32x32x16_bf16 v[144:159], v[212:215], v[216:219], 0
    s_nop 3
    v_cndmask_b32 v208, v115, v72, s[76:77]
    s_waitcnt lgkmcnt(2)
    v_mfma_f32_32x32x16_bf16 v[144:159], v[244:247], v[240:243], v[144:159]
    buffer_load_dwordx4 v[252:255], v62, s[16:19], s96 offen offset:3072 sc1
    v_cndmask_b32 v209, v119, v115, s[76:77]
    v_cndmask_b32 v210, v123, v119, s[76:77]
    v_cndmask_b32 v211, v127, v123, s[76:77]
    v_mov_b32_e64 v72, v127
    v_add_f32_dpp v114, v208, v114 wave_ror:1 row_mask:0xf bank_mask:0xf
    v_mfma_f32_32x32x16_bf16 v[160:175], v[212:215], v[240:243], 0
    ds_read_b64_tr_b16 v[216:217], v65 offset:2080
    ds_read_b64_tr_b16 v[218:219], v65 offset:2048
    v_add_f32_dpp v118, v209, v118 wave_ror:1 row_mask:0xf bank_mask:0xf
    v_add_f32_dpp v122, v210, v122 wave_ror:1 row_mask:0xf bank_mask:0xf
    v_add_f32_dpp v126, v211, v126 wave_ror:1 row_mask:0xf bank_mask:0xf
    s_waitcnt lgkmcnt(2)
    v_mfma_f32_32x32x16_bf16 v[144:159], v[228:231], v[224:227], v[144:159]
    buffer_load_dwordx4 v[96:99], v62, s[16:19], s97 offen offset:0 sc1
    v_cndmask_b32 v208, v114, v71, s[76:77]
    v_cndmask_b32 v209, v118, v114, s[76:77]
    v_cndmask_b32 v210, v122, v118, s[76:77]
    v_cndmask_b32 v211, v126, v122, s[76:77]
    v_mov_b32 v71, v126
    v_mfma_f32_32x32x16_bf16 v[160:175], v[244:247], v[224:227], v[160:175]
    v_add_f32_dpp v113, v208, v113 wave_ror:1 row_mask:0xf bank_mask:0xf
    v_add_f32_dpp v117, v209, v117 wave_ror:1 row_mask:0xf bank_mask:0xf
    v_add_f32_dpp v121, v210, v121 wave_ror:1 row_mask:0xf bank_mask:0xf
    v_add_f32_dpp v125, v211, v125 wave_ror:1 row_mask:0xf bank_mask:0xf
    v_cndmask_b32 v208, v113, v70, s[76:77]
    v_cndmask_b32 v209, v117, v113, s[76:77]
    v_mfma_f32_32x32x16_bf16 v[176:191], v[212:215], v[224:227], 0
    buffer_load_dwordx4 v[100:103], v62, s[16:19], s97 offen offset:1024 sc1
    v_cndmask_b32 v210, v121, v117, s[76:77]
    v_cndmask_b32 v211, v125, v121, s[76:77]
    v_mov_b32 v70, v125
    v_add_f32_dpp v112, v208, v112 wave_ror:1 row_mask:0xf bank_mask:0xf
    s_waitcnt lgkmcnt(0)
    v_mfma_f32_32x32x16_bf16 v[144:159], v[236:239], v[216:219], v[144:159]
    ds_read_b64_tr_b16 v[240:241], v65 offset:2592
    ds_read_b64_tr_b16 v[242:243], v65 offset:2560
    v_add_f32_dpp v116, v209, v116 wave_ror:1 row_mask:0xf bank_mask:0xf
    v_add_f32_dpp v120, v210, v120 wave_ror:1 row_mask:0xf bank_mask:0xf
    v_add_f32_dpp v124, v211, v124 wave_ror:1 row_mask:0xf bank_mask:0xf
    v_mfma_f32_32x32x16_bf16 v[160:175], v[228:231], v[216:219], v[160:175]
    buffer_load_dwordx4 v[104:107], v62, s[16:19], s97 offen offset:2048 sc1
    ds_write_b32 v66, v112 offset:768
    ds_write_b32 v66, v116 offset:832
    v_mfma_f32_32x32x16_bf16 v[176:191], v[244:247], v[216:219], v[176:191]
    ds_write_b32 v66, v120 offset:896
    ds_write_b32 v66, v124 offset:960
    v_mfma_f32_32x32x16_bf16 v[192:207], v[212:215], v[216:219], 0
    ds_read_b64_tr_b16 v[212:213], v65 offset:3104
    ds_read_b64_tr_b16 v[214:215], v65 offset:3072
    buffer_load_dwordx4 v[108:111], v62, s[16:19], s97 offen offset:3072 sc1
    s_waitcnt lgkmcnt(6)
    v_mfma_f32_32x32x16_bf16 v[160:175], v[236:239], v[240:243], v[160:175]
    v_mfma_f32_32x32x16_bf16 v[176:191], v[228:231], v[240:243], v[176:191]
    ds_read_b64_tr_b16 v[224:225], v65 offset:3616
    ds_read_b64_tr_b16 v[226:227], v65 offset:3584
    s_waitcnt vmcnt(6) lgkmcnt(4)
    s_barrier
    v_mfma_f32_32x32x16_bf16 v[192:207], v[244:247], v[240:243], v[192:207]
    ds_read_b64_tr_b16 v[244:245], v65 offset:672
    ds_read_b64_tr_b16 v[246:247], v65 offset:640
    ds_read_b64 v[112:113], v67 offset:0
    ds_read_b64 v[114:115], v67 offset:4224
    ds_read_b64 v[116:117], v67 offset:8448
    s_waitcnt lgkmcnt(7)
    v_mfma_f32_32x32x16_bf16 v[176:191], v[236:239], v[212:215], v[176:191]
    ds_read_b128 v[216:219], v64 offset:320
    ds_read_b64_tr_b16 v[240:241], v65 offset:1184
    ds_read_b64_tr_b16 v[242:243], v65 offset:1152
    ds_read_b64 v[118:119], v67 offset:12672
    ds_read_b64 v[120:121], v67 offset:512
    ds_read_b64 v[122:123], v67 offset:4736
    v_mfma_f32_32x32x16_bf16 v[192:207], v[228:231], v[212:215], v[192:207]
    ds_read_b64 v[124:125], v67 offset:8960
    ds_read_b64 v[126:127], v67 offset:13184
    s_lshl_b32 s25, s75, 14
    s_add_u32 s25, s25, 9437184
    s_waitcnt lgkmcnt(13)
    v_mfma_f32_32x32x16_bf16 v[192:207], v[236:239], v[224:227], v[192:207]
    ds_read_b128 v[228:231], v64 offset:192
    ds_read_b64_tr_b16 v[236:237], v65 offset:1696
    ds_read_b64_tr_b16 v[238:239], v65 offset:1664
    s_waitcnt lgkmcnt(14)
    v_mfma_f32_32x32x16_bf16 v[144:159], v[232:235], v[244:247], v[144:159]
    v_mov_b32 v5, 1
    s_add_u32 s82, s86, 24576
    buffer_atomic_add v5, v6, s[16:19], s82 offen offset:0 sc0 sc1
    s_waitcnt lgkmcnt(8)
    v_mfma_f32_32x32x16_bf16 v[144:159], v[216:219], v[240:243], v[144:159]
    v_mfma_f32_32x32x16_bf16 v[160:175], v[232:235], v[240:243], v[160:175]
    ds_read_b128 v[212:215], v64 offset:64
    ds_read_b64_tr_b16 v[224:225], v65 offset:2208
    ds_read_b64_tr_b16 v[226:227], v65 offset:2176
    s_waitcnt lgkmcnt(3)
    v_mfma_f32_32x32x16_bf16 v[144:159], v[228:231], v[236:239], v[144:159]
    v_mfma_f32_32x32x16_bf16 v[160:175], v[216:219], v[236:239], v[160:175]
    v_add_f32 v112, v112, v80
    v_add_f32 v113, v113, v81
    v_add_f32 v114, v114, v82
    v_add_f32 v115, v115, v83
    v_add_f32 v116, v116, v84
    v_mfma_f32_32x32x16_bf16 v[176:191], v[232:235], v[236:239], v[176:191]
    v_add_f32 v117, v117, v85
    v_add_f32 v118, v118, v86
    v_add_f32 v119, v119, v87
    v_cvt_pk_bf16_f32 v128, v112, v114
    v_cvt_pk_bf16_f32 v129, v116, v118
    s_waitcnt lgkmcnt(0)
    v_mfma_f32_32x32x16_bf16 v[144:159], v[212:215], v[224:227], v[144:159]
    ds_read_b64_tr_b16 v[244:245], v65 offset:2720
    ds_read_b64_tr_b16 v[246:247], v65 offset:2688
    v_cvt_pk_bf16_f32 v130, v113, v115
    v_cvt_pk_bf16_f32 v131, v117, v119
    v_mfma_f32_32x32x16_bf16 v[160:175], v[228:231], v[224:227], v[160:175]
    buffer_store_dwordx4 v[128:131], v62, s[16:19], s25 offen offset:0 sc1
    v_add_f32 v120, v120, v88
    v_add_f32 v121, v121, v89
    v_add_f32 v122, v122, v90
    v_add_f32 v123, v123, v91
    v_add_f32 v124, v124, v92
    v_mfma_f32_32x32x16_bf16 v[176:191], v[216:219], v[224:227], v[176:191]
    v_add_f32 v125, v125, v93
    v_add_f32 v126, v126, v94
    v_add_f32_e64 v127, v127, v95
    v_cvt_pk_bf16_f32 v132, v120, v122
    v_cvt_pk_bf16_f32 v133, v124, v126
    v_cvt_pk_bf16_f32 v134, v121, v123
    v_mfma_f32_32x32x16_bf16 v[192:207], v[232:235], v[224:227], v[192:207]
    ds_read_b64_tr_b16 v[232:233], v65 offset:3232
    ds_read_b64_tr_b16 v[234:235], v65 offset:3200
    v_cvt_pk_bf16_f32 v135, v125, v127
    s_waitcnt lgkmcnt(2)
    v_mfma_f32_32x32x16_bf16 v[160:175], v[212:215], v[244:247], v[160:175]
    buffer_store_dwordx4 v[132:135], v62, s[16:19], s25 offen offset:1024 sc1
    ds_read_b64_tr_b16 v[112:113], v65 offset:32
    ds_read_b64_tr_b16 v[114:115], v65 offset:0
    ds_read_b64_tr_b16 v[116:117], v65 offset:160
    ds_read_b64_tr_b16 v[118:119], v65 offset:128
    ds_read_b64_tr_b16 v[120:121], v65 offset:288
    v_mfma_f32_32x32x16_bf16 v[176:191], v[228:231], v[244:247], v[176:191]
    ds_read_b64_tr_b16 v[240:241], v65 offset:3744
    ds_read_b64_tr_b16 v[242:243], v65 offset:3712
    ds_read_b64_tr_b16 v[122:123], v65 offset:256
    ds_read_b64_tr_b16 v[124:125], v65 offset:416
    ds_read_b64_tr_b16 v[126:127], v65 offset:384
    ds_read_b64_tr_b16 v[128:129], v65 offset:544
    v_mfma_f32_32x32x16_bf16 v[192:207], v[216:219], v[244:247], v[192:207]
    ds_read_b128 v[216:219], v64 offset:416
    ds_read_b64_tr_b16 v[236:237], v65 offset:800
    ds_read_b64_tr_b16 v[238:239], v65 offset:768
    ds_read_b64_tr_b16 v[130:131], v65 offset:512
    ds_read_b64_tr_b16 v[132:133], v65 offset:672
    s_waitcnt lgkmcnt(15)
    v_mfma_f32_32x32x16_bf16 v[176:191], v[212:215], v[232:235], v[176:191]
    ds_read_b128 v[224:227], v64 offset:288
    ds_read_b64_tr_b16 v[244:245], v65 offset:1312
    ds_read_b64_tr_b16 v[246:247], v65 offset:1280
    ds_read_b64_tr_b16 v[134:135], v65 offset:640
    ds_read_b64_tr_b16 v[136:137], v65 offset:800
    ds_read_b64_tr_b16 v[138:139], v65 offset:768
    v_mfma_f32_32x32x16_bf16 v[192:207], v[228:231], v[232:235], v[192:207]
    ds_read_b64_tr_b16 v[140:141], v65 offset:928
    ds_read_b64_tr_b16 v[142:143], v65 offset:896
    s_waitcnt lgkmcnt(15)
    v_mfma_f32_32x32x16_bf16 v[192:207], v[212:215], v[240:243], v[192:207]
    ds_read_b128 v[228:231], v64 offset:160
    ds_read_b64_tr_b16 v[212:213], v65 offset:1824
    ds_read_b64_tr_b16 v[214:215], v65 offset:1792
    s_waitcnt vmcnt(3)
ce_31:
    v_max3_u32 v208, v248, v249, v250
    v_max3_u32 v208, v208, v251, v252
    v_max3_u32 v208, v208, v253, v254
    v_max_u32_e64 v208, v208, v255
    v_cmp_eq_u32 s[82:83], -1, v208
    v_min3_f32 v209, v96, v99, v100
    v_min3_f32 v209, v209, v103, v104
    v_min3_f32 v209, v209, v107, v108
    v_min_f32 v209, v209, v111
    v_cmp_neq_f32 vcc, 0x41000000, v209
    s_nop 0
    s_or_b64 vcc, vcc, s[82:83]
    s_cbranch_vccnz rd_32
rc_33:
    s_waitcnt lgkmcnt(13)
    v_mfma_f32_32x32x16_bf16 v[144:159], v[216:219], v[236:239], v[144:159]
    v_mul_f32 v208, 0x3acccccd, v97
    v_mul_f32 v209, 0x3acccccd, v101
    v_mul_f32 v98, 0x3acccccd, v98
    v_mul_f32 v102, 0x3acccccd, v102
    v_fma_f32 v98, -v208, v208, v98
    s_waitcnt lgkmcnt(8)
    v_mfma_f32_32x32x16_bf16 v[144:159], v[224:227], v[244:247], v[144:159]
    v_fma_f32 v102, -v209, v209, v102
    v_max_f32 v98, 0, v98
    v_max_f32 v102, 0, v102
    v_add_f32 v98, 0x3727c5ac, v98
    v_add_f32 v102, 0x3727c5ac, v102
    v_mfma_f32_32x32x16_bf16 v[160:175], v[216:219], v[244:247], v[160:175]
    ds_read_b64_tr_b16 v[232:233], v65 offset:2336
    ds_read_b64_tr_b16 v[234:235], v65 offset:2304
    v_rsq_f32 v97, v98
    s_waitcnt lgkmcnt(2)
    v_mfma_f32_32x32x16_bf16 v[144:159], v[228:231], v[212:215], v[144:159]
    v_rsq_f32_e64 v101, v102
    v_mul_f32 v98, -v208, v97
    v_mul_f32 v102, -v209, v101
    v_lshlrev_b32_e64 v80, 16, v248
    v_and_b32 v82, 0xffff0000, v248
    v_mfma_f32_32x32x16_bf16 v[160:175], v[224:227], v[212:215], v[160:175]
    v_lshlrev_b32 v84, 16, v249
    v_and_b32 v86, 0xffff0000, v249
    v_lshlrev_b32 v81, 16, v250
    v_and_b32 v83, 0xffff0000, v250
    v_lshlrev_b32_e64 v85, 16, v251
    v_and_b32 v87, 0xffff0000, v251
    v_mfma_f32_32x32x16_bf16 v[176:191], v[216:219], v[212:215], v[176:191]
    v_fma_f32 v208, v80, v97, v98
    v_fma_f32 v209, v81, v101, v102
    v_cvt_pk_bf16_f32 v248, v208, v209
    v_fma_f32 v208, v82, v97, v98
    v_fma_f32 v209, v83, v101, v102
    s_waitcnt lgkmcnt(0)
    v_mfma_f32_32x32x16_bf16 v[144:159], v[220:223], v[232:235], v[144:159]
    ds_read_b64_tr_b16 v[240:241], v65 offset:2848
    ds_read_b64_tr_b16 v[242:243], v65 offset:2816
    v_cvt_pk_bf16_f32 v249, v208, v209
    v_fma_f32 v208, v84, v97, v98
    v_fma_f32 v209, v85, v101, v102
    v_cvt_pk_bf16_f32 v250, v208, v209
    v_mfma_f32_32x32x16_bf16 v[160:175], v[228:231], v[232:235], v[160:175]
    v_fma_f32 v208, v86, v97, v98
    v_fma_f32 v209, v87, v101, v102
    v_cvt_pk_bf16_f32 v251, v208, v209
    v_mfma_f32_32x32x16_bf16 v[176:191], v[224:227], v[232:235], v[176:191]
    ds_write_b32 v63, v248 offset:512
    ds_write_b32 v63, v249 offset:5376
    ds_write_b32 v63, v250 offset:10240
    v_mfma_f32_32x32x16_bf16 v[192:207], v[216:219], v[232:235], v[192:207]
    ds_read_b64_tr_b16 v[216:217], v65 offset:3360
    ds_read_b64_tr_b16 v[218:219], v65 offset:3328
    ds_write_b32 v63, v251 offset:15104
    v_mul_f32 v208, 0x3acccccd, v105
    s_waitcnt lgkmcnt(6)
    v_mfma_f32_32x32x16_bf16 v[160:175], v[220:223], v[240:243], v[160:175]
    v_mul_f32 v209, 0x3acccccd, v109
    v_mul_f32 v106, 0x3acccccd, v106
    v_mul_f32 v110, 0x3acccccd, v110
    v_fma_f32 v106, -v208, v208, v106
    v_fma_f32 v110, -v209, v209, v110
    v_max_f32_e64 v106, 0, v106
    v_mfma_f32_32x32x16_bf16 v[176:191], v[228:231], v[240:243], v[176:191]
    ds_read_b64_tr_b16 v[236:237], v65 offset:3872
    ds_read_b64_tr_b16 v[238:239], v65 offset:3840
    v_max_f32_e64 v110, 0, v110
    v_add_f32 v106, 0x3727c5ac, v106
    v_add_f32 v110, 0x3727c5ac, v110
    v_mfma_f32_32x32x16_bf16 v[192:207], v[224:227], v[240:243], v[192:207]
    ds_read_b128 v[224:227], v64 offset:384
    ds_read_b64_tr_b16 v[244:245], v65 offset:928
    ds_read_b64_tr_b16 v[246:247], v65 offset:896
    v_rsq_f32 v105, v106
    s_waitcnt lgkmcnt(6)
    v_mfma_f32_32x32x16_bf16 v[176:191], v[220:223], v[216:219], v[176:191]
    ds_read_b128 v[212:215], v64 offset:256
    ds_read_b64_tr_b16 v[232:233], v65 offset:1440
    ds_read_b64_tr_b16 v[234:235], v65 offset:1408
    v_rsq_f32_e64 v109, v110
    v_mul_f32 v106, -v208, v105
    v_mfma_f32_32x32x16_bf16 v[192:207], v[228:231], v[216:219], v[192:207]
    v_mul_f32 v110, -v209, v109
    v_lshlrev_b32 v88, 16, v252
    v_and_b32 v90, 0xffff0000, v252
    v_lshlrev_b32 v92, 16, v253
    v_and_b32 v94, 0xffff0000, v253
    s_waitcnt lgkmcnt(6)
    v_mfma_f32_32x32x16_bf16 v[192:207], v[220:223], v[236:239], v[192:207]
    ds_read_b128 v[220:223], v64 offset:128
    ds_read_b64_tr_b16 v[228:229], v65 offset:1952
    ds_read_b64_tr_b16 v[230:231], v65 offset:1920
    v_lshlrev_b32 v89, 16, v254
    v_and_b32 v91, 0xffff0000, v254
    s_waitcnt lgkmcnt(6)
    v_mfma_f32_32x32x16_bf16 v[144:159], v[224:227], v[244:247], v[144:159]
    v_lshlrev_b32 v93, 16, v255
    v_and_b32 v95, 0xffff0000, v255
    v_fma_f32 v208, v88, v105, v106
    v_fma_f32 v209, v89, v109, v110
    v_cvt_pk_bf16_f32 v252, v208, v209
    s_waitcnt lgkmcnt(3)
    v_mfma_f32_32x32x16_bf16 v[144:159], v[212:215], v[232:235], v[144:159]
    v_fma_f32 v208, v90, v105, v106
    v_fma_f32 v209, v91, v109, v110
    v_cvt_pk_bf16_f32 v253, v208, v209
    v_fma_f32 v208, v92, v105, v106
    v_fma_f32 v209, v93, v109, v110
    v_cvt_pk_bf16_f32 v254, v208, v209
    v_mfma_f32_32x32x16_bf16 v[160:175], v[224:227], v[232:235], v[160:175]
    ds_read_b128 v[240:243], v64 offset:0
    ds_read_b64_tr_b16 v[216:217], v65 offset:2464
    ds_read_b64_tr_b16 v[218:219], v65 offset:2432
    v_fma_f32 v208, v94, v105, v106
    v_fma_f32 v209, v95, v109, v110
    s_waitcnt lgkmcnt(3)
    v_mfma_f32_32x32x16_bf16 v[144:159], v[220:223], v[228:231], v[144:159]
    v_cvt_pk_bf16_f32 v255, v208, v209
    ds_write_b32 v63, v252 offset:768
    v_mfma_f32_32x32x16_bf16 v[160:175], v[212:215], v[228:231], v[160:175]
    ds_write_b32 v63, v253 offset:5632
    ds_write_b32 v63, v254 offset:10496
    ds_write_b32 v63, v255 offset:15360
    v_mfma_f32_32x32x16_bf16 v[176:191], v[224:227], v[228:231], v[176:191]
    s_waitcnt vmcnt(2)
    v_cmp_eq_u32 vcc, 19, v5
    s_nop 0
    s_cbranch_vccnz gl_34
gc_35:
    s_lshl_b32 s25, s72, 5
    s_add_u32 s25, s25, 0
    s_sub_u32 s26, s25, 4
    s_waitcnt lgkmcnt(4)
    v_mfma_f32_32x32x16_bf16 v[144:159], v[240:243], v[216:219], v[144:159]
    ds_read_b64_tr_b16 v[236:237], v65 offset:2976
    ds_read_b64_tr_b16 v[238:239], v65 offset:2944
    s_max_i32 s26, s26, 0
    s_lshl_b32 s27, s71, 12
    s_add_u32 s27, s27, 9437184
    s_lshl_b32 s99, s25, 3
    v_mfma_f32_32x32x16_bf16 v[160:175], v[220:223], v[216:219], v[160:175]
    s_lshl_b32 s100, s26, 3
    s_lshl_b32 s92, s24, 12
    s_lshl_b32 s93, s24, 9
    s_add_u32 s99, s99, s27
    s_add_u32 s100, s100, s27
    v_mfma_f32_32x32x16_bf16 v[176:191], v[212:215], v[216:219], v[176:191]
    v_mfma_f32_32x32x16_bf16 v[192:207], v[224:227], v[216:219], v[192:207]
    ds_read_b64_tr_b16 v[224:225], v65 offset:3488
    ds_read_b64_tr_b16 v[226:227], v65 offset:3456
    s_waitcnt lgkmcnt(2)
    v_mfma_f32_32x32x16_bf16 v[160:175], v[240:243], v[236:239], v[160:175]
    v_mfma_f32_32x32x16_bf16 v[176:191], v[220:223], v[236:239], v[176:191]
    ds_read_b64_tr_b16 v[244:245], v65 offset:4000
    ds_read_b64_tr_b16 v[246:247], v65 offset:3968
    v_mfma_f32_32x32x16_bf16 v[192:207], v[212:215], v[236:239], v[192:207]
    s_waitcnt lgkmcnt(2)
    v_mfma_f32_32x32x16_bf16 v[176:191], v[240:243], v[224:227], v[176:191]
    v_mfma_f32_32x32x16_bf16 v[192:207], v[220:223], v[224:227], v[192:207]
    s_waitcnt lgkmcnt(0)
    v_mfma_f32_32x32x16_bf16 v[192:207], v[240:243], v[244:247], v[192:207]
    s_waitcnt lgkmcnt(0)
    s_barrier
    ds_read_b128 v[212:215], v64 offset:608
    ds_read_b128 v[216:219], v64 offset:576
    ds_read_b128 v[220:223], v64 offset:544
    ds_read_b128 v[224:227], v64 offset:512
    s_waitcnt lgkmcnt(3)
    v_mfma_f32_32x32x16_bf16 v[144:159], v[212:215], v[112:115], v[144:159]
    ds_read_b128 v[228:231], v64 offset:736
    s_waitcnt lgkmcnt(3)
    v_mfma_f32_32x32x16_bf16 v[144:159], v[216:219], v[116:119], v[144:159]
    ds_read_b128 v[232:235], v64 offset:704
    s_waitcnt lgkmcnt(3)
    v_mfma_f32_32x32x16_bf16 v[144:159], v[220:223], v[120:123], v[144:159]
    ds_read_b128 v[236:239], v64 offset:672
    s_waitcnt lgkmcnt(3)
    v_mfma_f32_32x32x16_bf16 v[144:159], v[224:227], v[124:127], v[144:159]
    ds_read_b128 v[240:243], v64 offset:640
    s_nop 3
    s_waitcnt lgkmcnt(3)
    v_mfma_f32_32x32x16_bf16 v[160:175], v[228:231], v[112:115], v[160:175]
    s_nop 4
    s_waitcnt lgkmcnt(2)
    v_mfma_f32_32x32x16_bf16 v[160:175], v[232:235], v[116:119], v[160:175]
    v_cndmask_b32 v208, v147, v72, s[76:77]
    v_cndmask_b32 v209, v151, v147, s[76:77]
    v_cndmask_b32 v210, v155, v151, s[76:77]
    v_cndmask_b32 v211, v159, v155, s[76:77]
    v_mov_b32_e64 v72, v159
    s_waitcnt lgkmcnt(1)
    v_mfma_f32_32x32x16_bf16 v[160:175], v[236:239], v[120:123], v[160:175]
    v_add_f32_dpp v146, v208, v146 wave_ror:1 row_mask:0xf bank_mask:0xf
    v_add_f32_dpp v150, v209, v150 wave_ror:1 row_mask:0xf bank_mask:0xf
    v_add_f32_dpp v154, v210, v154 wave_ror:1 row_mask:0xf bank_mask:0xf
    v_add_f32_dpp v158, v211, v158 wave_ror:1 row_mask:0xf bank_mask:0xf
    v_cndmask_b32 v208, v146, v71, s[76:77]
    s_waitcnt lgkmcnt(0)
    v_mfma_f32_32x32x16_bf16 v[160:175], v[240:243], v[124:127], v[160:175]
    v_cndmask_b32 v209, v150, v146, s[76:77]
    v_cndmask_b32 v210, v154, v150, s[76:77]
    v_cndmask_b32 v211, v158, v154, s[76:77]
    v_mov_b32 v71, v158
    v_add_f32_dpp v145, v208, v145 wave_ror:1 row_mask:0xf bank_mask:0xf
    v_add_f32_dpp v149, v209, v149 wave_ror:1 row_mask:0xf bank_mask:0xf
    v_mfma_f32_32x32x16_bf16 v[160:175], v[212:215], v[128:131], v[160:175]
    ds_read_b128 v[244:247], v64 offset:864
    v_add_f32_dpp v153, v210, v153 wave_ror:1 row_mask:0xf bank_mask:0xf
    v_add_f32_dpp v157, v211, v157 wave_ror:1 row_mask:0xf bank_mask:0xf
    v_cndmask_b32 v208, v145, v70, s[76:77]
    v_cndmask_b32 v209, v149, v145, s[76:77]
    v_cndmask_b32 v210, v153, v149, s[76:77]
    v_mfma_f32_32x32x16_bf16 v[160:175], v[216:219], v[132:135], v[160:175]
    ds_read_b128 v[248:251], v64 offset:832
    v_cndmask_b32 v211, v157, v153, s[76:77]
    v_mov_b32_e64 v70, v157
    v_add_f32_dpp v144, v208, v144 wave_ror:1 row_mask:0xf bank_mask:0xf
    v_add_f32_dpp v148, v209, v148 wave_ror:1 row_mask:0xf bank_mask:0xf
    v_add_f32_dpp v152, v210, v152 wave_ror:1 row_mask:0xf bank_mask:0xf
    v_mfma_f32_32x32x16_bf16 v[160:175], v[220:223], v[136:139], v[160:175]
    ds_read_b128 v[252:255], v64 offset:800
    v_add_f32_dpp v156, v211, v156 wave_ror:1 row_mask:0xf bank_mask:0xf
    ds_write_b32 v66, v144 offset:0
    v_mfma_f32_32x32x16_bf16 v[160:175], v[224:227], v[140:143], v[160:175]
    ds_read_b128 v[224:227], v64 offset:768
    ds_write_b32 v66, v148 offset:64
    ds_write_b32 v66, v152 offset:128
    s_waitcnt lgkmcnt(6)
    v_mfma_f32_32x32x16_bf16 v[176:191], v[244:247], v[112:115], v[176:191]
    ds_write_b32 v66, v156 offset:192
    buffer_load_dword v7, v4, s[16:19], s89 offen offset:0 sc1
    s_nop 1
    s_waitcnt lgkmcnt(6)
    v_mfma_f32_32x32x16_bf16 v[176:191], v[248:251], v[116:119], v[176:191]
    s_nop 2
    v_cndmask_b32 v208, v163, v72, s[76:77]
    v_cndmask_b32 v209, v167, v163, s[76:77]
    s_waitcnt lgkmcnt(5)
    v_mfma_f32_32x32x16_bf16 v[176:191], v[252:255], v[120:123], v[176:191]
    v_cndmask_b32 v210, v171, v167, s[76:77]
    v_cndmask_b32 v211, v175, v171, s[76:77]
    v_mov_b32 v72, v175
    v_add_f32_dpp v162, v208, v162 wave_ror:1 row_mask:0xf bank_mask:0xf
    v_add_f32_dpp v166, v209, v166 wave_ror:1 row_mask:0xf bank_mask:0xf
    s_waitcnt lgkmcnt(3)
    v_mfma_f32_32x32x16_bf16 v[176:191], v[224:227], v[124:127], v[176:191]
    v_add_f32_dpp v170, v210, v170 wave_ror:1 row_mask:0xf bank_mask:0xf
    v_add_f32_dpp v174, v211, v174 wave_ror:1 row_mask:0xf bank_mask:0xf
    v_cndmask_b32 v208, v162, v71, s[76:77]
    v_cndmask_b32 v209, v166, v162, s[76:77]
    v_cndmask_b32 v210, v170, v166, s[76:77]
    v_cndmask_b32 v211, v174, v170, s[76:77]
    v_mfma_f32_32x32x16_bf16 v[176:191], v[228:231], v[128:131], v[176:191]
    ds_read_b64_tr_b16 v[228:229], v65 offset:1056
    ds_read_b64_tr_b16 v[230:231], v65 offset:1024
    v_mov_b32 v71, v174
    v_add_f32_dpp v161, v208, v161 wave_ror:1 row_mask:0xf bank_mask:0xf
    v_add_f32_dpp v165, v209, v165 wave_ror:1 row_mask:0xf bank_mask:0xf
    v_add_f32_dpp v169, v210, v169 wave_ror:1 row_mask:0xf bank_mask:0xf
    v_mfma_f32_32x32x16_bf16 v[176:191], v[232:235], v[132:135], v[176:191]
    ds_read_b64_tr_b16 v[232:233], v65 offset:1184
    ds_read_b64_tr_b16 v[234:235], v65 offset:1152
    v_add_f32_dpp v173, v211, v173 wave_ror:1 row_mask:0xf bank_mask:0xf
    v_cndmask_b32 v208, v161, v70, s[76:77]
    v_cndmask_b32 v209, v165, v161, s[76:77]
    v_cndmask_b32 v210, v169, v165, s[76:77]
    v_mfma_f32_32x32x16_bf16 v[176:191], v[236:239], v[136:139], v[176:191]
    ds_read_b64_tr_b16 v[236:237], v65 offset:1312
    ds_read_b64_tr_b16 v[238:239], v65 offset:1280
    v_cndmask_b32 v211, v173, v169, s[76:77]
    v_mov_b32_e64 v70, v173
    v_add_f32_dpp v160, v208, v160 wave_ror:1 row_mask:0xf bank_mask:0xf
    v_add_f32_dpp v164, v209, v164 wave_ror:1 row_mask:0xf bank_mask:0xf
    v_mfma_f32_32x32x16_bf16 v[176:191], v[240:243], v[140:143], v[176:191]
    ds_read_b128 v[240:243], v64 offset:512
    ds_read_b64_tr_b16 v[224:225], v65 offset:1440
    ds_read_b64_tr_b16 v[226:227], v65 offset:1408
    v_add_f32_dpp v168, v210, v168 wave_ror:1 row_mask:0xf bank_mask:0xf
    v_add_f32_dpp v172, v211, v172 wave_ror:1 row_mask:0xf bank_mask:0xf
    s_waitcnt lgkmcnt(7)
    v_mfma_f32_32x32x16_bf16 v[176:191], v[212:215], v[228:231], v[176:191]
    ds_read_b128 v[212:215], v64 offset:992
    ds_write_b32 v66, v160 offset:256
    ds_write_b32 v66, v164 offset:320
    s_waitcnt lgkmcnt(8)
    v_mfma_f32_32x32x16_bf16 v[176:191], v[216:219], v[232:235], v[176:191]
    ds_read_b128 v[216:219], v64 offset:960
    ds_write_b32 v66, v168 offset:384
    ds_write_b32 v66, v172 offset:448
    s_waitcnt lgkmcnt(9)
    v_mfma_f32_32x32x16_bf16 v[176:191], v[220:223], v[236:239], v[176:191]
    ds_read_b128 v[220:223], v64 offset:928
    s_waitcnt lgkmcnt(7)
    v_mfma_f32_32x32x16_bf16 v[176:191], v[240:243], v[224:227], v[176:191]
    ds_read_b128 v[240:243], v64 offset:896
    s_waitcnt lgkmcnt(2)
    s_waitcnt vmcnt(0)
    v_cmp_gt_u32_e64 vcc, 1, v7
    s_nop 0
    s_and_b64 vcc, vcc, s[50:51]
    s_cbranch_scc1 ps_36
pc_38:
    s_barrier
    v_mfma_f32_32x32x16_bf16 v[192:207], v[212:215], v[112:115], v[192:207]
    ds_read_b64 v[144:145], v67 offset:0
    ds_read_b64 v[146:147], v67 offset:4224
    ds_read_b64 v[148:149], v67 offset:8448
    ds_read_b64 v[150:151], v67 offset:12672
    s_lshl_b32 s25, s75, 14
    v_mfma_f32_32x32x16_bf16 v[192:207], v[216:219], v[116:119], v[192:207]
    s_add_u32 s25, s25, 9437184
    s_add_u32 m0, s92, 36352
    s_nop 0
    buffer_load_dwordx4 v73, s[16:19], s99 offen offset:0 sc1 lds
    buffer_load_dwordx4 v74, s[16:19], s99 offen offset:1024 sc1 lds
    buffer_load_dwordx4 v75, s[16:19], s99 offen offset:2048 sc1 lds
    s_waitcnt lgkmcnt(5)
    v_mfma_f32_32x32x16_bf16 v[192:207], v[220:223], v[120:123], v[192:207]
    buffer_load_dwordx4 v76, s[16:19], s99 offen offset:3072 sc1 lds
    s_waitcnt lgkmcnt(4)
    v_mfma_f32_32x32x16_bf16 v[192:207], v[240:243], v[124:127], v[192:207]
    ds_read_b128 v[212:215], v64 offset:768
    s_add_u32 m0, s93, 53760
    s_add_u32 s99, s99, 524288
    s_mov_b64 exec, s[80:81]
    buffer_load_dwordx4 v77, s[16:19], s100 offen sc1 lds
    s_mov_b64 exec, -1
    s_add_u32 s100, s100, 524288
    v_mfma_f32_32x32x16_bf16 v[192:207], v[244:247], v[128:131], v[192:207]
    ds_read_b128 v[244:247], v64 offset:736
    v_cndmask_b32 v208, v179, v72, s[76:77]
    v_cndmask_b32 v209, v183, v179, s[76:77]
    v_cndmask_b32 v210, v187, v183, s[76:77]
    v_cndmask_b32 v211, v191, v187, s[76:77]
    v_mov_b32_e64 v72, v191
    v_mfma_f32_32x32x16_bf16 v[192:207], v[248:251], v[132:135], v[192:207]
    ds_read_b128 v[248:251], v64 offset:704
    v_add_f32_dpp v178, v208, v178 wave_ror:1 row_mask:0xf bank_mask:0xf
    v_add_f32_dpp v182, v209, v182 wave_ror:1 row_mask:0xf bank_mask:0xf
    v_add_f32_dpp v186, v210, v186 wave_ror:1 row_mask:0xf bank_mask:0xf
    v_add_f32_dpp v190, v211, v190 wave_ror:1 row_mask:0xf bank_mask:0xf
    v_cndmask_b32 v208, v178, v71, s[76:77]
    v_mfma_f32_32x32x16_bf16 v[192:207], v[252:255], v[136:139], v[192:207]
    ds_read_b128 v[252:255], v64 offset:672
    v_cndmask_b32 v209, v182, v178, s[76:77]
    v_cndmask_b32 v210, v186, v182, s[76:77]
    v_cndmask_b32 v211, v190, v186, s[76:77]
    v_mov_b32 v71, v190
    s_waitcnt lgkmcnt(3)
    v_mfma_f32_32x32x16_bf16 v[192:207], v[212:215], v[140:143], v[192:207]
    ds_read_b128 v[216:219], v64 offset:640
    v_add_f32_dpp v177, v208, v177 wave_ror:1 row_mask:0xf bank_mask:0xf
    v_add_f32_dpp v181, v209, v181 wave_ror:1 row_mask:0xf bank_mask:0xf
    v_add_f32_dpp v185, v210, v185 wave_ror:1 row_mask:0xf bank_mask:0xf
    v_add_f32_dpp v189, v211, v189 wave_ror:1 row_mask:0xf bank_mask:0xf
    s_waitcnt lgkmcnt(3)
    v_mfma_f32_32x32x16_bf16 v[192:207], v[244:247], v[228:231], v[192:207]
    ds_read_b128 v[228:231], v64 offset:608
    ds_read_b64_tr_b16 v[220:221], v65 offset:1568
    ds_read_b64_tr_b16 v[222:223], v65 offset:1536
    v_cndmask_b32 v208, v177, v70, s[76:77]
    v_cndmask_b32 v209, v181, v177, s[76:77]
    s_waitcnt lgkmcnt(5)
    v_mfma_f32_32x32x16_bf16 v[192:207], v[248:251], v[232:235], v[192:207]
    ds_read_b128 v[232:235], v64 offset:576
    ds_read_b64_tr_b16 v[240:241], v65 offset:1696
    ds_read_b64_tr_b16 v[242:243], v65 offset:1664
    v_cndmask_b32 v210, v185, v181, s[76:77]
    v_cndmask_b32 v211, v189, v185, s[76:77]
    s_waitcnt lgkmcnt(7)
    v_mfma_f32_32x32x16_bf16 v[192:207], v[252:255], v[236:239], v[192:207]
    ds_read_b128 v[236:239], v64 offset:544
    ds_read_b64_tr_b16 v[212:213], v65 offset:1824
    ds_read_b64_tr_b16 v[214:215], v65 offset:1792
    v_mov_b32 v70, v189
    v_add_f32_dpp v176, v208, v176 wave_ror:1 row_mask:0xf bank_mask:0xf
    s_waitcnt lgkmcnt(9)
    v_mfma_f32_32x32x16_bf16 v[192:207], v[216:219], v[224:227], v[192:207]
    ds_read_b128 v[224:227], v64 offset:512
    ds_read_b64_tr_b16 v[244:245], v65 offset:1952
    ds_read_b64_tr_b16 v[246:247], v65 offset:1920
    v_add_f32_dpp v180, v209, v180 wave_ror:1 row_mask:0xf bank_mask:0xf
    v_add_f32_dpp v184, v210, v184 wave_ror:1 row_mask:0xf bank_mask:0xf
    s_waitcnt lgkmcnt(9)
    v_mfma_f32_32x32x16_bf16 v[192:207], v[228:231], v[220:223], v[192:207]
    v_add_f32_dpp v188, v211, v188 wave_ror:1 row_mask:0xf bank_mask:0xf
    ds_write_b32 v66, v176 offset:512
    s_waitcnt lgkmcnt(7)
    v_mfma_f32_32x32x16_bf16 v[192:207], v[232:235], v[240:243], v[192:207]
    ds_write_b32 v66, v180 offset:576
    ds_write_b32 v66, v184 offset:640
    s_waitcnt lgkmcnt(6)
    v_mfma_f32_32x32x16_bf16 v[192:207], v[236:239], v[212:215], v[192:207]
    ds_write_b32 v66, v188 offset:704
    v_add_f32 v144, v144, v80
    v_add_f32 v145, v145, v81
    s_waitcnt lgkmcnt(4)
    v_mfma_f32_32x32x16_bf16 v[192:207], v[224:227], v[244:247], v[192:207]
    v_add_f32 v146, v146, v82
    v_add_f32 v147, v147, v83
    v_add_f32 v148, v148, v84
    v_add_f32 v149, v149, v85
    v_add_f32 v150, v150, v86
    v_add_f32_e64 v151, v151, v87
    v_cvt_pk_bf16_f32 v160, v144, v146
    v_cvt_pk_bf16_f32 v161, v148, v150
    v_cvt_pk_bf16_f32 v162, v145, v147
    v_cvt_pk_bf16_f32 v163, v149, v151
    buffer_store_dwordx4 v[160:163], v62, s[16:19], s25 offen offset:2048 sc1
    s_add_u32 m0, s92, 55936
    s_nop 0
    s_nop 0
    buffer_load_dwordx4 v73, s[16:19], s99 offen offset:0 sc1 lds
    buffer_load_dwordx4 v74, s[16:19], s99 offen offset:1024 sc1 lds
    buffer_load_dwordx4 v75, s[16:19], s99 offen offset:2048 sc1 lds
    buffer_load_dwordx4 v76, s[16:19], s99 offen offset:3072 sc1 lds
    s_add_u32 m0, s93, 73344
    s_add_u32 s99, s99, 524288
    s_mov_b64 exec, s[80:81]
    buffer_load_dwordx4 v77, s[16:19], s100 offen sc1 lds
    s_mov_b64 exec, -1
    s_add_u32 s100, s100, 524288
    s_add_u32 m0, s92, 75520
    s_nop 0
    s_nop 0
    buffer_load_dwordx4 v73, s[16:19], s99 offen offset:0 sc1 lds
    buffer_load_dwordx4 v74, s[16:19], s99 offen offset:1024 sc1 lds
    buffer_load_dwordx4 v75, s[16:19], s99 offen offset:2048 sc1 lds
    buffer_load_dwordx4 v76, s[16:19], s99 offen offset:3072 sc1 lds
    s_add_u32 m0, s93, 92928
    s_add_u32 s99, s99, 524288
    s_mov_b64 exec, s[80:81]
    buffer_load_dwordx4 v77, s[16:19], s100 offen sc1 lds
    s_mov_b64 exec, -1
    s_add_u32 s100, s100, 524288
    v_cndmask_b32 v208, v195, v72, s[76:77]
    v_cndmask_b32 v209, v199, v195, s[76:77]
    v_cndmask_b32 v210, v203, v199, s[76:77]
    v_cndmask_b32 v211, v207, v203, s[76:77]
    v_mov_b32_e64 v72, v207
    v_add_f32_dpp v194, v208, v194 wave_ror:1 row_mask:0xf bank_mask:0xf
    v_add_f32_dpp v198, v209, v198 wave_ror:1 row_mask:0xf bank_mask:0xf
    v_add_f32_dpp v202, v210, v202 wave_ror:1 row_mask:0xf bank_mask:0xf
    v_add_f32_dpp v206, v211, v206 wave_ror:1 row_mask:0xf bank_mask:0xf
    v_cndmask_b32 v208, v194, v71, s[76:77]
    v_cndmask_b32 v209, v198, v194, s[76:77]
    v_cndmask_b32 v210, v202, v198, s[76:77]
    v_cndmask_b32 v211, v206, v202, s[76:77]
    v_mov_b32_e64 v71, v206
    v_add_f32_dpp v193, v208, v193 wave_ror:1 row_mask:0xf bank_mask:0xf
    v_add_f32_dpp v197, v209, v197 wave_ror:1 row_mask:0xf bank_mask:0xf
    v_add_f32_dpp v201, v210, v201 wave_ror:1 row_mask:0xf bank_mask:0xf
    v_add_f32_dpp v205, v211, v205 wave_ror:1 row_mask:0xf bank_mask:0xf
    v_cndmask_b32 v208, v193, v70, s[76:77]
    v_cndmask_b32 v209, v197, v193, s[76:77]
    v_cndmask_b32 v210, v201, v197, s[76:77]
    v_cndmask_b32 v211, v205, v201, s[76:77]
    v_mov_b32_e64 v70, v205
    v_add_f32_dpp v192, v208, v192 wave_ror:1 row_mask:0xf bank_mask:0xf
    v_add_f32_dpp v196, v209, v196 wave_ror:1 row_mask:0xf bank_mask:0xf
    v_add_f32_dpp v200, v210, v200 wave_ror:1 row_mask:0xf bank_mask:0xf
    v_add_f32_dpp v204, v211, v204 wave_ror:1 row_mask:0xf bank_mask:0xf
    ds_write_b32 v66, v192 offset:768
    ds_write_b32 v66, v196 offset:832
    ds_write_b32 v66, v200 offset:896
    ds_write_b32 v66, v204 offset:960
    s_waitcnt lgkmcnt(0)
    s_barrier
    ds_read_b64 v[152:153], v67 offset:512
    ds_read_b64 v[154:155], v67 offset:4736
    ds_read_b64 v[156:157], v67 offset:8960
    ds_read_b64 v[158:159], v67 offset:13184
    s_lshl_b32 s25, s75, 14
    s_add_u32 s25, s25, 9437184
    s_waitcnt lgkmcnt(0)
    v_add_f32 v152, v152, v88
    v_add_f32 v153, v153, v89
    v_add_f32 v154, v154, v90
    v_add_f32 v155, v155, v91
    v_add_f32 v156, v156, v92
    v_add_f32 v157, v157, v93
    v_add_f32 v158, v158, v94
    v_add_f32 v159, v159, v95
    v_cvt_pk_bf16_f32 v164, v152, v154
    v_cvt_pk_bf16_f32 v165, v156, v158
    v_cvt_pk_bf16_f32 v166, v153, v155
    v_cvt_pk_bf16_f32 v167, v157, v159
    buffer_store_dwordx4 v[164:167], v62, s[16:19], s25 offen offset:3072 sc1
    v_mov_b32_e64 v5, 1
    s_add_u32 s82, s86, 24576
    buffer_atomic_add v5, v6, s[16:19], s82 offen offset:4 sc0 sc1
    s_branch ec_27
nc_26:
    v_lshlrev_b32 v2, 3, v4
    v_mov_b32_e64 v5, 1
    v_cndmask_b32 v2, v4, v2, s[50:51]
    buffer_atomic_add v5, v2, s[16:19], s86 offen offset:8 sc1
    buffer_load_dword v7, v4, s[16:19], s87 offen offset:8 sc1
    s_waitcnt vmcnt(0)
    v_cmp_gt_u32 vcc, 12, v7
    s_nop 0
    s_and_b64 vcc, vcc, s[50:51]
    s_cbranch_scc1 ps_39
pc_41:
    v_mov_b32 v100, -1
    v_mov_b32 v101, -1
    v_mov_b32 v102, -1
    v_mov_b32 v103, -1
    v_lshlrev_b32 v104, 4, v0
    s_sub_u32 s88, s2, 160
    s_mul_i32 s88, s88, 57344
    s_min_u32 s88, s88, 5185536
    s_add_u32 s88, s88, 12058624
    buffer_store_dwordx4 v[100:103], v104, s[16:19], s88 offen sc1
    s_add_u32 s88, s88, 4096
    buffer_store_dwordx4 v[100:103], v104, s[16:19], s88 offen sc1
    s_add_u32 s88, s88, 4096
    buffer_store_dwordx4 v[100:103], v104, s[16:19], s88 offen sc1
    s_add_u32 s88, s88, 4096
    buffer_store_dwordx4 v[100:103], v104, s[16:19], s88 offen sc1
    s_add_u32 s88, s88, 4096
    buffer_store_dwordx4 v[100:103], v104, s[16:19], s88 offen sc1
    s_add_u32 s88, s88, 4096
    buffer_store_dwordx4 v[100:103], v104, s[16:19], s88 offen sc1
    s_add_u32 s88, s88, 4096
    buffer_store_dwordx4 v[100:103], v104, s[16:19], s88 offen sc1
    s_add_u32 s88, s88, 4096
    buffer_store_dwordx4 v[100:103], v104, s[16:19], s88 offen sc1
    s_add_u32 s88, s88, 4096
    buffer_store_dwordx4 v[100:103], v104, s[16:19], s88 offen sc1
    s_add_u32 s88, s88, 4096
    buffer_store_dwordx4 v[100:103], v104, s[16:19], s88 offen sc1
    s_add_u32 s88, s88, 4096
    buffer_store_dwordx4 v[100:103], v104, s[16:19], s88 offen sc1
    s_add_u32 s88, s88, 4096
    buffer_store_dwordx4 v[100:103], v104, s[16:19], s88 offen sc1
    s_add_u32 s88, s88, 4096
    buffer_store_dwordx4 v[100:103], v104, s[16:19], s88 offen sc1
    s_add_u32 s88, s88, 4096
    buffer_store_dwordx4 v[100:103], v104, s[16:19], s88 offen sc1
    s_waitcnt vmcnt(0)
    s_barrier
    v_mov_b32_e64 v5, 1
    s_add_u32 s82, s86, 8192
    buffer_atomic_add v5, v6, s[16:19], s82 offen offset:12 sc0 sc1
    s_waitcnt vmcnt(0)
    v_cmp_eq_u32 vcc, 11, v5
    s_nop 0
    s_cbranch_vccnz gl_42
gc_43:
    buffer_load_dword v7, v4, s[16:19], s89 offen offset:0 sc1
    s_waitcnt vmcnt(0)
    v_cmp_gt_u32 vcc, 1, v7
    s_nop 0
    s_and_b64 vcc, vcc, s[50:51]
    s_cbranch_scc1 ps_44
pc_46:
    s_barrier
    s_sub_u32 s3, s2, 160
    s_and_b32 s3, s3, 63
    s_add_u32 s3, s3, 0
    s_and_b32 s25, s3, 3
    s_lshl_b32 s25, s25, 12
    s_lshr_b32 s26, s3, 2
    s_lshl_b32 s26, s26, 7
    s_add_u32 s3, s25, s26
    v_lshrrev_b32 v236, 3, v0
    v_and_b32 v237, 7, v0
    v_lshlrev_b32 v237, 4, v237
    v_lshl_add_u32 v236, v236, 14, v237
    s_sub_u32 s25, s2, 160
    s_cmp_lt_u32 s25, 64
    s_cselect_b32 s25, 0, 1073741824
    v_add_u32_e64 v236, s25, v236
    s_add_u32 s26, s3, 9437184
    buffer_load_dwordx4 v[216:219], v236, s[16:19], s26 offen sc1
    s_add_u32 s26, s26, 524288
    buffer_load_dwordx4 v[220:223], v236, s[16:19], s26 offen sc1
    s_add_u32 s26, s26, 524288
    buffer_load_dwordx4 v[224:227], v236, s[16:19], s26 offen sc1
    s_add_u32 s26, s26, 524288
    buffer_load_dwordx4 v[228:231], v236, s[16:19], s26 offen sc1
    s_add_u32 s26, s26, 524288
    buffer_load_dwordx4 v[232:235], v236, s[16:19], s26 offen sc1
    s_lshl_b32 s25, s72, 5
    s_add_u32 s25, s25, 0
    s_sub_u32 s26, s25, 4
    s_max_i32 s26, s26, 0
    s_lshl_b32 s27, s71, 12
    s_add_u32 s27, s27, 9437184
    s_lshl_b32 s99, s25, 3
    s_lshl_b32 s100, s26, 3
    s_lshl_b32 s92, s24, 12
    s_lshl_b32 s93, s24, 9
    s_add_u32 s99, s99, s27
    s_add_u32 s100, s100, s27
    s_add_u32 m0, s92, 36352
    s_nop 0
    buffer_load_dwordx4 v73, s[16:19], s99 offen offset:0 sc1 lds
    buffer_load_dwordx4 v74, s[16:19], s99 offen offset:1024 sc1 lds
    buffer_load_dwordx4 v75, s[16:19], s99 offen offset:2048 sc1 lds
    buffer_load_dwordx4 v76, s[16:19], s99 offen offset:3072 sc1 lds
    s_add_u32 m0, s93, 53760
    s_add_u32 s99, s99, 524288
    s_mov_b64 exec, s[80:81]
    buffer_load_dwordx4 v77, s[16:19], s100 offen sc1 lds
    s_mov_b64 exec, -1
    s_add_u32 s100, s100, 524288
    s_add_u32 m0, s92, 55936
    s_nop 0
    s_nop 0
    buffer_load_dwordx4 v73, s[16:19], s99 offen offset:0 sc1 lds
    buffer_load_dwordx4 v74, s[16:19], s99 offen offset:1024 sc1 lds
    buffer_load_dwordx4 v75, s[16:19], s99 offen offset:2048 sc1 lds
    buffer_load_dwordx4 v76, s[16:19], s99 offen offset:3072 sc1 lds
    s_add_u32 m0, s93, 73344
    s_add_u32 s99, s99, 524288
    s_mov_b64 exec, s[80:81]
    buffer_load_dwordx4 v77, s[16:19], s100 offen sc1 lds
    s_mov_b64 exec, -1
    s_add_u32 s100, s100, 524288
    s_sub_u32 s85, s2, 160
    s_cmp_ge_u32 s85, 64
    s_cbranch_scc1 s2_47
    v_mov_b32 v238, 0x3f803f80
    s_lshl_b32 s25, s24, 7
    s_add_u32 s25, s25, 134272
    v_lshrrev_b32 v239, 4, v1
    v_lshl_add_u32 v237, v239, 2, v237
    v_add_u32 v237, s25, v237
se_48:
    v_mov_b32 v240, 0
    v_mov_b32 v241, 0
    v_mov_b32 v242, 0
    v_mov_b32 v243, 0
    s_waitcnt vmcnt(14)
    v_dot2c_f32_bf16 v240, v216, v238
    v_dot2c_f32_bf16 v241, v216, v216
    v_dot2c_f32_bf16 v240, v217, v238
    v_dot2c_f32_bf16 v241, v217, v217
    v_dot2c_f32_bf16 v242, v218, v238
    v_dot2c_f32_bf16 v243, v218, v218
    v_dot2c_f32_bf16 v242, v219, v238
    v_dot2c_f32_bf16 v243, v219, v219
    s_waitcnt vmcnt(13)
    v_dot2c_f32_bf16 v240, v220, v238
    v_dot2c_f32_bf16 v241, v220, v220
    v_dot2c_f32_bf16 v240, v221, v238
    v_dot2c_f32_bf16 v241, v221, v221
    v_dot2c_f32_bf16 v242, v222, v238
    v_dot2c_f32_bf16 v243, v222, v222
    v_dot2c_f32_bf16 v242, v223, v238
    v_dot2c_f32_bf16 v243, v223, v223
    s_waitcnt vmcnt(12)
    v_dot2c_f32_bf16 v240, v224, v238
    v_dot2c_f32_bf16 v241, v224, v224
    v_dot2c_f32_bf16 v240, v225, v238
    v_dot2c_f32_bf16 v241, v225, v225
    v_dot2c_f32_bf16 v242, v226, v238
    v_dot2c_f32_bf16 v243, v226, v226
    v_dot2c_f32_bf16 v242, v227, v238
    v_dot2c_f32_bf16 v243, v227, v227
    s_waitcnt vmcnt(11)
    v_dot2c_f32_bf16 v240, v228, v238
    v_dot2c_f32_bf16 v241, v228, v228
    v_dot2c_f32_bf16 v240, v229, v238
    v_dot2c_f32_bf16 v241, v229, v229
    v_dot2c_f32_bf16 v242, v230, v238
    v_dot2c_f32_bf16 v243, v230, v230
    v_dot2c_f32_bf16 v242, v231, v238
    v_dot2c_f32_bf16 v243, v231, v231
    s_waitcnt vmcnt(10)
    v_dot2c_f32_bf16 v240, v232, v238
    v_dot2c_f32_bf16 v241, v232, v232
    v_dot2c_f32_bf16 v240, v233, v238
    v_dot2c_f32_bf16 v241, v233, v233
    v_dot2c_f32_bf16 v242, v234, v238
    v_dot2c_f32_bf16 v243, v234, v234
    v_dot2c_f32_bf16 v242, v235, v238
    v_dot2c_f32_bf16 v243, v235, v235
    s_nop 2
    v_cmp_u_f32 vcc, v241, v243
    s_nop 0
    s_cbranch_vccnz rd_49
rc_50:
    v_permlane32_swap_b32 v240, v242
    v_permlane32_swap_b32 v241, v243
    v_pk_add_f32 v[240:241], v[240:241], v[242:243]
    s_nop 1
    v_permlane16_swap_b32 v240, v241
    v_add_f32 v240, v240, v241
    s_nop 1
    v_add_f32_dpp v240, v240, v240 row_ror:8 row_mask:0xf bank_mask:0xf
    ds_write_b32 v237, v240
    v_and_b32 v236, 15, v0
    v_lshlrev_b32 v236, 3, v236
    v_add_u32 v237, 134272, v236
    v_mov_b32 v239, 1073741824
    v_cmp_gt_u32 vcc, 16, v0
    s_nop 1
    v_cndmask_b32 v236, v239, v236, vcc
    s_add_u32 s25, s3, 3457024
    s_waitcnt lgkmcnt(0)
    s_barrier
    ds_read_b64 v[216:217], v237 offset:0
    ds_read_b64 v[218:219], v237 offset:128
    ds_read_b64 v[220:221], v237 offset:256
    ds_read_b64 v[222:223], v237 offset:384
    s_waitcnt lgkmcnt(2)
    v_pk_add_f32 v[216:217], v[216:217], v[218:219]
    s_waitcnt lgkmcnt(0)
    v_pk_add_f32 v[220:221], v[220:221], v[222:223]
    v_pk_add_f32 v[216:217], v[216:217], v[220:221]
    v_mul_f32 v239, 0x3acccccd, v216
    v_mul_f32 v217, 0x3acccccd, v217
    v_fma_f32 v217, -v239, v239, v217
    v_max_f32 v217, 0, v217
    v_add_f32 v217, 0x3727c5ac, v217
    v_rsq_f32_e64 v216, v217
    s_nop 0
    v_mul_f32 v217, -v239, v216
    buffer_store_dwordx2 v[216:217], v236, s[16:19], s25 offen sc1
s2_47:
    s_add_u32 m0, s92, 75520
    s_nop 0
    s_nop 0
    buffer_load_dwordx4 v73, s[16:19], s99 offen offset:0 sc1 lds
    buffer_load_dwordx4 v74, s[16:19], s99 offen offset:1024 sc1 lds
    buffer_load_dwordx4 v75, s[16:19], s99 offen offset:2048 sc1 lds
    buffer_load_dwordx4 v76, s[16:19], s99 offen offset:3072 sc1 lds
    s_add_u32 m0, s93, 92928
    s_add_u32 s99, s99, 524288
    s_mov_b64 exec, s[80:81]
    buffer_load_dwordx4 v77, s[16:19], s100 offen sc1 lds
    s_mov_b64 exec, -1
    s_add_u32 s100, s100, 524288
ec_27:
ge_51:
    v_add_u32 v196, 36352, v78
    v_mov_b32_e64 v198, v79
    s_waitcnt vmcnt(10)
    s_barrier
    ds_read_b64 v[160:161], v198 offset:0
    ds_read_b64 v[162:163], v198 offset:64
    ds_read_b64 v[164:165], v196 offset:0
    ds_read_b64 v[166:167], v196 offset:512
    ds_read_b64 v[168:169], v196 offset:256
    ds_read_b64 v[170:171], v196 offset:768
    ds_read_b64 v[172:173], v198 offset:256
    ds_read_b64 v[174:175], v198 offset:320
    ds_read_b64 v[176:177], v196 offset:2048
    ds_read_b64 v[178:179], v196 offset:2560
    ds_read_b64 v[180:181], v196 offset:2304
    ds_read_b64 v[182:183], v196 offset:2816
    s_waitcnt lgkmcnt(6)
    v_mfma_f32_16x16x32_bf16 v[112:115], a[0:3], v[160:163], 0
    ds_read_b64 v[184:185], v198 offset:512
    v_mfma_f32_32x32x16_bf16 v[80:95], a[0:3], v[164:167], 0
    ds_read_b64 v[186:187], v198 offset:576
    ds_read_b64 v[188:189], v196 offset:4096
    ds_read_b64 v[190:191], v196 offset:4608
    v_mov_b32 v208, 0
    v_mov_b32_e64 v209, 0
    v_mfma_f32_32x32x16_bf16 v[96:111], a[0:3], v[168:171], 0
    ds_read_b64 v[192:193], v196 offset:4352
    ds_read_b64 v[194:195], v196 offset:4864
    buffer_load_dword v7, v4, s[16:19], s87 offen offset:12 sc1
    s_waitcnt lgkmcnt(6)
    v_mfma_f32_16x16x32_bf16 v[112:115], a[4:7], v[172:175], v[112:115]
    ds_read_b64 v[160:161], v198 offset:768
    v_mfma_f32_32x32x16_bf16 v[80:95], a[4:7], v[176:179], v[80:95]
    ds_read_b64 v[162:163], v198 offset:832
    ds_read_b64 v[164:165], v196 offset:6144
    ds_read_b64 v[166:167], v196 offset:6656
    v_lshrrev_b32 v210, 5, v0
    v_mul_u32_u24 v210, 1600, v210
    v_mfma_f32_32x32x16_bf16 v[96:111], a[4:7], v[180:183], v[96:111]
    ds_read_b64 v[168:169], v196 offset:6400
    ds_read_b64 v[170:171], v196 offset:6912
    s_add_u32 m0, s92, 95104
    s_nop 0
    buffer_load_dwordx4 v73, s[16:19], s99 offen offset:0 sc1 lds
    s_waitcnt lgkmcnt(6)
    v_mfma_f32_16x16x32_bf16 v[112:115], a[8:11], v[184:187], v[112:115]
    ds_read_b64 v[172:173], v198 offset:1024
    v_mfma_f32_32x32x16_bf16 v[80:95], a[8:11], v[188:191], v[80:95]
    ds_read_b64 v[174:175], v198 offset:1088
    ds_read_b64 v[176:177], v196 offset:8192
    ds_read_b64 v[178:179], v196 offset:8704
    v_and_b32 v211, 31, v0
    v_min_u32 v211, 19, v211
    v_mfma_f32_32x32x16_bf16 v[96:111], a[8:11], v[192:195], v[96:111]
    ds_read_b64 v[180:181], v196 offset:8448
    ds_read_b64 v[182:183], v196 offset:8960
    buffer_load_dwordx4 v74, s[16:19], s99 offen offset:1024 sc1 lds
    v_lshl_add_u32 v210, v211, 3, v210
    s_waitcnt lgkmcnt(6)
    v_mfma_f32_16x16x32_bf16 v[112:115], a[12:15], v[160:163], v[112:115]
    ds_read_b64 v[184:185], v198 offset:1280
    v_mfma_f32_32x32x16_bf16 v[80:95], a[12:15], v[164:167], v[80:95]
    ds_read_b64 v[186:187], v198 offset:1344
    ds_read_b64 v[188:189], v196 offset:10240
    ds_read_b64 v[190:191], v196 offset:10752
    v_add_u32 v210, 6400, v210
    ds_write_b64 v210, v[208:209]
    v_mfma_f32_32x32x16_bf16 v[96:111], a[12:15], v[168:171], v[96:111]
    ds_read_b64 v[192:193], v196 offset:10496
    ds_read_b64 v[194:195], v196 offset:11008
    buffer_load_dwordx4 v75, s[16:19], s99 offen offset:2048 sc1 lds
    s_waitcnt lgkmcnt(7)
    v_mfma_f32_16x16x32_bf16 v[112:115], a[16:19], v[172:175], v[112:115]
    ds_read_b64 v[160:161], v198 offset:1536
    v_mfma_f32_32x32x16_bf16 v[80:95], a[16:19], v[176:179], v[80:95]
    ds_read_b64 v[162:163], v198 offset:1600
    ds_read_b64 v[164:165], v196 offset:12288
    ds_read_b64 v[166:167], v196 offset:12800
    v_mfma_f32_32x32x16_bf16 v[96:111], a[16:19], v[180:183], v[96:111]
    ds_read_b64 v[168:169], v196 offset:12544
    ds_read_b64 v[170:171], v196 offset:13056
    buffer_load_dwordx4 v76, s[16:19], s99 offen offset:3072 sc1 lds
    s_waitcnt lgkmcnt(6)
    v_mfma_f32_16x16x32_bf16 v[112:115], a[20:23], v[184:187], v[112:115]
    ds_read_b64 v[172:173], v198 offset:1792
    v_mfma_f32_32x32x16_bf16 v[80:95], a[20:23], v[188:191], v[80:95]
    ds_read_b64 v[174:175], v198 offset:1856
    ds_read_b64 v[176:177], v196 offset:14336
    ds_read_b64 v[178:179], v196 offset:14848
    v_mfma_f32_32x32x16_bf16 v[96:111], a[20:23], v[192:195], v[96:111]
    ds_read_b64 v[180:181], v196 offset:14592
    ds_read_b64 v[182:183], v196 offset:15104
    s_add_u32 m0, s93, 112512
    s_add_u32 s99, s99, 524288
    s_mov_b64 exec, s[80:81]
    buffer_load_dwordx4 v77, s[16:19], s100 offen sc1 lds
    s_mov_b64 exec, -1
    s_add_u32 s100, s100, 524288
    s_waitcnt vmcnt(6)
    v_cmp_eq_u32 vcc, 19, v5
    s_nop 0
    s_cbranch_vccnz gl_52
gc_53:
    s_barrier
    s_waitcnt lgkmcnt(6)
    v_mfma_f32_16x16x32_bf16 v[112:115], a[24:27], v[160:163], v[112:115]
    v_add_u32 v198, v49, v198
    v_mfma_f32_32x32x16_bf16 v[80:95], a[24:27], v[164:167], v[80:95]
    v_add_u32 v196, 19584, v196
    ds_read_b64 v[184:185], v198 offset:0
    ds_read_b64 v[186:187], v198 offset:64
    ds_read_b64 v[188:189], v196 offset:0
    v_mfma_f32_32x32x16_bf16 v[96:111], a[24:27], v[168:171], v[96:111]
    ds_read_b64 v[190:191], v196 offset:512
    ds_read_b64 v[192:193], v196 offset:256
    ds_read_b64 v[194:195], v196 offset:768
    s_add_u32 m0, s92, 114688
    s_nop 0
    buffer_load_dwordx4 v73, s[16:19], s99 offen offset:0 sc1 lds
    s_waitcnt lgkmcnt(6)
    v_mfma_f32_16x16x32_bf16 v[112:115], a[28:31], v[172:175], v[112:115]
    ds_read_b64 v[160:161], v198 offset:256
    v_mfma_f32_32x32x16_bf16 v[80:95], a[28:31], v[176:179], v[80:95]
    ds_read_b64 v[162:163], v198 offset:320
    ds_read_b64 v[164:165], v196 offset:2048
    ds_read_b64 v[166:167], v196 offset:2560
    v_mfma_f32_32x32x16_bf16 v[96:111], a[28:31], v[180:183], v[96:111]
    ds_read_b64 v[168:169], v196 offset:2304
    ds_read_b64 v[170:171], v196 offset:2816
    buffer_load_dwordx4 v74, s[16:19], s99 offen offset:1024 sc1 lds
    s_waitcnt lgkmcnt(6)
    v_mfma_f32_16x16x32_bf16 v[112:115], a[32:35], v[184:187], v[112:115]
    ds_read_b64 v[172:173], v198 offset:512
    v_mfma_f32_32x32x16_bf16 v[80:95], a[32:35], v[188:191], v[80:95]
    ds_read_b64 v[174:175], v198 offset:576
    ds_read_b64 v[176:177], v196 offset:4096
    ds_read_b64 v[178:179], v196 offset:4608
    v_mfma_f32_32x32x16_bf16 v[96:111], a[32:35], v[192:195], v[96:111]
    ds_read_b64 v[180:181], v196 offset:4352
    ds_read_b64 v[182:183], v196 offset:4864
    buffer_load_dwordx4 v75, s[16:19], s99 offen offset:2048 sc1 lds
    s_waitcnt lgkmcnt(6)
    v_mfma_f32_16x16x32_bf16 v[112:115], a[36:39], v[160:163], v[112:115]
    ds_read_b64 v[184:185], v198 offset:768
    v_mfma_f32_32x32x16_bf16 v[80:95], a[36:39], v[164:167], v[80:95]
    ds_read_b64 v[186:187], v198 offset:832
    ds_read_b64 v[188:189], v196 offset:6144
    ds_read_b64 v[190:191], v196 offset:6656
    v_mfma_f32_32x32x16_bf16 v[96:111], a[36:39], v[168:171], v[96:111]
    ds_read_b64 v[192:193], v196 offset:6400
    ds_read_b64 v[194:195], v196 offset:6912
    buffer_load_dwordx4 v76, s[16:19], s99 offen offset:3072 sc1 lds
    s_waitcnt lgkmcnt(6)
    v_mfma_f32_16x16x32_bf16 v[112:115], a[40:43], v[172:175], v[112:115]
    ds_read_b64 v[160:161], v198 offset:1024
    v_mfma_f32_32x32x16_bf16 v[80:95], a[40:43], v[176:179], v[80:95]
    ds_read_b64 v[162:163], v198 offset:1088
    ds_read_b64 v[164:165], v196 offset:8192
    ds_read_b64 v[166:167], v196 offset:8704
    v_mfma_f32_32x32x16_bf16 v[96:111], a[40:43], v[180:183], v[96:111]
    ds_read_b64 v[168:169], v196 offset:8448
    ds_read_b64 v[170:171], v196 offset:8960
    s_add_u32 m0, s93, 132096
    s_add_u32 s99, s99, 524288
    s_mov_b64 exec, s[80:81]
    buffer_load_dwordx4 v77, s[16:19], s100 offen sc1 lds
    s_mov_b64 exec, -1
    s_add_u32 s100, s100, 524288
    s_waitcnt lgkmcnt(6)
    v_mfma_f32_16x16x32_bf16 v[112:115], a[44:47], v[184:187], v[112:115]
    ds_read_b64 v[172:173], v198 offset:1280
    v_mfma_f32_32x32x16_bf16 v[80:95], a[44:47], v[188:191], v[80:95]
    ds_read_b64 v[174:175], v198 offset:1344
    ds_read_b64 v[176:177], v196 offset:10240
    ds_read_b64 v[178:179], v196 offset:10752
    v_mfma_f32_32x32x16_bf16 v[96:111], a[44:47], v[192:195], v[96:111]
    ds_read_b64 v[180:181], v196 offset:10496
    ds_read_b64 v[182:183], v196 offset:11008
    s_lshl_b32 s25, s72, 5
    s_add_u32 s25, s25, 256
    s_sub_u32 s26, s25, 4
    s_max_i32 s26, s26, 0
    s_lshl_b32 s27, s71, 12
    s_add_u32 s27, s27, 9437184
    s_lshl_b32 s99, s25, 3
    s_lshl_b32 s100, s26, 3
    s_lshl_b32 s92, s24, 12
    s_lshl_b32 s93, s24, 9
    s_add_u32 s99, s99, s27
    s_add_u32 s100, s100, s27
    s_waitcnt lgkmcnt(6)
    v_mfma_f32_16x16x32_bf16 v[112:115], a[48:51], v[160:163], v[112:115]
    ds_read_b64 v[184:185], v198 offset:1536
    v_mfma_f32_32x32x16_bf16 v[80:95], a[48:51], v[164:167], v[80:95]
    ds_read_b64 v[186:187], v198 offset:1600
    ds_read_b64 v[188:189], v196 offset:12288
    ds_read_b64 v[190:191], v196 offset:12800
    v_mfma_f32_32x32x16_bf16 v[96:111], a[48:51], v[168:171], v[96:111]
    ds_read_b64 v[192:193], v196 offset:12544
    ds_read_b64 v[194:195], v196 offset:13056
    s_waitcnt lgkmcnt(6)
    v_mfma_f32_16x16x32_bf16 v[112:115], a[52:55], v[172:175], v[112:115]
    ds_read_b64 v[160:161], v198 offset:1792
    v_mfma_f32_32x32x16_bf16 v[80:95], a[52:55], v[176:179], v[80:95]
    ds_read_b64 v[162:163], v198 offset:1856
    ds_read_b64 v[164:165], v196 offset:14336
    ds_read_b64 v[166:167], v196 offset:14848
    v_mfma_f32_32x32x16_bf16 v[96:111], a[52:55], v[180:183], v[96:111]
    ds_read_b64 v[168:169], v196 offset:14592
    ds_read_b64 v[170:171], v196 offset:15104
    s_waitcnt vmcnt(10)
    v_cmp_gt_u32 vcc, 1, v7
    s_nop 0
    s_and_b64 vcc, vcc, s[50:51]
    s_cbranch_scc1 ps_54
pc_56:
    s_barrier
    s_waitcnt lgkmcnt(6)
    v_mfma_f32_16x16x32_bf16 v[112:115], a[56:59], v[184:187], v[112:115]
    v_add_u32 v198, v49, v198
    v_mfma_f32_32x32x16_bf16 v[80:95], a[56:59], v[188:191], v[80:95]
    v_add_u32 v196, 19584, v196
    ds_read_b64 v[172:173], v198 offset:0
    ds_read_b64 v[174:175], v198 offset:64
    ds_read_b64 v[176:177], v196 offset:0
    v_mfma_f32_32x32x16_bf16 v[96:111], a[56:59], v[192:195], v[96:111]
    ds_read_b64 v[178:179], v196 offset:512
    ds_read_b64 v[180:181], v196 offset:256
    ds_read_b64 v[182:183], v196 offset:768
    s_waitcnt lgkmcnt(6)
    v_mfma_f32_16x16x32_bf16 v[112:115], a[60:63], v[160:163], v[112:115]
    ds_read_b64 v[184:185], v198 offset:256
    v_mfma_f32_32x32x16_bf16 v[80:95], a[60:63], v[164:167], v[80:95]
    ds_read_b64 v[186:187], v198 offset:320
    ds_read_b64 v[188:189], v196 offset:2048
    ds_read_b64 v[190:191], v196 offset:2560
    v_mfma_f32_32x32x16_bf16 v[96:111], a[60:63], v[168:171], v[96:111]
    ds_read_b64 v[192:193], v196 offset:2304
    ds_read_b64 v[194:195], v196 offset:2816
    s_waitcnt lgkmcnt(6)
    v_mfma_f32_16x16x32_bf16 v[112:115], a[64:67], v[172:175], v[112:115]
    ds_read_b64 v[160:161], v198 offset:512
    v_mfma_f32_32x32x16_bf16 v[80:95], a[64:67], v[176:179], v[80:95]
    ds_read_b64 v[162:163], v198 offset:576
    ds_read_b64 v[164:165], v196 offset:4096
    ds_read_b64 v[166:167], v196 offset:4608
    v_mfma_f32_32x32x16_bf16 v[96:111], a[64:67], v[180:183], v[96:111]
    ds_read_b64 v[168:169], v196 offset:4352
    ds_read_b64 v[170:171], v196 offset:4864
    s_waitcnt lgkmcnt(6)
    v_mfma_f32_16x16x32_bf16 v[112:115], a[68:71], v[184:187], v[112:115]
    ds_read_b64 v[172:173], v198 offset:768
    v_mfma_f32_32x32x16_bf16 v[80:95], a[68:71], v[188:191], v[80:95]
    ds_read_b64 v[174:175], v198 offset:832
    ds_read_b64 v[176:177], v196 offset:6144
    ds_read_b64 v[178:179], v196 offset:6656
    v_mfma_f32_32x32x16_bf16 v[96:111], a[68:71], v[192:195], v[96:111]
    ds_read_b64 v[180:181], v196 offset:6400
    ds_read_b64 v[182:183], v196 offset:6912
    s_waitcnt lgkmcnt(6)
    v_mfma_f32_16x16x32_bf16 v[112:115], a[72:75], v[160:163], v[112:115]
    ds_read_b64 v[184:185], v198 offset:1024
    v_mfma_f32_32x32x16_bf16 v[80:95], a[72:75], v[164:167], v[80:95]
    ds_read_b64 v[186:187], v198 offset:1088
    ds_read_b64 v[188:189], v196 offset:8192
    ds_read_b64 v[190:191], v196 offset:8704
    v_mfma_f32_32x32x16_bf16 v[96:111], a[72:75], v[168:171], v[96:111]
    ds_read_b64 v[192:193], v196 offset:8448
    ds_read_b64 v[194:195], v196 offset:8960
    s_waitcnt lgkmcnt(6)
    v_mfma_f32_16x16x32_bf16 v[112:115], a[76:79], v[172:175], v[112:115]
    ds_read_b64 v[160:161], v198 offset:1280
    v_mfma_f32_32x32x16_bf16 v[80:95], a[76:79], v[176:179], v[80:95]
    ds_read_b64 v[162:163], v198 offset:1344
    ds_read_b64 v[164:165], v196 offset:10240
    ds_read_b64 v[166:167], v196 offset:10752
    v_mfma_f32_32x32x16_bf16 v[96:111], a[76:79], v[180:183], v[96:111]
    ds_read_b64 v[168:169], v196 offset:10496
    ds_read_b64 v[170:171], v196 offset:11008
    s_waitcnt lgkmcnt(6)
    v_mfma_f32_16x16x32_bf16 v[112:115], a[80:83], v[184:187], v[112:115]
    ds_read_b64 v[172:173], v198 offset:1536
    v_mfma_f32_32x32x16_bf16 v[80:95], a[80:83], v[188:191], v[80:95]
    ds_read_b64 v[174:175], v198 offset:1600
    ds_read_b64 v[176:177], v196 offset:12288
    ds_read_b64 v[178:179], v196 offset:12800
    v_mfma_f32_32x32x16_bf16 v[96:111], a[80:83], v[192:195], v[96:111]
    ds_read_b64 v[180:181], v196 offset:12544
    ds_read_b64 v[182:183], v196 offset:13056
    s_lshl_b32 s98, s72, 5
    s_add_u32 s98, s98, 0
    s_sub_u32 s95, s98, 4
    s_max_i32 s95, s95, 0
    s_lshl_b32 s94, s98, 3
    s_lshl_b32 s95, s95, 3
    s_add_u32 s94, s94, 3457024
    s_add_u32 s95, s95, 3457024
    s_add_u32 s96, s94, 8192
    buffer_load_dwordx2 v[152:153], v47, s[16:19], s94 offen sc1
    s_waitcnt lgkmcnt(6)
    v_mfma_f32_16x16x32_bf16 v[112:115], a[84:87], v[160:163], v[112:115]
    ds_read_b64 v[184:185], v198 offset:1792
    v_mfma_f32_32x32x16_bf16 v[80:95], a[84:87], v[164:167], v[80:95]
    ds_read_b64 v[186:187], v198 offset:1856
    ds_read_b64 v[188:189], v196 offset:14336
    ds_read_b64 v[190:191], v196 offset:14848
    v_mfma_f32_32x32x16_bf16 v[96:111], a[84:87], v[168:171], v[96:111]
    ds_read_b64 v[192:193], v196 offset:14592
    ds_read_b64 v[194:195], v196 offset:15104
    buffer_load_dwordx2 v[154:155], v47, s[16:19], s96 offen sc1
    s_waitcnt vmcnt(7)
    s_barrier
    s_waitcnt lgkmcnt(6)
    v_mfma_f32_16x16x32_bf16 v[112:115], a[88:91], v[172:175], v[112:115]
    v_add_u32_e64 v198, v49, v198
    v_mfma_f32_32x32x16_bf16 v[80:95], a[88:91], v[176:179], v[80:95]
    v_add_u32 v196, 19584, v196
    ds_read_b64 v[160:161], v198 offset:0
    ds_read_b64 v[162:163], v198 offset:64
    ds_read_b64 v[164:165], v196 offset:0
    v_mfma_f32_32x32x16_bf16 v[96:111], a[88:91], v[180:183], v[96:111]
    ds_read_b64 v[166:167], v196 offset:512
    ds_read_b64 v[168:169], v196 offset:256
    ds_read_b64 v[170:171], v196 offset:768
    buffer_load_dwordx2 v[156:157], v48, s[16:19], s95 offen sc1
    s_waitcnt lgkmcnt(6)
    v_mfma_f32_16x16x32_bf16 v[112:115], a[92:95], v[184:187], v[112:115]
    ds_read_b64 v[172:173], v198 offset:256
    v_mfma_f32_32x32x16_bf16 v[80:95], a[92:95], v[188:191], v[80:95]
    ds_read_b64 v[174:175], v198 offset:320
    ds_read_b64 v[176:177], v196 offset:2048
    ds_read_b64 v[178:179], v196 offset:2560
    v_mfma_f32_32x32x16_bf16 v[96:111], a[92:95], v[192:195], v[96:111]
    ds_read_b64 v[180:181], v196 offset:2304
    ds_read_b64 v[182:183], v196 offset:2816
    buffer_load_dword v7, v4, s[16:19], s89 offen offset:4 sc1
    s_waitcnt lgkmcnt(6)
    v_mfma_f32_16x16x32_bf16 v[112:115], a[96:99], v[160:163], v[112:115]
    ds_read_b64 v[184:185], v198 offset:512
    v_mfma_f32_32x32x16_bf16 v[80:95], a[96:99], v[164:167], v[80:95]
    ds_read_b64 v[186:187], v198 offset:576
    ds_read_b64 v[188:189], v196 offset:4096
    ds_read_b64 v[190:191], v196 offset:4608
    v_mfma_f32_32x32x16_bf16 v[96:111], a[96:99], v[168:171], v[96:111]
    ds_read_b64 v[192:193], v196 offset:4352
    ds_read_b64 v[194:195], v196 offset:4864
    s_waitcnt lgkmcnt(6)
    v_mfma_f32_16x16x32_bf16 v[112:115], a[100:103], v[172:175], v[112:115]
    ds_read_b64 v[160:161], v198 offset:768
    v_mfma_f32_32x32x16_bf16 v[80:95], a[100:103], v[176:179], v[80:95]
    ds_read_b64 v[162:163], v198 offset:832
    ds_read_b64 v[164:165], v196 offset:6144
    ds_read_b64 v[166:167], v196 offset:6656
    v_mfma_f32_32x32x16_bf16 v[96:111], a[100:103], v[180:183], v[96:111]
    ds_read_b64 v[168:169], v196 offset:6400
    ds_read_b64 v[170:171], v196 offset:6912
    s_waitcnt lgkmcnt(6)
    v_mfma_f32_16x16x32_bf16 v[112:115], a[104:107], v[184:187], v[112:115]
    ds_read_b64 v[172:173], v198 offset:1024
    v_mfma_f32_32x32x16_bf16 v[80:95], a[104:107], v[188:191], v[80:95]
    ds_read_b64 v[174:175], v198 offset:1088
    ds_read_b64 v[176:177], v196 offset:8192
    ds_read_b64 v[178:179], v196 offset:8704
    v_mfma_f32_32x32x16_bf16 v[96:111], a[104:107], v[192:195], v[96:111]
    ds_read_b64 v[180:181], v196 offset:8448
    ds_read_b64 v[182:183], v196 offset:8960
    s_waitcnt lgkmcnt(6)
    v_mfma_f32_16x16x32_bf16 v[112:115], a[108:111], v[160:163], v[112:115]
    ds_read_b64 v[184:185], v198 offset:1280
    v_mfma_f32_32x32x16_bf16 v[80:95], a[108:111], v[164:167], v[80:95]
    ds_read_b64 v[186:187], v198 offset:1344
    ds_read_b64 v[188:189], v196 offset:10240
    ds_read_b64 v[190:191], v196 offset:10752
    v_mfma_f32_32x32x16_bf16 v[96:111], a[108:111], v[168:171], v[96:111]
    ds_read_b64 v[192:193], v196 offset:10496
    ds_read_b64 v[194:195], v196 offset:11008
    s_waitcnt lgkmcnt(6)
    v_mfma_f32_16x16x32_bf16 v[112:115], a[112:115], v[172:175], v[112:115]
    ds_read_b64 v[160:161], v198 offset:1536
    v_mfma_f32_32x32x16_bf16 v[80:95], a[112:115], v[176:179], v[80:95]
    ds_read_b64 v[162:163], v198 offset:1600
    ds_read_b64 v[164:165], v196 offset:12288
    ds_read_b64 v[166:167], v196 offset:12800
    v_mfma_f32_32x32x16_bf16 v[96:111], a[112:115], v[180:183], v[96:111]
    ds_read_b64 v[168:169], v196 offset:12544
    ds_read_b64 v[170:171], v196 offset:13056
    s_waitcnt lgkmcnt(6)
    v_mfma_f32_16x16x32_bf16 v[112:115], a[116:119], v[184:187], v[112:115]
    ds_read_b64 v[172:173], v198 offset:1792
    v_mfma_f32_32x32x16_bf16 v[80:95], a[116:119], v[188:191], v[80:95]
    ds_read_b64 v[174:175], v198 offset:1856
    ds_read_b64 v[176:177], v196 offset:14336
    ds_read_b64 v[178:179], v196 offset:14848
    v_mfma_f32_32x32x16_bf16 v[96:111], a[116:119], v[192:195], v[96:111]
    ds_read_b64 v[180:181], v196 offset:14592
    ds_read_b64 v[182:183], v196 offset:15104
sl_57:
    s_waitcnt vmcnt(2)
    v_max3_u32 v2, v152, v153, v154
    s_waitcnt vmcnt(1)
    v_max3_u32 v2, v2, v155, v156
    v_max_u32 v2, v2, v157
    v_cmp_eq_u32 vcc, -1, v2
    s_nop 0
    s_cbranch_vccnz rd_58
rc_59:
    s_waitcnt vmcnt(0)
    v_cmp_gt_u32 vcc, 1, v7
    s_nop 0
    s_and_b64 vcc, vcc, s[50:51]
    s_cbranch_scc1 ps_60
pc_62:
    s_barrier
    s_waitcnt lgkmcnt(6)
    v_mfma_f32_16x16x32_bf16 v[112:115], a[120:123], v[160:163], v[112:115]
    v_add_u32_e64 v198, v49, v198
    v_mfma_f32_32x32x16_bf16 v[80:95], a[120:123], v[164:167], v[80:95]
    v_add_u32 v196, 19584, v196
    ds_read_b64 v[184:185], v198 offset:0
    ds_read_b64 v[186:187], v198 offset:64
    v_mul_f32 v148, v24, v157
    v_mul_f32 v149, v25, v157
    v_mfma_f32_32x32x16_bf16 v[96:111], a[120:123], v[168:171], v[96:111]
    ds_read_b64 v[188:189], v196 offset:0
    ds_read_b64 v[190:191], v196 offset:512
    s_sub_u32 s3, s2, 160
    s_and_b32 s3, s3, 63
    s_add_u32 s3, s3, 64
    s_and_b32 s25, s3, 3
    s_lshl_b32 s25, s25, 12
    s_lshr_b32 s26, s3, 2
    s_lshl_b32 s26, s26, 7
    s_add_u32 s3, s25, s26
    v_lshrrev_b32 v236, 3, v0
    v_and_b32 v237, 7, v0
    v_lshlrev_b32 v237, 4, v237
    v_lshl_add_u32 v236, v236, 14, v237
    s_sub_u32 s25, s2, 160
    s_cmp_lt_u32 s25, 64
    s_cselect_b32 s25, 0, 1073741824
    v_add_u32_e64 v236, s25, v236
    s_add_u32 s26, s3, 9437184
    buffer_load_dwordx4 v[216:219], v236, s[16:19], s26 offen sc1
    v_mul_f32 v150, v26, v157
    v_mul_f32_e64 v151, v27, v157
    s_waitcnt lgkmcnt(4)
    v_mfma_f32_16x16x32_bf16 v[112:115], a[124:127], v[172:175], v[112:115]
    ds_read_b64 v[192:193], v198 offset:256
    v_mfma_f32_32x32x16_bf16 v[80:95], a[124:127], v[176:179], v[80:95]
    ds_read_b64 v[194:195], v198 offset:320
    ds_read_b64 v[160:161], v196 offset:2048
    v_mul_f32 v116, v8, v153
    v_mul_f32 v117, v9, v153
    v_mul_f32_e64 v118, v10, v153
    v_mfma_f32_32x32x16_bf16 v[96:111], a[124:127], v[180:183], v[96:111]
    ds_read_b64 v[162:163], v196 offset:2560
    s_add_u32 s26, s26, 524288
    buffer_load_dwordx4 v[220:223], v236, s[16:19], s26 offen sc1
    v_mul_f32 v119, v11, v153
    v_mul_f32_e64 v120, v12, v153
    s_waitcnt lgkmcnt(4)
    v_mfma_f32_16x16x32_bf16 v[112:115], a[128:131], v[184:187], v[112:115]
    ds_read_b64 v[164:165], v198 offset:512
    v_mfma_f32_32x32x16_bf16 v[80:95], a[128:131], v[188:191], v[80:95]
    ds_read_b64 v[166:167], v198 offset:576
    ds_read_b64 v[168:169], v196 offset:4096
    ds_read_b64 v[170:171], v196 offset:4608
    v_mul_f32 v121, v13, v153
    v_mul_f32_e64 v122, v14, v153
    s_waitcnt lgkmcnt(4)
    v_mfma_f32_16x16x32_bf16 v[112:115], a[132:135], v[192:195], v[112:115]
    ds_read_b64 v[172:173], v198 offset:768
    v_mfma_f32_32x32x16_bf16 v[80:95], a[132:135], v[160:163], v[80:95]
    ds_read_b64 v[174:175], v198 offset:832
    ds_read_b64 v[176:177], v196 offset:6144
    ds_read_b64 v[178:179], v196 offset:6656
    s_add_u32 s26, s26, 524288
    buffer_load_dwordx4 v[224:227], v236, s[16:19], s26 offen sc1
    v_mul_f32 v123, v15, v153
    v_mul_f32_e64 v124, v16, v153
    s_waitcnt lgkmcnt(4)
    v_mfma_f32_16x16x32_bf16 v[112:115], a[136:139], v[164:167], v[112:115]
    ds_read_b64 v[180:181], v198 offset:1024
    v_mfma_f32_32x32x16_bf16 v[80:95], a[136:139], v[168:171], v[80:95]
    ds_read_b64 v[182:183], v198 offset:1088
    ds_read_b64 v[184:185], v196 offset:8192
    ds_read_b64 v[186:187], v196 offset:8704
    v_mul_f32 v125, v17, v153
    v_mul_f32_e64 v126, v18, v153
    s_waitcnt lgkmcnt(4)
    v_mfma_f32_16x16x32_bf16 v[112:115], a[140:143], v[172:175], v[112:115]
    ds_read_b64 v[188:189], v198 offset:1280
    v_mfma_f32_32x32x16_bf16 v[80:95], a[140:143], v[176:179], v[80:95]
    ds_read_b64 v[190:191], v198 offset:1344
    ds_read_b64 v[192:193], v196 offset:10240
    ds_read_b64 v[194:195], v196 offset:10752
    s_add_u32 s26, s26, 524288
    buffer_load_dwordx4 v[228:231], v236, s[16:19], s26 offen sc1
    v_mul_f32 v127, v19, v153
    v_mul_f32_e64 v128, v20, v153
    s_waitcnt lgkmcnt(4)
    v_mfma_f32_16x16x32_bf16 v[112:115], a[144:147], v[180:183], v[112:115]
    ds_read_b64 v[160:161], v198 offset:1536
    v_mfma_f32_32x32x16_bf16 v[80:95], a[144:147], v[184:187], v[80:95]
    ds_read_b64 v[162:163], v198 offset:1600
    ds_read_b64 v[164:165], v196 offset:12288
    ds_read_b64 v[166:167], v196 offset:12800
    v_mul_f32 v129, v21, v153
    v_mul_f32_e64 v130, v22, v153
    s_waitcnt lgkmcnt(4)
    v_mfma_f32_16x16x32_bf16 v[112:115], a[148:151], v[188:191], v[112:115]
    ds_read_b64 v[168:169], v198 offset:1792
    v_mfma_f32_32x32x16_bf16 v[80:95], a[148:151], v[192:195], v[80:95]
    ds_read_b64 v[170:171], v198 offset:1856
    ds_read_b64 v[172:173], v196 offset:14336
    ds_read_b64 v[174:175], v196 offset:14848
    s_add_u32 s26, s26, 524288
    buffer_load_dwordx4 v[232:235], v236, s[16:19], s26 offen sc1
    v_mul_f32 v131, v23, v153
    v_mul_f32_e64 v132, v8, v155
    s_waitcnt lgkmcnt(4)
    v_mfma_f32_16x16x32_bf16 v[112:115], a[152:155], v[160:163], v[112:115]
    ds_read_b64 v[176:177], v196 offset:256
    v_mfma_f32_32x32x16_bf16 v[80:95], a[152:155], v[164:167], v[80:95]
    ds_read_b64 v[178:179], v196 offset:768
    ds_read_b64 v[180:181], v196 offset:2304
    ds_read_b64 v[182:183], v196 offset:2816
    v_mul_f32 v133, v9, v155
    v_mul_f32_e64 v134, v10, v155
    s_waitcnt lgkmcnt(4)
    v_mfma_f32_16x16x32_bf16 v[112:115], a[156:159], v[168:171], v[112:115]
    ds_read_b64 v[184:185], v196 offset:4352
    v_mfma_f32_32x32x16_bf16 v[80:95], a[156:159], v[172:175], v[80:95]
    ds_read_b64 v[186:187], v196 offset:4864
    ds_read_b64 v[188:189], v196 offset:6400
    ds_read_b64 v[190:191], v196 offset:6912
    s_add_u32 m0, s92, 36352
    s_nop 0
    buffer_load_dwordx4 v73, s[16:19], s99 offen offset:0 sc1 lds
    v_mul_f32 v135, v11, v155
    v_mul_f32 v136, v12, v155
    v_mul_f32 v137, v13, v155
    v_mul_f32 v138, v14, v155
    v_mul_f32 v139, v15, v155
    v_mul_f32 v140, v16, v155
    v_mul_f32 v141, v17, v155
    v_mul_f32 v142, v18, v155
    v_mul_f32 v143, v19, v155
    v_mul_f32 v144, v20, v155
    v_mul_f32 v145, v21, v155
    v_mul_f32 v146, v22, v155
    v_mul_f32_e64 v147, v23, v155
    s_waitcnt lgkmcnt(4)
    v_mfma_f32_32x32x16_bf16 v[96:111], a[128:131], v[176:179], v[96:111]
    ds_read_b64 v[192:193], v196 offset:8448
    ds_read_b64 v[194:195], v196 offset:8960
    v_mfma_f32_32x32x16_bf16 v[96:111], a[132:135], v[180:183], v[96:111]
    ds_read_b64 v[160:161], v196 offset:10496
    ds_read_b64 v[162:163], v196 offset:11008
    buffer_load_dwordx4 v74, s[16:19], s99 offen offset:1024 sc1 lds
    v_fma_f32 v112, v112, v156, v148
    v_fma_f32 v113, v113, v156, v149
    s_waitcnt lgkmcnt(4)
    v_mfma_f32_32x32x16_bf16 v[96:111], a[136:139], v[184:187], v[96:111]
    ds_read_b64 v[164:165], v196 offset:12544
    ds_read_b64 v[166:167], v196 offset:13056
    v_fma_f32 v114, v114, v156, v150
    v_fma_f32 v115, v115, v156, v151
    v_cvt_pk_bf16_f32 v112, v112, v113
    v_mfma_f32_32x32x16_bf16 v[96:111], a[140:143], v[188:191], v[96:111]
    ds_read_b64 v[168:169], v196 offset:14592
    ds_read_b64 v[170:171], v196 offset:15104
    buffer_load_dwordx4 v75, s[16:19], s99 offen offset:2048 sc1 lds
    v_cvt_pk_bf16_f32 v113, v114, v115
    v_fma_f32 v80, v80, v152, v116
    s_waitcnt lgkmcnt(4)
    v_mfma_f32_32x32x16_bf16 v[96:111], a[144:147], v[192:195], v[96:111]
    v_fma_f32 v81, v81, v152, v117
    v_fma_f32 v82, v82, v152, v118
    v_fma_f32 v83, v83, v152, v119
    v_cvt_pk_bf16_f32 v80, v80, v81
    v_cvt_pk_bf16_f32 v81, v82, v83
    v_mfma_f32_32x32x16_bf16 v[96:111], a[148:151], v[160:163], v[96:111]
    ds_write_b64 v40, v[112:113] offset:0
    ds_write_b64 v38, v[80:81] offset:0
    v_fma_f32 v84, v84, v152, v120
    v_fma_f32 v85, v85, v152, v121
    s_waitcnt lgkmcnt(2)
    v_mfma_f32_32x32x16_bf16 v[96:111], a[152:155], v[164:167], v[96:111]
    v_fma_f32 v86, v86, v152, v122
    v_fma_f32 v87, v87, v152, v123
    v_cvt_pk_bf16_f32 v84, v84, v85
    v_cvt_pk_bf16_f32 v85, v86, v87
    v_fma_f32 v88, v88, v152, v124
    v_mfma_f32_32x32x16_bf16 v[96:111], a[156:159], v[168:171], v[96:111]
    buffer_load_dwordx4 v76, s[16:19], s99 offen offset:3072 sc1 lds
    v_fma_f32 v89, v89, v152, v125
    v_fma_f32 v90, v90, v152, v126
    v_fma_f32 v91, v91, v152, v127
    v_cvt_pk_bf16_f32 v88, v88, v89
    v_cvt_pk_bf16_f32 v89, v90, v91
    ds_write_b64 v38, v[84:85] offset:6400
    ds_write_b64 v38, v[88:89] offset:12800
    v_fma_f32 v92, v92, v152, v128
    v_fma_f32 v93, v93, v152, v129
    v_fma_f32 v94, v94, v152, v130
    v_fma_f32 v95, v95, v152, v131
    v_cvt_pk_bf16_f32 v92, v92, v93
    v_cvt_pk_bf16_f32 v93, v94, v95
    ds_write_b64 v39, v[92:93] offset:0
    v_pk_fma_f32 v[96:97], v[96:97], v[154:155], v[132:133] op_sel_hi:[1,0,1]
    v_pk_fma_f32 v[98:99], v[98:99], v[154:155], v[134:135] op_sel_hi:[1,0,1]
    v_cvt_pk_bf16_f32 v96, v96, v97
    v_cvt_pk_bf16_f32 v97, v98, v99
    v_pk_fma_f32 v[100:101], v[100:101], v[154:155], v[136:137] op_sel_hi:[1,0,1]
    v_pk_fma_f32 v[102:103], v[102:103], v[154:155], v[138:139] op_sel_hi:[1,0,1]
    v_cvt_pk_bf16_f32 v100, v100, v101
    v_cvt_pk_bf16_f32 v101, v102, v103
    ds_write_b64 v38, v[96:97] offset:1600
    ds_write_b64 v38, v[100:101] offset:8000
    v_pk_fma_f32 v[104:105], v[104:105], v[154:155], v[140:141] op_sel_hi:[1,0,1]
    v_pk_fma_f32 v[106:107], v[106:107], v[154:155], v[142:143] op_sel_hi:[1,0,1]
    v_cvt_pk_bf16_f32 v104, v104, v105
    v_cvt_pk_bf16_f32 v105, v106, v107
    v_pk_fma_f32 v[108:109], v[108:109], v[154:155], v[144:145] op_sel_hi:[1,0,1]
    v_pk_fma_f32 v[110:111], v[110:111], v[154:155], v[146:147] op_sel_hi:[1,0,1]
    v_cvt_pk_bf16_f32 v108, v108, v109
    v_cvt_pk_bf16_f32 v109, v110, v111
    ds_write_b64 v38, v[104:105] offset:14400
    ds_write_b64 v39, v[108:109] offset:1600
    v_cmp_u_f32 vcc, v82, v114
    v_cmp_u_f32 s[82:83], v98, v98
    s_lshl_b32 s25, s24, 2
    s_add_u32 s25, s25, 160256
    s_or_b64 vcc, vcc, s[82:83]
    s_cselect_b32 s26, 1, 0
    v_mov_b32 v196, s25
    v_mov_b32 v197, s26
    ds_write_b32 v196, v197
    s_waitcnt lgkmcnt(0)
    s_barrier
    s_sub_u32 s85, s2, 160
    s_cmp_ge_u32 s85, 64
    s_cbranch_scc1 s2_63
    v_mov_b32 v238, 0x3f803f80
    s_lshl_b32 s25, s24, 7
    s_add_u32 s25, s25, 134272
    v_lshrrev_b32 v239, 4, v1
    v_lshl_add_u32 v237, v239, 2, v237
    v_add_u32 v237, s25, v237
se_64:
    v_mov_b32 v240, 0
    v_mov_b32 v241, 0
    v_mov_b32 v242, 0
    v_mov_b32 v243, 0
    s_waitcnt vmcnt(8)
    v_dot2c_f32_bf16 v240, v216, v238
    v_dot2c_f32_bf16 v241, v216, v216
    v_dot2c_f32_bf16 v240, v217, v238
    v_dot2c_f32_bf16 v241, v217, v217
    v_dot2c_f32_bf16 v242, v218, v238
    v_dot2c_f32_bf16 v243, v218, v218
    v_dot2c_f32_bf16 v242, v219, v238
    v_dot2c_f32_bf16 v243, v219, v219
    s_waitcnt vmcnt(7)
    v_dot2c_f32_bf16 v240, v220, v238
    v_dot2c_f32_bf16 v241, v220, v220
    v_dot2c_f32_bf16 v240, v221, v238
    v_dot2c_f32_bf16 v241, v221, v221
    v_dot2c_f32_bf16 v242, v222, v238
    v_dot2c_f32_bf16 v243, v222, v222
    v_dot2c_f32_bf16 v242, v223, v238
    v_dot2c_f32_bf16 v243, v223, v223
    s_waitcnt vmcnt(6)
    v_dot2c_f32_bf16 v240, v224, v238
    v_dot2c_f32_bf16 v241, v224, v224
    v_dot2c_f32_bf16 v240, v225, v238
    v_dot2c_f32_bf16 v241, v225, v225
    v_dot2c_f32_bf16 v242, v226, v238
    v_dot2c_f32_bf16 v243, v226, v226
    v_dot2c_f32_bf16 v242, v227, v238
    v_dot2c_f32_bf16 v243, v227, v227
    s_waitcnt vmcnt(5)
    v_dot2c_f32_bf16 v240, v228, v238
    v_dot2c_f32_bf16 v241, v228, v228
    v_dot2c_f32_bf16 v240, v229, v238
    v_dot2c_f32_bf16 v241, v229, v229
    v_dot2c_f32_bf16 v242, v230, v238
    v_dot2c_f32_bf16 v243, v230, v230
    v_dot2c_f32_bf16 v242, v231, v238
    v_dot2c_f32_bf16 v243, v231, v231
    s_waitcnt vmcnt(4)
    v_dot2c_f32_bf16 v240, v232, v238
    v_dot2c_f32_bf16 v241, v232, v232
    v_dot2c_f32_bf16 v240, v233, v238
    v_dot2c_f32_bf16 v241, v233, v233
    v_dot2c_f32_bf16 v242, v234, v238
    v_dot2c_f32_bf16 v243, v234, v234
    v_dot2c_f32_bf16 v242, v235, v238
    v_dot2c_f32_bf16 v243, v235, v235
    s_nop 2
    v_cmp_u_f32 vcc, v241, v243
    s_nop 0
    s_cbranch_vccnz rd_65
rc_66:
    v_permlane32_swap_b32 v240, v242
    v_permlane32_swap_b32 v241, v243
    v_pk_add_f32 v[240:241], v[240:241], v[242:243]
    s_nop 1
    v_permlane16_swap_b32 v240, v241
    v_add_f32_e64 v240, v240, v241
    s_nop 1
    v_add_f32_dpp v240, v240, v240 row_ror:8 row_mask:0xf bank_mask:0xf
    ds_write_b32 v237, v240
    v_and_b32 v236, 15, v0
    v_lshlrev_b32 v236, 3, v236
    v_add_u32 v237, 134272, v236
    v_mov_b32 v239, 1073741824
    v_cmp_gt_u32 vcc, 16, v0
    s_nop 1
    v_cndmask_b32 v236, v239, v236, vcc
    s_add_u32 s25, s3, 3457024
    s_waitcnt lgkmcnt(0)
    s_barrier
    ds_read_b64 v[216:217], v237 offset:0
    ds_read_b64 v[218:219], v237 offset:128
    ds_read_b64 v[220:221], v237 offset:256
    ds_read_b64 v[222:223], v237 offset:384
    s_waitcnt lgkmcnt(2)
    v_pk_add_f32 v[216:217], v[216:217], v[218:219]
    s_waitcnt lgkmcnt(0)
    v_pk_add_f32 v[220:221], v[220:221], v[222:223]
    v_pk_add_f32 v[216:217], v[216:217], v[220:221]
    v_mul_f32 v239, 0x3acccccd, v216
    v_mul_f32 v217, 0x3acccccd, v217
    v_fma_f32 v217, -v239, v239, v217
    v_max_f32 v217, 0, v217
    v_add_f32 v217, 0x3727c5ac, v217
    v_rsq_f32_e64 v216, v217
    s_nop 0
    v_mul_f32 v217, -v239, v216
    buffer_store_dwordx2 v[216:217], v236, s[16:19], s25 offen sc1
s2_63:
    v_mov_b32 v158, 160256
    ds_read_b128 v[128:131], v158
    v_mov_b32 v94, 0
    v_mov_b32 v95, 0
    v_mov_b32 v98, 0
    v_mov_b32 v99, 0
    s_mov_b64 exec, 0xffff
    ds_read_b64 v[94:95], v42 offset:320
    ds_read_b64 v[98:99], v42 offset:640
    s_mov_b64 exec, -1
    s_nop 0
    ds_read_b64 v[92:93], v41 offset:320
    ds_read_b64 v[96:97], v41 offset:640
    ds_read_b64 v[84:85], v41 offset:6720
    ds_read_b64 v[86:87], v42 offset:6720
    ds_read_b64 v[80:81], v41 offset:6400
    ds_read_b64 v[82:83], v42 offset:6400
    ds_read_b64 v[88:89], v41 offset:7040
    ds_read_b64 v[90:91], v42 offset:7040
    ds_read_b64_tr_b16 v[106:107], v44 offset:0
    ds_read_b64_tr_b16 v[100:101], v43 offset:0
    s_add_u32 m0, s93, 53760
    s_add_u32 s99, s99, 524288
    s_mov_b64 exec, s[80:81]
    buffer_load_dwordx4 v77, s[16:19], s100 offen sc1 lds
    s_mov_b64 exec, -1
    s_add_u32 s100, s100, 524288
    ds_read_b64_tr_b16 v[108:109], v44 offset:320
    ds_read_b64_tr_b16 v[102:103], v43 offset:320
    ds_read_b64_tr_b16 v[110:111], v44 offset:640
    ds_read_b64_tr_b16 v[104:105], v43 offset:640
    v_mov_b32 v156, 0xf149f2ca
    v_cndmask_b32 v152, v32, v156, s[90:91]
    v_cndmask_b32 v153, v33, v156, s[90:91]
    v_cndmask_b32 v154, v34, v156, s[90:91]
    s_add_u32 m0, s92, 55936
    s_nop 0
    buffer_load_dwordx4 v73, s[16:19], s99 offen offset:0 sc1 lds
    v_cndmask_b32 v155, v35, v156, s[90:91]
    s_mov_b32 s82, 0x3ea52b5c
    s_lshl_b32 s25, s98, 4
    s_add_u32 s25, s25, 12058624
    s_lshl_b32 s26, s98, 3
    s_add_u32 s26, s26, 12058624
    s_waitcnt lgkmcnt(15)
    v_or3_b32 v128, v128, v129, v130
    v_or_b32 v128, v128, v131
    buffer_load_dwordx4 v74, s[16:19], s99 offen offset:1024 sc1 lds
    v_cmp_ne_u32_e64 vcc, 0, v128
    s_nop 0
    s_cbranch_vccnz rd_67
rc_68:
    s_waitcnt lgkmcnt(10)
    v_mfma_f32_16x16x32_bf16 v[116:119], v[84:87], v[92:95], v[28:31]
    v_mfma_f32_16x16x32_bf16 v[120:123], v[84:87], v[96:99], v[32:35]
    s_waitcnt lgkmcnt(8)
    v_mfma_f32_16x16x32_bf16 v[112:115], v[80:83], v[92:95], v[152:155]
    s_waitcnt lgkmcnt(6)
    v_mfma_f32_16x16x32_bf16 v[124:127], v[88:91], v[96:99], v[28:31]
    s_nop 5
    v_max_f32 v112, v112, v116
    v_max_f32 v113, v113, v117
    v_max_f32 v114, v114, v118
    buffer_load_dwordx4 v75, s[16:19], s99 offen offset:2048 sc1 lds
    v_max_f32 v115, v115, v119
    v_max3_f32 v156, v112, v113, v114
    v_max_f32 v156, v156, v115
    v_max_f32 v120, v120, v124
    v_max_f32 v121, v121, v125
    v_max_f32 v122, v122, v126
    v_max_f32 v123, v123, v127
    v_max3_f32 v157, v120, v121, v122
    buffer_load_dwordx4 v76, s[16:19], s99 offen offset:3072 sc1 lds
    v_max_f32 v157, v157, v123
    s_nop 1
    v_permlane16_swap_b32 v156, v157
    v_max_f32 v156, v156, v157
    v_mov_b32 v157, v156
    s_nop 1
    v_permlane32_swap_b32 v156, v157
    v_max_f32 v156, v156, v157
    v_mul_f32 v156, s82, v156
    v_mov_b32 v157, v156
    s_add_u32 m0, s93, 73344
    s_add_u32 s99, s99, 524288
    s_mov_b64 exec, s[80:81]
    buffer_load_dwordx4 v77, s[16:19], s100 offen sc1 lds
    s_mov_b64 exec, -1
    s_add_u32 s100, s100, 524288
    v_permlane16_swap_b32_e64 v156, v157
    v_fma_f32 v112, v112, s82, -v156
    v_fma_f32 v113, v113, s82, -v156
    v_fma_f32 v114, v114, s82, -v156
    v_fma_f32 v115, v115, s82, -v156
    v_exp_f32 v112, v112
    v_exp_f32 v113, v113
    v_exp_f32 v114, v114
    s_add_u32 m0, s92, 75520
    s_nop 0
    buffer_load_dwordx4 v73, s[16:19], s99 offen offset:0 sc1 lds
    v_exp_f32_e64 v115, v115
    v_cvt_pk_bf16_f32 v116, v112, v113
    v_cvt_pk_bf16_f32 v117, v114, v115
    v_bfi_b32 v128, v36, 0, v116
    v_and_b32 v130, v36, v116
    v_bfi_b32 v129, v37, 0, v117
    v_and_b32 v131, v37, v117
    s_waitcnt lgkmcnt(3)
    s_nop 0
    v_mfma_f32_16x16x32_bf16 v[144:147], v[106:109], v[128:131], 0
    buffer_load_dwordx4 v74, s[16:19], s99 offen offset:1024 sc1 lds
    s_waitcnt lgkmcnt(2)
    v_mfma_f32_16x16x32_bf16 v[136:139], v[100:103], v[128:131], 0
    v_fma_f32 v120, v120, s82, -v157
    v_fma_f32 v121, v121, s82, -v157
    v_fma_f32 v122, v122, s82, -v157
    v_fma_f32 v123, v123, s82, -v157
    v_exp_f32 v120, v120
    v_exp_f32 v121, v121
    v_exp_f32 v122, v122
    buffer_load_dwordx4 v75, s[16:19], s99 offen offset:2048 sc1 lds
    v_exp_f32_e64 v123, v123
    v_cvt_pk_bf16_f32 v124, v120, v121
    v_cvt_pk_bf16_f32 v125, v122, v123
    v_bfi_b32 v132, v36, 0, v124
    v_and_b32 v134, v36, v124
    v_bfi_b32 v133, v37, 0, v125
    v_and_b32 v135, v37, v125
    s_waitcnt lgkmcnt(1)
    s_nop 0
    v_mfma_f32_16x16x32_bf16 v[148:151], v[108:111], v[132:135], 0
    buffer_load_dwordx4 v76, s[16:19], s99 offen offset:3072 sc1 lds
    s_waitcnt lgkmcnt(0)
    v_mfma_f32_16x16x32_bf16 v[140:143], v[102:105], v[132:135], 0
    v_mov_b32 v158, v144
    s_nop 1
    v_permlane16_swap_b32 v144, v158
    v_rcp_f32 v158, v158
    s_nop 0
    v_pk_mul_f32 v[136:137], v[136:137], v[158:159] op_sel_hi:[1,0]
    v_pk_mul_f32 v[138:139], v[138:139], v[158:159] op_sel_hi:[1,0]
    v_pk_mul_f32 v[144:145], v[144:145], v[158:159] op_sel_hi:[1,0]
    v_pk_mul_f32 v[146:147], v[146:147], v[158:159] op_sel_hi:[1,0]
    s_add_u32 m0, s93, 92928
    s_add_u32 s99, s99, 524288
    s_mov_b64 exec, s[80:81]
    buffer_load_dwordx4 v77, s[16:19], s100 offen sc1 lds
    s_mov_b64 exec, -1
    s_add_u32 s100, s100, 524288
    v_cvt_pk_bf16_f32 v112, v136, v137
    v_cvt_pk_bf16_f32 v116, v144, v145
    v_cvt_pk_bf16_f32 v113, v138, v139
    v_cvt_pk_bf16_f32 v117, v146, v147
    v_mov_b32 v160, v148
    s_nop 1
    v_permlane16_swap_b32 v148, v160
    v_rcp_f32_e64 v160, v160
    s_nop 0
    v_pk_mul_f32 v[140:141], v[140:141], v[160:161] op_sel_hi:[1,0]
    v_pk_mul_f32 v[142:143], v[142:143], v[160:161] op_sel_hi:[1,0]
    v_pk_mul_f32 v[148:149], v[148:149], v[160:161] op_sel_hi:[1,0]
    v_pk_mul_f32 v[150:151], v[150:151], v[160:161] op_sel_hi:[1,0]
    v_cvt_pk_bf16_f32 v114, v140, v141
    v_cvt_pk_bf16_f32 v118, v148, v149
    v_cvt_pk_bf16_f32 v115, v142, v143
    v_cvt_pk_bf16_f32 v119, v150, v151
    v_permlane16_swap_b32 v112, v114
    v_permlane16_swap_b32 v113, v115
    v_permlane16_swap_b32 v116, v118
    v_permlane16_swap_b32 v117, v119
    buffer_store_dwordx4 v[112:115], v45, s[16:19], s25 offen sc1
    s_mov_b64 exec, s[80:81]
    buffer_store_dwordx2 v[116:117], v46, s[16:19], s26 offen sc1
    s_mov_b64 exec, -1
ge_69:
    v_add_u32 v196, 36352, v78
    v_mov_b32_e64 v198, v79
    s_waitcnt vmcnt(12)
    s_barrier
    ds_read_b64 v[160:161], v198 offset:0
    ds_read_b64 v[162:163], v198 offset:64
    ds_read_b64 v[164:165], v196 offset:0
    ds_read_b64 v[166:167], v196 offset:512
    ds_read_b64 v[168:169], v196 offset:256
    ds_read_b64 v[170:171], v196 offset:768
    ds_read_b64 v[172:173], v198 offset:256
    ds_read_b64 v[174:175], v198 offset:320
    ds_read_b64 v[176:177], v196 offset:2048
    ds_read_b64 v[178:179], v196 offset:2560
    ds_read_b64 v[180:181], v196 offset:2304
    ds_read_b64 v[182:183], v196 offset:2816
    s_waitcnt lgkmcnt(6)
    v_mfma_f32_16x16x32_bf16 v[112:115], a[0:3], v[160:163], 0
    ds_read_b64 v[184:185], v198 offset:512
    v_mfma_f32_32x32x16_bf16 v[80:95], a[0:3], v[164:167], 0
    ds_read_b64 v[186:187], v198 offset:576
    ds_read_b64 v[188:189], v196 offset:4096
    ds_read_b64 v[190:191], v196 offset:4608
    v_mfma_f32_32x32x16_bf16 v[96:111], a[0:3], v[168:171], 0
    ds_read_b64 v[192:193], v196 offset:4352
    ds_read_b64 v[194:195], v196 offset:4864
    s_add_u32 m0, s92, 95104
    s_nop 0
    buffer_load_dwordx4 v73, s[16:19], s99 offen offset:0 sc1 lds
    s_waitcnt lgkmcnt(6)
    v_mfma_f32_16x16x32_bf16 v[112:115], a[4:7], v[172:175], v[112:115]
    ds_read_b64 v[160:161], v198 offset:768
    v_mfma_f32_32x32x16_bf16 v[80:95], a[4:7], v[176:179], v[80:95]
    ds_read_b64 v[162:163], v198 offset:832
    ds_read_b64 v[164:165], v196 offset:6144
    ds_read_b64 v[166:167], v196 offset:6656
    v_mfma_f32_32x32x16_bf16 v[96:111], a[4:7], v[180:183], v[96:111]
    ds_read_b64 v[168:169], v196 offset:6400
    ds_read_b64 v[170:171], v196 offset:6912
    buffer_load_dwordx4 v74, s[16:19], s99 offen offset:1024 sc1 lds
    s_waitcnt lgkmcnt(6)
    v_mfma_f32_16x16x32_bf16 v[112:115], a[8:11], v[184:187], v[112:115]
    ds_read_b64 v[172:173], v198 offset:1024
    v_mfma_f32_32x32x16_bf16 v[80:95], a[8:11], v[188:191], v[80:95]
    ds_read_b64 v[174:175], v198 offset:1088
    ds_read_b64 v[176:177], v196 offset:8192
    ds_read_b64 v[178:179], v196 offset:8704
    v_mfma_f32_32x32x16_bf16 v[96:111], a[8:11], v[192:195], v[96:111]
    ds_read_b64 v[180:181], v196 offset:8448
    ds_read_b64 v[182:183], v196 offset:8960
    buffer_load_dwordx4 v75, s[16:19], s99 offen offset:2048 sc1 lds
    s_waitcnt lgkmcnt(6)
    v_mfma_f32_16x16x32_bf16 v[112:115], a[12:15], v[160:163], v[112:115]
    ds_read_b64 v[184:185], v198 offset:1280
    v_mfma_f32_32x32x16_bf16 v[80:95], a[12:15], v[164:167], v[80:95]
    ds_read_b64 v[186:187], v198 offset:1344
    ds_read_b64 v[188:189], v196 offset:10240
    ds_read_b64 v[190:191], v196 offset:10752
    v_mfma_f32_32x32x16_bf16 v[96:111], a[12:15], v[168:171], v[96:111]
    ds_read_b64 v[192:193], v196 offset:10496
    ds_read_b64 v[194:195], v196 offset:11008
    buffer_load_dwordx4 v76, s[16:19], s99 offen offset:3072 sc1 lds
    s_waitcnt lgkmcnt(6)
    v_mfma_f32_16x16x32_bf16 v[112:115], a[16:19], v[172:175], v[112:115]
    ds_read_b64 v[160:161], v198 offset:1536
    v_mfma_f32_32x32x16_bf16 v[80:95], a[16:19], v[176:179], v[80:95]
    ds_read_b64 v[162:163], v198 offset:1600
    ds_read_b64 v[164:165], v196 offset:12288
    ds_read_b64 v[166:167], v196 offset:12800
    v_mfma_f32_32x32x16_bf16 v[96:111], a[16:19], v[180:183], v[96:111]
    ds_read_b64 v[168:169], v196 offset:12544
    ds_read_b64 v[170:171], v196 offset:13056
    s_add_u32 m0, s93, 112512
    s_add_u32 s99, s99, 524288
    s_mov_b64 exec, s[80:81]
    buffer_load_dwordx4 v77, s[16:19], s100 offen sc1 lds
    s_mov_b64 exec, -1
    s_add_u32 s100, s100, 524288
    s_waitcnt lgkmcnt(6)
    v_mfma_f32_16x16x32_bf16 v[112:115], a[20:23], v[184:187], v[112:115]
    ds_read_b64 v[172:173], v198 offset:1792
    v_mfma_f32_32x32x16_bf16 v[80:95], a[20:23], v[188:191], v[80:95]
    ds_read_b64 v[174:175], v198 offset:1856
    ds_read_b64 v[176:177], v196 offset:14336
    ds_read_b64 v[178:179], v196 offset:14848
    v_mfma_f32_32x32x16_bf16 v[96:111], a[20:23], v[192:195], v[96:111]
    ds_read_b64 v[180:181], v196 offset:14592
    ds_read_b64 v[182:183], v196 offset:15104
    s_add_u32 m0, s92, 114688
    s_nop 0
    buffer_load_dwordx4 v73, s[16:19], s99 offen offset:0 sc1 lds
    s_waitcnt vmcnt(13)
    s_barrier
    s_waitcnt lgkmcnt(6)
    v_mfma_f32_16x16x32_bf16 v[112:115], a[24:27], v[160:163], v[112:115]
    v_add_u32 v198, v49, v198
    v_mfma_f32_32x32x16_bf16 v[80:95], a[24:27], v[164:167], v[80:95]
    v_add_u32 v196, 19584, v196
    ds_read_b64 v[184:185], v198 offset:0
    ds_read_b64 v[186:187], v198 offset:64
    ds_read_b64 v[188:189], v196 offset:0
    v_mfma_f32_32x32x16_bf16 v[96:111], a[24:27], v[168:171], v[96:111]
    ds_read_b64 v[190:191], v196 offset:512
    ds_read_b64 v[192:193], v196 offset:256
    ds_read_b64 v[194:195], v196 offset:768
    buffer_load_dwordx4 v74, s[16:19], s99 offen offset:1024 sc1 lds
    s_waitcnt lgkmcnt(6)
    v_mfma_f32_16x16x32_bf16 v[112:115], a[28:31], v[172:175], v[112:115]
    ds_read_b64 v[160:161], v198 offset:256
    v_mfma_f32_32x32x16_bf16 v[80:95], a[28:31], v[176:179], v[80:95]
    ds_read_b64 v[162:163], v198 offset:320
    ds_read_b64 v[164:165], v196 offset:2048
    ds_read_b64 v[166:167], v196 offset:2560
    v_mfma_f32_32x32x16_bf16 v[96:111], a[28:31], v[180:183], v[96:111]
    ds_read_b64 v[168:169], v196 offset:2304
    ds_read_b64 v[170:171], v196 offset:2816
    buffer_load_dwordx4 v75, s[16:19], s99 offen offset:2048 sc1 lds
    s_waitcnt lgkmcnt(6)
    v_mfma_f32_16x16x32_bf16 v[112:115], a[32:35], v[184:187], v[112:115]
    ds_read_b64 v[172:173], v198 offset:512
    v_mfma_f32_32x32x16_bf16 v[80:95], a[32:35], v[188:191], v[80:95]
    ds_read_b64 v[174:175], v198 offset:576
    ds_read_b64 v[176:177], v196 offset:4096
    ds_read_b64 v[178:179], v196 offset:4608
    v_mfma_f32_32x32x16_bf16 v[96:111], a[32:35], v[192:195], v[96:111]
    ds_read_b64 v[180:181], v196 offset:4352
    ds_read_b64 v[182:183], v196 offset:4864
    buffer_load_dwordx4 v76, s[16:19], s99 offen offset:3072 sc1 lds
    s_waitcnt lgkmcnt(6)
    v_mfma_f32_16x16x32_bf16 v[112:115], a[36:39], v[160:163], v[112:115]
    ds_read_b64 v[184:185], v198 offset:768
    v_mfma_f32_32x32x16_bf16 v[80:95], a[36:39], v[164:167], v[80:95]
    ds_read_b64 v[186:187], v198 offset:832
    ds_read_b64 v[188:189], v196 offset:6144
    ds_read_b64 v[190:191], v196 offset:6656
    v_mfma_f32_32x32x16_bf16 v[96:111], a[36:39], v[168:171], v[96:111]
    ds_read_b64 v[192:193], v196 offset:6400
    ds_read_b64 v[194:195], v196 offset:6912
    s_add_u32 m0, s93, 132096
    s_add_u32 s99, s99, 524288
    s_mov_b64 exec, s[80:81]
    buffer_load_dwordx4 v77, s[16:19], s100 offen sc1 lds
    s_mov_b64 exec, -1
    s_add_u32 s100, s100, 524288
    s_waitcnt lgkmcnt(6)
    v_mfma_f32_16x16x32_bf16 v[112:115], a[40:43], v[172:175], v[112:115]
    ds_read_b64 v[160:161], v198 offset:1024
    v_mfma_f32_32x32x16_bf16 v[80:95], a[40:43], v[176:179], v[80:95]
    ds_read_b64 v[162:163], v198 offset:1088
    ds_read_b64 v[164:165], v196 offset:8192
    ds_read_b64 v[166:167], v196 offset:8704
    v_add_u32 v199, 36352, v58
    s_lshl_b32 s32, s24, 11
    v_mfma_f32_32x32x16_bf16 v[96:111], a[40:43], v[180:183], v[96:111]
    ds_read_b64 v[168:169], v196 offset:8448
    ds_read_b64 v[170:171], v196 offset:8960
    v_add_u32 v203, s32, v199
    s_add_u32 s32, s24, 1
    s_waitcnt lgkmcnt(6)
    v_mfma_f32_16x16x32_bf16 v[112:115], a[44:47], v[184:187], v[112:115]
    ds_read_b64 v[172:173], v198 offset:1280
    v_mfma_f32_32x32x16_bf16 v[80:95], a[44:47], v[188:191], v[80:95]
    ds_read_b64 v[174:175], v198 offset:1344
    ds_read_b64 v[176:177], v196 offset:10240
    ds_read_b64 v[178:179], v196 offset:10752
    s_and_b32 s32, s32, 3
    s_mul_i32 s32, s32, 6144
    v_mfma_f32_32x32x16_bf16 v[96:111], a[44:47], v[192:195], v[96:111]
    ds_read_b64 v[180:181], v196 offset:10496
    ds_read_b64 v[182:183], v196 offset:11008
    v_add_u32 v200, s32, v199
    s_add_u32 s32, s24, 2
    s_waitcnt lgkmcnt(6)
    v_mfma_f32_16x16x32_bf16 v[112:115], a[48:51], v[160:163], v[112:115]
    ds_read_b64 v[184:185], v198 offset:1536
    v_mfma_f32_32x32x16_bf16 v[80:95], a[48:51], v[164:167], v[80:95]
    ds_read_b64 v[186:187], v198 offset:1600
    ds_read_b64 v[188:189], v196 offset:12288
    ds_read_b64 v[190:191], v196 offset:12800
    s_and_b32 s32, s32, 3
    s_mul_i32 s32, s32, 6144
    v_mfma_f32_32x32x16_bf16 v[96:111], a[48:51], v[168:171], v[96:111]
    ds_read_b64 v[192:193], v196 offset:12544
    ds_read_b64 v[194:195], v196 offset:13056
    v_add_u32 v201, s32, v199
    s_add_u32 s32, s24, 3
    s_waitcnt lgkmcnt(6)
    v_mfma_f32_16x16x32_bf16 v[112:115], a[52:55], v[172:175], v[112:115]
    ds_read_b64 v[160:161], v198 offset:1792
    v_mfma_f32_32x32x16_bf16 v[80:95], a[52:55], v[176:179], v[80:95]
    ds_read_b64 v[162:163], v198 offset:1856
    ds_read_b64 v[164:165], v196 offset:14336
    ds_read_b64 v[166:167], v196 offset:14848
    s_and_b32 s32, s32, 3
    s_mul_i32 s32, s32, 6144
    v_mfma_f32_32x32x16_bf16 v[96:111], a[52:55], v[180:183], v[96:111]
    ds_read_b64 v[168:169], v196 offset:14592
    ds_read_b64 v[170:171], v196 offset:15104
    v_add_u32 v202, s32, v199
    s_mul_i32 s32, s24, 6144
    s_waitcnt vmcnt(12)
    s_barrier
    s_waitcnt lgkmcnt(6)
    v_mfma_f32_16x16x32_bf16 v[112:115], a[56:59], v[184:187], v[112:115]
    v_add_u32 v198, v49, v198
    v_mfma_f32_32x32x16_bf16 v[80:95], a[56:59], v[188:191], v[80:95]
    v_add_u32 v196, 19584, v196
    ds_read_b64 v[172:173], v198 offset:0
    ds_read_b64 v[174:175], v198 offset:64
    ds_read_b64 v[176:177], v196 offset:0
    v_add_u32_e64 v204, s32, v199
    v_mfma_f32_32x32x16_bf16 v[96:111], a[56:59], v[192:195], v[96:111]
    ds_read_b64 v[178:179], v196 offset:512
    ds_read_b64 v[180:181], v196 offset:256
    ds_read_b64 v[182:183], v196 offset:768
    s_lshl_b32 s32, s24, 8
    s_waitcnt lgkmcnt(6)
    v_mfma_f32_16x16x32_bf16 v[112:115], a[60:63], v[160:163], v[112:115]
    ds_read_b64 v[184:185], v198 offset:256
    v_mfma_f32_32x32x16_bf16 v[80:95], a[60:63], v[164:167], v[80:95]
    ds_read_b64 v[186:187], v198 offset:320
    ds_read_b64 v[188:189], v196 offset:2048
    ds_read_b64 v[190:191], v196 offset:2560
    s_add_u32 s32, s32, 36352
    v_and_b32_e64 v214, 15, v1
    v_mfma_f32_32x32x16_bf16 v[96:111], a[60:63], v[168:171], v[96:111]
    ds_read_b64 v[192:193], v196 offset:2304
    ds_read_b64 v[194:195], v196 offset:2816
    v_lshl_add_u32 v206, v214, 4, s32
    v_lshrrev_b32 v215, 5, v1
    s_waitcnt lgkmcnt(6)
    v_mfma_f32_16x16x32_bf16 v[112:115], a[64:67], v[172:175], v[112:115]
    ds_read_b64 v[160:161], v198 offset:512
    v_mfma_f32_32x32x16_bf16 v[80:95], a[64:67], v[176:179], v[80:95]
    ds_read_b64 v[162:163], v198 offset:576
    ds_read_b64 v[164:165], v196 offset:4096
    ds_read_b64 v[166:167], v196 offset:4608
    v_lshl_add_u32 v205, v215, 10, v206
    v_bfe_u32 v215, v1, 4, 1
    v_mfma_f32_32x32x16_bf16 v[96:111], a[64:67], v[180:183], v[96:111]
    ds_read_b64 v[168:169], v196 offset:4352
    ds_read_b64 v[170:171], v196 offset:4864
    v_lshl_add_u32 v205, v215, 3, v205
    v_lshlrev_b32 v214, 2, v214
    s_waitcnt lgkmcnt(6)
    v_mfma_f32_16x16x32_bf16 v[112:115], a[68:71], v[184:187], v[112:115]
    ds_read_b64 v[172:173], v198 offset:768
    v_mfma_f32_32x32x16_bf16 v[80:95], a[68:71], v[188:191], v[80:95]
    ds_read_b64 v[174:175], v198 offset:832
    ds_read_b64 v[176:177], v196 offset:6144
    ds_read_b64 v[178:179], v196 offset:6656
    v_lshl_add_u32 v214, v215, 10, v214
    s_lshl_b32 s32, s24, 6
    v_mfma_f32_32x32x16_bf16 v[96:111], a[68:71], v[192:195], v[96:111]
    ds_read_b64 v[180:181], v196 offset:6400
    ds_read_b64 v[182:183], v196 offset:6912
    v_lshl_add_u32 v207, v215, 3, s32
    v_and_b32_e64 v215, 12, v1
    s_waitcnt lgkmcnt(6)
    v_mfma_f32_16x16x32_bf16 v[112:115], a[72:75], v[160:163], v[112:115]
    ds_read_b64 v[184:185], v198 offset:1024
    v_mfma_f32_32x32x16_bf16 v[80:95], a[72:75], v[164:167], v[80:95]
    ds_read_b64 v[186:187], v198 offset:1088
    ds_read_b64 v[188:189], v196 offset:8192
    ds_read_b64 v[190:191], v196 offset:8704
    v_lshl_add_u32 v207, v215, 2, v207
    v_and_b32_e64 v215, 2, v1
    v_mfma_f32_32x32x16_bf16 v[96:111], a[72:75], v[168:171], v[96:111]
    ds_read_b64 v[192:193], v196 offset:8448
    ds_read_b64 v[194:195], v196 offset:8960
    s_lshl_b32 s98, s72, 5
    s_add_u32 s98, s98, 256
    s_sub_u32 s95, s98, 4
    s_max_i32 s95, s95, 0
    s_lshl_b32 s94, s98, 3
    s_lshl_b32 s95, s95, 3
    s_add_u32 s94, s94, 3457024
    s_add_u32 s95, s95, 3457024
    s_add_u32 s96, s94, 8192
    buffer_load_dwordx2 v[152:153], v47, s[16:19], s94 offen sc1
    s_waitcnt lgkmcnt(6)
    v_mfma_f32_16x16x32_bf16 v[112:115], a[76:79], v[172:175], v[112:115]
    ds_read_b64 v[160:161], v198 offset:1280
    v_mfma_f32_32x32x16_bf16 v[80:95], a[76:79], v[176:179], v[80:95]
    ds_read_b64 v[162:163], v198 offset:1344
    ds_read_b64 v[164:165], v196 offset:10240
    ds_read_b64 v[166:167], v196 offset:10752
    v_lshl_add_u32 v207, v215, 1, v207
    v_add_u32 v207, 69120, v207
    v_mfma_f32_32x32x16_bf16 v[96:111], a[76:79], v[180:183], v[96:111]
    ds_read_b64 v[168:169], v196 offset:10496
    ds_read_b64 v[170:171], v196 offset:11008
    buffer_load_dwordx2 v[154:155], v47, s[16:19], s96 offen sc1
    v_lshrrev_b32 v215, 4, v1
    s_waitcnt lgkmcnt(6)
    v_mfma_f32_16x16x32_bf16 v[112:115], a[80:83], v[184:187], v[112:115]
    ds_read_b64 v[172:173], v198 offset:1536
    v_mfma_f32_32x32x16_bf16 v[80:95], a[80:83], v[188:191], v[80:95]
    ds_read_b64 v[174:175], v198 offset:1600
    ds_read_b64 v[176:177], v196 offset:12288
    ds_read_b64 v[178:179], v196 offset:12800
    v_lshl_add_u32 v206, v215, 2, v206
    v_mov_b32 v215, 0x3f803f80
    v_mfma_f32_32x32x16_bf16 v[96:111], a[80:83], v[192:195], v[96:111]
    ds_read_b64 v[180:181], v196 offset:12544
    ds_read_b64 v[182:183], v196 offset:13056
    buffer_load_dwordx2 v[156:157], v48, s[16:19], s95 offen sc1
    s_waitcnt lgkmcnt(6)
    v_mfma_f32_16x16x32_bf16 v[112:115], a[84:87], v[160:163], v[112:115]
    ds_read_b64 v[184:185], v198 offset:1792
    v_mfma_f32_32x32x16_bf16 v[80:95], a[84:87], v[164:167], v[80:95]
    ds_read_b64 v[186:187], v198 offset:1856
    ds_read_b64 v[188:189], v196 offset:14336
    ds_read_b64 v[190:191], v196 offset:14848
    v_mfma_f32_32x32x16_bf16 v[96:111], a[84:87], v[168:171], v[96:111]
    ds_read_b64 v[192:193], v196 offset:14592
    ds_read_b64 v[194:195], v196 offset:15104
    s_waitcnt vmcnt(8)
    s_barrier
    s_waitcnt lgkmcnt(6)
    v_mfma_f32_16x16x32_bf16 v[112:115], a[88:91], v[172:175], v[112:115]
    v_add_u32_e64 v198, v49, v198
    v_mfma_f32_32x32x16_bf16 v[80:95], a[88:91], v[176:179], v[80:95]
    v_add_u32 v196, 19584, v196
    ds_read_b64 v[160:161], v198 offset:0
    ds_read_b64 v[162:163], v198 offset:64
    ds_read_b64 v[164:165], v196 offset:0
    v_mfma_f32_32x32x16_bf16 v[96:111], a[88:91], v[180:183], v[96:111]
    ds_read_b64 v[166:167], v196 offset:512
    ds_read_b64 v[168:169], v196 offset:256
    ds_read_b64 v[170:171], v196 offset:768
    s_waitcnt lgkmcnt(6)
    v_mfma_f32_16x16x32_bf16 v[112:115], a[92:95], v[184:187], v[112:115]
    ds_read_b64 v[172:173], v198 offset:256
    v_mfma_f32_32x32x16_bf16 v[80:95], a[92:95], v[188:191], v[80:95]
    ds_read_b64 v[174:175], v198 offset:320
    ds_read_b64 v[176:177], v196 offset:2048
    ds_read_b64 v[178:179], v196 offset:2560
    v_mfma_f32_32x32x16_bf16 v[96:111], a[92:95], v[192:195], v[96:111]
    ds_read_b64 v[180:181], v196 offset:2304
    ds_read_b64 v[182:183], v196 offset:2816
    s_waitcnt lgkmcnt(6)
    v_mfma_f32_16x16x32_bf16 v[112:115], a[96:99], v[160:163], v[112:115]
    ds_read_b64 v[184:185], v198 offset:512
    v_mfma_f32_32x32x16_bf16 v[80:95], a[96:99], v[164:167], v[80:95]
    ds_read_b64 v[186:187], v198 offset:576
    ds_read_b64 v[188:189], v196 offset:4096
    ds_read_b64 v[190:191], v196 offset:4608
    v_mfma_f32_32x32x16_bf16 v[96:111], a[96:99], v[168:171], v[96:111]
    ds_read_b64 v[192:193], v196 offset:4352
    ds_read_b64 v[194:195], v196 offset:4864
    s_waitcnt lgkmcnt(6)
    v_mfma_f32_16x16x32_bf16 v[112:115], a[100:103], v[172:175], v[112:115]
    ds_read_b64 v[160:161], v198 offset:768
    v_mfma_f32_32x32x16_bf16 v[80:95], a[100:103], v[176:179], v[80:95]
    ds_read_b64 v[162:163], v198 offset:832
    ds_read_b64 v[164:165], v196 offset:6144
    ds_read_b64 v[166:167], v196 offset:6656
    v_mfma_f32_32x32x16_bf16 v[96:111], a[100:103], v[180:183], v[96:111]
    ds_read_b64 v[168:169], v196 offset:6400
    ds_read_b64 v[170:171], v196 offset:6912
    s_waitcnt lgkmcnt(6)
    v_mfma_f32_16x16x32_bf16 v[112:115], a[104:107], v[184:187], v[112:115]
    ds_read_b64 v[172:173], v198 offset:1024
    v_mfma_f32_32x32x16_bf16 v[80:95], a[104:107], v[188:191], v[80:95]
    ds_read_b64 v[174:175], v198 offset:1088
    ds_read_b64 v[176:177], v196 offset:8192
    ds_read_b64 v[178:179], v196 offset:8704
    v_mfma_f32_32x32x16_bf16 v[96:111], a[104:107], v[192:195], v[96:111]
    ds_read_b64 v[180:181], v196 offset:8448
    ds_read_b64 v[182:183], v196 offset:8960
    s_waitcnt lgkmcnt(6)
    v_mfma_f32_16x16x32_bf16 v[112:115], a[108:111], v[160:163], v[112:115]
    ds_read_b64 v[184:185], v198 offset:1280
    v_mfma_f32_32x32x16_bf16 v[80:95], a[108:111], v[164:167], v[80:95]
    ds_read_b64 v[186:187], v198 offset:1344
    ds_read_b64 v[188:189], v196 offset:10240
    ds_read_b64 v[190:191], v196 offset:10752
    v_mfma_f32_32x32x16_bf16 v[96:111], a[108:111], v[168:171], v[96:111]
    ds_read_b64 v[192:193], v196 offset:10496
    ds_read_b64 v[194:195], v196 offset:11008
    s_waitcnt lgkmcnt(6)
    v_mfma_f32_16x16x32_bf16 v[112:115], a[112:115], v[172:175], v[112:115]
    ds_read_b64 v[160:161], v198 offset:1536
    v_mfma_f32_32x32x16_bf16 v[80:95], a[112:115], v[176:179], v[80:95]
    ds_read_b64 v[162:163], v198 offset:1600
    ds_read_b64 v[164:165], v196 offset:12288
    ds_read_b64 v[166:167], v196 offset:12800
    v_mfma_f32_32x32x16_bf16 v[96:111], a[112:115], v[180:183], v[96:111]
    ds_read_b64 v[168:169], v196 offset:12544
    ds_read_b64 v[170:171], v196 offset:13056
    s_waitcnt lgkmcnt(6)
    v_mfma_f32_16x16x32_bf16 v[112:115], a[116:119], v[184:187], v[112:115]
    ds_read_b64 v[172:173], v198 offset:1792
    v_mfma_f32_32x32x16_bf16 v[80:95], a[116:119], v[188:191], v[80:95]
    ds_read_b64 v[174:175], v198 offset:1856
    ds_read_b64 v[176:177], v196 offset:14336
    ds_read_b64 v[178:179], v196 offset:14848
    v_mfma_f32_32x32x16_bf16 v[96:111], a[116:119], v[192:195], v[96:111]
    ds_read_b64 v[180:181], v196 offset:14592
    ds_read_b64 v[182:183], v196 offset:15104
sl_70:
    s_waitcnt vmcnt(1)
    v_max3_u32 v2, v152, v153, v154
    s_waitcnt vmcnt(0)
    v_max3_u32 v2, v2, v155, v156
    v_max_u32 v2, v2, v157
    v_cmp_eq_u32 vcc, -1, v2
    s_nop 0
    s_cbranch_vccnz rd_71
rc_72:
    s_barrier
    s_waitcnt lgkmcnt(6)
    v_mfma_f32_16x16x32_bf16 v[112:115], a[120:123], v[160:163], v[112:115]
    v_add_u32 v198, v49, v198
    v_mfma_f32_32x32x16_bf16 v[80:95], a[120:123], v[164:167], v[80:95]
    v_add_u32 v196, 19584, v196
    ds_read_b64 v[184:185], v198 offset:0
    ds_read_b64 v[186:187], v198 offset:64
    v_mul_f32 v148, v24, v157
    v_mul_f32 v149, v25, v157
    v_mfma_f32_32x32x16_bf16 v[96:111], a[120:123], v[168:171], v[96:111]
    ds_read_b64 v[188:189], v196 offset:0
    ds_read_b64 v[190:191], v196 offset:512
    s_mov_b32 s96, 12058624
    buffer_load_dwordx4 v[216:219], v56, s[16:19], s96 offen offset:0 sc1
    v_mul_f32 v150, v26, v157
    v_mul_f32_e64 v151, v27, v157
    s_waitcnt lgkmcnt(4)
    v_mfma_f32_16x16x32_bf16 v[112:115], a[124:127], v[172:175], v[112:115]
    ds_read_b64 v[192:193], v198 offset:256
    v_mfma_f32_32x32x16_bf16 v[80:95], a[124:127], v[176:179], v[80:95]
    ds_read_b64 v[194:195], v198 offset:320
    ds_read_b64 v[160:161], v196 offset:2048
    v_mul_f32 v116, v8, v153
    v_mul_f32 v117, v9, v153
    v_mul_f32_e64 v118, v10, v153
    v_mfma_f32_32x32x16_bf16 v[96:111], a[124:127], v[180:183], v[96:111]
    ds_read_b64 v[162:163], v196 offset:2560
    buffer_load_dwordx4 v[220:223], v56, s[16:19], s96 offen offset:256 sc1
    v_mul_f32 v119, v11, v153
    v_mul_f32_e64 v120, v12, v153
    s_waitcnt lgkmcnt(4)
    v_mfma_f32_16x16x32_bf16 v[112:115], a[128:131], v[184:187], v[112:115]
    ds_read_b64 v[164:165], v198 offset:512
    v_mfma_f32_32x32x16_bf16 v[80:95], a[128:131], v[188:191], v[80:95]
    ds_read_b64 v[166:167], v198 offset:576
    ds_read_b64 v[168:169], v196 offset:4096
    ds_read_b64 v[170:171], v196 offset:4608
    v_mul_f32 v121, v13, v153
    v_mul_f32_e64 v122, v14, v153
    s_waitcnt lgkmcnt(4)
    v_mfma_f32_16x16x32_bf16 v[112:115], a[132:135], v[192:195], v[112:115]
    ds_read_b64 v[172:173], v198 offset:768
    v_mfma_f32_32x32x16_bf16 v[80:95], a[132:135], v[160:163], v[80:95]
    ds_read_b64 v[174:175], v198 offset:832
    ds_read_b64 v[176:177], v196 offset:6144
    ds_read_b64 v[178:179], v196 offset:6656
    s_mov_b32 s96, 12091392
    buffer_load_dwordx4 v[224:227], v56, s[16:19], s96 offen offset:0 sc1
    v_mul_f32 v123, v15, v153
    v_mul_f32_e64 v124, v16, v153
    s_waitcnt lgkmcnt(4)
    v_mfma_f32_16x16x32_bf16 v[112:115], a[136:139], v[164:167], v[112:115]
    ds_read_b64 v[180:181], v198 offset:1024
    v_mfma_f32_32x32x16_bf16 v[80:95], a[136:139], v[168:171], v[80:95]
    ds_read_b64 v[182:183], v198 offset:1088
    ds_read_b64 v[184:185], v196 offset:8192
    ds_read_b64 v[186:187], v196 offset:8704
    v_mul_f32 v125, v17, v153
    v_mul_f32_e64 v126, v18, v153
    s_waitcnt lgkmcnt(4)
    v_mfma_f32_16x16x32_bf16 v[112:115], a[140:143], v[172:175], v[112:115]
    ds_read_b64 v[188:189], v198 offset:1280
    v_mfma_f32_32x32x16_bf16 v[80:95], a[140:143], v[176:179], v[80:95]
    ds_read_b64 v[190:191], v198 offset:1344
    ds_read_b64 v[192:193], v196 offset:10240
    ds_read_b64 v[194:195], v196 offset:10752
    buffer_load_dwordx4 v[228:231], v56, s[16:19], s96 offen offset:256 sc1
    v_mul_f32 v127, v19, v153
    v_mul_f32_e64 v128, v20, v153
    s_waitcnt lgkmcnt(4)
    v_mfma_f32_16x16x32_bf16 v[112:115], a[144:147], v[180:183], v[112:115]
    ds_read_b64 v[160:161], v198 offset:1536
    v_mfma_f32_32x32x16_bf16 v[80:95], a[144:147], v[184:187], v[80:95]
    ds_read_b64 v[162:163], v198 offset:1600
    ds_read_b64 v[164:165], v196 offset:12288
    ds_read_b64 v[166:167], v196 offset:12800
    v_mul_f32 v129, v21, v153
    v_mul_f32_e64 v130, v22, v153
    s_waitcnt lgkmcnt(4)
    v_mfma_f32_16x16x32_bf16 v[112:115], a[148:151], v[188:191], v[112:115]
    ds_read_b64 v[168:169], v198 offset:1792
    v_mfma_f32_32x32x16_bf16 v[80:95], a[148:151], v[192:195], v[80:95]
    ds_read_b64 v[170:171], v198 offset:1856
    ds_read_b64 v[172:173], v196 offset:14336
    ds_read_b64 v[174:175], v196 offset:14848
    s_mov_b32 s96, 12124160
    buffer_load_dwordx4 v[232:235], v56, s[16:19], s96 offen offset:0 sc1
    v_mul_f32 v131, v23, v153
    v_mul_f32_e64 v132, v8, v155
    s_waitcnt lgkmcnt(4)
    v_mfma_f32_16x16x32_bf16 v[112:115], a[152:155], v[160:163], v[112:115]
    ds_read_b64 v[176:177], v196 offset:256
    v_mfma_f32_32x32x16_bf16 v[80:95], a[152:155], v[164:167], v[80:95]
    ds_read_b64 v[178:179], v196 offset:768
    ds_read_b64 v[180:181], v196 offset:2304
    ds_read_b64 v[182:183], v196 offset:2816
    v_mul_f32 v133, v9, v155
    v_mul_f32_e64 v134, v10, v155
    s_waitcnt lgkmcnt(4)
    v_mfma_f32_16x16x32_bf16 v[112:115], a[156:159], v[168:171], v[112:115]
    ds_read_b64 v[184:185], v196 offset:4352
    v_mfma_f32_32x32x16_bf16 v[80:95], a[156:159], v[172:175], v[80:95]
    ds_read_b64 v[186:187], v196 offset:4864
    ds_read_b64 v[188:189], v196 offset:6400
    ds_read_b64 v[190:191], v196 offset:6912
    buffer_load_dwordx4 v[236:239], v56, s[16:19], s96 offen offset:256 sc1
    v_mul_f32 v135, v11, v155
    v_mul_f32 v136, v12, v155
    v_mul_f32 v137, v13, v155
    v_mul_f32 v138, v14, v155
    v_mul_f32 v139, v15, v155
    v_mul_f32 v140, v16, v155
    v_mul_f32 v141, v17, v155
    v_mul_f32 v142, v18, v155
    v_mul_f32 v143, v19, v155
    v_mul_f32 v144, v20, v155
    v_mul_f32 v145, v21, v155
    v_mul_f32 v146, v22, v155
    v_mul_f32 v147, v23, v155
    s_waitcnt lgkmcnt(4)
    v_mfma_f32_32x32x16_bf16 v[96:111], a[128:131], v[176:179], v[96:111]
    ds_read_b64 v[192:193], v196 offset:8448
    ds_read_b64 v[194:195], v196 offset:8960
    v_mfma_f32_32x32x16_bf16 v[96:111], a[132:135], v[180:183], v[96:111]
    ds_read_b64 v[160:161], v196 offset:10496
    ds_read_b64 v[162:163], v196 offset:11008
    s_mov_b32 s96, 12156928
    buffer_load_dwordx4 v[240:243], v56, s[16:19], s96 offen offset:0 sc1
    v_fma_f32 v112, v112, v156, v148
    v_fma_f32 v113, v113, v156, v149
    s_waitcnt lgkmcnt(4)
    v_mfma_f32_32x32x16_bf16 v[96:111], a[136:139], v[184:187], v[96:111]
    ds_read_b64 v[164:165], v196 offset:12544
    ds_read_b64 v[166:167], v196 offset:13056
    v_fma_f32 v114, v114, v156, v150
    v_fma_f32 v115, v115, v156, v151
    v_cvt_pk_bf16_f32 v112, v112, v113
    v_mfma_f32_32x32x16_bf16 v[96:111], a[140:143], v[188:191], v[96:111]
    ds_read_b64 v[168:169], v196 offset:14592
    ds_read_b64 v[170:171], v196 offset:15104
    buffer_load_dwordx4 v[244:247], v56, s[16:19], s96 offen offset:256 sc1
    v_cvt_pk_bf16_f32 v113, v114, v115
    v_fma_f32 v80, v80, v152, v116
    s_waitcnt lgkmcnt(4)
    v_mfma_f32_32x32x16_bf16 v[96:111], a[144:147], v[192:195], v[96:111]
    v_fma_f32 v81, v81, v152, v117
    v_fma_f32 v82, v82, v152, v118
    v_fma_f32 v83, v83, v152, v119
    v_cvt_pk_bf16_f32 v80, v80, v81
    v_cvt_pk_bf16_f32 v81, v82, v83
    v_mfma_f32_32x32x16_bf16 v[96:111], a[148:151], v[160:163], v[96:111]
    ds_write_b64 v40, v[112:113] offset:0
    ds_write_b64 v38, v[80:81] offset:0
    v_fma_f32 v84, v84, v152, v120
    v_fma_f32 v85, v85, v152, v121
    s_waitcnt lgkmcnt(2)
    v_mfma_f32_32x32x16_bf16 v[96:111], a[152:155], v[164:167], v[96:111]
    v_fma_f32 v86, v86, v152, v122
    v_fma_f32 v87, v87, v152, v123
    v_cvt_pk_bf16_f32 v84, v84, v85
    v_cvt_pk_bf16_f32 v85, v86, v87
    v_fma_f32 v88, v88, v152, v124
    v_mfma_f32_32x32x16_bf16 v[96:111], a[156:159], v[168:171], v[96:111]
    s_mov_b32 s96, 12058624
    buffer_load_dwordx2 v[248:249], v57, s[16:19], s96 offen offset:0 sc1
    v_fma_f32 v89, v89, v152, v125
    v_fma_f32 v90, v90, v152, v126
    v_fma_f32 v91, v91, v152, v127
    v_cvt_pk_bf16_f32 v88, v88, v89
    v_cvt_pk_bf16_f32 v89, v90, v91
    ds_write_b64 v38, v[84:85] offset:6400
    ds_write_b64 v38, v[88:89] offset:12800
    v_fma_f32 v92, v92, v152, v128
    v_fma_f32 v93, v93, v152, v129
    v_fma_f32 v94, v94, v152, v130
    v_fma_f32 v95, v95, v152, v131
    v_cvt_pk_bf16_f32 v92, v92, v93
    v_cvt_pk_bf16_f32 v93, v94, v95
    ds_write_b64 v39, v[92:93] offset:0
    v_pk_fma_f32 v[96:97], v[96:97], v[154:155], v[132:133] op_sel_hi:[1,0,1]
    v_pk_fma_f32 v[98:99], v[98:99], v[154:155], v[134:135] op_sel_hi:[1,0,1]
    v_cvt_pk_bf16_f32 v96, v96, v97
    v_cvt_pk_bf16_f32 v97, v98, v99
    v_pk_fma_f32 v[100:101], v[100:101], v[154:155], v[136:137] op_sel_hi:[1,0,1]
    v_pk_fma_f32 v[102:103], v[102:103], v[154:155], v[138:139] op_sel_hi:[1,0,1]
    v_cvt_pk_bf16_f32 v100, v100, v101
    v_cvt_pk_bf16_f32 v101, v102, v103
    ds_write_b64 v38, v[96:97] offset:1600
    ds_write_b64 v38, v[100:101] offset:8000
    v_pk_fma_f32 v[104:105], v[104:105], v[154:155], v[140:141] op_sel_hi:[1,0,1]
    v_pk_fma_f32 v[106:107], v[106:107], v[154:155], v[142:143] op_sel_hi:[1,0,1]
    v_cvt_pk_bf16_f32 v104, v104, v105
    v_cvt_pk_bf16_f32 v105, v106, v107
    v_pk_fma_f32 v[108:109], v[108:109], v[154:155], v[144:145] op_sel_hi:[1,0,1]
    v_pk_fma_f32 v[110:111], v[110:111], v[154:155], v[146:147] op_sel_hi:[1,0,1]
    v_cvt_pk_bf16_f32 v108, v108, v109
    v_cvt_pk_bf16_f32 v109, v110, v111
    ds_write_b64 v38, v[104:105] offset:14400
    ds_write_b64 v39, v[108:109] offset:1600
    v_cmp_u_f32 vcc, v82, v114
    v_cmp_u_f32 s[82:83], v98, v98
    s_lshl_b32 s25, s24, 2
    s_add_u32 s25, s25, 160256
    s_or_b64 vcc, vcc, s[82:83]
    s_cselect_b32 s26, 1, 0
    v_mov_b32 v196, s25
    v_mov_b32 v197, s26
    ds_write_b32 v196, v197
    s_waitcnt lgkmcnt(0)
    s_barrier
    v_mov_b32 v158, 160256
    ds_read_b128 v[128:131], v158
    v_mov_b32 v94, 0
    v_mov_b32 v95, 0
    v_mov_b32 v98, 0
    v_mov_b32_e64 v99, 0
    s_mov_b64 exec, 0xffff
    ds_read_b64 v[94:95], v42 offset:320
    ds_read_b64 v[98:99], v42 offset:640
    s_mov_b64 exec, -1
    s_nop 0
    ds_read_b64 v[92:93], v41 offset:320
    ds_read_b64 v[96:97], v41 offset:640
    ds_read_b64 v[84:85], v41 offset:6720
    ds_read_b64 v[86:87], v42 offset:6720
    ds_read_b64 v[80:81], v41 offset:6400
    ds_read_b64 v[82:83], v42 offset:6400
    ds_read_b64 v[88:89], v41 offset:7040
    ds_read_b64 v[90:91], v42 offset:7040
    ds_read_b64_tr_b16 v[106:107], v44 offset:0
    ds_read_b64_tr_b16 v[100:101], v43 offset:0
    buffer_load_dwordx2 v[252:253], v57, s[16:19], s96 offen offset:128 sc1
    ds_read_b64_tr_b16 v[108:109], v44 offset:320
    ds_read_b64_tr_b16 v[102:103], v43 offset:320
    ds_read_b64_tr_b16 v[110:111], v44 offset:640
    ds_read_b64_tr_b16 v[104:105], v43 offset:640
    s_mov_b32 s82, 0x3ea52b5c
    s_lshl_b32 s25, s98, 4
    s_add_u32 s25, s25, 12058624
    s_lshl_b32 s26, s98, 3
    s_mov_b32 s96, 12075008
    buffer_load_dwordx2 v[250:251], v57, s[16:19], s96 offen offset:0 sc1
    s_add_u32 s26, s26, 12058624
    s_waitcnt lgkmcnt(15)
    v_or3_b32 v128, v128, v129, v130
    v_or_b32 v128, v128, v131
    v_cmp_ne_u32 vcc, 0, v128
    s_nop 0
    s_cbranch_vccnz rd_73
rc_74:
    s_waitcnt lgkmcnt(10)
    v_mfma_f32_16x16x32_bf16 v[116:119], v[84:87], v[92:95], v[28:31]
    v_mfma_f32_16x16x32_bf16 v[120:123], v[84:87], v[96:99], v[32:35]
    s_waitcnt lgkmcnt(8)
    v_mfma_f32_16x16x32_bf16 v[112:115], v[80:83], v[92:95], v[32:35]
    s_waitcnt lgkmcnt(6)
    v_mfma_f32_16x16x32_bf16 v[124:127], v[88:91], v[96:99], v[28:31]
    buffer_load_dwordx2 v[254:255], v57, s[16:19], s96 offen offset:128 sc1
    s_nop 4
    v_max_f32 v112, v112, v116
    v_max_f32 v113, v113, v117
    v_max_f32 v114, v114, v118
    v_max_f32 v115, v115, v119
    v_max3_f32 v156, v112, v113, v114
    v_max_f32 v156, v156, v115
    v_max_f32 v120, v120, v124
    v_max_f32 v121, v121, v125
    s_mov_b32 s96, 9437184
    buffer_load_dwordx4 v[208:211], v59, s[16:19], s96 offen sc1
    v_max_f32 v122, v122, v126
    v_max_f32 v123, v123, v127
    v_max3_f32 v157, v120, v121, v122
    v_max_f32 v157, v157, v123
    s_nop 1
    v_permlane16_swap_b32 v156, v157
    v_max_f32 v156, v156, v157
    v_mov_b32 v157, v156
    s_nop 1
    v_permlane32_swap_b32_e64 v156, v157
    s_add_u32 s97, s36, 9437184
    buffer_load_dword v212, v61, s[16:19], s97 offen sc1
    v_max_f32 v156, v156, v157
    v_mul_f32 v156, s82, v156
    v_mov_b32 v157, v156
    s_nop 1
    v_permlane16_swap_b32_e64 v156, v157
    v_fma_f32 v112, v112, s82, -v156
    v_fma_f32 v113, v113, s82, -v156
    v_fma_f32 v114, v114, s82, -v156
    v_fma_f32 v115, v115, s82, -v156
    v_exp_f32 v112, v112
    v_exp_f32 v113, v113
    v_exp_f32 v114, v114
    v_exp_f32 v115, v115
    v_cvt_pk_bf16_f32 v116, v112, v113
    v_cvt_pk_bf16_f32 v117, v114, v115
    v_bfi_b32 v128, v36, 0, v116
    v_and_b32 v130, v36, v116
    v_bfi_b32 v129, v37, 0, v117
    v_and_b32 v131, v37, v117
    s_waitcnt lgkmcnt(3)
    s_nop 0
    v_mfma_f32_16x16x32_bf16 v[144:147], v[106:109], v[128:131], 0
    s_waitcnt lgkmcnt(2)
    v_mfma_f32_16x16x32_bf16 v[136:139], v[100:103], v[128:131], 0
    v_fma_f32 v120, v120, s82, -v157
    v_fma_f32 v121, v121, s82, -v157
    v_fma_f32 v122, v122, s82, -v157
    v_fma_f32 v123, v123, s82, -v157
    v_exp_f32 v120, v120
    v_exp_f32 v121, v121
    v_exp_f32 v122, v122
    v_exp_f32_e64 v123, v123
    v_cvt_pk_bf16_f32 v124, v120, v121
    v_cvt_pk_bf16_f32 v125, v122, v123
    v_bfi_b32 v132, v36, 0, v124
    v_and_b32 v134, v36, v124
    v_bfi_b32 v133, v37, 0, v125
    v_and_b32 v135, v37, v125
    s_waitcnt lgkmcnt(1)
    s_nop 0
    v_mfma_f32_16x16x32_bf16 v[148:151], v[108:111], v[132:135], 0
    s_waitcnt lgkmcnt(0)
    v_mfma_f32_16x16x32_bf16 v[140:143], v[102:105], v[132:135], 0
    v_mov_b32 v158, v144
    s_nop 1
    v_permlane16_swap_b32 v144, v158
    v_rcp_f32 v158, v158
    s_nop 0
    v_pk_mul_f32 v[136:137], v[136:137], v[158:159] op_sel_hi:[1,0]
    v_pk_mul_f32 v[138:139], v[138:139], v[158:159] op_sel_hi:[1,0]
    v_pk_mul_f32 v[144:145], v[144:145], v[158:159] op_sel_hi:[1,0]
    v_pk_mul_f32 v[146:147], v[146:147], v[158:159] op_sel_hi:[1,0]
    v_cvt_pk_bf16_f32 v112, v136, v137
    v_cvt_pk_bf16_f32 v116, v144, v145
    v_cvt_pk_bf16_f32 v113, v138, v139
    v_cvt_pk_bf16_f32 v117, v146, v147
    v_mov_b32 v160, v148
    s_nop 1
    v_permlane16_swap_b32 v148, v160
    v_rcp_f32_e64 v160, v160
    s_nop 0
    v_pk_mul_f32 v[140:141], v[140:141], v[160:161] op_sel_hi:[1,0]
    v_pk_mul_f32 v[142:143], v[142:143], v[160:161] op_sel_hi:[1,0]
    v_pk_mul_f32 v[148:149], v[148:149], v[160:161] op_sel_hi:[1,0]
    v_pk_mul_f32 v[150:151], v[150:151], v[160:161] op_sel_hi:[1,0]
    v_cvt_pk_bf16_f32 v114, v140, v141
    v_cvt_pk_bf16_f32 v118, v148, v149
    v_cvt_pk_bf16_f32 v115, v142, v143
    v_cvt_pk_bf16_f32 v119, v150, v151
    v_permlane16_swap_b32 v112, v114
    v_permlane16_swap_b32 v113, v115
    v_permlane16_swap_b32 v116, v118
    v_permlane16_swap_b32 v117, v119
    buffer_store_dwordx4 v[112:115], v45, s[16:19], s25 offen sc1
    s_mov_b64 exec, s[80:81]
    buffer_store_dwordx2 v[116:117], v46, s[16:19], s26 offen sc1
    s_mov_b64 exec, -1
oe_75:
    s_waitcnt vmcnt(15)
    v_mfma_f32_16x16x32_bf16 v[112:115], a[176:179], v[216:219], 0
    v_mov_b32 v136, 0
    v_mov_b32 v137, 0
    s_waitcnt vmcnt(14)
    v_mfma_f32_16x16x32_bf16 v[116:119], a[176:179], v[220:223], 0
    v_mov_b32 v138, 0
    v_mov_b32 v139, 0
    s_waitcnt vmcnt(13)
    v_mfma_f32_16x16x32_bf16 v[112:115], a[196:199], v[224:227], v[112:115]
    v_mov_b32 v140, 0
    v_mov_b32 v141, 0
    s_waitcnt vmcnt(12)
    v_mfma_f32_16x16x32_bf16 v[116:119], a[196:199], v[228:231], v[116:119]
    s_mov_b32 s25, 14680064
    s_add_u32 s26, s36, 14680064
    s_waitcnt vmcnt(11)
    v_mfma_f32_16x16x32_bf16 v[112:115], a[216:219], v[232:235], v[112:115]
    s_add_u32 s27, s35, 3506176
    s_mov_b32 s28, 0x99999999
    s_waitcnt vmcnt(10)
    v_mfma_f32_16x16x32_bf16 v[116:119], a[216:219], v[236:239], v[116:119]
    s_mov_b32 s29, 0x99999999
    s_waitcnt vmcnt(9)
    v_mfma_f32_16x16x32_bf16 v[112:115], a[236:239], v[240:243], v[112:115]
    s_waitcnt vmcnt(8)
    v_mfma_f32_16x16x32_bf16 v[116:119], a[236:239], v[244:247], v[116:119]
    s_waitcnt vmcnt(5)
    v_mfma_f32_16x16x32_bf16 v[112:115], v[52:55], v[248:251], v[112:115]
    s_waitcnt vmcnt(4)
    v_mfma_f32_16x16x32_bf16 v[116:119], v[52:55], v[252:255], v[116:119]
    v_mfma_f32_16x16x32_bf16 v[88:91], a[164:167], v[216:219], 0
    v_mfma_f32_16x16x32_bf16 v[92:95], a[164:167], v[220:223], 0
    v_mfma_f32_16x16x32_bf16 v[88:91], a[184:187], v[224:227], v[88:91]
    s_waitcnt vmcnt(3)
    v_max3_u32 v132, v208, v209, v210
    s_waitcnt vmcnt(2)
    v_max3_u32 v132, v132, v211, v212
    v_mfma_f32_16x16x32_bf16 v[92:95], a[184:187], v[228:231], v[92:95]
    v_cmp_eq_u32 s[82:83], -1, v132
    v_mfma_f32_16x16x32_bf16 v[88:91], a[204:207], v[232:235], v[88:91]
    v_mfma_f32_16x16x32_bf16 v[92:95], a[204:207], v[236:239], v[92:95]
    v_cmp_u_f32 vcc, v112, v116
    s_nop 0
    s_or_b64 vcc, vcc, s[82:83]
    s_cbranch_vccnz rd_76
rc_77:
    v_mfma_f32_16x16x32_bf16 v[88:91], a[224:227], v[240:243], v[88:91]
    ds_write_b128 v203, v[112:115] offset:24576
    v_mfma_f32_16x16x32_bf16 v[92:95], a[224:227], v[244:247], v[92:95]
    v_mfma_f32_16x16x32_bf16 v[88:91], a[244:247], v[248:251], v[88:91]
    ds_write_b128 v203, v[116:119] offset:25600
    v_mfma_f32_16x16x32_bf16 v[92:95], a[244:247], v[252:255], v[92:95]
    v_mfma_f32_16x16x32_bf16 v[96:99], a[168:171], v[216:219], 0
    v_lshlrev_b32_e64 v120, 16, v208
    v_and_b32 v121, 0xffff0000, v208
    v_mfma_f32_16x16x32_bf16 v[100:103], a[168:171], v[220:223], 0
    v_lshlrev_b32_e64 v122, 16, v209
    v_and_b32 v123, 0xffff0000, v209
    v_mfma_f32_16x16x32_bf16 v[96:99], a[188:191], v[224:227], v[96:99]
    v_lshlrev_b32_e64 v124, 16, v210
    v_and_b32 v125, 0xffff0000, v210
    v_mfma_f32_16x16x32_bf16 v[100:103], a[188:191], v[228:231], v[100:103]
    v_lshlrev_b32_e64 v126, 16, v211
    v_and_b32 v127, 0xffff0000, v211
    v_mfma_f32_16x16x32_bf16 v[96:99], a[208:211], v[232:235], v[96:99]
    v_lshlrev_b32_e64 v128, 16, v212
    v_and_b32 v129, 0xffff0000, v212
    v_mfma_f32_16x16x32_bf16 v[100:103], a[208:211], v[236:239], v[100:103]
    v_mfma_f32_16x16x32_bf16 v[96:99], a[228:231], v[240:243], v[96:99]
    ds_write_b128 v200, v[88:91] offset:0
    v_mfma_f32_16x16x32_bf16 v[100:103], a[228:231], v[244:247], v[100:103]
    v_mfma_f32_16x16x32_bf16 v[96:99], a[248:251], v[248:251], v[96:99]
    ds_write_b128 v200, v[92:95] offset:1024
    v_mfma_f32_16x16x32_bf16 v[100:103], a[248:251], v[252:255], v[100:103]
    v_mfma_f32_16x16x32_bf16 v[104:107], a[172:175], v[216:219], 0
    v_mfma_f32_16x16x32_bf16 v[108:111], a[172:175], v[220:223], 0
    v_mfma_f32_16x16x32_bf16 v[104:107], a[192:195], v[224:227], v[104:107]
    v_mfma_f32_16x16x32_bf16 v[108:111], a[192:195], v[228:231], v[108:111]
    v_mfma_f32_16x16x32_bf16 v[104:107], a[212:215], v[232:235], v[104:107]
    v_mfma_f32_16x16x32_bf16 v[108:111], a[212:215], v[236:239], v[108:111]
    v_mfma_f32_16x16x32_bf16 v[104:107], a[232:235], v[240:243], v[104:107]
    ds_write_b128 v201, v[96:99] offset:2048
    v_mfma_f32_16x16x32_bf16 v[108:111], a[232:235], v[244:247], v[108:111]
    v_mfma_f32_16x16x32_bf16 v[104:107], a[252:255], v[248:251], v[104:107]
    ds_write_b128 v201, v[100:103] offset:3072
    v_mfma_f32_16x16x32_bf16 v[108:111], a[252:255], v[252:255], v[108:111]
    v_mfma_f32_16x16x32_bf16 v[80:83], a[160:163], v[216:219], v[120:123]
    v_mfma_f32_16x16x32_bf16 v[84:87], a[160:163], v[220:223], v[124:127]
    v_mfma_f32_16x16x32_bf16 v[80:83], a[180:183], v[224:227], v[80:83]
    v_mfma_f32_16x16x32_bf16 v[84:87], a[180:183], v[228:231], v[84:87]
    v_mfma_f32_16x16x32_bf16 v[80:83], a[200:203], v[232:235], v[80:83]
    s_nop 0
    ds_write_b128 v202, v[104:107] offset:4096
    v_mfma_f32_16x16x32_bf16 v[84:87], a[200:203], v[236:239], v[84:87]
    ds_write_b128 v202, v[108:111] offset:5120
    v_mfma_f32_16x16x32_bf16 v[80:83], a[220:223], v[240:243], v[80:83]
    v_mfma_f32_16x16x32_bf16 v[84:87], a[220:223], v[244:247], v[84:87]
    v_mfma_f32_16x16x32_bf16 v[80:83], a[240:243], v[248:251], v[80:83]
    v_mfma_f32_16x16x32_bf16 v[84:87], a[240:243], v[252:255], v[84:87]
    s_waitcnt lgkmcnt(0)
    s_barrier
    s_nop 0
    ds_read_b128 v[88:91], v204 offset:0
    ds_read_b128 v[92:95], v204 offset:1024
    ds_read_b128 v[96:99], v204 offset:2048
    ds_read_b128 v[100:103], v204 offset:3072
    ds_read_b128 v[104:107], v204 offset:4096
    ds_read_b128 v[108:111], v204 offset:5120
    ds_read_b64 v[112:113], v205 offset:24576
    ds_read_b64 v[114:115], v205 offset:26624
    ds_read_b64 v[116:117], v205 offset:28672
    ds_read_b64 v[118:119], v205 offset:30720
    s_mov_b32 s96, 12062720
    buffer_load_dwordx4 v[216:219], v56, s[16:19], s96 offen offset:0 sc1
    buffer_load_dwordx4 v[220:223], v56, s[16:19], s96 offen offset:256 sc1
    s_mov_b32 s96, 12095488
    buffer_load_dwordx4 v[224:227], v56, s[16:19], s96 offen offset:0 sc1
    buffer_load_dwordx4 v[228:231], v56, s[16:19], s96 offen offset:256 sc1
    s_mov_b32 s96, 12128256
    buffer_load_dwordx4 v[232:235], v56, s[16:19], s96 offen offset:0 sc1
    buffer_load_dwordx4 v[236:239], v56, s[16:19], s96 offen offset:256 sc1
    s_waitcnt lgkmcnt(9)
    v_pk_add_f32 v[80:81], v[80:81], v[88:89]
    v_pk_add_f32 v[82:83], v[82:83], v[90:91]
    s_waitcnt lgkmcnt(8)
    v_pk_add_f32 v[84:85], v[84:85], v[92:93]
    v_pk_add_f32 v[86:87], v[86:87], v[94:95]
    s_waitcnt lgkmcnt(7)
    v_pk_add_f32 v[80:81], v[80:81], v[96:97]
    v_pk_add_f32 v[82:83], v[82:83], v[98:99]
    s_waitcnt lgkmcnt(6)
    v_pk_add_f32 v[84:85], v[84:85], v[100:101]
    v_pk_add_f32 v[86:87], v[86:87], v[102:103]
    s_waitcnt lgkmcnt(5)
    v_pk_add_f32 v[80:81], v[80:81], v[104:105]
    v_pk_add_f32 v[82:83], v[82:83], v[106:107]
    s_waitcnt lgkmcnt(4)
    v_pk_add_f32 v[84:85], v[84:85], v[108:109]
    v_pk_add_f32 v[86:87], v[86:87], v[110:111]
    v_cvt_pk_bf16_f32 v132, v80, v81
    v_cvt_pk_bf16_f32 v133, v82, v83
    v_cvt_pk_bf16_f32 v134, v84, v85
    v_cvt_pk_bf16_f32 v135, v86, v87
    s_waitcnt lgkmcnt(3)
    v_pk_add_f32 v[128:129], v[128:129], v[112:113]
    s_waitcnt lgkmcnt(2)
    v_pk_add_f32 v[128:129], v[128:129], v[114:115]
    s_waitcnt lgkmcnt(1)
    v_pk_add_f32 v[128:129], v[128:129], v[116:117]
    s_waitcnt lgkmcnt(0)
    v_pk_add_f32 v[128:129], v[128:129], v[118:119]
    v_cvt_pk_bf16_f32 v130, v128, v129
    buffer_store_dwordx4 v[132:135], v59, s[16:19], s25 offen sc1
    buffer_store_dword v130, v61, s[16:19], s26 offen sc1
    v_dot2c_f32_bf16 v136, v132, v215
    v_dot2c_f32_bf16 v137, v132, v132
    v_dot2c_f32_bf16 v136, v133, v215
    v_dot2c_f32_bf16 v137, v133, v133
    v_dot2c_f32_bf16 v138, v134, v215
    v_dot2c_f32_bf16 v139, v134, v134
    v_dot2c_f32_bf16 v138, v135, v215
    v_dot2c_f32_bf16 v139, v135, v135
    v_dot2c_f32_bf16 v140, v130, v215
    v_dot2c_f32_bf16 v141, v130, v130
    v_permlane32_swap_b32 v136, v138
    v_permlane32_swap_b32 v137, v139
    v_pk_add_f32 v[136:137], v[136:137], v[138:139]
    v_pk_add_f32 v[136:137], v[136:137], v[140:141]
    s_nop 1
    v_permlane16_swap_b32 v136, v137
    v_add_f32_e64 v136, v136, v137
    ds_write_b32 v206, v136 offset:32768
    s_mov_b32 s96, 12161024
    buffer_load_dwordx4 v[240:243], v56, s[16:19], s96 offen offset:0 sc1
    buffer_load_dwordx4 v[244:247], v56, s[16:19], s96 offen offset:256 sc1
    s_mov_b32 s96, 12060672
    buffer_load_dwordx2 v[248:249], v57, s[16:19], s96 offen offset:0 sc1
    buffer_load_dwordx2 v[252:253], v57, s[16:19], s96 offen offset:128 sc1
    s_mov_b32 s96, 12077056
    buffer_load_dwordx2 v[250:251], v57, s[16:19], s96 offen offset:0 sc1
    buffer_load_dwordx2 v[254:255], v57, s[16:19], s96 offen offset:128 sc1
    s_mov_b32 s96, 9439232
    buffer_load_dwordx4 v[208:211], v59, s[16:19], s96 offen sc1
    s_add_u32 s97, s36, 9439232
    buffer_load_dword v212, v61, s[16:19], s97 offen sc1
    s_waitcnt lgkmcnt(0)
    s_barrier
    ds_read2st64_b32 v[136:137], v207 offset0:0 offset1:1
    ds_read2st64_b32 v[138:139], v207 offset0:2 offset1:3
    ds_read_b64_tr_b16 v[144:145], v65 offset:32
    ds_read_b64_tr_b16 v[146:147], v65 offset:0
    ds_read_b64_tr_b16 v[148:149], v65 offset:160
    ds_read_b64_tr_b16 v[150:151], v65 offset:128
    ds_read_b64_tr_b16 v[152:153], v65 offset:288
    ds_read_b64_tr_b16 v[154:155], v65 offset:256
    ds_read_b64_tr_b16 v[156:157], v65 offset:416
    ds_read_b64_tr_b16 v[158:159], v65 offset:384
    ds_read_b64_tr_b16 v[160:161], v65 offset:544
    ds_read_b64_tr_b16 v[162:163], v65 offset:512
    ds_read_b64_tr_b16 v[164:165], v65 offset:672
    ds_read_b64_tr_b16 v[166:167], v65 offset:640
    ds_read_b64_tr_b16 v[168:169], v65 offset:800
    ds_read_b64_tr_b16 v[170:171], v65 offset:768
    ds_read_b64_tr_b16 v[172:173], v65 offset:928
    ds_read_b64_tr_b16 v[174:175], v65 offset:896
    s_waitcnt lgkmcnt(15)
    v_pk_add_f32 v[136:137], v[136:137], v[138:139]
    v_add_f32 v136, v136, v137
    v_cndmask_b32 v136, v136, 1.0, s[28:29]
    s_mov_b64 exec, s[80:81]
    buffer_atomic_add_f32 v136, v214, s[16:19], s27 offen
    s_mov_b64 exec, -1
    v_lshrrev_b32 v176, 4, v0
    v_mul_u32_u24 v176, 1216, v176
    v_and_b32 v177, 15, v0
    v_lshl_add_u32 v176, v177, 3, v176
    v_add_u32 v176, 64, v176
    v_mov_b32 v178, 0
    v_mov_b32 v179, 0
    ds_write_b64 v176, v[178:179]
    v_mov_b32 v70, 0
    v_mov_b32 v71, 0
    v_mov_b32 v72, 0
oe_78:
    s_waitcnt vmcnt(16)
    v_mfma_f32_16x16x32_bf16 v[112:115], a[176:179], v[216:219], 0
    v_mov_b32 v136, 0
    v_mov_b32 v137, 0
    s_waitcnt vmcnt(15)
    v_mfma_f32_16x16x32_bf16 v[116:119], a[176:179], v[220:223], 0
    v_mov_b32 v138, 0
    v_mov_b32 v139, 0
    s_waitcnt vmcnt(14)
    v_mfma_f32_16x16x32_bf16 v[112:115], a[196:199], v[224:227], v[112:115]
    v_mov_b32 v140, 0
    v_mov_b32 v141, 0
    s_waitcnt vmcnt(13)
    v_mfma_f32_16x16x32_bf16 v[116:119], a[196:199], v[228:231], v[116:119]
    s_mov_b32 s25, 14682112
    s_add_u32 s26, s36, 14682112
    s_waitcnt vmcnt(12)
    v_mfma_f32_16x16x32_bf16 v[112:115], a[216:219], v[232:235], v[112:115]
    s_add_u32 s27, s35, 3510272
    s_mov_b32 s28, 0x99999999
    s_waitcnt vmcnt(11)
    v_mfma_f32_16x16x32_bf16 v[116:119], a[216:219], v[236:239], v[116:119]
    s_mov_b32 s29, 0x99999999
    s_waitcnt vmcnt(8)
    v_mfma_f32_16x16x32_bf16 v[112:115], a[236:239], v[240:243], v[112:115]
    s_waitcnt vmcnt(7)
    v_mfma_f32_16x16x32_bf16 v[116:119], a[236:239], v[244:247], v[116:119]
    s_waitcnt vmcnt(4)
    v_mfma_f32_16x16x32_bf16 v[112:115], v[52:55], v[248:251], v[112:115]
    s_waitcnt vmcnt(3)
    v_mfma_f32_16x16x32_bf16 v[116:119], v[52:55], v[252:255], v[116:119]
    v_mfma_f32_16x16x32_bf16 v[88:91], a[164:167], v[216:219], 0
    v_mfma_f32_16x16x32_bf16 v[92:95], a[164:167], v[220:223], 0
    v_mfma_f32_16x16x32_bf16 v[88:91], a[184:187], v[224:227], v[88:91]
    s_waitcnt vmcnt(2)
    v_max3_u32 v132, v208, v209, v210
    s_waitcnt vmcnt(1)
    v_max3_u32 v132, v132, v211, v212
    v_mfma_f32_16x16x32_bf16 v[92:95], a[184:187], v[228:231], v[92:95]
    v_cmp_eq_u32 s[82:83], -1, v132
    v_mfma_f32_16x16x32_bf16 v[88:91], a[204:207], v[232:235], v[88:91]
    v_mfma_f32_16x16x32_bf16 v[92:95], a[204:207], v[236:239], v[92:95]
    v_cmp_u_f32 vcc, v112, v116
    s_nop 0
    s_or_b64 vcc, vcc, s[82:83]
    s_cbranch_vccnz rd_79
rc_80:
    v_mfma_f32_16x16x32_bf16 v[88:91], a[224:227], v[240:243], v[88:91]
    ds_write_b128 v203, v[112:115] offset:24576
    v_mfma_f32_16x16x32_bf16 v[92:95], a[224:227], v[244:247], v[92:95]
    v_mfma_f32_16x16x32_bf16 v[88:91], a[244:247], v[248:251], v[88:91]
    ds_write_b128 v203, v[116:119] offset:25600
    v_mfma_f32_16x16x32_bf16 v[92:95], a[244:247], v[252:255], v[92:95]
    v_mfma_f32_16x16x32_bf16 v[96:99], a[168:171], v[216:219], 0
    v_lshlrev_b32_e64 v120, 16, v208
    v_and_b32 v121, 0xffff0000, v208
    v_mfma_f32_16x16x32_bf16 v[100:103], a[168:171], v[220:223], 0
    v_lshlrev_b32_e64 v122, 16, v209
    v_and_b32 v123, 0xffff0000, v209
    v_mfma_f32_16x16x32_bf16 v[96:99], a[188:191], v[224:227], v[96:99]
    v_lshlrev_b32_e64 v124, 16, v210
    v_and_b32 v125, 0xffff0000, v210
    v_mfma_f32_16x16x32_bf16 v[100:103], a[188:191], v[228:231], v[100:103]
    v_lshlrev_b32_e64 v126, 16, v211
    v_and_b32 v127, 0xffff0000, v211
    v_mfma_f32_16x16x32_bf16 v[96:99], a[208:211], v[232:235], v[96:99]
    v_lshlrev_b32_e64 v128, 16, v212
    v_and_b32 v129, 0xffff0000, v212
    v_mfma_f32_16x16x32_bf16 v[100:103], a[208:211], v[236:239], v[100:103]
    v_mfma_f32_16x16x32_bf16 v[96:99], a[228:231], v[240:243], v[96:99]
    ds_write_b128 v200, v[88:91] offset:0
    v_mfma_f32_16x16x32_bf16 v[100:103], a[228:231], v[244:247], v[100:103]
    v_mfma_f32_16x16x32_bf16 v[96:99], a[248:251], v[248:251], v[96:99]
    ds_write_b128 v200, v[92:95] offset:1024
    v_mfma_f32_16x16x32_bf16 v[100:103], a[248:251], v[252:255], v[100:103]
    v_mfma_f32_16x16x32_bf16 v[104:107], a[172:175], v[216:219], 0
    v_mfma_f32_16x16x32_bf16 v[108:111], a[172:175], v[220:223], 0
    v_mfma_f32_16x16x32_bf16 v[104:107], a[192:195], v[224:227], v[104:107]
    v_mfma_f32_16x16x32_bf16 v[108:111], a[192:195], v[228:231], v[108:111]
    v_mfma_f32_16x16x32_bf16 v[104:107], a[212:215], v[232:235], v[104:107]
    v_mfma_f32_16x16x32_bf16 v[108:111], a[212:215], v[236:239], v[108:111]
    v_mfma_f32_16x16x32_bf16 v[104:107], a[232:235], v[240:243], v[104:107]
    ds_write_b128 v201, v[96:99] offset:2048
    v_mfma_f32_16x16x32_bf16 v[108:111], a[232:235], v[244:247], v[108:111]
    v_mfma_f32_16x16x32_bf16 v[104:107], a[252:255], v[248:251], v[104:107]
    ds_write_b128 v201, v[100:103] offset:3072
    v_mfma_f32_16x16x32_bf16 v[108:111], a[252:255], v[252:255], v[108:111]
    v_mfma_f32_16x16x32_bf16 v[80:83], a[160:163], v[216:219], v[120:123]
    v_mfma_f32_16x16x32_bf16 v[84:87], a[160:163], v[220:223], v[124:127]
    v_mfma_f32_16x16x32_bf16 v[80:83], a[180:183], v[224:227], v[80:83]
    v_mfma_f32_16x16x32_bf16 v[84:87], a[180:183], v[228:231], v[84:87]
    v_mfma_f32_16x16x32_bf16 v[80:83], a[200:203], v[232:235], v[80:83]
    s_nop 0
    ds_write_b128 v202, v[104:107] offset:4096
    v_mfma_f32_16x16x32_bf16 v[84:87], a[200:203], v[236:239], v[84:87]
    ds_write_b128 v202, v[108:111] offset:5120
    v_mfma_f32_16x16x32_bf16 v[80:83], a[220:223], v[240:243], v[80:83]
    v_mfma_f32_16x16x32_bf16 v[84:87], a[220:223], v[244:247], v[84:87]
    v_mfma_f32_16x16x32_bf16 v[80:83], a[240:243], v[248:251], v[80:83]
    v_mfma_f32_16x16x32_bf16 v[84:87], a[240:243], v[252:255], v[84:87]
    s_waitcnt lgkmcnt(0)
    s_barrier
    s_nop 0
    ds_read_b128 v[88:91], v204 offset:0
    ds_read_b128 v[92:95], v204 offset:1024
    ds_read_b128 v[96:99], v204 offset:2048
    ds_read_b128 v[100:103], v204 offset:3072
    ds_read_b128 v[104:107], v204 offset:4096
    ds_read_b128 v[108:111], v204 offset:5120
    ds_read_b64 v[112:113], v205 offset:24576
    ds_read_b64 v[114:115], v205 offset:26624
    ds_read_b64 v[116:117], v205 offset:28672
    ds_read_b64 v[118:119], v205 offset:30720
    s_lshl_b32 s96, s75, 14
    s_add_u32 s96, s96, 14680064
    s_lshl_b32 s97, s24, 12
    s_add_u32 s97, s97, 3506176
    buffer_load_dwordx4 v[176:179], v62, s[16:19], s96 offen offset:0 sc1
    buffer_load_dwordx4 v[180:183], v62, s[16:19], s96 offen offset:1024 sc1
    buffer_load_dwordx4 v[184:187], v62, s[16:19], s97 offen offset:0 sc1
    buffer_load_dwordx4 v[188:191], v62, s[16:19], s97 offen offset:1024 sc1
    buffer_load_dwordx4 v[192:195], v62, s[16:19], s97 offen offset:2048 sc1
    buffer_load_dwordx4 v[196:199], v62, s[16:19], s97 offen offset:3072 sc1
    s_waitcnt lgkmcnt(9)
    v_pk_add_f32 v[80:81], v[80:81], v[88:89]
    v_pk_add_f32 v[82:83], v[82:83], v[90:91]
    s_waitcnt lgkmcnt(8)
    v_pk_add_f32 v[84:85], v[84:85], v[92:93]
    v_pk_add_f32 v[86:87], v[86:87], v[94:95]
    s_waitcnt lgkmcnt(7)
    v_pk_add_f32 v[80:81], v[80:81], v[96:97]
    v_pk_add_f32 v[82:83], v[82:83], v[98:99]
    s_waitcnt lgkmcnt(6)
    v_pk_add_f32 v[84:85], v[84:85], v[100:101]
    v_pk_add_f32 v[86:87], v[86:87], v[102:103]
    s_waitcnt lgkmcnt(5)
    v_pk_add_f32 v[80:81], v[80:81], v[104:105]
    v_pk_add_f32 v[82:83], v[82:83], v[106:107]
    s_waitcnt lgkmcnt(4)
    v_pk_add_f32 v[84:85], v[84:85], v[108:109]
    v_pk_add_f32 v[86:87], v[86:87], v[110:111]
    v_cvt_pk_bf16_f32 v132, v80, v81
    v_cvt_pk_bf16_f32 v133, v82, v83
    v_cvt_pk_bf16_f32 v134, v84, v85
    v_cvt_pk_bf16_f32 v135, v86, v87
    s_waitcnt lgkmcnt(3)
    v_pk_add_f32 v[128:129], v[128:129], v[112:113]
    s_waitcnt lgkmcnt(2)
    v_pk_add_f32 v[128:129], v[128:129], v[114:115]
    s_waitcnt lgkmcnt(1)
    v_pk_add_f32 v[128:129], v[128:129], v[116:117]
    s_waitcnt lgkmcnt(0)
    v_pk_add_f32 v[128:129], v[128:129], v[118:119]
    v_cvt_pk_bf16_f32 v130, v128, v129
    buffer_store_dwordx4 v[132:135], v59, s[16:19], s25 offen sc1
    buffer_store_dword v130, v61, s[16:19], s26 offen sc1
    v_dot2c_f32_bf16 v136, v132, v215
    v_dot2c_f32_bf16 v137, v132, v132
    v_dot2c_f32_bf16 v136, v133, v215
    v_dot2c_f32_bf16 v137, v133, v133
    v_dot2c_f32_bf16 v138, v134, v215
    v_dot2c_f32_bf16 v139, v134, v134
    v_dot2c_f32_bf16 v138, v135, v215
    v_dot2c_f32_bf16 v139, v135, v135
    v_dot2c_f32_bf16 v140, v130, v215
    v_dot2c_f32_bf16 v141, v130, v130
    v_permlane32_swap_b32 v136, v138
    v_permlane32_swap_b32 v137, v139
    v_pk_add_f32 v[136:137], v[136:137], v[138:139]
    v_pk_add_f32 v[136:137], v[136:137], v[140:141]
    s_nop 1
    v_permlane16_swap_b32 v136, v137
    v_add_f32 v136, v136, v137
    ds_write_b32 v206, v136 offset:32768
    s_waitcnt lgkmcnt(0)
    s_barrier
    ds_read2st64_b32 v[136:137], v207 offset0:0 offset1:1
    ds_read2st64_b32 v[138:139], v207 offset0:2 offset1:3
    s_waitcnt lgkmcnt(0)
    v_pk_add_f32 v[136:137], v[136:137], v[138:139]
    v_add_f32 v136, v136, v137
    v_cndmask_b32 v136, v136, 1.0, s[28:29]
    s_mov_b64 exec, s[80:81]
    buffer_atomic_add_f32 v136, v214, s[16:19], s27 offen
    s_mov_b64 exec, -1
    s_cmp_ge_u32 s2, 160
    s_cbranch_scc1 nc_81
    s_waitcnt vmcnt(3)
ce_83:
    v_max3_u32 v208, v176, v177, v178
    v_max3_u32 v208, v208, v179, v180
    v_max3_u32 v208, v208, v181, v182
    v_max_u32 v208, v208, v183
    v_cmp_eq_u32 s[82:83], -1, v208
    v_min3_f32 v209, v184, v187, v188
    v_min3_f32 v209, v209, v191, v192
    v_min3_f32 v209, v209, v195, v196
    v_min_f32 v209, v209, v199
    v_cmp_neq_f32 vcc, 0x41000000, v209
    s_nop 0
    s_or_b64 vcc, vcc, s[82:83]
    s_cbranch_vccnz rd_84
rc_85:
    v_mul_f32 v208, 0x3acccccd, v185
    v_mul_f32 v209, 0x3acccccd, v189
    v_mul_f32 v186, 0x3acccccd, v186
    v_mul_f32 v190, 0x3acccccd, v190
    v_fma_f32 v186, -v208, v208, v186
    v_fma_f32 v190, -v209, v209, v190
    v_max_f32 v186, 0, v186
    v_max_f32 v190, 0, v190
    v_add_f32 v186, 0x3727c5ac, v186
    v_add_f32 v190, 0x3727c5ac, v190
    v_rsq_f32 v185, v186
    v_rsq_f32 v189, v190
    v_mul_f32 v186, -v208, v185
    v_mul_f32 v190, -v209, v189
    v_lshlrev_b32 v80, 16, v176
    v_and_b32 v82, 0xffff0000, v176
    v_lshlrev_b32 v84, 16, v177
    v_and_b32 v86, 0xffff0000, v177
    v_lshlrev_b32 v81, 16, v178
    v_and_b32 v83, 0xffff0000, v178
    v_lshlrev_b32 v85, 16, v179
    v_and_b32 v87, 0xffff0000, v179
    v_fma_f32 v208, v80, v185, v186
    v_fma_f32 v209, v81, v189, v190
    v_cvt_pk_bf16_f32 v176, v208, v209
    v_fma_f32 v208, v82, v185, v186
    v_fma_f32 v209, v83, v189, v190
    v_cvt_pk_bf16_f32 v177, v208, v209
    v_fma_f32 v208, v84, v185, v186
    v_fma_f32 v209, v85, v189, v190
    v_cvt_pk_bf16_f32 v178, v208, v209
    v_fma_f32 v208, v86, v185, v186
    v_fma_f32 v209, v87, v189, v190
    v_cvt_pk_bf16_f32 v179, v208, v209
    ds_write_b32 v63, v176 offset:0
    ds_write_b32 v63, v177 offset:4864
    ds_write_b32 v63, v178 offset:9728
    ds_write_b32 v63, v179 offset:14592
    v_mul_f32 v208, 0x3acccccd, v193
    v_mul_f32 v209, 0x3acccccd, v197
    v_mul_f32 v194, 0x3acccccd, v194
    v_mul_f32 v198, 0x3acccccd, v198
    v_fma_f32 v194, -v208, v208, v194
    v_fma_f32 v198, -v209, v209, v198
    v_max_f32 v194, 0, v194
    v_max_f32 v198, 0, v198
    v_add_f32 v194, 0x3727c5ac, v194
    v_add_f32 v198, 0x3727c5ac, v198
    v_rsq_f32 v193, v194
    v_rsq_f32 v197, v198
    v_mul_f32 v194, -v208, v193
    v_mul_f32 v198, -v209, v197
    v_lshlrev_b32 v88, 16, v180
    v_and_b32 v90, 0xffff0000, v180
    v_lshlrev_b32 v92, 16, v181
    v_and_b32 v94, 0xffff0000, v181
    v_lshlrev_b32 v89, 16, v182
    v_and_b32 v91, 0xffff0000, v182
    v_lshlrev_b32 v93, 16, v183
    v_and_b32 v95, 0xffff0000, v183
    v_fma_f32 v208, v88, v193, v194
    v_fma_f32 v209, v89, v197, v198
    v_cvt_pk_bf16_f32 v180, v208, v209
    v_fma_f32 v208, v90, v193, v194
    v_fma_f32 v209, v91, v197, v198
    v_cvt_pk_bf16_f32 v181, v208, v209
    v_fma_f32 v208, v92, v193, v194
    v_fma_f32 v209, v93, v197, v198
    v_cvt_pk_bf16_f32 v182, v208, v209
    v_fma_f32 v208, v94, v193, v194
    v_fma_f32 v209, v95, v197, v198
    v_cvt_pk_bf16_f32 v183, v208, v209
    ds_write_b32 v63, v180 offset:256
    ds_write_b32 v63, v181 offset:5120
    ds_write_b32 v63, v182 offset:9984
    ds_write_b32 v63, v183 offset:14848
    s_waitcnt lgkmcnt(0)
    s_barrier
    ds_read_b128 v[212:215], v64 offset:96
    ds_read_b128 v[216:219], v64 offset:64
    ds_read_b128 v[220:223], v64 offset:32
    ds_read_b128 v[224:227], v64 offset:0
    s_waitcnt lgkmcnt(3)
    v_mfma_f32_32x32x16_bf16 v[96:111], v[212:215], v[144:147], 0
    ds_read_b128 v[228:231], v64 offset:224
    ds_read_b64_tr_b16 v[176:177], v65 offset:1056
    ds_read_b64_tr_b16 v[178:179], v65 offset:1024
    ds_read_b64_tr_b16 v[180:181], v65 offset:1184
    ds_read_b64_tr_b16 v[182:183], v65 offset:1152
    s_waitcnt lgkmcnt(7)
    v_mfma_f32_32x32x16_bf16 v[96:111], v[216:219], v[148:151], v[96:111]
    ds_read_b128 v[232:235], v64 offset:192
    ds_read_b64_tr_b16 v[184:185], v65 offset:1312
    ds_read_b64_tr_b16 v[186:187], v65 offset:1280
    ds_read_b64_tr_b16 v[188:189], v65 offset:1440
    ds_read_b64_tr_b16 v[190:191], v65 offset:1408
    s_waitcnt lgkmcnt(11)
    v_mfma_f32_32x32x16_bf16 v[96:111], v[220:223], v[152:155], v[96:111]
    ds_read_b128 v[236:239], v64 offset:160
    ds_read_b64_tr_b16 v[192:193], v65 offset:1568
    ds_read_b64_tr_b16 v[194:195], v65 offset:1536
    ds_read_b64_tr_b16 v[196:197], v65 offset:1696
    ds_read_b64_tr_b16 v[198:199], v65 offset:1664
    s_waitcnt lgkmcnt(15)
    v_mfma_f32_32x32x16_bf16 v[96:111], v[224:227], v[156:159], v[96:111]
    ds_read_b128 v[240:243], v64 offset:128
    ds_read_b64_tr_b16 v[200:201], v65 offset:1824
    ds_read_b64_tr_b16 v[202:203], v65 offset:1792
    ds_read_b64_tr_b16 v[204:205], v65 offset:1952
    ds_read_b64_tr_b16 v[206:207], v65 offset:1920
    s_waitcnt lgkmcnt(15)
    v_mfma_f32_32x32x16_bf16 v[112:127], v[228:231], v[144:147], 0
    s_nop 4
    s_waitcnt lgkmcnt(14)
    v_mfma_f32_32x32x16_bf16 v[112:127], v[232:235], v[148:151], v[112:127]
    v_cndmask_b32 v208, v99, v72, s[76:77]
    v_cndmask_b32 v209, v103, v99, s[76:77]
    v_cndmask_b32 v210, v107, v103, s[76:77]
    v_cndmask_b32 v211, v111, v107, s[76:77]
    v_mov_b32_e64 v72, v111
    s_waitcnt lgkmcnt(9)
    v_mfma_f32_32x32x16_bf16 v[112:127], v[236:239], v[152:155], v[112:127]
    v_add_f32_dpp v98, v208, v98 wave_ror:1 row_mask:0xf bank_mask:0xf
    v_add_f32_dpp v102, v209, v102 wave_ror:1 row_mask:0xf bank_mask:0xf
    v_add_f32_dpp v106, v210, v106 wave_ror:1 row_mask:0xf bank_mask:0xf
    v_add_f32_dpp v110, v211, v110 wave_ror:1 row_mask:0xf bank_mask:0xf
    v_cndmask_b32 v208, v98, v71, s[76:77]
    s_waitcnt lgkmcnt(4)
    v_mfma_f32_32x32x16_bf16 v[112:127], v[240:243], v[156:159], v[112:127]
    v_cndmask_b32 v209, v102, v98, s[76:77]
    v_cndmask_b32 v210, v106, v102, s[76:77]
    v_cndmask_b32 v211, v110, v106, s[76:77]
    v_mov_b32 v71, v110
    v_add_f32_dpp v97, v208, v97 wave_ror:1 row_mask:0xf bank_mask:0xf
    v_add_f32_dpp v101, v209, v101 wave_ror:1 row_mask:0xf bank_mask:0xf
    v_mfma_f32_32x32x16_bf16 v[112:127], v[212:215], v[160:163], v[112:127]
    ds_read_b128 v[244:247], v64 offset:352
    v_add_f32_dpp v105, v210, v105 wave_ror:1 row_mask:0xf bank_mask:0xf
    v_add_f32_dpp v109, v211, v109 wave_ror:1 row_mask:0xf bank_mask:0xf
    v_cndmask_b32 v208, v97, v70, s[76:77]
    v_cndmask_b32 v209, v101, v97, s[76:77]
    v_cndmask_b32 v210, v105, v101, s[76:77]
    v_mfma_f32_32x32x16_bf16 v[112:127], v[216:219], v[164:167], v[112:127]
    ds_read_b128 v[216:219], v64 offset:320
    v_cndmask_b32 v211, v109, v105, s[76:77]
    v_mov_b32_e64 v70, v109
    v_add_f32_dpp v96, v208, v96 wave_ror:1 row_mask:0xf bank_mask:0xf
    v_add_f32_dpp v100, v209, v100 wave_ror:1 row_mask:0xf bank_mask:0xf
    v_add_f32_dpp v104, v210, v104 wave_ror:1 row_mask:0xf bank_mask:0xf
    v_mfma_f32_32x32x16_bf16 v[112:127], v[220:223], v[168:171], v[112:127]
    ds_read_b128 v[220:223], v64 offset:288
    v_add_f32_dpp v108, v211, v108 wave_ror:1 row_mask:0xf bank_mask:0xf
    ds_write_b32 v66, v96 offset:0
    v_mfma_f32_32x32x16_bf16 v[112:127], v[224:227], v[172:175], v[112:127]
    ds_read_b128 v[224:227], v64 offset:256
    ds_write_b32 v66, v100 offset:64
    ds_write_b32 v66, v104 offset:128
    s_waitcnt lgkmcnt(6)
    v_mfma_f32_32x32x16_bf16 v[128:143], v[244:247], v[144:147], 0
    ds_write_b32 v66, v108 offset:192
    s_nop 2
    s_waitcnt lgkmcnt(6)
    v_mfma_f32_32x32x16_bf16 v[128:143], v[216:219], v[148:151], v[128:143]
    s_nop 2
    v_cndmask_b32 v208, v115, v72, s[76:77]
    v_cndmask_b32 v209, v119, v115, s[76:77]
    s_waitcnt lgkmcnt(5)
    v_mfma_f32_32x32x16_bf16 v[128:143], v[220:223], v[152:155], v[128:143]
    v_cndmask_b32 v210, v123, v119, s[76:77]
    v_cndmask_b32 v211, v127, v123, s[76:77]
    v_mov_b32 v72, v127
    v_add_f32_dpp v114, v208, v114 wave_ror:1 row_mask:0xf bank_mask:0xf
    v_add_f32_dpp v118, v209, v118 wave_ror:1 row_mask:0xf bank_mask:0xf
    s_waitcnt lgkmcnt(3)
    v_mfma_f32_32x32x16_bf16 v[128:143], v[224:227], v[156:159], v[128:143]
    v_add_f32_dpp v122, v210, v122 wave_ror:1 row_mask:0xf bank_mask:0xf
    v_add_f32_dpp v126, v211, v126 wave_ror:1 row_mask:0xf bank_mask:0xf
    v_cndmask_b32 v208, v114, v71, s[76:77]
    v_cndmask_b32 v209, v118, v114, s[76:77]
    v_cndmask_b32 v210, v122, v118, s[76:77]
    v_cndmask_b32 v211, v126, v122, s[76:77]
    v_mfma_f32_32x32x16_bf16 v[128:143], v[228:231], v[160:163], v[128:143]
    v_mov_b32 v71, v126
    v_add_f32_dpp v113, v208, v113 wave_ror:1 row_mask:0xf bank_mask:0xf
    v_add_f32_dpp v117, v209, v117 wave_ror:1 row_mask:0xf bank_mask:0xf
    v_add_f32_dpp v121, v210, v121 wave_ror:1 row_mask:0xf bank_mask:0xf
    v_add_f32_dpp v125, v211, v125 wave_ror:1 row_mask:0xf bank_mask:0xf
    v_cndmask_b32 v208, v113, v70, s[76:77]
    v_mfma_f32_32x32x16_bf16 v[128:143], v[232:235], v[164:167], v[128:143]
    ds_read_b128 v[232:235], v64 offset:64
    v_cndmask_b32 v209, v117, v113, s[76:77]
    v_cndmask_b32 v210, v121, v117, s[76:77]
    v_cndmask_b32 v211, v125, v121, s[76:77]
    v_mov_b32_e64 v70, v125
    v_add_f32_dpp v112, v208, v112 wave_ror:1 row_mask:0xf bank_mask:0xf
    v_mfma_f32_32x32x16_bf16 v[128:143], v[236:239], v[168:171], v[128:143]
    ds_read_b128 v[236:239], v64 offset:32
    v_add_f32_dpp v116, v209, v116 wave_ror:1 row_mask:0xf bank_mask:0xf
    v_add_f32_dpp v120, v210, v120 wave_ror:1 row_mask:0xf bank_mask:0xf
    v_add_f32_dpp v124, v211, v124 wave_ror:1 row_mask:0xf bank_mask:0xf
    v_mfma_f32_32x32x16_bf16 v[128:143], v[240:243], v[172:175], v[128:143]
    ds_read_b128 v[240:243], v64 offset:0
    ds_write_b32 v66, v112 offset:256
    ds_write_b32 v66, v116 offset:320
    v_mfma_f32_32x32x16_bf16 v[128:143], v[212:215], v[176:179], v[128:143]
    ds_read_b128 v[212:215], v64 offset:480
    ds_write_b32 v66, v120 offset:384
    ds_write_b32 v66, v124 offset:448
    s_waitcnt lgkmcnt(7)
    v_mfma_f32_32x32x16_bf16 v[128:143], v[232:235], v[180:183], v[128:143]
    ds_read_b128 v[232:235], v64 offset:448
    s_waitcnt lgkmcnt(7)
    v_mfma_f32_32x32x16_bf16 v[128:143], v[236:239], v[184:187], v[128:143]
    ds_read_b128 v[236:239], v64 offset:416
    s_waitcnt lgkmcnt(7)
    v_mfma_f32_32x32x16_bf16 v[128:143], v[240:243], v[188:191], v[128:143]
    ds_read_b128 v[240:243], v64 offset:384
    s_nop 3
    s_waitcnt lgkmcnt(5)
    v_mfma_f32_32x32x16_bf16 v[112:127], v[212:215], v[144:147], 0
    s_nop 4
    s_waitcnt lgkmcnt(2)
    v_mfma_f32_32x32x16_bf16 v[112:127], v[232:235], v[148:151], v[112:127]
    v_cndmask_b32 v208, v131, v72, s[76:77]
    v_cndmask_b32 v209, v135, v131, s[76:77]
    v_cndmask_b32 v210, v139, v135, s[76:77]
    v_cndmask_b32 v211, v143, v139, s[76:77]
    v_mov_b32_e64 v72, v143
    s_waitcnt lgkmcnt(1)
    v_mfma_f32_32x32x16_bf16 v[112:127], v[236:239], v[152:155], v[112:127]
    v_add_f32_dpp v130, v208, v130 wave_ror:1 row_mask:0xf bank_mask:0xf
    v_add_f32_dpp v134, v209, v134 wave_ror:1 row_mask:0xf bank_mask:0xf
    v_add_f32_dpp v138, v210, v138 wave_ror:1 row_mask:0xf bank_mask:0xf
    v_add_f32_dpp v142, v211, v142 wave_ror:1 row_mask:0xf bank_mask:0xf
    v_cndmask_b32 v208, v130, v71, s[76:77]
    s_waitcnt lgkmcnt(0)
    v_mfma_f32_32x32x16_bf16 v[112:127], v[240:243], v[156:159], v[112:127]
    v_cndmask_b32 v209, v134, v130, s[76:77]
    v_cndmask_b32 v210, v138, v134, s[76:77]
    v_cndmask_b32 v211, v142, v138, s[76:77]
    v_mov_b32 v71, v142
    v_add_f32_dpp v129, v208, v129 wave_ror:1 row_mask:0xf bank_mask:0xf
    v_add_f32_dpp v133, v209, v133 wave_ror:1 row_mask:0xf bank_mask:0xf
    v_mfma_f32_32x32x16_bf16 v[112:127], v[244:247], v[160:163], v[112:127]
    v_add_f32_dpp v137, v210, v137 wave_ror:1 row_mask:0xf bank_mask:0xf
    v_add_f32_dpp v141, v211, v141 wave_ror:1 row_mask:0xf bank_mask:0xf
    v_cndmask_b32 v208, v129, v70, s[76:77]
    v_cndmask_b32 v209, v133, v129, s[76:77]
    v_cndmask_b32 v210, v137, v133, s[76:77]
    v_cndmask_b32 v211, v141, v137, s[76:77]
    v_mfma_f32_32x32x16_bf16 v[112:127], v[216:219], v[164:167], v[112:127]
    ds_read_b128 v[240:243], v64 offset:192
    v_mov_b32_e64 v70, v141
    v_add_f32_dpp v128, v208, v128 wave_ror:1 row_mask:0xf bank_mask:0xf
    v_add_f32_dpp v132, v209, v132 wave_ror:1 row_mask:0xf bank_mask:0xf
    v_add_f32_dpp v136, v210, v136 wave_ror:1 row_mask:0xf bank_mask:0xf
    v_add_f32_dpp v140, v211, v140 wave_ror:1 row_mask:0xf bank_mask:0xf
    v_mfma_f32_32x32x16_bf16 v[112:127], v[220:223], v[168:171], v[112:127]
    ds_read_b128 v[220:223], v64 offset:160
    ds_write_b32 v66, v128 offset:512
    ds_write_b32 v66, v132 offset:576
    v_mfma_f32_32x32x16_bf16 v[112:127], v[224:227], v[172:175], v[112:127]
    ds_read_b128 v[224:227], v64 offset:128
    ds_write_b32 v66, v136 offset:640
    ds_write_b32 v66, v140 offset:704
    v_mfma_f32_32x32x16_bf16 v[112:127], v[228:231], v[176:179], v[112:127]
    ds_read_b128 v[236:239], v64 offset:96
    s_waitcnt lgkmcnt(7)
    v_mfma_f32_32x32x16_bf16 v[112:127], v[240:243], v[180:183], v[112:127]
    ds_read_b128 v[240:243], v64 offset:64
    s_waitcnt lgkmcnt(7)
    v_mfma_f32_32x32x16_bf16 v[112:127], v[220:223], v[184:187], v[112:127]
    ds_read_b128 v[220:223], v64 offset:32
    s_waitcnt lgkmcnt(5)
    v_mfma_f32_32x32x16_bf16 v[112:127], v[224:227], v[188:191], v[112:127]
    ds_read_b128 v[224:227], v64 offset:0
    s_waitcnt lgkmcnt(3)
    v_mfma_f32_32x32x16_bf16 v[112:127], v[236:239], v[192:195], v[112:127]
    ds_read_b64_tr_b16 v[216:217], v65 offset:544
    ds_read_b64_tr_b16 v[218:219], v65 offset:512
    s_waitcnt lgkmcnt(4)
    v_mfma_f32_32x32x16_bf16 v[112:127], v[240:243], v[196:199], v[112:127]
    ds_read_b64_tr_b16 v[240:241], v65 offset:1056
    ds_read_b64_tr_b16 v[242:243], v65 offset:1024
    s_waitcnt lgkmcnt(5)
    v_mfma_f32_32x32x16_bf16 v[112:127], v[220:223], v[200:203], v[112:127]
    s_waitcnt lgkmcnt(4)
    v_mfma_f32_32x32x16_bf16 v[112:127], v[224:227], v[204:207], v[112:127]
    ds_read_b64_tr_b16 v[224:225], v65 offset:1568
    ds_read_b64_tr_b16 v[226:227], v65 offset:1536
    s_lshl_b32 s96, s75, 14
    s_add_u32 s96, s96, 14680064
    s_lshl_b32 s97, s24, 12
    s_add_u32 s97, s97, 3510272
    buffer_load_dwordx4 v[248:251], v62, s[16:19], s96 offen offset:2048 sc1
    s_waitcnt lgkmcnt(4)
    v_mfma_f32_32x32x16_bf16 v[144:159], v[212:215], v[216:219], 0
    s_nop 3
    v_cndmask_b32 v208, v115, v72, s[76:77]
    s_waitcnt lgkmcnt(2)
    v_mfma_f32_32x32x16_bf16 v[144:159], v[244:247], v[240:243], v[144:159]
    buffer_load_dwordx4 v[252:255], v62, s[16:19], s96 offen offset:3072 sc1
    v_cndmask_b32 v209, v119, v115, s[76:77]
    v_cndmask_b32 v210, v123, v119, s[76:77]
    v_cndmask_b32 v211, v127, v123, s[76:77]
    v_mov_b32_e64 v72, v127
    v_add_f32_dpp v114, v208, v114 wave_ror:1 row_mask:0xf bank_mask:0xf
    v_mfma_f32_32x32x16_bf16 v[160:175], v[212:215], v[240:243], 0
    ds_read_b64_tr_b16 v[216:217], v65 offset:2080
    ds_read_b64_tr_b16 v[218:219], v65 offset:2048
    v_add_f32_dpp v118, v209, v118 wave_ror:1 row_mask:0xf bank_mask:0xf
    v_add_f32_dpp v122, v210, v122 wave_ror:1 row_mask:0xf bank_mask:0xf
    v_add_f32_dpp v126, v211, v126 wave_ror:1 row_mask:0xf bank_mask:0xf
    s_waitcnt lgkmcnt(2)
    v_mfma_f32_32x32x16_bf16 v[144:159], v[228:231], v[224:227], v[144:159]
    buffer_load_dwordx4 v[96:99], v62, s[16:19], s97 offen offset:0 sc1
    v_cndmask_b32 v208, v114, v71, s[76:77]
    v_cndmask_b32 v209, v118, v114, s[76:77]
    v_cndmask_b32 v210, v122, v118, s[76:77]
    v_cndmask_b32 v211, v126, v122, s[76:77]
    v_mov_b32 v71, v126
    v_mfma_f32_32x32x16_bf16 v[160:175], v[244:247], v[224:227], v[160:175]
    v_add_f32_dpp v113, v208, v113 wave_ror:1 row_mask:0xf bank_mask:0xf
    v_add_f32_dpp v117, v209, v117 wave_ror:1 row_mask:0xf bank_mask:0xf
    v_add_f32_dpp v121, v210, v121 wave_ror:1 row_mask:0xf bank_mask:0xf
    v_add_f32_dpp v125, v211, v125 wave_ror:1 row_mask:0xf bank_mask:0xf
    v_cndmask_b32 v208, v113, v70, s[76:77]
    v_cndmask_b32 v209, v117, v113, s[76:77]
    v_mfma_f32_32x32x16_bf16 v[176:191], v[212:215], v[224:227], 0
    buffer_load_dwordx4 v[100:103], v62, s[16:19], s97 offen offset:1024 sc1
    v_cndmask_b32 v210, v121, v117, s[76:77]
    v_cndmask_b32 v211, v125, v121, s[76:77]
    v_mov_b32 v70, v125
    v_add_f32_dpp v112, v208, v112 wave_ror:1 row_mask:0xf bank_mask:0xf
    s_waitcnt lgkmcnt(0)
    v_mfma_f32_32x32x16_bf16 v[144:159], v[236:239], v[216:219], v[144:159]
    ds_read_b64_tr_b16 v[240:241], v65 offset:2592
    ds_read_b64_tr_b16 v[242:243], v65 offset:2560
    v_add_f32_dpp v116, v209, v116 wave_ror:1 row_mask:0xf bank_mask:0xf
    v_add_f32_dpp v120, v210, v120 wave_ror:1 row_mask:0xf bank_mask:0xf
    v_add_f32_dpp v124, v211, v124 wave_ror:1 row_mask:0xf bank_mask:0xf
    v_mfma_f32_32x32x16_bf16 v[160:175], v[228:231], v[216:219], v[160:175]
    buffer_load_dwordx4 v[104:107], v62, s[16:19], s97 offen offset:2048 sc1
    ds_write_b32 v66, v112 offset:768
    ds_write_b32 v66, v116 offset:832
    v_mfma_f32_32x32x16_bf16 v[176:191], v[244:247], v[216:219], v[176:191]
    ds_write_b32 v66, v120 offset:896
    ds_write_b32 v66, v124 offset:960
    v_mfma_f32_32x32x16_bf16 v[192:207], v[212:215], v[216:219], 0
    ds_read_b64_tr_b16 v[212:213], v65 offset:3104
    ds_read_b64_tr_b16 v[214:215], v65 offset:3072
    buffer_load_dwordx4 v[108:111], v62, s[16:19], s97 offen offset:3072 sc1
    s_waitcnt lgkmcnt(6)
    v_mfma_f32_32x32x16_bf16 v[160:175], v[236:239], v[240:243], v[160:175]
    v_mfma_f32_32x32x16_bf16 v[176:191], v[228:231], v[240:243], v[176:191]
    ds_read_b64_tr_b16 v[224:225], v65 offset:3616
    ds_read_b64_tr_b16 v[226:227], v65 offset:3584
    s_waitcnt lgkmcnt(4)
    s_barrier
    v_mfma_f32_32x32x16_bf16 v[192:207], v[244:247], v[240:243], v[192:207]
    ds_read_b64_tr_b16 v[244:245], v65 offset:672
    ds_read_b64_tr_b16 v[246:247], v65 offset:640
    ds_read_b64 v[112:113], v67 offset:0
    ds_read_b64 v[114:115], v67 offset:4224
    ds_read_b64 v[116:117], v67 offset:8448
    s_waitcnt lgkmcnt(7)
    v_mfma_f32_32x32x16_bf16 v[176:191], v[236:239], v[212:215], v[176:191]
    ds_read_b128 v[216:219], v64 offset:320
    ds_read_b64_tr_b16 v[240:241], v65 offset:1184
    ds_read_b64_tr_b16 v[242:243], v65 offset:1152
    ds_read_b64 v[118:119], v67 offset:12672
    ds_read_b64 v[120:121], v67 offset:512
    ds_read_b64 v[122:123], v67 offset:4736
    v_mfma_f32_32x32x16_bf16 v[192:207], v[228:231], v[212:215], v[192:207]
    ds_read_b64 v[124:125], v67 offset:8960
    ds_read_b64 v[126:127], v67 offset:13184
    s_waitcnt lgkmcnt(13)
    v_mfma_f32_32x32x16_bf16 v[192:207], v[236:239], v[224:227], v[192:207]
    ds_read_b128 v[228:231], v64 offset:192
    ds_read_b64_tr_b16 v[236:237], v65 offset:1696
    ds_read_b64_tr_b16 v[238:239], v65 offset:1664
    s_waitcnt lgkmcnt(14)
    v_mfma_f32_32x32x16_bf16 v[144:159], v[232:235], v[244:247], v[144:159]
    s_waitcnt lgkmcnt(8)
    v_mfma_f32_32x32x16_bf16 v[144:159], v[216:219], v[240:243], v[144:159]
    v_mfma_f32_32x32x16_bf16 v[160:175], v[232:235], v[240:243], v[160:175]
    ds_read_b128 v[212:215], v64 offset:64
    ds_read_b64_tr_b16 v[224:225], v65 offset:2208
    ds_read_b64_tr_b16 v[226:227], v65 offset:2176
    s_waitcnt lgkmcnt(6)
    v_add_f32 v112, v112, v80
    s_waitcnt lgkmcnt(3)
    v_mfma_f32_32x32x16_bf16 v[144:159], v[228:231], v[236:239], v[144:159]
    v_add_f32 v113, v113, v81
    v_add_f32 v114, v114, v82
    v_add_f32 v115, v115, v83
    v_add_f32 v116, v116, v84
    v_add_f32 v117, v117, v85
    v_add_f32 v118, v118, v86
    v_mfma_f32_32x32x16_bf16 v[160:175], v[216:219], v[236:239], v[160:175]
    v_add_f32_e64 v119, v119, v87
    v_cvt_pk_bf16_f32 v128, v112, v114
    v_cvt_pk_bf16_f32 v129, v116, v118
    v_cvt_pk_bf16_f32 v130, v113, v115
    v_cvt_pk_bf16_f32 v131, v117, v119
    s_mov_b32 s25, 0
    v_mfma_f32_32x32x16_bf16 v[176:191], v[232:235], v[236:239], v[176:191]
    buffer_store_dwordx2 v[128:129], v68, s[20:23], s25 offen
    s_mov_b32 s25, 5120
    buffer_store_dwordx2 v[130:131], v68, s[20:23], s25 offen
    v_add_f32 v120, v120, v88
    v_add_f32 v121, v121, v89
    s_waitcnt lgkmcnt(0)
    v_mfma_f32_32x32x16_bf16 v[144:159], v[212:215], v[224:227], v[144:159]
    ds_read_b64_tr_b16 v[244:245], v65 offset:2720
    ds_read_b64_tr_b16 v[246:247], v65 offset:2688
    v_add_f32 v122, v122, v90
    v_add_f32 v123, v123, v91
    v_add_f32 v124, v124, v92
    v_add_f32 v125, v125, v93
    v_mfma_f32_32x32x16_bf16 v[160:175], v[228:231], v[224:227], v[160:175]
    v_add_f32 v126, v126, v94
    v_add_f32 v127, v127, v95
    v_cvt_pk_bf16_f32 v132, v120, v122
    v_cvt_pk_bf16_f32 v133, v124, v126
    v_cvt_pk_bf16_f32 v134, v121, v123
    v_cvt_pk_bf16_f32 v135, v125, v127
    v_mfma_f32_32x32x16_bf16 v[176:191], v[216:219], v[224:227], v[176:191]
    s_mov_b32 s25, 655360
    buffer_store_dwordx2 v[132:133], v68, s[20:23], s25 offen
    s_mov_b32 s25, 660480
    buffer_store_dwordx2 v[134:135], v68, s[20:23], s25 offen
    ds_read_b64_tr_b16 v[112:113], v65 offset:32
    ds_read_b64_tr_b16 v[114:115], v65 offset:0
    v_mfma_f32_32x32x16_bf16 v[192:207], v[232:235], v[224:227], v[192:207]
    ds_read_b64_tr_b16 v[232:233], v65 offset:3232
    ds_read_b64_tr_b16 v[234:235], v65 offset:3200
    ds_read_b64_tr_b16 v[116:117], v65 offset:160
    ds_read_b64_tr_b16 v[118:119], v65 offset:128
    ds_read_b64_tr_b16 v[120:121], v65 offset:288
    s_waitcnt lgkmcnt(7)
    v_mfma_f32_32x32x16_bf16 v[160:175], v[212:215], v[244:247], v[160:175]
    ds_read_b64_tr_b16 v[122:123], v65 offset:256
    ds_read_b64_tr_b16 v[124:125], v65 offset:416
    ds_read_b64_tr_b16 v[126:127], v65 offset:384
    ds_read_b64_tr_b16 v[128:129], v65 offset:544
    ds_read_b64_tr_b16 v[130:131], v65 offset:512
    ds_read_b64_tr_b16 v[132:133], v65 offset:672
    v_mfma_f32_32x32x16_bf16 v[176:191], v[228:231], v[244:247], v[176:191]
    ds_read_b64_tr_b16 v[240:241], v65 offset:3744
    ds_read_b64_tr_b16 v[242:243], v65 offset:3712
    ds_read_b64_tr_b16 v[134:135], v65 offset:640
    ds_read_b64_tr_b16 v[136:137], v65 offset:800
    ds_read_b64_tr_b16 v[138:139], v65 offset:768
    ds_read_b64_tr_b16 v[140:141], v65 offset:928
    v_mfma_f32_32x32x16_bf16 v[192:207], v[216:219], v[244:247], v[192:207]
    ds_read_b128 v[216:219], v64 offset:416
    ds_read_b64_tr_b16 v[236:237], v65 offset:800
    ds_read_b64_tr_b16 v[238:239], v65 offset:768
    ds_read_b64_tr_b16 v[142:143], v65 offset:896
    s_waitcnt lgkmcnt(15)
    v_mfma_f32_32x32x16_bf16 v[176:191], v[212:215], v[232:235], v[176:191]
    ds_read_b128 v[224:227], v64 offset:288
    ds_read_b64_tr_b16 v[244:245], v65 offset:1312
    ds_read_b64_tr_b16 v[246:247], v65 offset:1280
    s_waitcnt vmcnt(4)
ce_86:
    v_max3_u32 v208, v248, v249, v250
    v_max3_u32 v208, v208, v251, v252
    v_max3_u32 v208, v208, v253, v254
    v_max_u32 v208, v208, v255
    v_cmp_eq_u32 s[82:83], -1, v208
    v_min3_f32 v209, v96, v99, v100
    v_min3_f32 v209, v209, v103, v104
    v_min3_f32 v209, v209, v107, v108
    v_min_f32 v209, v209, v111
    v_cmp_neq_f32 vcc, 0x41000000, v209
    s_nop 0
    s_or_b64 vcc, vcc, s[82:83]
    s_cbranch_vccnz rd_87
rc_88:
    v_mfma_f32_32x32x16_bf16 v[192:207], v[228:231], v[232:235], v[192:207]
    v_mul_f32 v208, 0x3acccccd, v97
    v_mul_f32 v209, 0x3acccccd, v101
    v_mul_f32 v98, 0x3acccccd, v98
    v_mul_f32 v102, 0x3acccccd, v102
    v_fma_f32 v98, -v208, v208, v98
    s_waitcnt lgkmcnt(11)
    v_mfma_f32_32x32x16_bf16 v[192:207], v[212:215], v[240:243], v[192:207]
    ds_read_b128 v[228:231], v64 offset:160
    ds_read_b64_tr_b16 v[212:213], v65 offset:1824
    ds_read_b64_tr_b16 v[214:215], v65 offset:1792
    v_fma_f32 v102, -v209, v209, v102
    v_max_f32 v98, 0, v98
    s_waitcnt lgkmcnt(7)
    v_mfma_f32_32x32x16_bf16 v[144:159], v[216:219], v[236:239], v[144:159]
    v_max_f32 v102, 0, v102
    v_add_f32 v98, 0x3727c5ac, v98
    v_add_f32 v102, 0x3727c5ac, v102
    v_rsq_f32 v97, v98
    s_waitcnt lgkmcnt(3)
    v_mfma_f32_32x32x16_bf16 v[144:159], v[224:227], v[244:247], v[144:159]
    v_rsq_f32_e64 v101, v102
    v_mul_f32 v98, -v208, v97
    v_mul_f32 v102, -v209, v101
    v_lshlrev_b32_e64 v80, 16, v248
    v_and_b32 v82, 0xffff0000, v248
    v_mfma_f32_32x32x16_bf16 v[160:175], v[216:219], v[244:247], v[160:175]
    ds_read_b64_tr_b16 v[232:233], v65 offset:2336
    ds_read_b64_tr_b16 v[234:235], v65 offset:2304
    v_lshlrev_b32 v84, 16, v249
    v_and_b32 v86, 0xffff0000, v249
    v_lshlrev_b32_e64 v81, 16, v250
    s_waitcnt lgkmcnt(2)
    v_mfma_f32_32x32x16_bf16 v[144:159], v[228:231], v[212:215], v[144:159]
    v_and_b32 v83, 0xffff0000, v250
    v_lshlrev_b32_e64 v85, 16, v251
    v_and_b32 v87, 0xffff0000, v251
    v_fma_f32 v208, v80, v97, v98
    v_fma_f32 v209, v81, v101, v102
    v_cvt_pk_bf16_f32 v248, v208, v209
    v_mfma_f32_32x32x16_bf16 v[160:175], v[224:227], v[212:215], v[160:175]
    v_fma_f32 v208, v82, v97, v98
    v_fma_f32 v209, v83, v101, v102
    v_cvt_pk_bf16_f32 v249, v208, v209
    v_fma_f32 v208, v84, v97, v98
    v_fma_f32 v209, v85, v101, v102
    v_cvt_pk_bf16_f32 v250, v208, v209
    v_mfma_f32_32x32x16_bf16 v[176:191], v[216:219], v[212:215], v[176:191]
    v_fma_f32 v208, v86, v97, v98
    v_fma_f32 v209, v87, v101, v102
    v_cvt_pk_bf16_f32 v251, v208, v209
    s_waitcnt lgkmcnt(0)
    v_mfma_f32_32x32x16_bf16 v[144:159], v[220:223], v[232:235], v[144:159]
    ds_read_b64_tr_b16 v[240:241], v65 offset:2848
    ds_read_b64_tr_b16 v[242:243], v65 offset:2816
    ds_write_b32 v63, v248 offset:512
    ds_write_b32 v63, v249 offset:5376
    v_mfma_f32_32x32x16_bf16 v[160:175], v[228:231], v[232:235], v[160:175]
    ds_write_b32 v63, v250 offset:10240
    ds_write_b32 v63, v251 offset:15104
    v_mul_f32 v208, 0x3acccccd, v105
    v_mul_f32 v209, 0x3acccccd, v109
    v_mfma_f32_32x32x16_bf16 v[176:191], v[224:227], v[232:235], v[176:191]
    v_mul_f32 v106, 0x3acccccd, v106
    v_mul_f32 v110, 0x3acccccd, v110
    v_fma_f32 v106, -v208, v208, v106
    v_fma_f32 v110, -v209, v209, v110
    v_max_f32 v106, 0, v106
    v_max_f32_e64 v110, 0, v110
    v_mfma_f32_32x32x16_bf16 v[192:207], v[216:219], v[232:235], v[192:207]
    ds_read_b64_tr_b16 v[216:217], v65 offset:3360
    ds_read_b64_tr_b16 v[218:219], v65 offset:3328
    v_add_f32 v106, 0x3727c5ac, v106
    v_add_f32 v110, 0x3727c5ac, v110
    s_waitcnt lgkmcnt(6)
    v_mfma_f32_32x32x16_bf16 v[160:175], v[220:223], v[240:243], v[160:175]
    v_rsq_f32 v105, v106
    v_rsq_f32_e64 v109, v110
    v_mul_f32 v106, -v208, v105
    v_mul_f32 v110, -v209, v109
    v_mfma_f32_32x32x16_bf16 v[176:191], v[228:231], v[240:243], v[176:191]
    ds_read_b64_tr_b16 v[236:237], v65 offset:3872
    ds_read_b64_tr_b16 v[238:239], v65 offset:3840
    v_lshlrev_b32 v88, 16, v252
    v_and_b32 v90, 0xffff0000, v252
    v_lshlrev_b32 v92, 16, v253
    v_and_b32 v94, 0xffff0000, v253
    v_mfma_f32_32x32x16_bf16 v[192:207], v[224:227], v[240:243], v[192:207]
    ds_read_b128 v[224:227], v64 offset:384
    ds_read_b64_tr_b16 v[244:245], v65 offset:928
    ds_read_b64_tr_b16 v[246:247], v65 offset:896
    v_lshlrev_b32 v89, 16, v254
    v_and_b32 v91, 0xffff0000, v254
    s_waitcnt lgkmcnt(5)
    v_mfma_f32_32x32x16_bf16 v[176:191], v[220:223], v[216:219], v[176:191]
    ds_read_b128 v[212:215], v64 offset:256
    ds_read_b64_tr_b16 v[232:233], v65 offset:1440
    ds_read_b64_tr_b16 v[234:235], v65 offset:1408
    v_lshlrev_b32_e64 v93, 16, v255
    v_and_b32 v95, 0xffff0000, v255
    v_fma_f32 v208, v88, v105, v106
    v_mfma_f32_32x32x16_bf16 v[192:207], v[228:231], v[216:219], v[192:207]
    v_fma_f32 v209, v89, v109, v110
    v_cvt_pk_bf16_f32 v252, v208, v209
    v_fma_f32 v208, v90, v105, v106
    v_fma_f32 v209, v91, v109, v110
    v_cvt_pk_bf16_f32 v253, v208, v209
    s_waitcnt lgkmcnt(6)
    v_mfma_f32_32x32x16_bf16 v[192:207], v[220:223], v[236:239], v[192:207]
    ds_read_b128 v[220:223], v64 offset:128
    ds_read_b64_tr_b16 v[228:229], v65 offset:1952
    ds_read_b64_tr_b16 v[230:231], v65 offset:1920
    v_fma_f32 v208, v92, v105, v106
    v_fma_f32 v209, v93, v109, v110
    s_waitcnt lgkmcnt(6)
    v_mfma_f32_32x32x16_bf16 v[144:159], v[224:227], v[244:247], v[144:159]
    v_cvt_pk_bf16_f32 v254, v208, v209
    v_fma_f32 v208, v94, v105, v106
    v_fma_f32 v209, v95, v109, v110
    v_cvt_pk_bf16_f32 v255, v208, v209
    s_waitcnt lgkmcnt(3)
    v_mfma_f32_32x32x16_bf16 v[144:159], v[212:215], v[232:235], v[144:159]
    ds_write_b32 v63, v252 offset:768
    ds_write_b32 v63, v253 offset:5632
    ds_write_b32 v63, v254 offset:10496
    v_mfma_f32_32x32x16_bf16 v[160:175], v[224:227], v[232:235], v[160:175]
    ds_read_b128 v[240:243], v64 offset:0
    ds_read_b64_tr_b16 v[216:217], v65 offset:2464
    ds_read_b64_tr_b16 v[218:219], v65 offset:2432
    ds_write_b32 v63, v255 offset:15360
    s_waitcnt lgkmcnt(7)
    v_mfma_f32_32x32x16_bf16 v[144:159], v[220:223], v[228:231], v[144:159]
    v_mfma_f32_32x32x16_bf16 v[160:175], v[212:215], v[228:231], v[160:175]
    v_mfma_f32_32x32x16_bf16 v[176:191], v[224:227], v[228:231], v[176:191]
    s_waitcnt lgkmcnt(1)
    v_mfma_f32_32x32x16_bf16 v[144:159], v[240:243], v[216:219], v[144:159]
    ds_read_b64_tr_b16 v[236:237], v65 offset:2976
    ds_read_b64_tr_b16 v[238:239], v65 offset:2944
    v_mfma_f32_32x32x16_bf16 v[160:175], v[220:223], v[216:219], v[160:175]
    v_mfma_f32_32x32x16_bf16 v[176:191], v[212:215], v[216:219], v[176:191]
    v_mfma_f32_32x32x16_bf16 v[192:207], v[224:227], v[216:219], v[192:207]
    ds_read_b64_tr_b16 v[224:225], v65 offset:3488
    ds_read_b64_tr_b16 v[226:227], v65 offset:3456
    s_waitcnt lgkmcnt(2)
    v_mfma_f32_32x32x16_bf16 v[160:175], v[240:243], v[236:239], v[160:175]
    v_mfma_f32_32x32x16_bf16 v[176:191], v[220:223], v[236:239], v[176:191]
    ds_read_b64_tr_b16 v[244:245], v65 offset:4000
    ds_read_b64_tr_b16 v[246:247], v65 offset:3968
    v_mfma_f32_32x32x16_bf16 v[192:207], v[212:215], v[236:239], v[192:207]
    s_waitcnt lgkmcnt(2)
    v_mfma_f32_32x32x16_bf16 v[176:191], v[240:243], v[224:227], v[176:191]
    v_mfma_f32_32x32x16_bf16 v[192:207], v[220:223], v[224:227], v[192:207]
    s_waitcnt lgkmcnt(0)
    v_mfma_f32_32x32x16_bf16 v[192:207], v[240:243], v[244:247], v[192:207]
    s_waitcnt lgkmcnt(0)
    s_barrier
    ds_read_b128 v[212:215], v64 offset:608
    ds_read_b128 v[216:219], v64 offset:576
    ds_read_b128 v[220:223], v64 offset:544
    ds_read_b128 v[224:227], v64 offset:512
    s_waitcnt lgkmcnt(3)
    v_mfma_f32_32x32x16_bf16 v[144:159], v[212:215], v[112:115], v[144:159]
    ds_read_b128 v[228:231], v64 offset:736
    s_waitcnt lgkmcnt(3)
    v_mfma_f32_32x32x16_bf16 v[144:159], v[216:219], v[116:119], v[144:159]
    ds_read_b128 v[232:235], v64 offset:704
    s_waitcnt lgkmcnt(3)
    v_mfma_f32_32x32x16_bf16 v[144:159], v[220:223], v[120:123], v[144:159]
    ds_read_b128 v[236:239], v64 offset:672
    s_waitcnt lgkmcnt(3)
    v_mfma_f32_32x32x16_bf16 v[144:159], v[224:227], v[124:127], v[144:159]
    ds_read_b128 v[240:243], v64 offset:640
    s_nop 3
    s_waitcnt lgkmcnt(3)
    v_mfma_f32_32x32x16_bf16 v[160:175], v[228:231], v[112:115], v[160:175]
    s_nop 4
    s_waitcnt lgkmcnt(2)
    v_mfma_f32_32x32x16_bf16 v[160:175], v[232:235], v[116:119], v[160:175]
    v_cndmask_b32 v208, v147, v72, s[76:77]
    v_cndmask_b32 v209, v151, v147, s[76:77]
    v_cndmask_b32 v210, v155, v151, s[76:77]
    v_cndmask_b32 v211, v159, v155, s[76:77]
    v_mov_b32 v72, v159
    s_waitcnt lgkmcnt(1)
    v_mfma_f32_32x32x16_bf16 v[160:175], v[236:239], v[120:123], v[160:175]
    v_add_f32_dpp v146, v208, v146 wave_ror:1 row_mask:0xf bank_mask:0xf
    v_add_f32_dpp v150, v209, v150 wave_ror:1 row_mask:0xf bank_mask:0xf
    v_add_f32_dpp v154, v210, v154 wave_ror:1 row_mask:0xf bank_mask:0xf
    v_add_f32_dpp v158, v211, v158 wave_ror:1 row_mask:0xf bank_mask:0xf
    v_cndmask_b32 v208, v146, v71, s[76:77]
    s_waitcnt lgkmcnt(0)
    v_mfma_f32_32x32x16_bf16 v[160:175], v[240:243], v[124:127], v[160:175]
    v_cndmask_b32 v209, v150, v146, s[76:77]
    v_cndmask_b32 v210, v154, v150, s[76:77]
    v_cndmask_b32 v211, v158, v154, s[76:77]
    v_mov_b32 v71, v158
    v_add_f32_dpp v145, v208, v145 wave_ror:1 row_mask:0xf bank_mask:0xf
    v_add_f32_dpp v149, v209, v149 wave_ror:1 row_mask:0xf bank_mask:0xf
    v_mfma_f32_32x32x16_bf16 v[160:175], v[212:215], v[128:131], v[160:175]
    ds_read_b128 v[244:247], v64 offset:864
    v_add_f32_dpp v153, v210, v153 wave_ror:1 row_mask:0xf bank_mask:0xf
    v_add_f32_dpp v157, v211, v157 wave_ror:1 row_mask:0xf bank_mask:0xf
    v_cndmask_b32 v208, v145, v70, s[76:77]
    v_cndmask_b32 v209, v149, v145, s[76:77]
    v_cndmask_b32 v210, v153, v149, s[76:77]
    v_mfma_f32_32x32x16_bf16 v[160:175], v[216:219], v[132:135], v[160:175]
    ds_read_b128 v[248:251], v64 offset:832
    v_cndmask_b32 v211, v157, v153, s[76:77]
    v_mov_b32_e64 v70, v157
    v_add_f32_dpp v144, v208, v144 wave_ror:1 row_mask:0xf bank_mask:0xf
    v_add_f32_dpp v148, v209, v148 wave_ror:1 row_mask:0xf bank_mask:0xf
    v_add_f32_dpp v152, v210, v152 wave_ror:1 row_mask:0xf bank_mask:0xf
    v_mfma_f32_32x32x16_bf16 v[160:175], v[220:223], v[136:139], v[160:175]
    ds_read_b128 v[252:255], v64 offset:800
    v_add_f32_dpp v156, v211, v156 wave_ror:1 row_mask:0xf bank_mask:0xf
    ds_write_b32 v66, v144 offset:0
    v_mfma_f32_32x32x16_bf16 v[160:175], v[224:227], v[140:143], v[160:175]
    ds_read_b128 v[224:227], v64 offset:768
    ds_write_b32 v66, v148 offset:64
    ds_write_b32 v66, v152 offset:128
    s_waitcnt lgkmcnt(6)
    v_mfma_f32_32x32x16_bf16 v[176:191], v[244:247], v[112:115], v[176:191]
    ds_write_b32 v66, v156 offset:192
    s_nop 2
    s_waitcnt lgkmcnt(6)
    v_mfma_f32_32x32x16_bf16 v[176:191], v[248:251], v[116:119], v[176:191]
    s_nop 2
    v_cndmask_b32 v208, v163, v72, s[76:77]
    v_cndmask_b32 v209, v167, v163, s[76:77]
    s_waitcnt lgkmcnt(5)
    v_mfma_f32_32x32x16_bf16 v[176:191], v[252:255], v[120:123], v[176:191]
    v_cndmask_b32 v210, v171, v167, s[76:77]
    v_cndmask_b32 v211, v175, v171, s[76:77]
    v_mov_b32 v72, v175
    v_add_f32_dpp v162, v208, v162 wave_ror:1 row_mask:0xf bank_mask:0xf
    v_add_f32_dpp v166, v209, v166 wave_ror:1 row_mask:0xf bank_mask:0xf
    s_waitcnt lgkmcnt(3)
    v_mfma_f32_32x32x16_bf16 v[176:191], v[224:227], v[124:127], v[176:191]
    v_add_f32_dpp v170, v210, v170 wave_ror:1 row_mask:0xf bank_mask:0xf
    v_add_f32_dpp v174, v211, v174 wave_ror:1 row_mask:0xf bank_mask:0xf
    v_cndmask_b32 v208, v162, v71, s[76:77]
    v_cndmask_b32 v209, v166, v162, s[76:77]
    v_cndmask_b32 v210, v170, v166, s[76:77]
    v_cndmask_b32 v211, v174, v170, s[76:77]
    v_mfma_f32_32x32x16_bf16 v[176:191], v[228:231], v[128:131], v[176:191]
    ds_read_b64_tr_b16 v[228:229], v65 offset:1056
    ds_read_b64_tr_b16 v[230:231], v65 offset:1024
    v_mov_b32 v71, v174
    v_add_f32_dpp v161, v208, v161 wave_ror:1 row_mask:0xf bank_mask:0xf
    v_add_f32_dpp v165, v209, v165 wave_ror:1 row_mask:0xf bank_mask:0xf
    v_add_f32_dpp v169, v210, v169 wave_ror:1 row_mask:0xf bank_mask:0xf
    v_mfma_f32_32x32x16_bf16 v[176:191], v[232:235], v[132:135], v[176:191]
    ds_read_b64_tr_b16 v[232:233], v65 offset:1184
    ds_read_b64_tr_b16 v[234:235], v65 offset:1152
    v_add_f32_dpp v173, v211, v173 wave_ror:1 row_mask:0xf bank_mask:0xf
    v_cndmask_b32 v208, v161, v70, s[76:77]
    v_cndmask_b32 v209, v165, v161, s[76:77]
    v_cndmask_b32 v210, v169, v165, s[76:77]
    v_mfma_f32_32x32x16_bf16 v[176:191], v[236:239], v[136:139], v[176:191]
    ds_read_b64_tr_b16 v[236:237], v65 offset:1312
    ds_read_b64_tr_b16 v[238:239], v65 offset:1280
    v_cndmask_b32 v211, v173, v169, s[76:77]
    v_mov_b32_e64 v70, v173
    v_add_f32_dpp v160, v208, v160 wave_ror:1 row_mask:0xf bank_mask:0xf
    v_add_f32_dpp v164, v209, v164 wave_ror:1 row_mask:0xf bank_mask:0xf
    v_mfma_f32_32x32x16_bf16 v[176:191], v[240:243], v[140:143], v[176:191]
    ds_read_b128 v[240:243], v64 offset:512
    ds_read_b64_tr_b16 v[224:225], v65 offset:1440
    ds_read_b64_tr_b16 v[226:227], v65 offset:1408
    v_add_f32_dpp v168, v210, v168 wave_ror:1 row_mask:0xf bank_mask:0xf
    v_add_f32_dpp v172, v211, v172 wave_ror:1 row_mask:0xf bank_mask:0xf
    s_waitcnt lgkmcnt(7)
    v_mfma_f32_32x32x16_bf16 v[176:191], v[212:215], v[228:231], v[176:191]
    ds_read_b128 v[212:215], v64 offset:992
    ds_write_b32 v66, v160 offset:256
    ds_write_b32 v66, v164 offset:320
    s_waitcnt lgkmcnt(8)
    v_mfma_f32_32x32x16_bf16 v[176:191], v[216:219], v[232:235], v[176:191]
    ds_read_b128 v[216:219], v64 offset:960
    ds_write_b32 v66, v168 offset:384
    ds_write_b32 v66, v172 offset:448
    s_waitcnt lgkmcnt(9)
    v_mfma_f32_32x32x16_bf16 v[176:191], v[220:223], v[236:239], v[176:191]
    ds_read_b128 v[220:223], v64 offset:928
    s_waitcnt lgkmcnt(7)
    v_mfma_f32_32x32x16_bf16 v[176:191], v[240:243], v[224:227], v[176:191]
    ds_read_b128 v[240:243], v64 offset:896
    s_waitcnt lgkmcnt(2)
    s_barrier
    v_mfma_f32_32x32x16_bf16 v[192:207], v[212:215], v[112:115], v[192:207]
    ds_read_b64 v[144:145], v67 offset:0
    ds_read_b64 v[146:147], v67 offset:4224
    ds_read_b64 v[148:149], v67 offset:8448
    ds_read_b64 v[150:151], v67 offset:12672
    s_nop 0
    v_mfma_f32_32x32x16_bf16 v[192:207], v[216:219], v[116:119], v[192:207]
    s_nop 2
    v_cndmask_b32 v208, v179, v72, s[76:77]
    v_cndmask_b32 v209, v183, v179, s[76:77]
    s_waitcnt lgkmcnt(5)
    v_mfma_f32_32x32x16_bf16 v[192:207], v[220:223], v[120:123], v[192:207]
    v_cndmask_b32 v210, v187, v183, s[76:77]
    v_cndmask_b32 v211, v191, v187, s[76:77]
    v_mov_b32 v72, v191
    v_add_f32_dpp v178, v208, v178 wave_ror:1 row_mask:0xf bank_mask:0xf
    v_add_f32_dpp v182, v209, v182 wave_ror:1 row_mask:0xf bank_mask:0xf
    s_waitcnt lgkmcnt(4)
    v_mfma_f32_32x32x16_bf16 v[192:207], v[240:243], v[124:127], v[192:207]
    ds_read_b128 v[212:215], v64 offset:768
    v_add_f32_dpp v186, v210, v186 wave_ror:1 row_mask:0xf bank_mask:0xf
    v_add_f32_dpp v190, v211, v190 wave_ror:1 row_mask:0xf bank_mask:0xf
    v_cndmask_b32 v208, v178, v71, s[76:77]
    v_cndmask_b32 v209, v182, v178, s[76:77]
    v_cndmask_b32 v210, v186, v182, s[76:77]
    v_mfma_f32_32x32x16_bf16 v[192:207], v[244:247], v[128:131], v[192:207]
    ds_read_b128 v[244:247], v64 offset:736
    v_cndmask_b32 v211, v190, v186, s[76:77]
    v_mov_b32 v71, v190
    v_add_f32_dpp v177, v208, v177 wave_ror:1 row_mask:0xf bank_mask:0xf
    v_add_f32_dpp v181, v209, v181 wave_ror:1 row_mask:0xf bank_mask:0xf
    v_add_f32_dpp v185, v210, v185 wave_ror:1 row_mask:0xf bank_mask:0xf
    v_mfma_f32_32x32x16_bf16 v[192:207], v[248:251], v[132:135], v[192:207]
    ds_read_b128 v[248:251], v64 offset:704
    v_add_f32_dpp v189, v211, v189 wave_ror:1 row_mask:0xf bank_mask:0xf
    v_cndmask_b32 v208, v177, v70, s[76:77]
    v_cndmask_b32 v209, v181, v177, s[76:77]
    v_cndmask_b32 v210, v185, v181, s[76:77]
    v_cndmask_b32 v211, v189, v185, s[76:77]
    v_mfma_f32_32x32x16_bf16 v[192:207], v[252:255], v[136:139], v[192:207]
    ds_read_b128 v[252:255], v64 offset:672
    v_mov_b32_e64 v70, v189
    v_add_f32_dpp v176, v208, v176 wave_ror:1 row_mask:0xf bank_mask:0xf
    v_add_f32_dpp v180, v209, v180 wave_ror:1 row_mask:0xf bank_mask:0xf
    v_add_f32_dpp v184, v210, v184 wave_ror:1 row_mask:0xf bank_mask:0xf
    s_waitcnt lgkmcnt(3)
    v_mfma_f32_32x32x16_bf16 v[192:207], v[212:215], v[140:143], v[192:207]
    ds_read_b128 v[216:219], v64 offset:640
    v_add_f32_dpp v188, v211, v188 wave_ror:1 row_mask:0xf bank_mask:0xf
    s_waitcnt lgkmcnt(3)
    v_mfma_f32_32x32x16_bf16 v[192:207], v[244:247], v[228:231], v[192:207]
    ds_read_b128 v[228:231], v64 offset:608
    ds_read_b64_tr_b16 v[220:221], v65 offset:1568
    ds_read_b64_tr_b16 v[222:223], v65 offset:1536
    ds_write_b32 v66, v176 offset:512
    s_waitcnt lgkmcnt(6)
    v_mfma_f32_32x32x16_bf16 v[192:207], v[248:251], v[232:235], v[192:207]
    ds_read_b128 v[232:235], v64 offset:576
    ds_read_b64_tr_b16 v[240:241], v65 offset:1696
    ds_read_b64_tr_b16 v[242:243], v65 offset:1664
    ds_write_b32 v66, v180 offset:576
    s_waitcnt lgkmcnt(9)
    v_mfma_f32_32x32x16_bf16 v[192:207], v[252:255], v[236:239], v[192:207]
    ds_read_b128 v[236:239], v64 offset:544
    ds_read_b64_tr_b16 v[212:213], v65 offset:1824
    ds_read_b64_tr_b16 v[214:215], v65 offset:1792
    ds_write_b32 v66, v184 offset:640
    s_waitcnt lgkmcnt(12)
    v_mfma_f32_32x32x16_bf16 v[192:207], v[216:219], v[224:227], v[192:207]
    ds_read_b128 v[224:227], v64 offset:512
    ds_read_b64_tr_b16 v[244:245], v65 offset:1952
    ds_read_b64_tr_b16 v[246:247], v65 offset:1920
    ds_write_b32 v66, v188 offset:704
    s_waitcnt lgkmcnt(13)
    v_mfma_f32_32x32x16_bf16 v[192:207], v[228:231], v[220:223], v[192:207]
    v_add_f32 v144, v144, v80
    v_add_f32 v145, v145, v81
    v_add_f32 v146, v146, v82
    v_add_f32 v147, v147, v83
    s_waitcnt lgkmcnt(9)
    v_mfma_f32_32x32x16_bf16 v[192:207], v[232:235], v[240:243], v[192:207]
    v_add_f32 v148, v148, v84
    v_add_f32 v149, v149, v85
    v_add_f32 v150, v150, v86
    v_add_f32 v151, v151, v87
    v_cvt_pk_bf16_f32 v160, v144, v146
    s_waitcnt lgkmcnt(5)
    v_mfma_f32_32x32x16_bf16 v[192:207], v[236:239], v[212:215], v[192:207]
    v_cvt_pk_bf16_f32 v161, v148, v150
    v_cvt_pk_bf16_f32 v162, v145, v147
    v_cvt_pk_bf16_f32 v163, v149, v151
    s_mov_b32 s25, 1310720
    s_waitcnt lgkmcnt(1)
    v_mfma_f32_32x32x16_bf16 v[192:207], v[224:227], v[244:247], v[192:207]
    buffer_store_dwordx2 v[160:161], v68, s[20:23], s25 offen
    s_mov_b32 s25, 1315840
    buffer_store_dwordx2 v[162:163], v68, s[20:23], s25 offen
    s_nop 8
    v_cndmask_b32 v208, v195, v72, s[76:77]
    v_cndmask_b32 v209, v199, v195, s[76:77]
    v_cndmask_b32 v210, v203, v199, s[76:77]
    v_cndmask_b32 v211, v207, v203, s[76:77]
    v_mov_b32_e64 v72, v207
    v_add_f32_dpp v194, v208, v194 wave_ror:1 row_mask:0xf bank_mask:0xf
    v_add_f32_dpp v198, v209, v198 wave_ror:1 row_mask:0xf bank_mask:0xf
    v_add_f32_dpp v202, v210, v202 wave_ror:1 row_mask:0xf bank_mask:0xf
    v_add_f32_dpp v206, v211, v206 wave_ror:1 row_mask:0xf bank_mask:0xf
    v_cndmask_b32 v208, v194, v71, s[76:77]
    v_cndmask_b32 v209, v198, v194, s[76:77]
    v_cndmask_b32 v210, v202, v198, s[76:77]
    v_cndmask_b32 v211, v206, v202, s[76:77]
    v_mov_b32_e64 v71, v206
    v_add_f32_dpp v193, v208, v193 wave_ror:1 row_mask:0xf bank_mask:0xf
    v_add_f32_dpp v197, v209, v197 wave_ror:1 row_mask:0xf bank_mask:0xf
    v_add_f32_dpp v201, v210, v201 wave_ror:1 row_mask:0xf bank_mask:0xf
    v_add_f32_dpp v205, v211, v205 wave_ror:1 row_mask:0xf bank_mask:0xf
    v_cndmask_b32 v208, v193, v70, s[76:77]
    v_cndmask_b32 v209, v197, v193, s[76:77]
    v_cndmask_b32 v210, v201, v197, s[76:77]
    v_cndmask_b32 v211, v205, v201, s[76:77]
    v_mov_b32_e64 v70, v205
    v_add_f32_dpp v192, v208, v192 wave_ror:1 row_mask:0xf bank_mask:0xf
    v_add_f32_dpp v196, v209, v196 wave_ror:1 row_mask:0xf bank_mask:0xf
    v_add_f32_dpp v200, v210, v200 wave_ror:1 row_mask:0xf bank_mask:0xf
    v_add_f32_dpp v204, v211, v204 wave_ror:1 row_mask:0xf bank_mask:0xf
    ds_write_b32 v66, v192 offset:768
    ds_write_b32 v66, v196 offset:832
    ds_write_b32 v66, v200 offset:896
    ds_write_b32 v66, v204 offset:960
    s_waitcnt lgkmcnt(0)
    s_barrier
    ds_read_b64 v[152:153], v67 offset:512
    ds_read_b64 v[154:155], v67 offset:4736
    ds_read_b64 v[156:157], v67 offset:8960
    ds_read_b64 v[158:159], v67 offset:13184
    s_waitcnt lgkmcnt(0)
    v_add_f32 v152, v152, v88
    v_add_f32 v153, v153, v89
    v_add_f32 v154, v154, v90
    v_add_f32 v155, v155, v91
    v_add_f32 v156, v156, v92
    v_add_f32 v157, v157, v93
    v_add_f32 v158, v158, v94
    v_add_f32_e64 v159, v159, v95
    v_cvt_pk_bf16_f32 v164, v152, v154
    v_cvt_pk_bf16_f32 v165, v156, v158
    v_cvt_pk_bf16_f32 v166, v153, v155
    v_cvt_pk_bf16_f32 v167, v157, v159
    s_mov_b32 s25, 1966080
    buffer_store_dwordx2 v[164:165], v68, s[20:23], s25 offen
    s_mov_b32 s25, 1971200
    buffer_store_dwordx2 v[166:167], v68, s[20:23], s25 offen
    s_branch ec_82
nc_81:
ec_82:
L_end:
    s_endpgm
ps_5:
    s_mov_b32 s84, 1048576
pl_6:
    global_load_dword v7, v5, s[66:67] sc1
    s_waitcnt vmcnt(0)
    s_sub_u32 s84, s84, 1
    s_cbranch_scc1 pc_7
    v_cmp_gt_u32_e64 vcc, 1, v7
    s_nop 0
    s_and_b64 vcc, vcc, s[50:51]
    s_and_b64 vcc, vcc, 1
    s_cbranch_scc1 pl_6
    s_branch pc_7
ps_8:
    s_mov_b32 s84, 1048576
pl_9:
    buffer_load_dword v7, v4, s[16:19], s87 offen offset:0 sc1
    s_waitcnt vmcnt(0)
    s_sub_u32 s84, s84, 1
    s_cbranch_scc1 pc_10
    v_cmp_gt_u32 vcc, 32, v7
    s_nop 0
    s_and_b64 vcc, vcc, s[50:51]
    s_cbranch_scc1 pl_9
    s_branch pc_10
ps_11:
    s_mov_b32 s84, 1048576
pl_12:
    global_load_dword v7, v5, s[66:67] sc1
    s_waitcnt vmcnt(0)
    s_sub_u32 s84, s84, 1
    s_cbranch_scc1 pc_13
    v_cmp_gt_u32_e64 vcc, 1, v7
    s_nop 0
    s_and_b64 vcc, vcc, s[50:51]
    s_and_b64 vcc, vcc, 1
    s_cbranch_scc1 pl_12
    s_branch pc_13
ps_14:
    s_mov_b32 s84, 1048576
pl_15:
    buffer_load_dword v7, v4, s[16:19], s87 offen offset:0 sc1
    s_waitcnt vmcnt(0)
    s_sub_u32 s84, s84, 1
    s_cbranch_scc1 pc_16
    v_cmp_gt_u32 vcc, 32, v7
    s_nop 0
    s_and_b64 vcc, vcc, s[50:51]
    s_cbranch_scc1 pl_15
    s_branch pc_16
ps_17:
    s_mov_b32 s84, 1048576
pl_18:
    buffer_load_dword v7, v4, s[16:19], s89 offen offset:8 sc1
    s_waitcnt vmcnt(0)
    s_sub_u32 s84, s84, 1
    s_cbranch_scc1 pc_19
    v_cmp_gt_u32_e64 vcc, 32, v7
    s_nop 0
    s_and_b64 vcc, vcc, s[50:51]
    s_cbranch_scc1 pl_18
    s_branch pc_19
rd_21:
    s_cmp_eq_u32 s38, 0
    s_cbranch_scc1 rc_22
    s_sub_u32 s38, s38, 1
    s_nop 7
    s_nop 7
    s_sleep 4
    s_mov_b64 exec, vcc
    s_mov_b32 s96, 4194304
    buffer_load_dwordx4 v[216:219], v56, s[16:19], s96 offen offset:0 sc1
    buffer_load_dwordx4 v[220:223], v56, s[16:19], s96 offen offset:256 sc1
    s_mov_b32 s96, 4227072
    buffer_load_dwordx4 v[224:227], v56, s[16:19], s96 offen offset:0 sc1
    buffer_load_dwordx4 v[228:231], v56, s[16:19], s96 offen offset:256 sc1
    s_mov_b32 s96, 4259840
    buffer_load_dwordx4 v[232:235], v56, s[16:19], s96 offen offset:0 sc1
    buffer_load_dwordx4 v[236:239], v56, s[16:19], s96 offen offset:256 sc1
    s_mov_b32 s96, 4292608
    buffer_load_dwordx4 v[240:243], v56, s[16:19], s96 offen offset:0 sc1
    buffer_load_dwordx4 v[244:247], v56, s[16:19], s96 offen offset:256 sc1
    s_mov_b32 s96, 4194304
    buffer_load_dwordx2 v[248:249], v57, s[16:19], s96 offen offset:0 sc1
    buffer_load_dwordx2 v[252:253], v57, s[16:19], s96 offen offset:128 sc1
    s_mov_b32 s96, 4210688
    buffer_load_dwordx2 v[250:251], v57, s[16:19], s96 offen offset:0 sc1
    buffer_load_dwordx2 v[254:255], v57, s[16:19], s96 offen offset:128 sc1
    s_mov_b32 s96, 0
    s_mov_b32 s97, 5120
    s_waitcnt vmcnt(16)
    buffer_load_dwordx2 v[208:209], v60, s[4:7], s96 offen
    s_waitcnt vmcnt(16)
    buffer_load_dwordx2 v[210:211], v60, s[4:7], s97 offen
    s_waitcnt vmcnt(16)
    v_lshrrev_b32_e64 v212, 5, v1
    v_mul_u32_u24 v212, 5104, v212
    v_bfe_u32 v213, v1, 4, 1
    v_lshlrev_b32 v213, 2, v213
    v_sub_u32 v212, v212, v213
    v_add_u32 v212, v212, v60
    s_mul_i32 s97, s24, 24
    s_sub_u32 s97, 128, s97
    buffer_load_dword v212, v212, s[4:7], s97 offen
    s_mov_b64 exec, -1
    s_waitcnt vmcnt(0) lgkmcnt(0)
    s_branch oe_20
rd_24:
    s_cmp_eq_u32 s38, 0
    s_cbranch_scc1 rc_25
    s_sub_u32 s38, s38, 1
    s_nop 7
    s_nop 7
    s_sleep 4
    s_mov_b64 exec, vcc
    s_mov_b32 s96, 4198400
    buffer_load_dwordx4 v[216:219], v56, s[16:19], s96 offen offset:0 sc1
    buffer_load_dwordx4 v[220:223], v56, s[16:19], s96 offen offset:256 sc1
    s_mov_b32 s96, 4231168
    buffer_load_dwordx4 v[224:227], v56, s[16:19], s96 offen offset:0 sc1
    buffer_load_dwordx4 v[228:231], v56, s[16:19], s96 offen offset:256 sc1
    s_mov_b32 s96, 4263936
    buffer_load_dwordx4 v[232:235], v56, s[16:19], s96 offen offset:0 sc1
    buffer_load_dwordx4 v[236:239], v56, s[16:19], s96 offen offset:256 sc1
    s_mov_b32 s96, 4296704
    buffer_load_dwordx4 v[240:243], v56, s[16:19], s96 offen offset:0 sc1
    buffer_load_dwordx4 v[244:247], v56, s[16:19], s96 offen offset:256 sc1
    s_mov_b32 s96, 4196352
    buffer_load_dwordx2 v[248:249], v57, s[16:19], s96 offen offset:0 sc1
    buffer_load_dwordx2 v[252:253], v57, s[16:19], s96 offen offset:128 sc1
    s_mov_b32 s96, 4212736
    buffer_load_dwordx2 v[250:251], v57, s[16:19], s96 offen offset:0 sc1
    buffer_load_dwordx2 v[254:255], v57, s[16:19], s96 offen offset:128 sc1
    s_mov_b32 s96, 1310720
    s_mov_b32 s97, 1315840
    s_waitcnt vmcnt(15)
    buffer_load_dwordx2 v[208:209], v60, s[4:7], s96 offen
    s_waitcnt vmcnt(15)
    buffer_load_dwordx2 v[210:211], v60, s[4:7], s97 offen
    s_waitcnt vmcnt(15)
    v_lshrrev_b32 v212, 5, v1
    v_mul_u32_u24 v212, 5104, v212
    v_bfe_u32 v213, v1, 4, 1
    v_lshlrev_b32 v213, 2, v213
    v_sub_u32 v212, v212, v213
    v_add_u32 v212, v212, v60
    s_mul_i32 s97, s24, 24
    s_sub_u32 s97, 1310848, s97
    buffer_load_dword v212, v212, s[4:7], s97 offen
    s_mov_b64 exec, -1
    s_waitcnt vmcnt(0) lgkmcnt(0)
    s_branch oe_23
rd_29:
    s_cmp_eq_u32 s38, 0
    s_cbranch_scc1 rc_30
    s_sub_u32 s38, s38, 1
    s_nop 7
    s_nop 7
    s_sleep 4
    s_mov_b64 exec, vcc
    s_lshl_b32 s96, s75, 14
    s_add_u32 s96, s96, 6815744
    s_lshl_b32 s97, s24, 12
    s_add_u32 s97, s97, 3473408
    buffer_load_dwordx4 v[176:179], v62, s[16:19], s96 offen offset:0 sc1
    buffer_load_dwordx4 v[180:183], v62, s[16:19], s96 offen offset:1024 sc1
    buffer_load_dwordx4 v[184:187], v62, s[16:19], s97 offen offset:0 sc1
    buffer_load_dwordx4 v[188:191], v62, s[16:19], s97 offen offset:1024 sc1
    buffer_load_dwordx4 v[192:195], v62, s[16:19], s97 offen offset:2048 sc1
    buffer_load_dwordx4 v[196:199], v62, s[16:19], s97 offen offset:3072 sc1
    s_mov_b64 exec, -1
    s_waitcnt vmcnt(0) lgkmcnt(0)
    s_branch ce_28
rd_32:
    s_cmp_eq_u32 s38, 0
    s_cbranch_scc1 rc_33
    s_sub_u32 s38, s38, 1
    s_nop 7
    s_nop 7
    s_sleep 4
    s_mov_b64 exec, vcc
    s_lshl_b32 s96, s75, 14
    s_add_u32 s96, s96, 6815744
    s_lshl_b32 s97, s24, 12
    s_add_u32 s97, s97, 3477504
    buffer_load_dwordx4 v[248:251], v62, s[16:19], s96 offen offset:2048 sc1
    buffer_load_dwordx4 v[252:255], v62, s[16:19], s96 offen offset:3072 sc1
    buffer_load_dwordx4 v[96:99], v62, s[16:19], s97 offen offset:0 sc1
    buffer_load_dwordx4 v[100:103], v62, s[16:19], s97 offen offset:1024 sc1
    buffer_load_dwordx4 v[104:107], v62, s[16:19], s97 offen offset:2048 sc1
    buffer_load_dwordx4 v[108:111], v62, s[16:19], s97 offen offset:3072 sc1
    s_mov_b64 exec, -1
    s_waitcnt vmcnt(0) lgkmcnt(0)
    s_branch ce_31
gl_34:
    s_add_u32 s82, s86, 16384
    v_lshlrev_b32 v2, 10, v1
    v_mov_b32_e64 v5, 1
    s_mov_b64 exec, 255
    buffer_store_dword v5, v2, s[16:19], s82 offen offset:0 sc1
    s_mov_b64 exec, -1
    s_branch gc_35
ps_36:
    s_mov_b32 s84, 1048576
pl_37:
    buffer_load_dword v7, v4, s[16:19], s89 offen offset:0 sc1
    s_waitcnt vmcnt(0)
    s_sub_u32 s84, s84, 1
    s_cbranch_scc1 pc_38
    v_cmp_gt_u32 vcc, 1, v7
    s_nop 0
    s_and_b64 vcc, vcc, s[50:51]
    s_cbranch_scc1 pl_37
    s_branch pc_38
ps_39:
    s_mov_b32 s84, 1048576
pl_40:
    buffer_load_dword v7, v4, s[16:19], s87 offen offset:8 sc1
    s_waitcnt vmcnt(0)
    s_sub_u32 s84, s84, 1
    s_cbranch_scc1 pc_41
    v_cmp_gt_u32 vcc, 12, v7
    s_nop 0
    s_and_b64 vcc, vcc, s[50:51]
    s_cbranch_scc1 pl_40
    s_branch pc_41
gl_42:
    s_add_u32 s82, s86, 0
    v_lshlrev_b32 v2, 10, v1
    v_mov_b32_e64 v5, 1
    s_mov_b64 exec, 255
    buffer_store_dword v5, v2, s[16:19], s82 offen offset:12 sc1
    s_mov_b64 exec, -1
    s_branch gc_43
ps_44:
    s_mov_b32 s84, 1048576
pl_45:
    buffer_load_dword v7, v4, s[16:19], s89 offen offset:0 sc1
    s_waitcnt vmcnt(0)
    s_sub_u32 s84, s84, 1
    s_cbranch_scc1 pc_46
    v_cmp_gt_u32_e64 vcc, 1, v7
    s_nop 0
    s_and_b64 vcc, vcc, s[50:51]
    s_cbranch_scc1 pl_45
    s_branch pc_46
rd_49:
    s_cmp_eq_u32 s38, 0
    s_cbranch_scc1 rc_50
    s_sub_u32 s38, s38, 1
    s_nop 7
    s_nop 7
    s_sleep 4
    s_mov_b64 exec, vcc
    s_add_u32 s26, s3, 9437184
    buffer_load_dwordx4 v[216:219], v236, s[16:19], s26 offen sc1
    s_add_u32 s26, s26, 524288
    buffer_load_dwordx4 v[220:223], v236, s[16:19], s26 offen sc1
    s_add_u32 s26, s26, 524288
    buffer_load_dwordx4 v[224:227], v236, s[16:19], s26 offen sc1
    s_add_u32 s26, s26, 524288
    buffer_load_dwordx4 v[228:231], v236, s[16:19], s26 offen sc1
    s_add_u32 s26, s26, 524288
    buffer_load_dwordx4 v[232:235], v236, s[16:19], s26 offen sc1
    s_mov_b64 exec, -1
    s_waitcnt vmcnt(0) lgkmcnt(0)
    s_branch se_48
gl_52:
    s_add_u32 s82, s86, 16384
    v_lshlrev_b32 v2, 10, v1
    v_mov_b32_e64 v5, 1
    s_mov_b64 exec, 255
    buffer_store_dword v5, v2, s[16:19], s82 offen offset:4 sc1
    s_mov_b64 exec, -1
    s_branch gc_53
ps_54:
    s_mov_b32 s84, 1048576
pl_55:
    buffer_load_dword v7, v4, s[16:19], s87 offen offset:12 sc1
    s_waitcnt vmcnt(0)
    s_sub_u32 s84, s84, 1
    s_cbranch_scc1 pc_56
    v_cmp_gt_u32_e64 vcc, 1, v7
    s_nop 0
    s_and_b64 vcc, vcc, s[50:51]
    s_cbranch_scc1 pl_55
    s_branch pc_56
rd_58:
    s_cmp_eq_u32 s38, 0
    s_cbranch_scc1 rc_59
    s_sub_u32 s38, s38, 1
    s_nop 7
    s_nop 7
    s_sleep 4
    s_mov_b64 exec, vcc
    s_lshl_b32 s98, s72, 5
    s_add_u32 s98, s98, 0
    s_sub_u32 s95, s98, 4
    s_max_i32 s95, s95, 0
    s_lshl_b32 s94, s98, 3
    s_lshl_b32 s95, s95, 3
    s_add_u32 s94, s94, 3457024
    s_add_u32 s95, s95, 3457024
    s_add_u32 s96, s94, 8192
    buffer_load_dwordx2 v[152:153], v47, s[16:19], s94 offen sc1
    buffer_load_dwordx2 v[154:155], v47, s[16:19], s96 offen sc1
    buffer_load_dwordx2 v[156:157], v48, s[16:19], s95 offen sc1
    s_mov_b64 exec, -1
    s_waitcnt vmcnt(0) lgkmcnt(0)
    s_branch sl_57
ps_60:
    s_mov_b32 s84, 1048576
pl_61:
    buffer_load_dword v7, v4, s[16:19], s89 offen offset:4 sc1
    s_waitcnt vmcnt(0)
    s_sub_u32 s84, s84, 1
    s_cbranch_scc1 pc_62
    v_cmp_gt_u32 vcc, 1, v7
    s_nop 0
    s_and_b64 vcc, vcc, s[50:51]
    s_cbranch_scc1 pl_61
    s_branch pc_62
rd_65:
    s_cmp_eq_u32 s38, 0
    s_cbranch_scc1 rc_66
    s_sub_u32 s38, s38, 1
    s_nop 7
    s_nop 7
    s_sleep 4
    s_mov_b64 exec, vcc
    s_add_u32 s26, s3, 9437184
    buffer_load_dwordx4 v[216:219], v236, s[16:19], s26 offen sc1
    s_add_u32 s26, s26, 524288
    buffer_load_dwordx4 v[220:223], v236, s[16:19], s26 offen sc1
    s_add_u32 s26, s26, 524288
    buffer_load_dwordx4 v[224:227], v236, s[16:19], s26 offen sc1
    s_add_u32 s26, s26, 524288
    buffer_load_dwordx4 v[228:231], v236, s[16:19], s26 offen sc1
    s_add_u32 s26, s26, 524288
    buffer_load_dwordx4 v[232:235], v236, s[16:19], s26 offen sc1
    s_mov_b64 exec, -1
    s_waitcnt vmcnt(0) lgkmcnt(0)
    s_branch se_64
rd_67:
    s_cmp_eq_u32 s39, 0
    s_cbranch_scc1 rc_68
    s_sub_u32 s39, s39, 1
    s_nop 7
    s_nop 7
    s_waitcnt vmcnt(0) lgkmcnt(0)
    s_barrier
    s_lshl_b32 s25, s72, 5
    s_add_u32 s25, s25, 0
    s_sub_u32 s26, s25, 4
    s_max_i32 s26, s26, 0
    s_lshl_b32 s27, s71, 12
    s_add_u32 s27, s27, 9437184
    s_lshl_b32 s99, s25, 3
    s_lshl_b32 s100, s26, 3
    s_lshl_b32 s92, s24, 12
    s_lshl_b32 s93, s24, 9
    s_add_u32 s99, s99, s27
    s_add_u32 s100, s100, s27
    s_add_u32 m0, s92, 36352
    s_nop 0
    buffer_load_dwordx4 v73, s[16:19], s99 offen offset:0 sc1 lds
    buffer_load_dwordx4 v74, s[16:19], s99 offen offset:1024 sc1 lds
    buffer_load_dwordx4 v75, s[16:19], s99 offen offset:2048 sc1 lds
    buffer_load_dwordx4 v76, s[16:19], s99 offen offset:3072 sc1 lds
    s_add_u32 m0, s93, 53760
    s_add_u32 s99, s99, 524288
    s_mov_b64 exec, s[80:81]
    buffer_load_dwordx4 v77, s[16:19], s100 offen sc1 lds
    s_mov_b64 exec, -1
    s_add_u32 s100, s100, 524288
    s_add_u32 m0, s92, 55936
    s_nop 0
    s_nop 0
    buffer_load_dwordx4 v73, s[16:19], s99 offen offset:0 sc1 lds
    buffer_load_dwordx4 v74, s[16:19], s99 offen offset:1024 sc1 lds
    buffer_load_dwordx4 v75, s[16:19], s99 offen offset:2048 sc1 lds
    buffer_load_dwordx4 v76, s[16:19], s99 offen offset:3072 sc1 lds
    s_add_u32 m0, s93, 73344
    s_add_u32 s99, s99, 524288
    s_mov_b64 exec, s[80:81]
    buffer_load_dwordx4 v77, s[16:19], s100 offen sc1 lds
    s_mov_b64 exec, -1
    s_add_u32 s100, s100, 524288
    s_add_u32 m0, s92, 75520
    s_nop 0
    s_nop 0
    buffer_load_dwordx4 v73, s[16:19], s99 offen offset:0 sc1 lds
    buffer_load_dwordx4 v74, s[16:19], s99 offen offset:1024 sc1 lds
    buffer_load_dwordx4 v75, s[16:19], s99 offen offset:2048 sc1 lds
    buffer_load_dwordx4 v76, s[16:19], s99 offen offset:3072 sc1 lds
    s_add_u32 m0, s93, 92928
    s_add_u32 s99, s99, 524288
    s_mov_b64 exec, s[80:81]
    buffer_load_dwordx4 v77, s[16:19], s100 offen sc1 lds
    s_mov_b64 exec, -1
    s_add_u32 s100, s100, 524288
    s_mov_b64 exec, -1
    s_waitcnt vmcnt(0) lgkmcnt(0)
    s_branch ge_51
rd_71:
    s_cmp_eq_u32 s38, 0
    s_cbranch_scc1 rc_72
    s_sub_u32 s38, s38, 1
    s_nop 7
    s_nop 7
    s_sleep 4
    s_mov_b64 exec, vcc
    s_lshl_b32 s98, s72, 5
    s_add_u32 s98, s98, 256
    s_sub_u32 s95, s98, 4
    s_max_i32 s95, s95, 0
    s_lshl_b32 s94, s98, 3
    s_lshl_b32 s95, s95, 3
    s_nop 0
    s_add_u32 s94, s94, 3457024
    s_add_u32 s95, s95, 3457024
    s_add_u32 s96, s94, 8192
    buffer_load_dwordx2 v[152:153], v47, s[16:19], s94 offen sc1
    buffer_load_dwordx2 v[154:155], v47, s[16:19], s96 offen sc1
    buffer_load_dwordx2 v[156:157], v48, s[16:19], s95 offen sc1
    s_mov_b64 exec, -1
    s_waitcnt vmcnt(0) lgkmcnt(0)
    s_branch sl_70
rd_73:
    s_cmp_eq_u32 s39, 0
    s_cbranch_scc1 rc_74
    s_sub_u32 s39, s39, 1
    s_nop 7
    s_nop 7
    s_waitcnt vmcnt(0) lgkmcnt(0)
    s_barrier
    s_lshl_b32 s25, s72, 5
    s_add_u32 s25, s25, 256
    s_sub_u32 s26, s25, 4
    s_max_i32 s26, s26, 0
    s_lshl_b32 s27, s71, 12
    s_add_u32 s27, s27, 9437184
    s_lshl_b32 s99, s25, 3
    s_lshl_b32 s100, s26, 3
    s_lshl_b32 s92, s24, 12
    s_lshl_b32 s93, s24, 9
    s_add_u32 s99, s99, s27
    s_add_u32 s100, s100, s27
    s_add_u32 m0, s92, 36352
    s_nop 0
    s_nop 0
    buffer_load_dwordx4 v73, s[16:19], s99 offen offset:0 sc1 lds
    buffer_load_dwordx4 v74, s[16:19], s99 offen offset:1024 sc1 lds
    buffer_load_dwordx4 v75, s[16:19], s99 offen offset:2048 sc1 lds
    buffer_load_dwordx4 v76, s[16:19], s99 offen offset:3072 sc1 lds
    s_add_u32 m0, s93, 53760
    s_add_u32 s99, s99, 524288
    s_mov_b64 exec, s[80:81]
    buffer_load_dwordx4 v77, s[16:19], s100 offen sc1 lds
    s_mov_b64 exec, -1
    s_add_u32 s100, s100, 524288
    s_add_u32 m0, s92, 55936
    s_nop 0
    s_nop 0
    buffer_load_dwordx4 v73, s[16:19], s99 offen offset:0 sc1 lds
    buffer_load_dwordx4 v74, s[16:19], s99 offen offset:1024 sc1 lds
    buffer_load_dwordx4 v75, s[16:19], s99 offen offset:2048 sc1 lds
    buffer_load_dwordx4 v76, s[16:19], s99 offen offset:3072 sc1 lds
    s_add_u32 m0, s93, 73344
    s_add_u32 s99, s99, 524288
    s_mov_b64 exec, s[80:81]
    buffer_load_dwordx4 v77, s[16:19], s100 offen sc1 lds
    s_mov_b64 exec, -1
    s_add_u32 s100, s100, 524288
    s_add_u32 m0, s92, 75520
    s_nop 0
    s_nop 0
    buffer_load_dwordx4 v73, s[16:19], s99 offen offset:0 sc1 lds
    buffer_load_dwordx4 v74, s[16:19], s99 offen offset:1024 sc1 lds
    buffer_load_dwordx4 v75, s[16:19], s99 offen offset:2048 sc1 lds
    buffer_load_dwordx4 v76, s[16:19], s99 offen offset:3072 sc1 lds
    s_add_u32 m0, s93, 92928
    s_add_u32 s99, s99, 524288
    s_mov_b64 exec, s[80:81]
    buffer_load_dwordx4 v77, s[16:19], s100 offen sc1 lds
    s_mov_b64 exec, -1
    s_add_u32 s100, s100, 524288
    s_mov_b64 exec, -1
    s_waitcnt vmcnt(0) lgkmcnt(0)
    s_branch ge_69
rd_76:
    s_cmp_eq_u32 s38, 0
    s_cbranch_scc1 rc_77
    s_sub_u32 s38, s38, 1
    s_nop 7
    s_nop 7
    s_sleep 4
    s_mov_b64 exec, vcc
    s_mov_b32 s96, 12058624
    buffer_load_dwordx4 v[216:219], v56, s[16:19], s96 offen offset:0 sc1
    buffer_load_dwordx4 v[220:223], v56, s[16:19], s96 offen offset:256 sc1
    s_mov_b32 s96, 12091392
    buffer_load_dwordx4 v[224:227], v56, s[16:19], s96 offen offset:0 sc1
    buffer_load_dwordx4 v[228:231], v56, s[16:19], s96 offen offset:256 sc1
    s_mov_b32 s96, 12124160
    buffer_load_dwordx4 v[232:235], v56, s[16:19], s96 offen offset:0 sc1
    buffer_load_dwordx4 v[236:239], v56, s[16:19], s96 offen offset:256 sc1
    s_mov_b32 s96, 12156928
    buffer_load_dwordx4 v[240:243], v56, s[16:19], s96 offen offset:0 sc1
    buffer_load_dwordx4 v[244:247], v56, s[16:19], s96 offen offset:256 sc1
    s_mov_b32 s96, 12058624
    buffer_load_dwordx2 v[248:249], v57, s[16:19], s96 offen offset:0 sc1
    buffer_load_dwordx2 v[252:253], v57, s[16:19], s96 offen offset:128 sc1
    s_mov_b32 s96, 12075008
    buffer_load_dwordx2 v[250:251], v57, s[16:19], s96 offen offset:0 sc1
    buffer_load_dwordx2 v[254:255], v57, s[16:19], s96 offen offset:128 sc1
    s_mov_b32 s96, 9437184
    buffer_load_dwordx4 v[208:211], v59, s[16:19], s96 offen sc1
    s_add_u32 s97, s36, 9437184
    buffer_load_dword v212, v61, s[16:19], s97 offen sc1
    s_mov_b64 exec, -1
    s_waitcnt vmcnt(0) lgkmcnt(0)
    s_branch oe_75
rd_79:
    s_cmp_eq_u32 s38, 0
    s_cbranch_scc1 rc_80
    s_sub_u32 s38, s38, 1
    s_nop 7
    s_nop 7
    s_sleep 4
    s_mov_b64 exec, vcc
    s_mov_b32 s96, 12062720
    buffer_load_dwordx4 v[216:219], v56, s[16:19], s96 offen offset:0 sc1
    buffer_load_dwordx4 v[220:223], v56, s[16:19], s96 offen offset:256 sc1
    s_mov_b32 s96, 12095488
    buffer_load_dwordx4 v[224:227], v56, s[16:19], s96 offen offset:0 sc1
    buffer_load_dwordx4 v[228:231], v56, s[16:19], s96 offen offset:256 sc1
    s_mov_b32 s96, 12128256
    buffer_load_dwordx4 v[232:235], v56, s[16:19], s96 offen offset:0 sc1
    buffer_load_dwordx4 v[236:239], v56, s[16:19], s96 offen offset:256 sc1
    s_mov_b32 s96, 12161024
    buffer_load_dwordx4 v[240:243], v56, s[16:19], s96 offen offset:0 sc1
    buffer_load_dwordx4 v[244:247], v56, s[16:19], s96 offen offset:256 sc1
    s_mov_b32 s96, 12060672
    buffer_load_dwordx2 v[248:249], v57, s[16:19], s96 offen offset:0 sc1
    buffer_load_dwordx2 v[252:253], v57, s[16:19], s96 offen offset:128 sc1
    s_mov_b32 s96, 12077056
    buffer_load_dwordx2 v[250:251], v57, s[16:19], s96 offen offset:0 sc1
    buffer_load_dwordx2 v[254:255], v57, s[16:19], s96 offen offset:128 sc1
    s_mov_b32 s96, 9439232
    buffer_load_dwordx4 v[208:211], v59, s[16:19], s96 offen sc1
    s_add_u32 s97, s36, 9439232
    buffer_load_dword v212, v61, s[16:19], s97 offen sc1
    s_mov_b64 exec, -1
    s_waitcnt vmcnt(0) lgkmcnt(0)
    s_branch oe_78
rd_84:
    s_cmp_eq_u32 s38, 0
    s_cbranch_scc1 rc_85
    s_sub_u32 s38, s38, 1
    s_nop 7
    s_nop 7
    s_sleep 4
    s_mov_b64 exec, vcc
    s_lshl_b32 s96, s75, 14
    s_add_u32 s96, s96, 14680064
    s_lshl_b32 s97, s24, 12
    s_add_u32 s97, s97, 3506176
    buffer_load_dwordx4 v[176:179], v62, s[16:19], s96 offen offset:0 sc1
    buffer_load_dwordx4 v[180:183], v62, s[16:19], s96 offen offset:1024 sc1
    buffer_load_dwordx4 v[184:187], v62, s[16:19], s97 offen offset:0 sc1
    buffer_load_dwordx4 v[188:191], v62, s[16:19], s97 offen offset:1024 sc1
    buffer_load_dwordx4 v[192:195], v62, s[16:19], s97 offen offset:2048 sc1
    buffer_load_dwordx4 v[196:199], v62, s[16:19], s97 offen offset:3072 sc1
    s_mov_b64 exec, -1
    s_waitcnt vmcnt(0) lgkmcnt(0)
    s_branch ce_83
rd_87:
    s_cmp_eq_u32 s38, 0
    s_cbranch_scc1 rc_88
    s_sub_u32 s38, s38, 1
    s_nop 7
    s_nop 7
    s_sleep 4
    s_mov_b64 exec, vcc
    s_lshl_b32 s96, s75, 14
    s_add_u32 s96, s96, 14680064
    s_lshl_b32 s97, s24, 12
    s_add_u32 s97, s97, 3510272
    buffer_load_dwordx4 v[248:251], v62, s[16:19], s96 offen offset:2048 sc1
    buffer_load_dwordx4 v[252:255], v62, s[16:19], s96 offen offset:3072 sc1
    buffer_load_dwordx4 v[96:99], v62, s[16:19], s97 offen offset:0 sc1
    buffer_load_dwordx4 v[100:103], v62, s[16:19], s97 offen offset:1024 sc1
    buffer_load_dwordx4 v[104:107], v62, s[16:19], s97 offen offset:2048 sc1
    buffer_load_dwordx4 v[108:111], v62, s[16:19], s97 offen offset:3072 sc1
    s_mov_b64 exec, -1
    s_waitcnt vmcnt(0) lgkmcnt(0)
    s_branch ce_86
L_last:
    s_endpgm
.section .rodata,"a"
.p2align 6
.amdhsa_kernel interleave_layers__sliding_local_dilated__ssm_conv_s4d__prompt_kernel
  .amdhsa_next_free_vgpr 512
  .amdhsa_next_free_sgpr 102
  .amdhsa_accum_offset 256
  .amdhsa_group_segment_fixed_size 0
  .amdhsa_kernarg_size 104
  .amdhsa_user_sgpr_count 2
  .amdhsa_user_sgpr_kernarg_segment_ptr 1
  .amdhsa_system_sgpr_workgroup_id_x 1
.end_amdhsa_kernel
```

```asm
; @launch grid=(256,1,1) block=(256,1,1) lds=163840
.amdgcn_target "amdgcn-amd-amdhsa--gfx950"
.text
.globl interleave_layers__sliding_local_dilated__ssm_conv_s4d__prompt_kernel
.p2align 8
.type interleave_layers__sliding_local_dilated__ssm_conv_s4d__prompt_kernel,@function
interleave_layers__sliding_local_dilated__ssm_conv_s4d__prompt_kernel:
    s_getpc_b64 s[42:43]
L_start:
    s_cmp_ge_u32 s2, 256
    s_cbranch_scc1 L_end
    s_load_dwordx16 s[44:59], s[0:1], 0
    s_load_dwordx8 s[60:67], s[0:1], 64
    s_load_dwordx2 s[68:69], s[0:1], 96
    v_and_b32 v1, 63, v0
    v_lshrrev_b32 v2, 6, v0
    s_nop 0
    v_readfirstlane_b32 s24, v2
    s_bfe_u32 s82, s2, 0x40003
    s_lshl_b32 s82, s82, 13
    v_lshrrev_b32 v159, 2, v0
    v_lshl_add_u32 v159, v159, 7, s82
    v_min_u32 v159, L_last-L_start, v159
    global_load_dword v159, v159, s[42:43]
    s_and_b32 s25, s2, 7
    s_lshr_b32 s26, s2, 3
    s_and_b32 s27, s26, 3
    s_lshr_b32 s28, s26, 4
    s_lshl_b32 s28, s28, 2
    s_add_u32 s3, s27, s28
    s_lshl_b32 s27, s3, 2
    s_lshr_b32 s70, 0x75206431, s27
    s_and_b32 s70, s70, 7
    s_and_b32 s27, s25, 1
    s_lshl_b32 s27, s27, 3
    s_add_u32 s70, s70, s27
    s_bfe_u32 s71, s26, 0x10002
    s_bfe_u32 s28, s26, 0x10003
    s_and_b32 s72, s25, 6
    s_add_u32 s72, s72, s28
    s_and_b32 s73, s26, 7
    s_lshr_b32 s28, s26, 3
    s_lshl_b32 s74, s25, 2
    s_add_u32 s74, s74, s28
    s_mul_i32 s75, s25, 20
    s_add_u32 s75, s75, s26
    s_min_u32 s27, s2, 239
    s_mul_i32 s25, s27, 10923
    s_lshr_b32 s25, s25, 16
    s_mul_i32 s26, s25, 6
    s_sub_u32 s26, s27, s26
    s_mul_i32 s27, s25, 61440
    s_mul_i32 s28, s26, 640
    s_add_u32 s27, s27, s28
    s_lshl_b32 s28, s24, 10
    v_add_u32 v85, 0, v0
    v_mul_u32_u24 v84, 1639, v85
    v_lshrrev_b32 v84, 16, v84
    v_mul_u32_u24 v84, 3200, v84
    v_lshl_add_u32 v85, v85, 4, v84
    v_add_u32 v86, 256, v0
    v_mul_u32_u24 v84, 1639, v86
    v_lshrrev_b32_e64 v84, 16, v84
    v_mul_u32_u24 v84, 3200, v84
    v_lshl_add_u32 v86, v86, 4, v84
    v_add_u32 v87, 512, v0
    v_min_u32 v87, 639, v87
    v_mul_u32_u24 v84, 1639, v87
    v_lshrrev_b32_e64 v84, 16, v84
    v_mul_u32_u24 v84, 3200, v84
    v_lshl_add_u32 v87, v87, 4, v84
    s_mov_b32 s76, 0
    s_mov_b32 s77, 0x80000000
    s_mov_b32 s80, -1
    s_mov_b32 s81, 0
    s_nop 0
    s_mov_b32 s78, 0xfe0000fe
    s_mov_b32 s79, 0xfe0000fe
    s_mov_b32 s6, 2621440
    s_mov_b32 s7, 0x20000
    s_mov_b32 s10, 2457600
    s_mov_b32 s11, 0x20000
    s_mov_b32 s14, 819200
    s_mov_b32 s15, 0x20000
    s_mov_b32 s18, 22061056
    s_mov_b32 s19, 0x20000
    s_mov_b32 s22, 2621440
    s_mov_b32 s23, 0x20000
    s_waitcnt lgkmcnt(0)
    s_mov_b32 s4, s44
    s_and_b32 s5, s45, 0xffff
    s_mov_b32 s8, s46
    s_and_b32 s9, s47, 0xffff
    s_mov_b32 s12, s48
    s_and_b32 s13, s49, 0xffff
    s_mov_b32 s16, s68
    s_and_b32 s17, s69, 0xffff
    s_mov_b32 s20, s64
    s_and_b32 s21, s65, 0xffff
    s_cmp_lg_u32 s2, 255
    s_cbranch_scc1 fz_1
    v_mov_b32 v120, 0
    v_mov_b32 v121, 0
    v_mov_b32 v122, 0
    v_mov_b32 v123, 0
    v_lshlrev_b32 v124, 4, v0
    s_mov_b32 s88, 3538944
    buffer_store_dwordx4 v[120:123], v124, s[16:19], s88 offen sc1
    s_mov_b32 s88, 3543040
    buffer_store_dwordx4 v[120:123], v124, s[16:19], s88 offen sc1
    s_mov_b32 s88, 3547136
    buffer_store_dwordx4 v[120:123], v124, s[16:19], s88 offen sc1
    s_mov_b32 s88, 3555328
    buffer_store_dwordx4 v[120:123], v124, s[16:19], s88 offen sc1
    s_mov_b32 s88, 3559424
    buffer_store_dwordx4 v[120:123], v124, s[16:19], s88 offen sc1
    s_mov_b32 s88, 3563520
    buffer_store_dwordx4 v[120:123], v124, s[16:19], s88 offen sc1
fz_1:
    s_min_u32 s96, s75, 159
    s_lshl_b32 s96, s96, 2
    s_add_u32 s96, s96, s24
    s_mul_i32 s97, s96, 384
    s_lshl_b32 s96, s96, 1
    v_lshl_add_u32 v2, v1, 2, s97
    v_mov_b32 v241, s96
    global_load_dword v232, v2, s[52:53]
    global_load_dword v233, v2, s[54:55]
    global_load_dword v234, v2, s[56:57]
    global_load_dword v235, v2, s[58:59]
    global_load_ushort v240, v241, s[60:61]
    s_add_u32 m0, s28, 134272
    s_nop 0
    buffer_load_dwordx4 v85, s[8:11], s27 offen lds
    s_add_u32 m0, s28, 138368
    s_nop 0
    buffer_load_dwordx4 v86, s[8:11], s27 offen lds
    s_add_u32 m0, s28, 142464
    s_nop 0
    buffer_load_dwordx4 v87, s[8:11], s27 offen lds
    s_lshr_b32 s29, s26, 1
    s_and_b32 s30, s26, 1
    s_lshl_b32 s30, s30, 3
    s_lshl_b32 s31, s25, 10
    s_add_u32 s31, s31, 0
    s_cmp_ge_u32 s2, 240
    s_cselect_b32 s31, 1073741824, s31
    v_bfe_u32 v93, v0, 2, 2
    v_bfe_u32 v92, v0, 1, 1
    v_lshl_add_u32 v92, v92, 3, v93
    v_mul_u32_u24 v92, 640, v92
    v_and_b32 v93, 1, v0
    v_mul_u32_u24 v93, 40, v93
    v_add_u32 v91, v92, v93
    v_add_u32 v91, 134272, v91
    v_lshrrev_b32 v88, 4, v0
    v_add_u32 v88, 0, v88
    v_cmp_gt_u32 vcc, 40, v88
    v_min_u32 v88, 39, v88
    v_mul_u32_u24 v89, 13108, v88
    v_lshrrev_b32 v89, 16, v89
    v_mul_u32_u24 v90, 5, v89
    v_sub_u32_e64 v90, v88, v90
    v_mul_u32_u24 v92, 80, v89
    v_lshl_add_u32 v92, v90, 3, v92
    v_add_u32 v111, v92, v91
    v_add_u32 v89, s30, v89
    v_cmp_eq_u32 s[82:83], 4, v90
    v_mov_b32 v92, s29
    s_nop 0
    v_cndmask_b32 v93, v90, v92, s[82:83]
    v_cndmask_b32 v92, v92, 3, s[82:83]
    v_lshl_add_u32 v89, v89, 2, v93
    v_mul_u32_u24 v89, 40960, v89
    v_lshl_add_u32 v89, v92, 8, v89
    v_and_b32 v92, 15, v0
    v_lshl_add_u32 v89, v92, 4, v89
    v_mov_b32 v92, 1073741824
    v_cndmask_b32 v89, v92, v89, vcc
    v_add_u32 v108, s31, v89
    v_lshrrev_b32 v88, 4, v0
    v_add_u32 v88, 16, v88
    v_cmp_gt_u32 vcc, 40, v88
    v_min_u32 v88, 39, v88
    v_mul_u32_u24 v89, 13108, v88
    v_lshrrev_b32 v89, 16, v89
    v_mul_u32_u24 v90, 5, v89
    v_sub_u32_e64 v90, v88, v90
    v_mul_u32_u24 v92, 80, v89
    v_lshl_add_u32 v92, v90, 3, v92
    v_add_u32 v112, v92, v91
    v_add_u32 v89, s30, v89
    v_cmp_eq_u32 s[82:83], 4, v90
    v_mov_b32 v92, s29
    s_nop 0
    v_cndmask_b32 v93, v90, v92, s[82:83]
    v_cndmask_b32 v92, v92, 3, s[82:83]
    v_lshl_add_u32 v89, v89, 2, v93
    v_mul_u32_u24 v89, 40960, v89
    v_lshl_add_u32 v89, v92, 8, v89
    v_and_b32 v92, 15, v0
    v_lshl_add_u32 v89, v92, 4, v89
    v_mov_b32 v92, 1073741824
    v_cndmask_b32 v89, v92, v89, vcc
    v_add_u32 v109, s31, v89
    v_lshrrev_b32 v88, 4, v0
    v_add_u32 v88, 32, v88
    v_cmp_gt_u32 vcc, 40, v88
    v_min_u32 v88, 39, v88
    v_mul_u32_u24 v89, 13108, v88
    v_lshrrev_b32 v89, 16, v89
    v_mul_u32_u24 v90, 5, v89
    v_sub_u32_e64 v90, v88, v90
    v_mul_u32_u24 v92, 80, v89
    v_lshl_add_u32 v92, v90, 3, v92
    v_add_u32 v113, v92, v91
    v_add_u32 v89, s30, v89
    v_cmp_eq_u32 s[82:83], 4, v90
    v_mov_b32 v92, s29
    s_nop 0
    v_cndmask_b32 v93, v90, v92, s[82:83]
    v_cndmask_b32 v92, v92, 3, s[82:83]
    v_lshl_add_u32 v89, v89, 2, v93
    v_mul_u32_u24 v89, 40960, v89
    v_lshl_add_u32 v89, v92, 8, v89
    v_and_b32 v92, 15, v0
    v_lshl_add_u32 v89, v92, 4, v89
    v_mov_b32 v92, 1073741824
    v_cndmask_b32 v89, v92, v89, vcc
    v_add_u32 v110, s31, v89
    s_mul_i32 s25, s3, 18
    s_lshl_b32 s26, s72, 7
    s_add_u32 s25, s25, s26
    s_add_u32 s25, s25, s71
    s_add_u32 s25, s25, -16
    s_max_i32 s25, s25, 0
    s_mul_i32 s25, s25, 1280
    v_lshrrev_b32_e64 v204, 1, v0
    v_min_u32 v204, 89, v204
    v_mul_u32_u24 v205, 6554, v204
    v_lshrrev_b32_e64 v205, 16, v205
    v_mul_u32_u24 v205, 1280, v205
    v_lshl_add_u32 v204, v204, 7, v205
    buffer_load_dword v204, v204, s[4:7], s25 offen
    s_and_b32 s25, s2, 7
    s_lshl_b32 s86, s25, 7
    s_add_u32 s86, s86, 3538944
    s_lshl_b32 s87, s25, 10
    s_add_u32 s87, s87, 3538944
    s_add_u32 s89, s87, 16384
    v_cmp_gt_u32 s[50:51], 8, v0
    v_cmp_eq_u32 vcc, 0, v0
    v_lshlrev_b32 v4, 7, v1
    v_mov_b32 v6, 1073741824
    v_cndmask_b32 v4, v6, v4, s[50:51]
    v_cndmask_b32 v6, v6, 0, vcc
    v_mov_b32 v5, 0
    s_cmp_lg_u32 s2, 255
    s_cbranch_scc1 fr_2
    v_mov_b32 v2, 1
    s_waitcnt vmcnt(9)
    s_barrier
    s_mov_b64 exec, 1
    global_store_dword v5, v2, s[66:67] sc1
    s_mov_b64 exec, -1
fr_2:
    v_mov_b32 v140, 0
    v_mov_b32_e64 v141, 0
    v_mov_b32 v142, 0x3f803f80
    v_mov_b32 v143, 0x3f803f80
    v_lshlrev_b32_e64 v144, 3, v0
    v_add_u32 v144, 155648, v144
    ds_write_b64 v144, v[140:141]
    ds_write_b64 v144, v[140:141] offset:512
    ds_write_b64 v144, v[142:143] offset:2560
    ds_write_b64 v144, v[142:143] offset:3072
    v_and_b32 v50, 31, v1
    v_lshrrev_b32 v51, 5, v1
    v_mul_u32_u24 v52, 40, v50
    v_mul_u32_u24 v53, 3200, v51
    v_add_u32 v53, v52, v53
    s_lshl_b32 s25, s24, 3
    s_add_u32 s25, s25, 320
    v_add_u32 v38, s25, v53
    s_mul_i32 s25, s24, 6400
    s_add_u32 s25, s25, 352
    v_add_u32 v39, s25, v53
    s_lshl_b32 s31, s71, 12
    v_lshl_add_u32 v47, v50, 3, s31
    v_bfe_u32 v52, v1, 2, 1
    v_and_b32 v53, 3, v1
    v_lshlrev_b32 v54, 13, v52
    v_lshl_add_u32 v54, v53, 3, v54
    v_add_u32_e64 v48, s31, v54
    v_bfe_u32 v54, v1, 4, 1
    v_lshl_add_u32 v52, v54, 1, v52
    v_mul_u32_u24 v52, 40, v52
    v_add_u32 v52, v52, v53
    v_mul_u32_u24_e64 v52, 40, v52
    v_bfe_u32 v53, v1, 3, 1
    v_cmp_eq_u32 s[82:83], v53, v54
    v_lshl_add_u32 v53, v53, 1, v51
    v_cmp_eq_u32 vcc, 3, v53
    v_mov_b32 v54, s24
    s_nop 0
    v_cndmask_b32 v53, v53, v54, vcc
    v_cndmask_b32 v54, v54, 4, vcc
    v_mul_u32_u24 v53, 6400, v53
    v_lshl_add_u32 v52, v54, 3, v52
    v_add_u32_e64 v52, v52, v53
    v_add_u32 v40, 160, v52
    v_mov_b32 v52, 19584
    v_mov_b32 v53, 128
    v_cndmask_b32 v49, v53, v52, s[78:79]
    v_and_b32 v50, 15, v1
    v_lshrrev_b32 v51, 4, v1
    s_and_b32 s25, s24, 1
    s_and_b32 s26, s24, 2
    s_mul_i32 s27, s25, 3200
    s_mul_i32 s28, s26, 320
    s_add_u32 s27, s27, s28
    s_add_u32 s27, s27, 0
    v_and_b32 v52, 1, v1
    v_mul_u32_u24 v52, 1600, v52
    v_lshrrev_b32 v53, 1, v50
    v_mul_u32_u24_e64 v54, 40, v53
    v_add3_u32 v52, v52, v54, s27
    v_lshl_add_u32 v41, v51, 3, v52
    v_add_u32_e64 v42, 32, v52
    v_bfe_u32 v52, v1, 2, 1
    v_mul_u32_u24 v52, 1600, v52
    v_lshrrev_b32 v54, 3, v1
    v_mul_u32_u24 v54, 40, v54
    v_add3_u32 v52, v52, v54, s27
    v_add_u32 v52, 12800, v52
    v_and_b32 v54, 3, v1
    v_lshl_add_u32 v43, v54, 3, v52
    v_add_u32 v52, 32, v52
    v_cmp_eq_u32 vcc, 0, v54
    v_mov_b32 v54, 158208
    s_nop 0
    v_cndmask_b32 v44, v54, v52, vcc
    v_and_b32 v52, 1, v51
    v_add_u32 v52, s26, v52
    v_lshrrev_b32 v54, 2, v50
    v_lshl_add_u32 v52, v52, 2, v54
    v_and_b32 v53, 1, v53
    v_lshl_add_u32 v52, v53, 4, v52
    v_and_b32 v53, 1, v50
    v_lshl_add_u32 v52, v53, 10, v52
    s_lshl_b32 s30, s70, 1
    s_add_u32 s30, s30, s25
    s_lshl_b32 s29, s30, 3
    s_add_u32 s29, s29, s71
    s_lshl_b32 s29, s29, 13
    v_lshrrev_b32 v53, 1, v51
    v_lshlrev_b32 v53, 15, v53
    v_lshl_add_u32 v53, v52, 4, v53
    v_add_u32_e64 v45, s29, v53
    s_lshl_b32 s29, s30, 2
    s_add_u32 s29, s29, s71
    s_lshl_b32 s29, s29, 12
    s_add_u32 s29, s29, 2097152
    v_lshl_add_u32 v46, v52, 3, s29
    s_or_b32 s29, s26, s72
    s_cmp_eq_u32 s29, 0
    s_cselect_b64 s[90:91], -1, 0
    v_lshlrev_b32 v52, 2, v51
    v_sub_u32 v52, v50, v52
    v_mov_b32 v55, 0xf149f2ca
    v_subrev_u32 v53, 0, v52
    v_cmp_lt_u32 vcc, 7, v53
    s_nop 1
    v_cndmask_b32 v28, 0, v55, vcc
    v_cmp_lt_i32 vcc, -9, v53
    s_nop 1
    v_cndmask_b32 v32, 0, v55, vcc
    v_cmp_le_i32 vcc, 0, v53
    v_mov_b32 v54, 0xffff
    s_nop 0
    v_cndmask_b32 v54, 0, v54, vcc
    v_mov_b32 v36, v54
    v_subrev_u32 v53, 1, v52
    v_cmp_lt_u32 vcc, 7, v53
    s_nop 1
    v_cndmask_b32 v29, 0, v55, vcc
    v_cmp_lt_i32 vcc, -9, v53
    s_nop 1
    v_cndmask_b32 v33, 0, v55, vcc
    v_cmp_le_i32 vcc, 0, v53
    v_mov_b32 v54, 0xffff0000
    s_nop 0
    v_cndmask_b32 v54, 0, v54, vcc
    v_or_b32 v36, v36, v54
    v_subrev_u32 v53, 2, v52
    v_cmp_lt_u32 vcc, 7, v53
    s_nop 1
    v_cndmask_b32 v30, 0, v55, vcc
    v_cmp_lt_i32 vcc, -9, v53
    s_nop 1
    v_cndmask_b32 v34, 0, v55, vcc
    v_cmp_le_i32 vcc, 0, v53
    v_mov_b32 v54, 0xffff
    s_nop 0
    v_cndmask_b32 v54, 0, v54, vcc
    v_mov_b32 v37, v54
    v_subrev_u32 v53, 3, v52
    v_cmp_lt_u32 vcc, 7, v53
    s_nop 1
    v_cndmask_b32 v31, 0, v55, vcc
    v_cmp_lt_i32 vcc, -9, v53
    s_nop 1
    v_cndmask_b32 v35, 0, v55, vcc
    v_cmp_le_i32 vcc, 0, v53
    v_mov_b32 v54, 0xffff0000
    s_nop 0
    v_cndmask_b32 v54, 0, v54, vcc
    v_or_b32 v37, v37, v54
    v_and_b32 v62, 15, v1
    v_lshrrev_b32 v63, 4, v1
    s_and_b32 s25, s74, 3
    s_lshr_b32 s26, s74, 2
    s_lshl_b32 s27, s24, 6
    s_add_u32 s27, s27, s25
    s_lshl_b32 s27, s27, 13
    s_lshl_b32 s28, s26, 9
    s_add_u32 s27, s27, s28
    v_lshl_add_u32 v64, v63, 17, s27
    v_lshl_add_u32 v56, v62, 4, v64
    s_lshl_b32 s27, s24, 5
    s_add_u32 s27, s27, s25
    s_lshl_b32 s27, s27, 12
    s_lshl_b32 s28, s26, 8
    s_add_u32 s27, s27, s28
    s_add_u32 s27, s27, 2097152
    v_lshl_add_u32 v64, v63, 15, s27
    v_lshl_add_u32 v57, v62, 3, v64
    v_lshlrev_b32 v58, 4, v1
    s_lshl_b32 s29, s25, 12
    s_add_u32 s29, s29, s28
    v_lshl_add_u32 v64, v62, 4, s29
    v_lshl_add_u32 v61, v63, 2, v64
    s_mul_i32 s30, s73, 20
    s_lshl_b32 s31, s24, 2
    s_add_u32 s30, s30, s31
    s_lshl_b32 s31, s30, 14
    v_lshl_add_u32 v64, v63, 14, v64
    v_add_u32 v59, s31, v64
    s_lshl_b32 s31, s26, 7
    s_add_u32 s31, s31, s25
    s_mul_i32 s31, s31, 1280
    s_lshl_b32 s30, s30, 3
    s_add_u32 s31, s31, s30
    v_mul_u32_u24 v64, 10240, v62
    v_lshl_add_u32 v64, v63, 3, v64
    v_add_u32_e64 v60, s31, v64
    s_lshl_b32 s25, s24, 12
    v_lshl_add_u32 v62, v1, 4, s25
    s_mul_i32 s25, s24, 1216
    s_add_u32 s25, s25, 192
    v_lshl_add_u32 v63, v1, 2, s25
    s_mul_i32 s25, s24, 4864
    s_add_u32 s25, s25, 80
    v_and_b32_e64 v70, 3, v1
    v_mul_u32_u24 v70, 1216, v70
    v_bfe_u32 v71, v1, 2, 3
    v_lshl_add_u32 v70, v71, 4, v70
    v_lshrrev_b32 v71, 5, v1
    v_lshl_add_u32 v70, v71, 4, v70
    v_add_u32 v64, s25, v70
    s_mul_i32 s25, s24, 4160
    s_add_u32 s25, s25, 134368
    v_lshlrev_b32 v71, 6, v71
    v_sub_u32 v71, s25, v71
    v_bfe_u32 v70, v1, 4, 1
    v_lshl_add_u32 v71, v70, 5, v71
    v_and_b32_e64 v70, 3, v1
    v_lshl_add_u32 v71, v70, 3, v71
    v_bfe_u32 v70, v1, 2, 2
    v_lshlrev_b32 v70, 3, v70
    v_sub_u32 v65, v71, v70
    s_mul_i32 s25, s24, 4224
    s_add_u32 s25, s25, 19456
    v_and_b32 v70, 3, v1
    v_mul_u32_u24 v70, 1056, v70
    v_and_b32 v71, 60, v1
    v_add3_u32 v66, v70, v71, s25
    s_mul_i32 s25, s24, 1056
    s_add_u32 s25, s25, 19456
    v_lshl_add_u32 v67, v1, 3, s25
    s_mul_i32 s25, s24, 1280
    s_lshl_b32 s26, s75, 3
    s_add_u32 s25, s25, s26
    v_mul_u32_u24 v70, 10240, v1
    v_add_u32 v68, s25, v70
    s_and_b32 s25, s24, 1
    s_lshl_b32 s25, s25, 6
    s_and_b32 s26, s24, 2
    s_add_u32 s25, s25, s26
    s_mul_i32 s25, s25, 1280
    v_lshrrev_b32 v140, 4, v1
    v_and_b32 v141, 15, v1
    v_xor_b32 v141, v140, v141
    v_lshlrev_b32_e64 v141, 4, v141
    v_mul_u32_u24 v142, 5120, v140
    v_add3_u32 v73, v141, v142, s25
    s_and_b32 s25, s24, 1
    s_lshl_b32 s25, s25, 3
    s_add_u32 s25, s25, s26
    s_mul_i32 s25, s25, 1280
    v_add3_u32 v77, v141, v142, s25
    v_lshrrev_b32 v141, 5, v1
    v_and_b32 v140, 3, v1
    v_xor_b32 v142, v140, v141
    v_lshlrev_b32_e64 v142, 4, v142
    v_lshl_add_u32 v142, v140, 8, v142
    v_bfe_u32 v140, v1, 2, 3
    v_mul_u32_u24 v140, 1088, v140
    v_add_u32 v78, v140, v142
    v_and_b32 v140, 1, v1
    v_xor_b32 v142, v140, v141
    v_lshlrev_b32 v142, 4, v142
    v_lshl_add_u32 v142, v140, 8, v142
    v_bfe_u32 v140, v1, 1, 2
    v_mul_u32_u24 v140, 544, v140
    v_add_u32_e64 v142, v140, v142
    v_add_u32 v74, 19392, v73
    v_add_u32 v75, 38784, v73
    v_add_u32 v76, 58176, v73
    v_add_u32 v142, 53760, v142
    v_and_b32 v140, 31, v1
    v_cmp_eq_u32 vcc, 0, v140
    v_cmp_eq_u32 s[82:83], 24, v140
    s_nop 0
    s_or_b64 vcc, vcc, s[82:83]
    v_mov_b32 v140, 155776
    v_mov_b32 v141, 158400
    v_cndmask_b32_e64 v140, v140, v141, vcc
    v_cndmask_b32 v79, v140, v142, s[78:79]
    v_bfe_u32 v201, v1, 3, 2
    v_and_b32 v202, s24, v201
    v_cmp_eq_u32 vcc, 3, v202
    v_lshrrev_b32 v202, 5, v1
    v_lshl_add_u32 v201, v201, 1, v202
    v_and_b32 v202, 7, v1
    v_lshl_add_u32 v201, v201, 3, v202
    v_lshlrev_b32 v200, 4, v201
    v_mov_b32 v201, 1073741824
    v_cndmask_b32 v200, v200, v201, vcc
    s_lshl_b32 s101, s70, 2
    s_add_u32 s101, s101, s24
    s_mul_i32 s101, s101, 40960
    s_add_u32 s101, s101, 0
    s_lshl_b32 s25, s72, 5
    s_add_u32 s25, s25, 0
    s_sub_u32 s26, s25, 4
    s_max_i32 s26, s26, 0
    s_mul_i32 s27, s71, 1280
    s_mul_i32 s99, s25, 5120
    s_mul_i32 s100, s26, 5120
    s_mul_i32 s92, s24, 4352
    s_mul_i32 s93, s24, 544
    s_add_u32 s99, s99, s27
    s_add_u32 s100, s100, s27
    s_mov_b32 s38, 0x10000
    s_mov_b32 s39, 0x1000
    s_cmp_ge_u32 s2, 160
    s_cbranch_scc1 nc_3
    s_mul_i32 s37, s24, 8704
    s_add_u32 s25, s37, 0
    s_add_u32 s37, s37, 0
    s_mov_b32 m0, s37
    v_and_b32 v199, 31, v1
    v_mul_u32_u24 v199, 272, v199
    v_lshrrev_b32 v215, 5, v1
    v_lshl_add_u32 v199, v215, 4, v199
    v_add_u32 v252, s25, v199
    s_waitcnt vmcnt(4)
    v_lshlrev_b32 v253, 16, v240
    v_mul_f32 v253, 0x3fb8aa3b, v253
    v_exp_f32 v253, v253
    s_nop 0
    v_cvt_pk_bf16_f32 v253, v253, v253
    v_lshlrev_b32 v253, 16, v253
    v_lshlrev_b32 v199, 16, v232
    v_mul_f32 v199, 0x3fb8aa3b, v199
    v_exp_f32 v199, v199
    v_lshlrev_b32 v255, 16, v233
    v_mul_f32 v255, v255, v253
    v_mul_f32 v255, 0x3e22f983, v255
    v_cvt_pk_bf16_f32 v199, v199, v199
    v_lshlrev_b32 v199, 16, v199
    v_mul_f32_e64 v254, v199, v253
    v_mul_f32 v254, 0xbfb8aa3b, v254
    v_mul_f32 v182, 0x41000000, v254
    v_mul_f32 v185, 0x41000000, v255
    v_mul_f32 v184, 0x43800000, v254
    v_mul_f32 v189, 0x43800000, v255
    v_fract_f32 v185, v185
    v_fract_f32 v188, v255
    s_waitcnt vmcnt(1)
    s_barrier
    ds_read_b64_tr_b16 v[96:97], v111
    ds_read_b64_tr_b16 v[98:99], v111 offset:2560
    ds_read_b64_tr_b16 v[100:101], v112
    ds_read_b64_tr_b16 v[102:103], v112 offset:2560
    ds_read_b64_tr_b16 v[104:105], v113
    ds_read_b64_tr_b16 v[106:107], v113 offset:2560
    s_waitcnt lgkmcnt(4)
    buffer_store_dwordx4 v[96:99], v108, s[16:19], 0 offen sc1
    s_waitcnt lgkmcnt(2)
    buffer_store_dwordx4 v[100:103], v109, s[16:19], 0 offen sc1
    s_waitcnt lgkmcnt(0)
    buffer_store_dwordx4 v[104:107], v110, s[16:19], 0 offen sc1
    global_load_dword v7, v5, s[66:67] sc1
    v_fract_f32 v189, v189
    v_exp_f32 v182, v182
    v_exp_f32 v183, v254
    v_exp_f32 v184, v184
    v_cos_f32 v186, v185
    v_sin_f32 v187, v185
    v_cos_f32 v180, v188
    v_sin_f32 v181, v188
    v_cos_f32 v190, v189
    v_sin_f32 v191, v189
    v_lshlrev_b32 v192, 16, v234
    v_lshlrev_b32 v193, 16, v235
    v_add_f32 v199, v253, v253
    v_mul_f32 v192, v192, v199
    v_mul_f32 v193, v193, v199
    v_mul_f32 v186, v186, v182
    v_mul_f32 v187, v187, v182
    v_mul_f32 v180, v180, v183
    v_mul_f32 v181, v181, v183
    v_mul_f32 v190, v190, v184
    v_mul_f32 v191, v191, v184
    v_mov_b32 v242, 0x3f80
    v_cvt_pk_bf16_f32 v243, v186, v187
    v_pk_mul_f32 v[194:195], v[186:187], v[186:187] op_sel:[0,0] op_sel_hi:[0,1]
    v_pk_fma_f32 v[172:173], v[186:187], v[186:187], v[194:195] op_sel:[1,1,0] op_sel_hi:[1,0,1] neg_lo:[0,1,0]
    v_cvt_pk_bf16_f32 v244, v172, v173
    v_pk_mul_f32 v[194:195], v[172:173], v[186:187] op_sel:[0,0] op_sel_hi:[0,1]
    v_pk_fma_f32 v[174:175], v[172:173], v[186:187], v[194:195] op_sel:[1,1,0] op_sel_hi:[1,0,1] neg_lo:[0,1,0]
    v_cvt_pk_bf16_f32 v245, v174, v175
    v_pk_mul_f32 v[194:195], v[174:175], v[186:187] op_sel:[0,0] op_sel_hi:[0,1]
    v_pk_fma_f32 v[172:173], v[174:175], v[186:187], v[194:195] op_sel:[1,1,0] op_sel_hi:[1,0,1] neg_lo:[0,1,0]
    v_cvt_pk_bf16_f32 v246, v172, v173
    v_pk_mul_f32 v[194:195], v[172:173], v[186:187] op_sel:[0,0] op_sel_hi:[0,1]
    v_pk_fma_f32 v[174:175], v[172:173], v[186:187], v[194:195] op_sel:[1,1,0] op_sel_hi:[1,0,1] neg_lo:[0,1,0]
    v_cvt_pk_bf16_f32 v247, v174, v175
    v_pk_mul_f32 v[194:195], v[174:175], v[186:187] op_sel:[0,0] op_sel_hi:[0,1]
    v_pk_fma_f32 v[172:173], v[174:175], v[186:187], v[194:195] op_sel:[1,1,0] op_sel_hi:[1,0,1] neg_lo:[0,1,0]
    v_cvt_pk_bf16_f32 v248, v172, v173
    v_pk_mul_f32 v[194:195], v[172:173], v[186:187] op_sel:[0,0] op_sel_hi:[0,1]
    v_pk_fma_f32 v[174:175], v[172:173], v[186:187], v[194:195] op_sel:[1,1,0] op_sel_hi:[1,0,1] neg_lo:[0,1,0]
    s_min_u32 s96, s75, 159
    s_lshl_b32 s96, s96, 2
    s_add_u32 s96, s96, s24
    s_mul_i32 s97, s96, 384
    s_lshl_b32 s96, s96, 1
    v_lshl_add_u32 v2, v1, 1, s97
    v_mov_b32 v241, s96
    global_load_ushort v236, v2, s[52:53] offset:256
    global_load_ushort v237, v2, s[54:55] offset:256
    global_load_ushort v238, v2, s[56:57] offset:256
    global_load_ushort v239, v2, s[58:59] offset:256
    global_load_ushort v241, v241, s[62:63]
    v_cvt_pk_bf16_f32 v249, v174, v175
    v_pk_mul_f32 v[194:195], v[174:175], v[186:187] op_sel:[0,0] op_sel_hi:[0,1]
    v_pk_fma_f32 v[172:173], v[174:175], v[186:187], v[194:195] op_sel:[1,1,0] op_sel_hi:[1,0,1] neg_lo:[0,1,0]
    v_cvt_pk_bf16_f32 v250, v172, v173
    v_pk_mul_f32 v[194:195], v[172:173], v[186:187] op_sel:[0,0] op_sel_hi:[0,1]
    v_pk_fma_f32 v[174:175], v[172:173], v[186:187], v[194:195] op_sel:[1,1,0] op_sel_hi:[1,0,1] neg_lo:[0,1,0]
    v_cvt_pk_bf16_f32 v251, v174, v175
    ds_write_addtid_b32 v242 offset:0
    ds_write_addtid_b32 v243 offset:272
    ds_write_addtid_b32 v244 offset:544
    ds_write_addtid_b32 v245 offset:816
    ds_write_addtid_b32 v246 offset:1088
    ds_write_addtid_b32 v247 offset:1360
    ds_write_addtid_b32 v248 offset:1632
    ds_write_addtid_b32 v249 offset:1904
    ds_write_addtid_b32 v250 offset:2176
    ds_write_addtid_b32 v251 offset:2448
    v_pk_mul_f32 v[194:195], v[174:175], v[186:187] op_sel:[0,0] op_sel_hi:[0,1]
    v_pk_fma_f32 v[172:173], v[174:175], v[186:187], v[194:195] op_sel:[1,1,0] op_sel_hi:[1,0,1] neg_lo:[0,1,0]
    v_cvt_pk_bf16_f32 v242, v172, v173
    v_pk_mul_f32 v[194:195], v[172:173], v[186:187] op_sel:[0,0] op_sel_hi:[0,1]
    v_pk_fma_f32 v[174:175], v[172:173], v[186:187], v[194:195] op_sel:[1,1,0] op_sel_hi:[1,0,1] neg_lo:[0,1,0]
    v_cvt_pk_bf16_f32 v243, v174, v175
    v_pk_mul_f32 v[194:195], v[174:175], v[186:187] op_sel:[0,0] op_sel_hi:[0,1]
    v_pk_fma_f32 v[172:173], v[174:175], v[186:187], v[194:195] op_sel:[1,1,0] op_sel_hi:[1,0,1] neg_lo:[0,1,0]
    v_cvt_pk_bf16_f32 v244, v172, v173
    v_pk_mul_f32 v[194:195], v[172:173], v[186:187] op_sel:[0,0] op_sel_hi:[0,1]
    v_pk_fma_f32 v[174:175], v[172:173], v[186:187], v[194:195] op_sel:[1,1,0] op_sel_hi:[1,0,1] neg_lo:[0,1,0]
    v_cvt_pk_bf16_f32 v245, v174, v175
    v_pk_mul_f32 v[194:195], v[174:175], v[186:187] op_sel:[0,0] op_sel_hi:[0,1]
    v_pk_fma_f32 v[172:173], v[174:175], v[186:187], v[194:195] op_sel:[1,1,0] op_sel_hi:[1,0,1] neg_lo:[0,1,0]
    v_cvt_pk_bf16_f32 v246, v172, v173
    v_pk_mul_f32 v[194:195], v[172:173], v[186:187] op_sel:[0,0] op_sel_hi:[0,1]
    v_pk_fma_f32 v[174:175], v[172:173], v[186:187], v[194:195] op_sel:[1,1,0] op_sel_hi:[1,0,1] neg_lo:[0,1,0]
    v_cvt_pk_bf16_f32 v247, v174, v175
    v_pk_mul_f32 v[194:195], v[174:175], v[186:187] op_sel:[0,0] op_sel_hi:[0,1]
    v_pk_fma_f32 v[172:173], v[174:175], v[186:187], v[194:195] op_sel:[1,1,0] op_sel_hi:[1,0,1] neg_lo:[0,1,0]
    v_cvt_pk_bf16_f32 v248, v172, v173
    v_pk_mul_f32 v[194:195], v[172:173], v[186:187] op_sel:[0,0] op_sel_hi:[0,1]
    v_pk_fma_f32 v[174:175], v[172:173], v[186:187], v[194:195] op_sel:[1,1,0] op_sel_hi:[1,0,1] neg_lo:[0,1,0]
    v_lshrrev_b32 v132, 5, v0
    v_and_b32 v133, 31, v0
    v_mul_u32_u24 v132, 1280, v132
    v_lshl_add_u32 v134, v133, 4, v132
    v_mov_b32 v135, 1073741824
    v_cmp_gt_u32 vcc, 16, v133
    s_mul_i32 s96, s2, 10240
    buffer_load_dwordx4 v[120:123], v134, s[4:7], s96 offen
    v_cndmask_b32_e64 v135, v135, v134, vcc
    buffer_load_dwordx4 v[124:127], v134, s[4:7], s96 offen offset:512
    buffer_load_dwordx4 v[128:131], v135, s[4:7], s96 offen offset:1024
    v_cvt_pk_bf16_f32 v249, v174, v175
    v_pk_mul_f32 v[194:195], v[174:175], v[186:187] op_sel:[0,0] op_sel_hi:[0,1]
    v_pk_fma_f32 v[172:173], v[174:175], v[186:187], v[194:195] op_sel:[1,1,0] op_sel_hi:[1,0,1] neg_lo:[0,1,0]
    v_cvt_pk_bf16_f32 v250, v172, v173
    v_pk_mul_f32 v[194:195], v[172:173], v[186:187] op_sel:[0,0] op_sel_hi:[0,1]
    v_pk_fma_f32 v[174:175], v[172:173], v[186:187], v[194:195] op_sel:[1,1,0] op_sel_hi:[1,0,1] neg_lo:[0,1,0]
    v_cvt_pk_bf16_f32 v251, v174, v175
    ds_write_addtid_b32 v242 offset:2720
    ds_write_addtid_b32 v243 offset:2992
    ds_write_addtid_b32 v244 offset:3264
    ds_write_addtid_b32 v245 offset:3536
    ds_write_addtid_b32 v246 offset:3808
    ds_write_addtid_b32 v247 offset:4080
    ds_write_addtid_b32 v248 offset:4352
    ds_write_addtid_b32 v249 offset:4624
    ds_write_addtid_b32 v250 offset:4896
    ds_write_addtid_b32 v251 offset:5168
    v_pk_mul_f32 v[194:195], v[174:175], v[186:187] op_sel:[0,0] op_sel_hi:[0,1]
    v_pk_fma_f32 v[172:173], v[174:175], v[186:187], v[194:195] op_sel:[1,1,0] op_sel_hi:[1,0,1] neg_lo:[0,1,0]
    v_cvt_pk_bf16_f32 v242, v172, v173
    v_pk_mul_f32 v[194:195], v[172:173], v[186:187] op_sel:[0,0] op_sel_hi:[0,1]
    v_pk_fma_f32 v[174:175], v[172:173], v[186:187], v[194:195] op_sel:[1,1,0] op_sel_hi:[1,0,1] neg_lo:[0,1,0]
    v_cvt_pk_bf16_f32 v243, v174, v175
    v_pk_mul_f32 v[194:195], v[174:175], v[186:187] op_sel:[0,0] op_sel_hi:[0,1]
    v_pk_fma_f32 v[172:173], v[174:175], v[186:187], v[194:195] op_sel:[1,1,0] op_sel_hi:[1,0,1] neg_lo:[0,1,0]
    v_cvt_pk_bf16_f32 v244, v172, v173
    v_pk_mul_f32 v[194:195], v[172:173], v[186:187] op_sel:[0,0] op_sel_hi:[0,1]
    v_pk_fma_f32 v[174:175], v[172:173], v[186:187], v[194:195] op_sel:[1,1,0] op_sel_hi:[1,0,1] neg_lo:[0,1,0]
    v_cvt_pk_bf16_f32 v245, v174, v175
    v_pk_mul_f32 v[194:195], v[174:175], v[186:187] op_sel:[0,0] op_sel_hi:[0,1]
    v_pk_fma_f32 v[172:173], v[174:175], v[186:187], v[194:195] op_sel:[1,1,0] op_sel_hi:[1,0,1] neg_lo:[0,1,0]
    v_cvt_pk_bf16_f32 v246, v172, v173
    v_pk_mul_f32 v[194:195], v[172:173], v[186:187] op_sel:[0,0] op_sel_hi:[0,1]
    v_pk_fma_f32 v[174:175], v[172:173], v[186:187], v[194:195] op_sel:[1,1,0] op_sel_hi:[1,0,1] neg_lo:[0,1,0]
    v_cvt_pk_bf16_f32 v247, v174, v175
    v_pk_mul_f32 v[194:195], v[174:175], v[186:187] op_sel:[0,0] op_sel_hi:[0,1]
    v_pk_fma_f32 v[172:173], v[174:175], v[186:187], v[194:195] op_sel:[1,1,0] op_sel_hi:[1,0,1] neg_lo:[0,1,0]
    v_cvt_pk_bf16_f32 v248, v172, v173
    v_pk_mul_f32 v[194:195], v[172:173], v[186:187] op_sel:[0,0] op_sel_hi:[0,1]
    v_pk_fma_f32 v[174:175], v[172:173], v[186:187], v[194:195] op_sel:[1,1,0] op_sel_hi:[1,0,1] neg_lo:[0,1,0]
    v_mov_b32 v140, 1073741824
    v_lshlrev_b32 v141, 2, v0
    v_cmp_gt_u32 vcc, 64, v0
    s_nop 1
    v_cndmask_b32 v141, v140, v141, vcc
    v_mov_b32_e64 v140, 0
    s_lshl_b32 s97, s2, 8
    s_add_u32 s97, s97, 3473408
    buffer_store_dword v140, v141, s[16:19], s97 offen sc1
    v_cvt_pk_bf16_f32 v249, v174, v175
    v_pk_mul_f32 v[194:195], v[174:175], v[186:187] op_sel:[0,0] op_sel_hi:[0,1]
    v_pk_fma_f32 v[172:173], v[174:175], v[186:187], v[194:195] op_sel:[1,1,0] op_sel_hi:[1,0,1] neg_lo:[0,1,0]
    v_cvt_pk_bf16_f32 v250, v172, v173
    v_pk_mul_f32 v[194:195], v[172:173], v[186:187] op_sel:[0,0] op_sel_hi:[0,1]
    v_pk_fma_f32 v[174:175], v[172:173], v[186:187], v[194:195] op_sel:[1,1,0] op_sel_hi:[1,0,1] neg_lo:[0,1,0]
    v_cvt_pk_bf16_f32 v251, v174, v175
    ds_write_addtid_b32 v242 offset:5440
    ds_write_addtid_b32 v243 offset:5712
    ds_write_addtid_b32 v244 offset:5984
    ds_write_addtid_b32 v245 offset:6256
    ds_write_addtid_b32 v246 offset:6528
    ds_write_addtid_b32 v247 offset:6800
    ds_write_addtid_b32 v248 offset:7072
    ds_write_addtid_b32 v249 offset:7344
    ds_write_addtid_b32 v250 offset:7616
    ds_write_addtid_b32 v251 offset:7888
    v_pk_mul_f32 v[194:195], v[174:175], v[186:187] op_sel:[0,0] op_sel_hi:[0,1]
    v_pk_fma_f32 v[172:173], v[174:175], v[186:187], v[194:195] op_sel:[1,1,0] op_sel_hi:[1,0,1] neg_lo:[0,1,0]
    v_cvt_pk_bf16_f32 v242, v172, v173
    v_pk_mul_f32 v[194:195], v[172:173], v[186:187] op_sel:[0,0] op_sel_hi:[0,1]
    v_pk_fma_f32 v[174:175], v[172:173], v[186:187], v[194:195] op_sel:[1,1,0] op_sel_hi:[1,0,1] neg_lo:[0,1,0]
    v_cvt_pk_bf16_f32 v243, v174, v175
    ds_write_addtid_b32 v242 offset:8160
    ds_write_addtid_b32 v243 offset:8432
    ds_read_b128 a[160:163], v252 offset:0
    ds_read_b128 a[164:167], v252 offset:32
    ds_read_b128 a[168:171], v252 offset:64
    ds_read_b128 a[172:175], v252 offset:96
    ds_read_b128 a[176:179], v252 offset:128
    ds_read_b128 a[180:183], v252 offset:160
    ds_read_b128 a[184:187], v252 offset:192
    ds_read_b128 a[188:191], v252 offset:224
    v_pk_mul_f32 v[194:195], v[180:181], v[180:181] op_sel:[0,0] op_sel_hi:[0,1]
    v_pk_fma_f32 v[182:183], v[180:181], v[180:181], v[194:195] op_sel:[1,1,0] op_sel_hi:[1,0,1] neg_lo:[0,1,0]
    v_pk_mul_f32 v[194:195], v[182:183], v[182:183] op_sel:[0,0] op_sel_hi:[0,1]
    v_pk_fma_f32 v[184:185], v[182:183], v[182:183], v[194:195] op_sel:[1,1,0] op_sel_hi:[1,0,1] neg_lo:[0,1,0]
    v_cvt_pk_bf16_f32 v242, v192, -v193
    v_pk_mul_f32 v[194:195], v[192:193], v[180:181] op_sel:[0,0] op_sel_hi:[0,1]
    v_pk_fma_f32 v[174:175], v[192:193], v[180:181], v[194:195] op_sel:[1,1,0] op_sel_hi:[1,0,1] neg_lo:[0,1,0]
    v_mov_b32 v142, 1073741824
    v_lshlrev_b32 v143, 2, v0
    v_cmp_gt_u32 vcc, 16, v0
    s_nop 1
    v_cndmask_b32 v143, v142, v143, vcc
    v_mov_b32_e64 v142, -1
    s_lshl_b32 s97, s2, 6
    s_add_u32 s97, s97, 3457024
    buffer_store_dword v142, v143, s[16:19], s97 offen sc1
    v_cvt_pk_bf16_f32 v243, v174, -v175
    v_pk_mul_f32 v[194:195], v[174:175], v[180:181] op_sel:[0,0] op_sel_hi:[0,1]
    v_pk_fma_f32 v[172:173], v[174:175], v[180:181], v[194:195] op_sel:[1,1,0] op_sel_hi:[1,0,1] neg_lo:[0,1,0]
    v_cvt_pk_bf16_f32 v244, v172, -v173
    v_pk_mul_f32 v[194:195], v[172:173], v[180:181] op_sel:[0,0] op_sel_hi:[0,1]
    v_pk_fma_f32 v[174:175], v[172:173], v[180:181], v[194:195] op_sel:[1,1,0] op_sel_hi:[1,0,1] neg_lo:[0,1,0]
    v_cvt_pk_bf16_f32 v245, v174, -v175
    v_pk_mul_f32 v[194:195], v[174:175], v[180:181] op_sel:[0,0] op_sel_hi:[0,1]
    v_pk_fma_f32 v[172:173], v[174:175], v[180:181], v[194:195] op_sel:[1,1,0] op_sel_hi:[1,0,1] neg_lo:[0,1,0]
    v_cvt_pk_bf16_f32 v246, v172, -v173
    v_pk_mul_f32 v[194:195], v[172:173], v[180:181] op_sel:[0,0] op_sel_hi:[0,1]
    v_pk_fma_f32 v[174:175], v[172:173], v[180:181], v[194:195] op_sel:[1,1,0] op_sel_hi:[1,0,1] neg_lo:[0,1,0]
    v_cvt_pk_bf16_f32 v247, v174, -v175
    v_pk_mul_f32 v[194:195], v[174:175], v[180:181] op_sel:[0,0] op_sel_hi:[0,1]
    v_pk_fma_f32 v[172:173], v[174:175], v[180:181], v[194:195] op_sel:[1,1,0] op_sel_hi:[1,0,1] neg_lo:[0,1,0]
    v_cvt_pk_bf16_f32 v248, v172, -v173
    v_pk_mul_f32 v[194:195], v[172:173], v[180:181] op_sel:[0,0] op_sel_hi:[0,1]
    v_pk_fma_f32 v[174:175], v[172:173], v[180:181], v[194:195] op_sel:[1,1,0] op_sel_hi:[1,0,1] neg_lo:[0,1,0]
    v_cvt_pk_bf16_f32 v249, v174, -v175
    v_pk_mul_f32 v[194:195], v[192:193], v[190:191] op_sel:[0,0] op_sel_hi:[0,1]
    v_pk_fma_f32 v[176:177], v[192:193], v[190:191], v[194:195] op_sel:[1,1,0] op_sel_hi:[1,0,1] neg_lo:[0,1,0]
    v_cvt_pk_bf16_f32 v250, v176, -v177
    v_pk_mul_f32 v[194:195], v[176:177], v[182:183] op_sel:[0,0] op_sel_hi:[0,1]
    v_pk_fma_f32 v[174:175], v[176:177], v[182:183], v[194:195] op_sel:[1,1,0] op_sel_hi:[1,0,1] neg_lo:[0,1,0]
    v_cvt_pk_bf16_f32 v251, v174, -v175
    ds_write_addtid_b32 v242 offset:0
    ds_write_addtid_b32 v243 offset:272
    ds_write_addtid_b32 v244 offset:544
    ds_write_addtid_b32 v245 offset:816
    ds_write_addtid_b32 v246 offset:1088
    ds_write_addtid_b32 v247 offset:1360
    ds_write_addtid_b32 v248 offset:1632
    ds_write_addtid_b32 v249 offset:1904
    ds_write_addtid_b32 v250 offset:2176
    ds_write_addtid_b32 v251 offset:2448
    v_pk_mul_f32 v[194:195], v[174:175], v[182:183] op_sel:[0,0] op_sel_hi:[0,1]
    v_pk_fma_f32 v[172:173], v[174:175], v[182:183], v[194:195] op_sel:[1,1,0] op_sel_hi:[1,0,1] neg_lo:[0,1,0]
    v_cvt_pk_bf16_f32 v242, v172, -v173
    v_pk_mul_f32 v[194:195], v[172:173], v[182:183] op_sel:[0,0] op_sel_hi:[0,1]
    v_pk_fma_f32 v[174:175], v[172:173], v[182:183], v[194:195] op_sel:[1,1,0] op_sel_hi:[1,0,1] neg_lo:[0,1,0]
    s_waitcnt vmcnt(11)
    s_waitcnt vmcnt(10)
    v_cmp_gt_u32 vcc, 1, v7
    s_nop 0
    s_and_b64 vcc, vcc, s[50:51]
    s_and_b64 vcc, vcc, 1
    s_cbranch_scc1 ps_5
pc_7:
    s_barrier
    v_lshlrev_b32 v2, 3, v4
    v_mov_b32 v5, 1
    v_cndmask_b32 v2, v4, v2, s[50:51]
    buffer_atomic_add v5, v2, s[16:19], s86 offen offset:0 sc1
    v_cvt_pk_bf16_f32 v243, v174, -v175
    v_pk_mul_f32 v[194:195], v[174:175], v[182:183] op_sel:[0,0] op_sel_hi:[0,1]
    v_pk_fma_f32 v[172:173], v[174:175], v[182:183], v[194:195] op_sel:[1,1,0] op_sel_hi:[1,0,1] neg_lo:[0,1,0]
    v_cvt_pk_bf16_f32 v244, v172, -v173
    v_pk_mul_f32 v[194:195], v[176:177], v[190:191] op_sel:[0,0] op_sel_hi:[0,1]
    v_pk_fma_f32 v[178:179], v[176:177], v[190:191], v[194:195] op_sel:[1,1,0] op_sel_hi:[1,0,1] neg_lo:[0,1,0]
    v_cvt_pk_bf16_f32 v245, v178, -v179
    v_pk_mul_f32 v[194:195], v[178:179], v[184:185] op_sel:[0,0] op_sel_hi:[0,1]
    v_pk_fma_f32 v[174:175], v[178:179], v[184:185], v[194:195] op_sel:[1,1,0] op_sel_hi:[1,0,1] neg_lo:[0,1,0]
    v_cvt_pk_bf16_f32 v246, v174, -v175
    v_pk_mul_f32 v[194:195], v[174:175], v[184:185] op_sel:[0,0] op_sel_hi:[0,1]
    v_pk_fma_f32 v[172:173], v[174:175], v[184:185], v[194:195] op_sel:[1,1,0] op_sel_hi:[1,0,1] neg_lo:[0,1,0]
    v_cvt_pk_bf16_f32 v247, v172, -v173
    v_pk_mul_f32 v[194:195], v[178:179], v[190:191] op_sel:[0,0] op_sel_hi:[0,1]
    v_pk_fma_f32 v[176:177], v[178:179], v[190:191], v[194:195] op_sel:[1,1,0] op_sel_hi:[1,0,1] neg_lo:[0,1,0]
    v_cvt_pk_bf16_f32 v248, v176, -v177
    v_pk_mul_f32 v[194:195], v[176:177], v[184:185] op_sel:[0,0] op_sel_hi:[0,1]
    v_pk_fma_f32 v[174:175], v[176:177], v[184:185], v[194:195] op_sel:[1,1,0] op_sel_hi:[1,0,1] neg_lo:[0,1,0]
    v_cvt_pk_bf16_f32 v249, v174, -v175
    v_pk_mul_f32 v[194:195], v[174:175], v[184:185] op_sel:[0,0] op_sel_hi:[0,1]
    v_pk_fma_f32 v[172:173], v[174:175], v[184:185], v[194:195] op_sel:[1,1,0] op_sel_hi:[1,0,1] neg_lo:[0,1,0]
    v_cvt_pk_bf16_f32 v250, v172, -v173
    v_pk_mul_f32 v[194:195], v[176:177], v[190:191] op_sel:[0,0] op_sel_hi:[0,1]
    v_pk_fma_f32 v[178:179], v[176:177], v[190:191], v[194:195] op_sel:[1,1,0] op_sel_hi:[1,0,1] neg_lo:[0,1,0]
    v_cvt_pk_bf16_f32 v251, v178, -v179
    ds_write_addtid_b32 v242 offset:2720
    ds_write_addtid_b32 v242 offset:3264
    ds_write_addtid_b32 v243 offset:3536
    ds_write_addtid_b32 v244 offset:3808
    ds_write_addtid_b32 v245 offset:4352
    ds_write_addtid_b32 v246 offset:4624
    ds_write_addtid_b32 v247 offset:4896
    ds_write_addtid_b32 v248 offset:5440
    ds_write_addtid_b32 v249 offset:5712
    ds_write_addtid_b32 v250 offset:5984
    v_mov_b32 v144, -1
    v_mov_b32 v145, -1
    v_mov_b32 v146, -1
    v_mov_b32 v147, -1
    v_lshlrev_b32 v148, 4, v0
    s_sub_u32 s88, s2, 0
    s_mul_i32 s88, s88, 20480
    s_min_u32 s88, s88, 5222400
    s_add_u32 s88, s88, 4194304
    buffer_store_dwordx4 v[144:147], v148, s[16:19], s88 offen sc1
    ds_write_addtid_b32 v251 offset:6528
    v_pk_mul_f32 v[194:195], v[178:179], v[186:187] op_sel:[0,0] op_sel_hi:[0,1]
    v_pk_fma_f32 v[174:175], v[178:179], v[186:187], v[194:195] op_sel:[1,1,0] op_sel_hi:[1,0,1] neg_lo:[0,1,0]
    v_cvt_pk_bf16_f32 v242, v174, -v175
    v_pk_mul_f32 v[194:195], v[178:179], v[190:191] op_sel:[0,0] op_sel_hi:[0,1]
    v_pk_fma_f32 v[176:177], v[178:179], v[190:191], v[194:195] op_sel:[1,1,0] op_sel_hi:[1,0,1] neg_lo:[0,1,0]
    v_cvt_pk_bf16_f32 v243, v176, -v177
    v_pk_mul_f32 v[194:195], v[176:177], v[186:187] op_sel:[0,0] op_sel_hi:[0,1]
    v_pk_fma_f32 v[174:175], v[176:177], v[186:187], v[194:195] op_sel:[1,1,0] op_sel_hi:[1,0,1] neg_lo:[0,1,0]
    v_cvt_pk_bf16_f32 v244, v174, -v175
    v_pk_mul_f32 v[194:195], v[176:177], v[190:191] op_sel:[0,0] op_sel_hi:[0,1]
    v_pk_fma_f32 v[178:179], v[176:177], v[190:191], v[194:195] op_sel:[1,1,0] op_sel_hi:[1,0,1] neg_lo:[0,1,0]
    v_cvt_pk_bf16_f32 v245, v178, -v179
    v_pk_mul_f32 v[194:195], v[178:179], v[186:187] op_sel:[0,0] op_sel_hi:[0,1]
    v_pk_fma_f32 v[174:175], v[178:179], v[186:187], v[194:195] op_sel:[1,1,0] op_sel_hi:[1,0,1] neg_lo:[0,1,0]
    v_cvt_pk_bf16_f32 v246, v174, -v175
    v_pk_mul_f32 v[194:195], v[178:179], v[190:191] op_sel:[0,0] op_sel_hi:[0,1]
    v_pk_fma_f32 v[176:177], v[178:179], v[190:191], v[194:195] op_sel:[1,1,0] op_sel_hi:[1,0,1] neg_lo:[0,1,0]
    v_cvt_pk_bf16_f32 v247, v176, -v177
    v_pk_mul_f32 v[194:195], v[176:177], v[186:187] op_sel:[0,0] op_sel_hi:[0,1]
    v_pk_fma_f32 v[174:175], v[176:177], v[186:187], v[194:195] op_sel:[1,1,0] op_sel_hi:[1,0,1] neg_lo:[0,1,0]
    v_cvt_pk_bf16_f32 v248, v174, -v175
    ds_write_addtid_b32 v242 offset:6800
    ds_write_addtid_b32 v243 offset:7072
    ds_write_addtid_b32 v244 offset:7344
    ds_write_addtid_b32 v245 offset:7616
    ds_write_addtid_b32 v246 offset:7888
    ds_write_addtid_b32 v247 offset:8160
    ds_write_addtid_b32 v248 offset:8432
    ds_read_b128 a[192:195], v252 offset:0
    ds_read_b128 a[196:199], v252 offset:32
    ds_read_b128 a[200:203], v252 offset:64
    ds_read_b128 a[204:207], v252 offset:96
    ds_read_b128 a[208:211], v252 offset:128
    ds_read_b128 a[212:215], v252 offset:160
    s_add_u32 s88, s88, 4096
    buffer_store_dwordx4 v[144:147], v148, s[16:19], s88 offen sc1
    ds_read_b128 a[216:219], v252 offset:192
    ds_read_b128 a[220:223], v252 offset:224
    v_and_b32 v199, 0xffff0000, v232
    v_mul_f32 v199, 0x3fb8aa3b, v199
    v_exp_f32 v199, v199
    v_and_b32 v255, 0xffff0000, v233
    v_mul_f32 v255, v255, v253
    v_mul_f32 v255, 0x3e22f983, v255
    v_cvt_pk_bf16_f32 v199, v199, v199
    v_lshlrev_b32 v199, 16, v199
    v_mul_f32 v254, v199, v253
    v_mul_f32 v254, 0xbfb8aa3b, v254
    s_waitcnt lgkmcnt(7)
    v_mfma_f32_32x32x16_bf16 v[216:231], a[192:195], a[160:163], 0
    v_mul_f32 v182, 0x41000000, v254
    v_mul_f32 v185, 0x41000000, v255
    v_mul_f32 v184, 0x43800000, v254
    v_mul_f32 v189, 0x43800000, v255
    s_waitcnt lgkmcnt(6)
    v_mfma_f32_32x32x16_bf16 v[216:231], a[196:199], a[164:167], v[216:231]
    v_fract_f32 v185, v185
    v_fract_f32 v188, v255
    v_fract_f32 v189, v189
    v_exp_f32 v182, v182
    s_waitcnt lgkmcnt(5)
    v_mfma_f32_32x32x16_bf16 v[216:231], a[200:203], a[168:171], v[216:231]
    v_exp_f32 v183, v254
    v_exp_f32 v184, v184
    v_cos_f32 v186, v185
    v_sin_f32 v187, v185
    s_waitcnt lgkmcnt(4)
    v_mfma_f32_32x32x16_bf16 v[216:231], a[204:207], a[172:175], v[216:231]
    v_cos_f32 v180, v188
    v_sin_f32 v181, v188
    v_cos_f32 v190, v189
    v_sin_f32 v191, v189
    s_waitcnt lgkmcnt(3)
    v_mfma_f32_32x32x16_bf16 v[216:231], a[208:211], a[176:179], v[216:231]
    v_and_b32 v192, 0xffff0000, v234
    v_and_b32 v193, 0xffff0000, v235
    s_add_u32 s88, s88, 4096
    buffer_store_dwordx4 v[144:147], v148, s[16:19], s88 offen sc1
    v_add_f32 v199, v253, v253
    v_mul_f32 v192, v192, v199
    s_waitcnt lgkmcnt(2)
    v_mfma_f32_32x32x16_bf16 v[216:231], a[212:215], a[180:183], v[216:231]
    v_mul_f32 v193, v193, v199
    v_mul_f32 v186, v186, v182
    v_mul_f32 v187, v187, v182
    v_mul_f32 v180, v180, v183
    s_waitcnt lgkmcnt(1)
    v_mfma_f32_32x32x16_bf16 v[216:231], a[216:219], a[184:187], v[216:231]
    v_mul_f32 v181, v181, v183
    v_mul_f32 v190, v190, v184
    v_mul_f32 v191, v191, v184
    s_waitcnt lgkmcnt(0)
    v_mfma_f32_32x32x16_bf16 v[216:231], a[220:223], a[188:191], v[216:231]
    v_mov_b32 v242, 0x3f80
    v_cvt_pk_bf16_f32 v243, v186, v187
    v_pk_mul_f32 v[194:195], v[186:187], v[186:187] op_sel:[0,0] op_sel_hi:[0,1]
    v_pk_fma_f32 v[172:173], v[186:187], v[186:187], v[194:195] op_sel:[1,1,0] op_sel_hi:[1,0,1] neg_lo:[0,1,0]
    v_cvt_pk_bf16_f32 v244, v172, v173
    v_pk_mul_f32 v[194:195], v[172:173], v[186:187] op_sel:[0,0] op_sel_hi:[0,1]
    v_pk_fma_f32 v[174:175], v[172:173], v[186:187], v[194:195] op_sel:[1,1,0] op_sel_hi:[1,0,1] neg_lo:[0,1,0]
    v_cvt_pk_bf16_f32 v245, v174, v175
    v_pk_mul_f32 v[194:195], v[174:175], v[186:187] op_sel:[0,0] op_sel_hi:[0,1]
    v_pk_fma_f32 v[172:173], v[174:175], v[186:187], v[194:195] op_sel:[1,1,0] op_sel_hi:[1,0,1] neg_lo:[0,1,0]
    v_cvt_pk_bf16_f32 v246, v172, v173
    v_pk_mul_f32 v[194:195], v[172:173], v[186:187] op_sel:[0,0] op_sel_hi:[0,1]
    v_pk_fma_f32 v[174:175], v[172:173], v[186:187], v[194:195] op_sel:[1,1,0] op_sel_hi:[1,0,1] neg_lo:[0,1,0]
    v_cvt_pk_bf16_f32 v247, v174, v175
    v_pk_mul_f32 v[194:195], v[174:175], v[186:187] op_sel:[0,0] op_sel_hi:[0,1]
    v_pk_fma_f32 v[172:173], v[174:175], v[186:187], v[194:195] op_sel:[1,1,0] op_sel_hi:[1,0,1] neg_lo:[0,1,0]
    v_cvt_pk_bf16_f32 v248, v172, v173
    v_pk_mul_f32 v[194:195], v[172:173], v[186:187] op_sel:[0,0] op_sel_hi:[0,1]
    v_pk_fma_f32 v[174:175], v[172:173], v[186:187], v[194:195] op_sel:[1,1,0] op_sel_hi:[1,0,1] neg_lo:[0,1,0]
    v_cvt_pk_bf16_f32 v249, v174, v175
    v_pk_mul_f32 v[194:195], v[174:175], v[186:187] op_sel:[0,0] op_sel_hi:[0,1]
    v_pk_fma_f32 v[172:173], v[174:175], v[186:187], v[194:195] op_sel:[1,1,0] op_sel_hi:[1,0,1] neg_lo:[0,1,0]
    v_cvt_pk_bf16_f32 v250, v172, v173
    s_add_u32 s88, s88, 4096
    buffer_store_dwordx4 v[144:147], v148, s[16:19], s88 offen sc1
    v_pk_mul_f32 v[194:195], v[172:173], v[186:187] op_sel:[0,0] op_sel_hi:[0,1]
    v_pk_fma_f32 v[174:175], v[172:173], v[186:187], v[194:195] op_sel:[1,1,0] op_sel_hi:[1,0,1] neg_lo:[0,1,0]
    v_cvt_pk_bf16_f32 v251, v174, v175
    ds_write_addtid_b32 v242 offset:0
    ds_write_addtid_b32 v243 offset:272
    ds_write_addtid_b32 v244 offset:544
    ds_write_addtid_b32 v245 offset:816
    ds_write_addtid_b32 v246 offset:1088
    ds_write_addtid_b32 v247 offset:1360
    ds_write_addtid_b32 v248 offset:1632
    ds_write_addtid_b32 v249 offset:1904
    ds_write_addtid_b32 v250 offset:2176
    ds_write_addtid_b32 v251 offset:2448
    v_pk_mul_f32 v[194:195], v[174:175], v[186:187] op_sel:[0,0] op_sel_hi:[0,1]
    v_pk_fma_f32 v[172:173], v[174:175], v[186:187], v[194:195] op_sel:[1,1,0] op_sel_hi:[1,0,1] neg_lo:[0,1,0]
    v_cvt_pk_bf16_f32 v242, v172, v173
    v_pk_mul_f32 v[194:195], v[172:173], v[186:187] op_sel:[0,0] op_sel_hi:[0,1]
    v_pk_fma_f32 v[174:175], v[172:173], v[186:187], v[194:195] op_sel:[1,1,0] op_sel_hi:[1,0,1] neg_lo:[0,1,0]
    v_cvt_pk_bf16_f32 v243, v174, v175
    v_pk_mul_f32 v[194:195], v[174:175], v[186:187] op_sel:[0,0] op_sel_hi:[0,1]
    v_pk_fma_f32 v[172:173], v[174:175], v[186:187], v[194:195] op_sel:[1,1,0] op_sel_hi:[1,0,1] neg_lo:[0,1,0]
    v_cvt_pk_bf16_f32 v244, v172, v173
    v_pk_mul_f32 v[194:195], v[172:173], v[186:187] op_sel:[0,0] op_sel_hi:[0,1]
    v_pk_fma_f32 v[174:175], v[172:173], v[186:187], v[194:195] op_sel:[1,1,0] op_sel_hi:[1,0,1] neg_lo:[0,1,0]
    v_cvt_pk_bf16_f32 v245, v174, v175
    v_pk_mul_f32 v[194:195], v[174:175], v[186:187] op_sel:[0,0] op_sel_hi:[0,1]
    v_pk_fma_f32 v[172:173], v[174:175], v[186:187], v[194:195] op_sel:[1,1,0] op_sel_hi:[1,0,1] neg_lo:[0,1,0]
    v_cvt_pk_bf16_f32 v246, v172, v173
    v_pk_mul_f32 v[194:195], v[172:173], v[186:187] op_sel:[0,0] op_sel_hi:[0,1]
    v_pk_fma_f32 v[174:175], v[172:173], v[186:187], v[194:195] op_sel:[1,1,0] op_sel_hi:[1,0,1] neg_lo:[0,1,0]
    v_cvt_pk_bf16_f32 v247, v174, v175
    v_pk_mul_f32 v[194:195], v[174:175], v[186:187] op_sel:[0,0] op_sel_hi:[0,1]
    v_pk_fma_f32 v[172:173], v[174:175], v[186:187], v[194:195] op_sel:[1,1,0] op_sel_hi:[1,0,1] neg_lo:[0,1,0]
    v_cvt_pk_bf16_f32 v248, v172, v173
    v_pk_mul_f32 v[194:195], v[172:173], v[186:187] op_sel:[0,0] op_sel_hi:[0,1]
    s_add_u32 s88, s88, 4096
    buffer_store_dwordx4 v[144:147], v148, s[16:19], s88 offen sc1
    v_pk_fma_f32 v[174:175], v[172:173], v[186:187], v[194:195] op_sel:[1,1,0] op_sel_hi:[1,0,1] neg_lo:[0,1,0]
    v_cvt_pk_bf16_f32 v249, v174, v175
    v_pk_mul_f32 v[194:195], v[174:175], v[186:187] op_sel:[0,0] op_sel_hi:[0,1]
    v_pk_fma_f32 v[172:173], v[174:175], v[186:187], v[194:195] op_sel:[1,1,0] op_sel_hi:[1,0,1] neg_lo:[0,1,0]
    v_cvt_pk_bf16_f32 v250, v172, v173
    v_pk_mul_f32 v[194:195], v[172:173], v[186:187] op_sel:[0,0] op_sel_hi:[0,1]
    v_pk_fma_f32 v[174:175], v[172:173], v[186:187], v[194:195] op_sel:[1,1,0] op_sel_hi:[1,0,1] neg_lo:[0,1,0]
    v_cvt_pk_bf16_f32 v251, v174, v175
    ds_write_addtid_b32 v242 offset:2720
    ds_write_addtid_b32 v243 offset:2992
    ds_write_addtid_b32 v244 offset:3264
    ds_write_addtid_b32 v245 offset:3536
    ds_write_addtid_b32 v246 offset:3808
    ds_write_addtid_b32 v247 offset:4080
    ds_write_addtid_b32 v248 offset:4352
    ds_write_addtid_b32 v249 offset:4624
    ds_write_addtid_b32 v250 offset:4896
    ds_write_addtid_b32 v251 offset:5168
    v_pk_mul_f32 v[194:195], v[174:175], v[186:187] op_sel:[0,0] op_sel_hi:[0,1]
    v_pk_fma_f32 v[172:173], v[174:175], v[186:187], v[194:195] op_sel:[1,1,0] op_sel_hi:[1,0,1] neg_lo:[0,1,0]
    v_cvt_pk_bf16_f32 v242, v172, v173
    v_pk_mul_f32 v[194:195], v[172:173], v[186:187] op_sel:[0,0] op_sel_hi:[0,1]
    v_pk_fma_f32 v[174:175], v[172:173], v[186:187], v[194:195] op_sel:[1,1,0] op_sel_hi:[1,0,1] neg_lo:[0,1,0]
    v_cvt_pk_bf16_f32 v243, v174, v175
    v_pk_mul_f32 v[194:195], v[174:175], v[186:187] op_sel:[0,0] op_sel_hi:[0,1]
    v_pk_fma_f32 v[172:173], v[174:175], v[186:187], v[194:195] op_sel:[1,1,0] op_sel_hi:[1,0,1] neg_lo:[0,1,0]
    v_cvt_pk_bf16_f32 v244, v172, v173
    v_pk_mul_f32 v[194:195], v[172:173], v[186:187] op_sel:[0,0] op_sel_hi:[0,1]
    v_pk_fma_f32 v[174:175], v[172:173], v[186:187], v[194:195] op_sel:[1,1,0] op_sel_hi:[1,0,1] neg_lo:[0,1,0]
    v_cvt_pk_bf16_f32 v245, v174, v175
    v_pk_mul_f32 v[194:195], v[174:175], v[186:187] op_sel:[0,0] op_sel_hi:[0,1]
    v_pk_fma_f32 v[172:173], v[174:175], v[186:187], v[194:195] op_sel:[1,1,0] op_sel_hi:[1,0,1] neg_lo:[0,1,0]
    v_cvt_pk_bf16_f32 v246, v172, v173
    v_pk_mul_f32 v[194:195], v[172:173], v[186:187] op_sel:[0,0] op_sel_hi:[0,1]
    v_pk_fma_f32 v[174:175], v[172:173], v[186:187], v[194:195] op_sel:[1,1,0] op_sel_hi:[1,0,1] neg_lo:[0,1,0]
    v_mov_b32 v134, 0x3f803f80
    v_mov_b32 v132, 0
    v_mov_b32 v133, 0
    s_waitcnt vmcnt(10)
    v_dot2c_f32_bf16 v132, v120, v134
    v_dot2c_f32_bf16 v133, v120, v120
    v_dot2c_f32_bf16 v132, v121, v134
    v_dot2c_f32_bf16 v133, v121, v121
    v_dot2c_f32_bf16 v132, v122, v134
    v_dot2c_f32_bf16 v133, v122, v122
    v_dot2c_f32_bf16 v132, v123, v134
    v_dot2c_f32_bf16 v133, v123, v123
    s_waitcnt vmcnt(9)
    v_dot2c_f32_bf16 v132, v124, v134
    v_dot2c_f32_bf16 v133, v124, v124
    v_dot2c_f32_bf16 v132, v125, v134
    v_dot2c_f32_bf16 v133, v125, v125
    v_dot2c_f32_bf16 v132, v126, v134
    v_dot2c_f32_bf16 v133, v126, v126
    v_dot2c_f32_bf16 v132, v127, v134
    v_dot2c_f32_bf16 v133, v127, v127
    s_waitcnt vmcnt(8)
    v_dot2c_f32_bf16 v132, v128, v134
    v_dot2c_f32_bf16 v133, v128, v128
    v_dot2c_f32_bf16 v132, v129, v134
    v_dot2c_f32_bf16 v133, v129, v129
    v_dot2c_f32_bf16 v132, v130, v134
    v_dot2c_f32_bf16 v133, v130, v130
    v_dot2c_f32_bf16 v132, v131, v134
    v_dot2c_f32_bf16 v133, v131, v131
    v_lshrrev_b32 v135, 5, v0
    v_and_b32 v121, 3, v135
    v_lshrrev_b32 v135, 2, v135
    v_add_f32_dpp v132, v132, v132 row_shr:1 row_mask:0xf bank_mask:0xf bound_ctrl:0
    v_add_f32_dpp v133, v133, v133 row_shr:1 row_mask:0xf bank_mask:0xf bound_ctrl:0
    v_lshlrev_b32_e64 v135, 3, v135
    v_add_f32_dpp v132, v132, v132 row_shr:2 row_mask:0xf bank_mask:0xf bound_ctrl:0
    v_add_f32_dpp v133, v133, v133 row_shr:2 row_mask:0xf bank_mask:0xf bound_ctrl:0
    v_lshl_add_u32 v135, v121, 12, v135
    v_add_f32_dpp v132, v132, v132 row_shr:4 row_mask:0xf bank_mask:0xf bound_ctrl:0
    v_add_f32_dpp v133, v133, v133 row_shr:4 row_mask:0xf bank_mask:0xf bound_ctrl:0
    v_and_b32_e64 v121, 31, v0
    v_add_f32_dpp v132, v132, v132 row_shr:8 row_mask:0xf bank_mask:0xf bound_ctrl:0
    v_add_f32_dpp v133, v133, v133 row_shr:8 row_mask:0xf bank_mask:0xf bound_ctrl:0
    v_cmp_eq_u32_e64 vcc, 31, v121
    v_add_f32_dpp v132, v132, v132 row_bcast:15 row_mask:0xa bank_mask:0xf
    v_add_f32_dpp v133, v133, v133 row_bcast:15 row_mask:0xa bank_mask:0xf
    v_mov_b32 v121, 1073741824
    v_cndmask_b32_e64 v120, v121, v135, vcc
    s_lshl_b32 s96, s2, 4
    s_add_u32 s96, s96, 3440640
    v_mul_f32 v135, 0x3acccccd, v132
    v_mul_f32 v133, 0x3acccccd, v133
    v_fma_f32 v133, -v135, v135, v133
    v_max_f32 v133, 0, v133
    v_add_f32 v133, 0x3727c5ac, v133
    v_rsq_f32_e64 v132, v133
    s_nop 0
    v_mul_f32 v133, -v135, v132
    buffer_store_dwordx2 v[132:133], v120, s[16:19], s96 offen sc1
    v_cvt_pk_bf16_f32 v247, v174, v175
    v_pk_mul_f32 v[194:195], v[174:175], v[186:187] op_sel:[0,0] op_sel_hi:[0,1]
    v_pk_fma_f32 v[172:173], v[174:175], v[186:187], v[194:195] op_sel:[1,1,0] op_sel_hi:[1,0,1] neg_lo:[0,1,0]
    v_cvt_pk_bf16_f32 v248, v172, v173
    v_pk_mul_f32 v[194:195], v[172:173], v[186:187] op_sel:[0,0] op_sel_hi:[0,1]
    v_pk_fma_f32 v[174:175], v[172:173], v[186:187], v[194:195] op_sel:[1,1,0] op_sel_hi:[1,0,1] neg_lo:[0,1,0]
    v_cvt_pk_bf16_f32 v249, v174, v175
    v_pk_mul_f32 v[194:195], v[174:175], v[186:187] op_sel:[0,0] op_sel_hi:[0,1]
    v_pk_fma_f32 v[172:173], v[174:175], v[186:187], v[194:195] op_sel:[1,1,0] op_sel_hi:[1,0,1] neg_lo:[0,1,0]
    v_cvt_pk_bf16_f32 v250, v172, v173
    v_pk_mul_f32 v[194:195], v[172:173], v[186:187] op_sel:[0,0] op_sel_hi:[0,1]
    v_pk_fma_f32 v[174:175], v[172:173], v[186:187], v[194:195] op_sel:[1,1,0] op_sel_hi:[1,0,1] neg_lo:[0,1,0]
    v_cvt_pk_bf16_f32 v251, v174, v175
    ds_write_addtid_b32 v242 offset:5440
    ds_write_addtid_b32 v243 offset:5712
    ds_write_addtid_b32 v244 offset:5984
    ds_write_addtid_b32 v245 offset:6256
    ds_write_addtid_b32 v246 offset:6528
    ds_write_addtid_b32 v247 offset:6800
    ds_write_addtid_b32 v248 offset:7072
    ds_write_addtid_b32 v249 offset:7344
    ds_write_addtid_b32 v250 offset:7616
    ds_write_addtid_b32 v251 offset:7888
    v_pk_mul_f32 v[194:195], v[174:175], v[186:187] op_sel:[0,0] op_sel_hi:[0,1]
    v_pk_fma_f32 v[172:173], v[174:175], v[186:187], v[194:195] op_sel:[1,1,0] op_sel_hi:[1,0,1] neg_lo:[0,1,0]
    v_cvt_pk_bf16_f32 v242, v172, v173
    v_pk_mul_f32 v[194:195], v[172:173], v[186:187] op_sel:[0,0] op_sel_hi:[0,1]
    v_pk_fma_f32 v[174:175], v[172:173], v[186:187], v[194:195] op_sel:[1,1,0] op_sel_hi:[1,0,1] neg_lo:[0,1,0]
    v_cvt_pk_bf16_f32 v243, v174, v175
    ds_write_addtid_b32 v242 offset:8160
    ds_write_addtid_b32 v243 offset:8432
    ds_read_b128 a[160:163], v252 offset:0
    ds_read_b128 a[164:167], v252 offset:32
    ds_read_b128 a[168:171], v252 offset:64
    ds_read_b128 a[172:175], v252 offset:96
    ds_read_b128 a[176:179], v252 offset:128
    ds_read_b128 a[180:183], v252 offset:160
    ds_read_b128 a[184:187], v252 offset:192
    ds_read_b128 a[188:191], v252 offset:224
    v_pk_mul_f32 v[194:195], v[180:181], v[180:181] op_sel:[0,0] op_sel_hi:[0,1]
    v_pk_fma_f32 v[182:183], v[180:181], v[180:181], v[194:195] op_sel:[1,1,0] op_sel_hi:[1,0,1] neg_lo:[0,1,0]
    v_pk_mul_f32 v[194:195], v[182:183], v[182:183] op_sel:[0,0] op_sel_hi:[0,1]
    v_pk_fma_f32 v[184:185], v[182:183], v[182:183], v[194:195] op_sel:[1,1,0] op_sel_hi:[1,0,1] neg_lo:[0,1,0]
    v_cvt_pk_bf16_f32 v242, v192, -v193
    v_pk_mul_f32 v[194:195], v[192:193], v[180:181] op_sel:[0,0] op_sel_hi:[0,1]
    v_pk_fma_f32 v[174:175], v[192:193], v[180:181], v[194:195] op_sel:[1,1,0] op_sel_hi:[1,0,1] neg_lo:[0,1,0]
    v_cvt_pk_bf16_f32 v243, v174, -v175
    v_pk_mul_f32 v[194:195], v[174:175], v[180:181] op_sel:[0,0] op_sel_hi:[0,1]
    v_pk_fma_f32 v[172:173], v[174:175], v[180:181], v[194:195] op_sel:[1,1,0] op_sel_hi:[1,0,1] neg_lo:[0,1,0]
    v_cvt_pk_bf16_f32 v244, v172, -v173
    v_pk_mul_f32 v[194:195], v[172:173], v[180:181] op_sel:[0,0] op_sel_hi:[0,1]
    v_pk_fma_f32 v[174:175], v[172:173], v[180:181], v[194:195] op_sel:[1,1,0] op_sel_hi:[1,0,1] neg_lo:[0,1,0]
    v_cvt_pk_bf16_f32 v245, v174, -v175
    v_pk_mul_f32 v[194:195], v[174:175], v[180:181] op_sel:[0,0] op_sel_hi:[0,1]
    v_pk_fma_f32 v[172:173], v[174:175], v[180:181], v[194:195] op_sel:[1,1,0] op_sel_hi:[1,0,1] neg_lo:[0,1,0]
    v_cvt_pk_bf16_f32 v246, v172, -v173
    v_pk_mul_f32 v[194:195], v[172:173], v[180:181] op_sel:[0,0] op_sel_hi:[0,1]
    v_pk_fma_f32 v[174:175], v[172:173], v[180:181], v[194:195] op_sel:[1,1,0] op_sel_hi:[1,0,1] neg_lo:[0,1,0]
    v_cvt_pk_bf16_f32 v247, v174, -v175
    v_pk_mul_f32 v[194:195], v[174:175], v[180:181] op_sel:[0,0] op_sel_hi:[0,1]
    buffer_load_dword v7, v4, s[16:19], s87 offen offset:0 sc1
    v_pk_fma_f32 v[172:173], v[174:175], v[180:181], v[194:195] op_sel:[1,1,0] op_sel_hi:[1,0,1] neg_lo:[0,1,0]
    v_cvt_pk_bf16_f32 v248, v172, -v173
    v_pk_mul_f32 v[194:195], v[172:173], v[180:181] op_sel:[0,0] op_sel_hi:[0,1]
    v_pk_fma_f32 v[174:175], v[172:173], v[180:181], v[194:195] op_sel:[1,1,0] op_sel_hi:[1,0,1] neg_lo:[0,1,0]
    v_cvt_pk_bf16_f32 v249, v174, -v175
    v_pk_mul_f32 v[194:195], v[192:193], v[190:191] op_sel:[0,0] op_sel_hi:[0,1]
    v_pk_fma_f32 v[176:177], v[192:193], v[190:191], v[194:195] op_sel:[1,1,0] op_sel_hi:[1,0,1] neg_lo:[0,1,0]
    v_cvt_pk_bf16_f32 v250, v176, -v177
    v_pk_mul_f32 v[194:195], v[176:177], v[182:183] op_sel:[0,0] op_sel_hi:[0,1]
    v_pk_fma_f32 v[174:175], v[176:177], v[182:183], v[194:195] op_sel:[1,1,0] op_sel_hi:[1,0,1] neg_lo:[0,1,0]
    v_cvt_pk_bf16_f32 v251, v174, -v175
    ds_write_addtid_b32 v242 offset:0
    ds_write_addtid_b32 v243 offset:272
    ds_write_addtid_b32 v244 offset:544
    ds_write_addtid_b32 v245 offset:816
    ds_write_addtid_b32 v246 offset:1088
    ds_write_addtid_b32 v247 offset:1360
    ds_write_addtid_b32 v248 offset:1632
    ds_write_addtid_b32 v249 offset:1904
    ds_write_addtid_b32 v250 offset:2176
    ds_write_addtid_b32 v251 offset:2448
    v_pk_mul_f32 v[194:195], v[174:175], v[182:183] op_sel:[0,0] op_sel_hi:[0,1]
    v_pk_fma_f32 v[172:173], v[174:175], v[182:183], v[194:195] op_sel:[1,1,0] op_sel_hi:[1,0,1] neg_lo:[0,1,0]
    v_cvt_pk_bf16_f32 v242, v172, -v173
    v_pk_mul_f32 v[194:195], v[172:173], v[182:183] op_sel:[0,0] op_sel_hi:[0,1]
    v_pk_fma_f32 v[174:175], v[172:173], v[182:183], v[194:195] op_sel:[1,1,0] op_sel_hi:[1,0,1] neg_lo:[0,1,0]
    v_cvt_pk_bf16_f32 v243, v174, -v175
    v_pk_mul_f32 v[194:195], v[174:175], v[182:183] op_sel:[0,0] op_sel_hi:[0,1]
    v_pk_fma_f32 v[172:173], v[174:175], v[182:183], v[194:195] op_sel:[1,1,0] op_sel_hi:[1,0,1] neg_lo:[0,1,0]
    v_cvt_pk_bf16_f32 v244, v172, -v173
    v_pk_mul_f32 v[194:195], v[176:177], v[190:191] op_sel:[0,0] op_sel_hi:[0,1]
    v_pk_fma_f32 v[178:179], v[176:177], v[190:191], v[194:195] op_sel:[1,1,0] op_sel_hi:[1,0,1] neg_lo:[0,1,0]
    v_cvt_pk_bf16_f32 v245, v178, -v179
    v_pk_mul_f32 v[194:195], v[178:179], v[184:185] op_sel:[0,0] op_sel_hi:[0,1]
    v_pk_fma_f32 v[174:175], v[178:179], v[184:185], v[194:195] op_sel:[1,1,0] op_sel_hi:[1,0,1] neg_lo:[0,1,0]
    v_cvt_pk_bf16_f32 v246, v174, -v175
    v_pk_mul_f32 v[194:195], v[174:175], v[184:185] op_sel:[0,0] op_sel_hi:[0,1]
    v_pk_fma_f32 v[172:173], v[174:175], v[184:185], v[194:195] op_sel:[1,1,0] op_sel_hi:[1,0,1] neg_lo:[0,1,0]
    v_cvt_pk_bf16_f32 v247, v172, -v173
    v_pk_mul_f32 v[194:195], v[178:179], v[190:191] op_sel:[0,0] op_sel_hi:[0,1]
    v_pk_fma_f32 v[176:177], v[178:179], v[190:191], v[194:195] op_sel:[1,1,0] op_sel_hi:[1,0,1] neg_lo:[0,1,0]
    v_cvt_pk_bf16_f32 v248, v176, -v177
    v_pk_mul_f32 v[194:195], v[176:177], v[184:185] op_sel:[0,0] op_sel_hi:[0,1]
    v_pk_fma_f32 v[174:175], v[176:177], v[184:185], v[194:195] op_sel:[1,1,0] op_sel_hi:[1,0,1] neg_lo:[0,1,0]
    v_cvt_pk_bf16_f32 v249, v174, -v175
    v_pk_mul_f32 v[194:195], v[174:175], v[184:185] op_sel:[0,0] op_sel_hi:[0,1]
    v_pk_fma_f32 v[172:173], v[174:175], v[184:185], v[194:195] op_sel:[1,1,0] op_sel_hi:[1,0,1] neg_lo:[0,1,0]
    v_cvt_pk_bf16_f32 v250, v172, -v173
    v_pk_mul_f32 v[194:195], v[176:177], v[190:191] op_sel:[0,0] op_sel_hi:[0,1]
    v_pk_fma_f32 v[178:179], v[176:177], v[190:191], v[194:195] op_sel:[1,1,0] op_sel_hi:[1,0,1] neg_lo:[0,1,0]
    v_cvt_pk_bf16_f32 v251, v178, -v179
    ds_write_addtid_b32 v242 offset:2720
    ds_write_addtid_b32 v242 offset:3264
    ds_write_addtid_b32 v243 offset:3536
    ds_write_addtid_b32 v244 offset:3808
    ds_write_addtid_b32 v245 offset:4352
    ds_write_addtid_b32 v246 offset:4624
    ds_write_addtid_b32 v247 offset:4896
    ds_write_addtid_b32 v248 offset:5440
    ds_write_addtid_b32 v249 offset:5712
    ds_write_addtid_b32 v250 offset:5984
    ds_write_addtid_b32 v251 offset:6528
    v_pk_mul_f32 v[194:195], v[178:179], v[186:187] op_sel:[0,0] op_sel_hi:[0,1]
    v_pk_fma_f32 v[174:175], v[178:179], v[186:187], v[194:195] op_sel:[1,1,0] op_sel_hi:[1,0,1] neg_lo:[0,1,0]
    v_cvt_pk_bf16_f32 v242, v174, -v175
    v_pk_mul_f32 v[194:195], v[178:179], v[190:191] op_sel:[0,0] op_sel_hi:[0,1]
    v_pk_fma_f32 v[176:177], v[178:179], v[190:191], v[194:195] op_sel:[1,1,0] op_sel_hi:[1,0,1] neg_lo:[0,1,0]
    v_cvt_pk_bf16_f32 v243, v176, -v177
    v_pk_mul_f32 v[194:195], v[176:177], v[186:187] op_sel:[0,0] op_sel_hi:[0,1]
    v_pk_fma_f32 v[174:175], v[176:177], v[186:187], v[194:195] op_sel:[1,1,0] op_sel_hi:[1,0,1] neg_lo:[0,1,0]
    v_cvt_pk_bf16_f32 v244, v174, -v175
    v_pk_mul_f32 v[194:195], v[176:177], v[190:191] op_sel:[0,0] op_sel_hi:[0,1]
    v_pk_fma_f32 v[178:179], v[176:177], v[190:191], v[194:195] op_sel:[1,1,0] op_sel_hi:[1,0,1] neg_lo:[0,1,0]
    v_cvt_pk_bf16_f32 v245, v178, -v179
    v_pk_mul_f32 v[194:195], v[178:179], v[186:187] op_sel:[0,0] op_sel_hi:[0,1]
    v_pk_fma_f32 v[174:175], v[178:179], v[186:187], v[194:195] op_sel:[1,1,0] op_sel_hi:[1,0,1] neg_lo:[0,1,0]
    v_cvt_pk_bf16_f32 v246, v174, -v175
    v_pk_mul_f32 v[194:195], v[178:179], v[190:191] op_sel:[0,0] op_sel_hi:[0,1]
    v_pk_fma_f32 v[176:177], v[178:179], v[190:191], v[194:195] op_sel:[1,1,0] op_sel_hi:[1,0,1] neg_lo:[0,1,0]
    v_cvt_pk_bf16_f32 v247, v176, -v177
    v_pk_mul_f32 v[194:195], v[176:177], v[186:187] op_sel:[0,0] op_sel_hi:[0,1]
    v_pk_fma_f32 v[174:175], v[176:177], v[186:187], v[194:195] op_sel:[1,1,0] op_sel_hi:[1,0,1] neg_lo:[0,1,0]
    v_cvt_pk_bf16_f32 v248, v174, -v175
    ds_write_addtid_b32 v242 offset:6800
    ds_write_addtid_b32 v243 offset:7072
    ds_write_addtid_b32 v244 offset:7344
    ds_write_addtid_b32 v245 offset:7616
    ds_write_addtid_b32 v246 offset:7888
    ds_write_addtid_b32 v247 offset:8160
    ds_write_addtid_b32 v248 offset:8432
    ds_read_b128 a[192:195], v252 offset:0
    ds_read_b128 a[196:199], v252 offset:32
    ds_read_b128 a[200:203], v252 offset:64
    ds_read_b128 a[204:207], v252 offset:96
    ds_read_b128 a[208:211], v252 offset:128
    ds_read_b128 a[212:215], v252 offset:160
    ds_read_b128 a[216:219], v252 offset:192
    ds_read_b128 a[220:223], v252 offset:224
    s_add_u32 m0, s92, 36352
    s_nop 0
    buffer_load_dwordx4 v73, s[4:7], s99 offen offset:0  lds
    v_lshlrev_b32 v199, 16, v236
    v_mul_f32 v199, 0x3fb8aa3b, v199
    v_exp_f32 v199, v199
    v_lshlrev_b32 v255, 16, v237
    v_mul_f32 v255, v255, v253
    v_mul_f32 v255, 0x3e22f983, v255
    v_cvt_pk_bf16_f32 v199, v199, v199
    v_lshlrev_b32 v199, 16, v199
    v_mul_f32 v254, v199, v253
    v_mul_f32 v254, 0xbfb8aa3b, v254
    s_waitcnt lgkmcnt(7)
    v_mfma_f32_32x32x16_bf16 v[216:231], a[192:195], a[160:163], v[216:231]
    s_add_u32 m0, s92, 36352
    s_nop 0
    buffer_load_dwordx4 v74, s[4:7], s99 offen offset:1088  lds
    v_mul_f32 v182, 0x41000000, v254
    v_mul_f32 v185, 0x41000000, v255
    v_mul_f32 v184, 0x43800000, v254
    v_mul_f32 v189, 0x43800000, v255
    s_waitcnt lgkmcnt(6)
    v_mfma_f32_32x32x16_bf16 v[216:231], a[196:199], a[164:167], v[216:231]
    s_add_u32 m0, s92, 36352
    s_nop 0
    buffer_load_dwordx4 v75, s[4:7], s99 offen offset:2176  lds
    v_fract_f32 v185, v185
    v_fract_f32 v188, v255
    v_fract_f32 v189, v189
    v_exp_f32_e64 v182, v182
    s_waitcnt lgkmcnt(5)
    v_mfma_f32_32x32x16_bf16 v[216:231], a[200:203], a[168:171], v[216:231]
    s_add_u32 m0, s92, 36352
    s_nop 0
    buffer_load_dwordx4 v76, s[4:7], s99 offen offset:3264  lds
    v_exp_f32 v183, v254
    v_exp_f32 v184, v184
    v_cos_f32 v186, v185
    v_sin_f32 v187, v185
    s_waitcnt lgkmcnt(4)
    v_mfma_f32_32x32x16_bf16 v[216:231], a[204:207], a[172:175], v[216:231]
    s_add_u32 m0, s93, 53760
    s_add_u32 s99, s99, 256
    s_mov_b64 exec, s[80:81]
    buffer_load_dwordx4 v77, s[4:7], s100 offen  lds
    s_mov_b64 exec, -1
    s_add_u32 s100, s100, 256
    v_cos_f32 v180, v188
    v_sin_f32 v181, v188
    v_cos_f32 v190, v189
    v_sin_f32_e64 v191, v189
    s_waitcnt lgkmcnt(3)
    v_mfma_f32_32x32x16_bf16 v[216:231], a[208:211], a[176:179], v[216:231]
    s_add_u32 m0, s92, 55936
    s_nop 0
    buffer_load_dwordx4 v73, s[4:7], s99 offen offset:0  lds
    v_lshlrev_b32 v192, 16, v238
    v_lshlrev_b32 v193, 16, v239
    v_add_f32 v199, v253, v253
    v_mul_f32 v192, v192, v199
    s_waitcnt lgkmcnt(2)
    v_mfma_f32_32x32x16_bf16 v[216:231], a[212:215], a[180:183], v[216:231]
    s_add_u32 m0, s92, 55936
    s_nop 0
    buffer_load_dwordx4 v74, s[4:7], s99 offen offset:1088  lds
    v_mul_f32 v193, v193, v199
    v_mul_f32 v186, v186, v182
    v_mul_f32 v187, v187, v182
    v_mul_f32 v180, v180, v183
    s_waitcnt lgkmcnt(1)
    v_mfma_f32_32x32x16_bf16 v[216:231], a[216:219], a[184:187], v[216:231]
    s_add_u32 m0, s92, 55936
    s_nop 0
    buffer_load_dwordx4 v75, s[4:7], s99 offen offset:2176  lds
    v_mul_f32 v181, v181, v183
    v_mul_f32 v190, v190, v184
    v_mul_f32_e64 v191, v191, v184
    s_waitcnt lgkmcnt(0)
    v_mfma_f32_32x32x16_bf16 v[216:231], a[220:223], a[188:191], v[216:231]
    s_add_u32 m0, s92, 55936
    s_nop 0
    buffer_load_dwordx4 v76, s[4:7], s99 offen offset:3264  lds
    s_add_u32 m0, s93, 73344
    s_add_u32 s99, s99, 256
    s_mov_b64 exec, s[80:81]
    buffer_load_dwordx4 v77, s[4:7], s100 offen  lds
    s_mov_b64 exec, -1
    s_add_u32 s100, s100, 256
    s_add_u32 m0, s92, 75520
    s_nop 0
    buffer_load_dwordx4 v73, s[4:7], s99 offen offset:0  lds
    s_add_u32 m0, s92, 75520
    s_nop 0
    buffer_load_dwordx4 v74, s[4:7], s99 offen offset:1088  lds
    s_mov_b32 m0, s37
    v_mov_b32 v242, 0x3f80
    v_cvt_pk_bf16_f32 v243, v186, v187
    v_pk_mul_f32 v[194:195], v[186:187], v[186:187] op_sel:[0,0] op_sel_hi:[0,1]
    v_pk_fma_f32 v[172:173], v[186:187], v[186:187], v[194:195] op_sel:[1,1,0] op_sel_hi:[1,0,1] neg_lo:[0,1,0]
    v_cvt_pk_bf16_f32 v244, v172, v173
    v_pk_mul_f32 v[194:195], v[172:173], v[186:187] op_sel:[0,0] op_sel_hi:[0,1]
    v_pk_fma_f32 v[174:175], v[172:173], v[186:187], v[194:195] op_sel:[1,1,0] op_sel_hi:[1,0,1] neg_lo:[0,1,0]
    v_cvt_pk_bf16_f32 v245, v174, v175
    v_pk_mul_f32 v[194:195], v[174:175], v[186:187] op_sel:[0,0] op_sel_hi:[0,1]
    v_pk_fma_f32 v[172:173], v[174:175], v[186:187], v[194:195] op_sel:[1,1,0] op_sel_hi:[1,0,1] neg_lo:[0,1,0]
    v_cvt_pk_bf16_f32 v246, v172, v173
    v_pk_mul_f32 v[194:195], v[172:173], v[186:187] op_sel:[0,0] op_sel_hi:[0,1]
    v_pk_fma_f32 v[174:175], v[172:173], v[186:187], v[194:195] op_sel:[1,1,0] op_sel_hi:[1,0,1] neg_lo:[0,1,0]
    v_cvt_pk_bf16_f32 v247, v174, v175
    v_pk_mul_f32 v[194:195], v[174:175], v[186:187] op_sel:[0,0] op_sel_hi:[0,1]
    v_pk_fma_f32 v[172:173], v[174:175], v[186:187], v[194:195] op_sel:[1,1,0] op_sel_hi:[1,0,1] neg_lo:[0,1,0]
    v_cvt_pk_bf16_f32 v248, v172, v173
    v_pk_mul_f32 v[194:195], v[172:173], v[186:187] op_sel:[0,0] op_sel_hi:[0,1]
    v_pk_fma_f32 v[174:175], v[172:173], v[186:187], v[194:195] op_sel:[1,1,0] op_sel_hi:[1,0,1] neg_lo:[0,1,0]
    v_cvt_pk_bf16_f32 v249, v174, v175
    v_pk_mul_f32 v[194:195], v[174:175], v[186:187] op_sel:[0,0] op_sel_hi:[0,1]
    v_pk_fma_f32 v[172:173], v[174:175], v[186:187], v[194:195] op_sel:[1,1,0] op_sel_hi:[1,0,1] neg_lo:[0,1,0]
    v_cvt_pk_bf16_f32 v250, v172, v173
    v_pk_mul_f32 v[194:195], v[172:173], v[186:187] op_sel:[0,0] op_sel_hi:[0,1]
    s_waitcnt vmcnt(12)
    v_cmp_gt_u32 vcc, 32, v7
    s_nop 0
    s_and_b64 vcc, vcc, s[50:51]
    s_cbranch_scc1 ps_8
pc_10:
    s_barrier
    v_pk_fma_f32 v[174:175], v[172:173], v[186:187], v[194:195] op_sel:[1,1,0] op_sel_hi:[1,0,1] neg_lo:[0,1,0]
    v_cvt_pk_bf16_f32 v251, v174, v175
    ds_write_addtid_b32 v242 offset:0
    ds_write_addtid_b32 v243 offset:272
    ds_write_addtid_b32 v244 offset:544
    ds_write_addtid_b32 v245 offset:816
    ds_write_addtid_b32 v246 offset:1088
    ds_write_addtid_b32 v247 offset:1360
    ds_write_addtid_b32 v248 offset:1632
    ds_write_addtid_b32 v249 offset:1904
    ds_write_addtid_b32 v250 offset:2176
    ds_write_addtid_b32 v251 offset:2448
    v_pk_mul_f32 v[194:195], v[174:175], v[186:187] op_sel:[0,0] op_sel_hi:[0,1]
    v_pk_fma_f32 v[172:173], v[174:175], v[186:187], v[194:195] op_sel:[1,1,0] op_sel_hi:[1,0,1] neg_lo:[0,1,0]
    v_cvt_pk_bf16_f32 v242, v172, v173
    v_pk_mul_f32 v[194:195], v[172:173], v[186:187] op_sel:[0,0] op_sel_hi:[0,1]
    v_pk_fma_f32 v[174:175], v[172:173], v[186:187], v[194:195] op_sel:[1,1,0] op_sel_hi:[1,0,1] neg_lo:[0,1,0]
    v_cvt_pk_bf16_f32 v243, v174, v175
    buffer_load_dwordx4 a[0:3], v200, s[16:19], s101 offen offset:0 sc1
    v_pk_mul_f32 v[194:195], v[174:175], v[186:187] op_sel:[0,0] op_sel_hi:[0,1]
    v_pk_fma_f32 v[172:173], v[174:175], v[186:187], v[194:195] op_sel:[1,1,0] op_sel_hi:[1,0,1] neg_lo:[0,1,0]
    v_cvt_pk_bf16_f32 v244, v172, v173
    v_pk_mul_f32 v[194:195], v[172:173], v[186:187] op_sel:[0,0] op_sel_hi:[0,1]
    v_pk_fma_f32 v[174:175], v[172:173], v[186:187], v[194:195] op_sel:[1,1,0] op_sel_hi:[1,0,1] neg_lo:[0,1,0]
    v_cvt_pk_bf16_f32 v245, v174, v175
    v_pk_mul_f32 v[194:195], v[174:175], v[186:187] op_sel:[0,0] op_sel_hi:[0,1]
    v_pk_fma_f32 v[172:173], v[174:175], v[186:187], v[194:195] op_sel:[1,1,0] op_sel_hi:[1,0,1] neg_lo:[0,1,0]
    v_cvt_pk_bf16_f32 v246, v172, v173
    v_pk_mul_f32 v[194:195], v[172:173], v[186:187] op_sel:[0,0] op_sel_hi:[0,1]
    v_pk_fma_f32 v[174:175], v[172:173], v[186:187], v[194:195] op_sel:[1,1,0] op_sel_hi:[1,0,1] neg_lo:[0,1,0]
    v_cvt_pk_bf16_f32 v247, v174, v175
    v_pk_mul_f32 v[194:195], v[174:175], v[186:187] op_sel:[0,0] op_sel_hi:[0,1]
    v_pk_fma_f32 v[172:173], v[174:175], v[186:187], v[194:195] op_sel:[1,1,0] op_sel_hi:[1,0,1] neg_lo:[0,1,0]
    v_cvt_pk_bf16_f32 v248, v172, v173
    v_pk_mul_f32 v[194:195], v[172:173], v[186:187] op_sel:[0,0] op_sel_hi:[0,1]
    v_pk_fma_f32 v[174:175], v[172:173], v[186:187], v[194:195] op_sel:[1,1,0] op_sel_hi:[1,0,1] neg_lo:[0,1,0]
    v_cvt_pk_bf16_f32 v249, v174, v175
    buffer_load_dwordx4 a[4:7], v200, s[16:19], s101 offen offset:1024 sc1
    v_pk_mul_f32 v[194:195], v[174:175], v[186:187] op_sel:[0,0] op_sel_hi:[0,1]
    v_pk_fma_f32 v[172:173], v[174:175], v[186:187], v[194:195] op_sel:[1,1,0] op_sel_hi:[1,0,1] neg_lo:[0,1,0]
    v_cvt_pk_bf16_f32 v250, v172, v173
    v_pk_mul_f32 v[194:195], v[172:173], v[186:187] op_sel:[0,0] op_sel_hi:[0,1]
    v_pk_fma_f32 v[174:175], v[172:173], v[186:187], v[194:195] op_sel:[1,1,0] op_sel_hi:[1,0,1] neg_lo:[0,1,0]
    v_cvt_pk_bf16_f32 v251, v174, v175
    ds_write_addtid_b32 v242 offset:2720
    ds_write_addtid_b32 v243 offset:2992
    ds_write_addtid_b32 v244 offset:3264
    ds_write_addtid_b32 v245 offset:3536
    ds_write_addtid_b32 v246 offset:3808
    ds_write_addtid_b32 v247 offset:4080
    ds_write_addtid_b32 v248 offset:4352
    ds_write_addtid_b32 v249 offset:4624
    ds_write_addtid_b32 v250 offset:4896
    ds_write_addtid_b32 v251 offset:5168
    v_pk_mul_f32 v[194:195], v[174:175], v[186:187] op_sel:[0,0] op_sel_hi:[0,1]
    v_pk_fma_f32 v[172:173], v[174:175], v[186:187], v[194:195] op_sel:[1,1,0] op_sel_hi:[1,0,1] neg_lo:[0,1,0]
    buffer_load_dwordx4 a[8:11], v200, s[16:19], s101 offen offset:2048 sc1
    v_cvt_pk_bf16_f32 v242, v172, v173
    v_pk_mul_f32 v[194:195], v[172:173], v[186:187] op_sel:[0,0] op_sel_hi:[0,1]
    v_pk_fma_f32 v[174:175], v[172:173], v[186:187], v[194:195] op_sel:[1,1,0] op_sel_hi:[1,0,1] neg_lo:[0,1,0]
    v_cvt_pk_bf16_f32 v243, v174, v175
    v_pk_mul_f32 v[194:195], v[174:175], v[186:187] op_sel:[0,0] op_sel_hi:[0,1]
    v_pk_fma_f32 v[172:173], v[174:175], v[186:187], v[194:195] op_sel:[1,1,0] op_sel_hi:[1,0,1] neg_lo:[0,1,0]
    v_cvt_pk_bf16_f32 v244, v172, v173
    v_pk_mul_f32 v[194:195], v[172:173], v[186:187] op_sel:[0,0] op_sel_hi:[0,1]
    v_pk_fma_f32 v[174:175], v[172:173], v[186:187], v[194:195] op_sel:[1,1,0] op_sel_hi:[1,0,1] neg_lo:[0,1,0]
    v_cvt_pk_bf16_f32 v245, v174, v175
    v_pk_mul_f32 v[194:195], v[174:175], v[186:187] op_sel:[0,0] op_sel_hi:[0,1]
    v_pk_fma_f32 v[172:173], v[174:175], v[186:187], v[194:195] op_sel:[1,1,0] op_sel_hi:[1,0,1] neg_lo:[0,1,0]
    v_cvt_pk_bf16_f32 v246, v172, v173
    v_pk_mul_f32 v[194:195], v[172:173], v[186:187] op_sel:[0,0] op_sel_hi:[0,1]
    v_pk_fma_f32 v[174:175], v[172:173], v[186:187], v[194:195] op_sel:[1,1,0] op_sel_hi:[1,0,1] neg_lo:[0,1,0]
    v_cvt_pk_bf16_f32 v247, v174, v175
    v_pk_mul_f32 v[194:195], v[174:175], v[186:187] op_sel:[0,0] op_sel_hi:[0,1]
    v_pk_fma_f32 v[172:173], v[174:175], v[186:187], v[194:195] op_sel:[1,1,0] op_sel_hi:[1,0,1] neg_lo:[0,1,0]
    buffer_load_dwordx4 a[12:15], v200, s[16:19], s101 offen offset:3072 sc1
    v_cvt_pk_bf16_f32 v248, v172, v173
    v_pk_mul_f32 v[194:195], v[172:173], v[186:187] op_sel:[0,0] op_sel_hi:[0,1]
    v_pk_fma_f32 v[174:175], v[172:173], v[186:187], v[194:195] op_sel:[1,1,0] op_sel_hi:[1,0,1] neg_lo:[0,1,0]
    v_cvt_pk_bf16_f32 v249, v174, v175
    v_pk_mul_f32 v[194:195], v[174:175], v[186:187] op_sel:[0,0] op_sel_hi:[0,1]
    v_pk_fma_f32 v[172:173], v[174:175], v[186:187], v[194:195] op_sel:[1,1,0] op_sel_hi:[1,0,1] neg_lo:[0,1,0]
    v_cvt_pk_bf16_f32 v250, v172, v173
    v_pk_mul_f32 v[194:195], v[172:173], v[186:187] op_sel:[0,0] op_sel_hi:[0,1]
    v_pk_fma_f32 v[174:175], v[172:173], v[186:187], v[194:195] op_sel:[1,1,0] op_sel_hi:[1,0,1] neg_lo:[0,1,0]
    v_cvt_pk_bf16_f32 v251, v174, v175
    ds_write_addtid_b32 v242 offset:5440
    ds_write_addtid_b32 v243 offset:5712
    ds_write_addtid_b32 v244 offset:5984
    ds_write_addtid_b32 v245 offset:6256
    ds_write_addtid_b32 v246 offset:6528
    ds_write_addtid_b32 v247 offset:6800
    ds_write_addtid_b32 v248 offset:7072
    ds_write_addtid_b32 v249 offset:7344
    s_add_u32 s101, s101, 4096
    buffer_load_dwordx4 a[16:19], v200, s[16:19], s101 offen offset:0 sc1
    ds_write_addtid_b32 v250 offset:7616
    ds_write_addtid_b32 v251 offset:7888
    v_pk_mul_f32 v[194:195], v[174:175], v[186:187] op_sel:[0,0] op_sel_hi:[0,1]
    v_pk_fma_f32 v[172:173], v[174:175], v[186:187], v[194:195] op_sel:[1,1,0] op_sel_hi:[1,0,1] neg_lo:[0,1,0]
    v_cvt_pk_bf16_f32 v242, v172, v173
    v_pk_mul_f32 v[194:195], v[172:173], v[186:187] op_sel:[0,0] op_sel_hi:[0,1]
    v_pk_fma_f32 v[174:175], v[172:173], v[186:187], v[194:195] op_sel:[1,1,0] op_sel_hi:[1,0,1] neg_lo:[0,1,0]
    v_cvt_pk_bf16_f32 v243, v174, v175
    ds_write_addtid_b32 v242 offset:8160
    ds_write_addtid_b32 v243 offset:8432
    ds_read_b128 a[160:163], v252 offset:0
    ds_read_b128 a[164:167], v252 offset:32
    ds_read_b128 a[168:171], v252 offset:64
    ds_read_b128 a[172:175], v252 offset:96
    ds_read_b128 a[176:179], v252 offset:128
    ds_read_b128 a[180:183], v252 offset:160
    ds_read_b128 a[184:187], v252 offset:192
    ds_read_b128 a[188:191], v252 offset:224
    buffer_load_dwordx4 a[20:23], v200, s[16:19], s101 offen offset:1024 sc1
    v_pk_mul_f32 v[194:195], v[180:181], v[180:181] op_sel:[0,0] op_sel_hi:[0,1]
    v_pk_fma_f32 v[182:183], v[180:181], v[180:181], v[194:195] op_sel:[1,1,0] op_sel_hi:[1,0,1] neg_lo:[0,1,0]
    v_pk_mul_f32 v[194:195], v[182:183], v[182:183] op_sel:[0,0] op_sel_hi:[0,1]
    v_pk_fma_f32 v[184:185], v[182:183], v[182:183], v[194:195] op_sel:[1,1,0] op_sel_hi:[1,0,1] neg_lo:[0,1,0]
    v_cvt_pk_bf16_f32 v242, v192, -v193
    v_pk_mul_f32 v[194:195], v[192:193], v[180:181] op_sel:[0,0] op_sel_hi:[0,1]
    v_pk_fma_f32 v[174:175], v[192:193], v[180:181], v[194:195] op_sel:[1,1,0] op_sel_hi:[1,0,1] neg_lo:[0,1,0]
    v_cvt_pk_bf16_f32 v243, v174, -v175
    v_pk_mul_f32 v[194:195], v[174:175], v[180:181] op_sel:[0,0] op_sel_hi:[0,1]
    v_pk_fma_f32 v[172:173], v[174:175], v[180:181], v[194:195] op_sel:[1,1,0] op_sel_hi:[1,0,1] neg_lo:[0,1,0]
    v_cvt_pk_bf16_f32 v244, v172, -v173
    v_pk_mul_f32 v[194:195], v[172:173], v[180:181] op_sel:[0,0] op_sel_hi:[0,1]
    v_pk_fma_f32 v[174:175], v[172:173], v[180:181], v[194:195] op_sel:[1,1,0] op_sel_hi:[1,0,1] neg_lo:[0,1,0]
    v_cvt_pk_bf16_f32 v245, v174, -v175
    v_pk_mul_f32 v[194:195], v[174:175], v[180:181] op_sel:[0,0] op_sel_hi:[0,1]
    v_pk_fma_f32 v[172:173], v[174:175], v[180:181], v[194:195] op_sel:[1,1,0] op_sel_hi:[1,0,1] neg_lo:[0,1,0]
    v_cvt_pk_bf16_f32 v246, v172, -v173
    v_pk_mul_f32 v[194:195], v[172:173], v[180:181] op_sel:[0,0] op_sel_hi:[0,1]
    buffer_load_dwordx4 a[24:27], v200, s[16:19], s101 offen offset:2048 sc1
    v_pk_fma_f32 v[174:175], v[172:173], v[180:181], v[194:195] op_sel:[1,1,0] op_sel_hi:[1,0,1] neg_lo:[0,1,0]
    v_cvt_pk_bf16_f32 v247, v174, -v175
    v_pk_mul_f32 v[194:195], v[174:175], v[180:181] op_sel:[0,0] op_sel_hi:[0,1]
    v_pk_fma_f32 v[172:173], v[174:175], v[180:181], v[194:195] op_sel:[1,1,0] op_sel_hi:[1,0,1] neg_lo:[0,1,0]
    v_cvt_pk_bf16_f32 v248, v172, -v173
    v_pk_mul_f32 v[194:195], v[172:173], v[180:181] op_sel:[0,0] op_sel_hi:[0,1]
    v_pk_fma_f32 v[174:175], v[172:173], v[180:181], v[194:195] op_sel:[1,1,0] op_sel_hi:[1,0,1] neg_lo:[0,1,0]
    v_cvt_pk_bf16_f32 v249, v174, -v175
    v_pk_mul_f32 v[194:195], v[192:193], v[190:191] op_sel:[0,0] op_sel_hi:[0,1]
    v_pk_fma_f32 v[176:177], v[192:193], v[190:191], v[194:195] op_sel:[1,1,0] op_sel_hi:[1,0,1] neg_lo:[0,1,0]
    v_cvt_pk_bf16_f32 v250, v176, -v177
    v_pk_mul_f32 v[194:195], v[176:177], v[182:183] op_sel:[0,0] op_sel_hi:[0,1]
    v_pk_fma_f32 v[174:175], v[176:177], v[182:183], v[194:195] op_sel:[1,1,0] op_sel_hi:[1,0,1] neg_lo:[0,1,0]
    v_cvt_pk_bf16_f32 v251, v174, -v175
    ds_write_addtid_b32 v242 offset:0
    ds_write_addtid_b32 v243 offset:272
    ds_write_addtid_b32 v244 offset:544
    ds_write_addtid_b32 v245 offset:816
    buffer_load_dwordx4 a[28:31], v200, s[16:19], s101 offen offset:3072 sc1
    ds_write_addtid_b32 v246 offset:1088
    ds_write_addtid_b32 v247 offset:1360
    ds_write_addtid_b32 v248 offset:1632
    ds_write_addtid_b32 v249 offset:1904
    ds_write_addtid_b32 v250 offset:2176
    ds_write_addtid_b32 v251 offset:2448
    v_pk_mul_f32 v[194:195], v[174:175], v[182:183] op_sel:[0,0] op_sel_hi:[0,1]
    v_pk_fma_f32 v[172:173], v[174:175], v[182:183], v[194:195] op_sel:[1,1,0] op_sel_hi:[1,0,1] neg_lo:[0,1,0]
    v_cvt_pk_bf16_f32 v242, v172, -v173
    v_pk_mul_f32 v[194:195], v[172:173], v[182:183] op_sel:[0,0] op_sel_hi:[0,1]
    v_pk_fma_f32 v[174:175], v[172:173], v[182:183], v[194:195] op_sel:[1,1,0] op_sel_hi:[1,0,1] neg_lo:[0,1,0]
    v_cvt_pk_bf16_f32 v243, v174, -v175
    v_pk_mul_f32 v[194:195], v[174:175], v[182:183] op_sel:[0,0] op_sel_hi:[0,1]
    v_pk_fma_f32 v[172:173], v[174:175], v[182:183], v[194:195] op_sel:[1,1,0] op_sel_hi:[1,0,1] neg_lo:[0,1,0]
    v_cvt_pk_bf16_f32 v244, v172, -v173
    v_pk_mul_f32 v[194:195], v[176:177], v[190:191] op_sel:[0,0] op_sel_hi:[0,1]
    v_pk_fma_f32 v[178:179], v[176:177], v[190:191], v[194:195] op_sel:[1,1,0] op_sel_hi:[1,0,1] neg_lo:[0,1,0]
    v_cvt_pk_bf16_f32 v245, v178, -v179
    s_add_u32 s101, s101, 4096
    buffer_load_dwordx4 a[32:35], v200, s[16:19], s101 offen offset:0 sc1
    v_pk_mul_f32 v[194:195], v[178:179], v[184:185] op_sel:[0,0] op_sel_hi:[0,1]
    v_pk_fma_f32 v[174:175], v[178:179], v[184:185], v[194:195] op_sel:[1,1,0] op_sel_hi:[1,0,1] neg_lo:[0,1,0]
    v_cvt_pk_bf16_f32 v246, v174, -v175
    v_pk_mul_f32 v[194:195], v[174:175], v[184:185] op_sel:[0,0] op_sel_hi:[0,1]
    v_pk_fma_f32 v[172:173], v[174:175], v[184:185], v[194:195] op_sel:[1,1,0] op_sel_hi:[1,0,1] neg_lo:[0,1,0]
    v_cvt_pk_bf16_f32 v247, v172, -v173
    v_pk_mul_f32 v[194:195], v[178:179], v[190:191] op_sel:[0,0] op_sel_hi:[0,1]
    v_pk_fma_f32 v[176:177], v[178:179], v[190:191], v[194:195] op_sel:[1,1,0] op_sel_hi:[1,0,1] neg_lo:[0,1,0]
    v_cvt_pk_bf16_f32 v248, v176, -v177
    v_pk_mul_f32 v[194:195], v[176:177], v[184:185] op_sel:[0,0] op_sel_hi:[0,1]
    v_pk_fma_f32 v[174:175], v[176:177], v[184:185], v[194:195] op_sel:[1,1,0] op_sel_hi:[1,0,1] neg_lo:[0,1,0]
    v_cvt_pk_bf16_f32 v249, v174, -v175
    v_pk_mul_f32 v[194:195], v[174:175], v[184:185] op_sel:[0,0] op_sel_hi:[0,1]
    v_pk_fma_f32 v[172:173], v[174:175], v[184:185], v[194:195] op_sel:[1,1,0] op_sel_hi:[1,0,1] neg_lo:[0,1,0]
    v_cvt_pk_bf16_f32 v250, v172, -v173
    v_pk_mul_f32 v[194:195], v[176:177], v[190:191] op_sel:[0,0] op_sel_hi:[0,1]
    v_pk_fma_f32 v[178:179], v[176:177], v[190:191], v[194:195] op_sel:[1,1,0] op_sel_hi:[1,0,1] neg_lo:[0,1,0]
    v_cvt_pk_bf16_f32 v251, v178, -v179
    buffer_load_dwordx4 a[36:39], v200, s[16:19], s101 offen offset:1024 sc1
    ds_write_addtid_b32 v242 offset:2720
    ds_write_addtid_b32 v242 offset:3264
    ds_write_addtid_b32 v243 offset:3536
    ds_write_addtid_b32 v244 offset:3808
    ds_write_addtid_b32 v245 offset:4352
    ds_write_addtid_b32 v246 offset:4624
    ds_write_addtid_b32 v247 offset:4896
    ds_write_addtid_b32 v248 offset:5440
    ds_write_addtid_b32 v249 offset:5712
    ds_write_addtid_b32 v250 offset:5984
    ds_write_addtid_b32 v251 offset:6528
    v_pk_mul_f32 v[194:195], v[178:179], v[186:187] op_sel:[0,0] op_sel_hi:[0,1]
    v_pk_fma_f32 v[174:175], v[178:179], v[186:187], v[194:195] op_sel:[1,1,0] op_sel_hi:[1,0,1] neg_lo:[0,1,0]
    v_cvt_pk_bf16_f32 v242, v174, -v175
    v_pk_mul_f32 v[194:195], v[178:179], v[190:191] op_sel:[0,0] op_sel_hi:[0,1]
    v_pk_fma_f32 v[176:177], v[178:179], v[190:191], v[194:195] op_sel:[1,1,0] op_sel_hi:[1,0,1] neg_lo:[0,1,0]
    v_cvt_pk_bf16_f32 v243, v176, -v177
    v_pk_mul_f32 v[194:195], v[176:177], v[186:187] op_sel:[0,0] op_sel_hi:[0,1]
    buffer_load_dwordx4 a[40:43], v200, s[16:19], s101 offen offset:2048 sc1
    v_pk_fma_f32 v[174:175], v[176:177], v[186:187], v[194:195] op_sel:[1,1,0] op_sel_hi:[1,0,1] neg_lo:[0,1,0]
    v_cvt_pk_bf16_f32 v244, v174, -v175
    v_pk_mul_f32 v[194:195], v[176:177], v[190:191] op_sel:[0,0] op_sel_hi:[0,1]
    v_pk_fma_f32 v[178:179], v[176:177], v[190:191], v[194:195] op_sel:[1,1,0] op_sel_hi:[1,0,1] neg_lo:[0,1,0]
    v_cvt_pk_bf16_f32 v245, v178, -v179
    v_pk_mul_f32 v[194:195], v[178:179], v[186:187] op_sel:[0,0] op_sel_hi:[0,1]
    v_pk_fma_f32 v[174:175], v[178:179], v[186:187], v[194:195] op_sel:[1,1,0] op_sel_hi:[1,0,1] neg_lo:[0,1,0]
    v_cvt_pk_bf16_f32 v246, v174, -v175
    v_pk_mul_f32 v[194:195], v[178:179], v[190:191] op_sel:[0,0] op_sel_hi:[0,1]
    v_pk_fma_f32 v[176:177], v[178:179], v[190:191], v[194:195] op_sel:[1,1,0] op_sel_hi:[1,0,1] neg_lo:[0,1,0]
    v_cvt_pk_bf16_f32 v247, v176, -v177
    v_pk_mul_f32 v[194:195], v[176:177], v[186:187] op_sel:[0,0] op_sel_hi:[0,1]
    v_pk_fma_f32 v[174:175], v[176:177], v[186:187], v[194:195] op_sel:[1,1,0] op_sel_hi:[1,0,1] neg_lo:[0,1,0]
    v_cvt_pk_bf16_f32 v248, v174, -v175
    ds_write_addtid_b32 v242 offset:6800
    ds_write_addtid_b32 v243 offset:7072
    ds_write_addtid_b32 v244 offset:7344
    ds_write_addtid_b32 v245 offset:7616
    buffer_load_dwordx4 a[44:47], v200, s[16:19], s101 offen offset:3072 sc1
    ds_write_addtid_b32 v246 offset:7888
    ds_write_addtid_b32 v247 offset:8160
    ds_write_addtid_b32 v248 offset:8432
    ds_read_b128 a[192:195], v252 offset:0
    ds_read_b128 a[196:199], v252 offset:32
    ds_read_b128 a[200:203], v252 offset:64
    ds_read_b128 a[204:207], v252 offset:96
    ds_read_b128 a[208:211], v252 offset:128
    ds_read_b128 a[212:215], v252 offset:160
    ds_read_b128 a[216:219], v252 offset:192
    ds_read_b128 a[220:223], v252 offset:224
    s_add_u32 m0, s92, 75520
    s_nop 0
    buffer_load_dwordx4 v75, s[4:7], s99 offen offset:2176  lds
    s_waitcnt lgkmcnt(7)
    v_mfma_f32_32x32x16_bf16 v[216:231], a[192:195], a[160:163], v[216:231]
    s_add_u32 m0, s92, 75520
    s_nop 0
    buffer_load_dwordx4 v76, s[4:7], s99 offen offset:3264  lds
    s_waitcnt lgkmcnt(6)
    v_mfma_f32_32x32x16_bf16 v[216:231], a[196:199], a[164:167], v[216:231]
    s_add_u32 m0, s93, 92928
    s_add_u32 s101, s101, 4096
    buffer_load_dwordx4 a[48:51], v200, s[16:19], s101 offen offset:0 sc1
    s_add_u32 s99, s99, 256
    s_mov_b64 exec, s[80:81]
    buffer_load_dwordx4 v77, s[4:7], s100 offen  lds
    s_mov_b64 exec, -1
    s_add_u32 s100, s100, 256
    s_waitcnt lgkmcnt(5)
    v_mfma_f32_32x32x16_bf16 v[216:231], a[200:203], a[168:171], v[216:231]
    s_add_u32 m0, s92, 95104
    s_nop 0
    buffer_load_dwordx4 v73, s[4:7], s99 offen offset:0  lds
    s_waitcnt lgkmcnt(4)
    v_mfma_f32_32x32x16_bf16 v[216:231], a[204:207], a[172:175], v[216:231]
    s_add_u32 m0, s92, 95104
    s_nop 0
    buffer_load_dwordx4 v74, s[4:7], s99 offen offset:1088  lds
    s_waitcnt lgkmcnt(3)
    v_mfma_f32_32x32x16_bf16 v[216:231], a[208:211], a[176:179], v[216:231]
    s_add_u32 m0, s92, 95104
    s_nop 0
    buffer_load_dwordx4 v75, s[4:7], s99 offen offset:2176  lds
    s_waitcnt lgkmcnt(2)
    v_mfma_f32_32x32x16_bf16 v[216:231], a[212:215], a[180:183], v[216:231]
    s_add_u32 m0, s92, 95104
    s_nop 0
    buffer_load_dwordx4 v76, s[4:7], s99 offen offset:3264  lds
    s_waitcnt lgkmcnt(1)
    v_mfma_f32_32x32x16_bf16 v[216:231], a[216:219], a[184:187], v[216:231]
    buffer_load_dwordx4 a[52:55], v200, s[16:19], s101 offen offset:1024 sc1
    s_add_u32 m0, s93, 112512
    s_add_u32 s99, s99, 256
    s_mov_b64 exec, s[80:81]
    buffer_load_dwordx4 v77, s[4:7], s100 offen  lds
    s_mov_b64 exec, -1
    s_add_u32 s100, s100, 256
    s_waitcnt lgkmcnt(0)
    v_mfma_f32_32x32x16_bf16 v[216:231], a[220:223], a[188:191], v[216:231]
    s_add_u32 m0, s92, 114688
    s_nop 0
    buffer_load_dwordx4 v73, s[4:7], s99 offen offset:0  lds
    s_add_u32 m0, s92, 114688
    s_nop 0
    buffer_load_dwordx4 v74, s[4:7], s99 offen offset:1088  lds
    s_add_u32 m0, s92, 114688
    s_nop 0
    buffer_load_dwordx4 v75, s[4:7], s99 offen offset:2176  lds
    s_add_u32 m0, s92, 114688
    s_nop 0
    buffer_load_dwordx4 v76, s[4:7], s99 offen offset:3264  lds
    s_add_u32 m0, s93, 132096
    s_add_u32 s99, s99, 256
    s_mov_b64 exec, s[80:81]
    buffer_load_dwordx4 v77, s[4:7], s100 offen  lds
    s_mov_b64 exec, -1
    s_add_u32 s100, s100, 256
    s_mov_b32 m0, s37
    s_branch ec_4
nc_3:
    s_sub_u32 s33, s2, 160
    s_min_u32 s33, s33, 159
    s_mul_i32 s29, s33, 3277
    s_lshr_b32 s29, s29, 16
    s_mul_i32 s30, s29, 20
    s_sub_u32 s30, s33, s30
    s_mul_i32 s31, s30, 13108
    s_lshr_b32 s31, s31, 16
    s_mul_i32 s32, s31, 5
    s_sub_u32 s32, s30, s32
    s_lshl_b32 s28, s24, 10
    s_lshr_b32 s34, s32, 1
    s_mul_i32 s34, s34, 20
    s_and_b32 s35, s32, 1
    s_lshl_b32 s35, s35, 3
    s_add_u32 s34, s34, s35
    s_cmp_eq_u32 s32, 4
    s_cselect_b32 s34, 16, s34
    s_cselect_b32 s35, 20, 4
    s_mul_i32 s36, s31, 160
    s_add_u32 s34, s34, s36
    s_mul_i32 s34, s34, 1280
    s_mul_i32 s36, s29, 160
    s_add_u32 s34, s34, s36
    v_add_u32 v162, 0, v0
    v_mul_u32_u24 v160, 6554, v162
    v_lshrrev_b32 v160, 16, v160
    v_mul_u32_u24 v161, 10, v160
    v_sub_u32 v161, v162, v161
    v_lshrrev_b32 v163, 3, v160
    v_mul_u32_u24 v163, 40, v163
    v_bfe_u32 v164, v160, 2, 1
    v_mul_u32_u24 v164, s35, v164
    v_and_b32_e64 v160, 3, v160
    v_add3_u32 v160, v160, v163, v164
    v_mul_u32_u24 v160, 1280, v160
    v_lshl_add_u32 v162, v161, 4, v160
    s_add_u32 m0, s28, 0
    s_nop 0
    buffer_load_dwordx4 v162, s[12:15], s34 offen lds
    v_add_u32 v162, 256, v0
    v_min_u32 v162, 319, v162
    v_mul_u32_u24 v160, 6554, v162
    v_lshrrev_b32 v160, 16, v160
    v_mul_u32_u24 v161, 10, v160
    v_sub_u32 v161, v162, v161
    v_lshrrev_b32 v163, 3, v160
    v_mul_u32_u24 v163, 40, v163
    v_bfe_u32 v164, v160, 2, 1
    v_mul_u32_u24 v164, s35, v164
    v_and_b32_e64 v160, 3, v160
    v_add3_u32 v160, v160, v163, v164
    v_mul_u32_u24 v160, 1280, v160
    v_lshl_add_u32 v162, v161, 4, v160
    s_add_u32 m0, s28, 4096
    s_nop 0
    buffer_load_dwordx4 v162, s[12:15], s34 offen lds
    v_bfe_u32 v163, v0, 4, 2
    v_bfe_u32 v164, v0, 2, 2
    v_lshl_add_u32 v163, v163, 3, v164
    v_mul_u32_u24 v163, 160, v163
    v_and_b32 v164, 3, v0
    v_lshl_add_u32 v165, v164, 3, v163
    v_add_u32 v165, 0, v165
    s_lshl_b32 s36, s24, 5
    v_add_u32_e64 v166, s36, v165
    s_mul_i32 s33, s33, 5120
    s_add_u32 s33, s33, 2621440
    v_lshl_add_u32 v167, v1, 4, s33
    v_add_u32 v164, 4096, v167
    v_mov_b32 v163, 1073741824
    v_cmp_gt_u32 vcc, 64, v0
    s_sub_u32 s36, s24, s31
    s_and_b32 s36, s36, 3
    s_lshl_b32 s36, s36, 10
    v_cndmask_b32 v168, v163, v164, vcc
    v_add_u32 v167, s36, v167
    s_sub_u32 s33, s2, 64
    s_min_u32 s33, s33, 159
    s_mul_i32 s29, s33, 3277
    s_lshr_b32 s29, s29, 16
    s_mul_i32 s30, s29, 20
    s_sub_u32 s30, s33, s30
    s_mul_i32 s31, s30, 13108
    s_lshr_b32 s31, s31, 16
    s_mul_i32 s32, s31, 5
    s_sub_u32 s32, s30, s32
    s_lshl_b32 s28, s24, 10
    s_lshr_b32 s34, s32, 1
    s_mul_i32 s34, s34, 20
    s_and_b32 s35, s32, 1
    s_lshl_b32 s35, s35, 3
    s_add_u32 s34, s34, s35
    s_cmp_eq_u32 s32, 4
    s_cselect_b32 s34, 16, s34
    s_cselect_b32 s35, 20, 4
    s_mul_i32 s36, s31, 160
    s_add_u32 s34, s34, s36
    s_mul_i32 s34, s34, 1280
    s_mul_i32 s36, s29, 160
    s_add_u32 s34, s34, s36
    v_add_u32 v182, 0, v0
    v_mul_u32_u24 v180, 6554, v182
    v_lshrrev_b32 v180, 16, v180
    v_mul_u32_u24 v181, 10, v180
    v_sub_u32 v181, v182, v181
    v_lshrrev_b32 v183, 3, v180
    v_mul_u32_u24 v183, 40, v183
    v_bfe_u32 v184, v180, 2, 1
    v_mul_u32_u24 v184, s35, v184
    v_and_b32_e64 v180, 3, v180
    v_add3_u32 v180, v180, v183, v184
    v_mul_u32_u24 v180, 1280, v180
    v_lshl_add_u32 v182, v181, 4, v180
    s_add_u32 m0, s28, 8192
    s_nop 0
    buffer_load_dwordx4 v182, s[12:15], s34 offen lds
    v_add_u32 v182, 256, v0
    v_min_u32 v182, 319, v182
    v_mul_u32_u24 v180, 6554, v182
    v_lshrrev_b32 v180, 16, v180
    v_mul_u32_u24 v181, 10, v180
    v_sub_u32 v181, v182, v181
    v_lshrrev_b32 v183, 3, v180
    v_mul_u32_u24 v183, 40, v183
    v_bfe_u32 v184, v180, 2, 1
    v_mul_u32_u24 v184, s35, v184
    v_and_b32 v180, 3, v180
    v_add3_u32 v180, v180, v183, v184
    v_mul_u32_u24 v180, 1280, v180
    v_lshl_add_u32 v182, v181, 4, v180
    s_add_u32 m0, s28, 12288
    s_nop 0
    buffer_load_dwordx4 v182, s[12:15], s34 offen lds
    v_bfe_u32 v183, v0, 4, 2
    v_bfe_u32 v184, v0, 2, 2
    v_lshl_add_u32 v183, v183, 3, v184
    v_mul_u32_u24 v183, 160, v183
    v_and_b32 v184, 3, v0
    v_lshl_add_u32 v185, v184, 3, v183
    v_add_u32 v185, 8192, v185
    s_lshl_b32 s36, s24, 5
    v_add_u32 v186, s36, v185
    s_mul_i32 s33, s33, 5120
    s_add_u32 s33, s33, 2621440
    v_lshl_add_u32 v187, v1, 4, s33
    v_add_u32 v184, 4096, v187
    v_mov_b32 v183, 1073741824
    v_cmp_gt_u32 vcc, 64, v0
    s_sub_u32 s36, s24, s31
    s_and_b32 s36, s36, 3
    s_lshl_b32 s36, s36, 10
    v_cndmask_b32 v188, v183, v184, vcc
    v_add_u32 v187, s36, v187
    v_mov_b32 v216, 0
    v_mov_b32 v217, 0
    v_mov_b32 v218, 0
    v_mov_b32 v219, 0
    v_mov_b32 v220, 0
    v_mov_b32 v221, 0
    v_mov_b32 v222, 0
    v_mov_b32 v223, 0
    v_mov_b32 v224, 0
    v_mov_b32 v225, 0
    v_mov_b32 v226, 0
    v_mov_b32 v227, 0
    v_mov_b32 v228, 0
    v_mov_b32 v229, 0
    v_mov_b32 v230, 0
    v_mov_b32_e64 v231, 0
    s_waitcnt vmcnt(5)
    s_barrier
    ds_read_b64_tr_b16 v[96:97], v111
    ds_read_b64_tr_b16 v[98:99], v111 offset:2560
    ds_read_b64_tr_b16 v[100:101], v112
    ds_read_b64_tr_b16 v[102:103], v112 offset:2560
    ds_read_b64_tr_b16 v[104:105], v113
    ds_read_b64_tr_b16 v[106:107], v113 offset:2560
    s_waitcnt lgkmcnt(4)
    buffer_store_dwordx4 v[96:99], v108, s[16:19], 0 offen sc1
    s_waitcnt lgkmcnt(2)
    buffer_store_dwordx4 v[100:103], v109, s[16:19], 0 offen sc1
    s_waitcnt lgkmcnt(0)
    buffer_store_dwordx4 v[104:107], v110, s[16:19], 0 offen sc1
    global_load_dword v7, v5, s[66:67] sc1
    v_lshrrev_b32 v132, 5, v0
    v_and_b32_e64 v133, 31, v0
    v_mul_u32_u24 v132, 1280, v132
    v_lshl_add_u32 v134, v133, 4, v132
    v_mov_b32 v135, 1073741824
    v_cmp_gt_u32 vcc, 16, v133
    s_mul_i32 s96, s2, 10240
    buffer_load_dwordx4 v[120:123], v134, s[4:7], s96 offen
    v_cndmask_b32_e64 v135, v135, v134, vcc
    buffer_load_dwordx4 v[124:127], v134, s[4:7], s96 offen offset:512
    buffer_load_dwordx4 v[128:131], v135, s[4:7], s96 offen offset:1024
    s_waitcnt vmcnt(4)
    s_waitcnt vmcnt(3)
    v_cmp_gt_u32 vcc, 1, v7
    s_nop 0
    s_and_b64 vcc, vcc, s[50:51]
    s_and_b64 vcc, vcc, 1
    s_cbranch_scc1 ps_11
pc_13:
    s_barrier
    v_lshlrev_b32 v2, 3, v4
    v_mov_b32 v5, 1
    v_cndmask_b32 v2, v4, v2, s[50:51]
    buffer_atomic_add v5, v2, s[16:19], s86 offen offset:0 sc1
    ds_read_b64_tr_b16 v[172:173], v166
    ds_read_b64_tr_b16 v[174:175], v166 offset:640
    ds_read_b64_tr_b16 v[176:177], v165 offset:128
    ds_read_b64_tr_b16 v[178:179], v165 offset:768
    s_waitcnt lgkmcnt(2)
    buffer_store_dwordx4 v[172:175], v167, s[16:19], 0 offen sc1
    s_waitcnt lgkmcnt(0)
    buffer_store_dwordx4 v[176:179], v168, s[16:19], 0 offen sc1
    ds_read_b64_tr_b16 v[192:193], v186
    ds_read_b64_tr_b16 v[194:195], v186 offset:640
    ds_read_b64_tr_b16 v[196:197], v185 offset:128
    ds_read_b64_tr_b16 v[198:199], v185 offset:768
    s_waitcnt lgkmcnt(2)
    buffer_store_dwordx4 v[192:195], v187, s[16:19], 0 offen sc1
    s_waitcnt lgkmcnt(0)
    buffer_store_dwordx4 v[196:199], v188, s[16:19], 0 offen sc1
    v_mov_b32 v134, 0x3f803f80
    v_mov_b32 v132, 0
    v_mov_b32 v133, 0
    s_waitcnt vmcnt(7)
    v_dot2c_f32_bf16 v132, v120, v134
    v_dot2c_f32_bf16 v133, v120, v120
    v_dot2c_f32_bf16 v132, v121, v134
    v_dot2c_f32_bf16 v133, v121, v121
    v_dot2c_f32_bf16 v132, v122, v134
    v_dot2c_f32_bf16 v133, v122, v122
    v_dot2c_f32_bf16 v132, v123, v134
    v_dot2c_f32_bf16 v133, v123, v123
    s_waitcnt vmcnt(6)
    v_dot2c_f32_bf16 v132, v124, v134
    v_dot2c_f32_bf16 v133, v124, v124
    v_dot2c_f32_bf16 v132, v125, v134
    v_dot2c_f32_bf16 v133, v125, v125
    v_dot2c_f32_bf16 v132, v126, v134
    v_dot2c_f32_bf16 v133, v126, v126
    v_dot2c_f32_bf16 v132, v127, v134
    v_dot2c_f32_bf16 v133, v127, v127
    s_waitcnt vmcnt(5)
    v_dot2c_f32_bf16 v132, v128, v134
    v_dot2c_f32_bf16 v133, v128, v128
    v_dot2c_f32_bf16 v132, v129, v134
    v_dot2c_f32_bf16 v133, v129, v129
    v_dot2c_f32_bf16 v132, v130, v134
    v_dot2c_f32_bf16 v133, v130, v130
    v_dot2c_f32_bf16 v132, v131, v134
    v_dot2c_f32_bf16 v133, v131, v131
    v_lshrrev_b32 v135, 5, v0
    v_and_b32 v121, 3, v135
    v_lshrrev_b32 v135, 2, v135
    v_add_f32_dpp v132, v132, v132 row_shr:1 row_mask:0xf bank_mask:0xf bound_ctrl:0
    v_add_f32_dpp v133, v133, v133 row_shr:1 row_mask:0xf bank_mask:0xf bound_ctrl:0
    v_lshlrev_b32_e64 v135, 3, v135
    v_add_f32_dpp v132, v132, v132 row_shr:2 row_mask:0xf bank_mask:0xf bound_ctrl:0
    v_add_f32_dpp v133, v133, v133 row_shr:2 row_mask:0xf bank_mask:0xf bound_ctrl:0
    v_lshl_add_u32 v135, v121, 12, v135
    v_add_f32_dpp v132, v132, v132 row_shr:4 row_mask:0xf bank_mask:0xf bound_ctrl:0
    v_add_f32_dpp v133, v133, v133 row_shr:4 row_mask:0xf bank_mask:0xf bound_ctrl:0
    v_and_b32_e64 v121, 31, v0
    v_add_f32_dpp v132, v132, v132 row_shr:8 row_mask:0xf bank_mask:0xf bound_ctrl:0
    v_add_f32_dpp v133, v133, v133 row_shr:8 row_mask:0xf bank_mask:0xf bound_ctrl:0
    v_cmp_eq_u32_e64 vcc, 31, v121
    v_add_f32_dpp v132, v132, v132 row_bcast:15 row_mask:0xa bank_mask:0xf
    v_add_f32_dpp v133, v133, v133 row_bcast:15 row_mask:0xa bank_mask:0xf
    v_mov_b32 v121, 1073741824
    v_cndmask_b32_e64 v120, v121, v135, vcc
    s_lshl_b32 s96, s2, 4
    s_add_u32 s96, s96, 3440640
    v_mul_f32 v135, 0x3acccccd, v132
    v_mul_f32 v133, 0x3acccccd, v133
    v_fma_f32 v133, -v135, v135, v133
    v_max_f32 v133, 0, v133
    v_add_f32 v133, 0x3727c5ac, v133
    v_rsq_f32_e64 v132, v133
    s_nop 0
    v_mul_f32 v133, -v135, v132
    buffer_store_dwordx2 v[132:133], v120, s[16:19], s96 offen sc1
    s_add_u32 m0, s92, 36352
    s_nop 0
    s_nop 0
    buffer_load_dwordx4 v73, s[4:7], s99 offen offset:0  lds
    buffer_load_dwordx4 v74, s[4:7], s99 offen offset:1088  lds
    buffer_load_dwordx4 v75, s[4:7], s99 offen offset:2176  lds
    buffer_load_dwordx4 v76, s[4:7], s99 offen offset:3264  lds
    s_add_u32 m0, s93, 53760
    s_add_u32 s99, s99, 256
    s_mov_b64 exec, s[80:81]
    buffer_load_dwordx4 v77, s[4:7], s100 offen  lds
    s_mov_b64 exec, -1
    s_add_u32 s100, s100, 256
    s_add_u32 m0, s92, 55936
    s_nop 0
    s_nop 0
    buffer_load_dwordx4 v73, s[4:7], s99 offen offset:0  lds
    buffer_load_dwordx4 v74, s[4:7], s99 offen offset:1088  lds
    buffer_load_dwordx4 v75, s[4:7], s99 offen offset:2176  lds
    buffer_load_dwordx4 v76, s[4:7], s99 offen offset:3264  lds
    s_add_u32 m0, s93, 73344
    s_add_u32 s99, s99, 256
    s_mov_b64 exec, s[80:81]
    buffer_load_dwordx4 v77, s[4:7], s100 offen  lds
    s_mov_b64 exec, -1
    s_add_u32 s100, s100, 256
    v_mov_b32 v140, 1073741824
    v_lshlrev_b32 v141, 2, v0
    v_cmp_gt_u32 vcc, 64, v0
    s_nop 1
    v_cndmask_b32 v141, v140, v141, vcc
    v_mov_b32_e64 v140, 0
    s_lshl_b32 s97, s2, 8
    s_add_u32 s97, s97, 3473408
    buffer_store_dword v140, v141, s[16:19], s97 offen sc1
    v_mov_b32 v142, 1073741824
    v_lshlrev_b32 v143, 2, v0
    v_cmp_gt_u32 vcc, 16, v0
    s_nop 1
    v_cndmask_b32 v143, v142, v143, vcc
    v_mov_b32_e64 v142, -1
    s_lshl_b32 s97, s2, 6
    s_add_u32 s97, s97, 3457024
    buffer_store_dword v142, v143, s[16:19], s97 offen sc1
    v_mov_b32 v144, -1
    v_mov_b32 v145, -1
    v_mov_b32 v146, -1
    v_mov_b32 v147, -1
    v_lshlrev_b32 v148, 4, v0
    s_sub_u32 s88, s2, 0
    s_mul_i32 s88, s88, 20480
    s_min_u32 s88, s88, 5222400
    s_add_u32 s88, s88, 4194304
    buffer_store_dwordx4 v[144:147], v148, s[16:19], s88 offen sc1
    s_add_u32 s88, s88, 4096
    buffer_store_dwordx4 v[144:147], v148, s[16:19], s88 offen sc1
    s_add_u32 s88, s88, 4096
    buffer_store_dwordx4 v[144:147], v148, s[16:19], s88 offen sc1
    s_add_u32 s88, s88, 4096
    buffer_store_dwordx4 v[144:147], v148, s[16:19], s88 offen sc1
    s_add_u32 s88, s88, 4096
    buffer_store_dwordx4 v[144:147], v148, s[16:19], s88 offen sc1
    s_add_u32 m0, s92, 75520
    s_nop 0
    s_nop 0
    buffer_load_dwordx4 v73, s[4:7], s99 offen offset:0  lds
    buffer_load_dwordx4 v74, s[4:7], s99 offen offset:1088  lds
    buffer_load_dwordx4 v75, s[4:7], s99 offen offset:2176  lds
    buffer_load_dwordx4 v76, s[4:7], s99 offen offset:3264  lds
    s_add_u32 m0, s93, 92928
    s_add_u32 s99, s99, 256
    s_mov_b64 exec, s[80:81]
    buffer_load_dwordx4 v77, s[4:7], s100 offen  lds
    s_mov_b64 exec, -1
    s_add_u32 s100, s100, 256
    s_add_u32 m0, s92, 95104
    s_nop 0
    s_nop 0
    buffer_load_dwordx4 v73, s[4:7], s99 offen offset:0  lds
    buffer_load_dwordx4 v74, s[4:7], s99 offen offset:1088  lds
    buffer_load_dwordx4 v75, s[4:7], s99 offen offset:2176  lds
    buffer_load_dwordx4 v76, s[4:7], s99 offen offset:3264  lds
    s_add_u32 m0, s93, 112512
    s_add_u32 s99, s99, 256
    s_mov_b64 exec, s[80:81]
    buffer_load_dwordx4 v77, s[4:7], s100 offen  lds
    s_mov_b64 exec, -1
    s_add_u32 s100, s100, 256
    s_add_u32 m0, s92, 114688
    s_nop 0
    s_nop 0
    buffer_load_dwordx4 v73, s[4:7], s99 offen offset:0  lds
    buffer_load_dwordx4 v74, s[4:7], s99 offen offset:1088  lds
    buffer_load_dwordx4 v75, s[4:7], s99 offen offset:2176  lds
    buffer_load_dwordx4 v76, s[4:7], s99 offen offset:3264  lds
    s_add_u32 m0, s93, 132096
    s_add_u32 s99, s99, 256
    s_mov_b64 exec, s[80:81]
    buffer_load_dwordx4 v77, s[4:7], s100 offen  lds
    s_mov_b64 exec, -1
    s_add_u32 s100, s100, 256
    s_waitcnt vmcnt(15)
    buffer_load_dword v7, v4, s[16:19], s87 offen offset:0 sc1
    s_waitcnt vmcnt(0)
    v_cmp_gt_u32_e64 vcc, 32, v7
    s_nop 0
    s_and_b64 vcc, vcc, s[50:51]
    s_cbranch_scc1 ps_14
pc_16:
    s_barrier
    buffer_load_dwordx4 a[0:3], v200, s[16:19], s101 offen offset:0 sc1
    buffer_load_dwordx4 a[4:7], v200, s[16:19], s101 offen offset:1024 sc1
    buffer_load_dwordx4 a[8:11], v200, s[16:19], s101 offen offset:2048 sc1
    buffer_load_dwordx4 a[12:15], v200, s[16:19], s101 offen offset:3072 sc1
    s_add_u32 s101, s101, 4096
    buffer_load_dwordx4 a[16:19], v200, s[16:19], s101 offen offset:0 sc1
    buffer_load_dwordx4 a[20:23], v200, s[16:19], s101 offen offset:1024 sc1
    buffer_load_dwordx4 a[24:27], v200, s[16:19], s101 offen offset:2048 sc1
    buffer_load_dwordx4 a[28:31], v200, s[16:19], s101 offen offset:3072 sc1
    s_add_u32 s101, s101, 4096
    buffer_load_dwordx4 a[32:35], v200, s[16:19], s101 offen offset:0 sc1
    buffer_load_dwordx4 a[36:39], v200, s[16:19], s101 offen offset:1024 sc1
    buffer_load_dwordx4 a[40:43], v200, s[16:19], s101 offen offset:2048 sc1
    buffer_load_dwordx4 a[44:47], v200, s[16:19], s101 offen offset:3072 sc1
    s_add_u32 s101, s101, 4096
    buffer_load_dwordx4 a[48:51], v200, s[16:19], s101 offen offset:0 sc1
    buffer_load_dwordx4 a[52:55], v200, s[16:19], s101 offen offset:1024 sc1
ec_4:
    v_add_u32 v196, 36352, v78
    v_mov_b32 v198, v79
    v_xor_b32 v197, 32, v196
    s_waitcnt vmcnt(34)
    s_barrier
    s_add_u32 s82, s86, 16384
    v_lshlrev_b32 v2, 3, v4
    v_mov_b32 v5, 1
    v_cndmask_b32 v2, v4, v2, s[50:51]
    buffer_atomic_add v5, v2, s[16:19], s82 offen offset:8 sc1
    ds_read_b128 v[160:163], v198 offset:0
    ds_read_b128 v[164:167], v196 offset:0
    ds_read_b128 v[168:171], v196 offset:8704
    ds_read_b128 v[172:175], v198 offset:32
    ds_read_b128 v[176:179], v197 offset:0
    ds_read_b128 v[180:183], v197 offset:8704
    s_waitcnt lgkmcnt(3)
    s_waitcnt vmcnt(14)
    v_mfma_f32_16x16x32_bf16 v[112:115], a[0:3], v[160:163], 0
    ds_read_b128 v[184:187], v198 offset:64
    v_mfma_f32_32x32x16_bf16 v[80:95], a[0:3], v[164:167], 0
    ds_read_b128 v[188:191], v196 offset:64
    v_mov_b32 v208, 0
    v_mov_b32 v209, 0
    v_lshrrev_b32_e64 v210, 5, v0
    v_mul_u32_u24 v210, 1600, v210
    v_mfma_f32_32x32x16_bf16 v[96:111], a[0:3], v[168:171], 0
    ds_read_b128 v[192:195], v196 offset:8768
    buffer_load_dwordx4 a[56:59], v200, s[16:19], s101 offen offset:2048 sc1
    v_and_b32 v211, 31, v0
    v_min_u32 v211, 19, v211
    s_waitcnt lgkmcnt(3)
    s_waitcnt vmcnt(14)
    v_mfma_f32_16x16x32_bf16 v[112:115], a[4:7], v[172:175], v[112:115]
    ds_read_b128 v[160:163], v198 offset:96
    v_mfma_f32_32x32x16_bf16 v[80:95], a[4:7], v[176:179], v[80:95]
    ds_read_b128 v[164:167], v197 offset:64
    v_lshl_add_u32 v210, v211, 3, v210
    v_add_u32 v210, 6400, v210
    ds_write_b64 v210, v[208:209]
    s_mul_i32 s33, s24, 4160
    v_mfma_f32_32x32x16_bf16 v[96:111], a[4:7], v[180:183], v[96:111]
    ds_read_b128 v[168:171], v197 offset:8768
    buffer_load_dwordx4 a[60:63], v200, s[16:19], s101 offen offset:3072 sc1
    s_add_u32 s33, s33, 134272
    v_and_b32_e64 v250, 31, v1
    s_waitcnt lgkmcnt(4)
    s_waitcnt vmcnt(14)
    v_mfma_f32_16x16x32_bf16 v[112:115], a[8:11], v[184:187], v[112:115]
    ds_read_b128 v[172:175], v198 offset:128
    v_mfma_f32_32x32x16_bf16 v[80:95], a[8:11], v[188:191], v[80:95]
    ds_read_b128 v[176:179], v196 offset:128
    v_lshl_add_u32 v250, v250, 4, s33
    v_lshrrev_b32_e64 v253, 5, v1
    v_lshl_add_u32 v251, v253, 3, v250
    v_lshl_add_u32 v252, v253, 9, v250
    v_mfma_f32_32x32x16_bf16 v[96:111], a[8:11], v[192:195], v[96:111]
    ds_read_b128 v[180:183], v196 offset:8832
    s_add_u32 s101, s101, 4096
    buffer_load_dwordx4 a[64:67], v200, s[16:19], s101 offen offset:0 sc1
    v_lshl_add_u32 v250, v253, 10, v250
    s_waitcnt lgkmcnt(3)
    s_waitcnt vmcnt(14)
    v_mfma_f32_16x16x32_bf16 v[112:115], a[12:15], v[160:163], v[112:115]
    ds_read_b128 v[184:187], v198 offset:160
    v_mfma_f32_32x32x16_bf16 v[80:95], a[12:15], v[164:167], v[80:95]
    ds_read_b128 v[188:191], v197 offset:128
    v_cmp_eq_u32 vcc, 0, v1
    v_lshlrev_b32 v254, 16, v241
    v_min_u32 v253, 15, v1
    v_cndmask_b32 v254, 0, v254, vcc
    v_mfma_f32_32x32x16_bf16 v[96:111], a[12:15], v[168:171], v[96:111]
    ds_read_b128 v[192:195], v197 offset:8832
    buffer_load_dwordx4 a[68:71], v200, s[16:19], s101 offen offset:1024 sc1
    v_lshl_add_u32 v253, v253, 2, s33
    v_add_f32_e64 v216, v216, v254
    s_waitcnt lgkmcnt(3)
    s_waitcnt vmcnt(14)
    v_mfma_f32_16x16x32_bf16 v[112:115], a[16:19], v[172:175], v[112:115]
    ds_read_b128 v[160:163], v198 offset:192
    v_mfma_f32_32x32x16_bf16 v[80:95], a[16:19], v[176:179], v[80:95]
    ds_read_b128 v[164:167], v196 offset:192
    v_and_b32 v254, 1, v1
    v_cmp_eq_u32 vcc, 1, v254
    v_mov_b32_e64 v254, 0
    v_cvt_pk_bf16_f32 v242, v216, v217
    v_mfma_f32_32x32x16_bf16 v[96:111], a[16:19], v[180:183], v[96:111]
    ds_read_b128 v[168:171], v196 offset:8896
    buffer_load_dwordx4 a[72:75], v200, s[16:19], s101 offen offset:2048 sc1
    v_cvt_pk_bf16_f32 v243, v218, v219
    v_cvt_pk_bf16_f32 v244, v220, v220
    s_waitcnt lgkmcnt(3)
    s_waitcnt vmcnt(14)
    v_mfma_f32_16x16x32_bf16 v[112:115], a[20:23], v[184:187], v[112:115]
    ds_read_b128 v[172:175], v198 offset:224
    v_mfma_f32_32x32x16_bf16 v[80:95], a[20:23], v[188:191], v[80:95]
    ds_read_b128 v[176:179], v197 offset:192
    v_cvt_pk_bf16_f32 v245, v221, v222
    v_cvt_pk_bf16_f32 v246, v224, v224
    v_cvt_pk_bf16_f32 v247, v224, v225
    v_cvt_pk_bf16_f32 v248, v225, v225
    v_mfma_f32_32x32x16_bf16 v[96:111], a[20:23], v[192:195], v[96:111]
    ds_read_b128 v[180:183], v197 offset:8896
    buffer_load_dwordx4 a[76:79], v200, s[16:19], s101 offen offset:3072 sc1
    v_cvt_pk_bf16_f32 v249, v226, v226
    ds_write_b32 v253, v254
    s_barrier
    s_waitcnt lgkmcnt(4)
    s_waitcnt vmcnt(14)
    v_mfma_f32_16x16x32_bf16 v[112:115], a[24:27], v[160:163], v[112:115]
    v_add_u32 v198, v49, v198
    v_mfma_f32_32x32x16_bf16 v[80:95], a[24:27], v[164:167], v[80:95]
    v_add_u32 v196, 19584, v196
    v_add_u32 v197, 19584, v197
    ds_read_b128 v[184:187], v198 offset:0
    ds_write_b64 v251, v[242:243] offset:64
    ds_write_b64 v251, v[244:245] offset:576
    v_mfma_f32_32x32x16_bf16 v[96:111], a[24:27], v[168:171], v[96:111]
    ds_read_b128 v[188:191], v196 offset:0
    ds_read_b128 v[192:195], v196 offset:8704
    s_add_u32 s101, s101, 4096
    buffer_load_dwordx4 a[80:83], v200, s[16:19], s101 offen offset:0 sc1
    s_waitcnt lgkmcnt(6)
    s_waitcnt vmcnt(14)
    v_mfma_f32_16x16x32_bf16 v[112:115], a[28:31], v[172:175], v[112:115]
    ds_read_b128 v[160:163], v198 offset:32
    v_mfma_f32_32x32x16_bf16 v[80:95], a[28:31], v[176:179], v[80:95]
    ds_read_b128 v[164:167], v197 offset:0
    ds_write_b128 v252, v[246:249] offset:1088
    v_cndmask_b32 v255, v228, v229, vcc
    v_cvt_pk_bf16_f32 v216, v228, v228
    v_mov_b32 v217, v216
    v_mfma_f32_32x32x16_bf16 v[96:111], a[28:31], v[180:183], v[96:111]
    ds_read_b128 v[168:171], v197 offset:8704
    buffer_load_dwordx4 a[84:87], v200, s[16:19], s101 offen offset:1024 sc1
    v_cvt_pk_bf16_f32 v218, v255, v229
    v_cvt_pk_bf16_f32 v219, v229, v229
    s_waitcnt lgkmcnt(4)
    s_waitcnt vmcnt(14)
    v_mfma_f32_16x16x32_bf16 v[112:115], a[32:35], v[184:187], v[112:115]
    ds_read_b128 v[172:175], v198 offset:64
    v_mfma_f32_32x32x16_bf16 v[80:95], a[32:35], v[188:191], v[80:95]
    ds_read_b128 v[176:179], v196 offset:64
    ds_write_b128 v250, v[216:219] offset:2112
    v_cndmask_b32 v255, v230, v231, vcc
    v_cvt_pk_bf16_f32 v220, v230, v230
    v_mov_b32 v221, v220
    v_mfma_f32_32x32x16_bf16 v[96:111], a[32:35], v[192:195], v[96:111]
    ds_read_b128 v[180:183], v196 offset:8768
    buffer_load_dwordx4 a[88:91], v200, s[16:19], s101 offen offset:2048 sc1
    v_cvt_pk_bf16_f32 v222, v255, v231
    v_cvt_pk_bf16_f32 v223, v231, v231
    s_waitcnt lgkmcnt(4)
    s_waitcnt vmcnt(14)
    v_mfma_f32_16x16x32_bf16 v[112:115], a[36:39], v[160:163], v[112:115]
    ds_read_b128 v[184:187], v198 offset:96
    v_mfma_f32_32x32x16_bf16 v[80:95], a[36:39], v[164:167], v[80:95]
    ds_read_b128 v[188:191], v197 offset:64
    ds_write_b128 v250, v[220:223] offset:2624
    v_mfma_f32_32x32x16_bf16 v[96:111], a[36:39], v[168:171], v[96:111]
    ds_read_b128 v[192:195], v197 offset:8768
    buffer_load_dwordx4 a[92:95], v200, s[16:19], s101 offen offset:3072 sc1
    s_waitcnt lgkmcnt(4)
    s_waitcnt vmcnt(14)
    v_mfma_f32_16x16x32_bf16 v[112:115], a[40:43], v[172:175], v[112:115]
    ds_read_b128 v[160:163], v198 offset:128
    v_mfma_f32_32x32x16_bf16 v[80:95], a[40:43], v[176:179], v[80:95]
    ds_read_b128 v[164:167], v196 offset:128
    v_mfma_f32_32x32x16_bf16 v[96:111], a[40:43], v[180:183], v[96:111]
    ds_read_b128 v[168:171], v196 offset:8832
    s_add_u32 s101, s101, 4096
    buffer_load_dwordx4 a[96:99], v200, s[16:19], s101 offen offset:0 sc1
    s_waitcnt lgkmcnt(3)
    s_waitcnt vmcnt(14)
    v_mfma_f32_16x16x32_bf16 v[112:115], a[44:47], v[184:187], v[112:115]
    ds_read_b128 v[172:175], v198 offset:160
    v_mfma_f32_32x32x16_bf16 v[80:95], a[44:47], v[188:191], v[80:95]
    ds_read_b128 v[176:179], v197 offset:128
    v_mfma_f32_32x32x16_bf16 v[96:111], a[44:47], v[192:195], v[96:111]
    ds_read_b128 v[180:183], v197 offset:8832
    buffer_load_dwordx4 a[100:103], v200, s[16:19], s101 offen offset:1024 sc1
    s_waitcnt lgkmcnt(3)
    s_waitcnt vmcnt(14)
    v_mfma_f32_16x16x32_bf16 v[112:115], a[48:51], v[160:163], v[112:115]
    ds_read_b128 v[184:187], v198 offset:192
    v_mfma_f32_32x32x16_bf16 v[80:95], a[48:51], v[164:167], v[80:95]
    ds_read_b128 v[188:191], v196 offset:192
    v_mfma_f32_32x32x16_bf16 v[96:111], a[48:51], v[168:171], v[96:111]
    ds_read_b128 v[192:195], v196 offset:8896
    buffer_load_dwordx4 a[104:107], v200, s[16:19], s101 offen offset:2048 sc1
    s_waitcnt lgkmcnt(3)
    s_waitcnt vmcnt(14)
    v_mfma_f32_16x16x32_bf16 v[112:115], a[52:55], v[172:175], v[112:115]
    ds_read_b128 v[160:163], v198 offset:224
    v_mfma_f32_32x32x16_bf16 v[80:95], a[52:55], v[176:179], v[80:95]
    ds_read_b128 v[164:167], v197 offset:192
    v_mfma_f32_32x32x16_bf16 v[96:111], a[52:55], v[180:183], v[96:111]
    ds_read_b128 v[168:171], v197 offset:8896
    buffer_load_dwordx4 a[108:111], v200, s[16:19], s101 offen offset:3072 sc1
    s_barrier
    s_waitcnt lgkmcnt(3)
    s_waitcnt vmcnt(13)
    v_mfma_f32_16x16x32_bf16 v[112:115], a[56:59], v[184:187], v[112:115]
    v_add_u32 v198, v49, v198
    v_mfma_f32_32x32x16_bf16 v[80:95], a[56:59], v[188:191], v[80:95]
    v_add_u32 v196, 19584, v196
    v_add_u32 v197, 19584, v197
    ds_read_b128 v[172:175], v198 offset:0
    v_mfma_f32_32x32x16_bf16 v[96:111], a[56:59], v[192:195], v[96:111]
    ds_read_b128 v[176:179], v196 offset:0
    ds_read_b128 v[180:183], v196 offset:8704
    s_add_u32 s101, s101, 4096
    buffer_load_dwordx4 a[112:115], v200, s[16:19], s101 offen offset:0 sc1
    s_waitcnt lgkmcnt(3)
    s_waitcnt vmcnt(13)
    v_mfma_f32_16x16x32_bf16 v[112:115], a[60:63], v[160:163], v[112:115]
    ds_read_b128 v[184:187], v198 offset:32
    v_mfma_f32_32x32x16_bf16 v[80:95], a[60:63], v[164:167], v[80:95]
    ds_read_b128 v[188:191], v197 offset:0
    v_mfma_f32_32x32x16_bf16 v[96:111], a[60:63], v[168:171], v[96:111]
    ds_read_b128 v[192:195], v197 offset:8704
    buffer_load_dwordx4 a[116:119], v200, s[16:19], s101 offen offset:1024 sc1
    s_waitcnt lgkmcnt(3)
    s_waitcnt vmcnt(13)
    v_mfma_f32_16x16x32_bf16 v[112:115], a[64:67], v[172:175], v[112:115]
    ds_read_b128 v[160:163], v198 offset:64
    v_mfma_f32_32x32x16_bf16 v[80:95], a[64:67], v[176:179], v[80:95]
    ds_read_b128 v[164:167], v196 offset:64
    v_mfma_f32_32x32x16_bf16 v[96:111], a[64:67], v[180:183], v[96:111]
    ds_read_b128 v[168:171], v196 offset:8768
    buffer_load_dwordx4 a[120:123], v200, s[16:19], s101 offen offset:2048 sc1
    s_waitcnt lgkmcnt(3)
    s_waitcnt vmcnt(13)
    v_mfma_f32_16x16x32_bf16 v[112:115], a[68:71], v[184:187], v[112:115]
    ds_read_b128 v[172:175], v198 offset:96
    v_mfma_f32_32x32x16_bf16 v[80:95], a[68:71], v[188:191], v[80:95]
    ds_read_b128 v[176:179], v197 offset:64
    v_mfma_f32_32x32x16_bf16 v[96:111], a[68:71], v[192:195], v[96:111]
    ds_read_b128 v[180:183], v197 offset:8768
    buffer_load_dwordx4 a[124:127], v200, s[16:19], s101 offen offset:3072 sc1
    s_waitcnt lgkmcnt(3)
    s_waitcnt vmcnt(13)
    v_mfma_f32_16x16x32_bf16 v[112:115], a[72:75], v[160:163], v[112:115]
    ds_read_b128 v[184:187], v198 offset:128
    v_mfma_f32_32x32x16_bf16 v[80:95], a[72:75], v[164:167], v[80:95]
    ds_read_b128 v[188:191], v196 offset:128
    v_mfma_f32_32x32x16_bf16 v[96:111], a[72:75], v[168:171], v[96:111]
    ds_read_b128 v[192:195], v196 offset:8832
    s_add_u32 s101, s101, 4096
    buffer_load_dwordx4 a[128:131], v200, s[16:19], s101 offen offset:0 sc1
    s_waitcnt lgkmcnt(3)
    s_waitcnt vmcnt(13)
    v_mfma_f32_16x16x32_bf16 v[112:115], a[76:79], v[172:175], v[112:115]
    ds_read_b128 v[160:163], v198 offset:160
    v_mfma_f32_32x32x16_bf16 v[80:95], a[76:79], v[176:179], v[80:95]
    ds_read_b128 v[164:167], v197 offset:128
    v_mfma_f32_32x32x16_bf16 v[96:111], a[76:79], v[180:183], v[96:111]
    ds_read_b128 v[168:171], v197 offset:8832
    buffer_load_dwordx4 a[132:135], v200, s[16:19], s101 offen offset:1024 sc1
    s_waitcnt lgkmcnt(3)
    s_waitcnt vmcnt(13)
    v_mfma_f32_16x16x32_bf16 v[112:115], a[80:83], v[184:187], v[112:115]
    ds_read_b128 v[172:175], v198 offset:192
    v_mfma_f32_32x32x16_bf16 v[80:95], a[80:83], v[188:191], v[80:95]
    ds_read_b128 v[176:179], v196 offset:192
    v_mfma_f32_32x32x16_bf16 v[96:111], a[80:83], v[192:195], v[96:111]
    ds_read_b128 v[180:183], v196 offset:8896
    buffer_load_dwordx4 a[136:139], v200, s[16:19], s101 offen offset:2048 sc1
    s_waitcnt lgkmcnt(3)
    s_waitcnt vmcnt(13)
    v_mfma_f32_16x16x32_bf16 v[112:115], a[84:87], v[160:163], v[112:115]
    ds_read_b128 v[184:187], v198 offset:224
    v_mfma_f32_32x32x16_bf16 v[80:95], a[84:87], v[164:167], v[80:95]
    ds_read_b128 v[188:191], v197 offset:192
    v_mfma_f32_32x32x16_bf16 v[96:111], a[84:87], v[168:171], v[96:111]
    ds_read_b128 v[192:195], v197 offset:8896
    buffer_load_dwordx4 a[140:143], v200, s[16:19], s101 offen offset:3072 sc1
    s_barrier
    s_waitcnt lgkmcnt(3)
    s_waitcnt vmcnt(13)
    v_mfma_f32_16x16x32_bf16 v[112:115], a[88:91], v[172:175], v[112:115]
    v_add_u32 v198, v49, v198
    v_mfma_f32_32x32x16_bf16 v[80:95], a[88:91], v[176:179], v[80:95]
    v_add_u32 v196, 19584, v196
    v_add_u32 v197, 19584, v197
    ds_read_b128 v[160:163], v198 offset:0
    v_mfma_f32_32x32x16_bf16 v[96:111], a[88:91], v[180:183], v[96:111]
    ds_read_b128 v[164:167], v196 offset:0
    ds_read_b128 v[168:171], v196 offset:8704
    s_add_u32 s101, s101, 4096
    buffer_load_dword v7, v4, s[16:19], s89 offen offset:8 sc1
    s_waitcnt lgkmcnt(3)
    s_waitcnt vmcnt(13)
    v_mfma_f32_16x16x32_bf16 v[112:115], a[92:95], v[184:187], v[112:115]
    ds_read_b128 v[172:175], v198 offset:32
    v_mfma_f32_32x32x16_bf16 v[80:95], a[92:95], v[188:191], v[80:95]
    ds_read_b128 v[176:179], v197 offset:0
    v_mfma_f32_32x32x16_bf16 v[96:111], a[92:95], v[192:195], v[96:111]
    ds_read_b128 v[180:183], v197 offset:8704
    buffer_load_dwordx4 a[144:147], v200, s[16:19], s101 offen offset:0 sc1
    s_waitcnt lgkmcnt(3)
    s_waitcnt vmcnt(13)
    v_mfma_f32_16x16x32_bf16 v[112:115], a[96:99], v[160:163], v[112:115]
    ds_read_b128 v[184:187], v198 offset:64
    v_mfma_f32_32x32x16_bf16 v[80:95], a[96:99], v[164:167], v[80:95]
    ds_read_b128 v[188:191], v196 offset:64
    v_mfma_f32_32x32x16_bf16 v[96:111], a[96:99], v[168:171], v[96:111]
    ds_read_b128 v[192:195], v196 offset:8768
    buffer_load_dwordx4 a[148:151], v200, s[16:19], s101 offen offset:1024 sc1
    s_waitcnt lgkmcnt(3)
    s_waitcnt vmcnt(13)
    v_mfma_f32_16x16x32_bf16 v[112:115], a[100:103], v[172:175], v[112:115]
    ds_read_b128 v[160:163], v198 offset:96
    v_mfma_f32_32x32x16_bf16 v[80:95], a[100:103], v[176:179], v[80:95]
    ds_read_b128 v[164:167], v197 offset:64
    v_mfma_f32_32x32x16_bf16 v[96:111], a[100:103], v[180:183], v[96:111]
    ds_read_b128 v[168:171], v197 offset:8768
    buffer_load_dwordx4 a[152:155], v200, s[16:19], s101 offen offset:2048 sc1
    s_waitcnt lgkmcnt(3)
    s_waitcnt vmcnt(13)
    v_mfma_f32_16x16x32_bf16 v[112:115], a[104:107], v[184:187], v[112:115]
    ds_read_b128 v[172:175], v198 offset:128
    v_mfma_f32_32x32x16_bf16 v[80:95], a[104:107], v[188:191], v[80:95]
    ds_read_b128 v[176:179], v196 offset:128
    v_mfma_f32_32x32x16_bf16 v[96:111], a[104:107], v[192:195], v[96:111]
    ds_read_b128 v[180:183], v196 offset:8832
    buffer_load_dwordx4 a[156:159], v200, s[16:19], s101 offen offset:3072 sc1
    s_waitcnt lgkmcnt(3)
    s_waitcnt vmcnt(13)
    v_mfma_f32_16x16x32_bf16 v[112:115], a[108:111], v[160:163], v[112:115]
    ds_read_b128 v[184:187], v198 offset:160
    v_mfma_f32_32x32x16_bf16 v[80:95], a[108:111], v[164:167], v[80:95]
    ds_read_b128 v[188:191], v197 offset:128
    v_mfma_f32_32x32x16_bf16 v[96:111], a[108:111], v[168:171], v[96:111]
    ds_read_b128 v[192:195], v197 offset:8832
    s_add_u32 s101, s101, 4096
    s_lshl_b32 s25, s72, 5
    s_add_u32 s25, s25, 256
    s_sub_u32 s26, s25, 4
    s_max_i32 s26, s26, 0
    s_mul_i32 s27, s71, 1280
    s_mul_i32 s99, s25, 5120
    s_mul_i32 s100, s26, 5120
    s_mul_i32 s92, s24, 4352
    s_mul_i32 s93, s24, 544
    s_add_u32 s99, s99, s27
    s_add_u32 s100, s100, s27
    s_waitcnt lgkmcnt(3)
    s_waitcnt vmcnt(12)
    v_mfma_f32_16x16x32_bf16 v[112:115], a[112:115], v[172:175], v[112:115]
    ds_read_b128 v[160:163], v198 offset:192
    v_mfma_f32_32x32x16_bf16 v[80:95], a[112:115], v[176:179], v[80:95]
    ds_read_b128 v[164:167], v196 offset:192
    v_mfma_f32_32x32x16_bf16 v[96:111], a[112:115], v[180:183], v[96:111]
    ds_read_b128 v[168:171], v196 offset:8896
    s_waitcnt lgkmcnt(3)
    s_waitcnt vmcnt(11)
    v_mfma_f32_16x16x32_bf16 v[112:115], a[116:119], v[184:187], v[112:115]
    ds_read_b128 v[172:175], v198 offset:224
    v_mfma_f32_32x32x16_bf16 v[80:95], a[116:119], v[188:191], v[80:95]
    ds_read_b128 v[176:179], v197 offset:192
    v_mfma_f32_32x32x16_bf16 v[96:111], a[116:119], v[192:195], v[96:111]
    ds_read_b128 v[180:183], v197 offset:8896
    s_waitcnt vmcnt(4)
    v_cmp_gt_u32 vcc, 32, v7
    s_nop 0
    s_and_b64 vcc, vcc, s[50:51]
    s_cbranch_scc1 ps_17
pc_19:
    s_barrier
    s_waitcnt lgkmcnt(3)
    v_mfma_f32_16x16x32_bf16 v[112:115], a[120:123], v[160:163], v[112:115]
    v_add_u32_e64 v198, v49, v198
    v_mfma_f32_32x32x16_bf16 v[80:95], a[120:123], v[164:167], v[80:95]
    v_add_u32 v196, 19584, v196
    v_add_u32 v197, 19584, v197
    s_lshl_b32 s31, s24, 7
    s_add_u32 s31, s31, 160768
    v_bfe_u32 v132, v1, 3, 1
    v_mfma_f32_32x32x16_bf16 v[96:111], a[120:123], v[168:171], v[96:111]
    ds_read_b128 v[184:187], v198 offset:0
    ds_read_b128 v[188:191], v196 offset:0
    s_lshl_b32 s98, s72, 5
    s_add_u32 s98, s98, 0
    s_sub_u32 s95, s98, 4
    s_max_i32 s95, s95, 0
    s_lshl_b32 s94, s98, 3
    s_lshl_b32 s95, s95, 3
    s_add_u32 s94, s94, 3440640
    s_add_u32 s95, s95, 3440640
    s_add_u32 s96, s94, 8192
    buffer_load_dwordx2 v[152:153], v47, s[16:19], s94 offen sc1
    v_lshrrev_b32 v133, 4, v1
    v_lshl_add_u32 v132, v132, 2, v133
    s_waitcnt lgkmcnt(2)
    v_mfma_f32_16x16x32_bf16 v[112:115], a[124:127], v[172:175], v[112:115]
    ds_read_b128 v[192:195], v198 offset:32
    v_mfma_f32_32x32x16_bf16 v[80:95], a[124:127], v[176:179], v[80:95]
    ds_read_b128 v[160:163], v197 offset:0
    v_lshl_add_u32 v132, v132, 4, s31
    v_lshrrev_b32 v133, 5, v1
    v_lshl_add_u32 v133, v133, 4, s31
    v_mfma_f32_32x32x16_bf16 v[96:111], a[124:127], v[180:183], v[96:111]
    buffer_load_dwordx2 v[154:155], v47, s[16:19], s96 offen sc1
    s_waitcnt lgkmcnt(2)
    v_mfma_f32_16x16x32_bf16 v[112:115], a[128:131], v[184:187], v[112:115]
    ds_read_b128 v[164:167], v198 offset:64
    v_mfma_f32_32x32x16_bf16 v[80:95], a[128:131], v[188:191], v[80:95]
    ds_read_b128 v[168:171], v196 offset:64
    s_waitcnt lgkmcnt(2)
    v_mfma_f32_16x16x32_bf16 v[112:115], a[132:135], v[192:195], v[112:115]
    ds_read_b128 v[172:175], v198 offset:96
    v_mfma_f32_32x32x16_bf16 v[80:95], a[132:135], v[160:163], v[80:95]
    ds_read_b128 v[176:179], v197 offset:64
    buffer_load_dwordx2 v[156:157], v48, s[16:19], s95 offen sc1
    s_waitcnt lgkmcnt(2)
    v_mfma_f32_16x16x32_bf16 v[112:115], a[136:139], v[164:167], v[112:115]
    ds_read_b128 v[180:183], v198 offset:128
    v_mfma_f32_32x32x16_bf16 v[80:95], a[136:139], v[168:171], v[80:95]
    ds_read_b128 v[184:187], v196 offset:128
    s_waitcnt lgkmcnt(2)
    v_mfma_f32_16x16x32_bf16 v[112:115], a[140:143], v[172:175], v[112:115]
    ds_read_b128 v[188:191], v198 offset:160
    v_mfma_f32_32x32x16_bf16 v[80:95], a[140:143], v[176:179], v[80:95]
    ds_read_b128 v[192:195], v197 offset:128
    s_add_u32 m0, s92, 36352
    s_nop 0
    buffer_load_dwordx4 v73, s[4:7], s99 offen offset:0  lds
    s_waitcnt lgkmcnt(2)
    s_waitcnt vmcnt(7)
    v_mfma_f32_16x16x32_bf16 v[112:115], a[144:147], v[180:183], v[112:115]
    ds_read_b128 v[160:163], v198 offset:192
    v_mfma_f32_32x32x16_bf16 v[80:95], a[144:147], v[184:187], v[80:95]
    ds_read_b128 v[164:167], v196 offset:192
    s_waitcnt lgkmcnt(2)
    s_waitcnt vmcnt(6)
    v_mfma_f32_16x16x32_bf16 v[112:115], a[148:151], v[188:191], v[112:115]
    ds_read_b128 v[168:171], v198 offset:224
    v_mfma_f32_32x32x16_bf16 v[80:95], a[148:151], v[192:195], v[80:95]
    ds_read_b128 v[172:175], v197 offset:192
    buffer_load_dwordx4 v74, s[4:7], s99 offen offset:1088  lds
    s_waitcnt lgkmcnt(2)
    s_waitcnt vmcnt(6)
    v_mfma_f32_16x16x32_bf16 v[112:115], a[152:155], v[160:163], v[112:115]
    ds_read_b128 v[176:179], v196 offset:8704
    v_mfma_f32_32x32x16_bf16 v[80:95], a[152:155], v[164:167], v[80:95]
    ds_read_b128 v[180:183], v197 offset:8704
    s_waitcnt lgkmcnt(2)
    s_waitcnt vmcnt(5)
    v_mfma_f32_16x16x32_bf16 v[112:115], a[156:159], v[168:171], v[112:115]
    ds_read_b128 v[184:187], v196 offset:8768
    v_mfma_f32_32x32x16_bf16 v[80:95], a[156:159], v[172:175], v[80:95]
    ds_read_b128 v[188:191], v197 offset:8768
    buffer_load_dwordx4 v75, s[4:7], s99 offen offset:2176  lds
    s_waitcnt lgkmcnt(2)
    v_mfma_f32_32x32x16_bf16 v[96:111], a[128:131], v[176:179], v[96:111]
    ds_read_b128 v[192:195], v196 offset:8832
    v_mfma_f32_32x32x16_bf16 v[96:111], a[132:135], v[180:183], v[96:111]
    ds_read_b128 v[160:163], v197 offset:8832
    buffer_load_dwordx4 v76, s[4:7], s99 offen offset:3264  lds
    s_mov_b32 exec_lo, 0x01010101
    s_mov_b32 exec_hi, 0x01010101
    ds_write_b128 v132, v[112:115]
    s_mov_b64 exec, -1
    s_waitcnt lgkmcnt(3)
    v_mfma_f32_32x32x16_bf16 v[96:111], a[136:139], v[184:187], v[96:111]
    ds_read_b128 v[164:167], v196 offset:8896
    ds_read_b128 v[24:27], v132
    ds_read_b128 v[8:11], v133 offset:0
    ds_read_b128 v[12:15], v133 offset:32
    ds_read_b128 v[16:19], v133 offset:64
    v_mfma_f32_32x32x16_bf16 v[96:111], a[140:143], v[188:191], v[96:111]
    ds_read_b128 v[168:171], v197 offset:8896
    s_add_u32 m0, s93, 53760
    s_add_u32 s99, s99, 256
    s_mov_b64 exec, s[80:81]
    buffer_load_dwordx4 v77, s[4:7], s100 offen  lds
    s_mov_b64 exec, -1
    s_add_u32 s100, s100, 256
    ds_read_b128 v[20:23], v133 offset:96
    s_waitcnt vmcnt(5) lgkmcnt(5)
    v_mul_f32 v148, v24, v157
    v_mfma_f32_32x32x16_bf16 v[96:111], a[144:147], v[192:195], v[96:111]
    v_mul_f32 v149, v25, v157
    v_mul_f32 v150, v26, v157
    v_mul_f32 v151, v27, v157
    s_waitcnt lgkmcnt(4)
    v_mul_f32 v116, v8, v153
    v_mul_f32 v117, v9, v153
    v_mfma_f32_32x32x16_bf16 v[96:111], a[148:151], v[160:163], v[96:111]
    v_mul_f32 v118, v10, v153
    v_mul_f32 v119, v11, v153
    s_waitcnt lgkmcnt(3)
    v_mul_f32 v120, v12, v153
    v_mul_f32 v121, v13, v153
    s_waitcnt lgkmcnt(1)
    v_mfma_f32_32x32x16_bf16 v[96:111], a[152:155], v[164:167], v[96:111]
    v_mul_f32 v122, v14, v153
    v_mul_f32 v123, v15, v153
    v_mul_f32 v124, v16, v153
    v_mul_f32 v125, v17, v153
    v_mul_f32_e64 v126, v18, v153
    v_mfma_f32_32x32x16_bf16 v[96:111], a[156:159], v[168:171], v[96:111]
    s_add_u32 m0, s92, 55936
    s_nop 0
    buffer_load_dwordx4 v73, s[4:7], s99 offen offset:0  lds
    v_mul_f32 v127, v19, v153
    s_waitcnt lgkmcnt(0)
    v_mul_f32 v128, v20, v153
    v_mul_f32 v129, v21, v153
    v_mul_f32 v130, v22, v153
    v_mul_f32_e64 v131, v23, v153
    v_fma_f32 v112, v112, v156, v148
    v_fma_f32 v113, v113, v156, v149
    v_fma_f32 v114, v114, v156, v150
    v_fma_f32 v115, v115, v156, v151
    v_cvt_pk_bf16_f32 v112, v112, v113
    v_cvt_pk_bf16_f32 v113, v114, v115
    v_fma_f32 v80, v80, v152, v116
    v_fma_f32 v81, v81, v152, v117
    v_fma_f32 v82, v82, v152, v118
    v_fma_f32 v83, v83, v152, v119
    v_cvt_pk_bf16_f32 v80, v80, v81
    v_cvt_pk_bf16_f32 v81, v82, v83
    ds_write_b64 v40, v[112:113] offset:0
    ds_write_b64 v38, v[80:81] offset:0
    v_fma_f32 v84, v84, v152, v120
    v_fma_f32 v85, v85, v152, v121
    v_fma_f32 v86, v86, v152, v122
    v_fma_f32 v87, v87, v152, v123
    v_cvt_pk_bf16_f32 v84, v84, v85
    v_cvt_pk_bf16_f32 v85, v86, v87
    v_fma_f32 v88, v88, v152, v124
    v_fma_f32 v89, v89, v152, v125
    v_fma_f32 v90, v90, v152, v126
    v_fma_f32 v91, v91, v152, v127
    v_cvt_pk_bf16_f32 v88, v88, v89
    v_cvt_pk_bf16_f32 v89, v90, v91
    ds_write_b64 v38, v[84:85] offset:6400
    ds_write_b64 v38, v[88:89] offset:12800
    v_fma_f32 v92, v92, v152, v128
    v_fma_f32 v93, v93, v152, v129
    v_fma_f32 v94, v94, v152, v130
    v_fma_f32 v95, v95, v152, v131
    v_cvt_pk_bf16_f32 v92, v92, v93
    v_cvt_pk_bf16_f32 v93, v94, v95
    ds_write_b64 v39, v[92:93] offset:0
    v_mul_f32 v132, v8, v155
    v_mul_f32 v133, v9, v155
    v_mul_f32 v134, v10, v155
    v_mul_f32 v135, v11, v155
    v_mul_f32 v136, v12, v155
    v_mul_f32 v137, v13, v155
    v_mul_f32 v138, v14, v155
    v_mul_f32 v139, v15, v155
    v_mul_f32 v140, v16, v155
    v_mul_f32 v141, v17, v155
    v_mul_f32 v142, v18, v155
    v_mul_f32 v143, v19, v155
    v_mul_f32 v144, v20, v155
    v_mul_f32 v145, v21, v155
    v_mul_f32 v146, v22, v155
    v_mul_f32 v147, v23, v155
    v_pk_fma_f32 v[96:97], v[96:97], v[154:155], v[132:133] op_sel_hi:[1,0,1]
    v_pk_fma_f32 v[98:99], v[98:99], v[154:155], v[134:135] op_sel_hi:[1,0,1]
    v_cvt_pk_bf16_f32 v96, v96, v97
    v_cvt_pk_bf16_f32 v97, v98, v99
    v_pk_fma_f32 v[100:101], v[100:101], v[154:155], v[136:137] op_sel_hi:[1,0,1]
    v_pk_fma_f32 v[102:103], v[102:103], v[154:155], v[138:139] op_sel_hi:[1,0,1]
    v_cvt_pk_bf16_f32 v100, v100, v101
    v_cvt_pk_bf16_f32 v101, v102, v103
    ds_write_b64 v38, v[96:97] offset:1600
    ds_write_b64 v38, v[100:101] offset:8000
    v_pk_fma_f32 v[104:105], v[104:105], v[154:155], v[140:141] op_sel_hi:[1,0,1]
    v_pk_fma_f32 v[106:107], v[106:107], v[154:155], v[142:143] op_sel_hi:[1,0,1]
    v_cvt_pk_bf16_f32 v104, v104, v105
    v_cvt_pk_bf16_f32 v105, v106, v107
    v_pk_fma_f32 v[108:109], v[108:109], v[154:155], v[144:145] op_sel_hi:[1,0,1]
    v_pk_fma_f32 v[110:111], v[110:111], v[154:155], v[146:147] op_sel_hi:[1,0,1]
    v_cvt_pk_bf16_f32 v108, v108, v109
    v_cvt_pk_bf16_f32 v109, v110, v111
    ds_write_b64 v38, v[104:105] offset:14400
    ds_write_b64 v39, v[108:109] offset:1600
    s_waitcnt lgkmcnt(0)
    s_barrier
    v_mov_b32 v94, 0
    v_mov_b32 v95, 0
    v_mov_b32 v98, 0
    v_mov_b32 v99, 0
    s_mov_b64 exec, 0xffff
    ds_read_b64 v[94:95], v42 offset:320
    ds_read_b64 v[98:99], v42 offset:640
    s_mov_b64 exec, -1
    s_nop 0
    ds_read_b64 v[92:93], v41 offset:320
    ds_read_b64 v[96:97], v41 offset:640
    ds_read_b64 v[84:85], v41 offset:6720
    ds_read_b64 v[86:87], v42 offset:6720
    ds_read_b64 v[80:81], v41 offset:6400
    ds_read_b64 v[82:83], v42 offset:6400
    ds_read_b64 v[88:89], v41 offset:7040
    ds_read_b64 v[90:91], v42 offset:7040
    ds_read_b64_tr_b16 v[106:107], v44 offset:0
    ds_read_b64_tr_b16 v[100:101], v43 offset:0
    ds_read_b64_tr_b16 v[108:109], v44 offset:320
    ds_read_b64_tr_b16 v[102:103], v43 offset:320
    buffer_load_dwordx4 v74, s[4:7], s99 offen offset:1088  lds
    ds_read_b64_tr_b16 v[110:111], v44 offset:640
    ds_read_b64_tr_b16 v[104:105], v43 offset:640
    v_mov_b32 v156, 0xf149f2ca
    v_cndmask_b32 v152, v32, v156, s[90:91]
    v_cndmask_b32 v153, v33, v156, s[90:91]
    v_cndmask_b32 v154, v34, v156, s[90:91]
    v_cndmask_b32 v155, v35, v156, s[90:91]
    s_mov_b32 s82, 0x3ea52b5c
    buffer_load_dwordx4 v75, s[4:7], s99 offen offset:2176  lds
    s_lshl_b32 s25, s98, 4
    s_add_u32 s25, s25, 4194304
    s_lshl_b32 s26, s98, 3
    s_add_u32 s26, s26, 4194304
    s_waitcnt lgkmcnt(10)
    v_mfma_f32_16x16x32_bf16 v[116:119], v[84:87], v[92:95], v[28:31]
    v_mfma_f32_16x16x32_bf16 v[120:123], v[84:87], v[96:99], v[32:35]
    s_waitcnt lgkmcnt(8)
    v_mfma_f32_16x16x32_bf16 v[112:115], v[80:83], v[92:95], v[152:155]
    s_waitcnt lgkmcnt(6)
    v_mfma_f32_16x16x32_bf16 v[124:127], v[88:91], v[96:99], v[28:31]
    buffer_load_dwordx4 v76, s[4:7], s99 offen offset:3264  lds
    s_nop 4
    v_max_f32 v112, v112, v116
    v_max_f32 v113, v113, v117
    v_max_f32 v114, v114, v118
    v_max_f32 v115, v115, v119
    v_max3_f32 v156, v112, v113, v114
    v_max_f32 v156, v156, v115
    v_max_f32 v120, v120, v124
    v_max_f32_e64 v121, v121, v125
    s_add_u32 m0, s93, 73344
    s_add_u32 s99, s99, 256
    s_mov_b64 exec, s[80:81]
    buffer_load_dwordx4 v77, s[4:7], s100 offen  lds
    s_mov_b64 exec, -1
    s_add_u32 s100, s100, 256
    v_max_f32 v122, v122, v126
    v_max_f32 v123, v123, v127
    v_max3_f32 v157, v120, v121, v122
    v_max_f32 v157, v157, v123
    s_nop 1
    v_permlane16_swap_b32 v156, v157
    v_max_f32 v156, v156, v157
    v_mov_b32 v157, v156
    s_nop 1
    v_permlane32_swap_b32 v156, v157
    s_add_u32 m0, s92, 75520
    s_nop 0
    buffer_load_dwordx4 v73, s[4:7], s99 offen offset:0  lds
    v_max_f32 v156, v156, v157
    v_mul_f32 v156, s82, v156
    v_mov_b32 v157, v156
    s_nop 1
    v_permlane16_swap_b32_e64 v156, v157
    v_fma_f32 v112, v112, s82, -v156
    v_fma_f32 v113, v113, s82, -v156
    v_fma_f32 v114, v114, s82, -v156
    v_fma_f32 v115, v115, s82, -v156
    buffer_load_dwordx4 v74, s[4:7], s99 offen offset:1088  lds
    v_exp_f32 v112, v112
    v_exp_f32 v113, v113
    v_exp_f32 v114, v114
    v_exp_f32 v115, v115
    v_cvt_pk_bf16_f32 v116, v112, v113
    v_cvt_pk_bf16_f32 v117, v114, v115
    v_bfi_b32 v128, v36, 0, v116
    v_and_b32_e64 v130, v36, v116
    buffer_load_dwordx4 v75, s[4:7], s99 offen offset:2176  lds
    v_bfi_b32 v129, v37, 0, v117
    v_and_b32 v131, v37, v117
    s_waitcnt lgkmcnt(3)
    s_nop 0
    v_mfma_f32_16x16x32_bf16 v[144:147], v[106:109], v[128:131], 0
    s_waitcnt lgkmcnt(2)
    v_mfma_f32_16x16x32_bf16 v[136:139], v[100:103], v[128:131], 0
    v_fma_f32 v120, v120, s82, -v157
    v_fma_f32 v121, v121, s82, -v157
    v_fma_f32 v122, v122, s82, -v157
    v_fma_f32 v123, v123, s82, -v157
    buffer_load_dwordx4 v76, s[4:7], s99 offen offset:3264  lds
    v_exp_f32 v120, v120
    v_exp_f32 v121, v121
    v_exp_f32 v122, v122
    v_exp_f32 v123, v123
    v_cvt_pk_bf16_f32 v124, v120, v121
    v_cvt_pk_bf16_f32 v125, v122, v123
    v_bfi_b32 v132, v36, 0, v124
    v_and_b32_e64 v134, v36, v124
    s_add_u32 m0, s93, 92928
    s_add_u32 s99, s99, 256
    s_mov_b64 exec, s[80:81]
    buffer_load_dwordx4 v77, s[4:7], s100 offen  lds
    s_mov_b64 exec, -1
    s_add_u32 s100, s100, 256
    v_bfi_b32 v133, v37, 0, v125
    v_and_b32 v135, v37, v125
    s_waitcnt lgkmcnt(1)
    s_nop 0
    v_mfma_f32_16x16x32_bf16 v[148:151], v[108:111], v[132:135], 0
    s_waitcnt lgkmcnt(0)
    v_mfma_f32_16x16x32_bf16 v[140:143], v[102:105], v[132:135], 0
    v_mov_b32 v158, v144
    s_nop 1
    v_permlane16_swap_b32 v144, v158
    v_rcp_f32 v158, v158
    s_nop 0
    v_pk_mul_f32 v[136:137], v[136:137], v[158:159] op_sel_hi:[1,0]
    s_lshl_b32 s97, s73, 2
    s_add_u32 s97, s97, s24
    s_nop 0
    s_mul_i32 s97, s97, 25600
    s_add_u32 s97, s97, 2621440
    buffer_load_dwordx4 a[160:163], v58, s[16:19], s97 offen offset:0 sc1
    v_pk_mul_f32 v[138:139], v[138:139], v[158:159] op_sel_hi:[1,0]
    v_pk_mul_f32 v[144:145], v[144:145], v[158:159] op_sel_hi:[1,0]
    v_pk_mul_f32 v[146:147], v[146:147], v[158:159] op_sel_hi:[1,0]
    v_cvt_pk_bf16_f32 v112, v136, v137
    v_cvt_pk_bf16_f32 v116, v144, v145
    v_cvt_pk_bf16_f32 v113, v138, v139
    v_cvt_pk_bf16_f32 v117, v146, v147
    v_mov_b32 v160, v148
    buffer_load_dwordx4 a[164:167], v58, s[16:19], s97 offen offset:1024 sc1
    s_nop 0
    v_permlane16_swap_b32 v148, v160
    v_rcp_f32_e64 v160, v160
    s_nop 0
    v_pk_mul_f32 v[140:141], v[140:141], v[160:161] op_sel_hi:[1,0]
    v_pk_mul_f32 v[142:143], v[142:143], v[160:161] op_sel_hi:[1,0]
    v_pk_mul_f32 v[148:149], v[148:149], v[160:161] op_sel_hi:[1,0]
    v_pk_mul_f32 v[150:151], v[150:151], v[160:161] op_sel_hi:[1,0]
    v_cvt_pk_bf16_f32 v114, v140, v141
    v_cvt_pk_bf16_f32 v118, v148, v149
    buffer_load_dwordx4 a[168:171], v58, s[16:19], s97 offen offset:2048 sc1
    v_cvt_pk_bf16_f32 v115, v142, v143
    v_cvt_pk_bf16_f32 v119, v150, v151
    v_permlane16_swap_b32 v112, v114
    v_permlane16_swap_b32 v113, v115
    v_permlane16_swap_b32 v116, v118
    v_permlane16_swap_b32 v117, v119
    buffer_store_dwordx4 v[112:115], v45, s[16:19], s25 offen sc1
    s_mov_b64 exec, s[80:81]
    buffer_store_dwordx2 v[116:117], v46, s[16:19], s26 offen sc1
    s_mov_b64 exec, -1
    buffer_load_dwordx4 a[172:175], v58, s[16:19], s97 offen offset:3072 sc1
    s_add_u32 s97, s97, 4096
    buffer_load_dwordx4 a[176:179], v58, s[16:19], s97 offen offset:0 sc1
    v_add_u32 v196, 36352, v78
    v_mov_b32 v198, v79
    v_xor_b32 v197, 32, v196
    s_waitcnt vmcnt(17)
    s_barrier
    ds_read_b128 v[160:163], v198 offset:0
    ds_read_b128 v[164:167], v196 offset:0
    ds_read_b128 v[168:171], v196 offset:8704
    ds_read_b128 v[172:175], v198 offset:32
    ds_read_b128 v[176:179], v197 offset:0
    ds_read_b128 v[180:183], v197 offset:8704
    s_waitcnt lgkmcnt(3)
    v_mfma_f32_16x16x32_bf16 v[112:115], a[0:3], v[160:163], 0
    ds_read_b128 v[184:187], v198 offset:64
    v_mfma_f32_32x32x16_bf16 v[80:95], a[0:3], v[164:167], 0
    ds_read_b128 v[188:191], v196 offset:64
    v_mfma_f32_32x32x16_bf16 v[96:111], a[0:3], v[168:171], 0
    ds_read_b128 v[192:195], v196 offset:8768
    s_add_u32 m0, s92, 95104
    s_nop 0
    buffer_load_dwordx4 v73, s[4:7], s99 offen offset:0  lds
    s_waitcnt lgkmcnt(3)
    v_mfma_f32_16x16x32_bf16 v[112:115], a[4:7], v[172:175], v[112:115]
    ds_read_b128 v[160:163], v198 offset:96
    v_mfma_f32_32x32x16_bf16 v[80:95], a[4:7], v[176:179], v[80:95]
    ds_read_b128 v[164:167], v197 offset:64
    v_mfma_f32_32x32x16_bf16 v[96:111], a[4:7], v[180:183], v[96:111]
    ds_read_b128 v[168:171], v197 offset:8768
    buffer_load_dwordx4 v74, s[4:7], s99 offen offset:1088  lds
    s_waitcnt lgkmcnt(3)
    v_mfma_f32_16x16x32_bf16 v[112:115], a[8:11], v[184:187], v[112:115]
    ds_read_b128 v[172:175], v198 offset:128
    v_mfma_f32_32x32x16_bf16 v[80:95], a[8:11], v[188:191], v[80:95]
    ds_read_b128 v[176:179], v196 offset:128
    v_mfma_f32_32x32x16_bf16 v[96:111], a[8:11], v[192:195], v[96:111]
    ds_read_b128 v[180:183], v196 offset:8832
    buffer_load_dwordx4 v75, s[4:7], s99 offen offset:2176  lds
    s_waitcnt lgkmcnt(3)
    v_mfma_f32_16x16x32_bf16 v[112:115], a[12:15], v[160:163], v[112:115]
    ds_read_b128 v[184:187], v198 offset:160
    v_mfma_f32_32x32x16_bf16 v[80:95], a[12:15], v[164:167], v[80:95]
    ds_read_b128 v[188:191], v197 offset:128
    v_mfma_f32_32x32x16_bf16 v[96:111], a[12:15], v[168:171], v[96:111]
    ds_read_b128 v[192:195], v197 offset:8832
    buffer_load_dwordx4 v76, s[4:7], s99 offen offset:3264  lds
    s_waitcnt lgkmcnt(3)
    v_mfma_f32_16x16x32_bf16 v[112:115], a[16:19], v[172:175], v[112:115]
    ds_read_b128 v[160:163], v198 offset:192
    v_mfma_f32_32x32x16_bf16 v[80:95], a[16:19], v[176:179], v[80:95]
    ds_read_b128 v[164:167], v196 offset:192
    v_mfma_f32_32x32x16_bf16 v[96:111], a[16:19], v[180:183], v[96:111]
    ds_read_b128 v[168:171], v196 offset:8896
    s_add_u32 m0, s93, 112512
    s_add_u32 s99, s99, 256
    s_mov_b64 exec, s[80:81]
    buffer_load_dwordx4 v77, s[4:7], s100 offen  lds
    s_mov_b64 exec, -1
    s_add_u32 s100, s100, 256
    s_waitcnt lgkmcnt(3)
    v_mfma_f32_16x16x32_bf16 v[112:115], a[20:23], v[184:187], v[112:115]
    ds_read_b128 v[172:175], v198 offset:224
    v_mfma_f32_32x32x16_bf16 v[80:95], a[20:23], v[188:191], v[80:95]
    ds_read_b128 v[176:179], v197 offset:192
    v_mfma_f32_32x32x16_bf16 v[96:111], a[20:23], v[192:195], v[96:111]
    ds_read_b128 v[180:183], v197 offset:8896
    s_add_u32 m0, s92, 114688
    s_nop 0
    buffer_load_dwordx4 v73, s[4:7], s99 offen offset:0  lds
    s_waitcnt vmcnt(18)
    s_barrier
    s_waitcnt lgkmcnt(3)
    v_mfma_f32_16x16x32_bf16 v[112:115], a[24:27], v[160:163], v[112:115]
    v_add_u32 v198, v49, v198
    v_mfma_f32_32x32x16_bf16 v[80:95], a[24:27], v[164:167], v[80:95]
    v_add_u32 v196, 19584, v196
    v_add_u32 v197, 19584, v197
    ds_read_b128 v[184:187], v198 offset:0
    v_mfma_f32_32x32x16_bf16 v[96:111], a[24:27], v[168:171], v[96:111]
    ds_read_b128 v[188:191], v196 offset:0
    ds_read_b128 v[192:195], v196 offset:8704
    buffer_load_dwordx4 v74, s[4:7], s99 offen offset:1088  lds
    s_waitcnt lgkmcnt(3)
    v_mfma_f32_16x16x32_bf16 v[112:115], a[28:31], v[172:175], v[112:115]
    ds_read_b128 v[160:163], v198 offset:32
    v_mfma_f32_32x32x16_bf16 v[80:95], a[28:31], v[176:179], v[80:95]
    ds_read_b128 v[164:167], v197 offset:0
    v_mfma_f32_32x32x16_bf16 v[96:111], a[28:31], v[180:183], v[96:111]
    ds_read_b128 v[168:171], v197 offset:8704
    buffer_load_dwordx4 v75, s[4:7], s99 offen offset:2176  lds
    s_waitcnt lgkmcnt(3)
    v_mfma_f32_16x16x32_bf16 v[112:115], a[32:35], v[184:187], v[112:115]
    ds_read_b128 v[172:175], v198 offset:64
    v_mfma_f32_32x32x16_bf16 v[80:95], a[32:35], v[188:191], v[80:95]
    ds_read_b128 v[176:179], v196 offset:64
    v_mfma_f32_32x32x16_bf16 v[96:111], a[32:35], v[192:195], v[96:111]
    ds_read_b128 v[180:183], v196 offset:8768
    buffer_load_dwordx4 v76, s[4:7], s99 offen offset:3264  lds
    s_waitcnt lgkmcnt(3)
    v_mfma_f32_16x16x32_bf16 v[112:115], a[36:39], v[160:163], v[112:115]
    ds_read_b128 v[184:187], v198 offset:96
    v_mfma_f32_32x32x16_bf16 v[80:95], a[36:39], v[164:167], v[80:95]
    ds_read_b128 v[188:191], v197 offset:64
    v_mfma_f32_32x32x16_bf16 v[96:111], a[36:39], v[168:171], v[96:111]
    ds_read_b128 v[192:195], v197 offset:8768
    s_add_u32 m0, s93, 132096
    s_add_u32 s99, s99, 256
    s_mov_b64 exec, s[80:81]
    buffer_load_dwordx4 v77, s[4:7], s100 offen  lds
    s_mov_b64 exec, -1
    s_add_u32 s100, s100, 256
    s_waitcnt lgkmcnt(3)
    v_mfma_f32_16x16x32_bf16 v[112:115], a[40:43], v[172:175], v[112:115]
    ds_read_b128 v[160:163], v198 offset:128
    v_mfma_f32_32x32x16_bf16 v[80:95], a[40:43], v[176:179], v[80:95]
    ds_read_b128 v[164:167], v196 offset:128
    s_lshl_b32 s25, s24, 6
    s_and_b32 s35, s74, 3
    s_lshl_b32 s35, s35, 13
    s_add_u32 s35, s35, s25
    v_mfma_f32_32x32x16_bf16 v[96:111], a[40:43], v[180:183], v[96:111]
    ds_read_b128 v[168:171], v196 offset:8832
    s_lshl_b32 s98, s72, 5
    s_add_u32 s98, s98, 256
    s_sub_u32 s95, s98, 4
    s_max_i32 s95, s95, 0
    s_lshl_b32 s94, s98, 3
    s_lshl_b32 s95, s95, 3
    s_add_u32 s94, s94, 3440640
    s_add_u32 s95, s95, 3440640
    s_add_u32 s96, s94, 8192
    buffer_load_dwordx2 v[152:153], v47, s[16:19], s94 offen sc1
    s_waitcnt lgkmcnt(3)
    v_mfma_f32_16x16x32_bf16 v[112:115], a[44:47], v[184:187], v[112:115]
    ds_read_b128 v[172:175], v198 offset:160
    v_mfma_f32_32x32x16_bf16 v[80:95], a[44:47], v[188:191], v[80:95]
    ds_read_b128 v[176:179], v197 offset:128
    s_lshr_b32 s25, s74, 4
    s_lshl_b32 s25, s25, 11
    s_add_u32 s35, s35, s25
    s_and_b32 s25, s74, 12
    v_mfma_f32_32x32x16_bf16 v[96:111], a[44:47], v[192:195], v[96:111]
    ds_read_b128 v[180:183], v197 offset:8832
    buffer_load_dwordx2 v[154:155], v47, s[16:19], s96 offen sc1
    s_lshl_b32 s25, s25, 6
    s_add_u32 s35, s35, s25
    s_waitcnt lgkmcnt(3)
    v_mfma_f32_16x16x32_bf16 v[112:115], a[48:51], v[160:163], v[112:115]
    ds_read_b128 v[184:187], v198 offset:192
    v_mfma_f32_32x32x16_bf16 v[80:95], a[48:51], v[164:167], v[80:95]
    ds_read_b128 v[188:191], v196 offset:192
    s_mul_i32 s36, s73, 20
    s_add_u32 s36, s36, s24
    s_add_u32 s36, s36, 16
    s_lshl_b32 s36, s36, 14
    v_mfma_f32_32x32x16_bf16 v[96:111], a[48:51], v[168:171], v[96:111]
    ds_read_b128 v[192:195], v196 offset:8896
    buffer_load_dwordx2 v[156:157], v48, s[16:19], s95 offen sc1
    v_add_u32 v199, 36352, v58
    s_lshl_b32 s32, s24, 11
    s_waitcnt lgkmcnt(3)
    v_mfma_f32_16x16x32_bf16 v[112:115], a[52:55], v[172:175], v[112:115]
    ds_read_b128 v[160:163], v198 offset:224
    v_mfma_f32_32x32x16_bf16 v[80:95], a[52:55], v[176:179], v[80:95]
    ds_read_b128 v[164:167], v197 offset:192
    v_add_u32 v203, s32, v199
    s_add_u32 s32, s24, 1
    s_and_b32 s32, s32, 3
    s_mul_i32 s32, s32, 6144
    v_mfma_f32_32x32x16_bf16 v[96:111], a[52:55], v[180:183], v[96:111]
    ds_read_b128 v[168:171], v197 offset:8896
    buffer_load_dwordx4 a[180:183], v58, s[16:19], s97 offen offset:1024 sc1
    v_add_u32 v200, s32, v199
    s_add_u32 s32, s24, 2
    s_waitcnt vmcnt(21)
    s_barrier
    s_waitcnt lgkmcnt(3)
    v_mfma_f32_16x16x32_bf16 v[112:115], a[56:59], v[184:187], v[112:115]
    v_add_u32 v198, v49, v198
    v_mfma_f32_32x32x16_bf16 v[80:95], a[56:59], v[188:191], v[80:95]
    v_add_u32 v196, 19584, v196
    v_add_u32 v197, 19584, v197
    ds_read_b128 v[172:175], v198 offset:0
    s_and_b32 s32, s32, 3
    s_mul_i32 s32, s32, 6144
    v_mfma_f32_32x32x16_bf16 v[96:111], a[56:59], v[192:195], v[96:111]
    ds_read_b128 v[176:179], v196 offset:0
    ds_read_b128 v[180:183], v196 offset:8704
    buffer_load_dwordx4 a[184:187], v58, s[16:19], s97 offen offset:2048 sc1
    v_add_u32_e64 v201, s32, v199
    s_waitcnt lgkmcnt(3)
    v_mfma_f32_16x16x32_bf16 v[112:115], a[60:63], v[160:163], v[112:115]
    ds_read_b128 v[184:187], v198 offset:32
    v_mfma_f32_32x32x16_bf16 v[80:95], a[60:63], v[164:167], v[80:95]
    ds_read_b128 v[188:191], v197 offset:0
    s_add_u32 s32, s24, 3
    s_and_b32 s32, s32, 3
    s_mul_i32 s32, s32, 6144
    v_add_u32_e64 v202, s32, v199
    v_mfma_f32_32x32x16_bf16 v[96:111], a[60:63], v[168:171], v[96:111]
    ds_read_b128 v[192:195], v197 offset:8704
    buffer_load_dwordx4 a[188:191], v58, s[16:19], s97 offen offset:3072 sc1
    s_mul_i32 s32, s24, 6144
    v_add_u32 v204, s32, v199
    s_waitcnt lgkmcnt(3)
    v_mfma_f32_16x16x32_bf16 v[112:115], a[64:67], v[172:175], v[112:115]
    ds_read_b128 v[160:163], v198 offset:64
    v_mfma_f32_32x32x16_bf16 v[80:95], a[64:67], v[176:179], v[80:95]
    ds_read_b128 v[164:167], v196 offset:64
    s_lshl_b32 s32, s24, 8
    s_add_u32 s32, s32, 36352
    v_and_b32 v214, 15, v1
    v_lshl_add_u32 v206, v214, 4, s32
    v_mfma_f32_32x32x16_bf16 v[96:111], a[64:67], v[180:183], v[96:111]
    ds_read_b128 v[168:171], v196 offset:8768
    s_add_u32 s97, s97, 4096
    buffer_load_dwordx4 a[192:195], v58, s[16:19], s97 offen offset:0 sc1
    v_lshrrev_b32 v215, 5, v1
    s_waitcnt lgkmcnt(3)
    v_mfma_f32_16x16x32_bf16 v[112:115], a[68:71], v[184:187], v[112:115]
    ds_read_b128 v[172:175], v198 offset:96
    v_mfma_f32_32x32x16_bf16 v[80:95], a[68:71], v[188:191], v[80:95]
    ds_read_b128 v[176:179], v197 offset:64
    v_lshl_add_u32 v205, v215, 10, v206
    v_bfe_u32 v215, v1, 4, 1
    v_lshl_add_u32 v205, v215, 3, v205
    v_lshlrev_b32_e64 v214, 2, v214
    v_mfma_f32_32x32x16_bf16 v[96:111], a[68:71], v[192:195], v[96:111]
    ds_read_b128 v[180:183], v197 offset:8768
    buffer_load_dwordx4 a[196:199], v58, s[16:19], s97 offen offset:1024 sc1
    v_lshl_add_u32 v214, v215, 10, v214
    s_lshl_b32 s32, s24, 6
    s_waitcnt lgkmcnt(3)
    v_mfma_f32_16x16x32_bf16 v[112:115], a[72:75], v[160:163], v[112:115]
    ds_read_b128 v[184:187], v198 offset:128
    v_mfma_f32_32x32x16_bf16 v[80:95], a[72:75], v[164:167], v[80:95]
    ds_read_b128 v[188:191], v196 offset:128
    v_lshl_add_u32 v207, v215, 3, s32
    v_and_b32 v215, 12, v1
    v_lshl_add_u32 v207, v215, 2, v207
    v_and_b32 v215, 2, v1
    v_mfma_f32_32x32x16_bf16 v[96:111], a[72:75], v[168:171], v[96:111]
    ds_read_b128 v[192:195], v196 offset:8832
    buffer_load_dwordx4 a[200:203], v58, s[16:19], s97 offen offset:2048 sc1
    v_lshl_add_u32 v207, v215, 1, v207
    v_add_u32 v207, 69120, v207
    s_waitcnt lgkmcnt(3)
    v_mfma_f32_16x16x32_bf16 v[112:115], a[76:79], v[172:175], v[112:115]
    ds_read_b128 v[160:163], v198 offset:160
    v_mfma_f32_32x32x16_bf16 v[80:95], a[76:79], v[176:179], v[80:95]
    ds_read_b128 v[164:167], v197 offset:128
    v_lshrrev_b32 v215, 4, v1
    v_lshl_add_u32 v206, v215, 2, v206
    v_mov_b32 v215, 0x3f803f80
    v_mfma_f32_32x32x16_bf16 v[96:111], a[76:79], v[180:183], v[96:111]
    ds_read_b128 v[168:171], v197 offset:8832
    buffer_load_dwordx4 a[204:207], v58, s[16:19], s97 offen offset:3072 sc1
    s_waitcnt lgkmcnt(3)
    v_mfma_f32_16x16x32_bf16 v[112:115], a[80:83], v[184:187], v[112:115]
    ds_read_b128 v[172:175], v198 offset:192
    v_mfma_f32_32x32x16_bf16 v[80:95], a[80:83], v[188:191], v[80:95]
    ds_read_b128 v[176:179], v196 offset:192
    v_mfma_f32_32x32x16_bf16 v[96:111], a[80:83], v[192:195], v[96:111]
    ds_read_b128 v[180:183], v196 offset:8896
    s_add_u32 s97, s97, 4096
    buffer_load_dwordx4 a[208:211], v58, s[16:19], s97 offen offset:0 sc1
    s_waitcnt lgkmcnt(3)
    v_mfma_f32_16x16x32_bf16 v[112:115], a[84:87], v[160:163], v[112:115]
    ds_read_b128 v[184:187], v198 offset:224
    v_mfma_f32_32x32x16_bf16 v[80:95], a[84:87], v[164:167], v[80:95]
    ds_read_b128 v[188:191], v197 offset:192
    v_mfma_f32_32x32x16_bf16 v[96:111], a[84:87], v[168:171], v[96:111]
    ds_read_b128 v[192:195], v197 offset:8896
    buffer_load_dwordx4 a[212:215], v58, s[16:19], s97 offen offset:1024 sc1
    s_waitcnt vmcnt(17)
    s_barrier
    s_waitcnt lgkmcnt(3)
    v_mfma_f32_16x16x32_bf16 v[112:115], a[88:91], v[172:175], v[112:115]
    v_add_u32 v198, v49, v198
    v_mfma_f32_32x32x16_bf16 v[80:95], a[88:91], v[176:179], v[80:95]
    v_add_u32 v196, 19584, v196
    v_add_u32 v197, 19584, v197
    ds_read_b128 v[160:163], v198 offset:0
    v_mfma_f32_32x32x16_bf16 v[96:111], a[88:91], v[180:183], v[96:111]
    ds_read_b128 v[164:167], v196 offset:0
    ds_read_b128 v[168:171], v196 offset:8704
    buffer_load_dwordx4 a[216:219], v58, s[16:19], s97 offen offset:2048 sc1
    s_waitcnt lgkmcnt(3)
    v_mfma_f32_16x16x32_bf16 v[112:115], a[92:95], v[184:187], v[112:115]
    ds_read_b128 v[172:175], v198 offset:32
    v_mfma_f32_32x32x16_bf16 v[80:95], a[92:95], v[188:191], v[80:95]
    ds_read_b128 v[176:179], v197 offset:0
    v_mfma_f32_32x32x16_bf16 v[96:111], a[92:95], v[192:195], v[96:111]
    ds_read_b128 v[180:183], v197 offset:8704
    buffer_load_dwordx4 a[220:223], v58, s[16:19], s97 offen offset:3072 sc1
    s_waitcnt lgkmcnt(3)
    v_mfma_f32_16x16x32_bf16 v[112:115], a[96:99], v[160:163], v[112:115]
    ds_read_b128 v[184:187], v198 offset:64
    v_mfma_f32_32x32x16_bf16 v[80:95], a[96:99], v[164:167], v[80:95]
    ds_read_b128 v[188:191], v196 offset:64
    v_mfma_f32_32x32x16_bf16 v[96:111], a[96:99], v[168:171], v[96:111]
    ds_read_b128 v[192:195], v196 offset:8768
    s_add_u32 s97, s97, 4096
    buffer_load_dwordx4 a[224:227], v58, s[16:19], s97 offen offset:0 sc1
    s_waitcnt lgkmcnt(3)
    v_mfma_f32_16x16x32_bf16 v[112:115], a[100:103], v[172:175], v[112:115]
    ds_read_b128 v[160:163], v198 offset:96
    v_mfma_f32_32x32x16_bf16 v[80:95], a[100:103], v[176:179], v[80:95]
    ds_read_b128 v[164:167], v197 offset:64
    v_mfma_f32_32x32x16_bf16 v[96:111], a[100:103], v[180:183], v[96:111]
    ds_read_b128 v[168:171], v197 offset:8768
    buffer_load_dwordx4 a[228:231], v58, s[16:19], s97 offen offset:1024 sc1
    s_waitcnt lgkmcnt(3)
    v_mfma_f32_16x16x32_bf16 v[112:115], a[104:107], v[184:187], v[112:115]
    ds_read_b128 v[172:175], v198 offset:128
    v_mfma_f32_32x32x16_bf16 v[80:95], a[104:107], v[188:191], v[80:95]
    ds_read_b128 v[176:179], v196 offset:128
    v_mfma_f32_32x32x16_bf16 v[96:111], a[104:107], v[192:195], v[96:111]
    ds_read_b128 v[180:183], v196 offset:8832
    buffer_load_dwordx4 a[232:235], v58, s[16:19], s97 offen offset:2048 sc1
    s_waitcnt lgkmcnt(3)
    v_mfma_f32_16x16x32_bf16 v[112:115], a[108:111], v[160:163], v[112:115]
    ds_read_b128 v[184:187], v198 offset:160
    v_mfma_f32_32x32x16_bf16 v[80:95], a[108:111], v[164:167], v[80:95]
    ds_read_b128 v[188:191], v197 offset:128
    v_mfma_f32_32x32x16_bf16 v[96:111], a[108:111], v[168:171], v[96:111]
    ds_read_b128 v[192:195], v197 offset:8832
    buffer_load_dwordx4 a[236:239], v58, s[16:19], s97 offen offset:3072 sc1
    s_waitcnt lgkmcnt(3)
    v_mfma_f32_16x16x32_bf16 v[112:115], a[112:115], v[172:175], v[112:115]
    ds_read_b128 v[160:163], v198 offset:192
    v_mfma_f32_32x32x16_bf16 v[80:95], a[112:115], v[176:179], v[80:95]
    ds_read_b128 v[164:167], v196 offset:192
    v_mfma_f32_32x32x16_bf16 v[96:111], a[112:115], v[180:183], v[96:111]
    ds_read_b128 v[168:171], v196 offset:8896
    s_add_u32 s97, s97, 4096
    buffer_load_dwordx4 a[240:243], v58, s[16:19], s97 offen offset:0 sc1
    s_waitcnt lgkmcnt(3)
    v_mfma_f32_16x16x32_bf16 v[112:115], a[116:119], v[184:187], v[112:115]
    ds_read_b128 v[172:175], v198 offset:224
    v_mfma_f32_32x32x16_bf16 v[80:95], a[116:119], v[188:191], v[80:95]
    ds_read_b128 v[176:179], v197 offset:192
    v_mfma_f32_32x32x16_bf16 v[96:111], a[116:119], v[192:195], v[96:111]
    ds_read_b128 v[180:183], v197 offset:8896
    buffer_load_dwordx4 a[244:247], v58, s[16:19], s97 offen offset:1024 sc1
    s_waitcnt vmcnt(20)
    s_barrier
    s_waitcnt lgkmcnt(3)
    v_mfma_f32_16x16x32_bf16 v[112:115], a[120:123], v[160:163], v[112:115]
    v_add_u32_e64 v198, v49, v198
    v_mfma_f32_32x32x16_bf16 v[80:95], a[120:123], v[164:167], v[80:95]
    v_add_u32 v196, 19584, v196
    v_add_u32 v197, 19584, v197
    s_waitcnt vmcnt(17)
    v_mul_f32 v148, v24, v157
    v_mul_f32 v149, v25, v157
    v_mul_f32 v150, v26, v157
    v_mfma_f32_32x32x16_bf16 v[96:111], a[120:123], v[168:171], v[96:111]
    ds_read_b128 v[184:187], v198 offset:0
    ds_read_b128 v[188:191], v196 offset:0
    buffer_load_dwordx4 a[248:251], v58, s[16:19], s97 offen offset:2048 sc1
    v_mul_f32 v151, v27, v157
    v_mul_f32_e64 v116, v8, v153
    s_waitcnt lgkmcnt(2)
    v_mfma_f32_16x16x32_bf16 v[112:115], a[124:127], v[172:175], v[112:115]
    ds_read_b128 v[192:195], v198 offset:32
    v_mfma_f32_32x32x16_bf16 v[80:95], a[124:127], v[176:179], v[80:95]
    ds_read_b128 v[160:163], v197 offset:0
    v_mul_f32 v117, v9, v153
    v_mul_f32 v118, v10, v153
    v_mul_f32 v119, v11, v153
    v_mul_f32 v120, v12, v153
    v_mfma_f32_32x32x16_bf16 v[96:111], a[124:127], v[180:183], v[96:111]
    buffer_load_dwordx4 a[252:255], v58, s[16:19], s97 offen offset:3072 sc1
    v_mul_f32 v121, v13, v153
    v_mul_f32 v122, v14, v153
    v_mul_f32 v123, v15, v153
    s_waitcnt lgkmcnt(2)
    v_mfma_f32_16x16x32_bf16 v[112:115], a[128:131], v[184:187], v[112:115]
    ds_read_b128 v[164:167], v198 offset:64
    v_mfma_f32_32x32x16_bf16 v[80:95], a[128:131], v[188:191], v[80:95]
    ds_read_b128 v[168:171], v196 offset:64
    v_mul_f32 v124, v16, v153
    v_mul_f32 v125, v17, v153
    v_mul_f32 v126, v18, v153
    s_waitcnt lgkmcnt(2)
    v_mfma_f32_16x16x32_bf16 v[112:115], a[132:135], v[192:195], v[112:115]
    ds_read_b128 v[172:175], v198 offset:96
    v_mfma_f32_32x32x16_bf16 v[80:95], a[132:135], v[160:163], v[80:95]
    ds_read_b128 v[176:179], v197 offset:64
    s_add_u32 s97, s97, 4096
    buffer_load_dwordx4 v[52:55], v58, s[16:19], s97 offen offset:0 sc1
    v_mul_f32 v127, v19, v153
    v_mul_f32_e64 v128, v20, v153
    s_waitcnt lgkmcnt(2)
    v_mfma_f32_16x16x32_bf16 v[112:115], a[136:139], v[164:167], v[112:115]
    ds_read_b128 v[180:183], v198 offset:128
    v_mfma_f32_32x32x16_bf16 v[80:95], a[136:139], v[168:171], v[80:95]
    ds_read_b128 v[184:187], v196 offset:128
    v_mul_f32 v129, v21, v153
    v_mul_f32 v130, v22, v153
    v_mul_f32 v131, v23, v153
    s_waitcnt lgkmcnt(2)
    v_mfma_f32_16x16x32_bf16 v[112:115], a[140:143], v[172:175], v[112:115]
    ds_read_b128 v[188:191], v198 offset:160
    v_mfma_f32_32x32x16_bf16 v[80:95], a[140:143], v[176:179], v[80:95]
    ds_read_b128 v[192:195], v197 offset:128
    s_mov_b32 s96, 4194304
    buffer_load_dwordx4 v[216:219], v56, s[16:19], s96 offen offset:0 sc1
    v_mul_f32 v132, v8, v155
    v_mul_f32_e64 v133, v9, v155
    s_waitcnt lgkmcnt(2)
    v_mfma_f32_16x16x32_bf16 v[112:115], a[144:147], v[180:183], v[112:115]
    ds_read_b128 v[160:163], v198 offset:192
    v_mfma_f32_32x32x16_bf16 v[80:95], a[144:147], v[184:187], v[80:95]
    ds_read_b128 v[164:167], v196 offset:192
    v_mul_f32 v134, v10, v155
    v_mul_f32 v135, v11, v155
    v_mul_f32 v136, v12, v155
    s_waitcnt lgkmcnt(2)
    v_mfma_f32_16x16x32_bf16 v[112:115], a[148:151], v[188:191], v[112:115]
    ds_read_b128 v[168:171], v198 offset:224
    v_mfma_f32_32x32x16_bf16 v[80:95], a[148:151], v[192:195], v[80:95]
    ds_read_b128 v[172:175], v197 offset:192
    buffer_load_dwordx4 v[220:223], v56, s[16:19], s96 offen offset:256 sc1
    v_mul_f32 v137, v13, v155
    v_mul_f32_e64 v138, v14, v155
    s_waitcnt lgkmcnt(2)
    v_mfma_f32_16x16x32_bf16 v[112:115], a[152:155], v[160:163], v[112:115]
    ds_read_b128 v[176:179], v196 offset:8704
    v_mfma_f32_32x32x16_bf16 v[80:95], a[152:155], v[164:167], v[80:95]
    ds_read_b128 v[180:183], v197 offset:8704
    v_mul_f32 v139, v15, v155
    v_mul_f32 v140, v16, v155
    v_mul_f32 v141, v17, v155
    s_waitcnt lgkmcnt(2)
    v_mfma_f32_16x16x32_bf16 v[112:115], a[156:159], v[168:171], v[112:115]
    ds_read_b128 v[184:187], v196 offset:8768
    v_mfma_f32_32x32x16_bf16 v[80:95], a[156:159], v[172:175], v[80:95]
    ds_read_b128 v[188:191], v197 offset:8768
    s_mov_b32 s96, 4227072
    buffer_load_dwordx4 v[224:227], v56, s[16:19], s96 offen offset:0 sc1
    v_mul_f32 v142, v18, v155
    v_mul_f32 v143, v19, v155
    v_mul_f32 v144, v20, v155
    v_mul_f32 v145, v21, v155
    v_mul_f32 v146, v22, v155
    v_mul_f32_e64 v147, v23, v155
    s_waitcnt lgkmcnt(2)
    v_mfma_f32_32x32x16_bf16 v[96:111], a[128:131], v[176:179], v[96:111]
    ds_read_b128 v[192:195], v196 offset:8832
    v_mfma_f32_32x32x16_bf16 v[96:111], a[132:135], v[180:183], v[96:111]
    ds_read_b128 v[160:163], v197 offset:8832
    buffer_load_dwordx4 v[228:231], v56, s[16:19], s96 offen offset:256 sc1
    v_fma_f32 v112, v112, v156, v148
    v_fma_f32 v113, v113, v156, v149
    s_waitcnt lgkmcnt(2)
    v_mfma_f32_32x32x16_bf16 v[96:111], a[136:139], v[184:187], v[96:111]
    ds_read_b128 v[164:167], v196 offset:8896
    v_fma_f32 v114, v114, v156, v150
    v_fma_f32 v115, v115, v156, v151
    v_cvt_pk_bf16_f32 v112, v112, v113
    v_cvt_pk_bf16_f32 v113, v114, v115
    v_mfma_f32_32x32x16_bf16 v[96:111], a[140:143], v[188:191], v[96:111]
    ds_read_b128 v[168:171], v197 offset:8896
    s_mov_b32 s96, 4259840
    buffer_load_dwordx4 v[232:235], v56, s[16:19], s96 offen offset:0 sc1
    v_fma_f32 v80, v80, v152, v116
    v_fma_f32 v81, v81, v152, v117
    s_waitcnt lgkmcnt(2)
    v_mfma_f32_32x32x16_bf16 v[96:111], a[144:147], v[192:195], v[96:111]
    v_fma_f32 v82, v82, v152, v118
    v_fma_f32 v83, v83, v152, v119
    v_cvt_pk_bf16_f32 v80, v80, v81
    v_cvt_pk_bf16_f32 v81, v82, v83
    ds_write_b64 v40, v[112:113] offset:0
    v_mfma_f32_32x32x16_bf16 v[96:111], a[148:151], v[160:163], v[96:111]
    ds_write_b64 v38, v[80:81] offset:0
    v_fma_f32 v84, v84, v152, v120
    v_fma_f32 v85, v85, v152, v121
    v_fma_f32 v86, v86, v152, v122
    s_waitcnt lgkmcnt(2)
    v_mfma_f32_32x32x16_bf16 v[96:111], a[152:155], v[164:167], v[96:111]
    v_fma_f32 v87, v87, v152, v123
    v_cvt_pk_bf16_f32 v84, v84, v85
    v_cvt_pk_bf16_f32 v85, v86, v87
    v_fma_f32 v88, v88, v152, v124
    v_fma_f32 v89, v89, v152, v125
    v_mfma_f32_32x32x16_bf16 v[96:111], a[156:159], v[168:171], v[96:111]
    buffer_load_dwordx4 v[236:239], v56, s[16:19], s96 offen offset:256 sc1
    v_fma_f32 v90, v90, v152, v126
    v_fma_f32 v91, v91, v152, v127
    v_cvt_pk_bf16_f32 v88, v88, v89
    v_cvt_pk_bf16_f32 v89, v90, v91
    ds_write_b64 v38, v[84:85] offset:6400
    ds_write_b64 v38, v[88:89] offset:12800
    v_fma_f32 v92, v92, v152, v128
    v_fma_f32 v93, v93, v152, v129
    v_fma_f32 v94, v94, v152, v130
    v_fma_f32 v95, v95, v152, v131
    v_cvt_pk_bf16_f32 v92, v92, v93
    v_cvt_pk_bf16_f32 v93, v94, v95
    ds_write_b64 v39, v[92:93] offset:0
    v_pk_fma_f32 v[96:97], v[96:97], v[154:155], v[132:133] op_sel_hi:[1,0,1]
    v_pk_fma_f32 v[98:99], v[98:99], v[154:155], v[134:135] op_sel_hi:[1,0,1]
    v_cvt_pk_bf16_f32 v96, v96, v97
    v_cvt_pk_bf16_f32 v97, v98, v99
    v_pk_fma_f32 v[100:101], v[100:101], v[154:155], v[136:137] op_sel_hi:[1,0,1]
    v_pk_fma_f32 v[102:103], v[102:103], v[154:155], v[138:139] op_sel_hi:[1,0,1]
    v_cvt_pk_bf16_f32 v100, v100, v101
    v_cvt_pk_bf16_f32 v101, v102, v103
    ds_write_b64 v38, v[96:97] offset:1600
    ds_write_b64 v38, v[100:101] offset:8000
    v_pk_fma_f32 v[104:105], v[104:105], v[154:155], v[140:141] op_sel_hi:[1,0,1]
    v_pk_fma_f32 v[106:107], v[106:107], v[154:155], v[142:143] op_sel_hi:[1,0,1]
    v_cvt_pk_bf16_f32 v104, v104, v105
    v_cvt_pk_bf16_f32 v105, v106, v107
    v_pk_fma_f32 v[108:109], v[108:109], v[154:155], v[144:145] op_sel_hi:[1,0,1]
    v_pk_fma_f32 v[110:111], v[110:111], v[154:155], v[146:147] op_sel_hi:[1,0,1]
    v_cvt_pk_bf16_f32 v108, v108, v109
    v_cvt_pk_bf16_f32 v109, v110, v111
    ds_write_b64 v38, v[104:105] offset:14400
    ds_write_b64 v39, v[108:109] offset:1600
    s_waitcnt lgkmcnt(0)
    s_barrier
    v_mov_b32 v94, 0
    v_mov_b32 v95, 0
    v_mov_b32 v98, 0
    v_mov_b32_e64 v99, 0
    s_mov_b64 exec, 0xffff
    ds_read_b64 v[94:95], v42 offset:320
    ds_read_b64 v[98:99], v42 offset:640
    s_mov_b64 exec, -1
    s_nop 0
    ds_read_b64 v[92:93], v41 offset:320
    ds_read_b64 v[96:97], v41 offset:640
    ds_read_b64 v[84:85], v41 offset:6720
    ds_read_b64 v[86:87], v42 offset:6720
    ds_read_b64 v[80:81], v41 offset:6400
    ds_read_b64 v[82:83], v42 offset:6400
    ds_read_b64 v[88:89], v41 offset:7040
    ds_read_b64 v[90:91], v42 offset:7040
    ds_read_b64_tr_b16 v[106:107], v44 offset:0
    ds_read_b64_tr_b16 v[100:101], v43 offset:0
    ds_read_b64_tr_b16 v[108:109], v44 offset:320
    ds_read_b64_tr_b16 v[102:103], v43 offset:320
    s_mov_b32 s96, 4292608
    buffer_load_dwordx4 v[240:243], v56, s[16:19], s96 offen offset:0 sc1
    ds_read_b64_tr_b16 v[110:111], v44 offset:640
    ds_read_b64_tr_b16 v[104:105], v43 offset:640
    s_mov_b32 s82, 0x3ea52b5c
    s_lshl_b32 s25, s98, 4
    s_add_u32 s25, s25, 4194304
    s_lshl_b32 s26, s98, 3
    s_add_u32 s26, s26, 4194304
    s_waitcnt lgkmcnt(10)
    v_mfma_f32_16x16x32_bf16 v[116:119], v[84:87], v[92:95], v[28:31]
    buffer_load_dwordx4 v[244:247], v56, s[16:19], s96 offen offset:256 sc1
    v_mfma_f32_16x16x32_bf16 v[120:123], v[84:87], v[96:99], v[32:35]
    s_waitcnt lgkmcnt(8)
    v_mfma_f32_16x16x32_bf16 v[112:115], v[80:83], v[92:95], v[32:35]
    s_waitcnt lgkmcnt(6)
    v_mfma_f32_16x16x32_bf16 v[124:127], v[88:91], v[96:99], v[28:31]
    s_nop 5
    v_max_f32 v112, v112, v116
    v_max_f32 v113, v113, v117
    v_max_f32 v114, v114, v118
    v_max_f32 v115, v115, v119
    v_max3_f32 v156, v112, v113, v114
    s_mov_b32 s96, 4194304
    buffer_load_dwordx2 v[248:249], v57, s[16:19], s96 offen offset:0 sc1
    v_max_f32 v156, v156, v115
    v_max_f32 v120, v120, v124
    v_max_f32 v121, v121, v125
    v_max_f32 v122, v122, v126
    v_max_f32 v123, v123, v127
    v_max3_f32 v157, v120, v121, v122
    v_max_f32 v157, v157, v123
    s_nop 1
    v_permlane16_swap_b32 v156, v157
    buffer_load_dwordx2 v[252:253], v57, s[16:19], s96 offen offset:128 sc1
    v_max_f32 v156, v156, v157
    v_mov_b32 v157, v156
    s_nop 1
    v_permlane32_swap_b32 v156, v157
    v_max_f32 v156, v156, v157
    v_mul_f32 v156, s82, v156
    v_mov_b32 v157, v156
    s_nop 1
    v_permlane16_swap_b32_e64 v156, v157
    v_fma_f32 v112, v112, s82, -v156
    s_mov_b32 s96, 4210688
    buffer_load_dwordx2 v[250:251], v57, s[16:19], s96 offen offset:0 sc1
    v_fma_f32 v113, v113, s82, -v156
    v_fma_f32 v114, v114, s82, -v156
    v_fma_f32 v115, v115, s82, -v156
    v_exp_f32 v112, v112
    v_exp_f32 v113, v113
    v_exp_f32 v114, v114
    v_exp_f32 v115, v115
    v_cvt_pk_bf16_f32 v116, v112, v113
    buffer_load_dwordx2 v[254:255], v57, s[16:19], s96 offen offset:128 sc1
    v_cvt_pk_bf16_f32 v117, v114, v115
    v_bfi_b32 v128, v36, 0, v116
    v_and_b32 v130, v36, v116
    v_bfi_b32 v129, v37, 0, v117
    v_and_b32 v131, v37, v117
    s_waitcnt lgkmcnt(3)
    s_nop 0
    v_mfma_f32_16x16x32_bf16 v[144:147], v[106:109], v[128:131], 0
    s_waitcnt lgkmcnt(2)
    v_mfma_f32_16x16x32_bf16 v[136:139], v[100:103], v[128:131], 0
    v_fma_f32 v120, v120, s82, -v157
    s_mov_b32 s96, 0
    s_mov_b32 s97, 5120
    buffer_load_dwordx2 v[208:209], v60, s[4:7], s96 offen
    v_fma_f32 v121, v121, s82, -v157
    v_fma_f32 v122, v122, s82, -v157
    v_fma_f32 v123, v123, s82, -v157
    v_exp_f32 v120, v120
    v_exp_f32 v121, v121
    v_exp_f32 v122, v122
    v_exp_f32 v123, v123
    v_cvt_pk_bf16_f32 v124, v120, v121
    buffer_load_dwordx2 v[210:211], v60, s[4:7], s97 offen
    v_cvt_pk_bf16_f32 v125, v122, v123
    v_bfi_b32 v132, v36, 0, v124
    v_and_b32 v134, v36, v124
    v_bfi_b32 v133, v37, 0, v125
    v_and_b32 v135, v37, v125
    s_waitcnt lgkmcnt(1)
    s_nop 0
    v_mfma_f32_16x16x32_bf16 v[148:151], v[108:111], v[132:135], 0
    s_waitcnt lgkmcnt(0)
    v_mfma_f32_16x16x32_bf16 v[140:143], v[102:105], v[132:135], 0
    v_mov_b32 v158, v144
    v_lshrrev_b32_e64 v212, 5, v1
    v_mul_u32_u24 v212, 5104, v212
    v_bfe_u32 v213, v1, 4, 1
    v_lshlrev_b32 v213, 2, v213
    v_sub_u32 v212, v212, v213
    v_add_u32 v212, v212, v60
    s_mul_i32 s97, s24, 24
    s_sub_u32 s97, 128, s97
    buffer_load_dword v212, v212, s[4:7], s97 offen
    v_permlane16_swap_b32 v144, v158
    v_rcp_f32_e64 v158, v158
    s_nop 0
    v_pk_mul_f32 v[136:137], v[136:137], v[158:159] op_sel_hi:[1,0]
    v_pk_mul_f32 v[138:139], v[138:139], v[158:159] op_sel_hi:[1,0]
    v_pk_mul_f32 v[144:145], v[144:145], v[158:159] op_sel_hi:[1,0]
    v_pk_mul_f32 v[146:147], v[146:147], v[158:159] op_sel_hi:[1,0]
    v_cvt_pk_bf16_f32 v112, v136, v137
    v_cvt_pk_bf16_f32 v116, v144, v145
    v_cvt_pk_bf16_f32 v113, v138, v139
    v_cvt_pk_bf16_f32 v117, v146, v147
    v_mov_b32 v160, v148
    s_nop 1
    v_permlane16_swap_b32 v148, v160
    v_rcp_f32_e64 v160, v160
    s_nop 0
    v_pk_mul_f32 v[140:141], v[140:141], v[160:161] op_sel_hi:[1,0]
    v_pk_mul_f32 v[142:143], v[142:143], v[160:161] op_sel_hi:[1,0]
    v_pk_mul_f32 v[148:149], v[148:149], v[160:161] op_sel_hi:[1,0]
    v_pk_mul_f32 v[150:151], v[150:151], v[160:161] op_sel_hi:[1,0]
    v_cvt_pk_bf16_f32 v114, v140, v141
    v_cvt_pk_bf16_f32 v118, v148, v149
    v_cvt_pk_bf16_f32 v115, v142, v143
    v_cvt_pk_bf16_f32 v119, v150, v151
    v_permlane16_swap_b32 v112, v114
    v_permlane16_swap_b32 v113, v115
    v_permlane16_swap_b32 v116, v118
    v_permlane16_swap_b32 v117, v119
    buffer_store_dwordx4 v[112:115], v45, s[16:19], s25 offen sc1
    s_mov_b64 exec, s[80:81]
    buffer_store_dwordx2 v[116:117], v46, s[16:19], s26 offen sc1
    s_mov_b64 exec, -1
oe_20:
    s_waitcnt vmcnt(16)
    v_mfma_f32_16x16x32_bf16 v[112:115], a[176:179], v[216:219], 0
    v_mov_b32 v136, 0
    v_mov_b32 v137, 0
    s_waitcnt vmcnt(15)
    v_mfma_f32_16x16x32_bf16 v[116:119], a[176:179], v[220:223], 0
    v_mov_b32 v138, 0
    v_mov_b32 v139, 0
    s_waitcnt vmcnt(14)
    v_mfma_f32_16x16x32_bf16 v[112:115], a[196:199], v[224:227], v[112:115]
    v_mov_b32 v140, 0
    v_mov_b32 v141, 0
    s_waitcnt vmcnt(13)
    v_mfma_f32_16x16x32_bf16 v[116:119], a[196:199], v[228:231], v[116:119]
    s_mov_b32 s25, 6815744
    s_add_u32 s26, s36, 6815744
    s_waitcnt vmcnt(12)
    v_mfma_f32_16x16x32_bf16 v[112:115], a[216:219], v[232:235], v[112:115]
    s_add_u32 s27, s35, 3473408
    s_mov_b32 s28, 0x99999999
    s_waitcnt vmcnt(11)
    v_mfma_f32_16x16x32_bf16 v[116:119], a[216:219], v[236:239], v[116:119]
    s_mov_b32 s29, 0x99999999
    s_waitcnt vmcnt(10)
    v_mfma_f32_16x16x32_bf16 v[112:115], a[236:239], v[240:243], v[112:115]
    s_waitcnt vmcnt(9)
    v_mfma_f32_16x16x32_bf16 v[116:119], a[236:239], v[244:247], v[116:119]
    s_waitcnt vmcnt(6)
    v_mfma_f32_16x16x32_bf16 v[112:115], v[52:55], v[248:251], v[112:115]
    s_waitcnt vmcnt(5)
    v_mfma_f32_16x16x32_bf16 v[116:119], v[52:55], v[252:255], v[116:119]
    v_mfma_f32_16x16x32_bf16 v[88:91], a[164:167], v[216:219], 0
    v_mfma_f32_16x16x32_bf16 v[92:95], a[164:167], v[220:223], 0
    v_mfma_f32_16x16x32_bf16 v[88:91], a[184:187], v[224:227], v[88:91]
    v_mfma_f32_16x16x32_bf16 v[92:95], a[184:187], v[228:231], v[92:95]
    v_mfma_f32_16x16x32_bf16 v[88:91], a[204:207], v[232:235], v[88:91]
    v_mfma_f32_16x16x32_bf16 v[92:95], a[204:207], v[236:239], v[92:95]
    s_nop 1
    v_cmp_u_f32 vcc, v112, v116
    s_nop 0
    s_cbranch_vccnz rd_21
rc_22:
    v_mfma_f32_16x16x32_bf16 v[88:91], a[224:227], v[240:243], v[88:91]
    ds_write_b128 v203, v[112:115] offset:24576
    v_mfma_f32_16x16x32_bf16 v[92:95], a[224:227], v[244:247], v[92:95]
    v_mfma_f32_16x16x32_bf16 v[88:91], a[244:247], v[248:251], v[88:91]
    ds_write_b128 v203, v[116:119] offset:25600
    v_mfma_f32_16x16x32_bf16 v[92:95], a[244:247], v[252:255], v[92:95]
    v_mfma_f32_16x16x32_bf16 v[96:99], a[168:171], v[216:219], 0
    s_waitcnt vmcnt(4)
    v_lshlrev_b32 v120, 16, v208
    v_and_b32 v121, 0xffff0000, v208
    v_mfma_f32_16x16x32_bf16 v[100:103], a[168:171], v[220:223], 0
    v_lshlrev_b32_e64 v122, 16, v209
    v_and_b32 v123, 0xffff0000, v209
    v_mfma_f32_16x16x32_bf16 v[96:99], a[188:191], v[224:227], v[96:99]
    s_waitcnt vmcnt(3)
    v_lshlrev_b32 v124, 16, v210
    v_and_b32 v125, 0xffff0000, v210
    v_mfma_f32_16x16x32_bf16 v[100:103], a[188:191], v[228:231], v[100:103]
    v_lshlrev_b32_e64 v126, 16, v211
    v_and_b32 v127, 0xffff0000, v211
    v_mfma_f32_16x16x32_bf16 v[96:99], a[208:211], v[232:235], v[96:99]
    s_waitcnt vmcnt(2)
    v_lshlrev_b32 v128, 16, v212
    v_and_b32 v129, 0xffff0000, v212
    v_mfma_f32_16x16x32_bf16 v[100:103], a[208:211], v[236:239], v[100:103]
    v_mfma_f32_16x16x32_bf16 v[96:99], a[228:231], v[240:243], v[96:99]
    ds_write_b128 v200, v[88:91] offset:0
    v_mfma_f32_16x16x32_bf16 v[100:103], a[228:231], v[244:247], v[100:103]
    v_mfma_f32_16x16x32_bf16 v[96:99], a[248:251], v[248:251], v[96:99]
    ds_write_b128 v200, v[92:95] offset:1024
    v_mfma_f32_16x16x32_bf16 v[100:103], a[248:251], v[252:255], v[100:103]
    v_mfma_f32_16x16x32_bf16 v[104:107], a[172:175], v[216:219], 0
    v_mfma_f32_16x16x32_bf16 v[108:111], a[172:175], v[220:223], 0
    v_mfma_f32_16x16x32_bf16 v[104:107], a[192:195], v[224:227], v[104:107]
    v_mfma_f32_16x16x32_bf16 v[108:111], a[192:195], v[228:231], v[108:111]
    v_mfma_f32_16x16x32_bf16 v[104:107], a[212:215], v[232:235], v[104:107]
    v_mfma_f32_16x16x32_bf16 v[108:111], a[212:215], v[236:239], v[108:111]
    v_mfma_f32_16x16x32_bf16 v[104:107], a[232:235], v[240:243], v[104:107]
    ds_write_b128 v201, v[96:99] offset:2048
    v_mfma_f32_16x16x32_bf16 v[108:111], a[232:235], v[244:247], v[108:111]
    v_mfma_f32_16x16x32_bf16 v[104:107], a[252:255], v[248:251], v[104:107]
    ds_write_b128 v201, v[100:103] offset:3072
    v_mfma_f32_16x16x32_bf16 v[108:111], a[252:255], v[252:255], v[108:111]
    v_mfma_f32_16x16x32_bf16 v[80:83], a[160:163], v[216:219], v[120:123]
    v_mfma_f32_16x16x32_bf16 v[84:87], a[160:163], v[220:223], v[124:127]
    v_mfma_f32_16x16x32_bf16 v[80:83], a[180:183], v[224:227], v[80:83]
    v_mfma_f32_16x16x32_bf16 v[84:87], a[180:183], v[228:231], v[84:87]
    v_mfma_f32_16x16x32_bf16 v[80:83], a[200:203], v[232:235], v[80:83]
    s_nop 0
    ds_write_b128 v202, v[104:107] offset:4096
    v_mfma_f32_16x16x32_bf16 v[84:87], a[200:203], v[236:239], v[84:87]
    ds_write_b128 v202, v[108:111] offset:5120
    v_mfma_f32_16x16x32_bf16 v[80:83], a[220:223], v[240:243], v[80:83]
    v_mfma_f32_16x16x32_bf16 v[84:87], a[220:223], v[244:247], v[84:87]
    v_mfma_f32_16x16x32_bf16 v[80:83], a[240:243], v[248:251], v[80:83]
    v_mfma_f32_16x16x32_bf16 v[84:87], a[240:243], v[252:255], v[84:87]
    s_waitcnt lgkmcnt(0)
    s_barrier
    s_nop 0
    ds_read_b128 v[88:91], v204 offset:0
    ds_read_b128 v[92:95], v204 offset:1024
    ds_read_b128 v[96:99], v204 offset:2048
    ds_read_b128 v[100:103], v204 offset:3072
    ds_read_b128 v[104:107], v204 offset:4096
    ds_read_b128 v[108:111], v204 offset:5120
    ds_read_b64 v[112:113], v205 offset:24576
    ds_read_b64 v[114:115], v205 offset:26624
    ds_read_b64 v[116:117], v205 offset:28672
    ds_read_b64 v[118:119], v205 offset:30720
    s_mov_b32 s96, 4198400
    buffer_load_dwordx4 v[216:219], v56, s[16:19], s96 offen offset:0 sc1
    buffer_load_dwordx4 v[220:223], v56, s[16:19], s96 offen offset:256 sc1
    s_mov_b32 s96, 4231168
    buffer_load_dwordx4 v[224:227], v56, s[16:19], s96 offen offset:0 sc1
    buffer_load_dwordx4 v[228:231], v56, s[16:19], s96 offen offset:256 sc1
    s_mov_b32 s96, 4263936
    buffer_load_dwordx4 v[232:235], v56, s[16:19], s96 offen offset:0 sc1
    buffer_load_dwordx4 v[236:239], v56, s[16:19], s96 offen offset:256 sc1
    s_waitcnt lgkmcnt(9)
    v_pk_add_f32 v[80:81], v[80:81], v[88:89]
    v_pk_add_f32 v[82:83], v[82:83], v[90:91]
    s_waitcnt lgkmcnt(8)
    v_pk_add_f32 v[84:85], v[84:85], v[92:93]
    v_pk_add_f32 v[86:87], v[86:87], v[94:95]
    s_waitcnt lgkmcnt(7)
    v_pk_add_f32 v[80:81], v[80:81], v[96:97]
    v_pk_add_f32 v[82:83], v[82:83], v[98:99]
    s_waitcnt lgkmcnt(6)
    v_pk_add_f32 v[84:85], v[84:85], v[100:101]
    v_pk_add_f32 v[86:87], v[86:87], v[102:103]
    s_waitcnt lgkmcnt(5)
    v_pk_add_f32 v[80:81], v[80:81], v[104:105]
    v_pk_add_f32 v[82:83], v[82:83], v[106:107]
    s_waitcnt lgkmcnt(4)
    v_pk_add_f32 v[84:85], v[84:85], v[108:109]
    v_pk_add_f32 v[86:87], v[86:87], v[110:111]
    v_cvt_pk_bf16_f32 v132, v80, v81
    v_cvt_pk_bf16_f32 v133, v82, v83
    v_cvt_pk_bf16_f32 v134, v84, v85
    v_cvt_pk_bf16_f32 v135, v86, v87
    s_waitcnt lgkmcnt(3)
    v_pk_add_f32 v[128:129], v[128:129], v[112:113]
    s_waitcnt lgkmcnt(2)
    v_pk_add_f32 v[128:129], v[128:129], v[114:115]
    s_waitcnt lgkmcnt(1)
    v_pk_add_f32 v[128:129], v[128:129], v[116:117]
    s_waitcnt lgkmcnt(0)
    v_pk_add_f32 v[128:129], v[128:129], v[118:119]
    v_cvt_pk_bf16_f32 v130, v128, v129
    buffer_store_dwordx4 v[132:135], v59, s[16:19], s25 offen sc1
    buffer_store_dword v130, v61, s[16:19], s26 offen sc1
    v_dot2c_f32_bf16 v136, v132, v215
    v_dot2c_f32_bf16 v137, v132, v132
    v_dot2c_f32_bf16 v136, v133, v215
    v_dot2c_f32_bf16 v137, v133, v133
    v_dot2c_f32_bf16 v138, v134, v215
    v_dot2c_f32_bf16 v139, v134, v134
    v_dot2c_f32_bf16 v138, v135, v215
    v_dot2c_f32_bf16 v139, v135, v135
    v_dot2c_f32_bf16 v140, v130, v215
    v_dot2c_f32_bf16 v141, v130, v130
    v_permlane32_swap_b32 v136, v138
    v_permlane32_swap_b32 v137, v139
    v_pk_add_f32 v[136:137], v[136:137], v[138:139]
    v_pk_add_f32 v[136:137], v[136:137], v[140:141]
    s_nop 1
    v_permlane16_swap_b32 v136, v137
    v_add_f32_e64 v136, v136, v137
    ds_write_b32 v206, v136 offset:32768
    s_mov_b32 s96, 4296704
    buffer_load_dwordx4 v[240:243], v56, s[16:19], s96 offen offset:0 sc1
    buffer_load_dwordx4 v[244:247], v56, s[16:19], s96 offen offset:256 sc1
    s_mov_b32 s96, 4196352
    buffer_load_dwordx2 v[248:249], v57, s[16:19], s96 offen offset:0 sc1
    buffer_load_dwordx2 v[252:253], v57, s[16:19], s96 offen offset:128 sc1
    s_mov_b32 s96, 4212736
    buffer_load_dwordx2 v[250:251], v57, s[16:19], s96 offen offset:0 sc1
    buffer_load_dwordx2 v[254:255], v57, s[16:19], s96 offen offset:128 sc1
    s_mov_b32 s96, 1310720
    s_mov_b32 s97, 1315840
    buffer_load_dwordx2 v[208:209], v60, s[4:7], s96 offen
    buffer_load_dwordx2 v[210:211], v60, s[4:7], s97 offen
    v_lshrrev_b32_e64 v212, 5, v1
    v_mul_u32_u24 v212, 5104, v212
    v_bfe_u32 v213, v1, 4, 1
    v_lshlrev_b32 v213, 2, v213
    v_sub_u32 v212, v212, v213
    v_add_u32 v212, v212, v60
    s_mul_i32 s97, s24, 24
    s_sub_u32 s97, 1310848, s97
    buffer_load_dword v212, v212, s[4:7], s97 offen
    s_waitcnt lgkmcnt(0)
    s_barrier
    ds_read2st64_b32 v[136:137], v207 offset0:0 offset1:1
    ds_read2st64_b32 v[138:139], v207 offset0:2 offset1:3
    ds_read_b64_tr_b16 v[144:145], v65 offset:32
    ds_read_b64_tr_b16 v[146:147], v65 offset:0
    ds_read_b64_tr_b16 v[148:149], v65 offset:160
    ds_read_b64_tr_b16 v[150:151], v65 offset:128
    ds_read_b64_tr_b16 v[152:153], v65 offset:288
    ds_read_b64_tr_b16 v[154:155], v65 offset:256
    ds_read_b64_tr_b16 v[156:157], v65 offset:416
    ds_read_b64_tr_b16 v[158:159], v65 offset:384
    ds_read_b64_tr_b16 v[160:161], v65 offset:544
    ds_read_b64_tr_b16 v[162:163], v65 offset:512
    ds_read_b64_tr_b16 v[164:165], v65 offset:672
    ds_read_b64_tr_b16 v[166:167], v65 offset:640
    ds_read_b64_tr_b16 v[168:169], v65 offset:800
    ds_read_b64_tr_b16 v[170:171], v65 offset:768
    ds_read_b64_tr_b16 v[172:173], v65 offset:928
    ds_read_b64_tr_b16 v[174:175], v65 offset:896
    s_waitcnt lgkmcnt(15)
    v_pk_add_f32 v[136:137], v[136:137], v[138:139]
    v_add_f32 v136, v136, v137
    v_cndmask_b32 v136, v136, 1.0, s[28:29]
    s_mov_b64 exec, s[80:81]
    buffer_atomic_add_f32 v136, v214, s[16:19], s27 offen sc1
    s_mov_b64 exec, -1
    v_lshrrev_b32 v176, 4, v0
    v_mul_u32_u24 v176, 1216, v176
    v_and_b32 v177, 15, v0
    v_lshl_add_u32 v176, v177, 3, v176
    v_add_u32 v176, 64, v176
    v_mov_b32 v178, 0
    v_mov_b32 v179, 0
    ds_write_b64 v176, v[178:179]
    v_mov_b32 v70, 0
    v_mov_b32 v71, 0
    v_mov_b32 v72, 0
    s_lshl_b32 s25, s24, 17
    v_lshrrev_b32 v176, 5, v1
    v_lshl_add_u32 v176, v176, 14, s25
    v_bfe_u32 v177, v1, 4, 1
    v_lshl_add_u32 v176, v177, 13, v176
    v_and_b32_e64 v177, 15, v1
    v_lshl_add_u32 v73, v177, 4, v176
    v_bfe_u32 v176, v1, 2, 3
    v_lshl_add_u32 v176, v176, 14, s25
    v_bfe_u32 v177, v1, 1, 1
    v_lshl_add_u32 v176, v177, 13, v176
    v_and_b32 v177, 1, v1
    v_lshl_add_u32 v77, v177, 4, v176
    v_lshrrev_b32 v177, 5, v1
    v_and_b32 v176, 31, v1
    v_lshlrev_b32 v176, 3, v176
    v_lshl_add_u32 v78, v177, 10, v176
    v_and_b32 v176, 7, v1
    v_lshlrev_b32 v176, 3, v176
    v_lshl_add_u32 v178, v177, 7, v176
    v_add_u32 v74, 31744, v73
    v_add_u32 v75, 63488, v73
    v_add_u32 v76, 95232, v73
    v_add_u32 v178, 53760, v178
    v_and_b32 v176, 31, v1
    v_cmp_eq_u32 vcc, 0, v176
    v_cmp_eq_u32 s[82:83], 24, v176
    s_nop 0
    s_or_b64 vcc, vcc, s[82:83]
    v_mov_b32 v176, 155712
    v_mov_b32 v177, 158288
    v_cndmask_b32 v176, v176, v177, vcc
    v_cndmask_b32 v79, v176, v178, s[78:79]
oe_23:
    s_waitcnt vmcnt(17)
    v_mfma_f32_16x16x32_bf16 v[112:115], a[176:179], v[216:219], 0
    v_mov_b32 v136, 0
    v_mov_b32 v137, 0
    s_waitcnt vmcnt(16)
    v_mfma_f32_16x16x32_bf16 v[116:119], a[176:179], v[220:223], 0
    v_mov_b32 v138, 0
    v_mov_b32 v139, 0
    s_waitcnt vmcnt(15)
    v_mfma_f32_16x16x32_bf16 v[112:115], a[196:199], v[224:227], v[112:115]
    v_mov_b32 v140, 0
    v_mov_b32_e64 v141, 0
    s_waitcnt vmcnt(14)
    v_mfma_f32_16x16x32_bf16 v[116:119], a[196:199], v[228:231], v[116:119]
    s_mov_b32 s25, 6817792
    s_add_u32 s26, s36, 6817792
    s_waitcnt vmcnt(13)
    v_mfma_f32_16x16x32_bf16 v[112:115], a[216:219], v[232:235], v[112:115]
    s_add_u32 s27, s35, 3477504
    s_mov_b32 s28, 0x99999999
    s_waitcnt vmcnt(12)
    v_mfma_f32_16x16x32_bf16 v[116:119], a[216:219], v[236:239], v[116:119]
    s_mov_b32 s29, 0x99999999
    s_waitcnt vmcnt(9)
    v_mfma_f32_16x16x32_bf16 v[112:115], a[236:239], v[240:243], v[112:115]
    s_waitcnt vmcnt(8)
    v_mfma_f32_16x16x32_bf16 v[116:119], a[236:239], v[244:247], v[116:119]
    s_waitcnt vmcnt(5)
    v_mfma_f32_16x16x32_bf16 v[112:115], v[52:55], v[248:251], v[112:115]
    s_waitcnt vmcnt(4)
    v_mfma_f32_16x16x32_bf16 v[116:119], v[52:55], v[252:255], v[116:119]
    v_mfma_f32_16x16x32_bf16 v[88:91], a[164:167], v[216:219], 0
    v_mfma_f32_16x16x32_bf16 v[92:95], a[164:167], v[220:223], 0
    v_mfma_f32_16x16x32_bf16 v[88:91], a[184:187], v[224:227], v[88:91]
    v_mfma_f32_16x16x32_bf16 v[92:95], a[184:187], v[228:231], v[92:95]
    v_mfma_f32_16x16x32_bf16 v[88:91], a[204:207], v[232:235], v[88:91]
    v_mfma_f32_16x16x32_bf16 v[92:95], a[204:207], v[236:239], v[92:95]
    s_nop 1
    v_cmp_u_f32 vcc, v112, v116
    s_nop 0
    s_cbranch_vccnz rd_24
rc_25:
    v_mfma_f32_16x16x32_bf16 v[88:91], a[224:227], v[240:243], v[88:91]
    ds_write_b128 v203, v[112:115] offset:24576
    v_mfma_f32_16x16x32_bf16 v[92:95], a[224:227], v[244:247], v[92:95]
    v_mfma_f32_16x16x32_bf16 v[88:91], a[244:247], v[248:251], v[88:91]
    ds_write_b128 v203, v[116:119] offset:25600
    v_mfma_f32_16x16x32_bf16 v[92:95], a[244:247], v[252:255], v[92:95]
    v_mfma_f32_16x16x32_bf16 v[96:99], a[168:171], v[216:219], 0
    s_waitcnt vmcnt(3)
    v_lshlrev_b32 v120, 16, v208
    v_and_b32 v121, 0xffff0000, v208
    v_mfma_f32_16x16x32_bf16 v[100:103], a[168:171], v[220:223], 0
    v_lshlrev_b32_e64 v122, 16, v209
    v_and_b32 v123, 0xffff0000, v209
    v_mfma_f32_16x16x32_bf16 v[96:99], a[188:191], v[224:227], v[96:99]
    s_waitcnt vmcnt(2)
    v_lshlrev_b32 v124, 16, v210
    v_and_b32 v125, 0xffff0000, v210
    v_mfma_f32_16x16x32_bf16 v[100:103], a[188:191], v[228:231], v[100:103]
    v_lshlrev_b32_e64 v126, 16, v211
    v_and_b32 v127, 0xffff0000, v211
    v_mfma_f32_16x16x32_bf16 v[96:99], a[208:211], v[232:235], v[96:99]
    s_waitcnt vmcnt(1)
    v_lshlrev_b32 v128, 16, v212
    v_and_b32 v129, 0xffff0000, v212
    v_mfma_f32_16x16x32_bf16 v[100:103], a[208:211], v[236:239], v[100:103]
    v_mfma_f32_16x16x32_bf16 v[96:99], a[228:231], v[240:243], v[96:99]
    ds_write_b128 v200, v[88:91] offset:0
    v_mfma_f32_16x16x32_bf16 v[100:103], a[228:231], v[244:247], v[100:103]
    v_mfma_f32_16x16x32_bf16 v[96:99], a[248:251], v[248:251], v[96:99]
    ds_write_b128 v200, v[92:95] offset:1024
    v_mfma_f32_16x16x32_bf16 v[100:103], a[248:251], v[252:255], v[100:103]
    v_mfma_f32_16x16x32_bf16 v[104:107], a[172:175], v[216:219], 0
    v_mfma_f32_16x16x32_bf16 v[108:111], a[172:175], v[220:223], 0
    v_mfma_f32_16x16x32_bf16 v[104:107], a[192:195], v[224:227], v[104:107]
    v_mfma_f32_16x16x32_bf16 v[108:111], a[192:195], v[228:231], v[108:111]
    v_mfma_f32_16x16x32_bf16 v[104:107], a[212:215], v[232:235], v[104:107]
    v_mfma_f32_16x16x32_bf16 v[108:111], a[212:215], v[236:239], v[108:111]
    v_mfma_f32_16x16x32_bf16 v[104:107], a[232:235], v[240:243], v[104:107]
    ds_write_b128 v201, v[96:99] offset:2048
    v_mfma_f32_16x16x32_bf16 v[108:111], a[232:235], v[244:247], v[108:111]
    v_mfma_f32_16x16x32_bf16 v[104:107], a[252:255], v[248:251], v[104:107]
    ds_write_b128 v201, v[100:103] offset:3072
    v_mfma_f32_16x16x32_bf16 v[108:111], a[252:255], v[252:255], v[108:111]
    v_mfma_f32_16x16x32_bf16 v[80:83], a[160:163], v[216:219], v[120:123]
    v_mfma_f32_16x16x32_bf16 v[84:87], a[160:163], v[220:223], v[124:127]
    v_mfma_f32_16x16x32_bf16 v[80:83], a[180:183], v[224:227], v[80:83]
    v_mfma_f32_16x16x32_bf16 v[84:87], a[180:183], v[228:231], v[84:87]
    v_mfma_f32_16x16x32_bf16 v[80:83], a[200:203], v[232:235], v[80:83]
    s_nop 0
    ds_write_b128 v202, v[104:107] offset:4096
    v_mfma_f32_16x16x32_bf16 v[84:87], a[200:203], v[236:239], v[84:87]
    ds_write_b128 v202, v[108:111] offset:5120
    v_mfma_f32_16x16x32_bf16 v[80:83], a[220:223], v[240:243], v[80:83]
    v_mfma_f32_16x16x32_bf16 v[84:87], a[220:223], v[244:247], v[84:87]
    v_mfma_f32_16x16x32_bf16 v[80:83], a[240:243], v[248:251], v[80:83]
    v_mfma_f32_16x16x32_bf16 v[84:87], a[240:243], v[252:255], v[84:87]
    s_waitcnt lgkmcnt(0)
    s_barrier
    s_nop 0
    ds_read_b128 v[88:91], v204 offset:0
    ds_read_b128 v[92:95], v204 offset:1024
    ds_read_b128 v[96:99], v204 offset:2048
    ds_read_b128 v[100:103], v204 offset:3072
    ds_read_b128 v[104:107], v204 offset:4096
    ds_read_b128 v[108:111], v204 offset:5120
    ds_read_b64 v[112:113], v205 offset:24576
    ds_read_b64 v[114:115], v205 offset:26624
    ds_read_b64 v[116:117], v205 offset:28672
    ds_read_b64 v[118:119], v205 offset:30720
    s_lshl_b32 s96, s75, 14
    s_add_u32 s96, s96, 6815744
    s_lshl_b32 s97, s24, 12
    s_add_u32 s97, s97, 3473408
    buffer_load_dwordx4 v[176:179], v62, s[16:19], s96 offen offset:0 sc1
    buffer_load_dwordx4 v[180:183], v62, s[16:19], s96 offen offset:1024 sc1
    buffer_load_dwordx4 v[184:187], v62, s[16:19], s97 offen offset:0 sc1
    buffer_load_dwordx4 v[188:191], v62, s[16:19], s97 offen offset:1024 sc1
    buffer_load_dwordx4 v[192:195], v62, s[16:19], s97 offen offset:2048 sc1
    buffer_load_dwordx4 v[196:199], v62, s[16:19], s97 offen offset:3072 sc1
    s_waitcnt lgkmcnt(9)
    v_pk_add_f32 v[80:81], v[80:81], v[88:89]
    v_pk_add_f32 v[82:83], v[82:83], v[90:91]
    s_waitcnt lgkmcnt(8)
    v_pk_add_f32 v[84:85], v[84:85], v[92:93]
    v_pk_add_f32 v[86:87], v[86:87], v[94:95]
    s_waitcnt lgkmcnt(7)
    v_pk_add_f32 v[80:81], v[80:81], v[96:97]
    v_pk_add_f32 v[82:83], v[82:83], v[98:99]
    s_waitcnt lgkmcnt(6)
    v_pk_add_f32 v[84:85], v[84:85], v[100:101]
    v_pk_add_f32 v[86:87], v[86:87], v[102:103]
    s_waitcnt lgkmcnt(5)
    v_pk_add_f32 v[80:81], v[80:81], v[104:105]
    v_pk_add_f32 v[82:83], v[82:83], v[106:107]
    s_waitcnt lgkmcnt(4)
    v_pk_add_f32 v[84:85], v[84:85], v[108:109]
    v_pk_add_f32 v[86:87], v[86:87], v[110:111]
    v_cvt_pk_bf16_f32 v132, v80, v81
    v_cvt_pk_bf16_f32 v133, v82, v83
    v_cvt_pk_bf16_f32 v134, v84, v85
    v_cvt_pk_bf16_f32 v135, v86, v87
    s_waitcnt lgkmcnt(3)
    v_pk_add_f32 v[128:129], v[128:129], v[112:113]
    s_waitcnt lgkmcnt(2)
    v_pk_add_f32 v[128:129], v[128:129], v[114:115]
    s_waitcnt lgkmcnt(1)
    v_pk_add_f32 v[128:129], v[128:129], v[116:117]
    s_waitcnt lgkmcnt(0)
    v_pk_add_f32 v[128:129], v[128:129], v[118:119]
    v_cvt_pk_bf16_f32 v130, v128, v129
    buffer_store_dwordx4 v[132:135], v59, s[16:19], s25 offen sc1
    buffer_store_dword v130, v61, s[16:19], s26 offen sc1
    v_dot2c_f32_bf16 v136, v132, v215
    v_dot2c_f32_bf16 v137, v132, v132
    v_dot2c_f32_bf16 v136, v133, v215
    v_dot2c_f32_bf16 v137, v133, v133
    v_dot2c_f32_bf16 v138, v134, v215
    v_dot2c_f32_bf16 v139, v134, v134
    v_dot2c_f32_bf16 v138, v135, v215
    v_dot2c_f32_bf16 v139, v135, v135
    v_dot2c_f32_bf16 v140, v130, v215
    v_dot2c_f32_bf16 v141, v130, v130
    v_permlane32_swap_b32 v136, v138
    v_permlane32_swap_b32 v137, v139
    v_pk_add_f32 v[136:137], v[136:137], v[138:139]
    v_pk_add_f32 v[136:137], v[136:137], v[140:141]
    s_nop 1
    v_permlane16_swap_b32 v136, v137
    v_add_f32 v136, v136, v137
    ds_write_b32 v206, v136 offset:32768
    s_waitcnt lgkmcnt(0)
    s_barrier
    ds_read2st64_b32 v[136:137], v207 offset0:0 offset1:1
    ds_read2st64_b32 v[138:139], v207 offset0:2 offset1:3
    s_waitcnt lgkmcnt(0)
    v_pk_add_f32 v[136:137], v[136:137], v[138:139]
    v_add_f32 v136, v136, v137
    v_cndmask_b32 v136, v136, 1.0, s[28:29]
    s_mov_b64 exec, s[80:81]
    buffer_atomic_add_f32 v136, v214, s[16:19], s27 offen sc1
    s_mov_b64 exec, -1
    s_cmp_ge_u32 s2, 160
    s_cbranch_scc1 nc_26
    v_mov_b32 v248, -1
    v_mov_b32 v249, -1
    v_mov_b32 v250, -1
    v_mov_b32_e64 v251, -1
    s_lshl_b32 s88, s75, 14
    s_add_u32 s88, s88, 9437184
    buffer_store_dwordx4 v[248:251], v62, s[16:19], s88 offen offset:0 sc1
    s_waitcnt vmcnt(4)
ce_28:
    v_max3_u32 v208, v176, v177, v178
    v_max3_u32 v208, v208, v179, v180
    v_max3_u32 v208, v208, v181, v182
    v_max_u32 v208, v208, v183
    v_cmp_eq_u32 s[82:83], -1, v208
    v_min3_f32 v209, v184, v187, v188
    v_min3_f32 v209, v209, v191, v192
    v_min3_f32 v209, v209, v195, v196
    v_min_f32 v209, v209, v199
    v_cmp_neq_f32 vcc, 0x41000000, v209
    s_nop 0
    s_or_b64 vcc, vcc, s[82:83]
    s_cbranch_vccnz rd_29
rc_30:
    v_mul_f32 v208, 0x3acccccd, v185
    v_mul_f32 v209, 0x3acccccd, v189
    v_mul_f32 v186, 0x3acccccd, v186
    v_mul_f32 v190, 0x3acccccd, v190
    v_fma_f32 v186, -v208, v208, v186
    v_fma_f32 v190, -v209, v209, v190
    v_max_f32 v186, 0, v186
    v_max_f32 v190, 0, v190
    v_add_f32 v186, 0x3727c5ac, v186
    v_add_f32 v190, 0x3727c5ac, v190
    v_rsq_f32 v185, v186
    v_rsq_f32 v189, v190
    v_mul_f32 v186, -v208, v185
    v_mul_f32 v190, -v209, v189
    v_lshlrev_b32 v80, 16, v176
    v_and_b32 v82, 0xffff0000, v176
    v_lshlrev_b32 v84, 16, v177
    v_and_b32 v86, 0xffff0000, v177
    v_lshlrev_b32 v81, 16, v178
    v_and_b32 v83, 0xffff0000, v178
    v_lshlrev_b32 v85, 16, v179
    v_and_b32 v87, 0xffff0000, v179
    v_fma_f32 v208, v80, v185, v186
    v_fma_f32 v209, v81, v189, v190
    v_cvt_pk_bf16_f32 v176, v208, v209
    v_fma_f32 v208, v82, v185, v186
    v_fma_f32 v209, v83, v189, v190
    v_cvt_pk_bf16_f32 v177, v208, v209
    v_fma_f32 v208, v84, v185, v186
    v_fma_f32 v209, v85, v189, v190
    v_cvt_pk_bf16_f32 v178, v208, v209
    v_fma_f32 v208, v86, v185, v186
    v_fma_f32 v209, v87, v189, v190
    v_cvt_pk_bf16_f32 v179, v208, v209
    ds_write_b32 v63, v176 offset:0
    ds_write_b32 v63, v177 offset:4864
    ds_write_b32 v63, v178 offset:9728
    ds_write_b32 v63, v179 offset:14592
    v_mul_f32 v208, 0x3acccccd, v193
    v_mul_f32 v209, 0x3acccccd, v197
    v_mul_f32 v194, 0x3acccccd, v194
    v_mul_f32 v198, 0x3acccccd, v198
    v_fma_f32 v194, -v208, v208, v194
    v_fma_f32 v198, -v209, v209, v198
    v_max_f32 v194, 0, v194
    v_max_f32 v198, 0, v198
    v_add_f32 v194, 0x3727c5ac, v194
    v_add_f32 v198, 0x3727c5ac, v198
    v_rsq_f32 v193, v194
    v_rsq_f32 v197, v198
    v_mul_f32 v194, -v208, v193
    v_mul_f32 v198, -v209, v197
    v_lshlrev_b32 v88, 16, v180
    v_and_b32 v90, 0xffff0000, v180
    v_lshlrev_b32 v92, 16, v181
    v_and_b32 v94, 0xffff0000, v181
    v_lshlrev_b32 v89, 16, v182
    v_and_b32 v91, 0xffff0000, v182
    v_lshlrev_b32 v93, 16, v183
    v_and_b32 v95, 0xffff0000, v183
    v_fma_f32 v208, v88, v193, v194
    v_fma_f32 v209, v89, v197, v198
    v_cvt_pk_bf16_f32 v180, v208, v209
    v_fma_f32 v208, v90, v193, v194
    v_fma_f32 v209, v91, v197, v198
    v_cvt_pk_bf16_f32 v181, v208, v209
    v_fma_f32 v208, v92, v193, v194
    v_fma_f32 v209, v93, v197, v198
    v_cvt_pk_bf16_f32 v182, v208, v209
    v_fma_f32 v208, v94, v193, v194
    v_fma_f32 v209, v95, v197, v198
    v_cvt_pk_bf16_f32 v183, v208, v209
    ds_write_b32 v63, v180 offset:256
    ds_write_b32 v63, v181 offset:5120
    ds_write_b32 v63, v182 offset:9984
    ds_write_b32 v63, v183 offset:14848
    s_waitcnt lgkmcnt(0)
    s_barrier
    ds_read_b128 v[212:215], v64 offset:96
    ds_read_b128 v[216:219], v64 offset:64
    ds_read_b128 v[220:223], v64 offset:32
    ds_read_b128 v[224:227], v64 offset:0
    s_waitcnt lgkmcnt(3)
    v_mfma_f32_32x32x16_bf16 v[96:111], v[212:215], v[144:147], 0
    ds_read_b128 v[228:231], v64 offset:224
    ds_read_b64_tr_b16 v[176:177], v65 offset:1056
    ds_read_b64_tr_b16 v[178:179], v65 offset:1024
    ds_read_b64_tr_b16 v[180:181], v65 offset:1184
    ds_read_b64_tr_b16 v[182:183], v65 offset:1152
    s_waitcnt lgkmcnt(7)
    v_mfma_f32_32x32x16_bf16 v[96:111], v[216:219], v[148:151], v[96:111]
    ds_read_b128 v[232:235], v64 offset:192
    ds_read_b64_tr_b16 v[184:185], v65 offset:1312
    ds_read_b64_tr_b16 v[186:187], v65 offset:1280
    ds_read_b64_tr_b16 v[188:189], v65 offset:1440
    ds_read_b64_tr_b16 v[190:191], v65 offset:1408
    s_waitcnt lgkmcnt(11)
    v_mfma_f32_32x32x16_bf16 v[96:111], v[220:223], v[152:155], v[96:111]
    ds_read_b128 v[236:239], v64 offset:160
    ds_read_b64_tr_b16 v[192:193], v65 offset:1568
    ds_read_b64_tr_b16 v[194:195], v65 offset:1536
    ds_read_b64_tr_b16 v[196:197], v65 offset:1696
    ds_read_b64_tr_b16 v[198:199], v65 offset:1664
    s_waitcnt lgkmcnt(15)
    v_mfma_f32_32x32x16_bf16 v[96:111], v[224:227], v[156:159], v[96:111]
    ds_read_b128 v[240:243], v64 offset:128
    ds_read_b64_tr_b16 v[200:201], v65 offset:1824
    ds_read_b64_tr_b16 v[202:203], v65 offset:1792
    ds_read_b64_tr_b16 v[204:205], v65 offset:1952
    ds_read_b64_tr_b16 v[206:207], v65 offset:1920
    s_waitcnt lgkmcnt(15)
    v_mfma_f32_32x32x16_bf16 v[112:127], v[228:231], v[144:147], 0
    buffer_store_dwordx4 v[248:251], v62, s[16:19], s88 offen offset:1024 sc1
    s_nop 3
    s_waitcnt lgkmcnt(14)
    v_mfma_f32_32x32x16_bf16 v[112:127], v[232:235], v[148:151], v[112:127]
    v_cndmask_b32 v208, v99, v72, s[76:77]
    v_cndmask_b32 v209, v103, v99, s[76:77]
    v_cndmask_b32 v210, v107, v103, s[76:77]
    v_cndmask_b32 v211, v111, v107, s[76:77]
    v_mov_b32_e64 v72, v111
    s_waitcnt lgkmcnt(9)
    v_mfma_f32_32x32x16_bf16 v[112:127], v[236:239], v[152:155], v[112:127]
    v_add_f32_dpp v98, v208, v98 wave_ror:1 row_mask:0xf bank_mask:0xf
    v_add_f32_dpp v102, v209, v102 wave_ror:1 row_mask:0xf bank_mask:0xf
    v_add_f32_dpp v106, v210, v106 wave_ror:1 row_mask:0xf bank_mask:0xf
    v_add_f32_dpp v110, v211, v110 wave_ror:1 row_mask:0xf bank_mask:0xf
    v_cndmask_b32 v208, v98, v71, s[76:77]
    s_waitcnt lgkmcnt(4)
    v_mfma_f32_32x32x16_bf16 v[112:127], v[240:243], v[156:159], v[112:127]
    v_cndmask_b32 v209, v102, v98, s[76:77]
    v_cndmask_b32 v210, v106, v102, s[76:77]
    v_cndmask_b32 v211, v110, v106, s[76:77]
    v_mov_b32 v71, v110
    v_add_f32_dpp v97, v208, v97 wave_ror:1 row_mask:0xf bank_mask:0xf
    v_add_f32_dpp v101, v209, v101 wave_ror:1 row_mask:0xf bank_mask:0xf
    v_mfma_f32_32x32x16_bf16 v[112:127], v[212:215], v[160:163], v[112:127]
    ds_read_b128 v[244:247], v64 offset:352
    v_add_f32_dpp v105, v210, v105 wave_ror:1 row_mask:0xf bank_mask:0xf
    v_add_f32_dpp v109, v211, v109 wave_ror:1 row_mask:0xf bank_mask:0xf
    v_cndmask_b32 v208, v97, v70, s[76:77]
    v_cndmask_b32 v209, v101, v97, s[76:77]
    v_cndmask_b32 v210, v105, v101, s[76:77]
    v_mfma_f32_32x32x16_bf16 v[112:127], v[216:219], v[164:167], v[112:127]
    ds_read_b128 v[216:219], v64 offset:320
    v_cndmask_b32 v211, v109, v105, s[76:77]
    v_mov_b32_e64 v70, v109
    v_add_f32_dpp v96, v208, v96 wave_ror:1 row_mask:0xf bank_mask:0xf
    v_add_f32_dpp v100, v209, v100 wave_ror:1 row_mask:0xf bank_mask:0xf
    v_add_f32_dpp v104, v210, v104 wave_ror:1 row_mask:0xf bank_mask:0xf
    v_mfma_f32_32x32x16_bf16 v[112:127], v[220:223], v[168:171], v[112:127]
    ds_read_b128 v[220:223], v64 offset:288
    buffer_store_dwordx4 v[248:251], v62, s[16:19], s88 offen offset:2048 sc1
    v_add_f32_dpp v108, v211, v108 wave_ror:1 row_mask:0xf bank_mask:0xf
    v_mfma_f32_32x32x16_bf16 v[112:127], v[224:227], v[172:175], v[112:127]
    ds_read_b128 v[224:227], v64 offset:256
    ds_write_b32 v66, v96 offset:0
    ds_write_b32 v66, v100 offset:64
    s_waitcnt lgkmcnt(5)
    v_mfma_f32_32x32x16_bf16 v[128:143], v[244:247], v[144:147], 0
    ds_write_b32 v66, v104 offset:128
    ds_write_b32 v66, v108 offset:192
    s_nop 0
    s_waitcnt lgkmcnt(6)
    v_mfma_f32_32x32x16_bf16 v[128:143], v[216:219], v[148:151], v[128:143]
    s_nop 3
    v_cndmask_b32 v208, v115, v72, s[76:77]
    s_waitcnt lgkmcnt(5)
    v_mfma_f32_32x32x16_bf16 v[128:143], v[220:223], v[152:155], v[128:143]
    v_cndmask_b32 v209, v119, v115, s[76:77]
    v_cndmask_b32 v210, v123, v119, s[76:77]
    v_cndmask_b32 v211, v127, v123, s[76:77]
    v_mov_b32 v72, v127
    v_add_f32_dpp v114, v208, v114 wave_ror:1 row_mask:0xf bank_mask:0xf
    s_waitcnt lgkmcnt(4)
    v_mfma_f32_32x32x16_bf16 v[128:143], v[224:227], v[156:159], v[128:143]
    v_add_f32_dpp v118, v209, v118 wave_ror:1 row_mask:0xf bank_mask:0xf
    v_add_f32_dpp v122, v210, v122 wave_ror:1 row_mask:0xf bank_mask:0xf
    v_add_f32_dpp v126, v211, v126 wave_ror:1 row_mask:0xf bank_mask:0xf
    v_cndmask_b32 v208, v114, v71, s[76:77]
    v_cndmask_b32 v209, v118, v114, s[76:77]
    v_cndmask_b32 v210, v122, v118, s[76:77]
    v_mfma_f32_32x32x16_bf16 v[128:143], v[228:231], v[160:163], v[128:143]
    buffer_store_dwordx4 v[248:251], v62, s[16:19], s88 offen offset:3072 sc1
    v_cndmask_b32 v211, v126, v122, s[76:77]
    v_mov_b32 v71, v126
    v_add_f32_dpp v113, v208, v113 wave_ror:1 row_mask:0xf bank_mask:0xf
    v_add_f32_dpp v117, v209, v117 wave_ror:1 row_mask:0xf bank_mask:0xf
    v_add_f32_dpp v121, v210, v121 wave_ror:1 row_mask:0xf bank_mask:0xf
    v_mfma_f32_32x32x16_bf16 v[128:143], v[232:235], v[164:167], v[128:143]
    ds_read_b128 v[232:235], v64 offset:64
    v_add_f32_dpp v125, v211, v125 wave_ror:1 row_mask:0xf bank_mask:0xf
    v_cndmask_b32 v208, v113, v70, s[76:77]
    v_cndmask_b32 v209, v117, v113, s[76:77]
    v_cndmask_b32 v210, v121, v117, s[76:77]
    v_cndmask_b32 v211, v125, v121, s[76:77]
    v_mfma_f32_32x32x16_bf16 v[128:143], v[236:239], v[168:171], v[128:143]
    ds_read_b128 v[236:239], v64 offset:32
    v_mov_b32_e64 v70, v125
    v_add_f32_dpp v112, v208, v112 wave_ror:1 row_mask:0xf bank_mask:0xf
    v_add_f32_dpp v116, v209, v116 wave_ror:1 row_mask:0xf bank_mask:0xf
    v_add_f32_dpp v120, v210, v120 wave_ror:1 row_mask:0xf bank_mask:0xf
    v_add_f32_dpp v124, v211, v124 wave_ror:1 row_mask:0xf bank_mask:0xf
    v_mfma_f32_32x32x16_bf16 v[128:143], v[240:243], v[172:175], v[128:143]
    ds_read_b128 v[240:243], v64 offset:0
    ds_write_b32 v66, v112 offset:256
    ds_write_b32 v66, v116 offset:320
    v_mfma_f32_32x32x16_bf16 v[128:143], v[212:215], v[176:179], v[128:143]
    ds_read_b128 v[212:215], v64 offset:480
    ds_write_b32 v66, v120 offset:384
    ds_write_b32 v66, v124 offset:448
    s_waitcnt lgkmcnt(7)
    v_mfma_f32_32x32x16_bf16 v[128:143], v[232:235], v[180:183], v[128:143]
    ds_read_b128 v[232:235], v64 offset:448
    s_waitcnt lgkmcnt(7)
    v_mfma_f32_32x32x16_bf16 v[128:143], v[236:239], v[184:187], v[128:143]
    ds_read_b128 v[236:239], v64 offset:416
    s_waitcnt lgkmcnt(7)
    v_mfma_f32_32x32x16_bf16 v[128:143], v[240:243], v[188:191], v[128:143]
    ds_read_b128 v[240:243], v64 offset:384
    s_nop 3
    s_waitcnt lgkmcnt(5)
    v_mfma_f32_32x32x16_bf16 v[112:127], v[212:215], v[144:147], 0
    s_nop 4
    s_waitcnt lgkmcnt(2)
    v_mfma_f32_32x32x16_bf16 v[112:127], v[232:235], v[148:151], v[112:127]
    v_cndmask_b32 v208, v131, v72, s[76:77]
    v_cndmask_b32 v209, v135, v131, s[76:77]
    v_cndmask_b32 v210, v139, v135, s[76:77]
    v_cndmask_b32 v211, v143, v139, s[76:77]
    v_mov_b32_e64 v72, v143
    s_waitcnt lgkmcnt(1)
    v_mfma_f32_32x32x16_bf16 v[112:127], v[236:239], v[152:155], v[112:127]
    v_add_f32_dpp v130, v208, v130 wave_ror:1 row_mask:0xf bank_mask:0xf
    v_add_f32_dpp v134, v209, v134 wave_ror:1 row_mask:0xf bank_mask:0xf
    v_add_f32_dpp v138, v210, v138 wave_ror:1 row_mask:0xf bank_mask:0xf
    v_add_f32_dpp v142, v211, v142 wave_ror:1 row_mask:0xf bank_mask:0xf
    v_cndmask_b32 v208, v130, v71, s[76:77]
    s_waitcnt lgkmcnt(0)
    v_mfma_f32_32x32x16_bf16 v[112:127], v[240:243], v[156:159], v[112:127]
    v_cndmask_b32 v209, v134, v130, s[76:77]
    v_cndmask_b32 v210, v138, v134, s[76:77]
    v_cndmask_b32 v211, v142, v138, s[76:77]
    v_mov_b32 v71, v142
    v_add_f32_dpp v129, v208, v129 wave_ror:1 row_mask:0xf bank_mask:0xf
    v_add_f32_dpp v133, v209, v133 wave_ror:1 row_mask:0xf bank_mask:0xf
    v_mfma_f32_32x32x16_bf16 v[112:127], v[244:247], v[160:163], v[112:127]
    v_add_f32_dpp v137, v210, v137 wave_ror:1 row_mask:0xf bank_mask:0xf
    v_add_f32_dpp v141, v211, v141 wave_ror:1 row_mask:0xf bank_mask:0xf
    v_cndmask_b32 v208, v129, v70, s[76:77]
    v_cndmask_b32 v209, v133, v129, s[76:77]
    v_cndmask_b32 v210, v137, v133, s[76:77]
    v_cndmask_b32 v211, v141, v137, s[76:77]
    v_mfma_f32_32x32x16_bf16 v[112:127], v[216:219], v[164:167], v[112:127]
    ds_read_b128 v[240:243], v64 offset:192
    v_mov_b32_e64 v70, v141
    v_add_f32_dpp v128, v208, v128 wave_ror:1 row_mask:0xf bank_mask:0xf
    v_add_f32_dpp v132, v209, v132 wave_ror:1 row_mask:0xf bank_mask:0xf
    v_add_f32_dpp v136, v210, v136 wave_ror:1 row_mask:0xf bank_mask:0xf
    v_add_f32_dpp v140, v211, v140 wave_ror:1 row_mask:0xf bank_mask:0xf
    v_mfma_f32_32x32x16_bf16 v[112:127], v[220:223], v[168:171], v[112:127]
    ds_read_b128 v[220:223], v64 offset:160
    ds_write_b32 v66, v128 offset:512
    ds_write_b32 v66, v132 offset:576
    v_mfma_f32_32x32x16_bf16 v[112:127], v[224:227], v[172:175], v[112:127]
    ds_read_b128 v[224:227], v64 offset:128
    ds_write_b32 v66, v136 offset:640
    ds_write_b32 v66, v140 offset:704
    v_mfma_f32_32x32x16_bf16 v[112:127], v[228:231], v[176:179], v[112:127]
    ds_read_b128 v[236:239], v64 offset:96
    s_waitcnt lgkmcnt(7)
    v_mfma_f32_32x32x16_bf16 v[112:127], v[240:243], v[180:183], v[112:127]
    ds_read_b128 v[240:243], v64 offset:64
    s_waitcnt lgkmcnt(7)
    v_mfma_f32_32x32x16_bf16 v[112:127], v[220:223], v[184:187], v[112:127]
    ds_read_b128 v[220:223], v64 offset:32
    s_waitcnt lgkmcnt(5)
    v_mfma_f32_32x32x16_bf16 v[112:127], v[224:227], v[188:191], v[112:127]
    ds_read_b128 v[224:227], v64 offset:0
    s_waitcnt lgkmcnt(3)
    v_mfma_f32_32x32x16_bf16 v[112:127], v[236:239], v[192:195], v[112:127]
    ds_read_b64_tr_b16 v[216:217], v65 offset:544
    ds_read_b64_tr_b16 v[218:219], v65 offset:512
    s_waitcnt lgkmcnt(4)
    v_mfma_f32_32x32x16_bf16 v[112:127], v[240:243], v[196:199], v[112:127]
    ds_read_b64_tr_b16 v[240:241], v65 offset:1056
    ds_read_b64_tr_b16 v[242:243], v65 offset:1024
    s_waitcnt lgkmcnt(5)
    v_mfma_f32_32x32x16_bf16 v[112:127], v[220:223], v[200:203], v[112:127]
    s_waitcnt lgkmcnt(4)
    v_mfma_f32_32x32x16_bf16 v[112:127], v[224:227], v[204:207], v[112:127]
    ds_read_b64_tr_b16 v[224:225], v65 offset:1568
    ds_read_b64_tr_b16 v[226:227], v65 offset:1536
    s_lshl_b32 s96, s75, 14
    s_add_u32 s96, s96, 6815744
    s_lshl_b32 s97, s24, 12
    s_add_u32 s97, s97, 3477504
    buffer_load_dwordx4 v[248:251], v62, s[16:19], s96 offen offset:2048 sc1
    s_waitcnt lgkmcnt(4)
    v_mfma_f32_32x32x16_bf16 v[144:159], v[212:215], v[216:219], 0
    s_nop 3
    v_cndmask_b32 v208, v115, v72, s[76:77]
    s_waitcnt lgkmcnt(2)
    v_mfma_f32_32x32x16_bf16 v[144:159], v[244:247], v[240:243], v[144:159]
    buffer_load_dwordx4 v[252:255], v62, s[16:19], s96 offen offset:3072 sc1
    v_cndmask_b32 v209, v119, v115, s[76:77]
    v_cndmask_b32 v210, v123, v119, s[76:77]
    v_cndmask_b32 v211, v127, v123, s[76:77]
    v_mov_b32_e64 v72, v127
    v_add_f32_dpp v114, v208, v114 wave_ror:1 row_mask:0xf bank_mask:0xf
    v_mfma_f32_32x32x16_bf16 v[160:175], v[212:215], v[240:243], 0
    ds_read_b64_tr_b16 v[216:217], v65 offset:2080
    ds_read_b64_tr_b16 v[218:219], v65 offset:2048
    v_add_f32_dpp v118, v209, v118 wave_ror:1 row_mask:0xf bank_mask:0xf
    v_add_f32_dpp v122, v210, v122 wave_ror:1 row_mask:0xf bank_mask:0xf
    v_add_f32_dpp v126, v211, v126 wave_ror:1 row_mask:0xf bank_mask:0xf
    s_waitcnt lgkmcnt(2)
    v_mfma_f32_32x32x16_bf16 v[144:159], v[228:231], v[224:227], v[144:159]
    buffer_load_dwordx4 v[96:99], v62, s[16:19], s97 offen offset:0 sc1
    v_cndmask_b32 v208, v114, v71, s[76:77]
    v_cndmask_b32 v209, v118, v114, s[76:77]
    v_cndmask_b32 v210, v122, v118, s[76:77]
    v_cndmask_b32 v211, v126, v122, s[76:77]
    v_mov_b32 v71, v126
    v_mfma_f32_32x32x16_bf16 v[160:175], v[244:247], v[224:227], v[160:175]
    v_add_f32_dpp v113, v208, v113 wave_ror:1 row_mask:0xf bank_mask:0xf
    v_add_f32_dpp v117, v209, v117 wave_ror:1 row_mask:0xf bank_mask:0xf
    v_add_f32_dpp v121, v210, v121 wave_ror:1 row_mask:0xf bank_mask:0xf
    v_add_f32_dpp v125, v211, v125 wave_ror:1 row_mask:0xf bank_mask:0xf
    v_cndmask_b32 v208, v113, v70, s[76:77]
    v_cndmask_b32 v209, v117, v113, s[76:77]
    v_mfma_f32_32x32x16_bf16 v[176:191], v[212:215], v[224:227], 0
    buffer_load_dwordx4 v[100:103], v62, s[16:19], s97 offen offset:1024 sc1
    v_cndmask_b32 v210, v121, v117, s[76:77]
    v_cndmask_b32 v211, v125, v121, s[76:77]
    v_mov_b32 v70, v125
    v_add_f32_dpp v112, v208, v112 wave_ror:1 row_mask:0xf bank_mask:0xf
    s_waitcnt lgkmcnt(0)
    v_mfma_f32_32x32x16_bf16 v[144:159], v[236:239], v[216:219], v[144:159]
    ds_read_b64_tr_b16 v[240:241], v65 offset:2592
    ds_read_b64_tr_b16 v[242:243], v65 offset:2560
    v_add_f32_dpp v116, v209, v116 wave_ror:1 row_mask:0xf bank_mask:0xf
    v_add_f32_dpp v120, v210, v120 wave_ror:1 row_mask:0xf bank_mask:0xf
    v_add_f32_dpp v124, v211, v124 wave_ror:1 row_mask:0xf bank_mask:0xf
    v_mfma_f32_32x32x16_bf16 v[160:175], v[228:231], v[216:219], v[160:175]
    buffer_load_dwordx4 v[104:107], v62, s[16:19], s97 offen offset:2048 sc1
    ds_write_b32 v66, v112 offset:768
    ds_write_b32 v66, v116 offset:832
    v_mfma_f32_32x32x16_bf16 v[176:191], v[244:247], v[216:219], v[176:191]
    ds_write_b32 v66, v120 offset:896
    ds_write_b32 v66, v124 offset:960
    v_mfma_f32_32x32x16_bf16 v[192:207], v[212:215], v[216:219], 0
    ds_read_b64_tr_b16 v[212:213], v65 offset:3104
    ds_read_b64_tr_b16 v[214:215], v65 offset:3072
    buffer_load_dwordx4 v[108:111], v62, s[16:19], s97 offen offset:3072 sc1
    s_waitcnt lgkmcnt(6)
    v_mfma_f32_32x32x16_bf16 v[160:175], v[236:239], v[240:243], v[160:175]
    v_mfma_f32_32x32x16_bf16 v[176:191], v[228:231], v[240:243], v[176:191]
    ds_read_b64_tr_b16 v[224:225], v65 offset:3616
    ds_read_b64_tr_b16 v[226:227], v65 offset:3584
    s_waitcnt vmcnt(6) lgkmcnt(4)
    s_barrier
    v_mfma_f32_32x32x16_bf16 v[192:207], v[244:247], v[240:243], v[192:207]
    ds_read_b64_tr_b16 v[244:245], v65 offset:672
    ds_read_b64_tr_b16 v[246:247], v65 offset:640
    ds_read_b64 v[112:113], v67 offset:0
    ds_read_b64 v[114:115], v67 offset:4224
    ds_read_b64 v[116:117], v67 offset:8448
    s_waitcnt lgkmcnt(7)
    v_mfma_f32_32x32x16_bf16 v[176:191], v[236:239], v[212:215], v[176:191]
    ds_read_b128 v[216:219], v64 offset:320
    ds_read_b64_tr_b16 v[240:241], v65 offset:1184
    ds_read_b64_tr_b16 v[242:243], v65 offset:1152
    ds_read_b64 v[118:119], v67 offset:12672
    ds_read_b64 v[120:121], v67 offset:512
    ds_read_b64 v[122:123], v67 offset:4736
    v_mfma_f32_32x32x16_bf16 v[192:207], v[228:231], v[212:215], v[192:207]
    ds_read_b64 v[124:125], v67 offset:8960
    ds_read_b64 v[126:127], v67 offset:13184
    s_lshl_b32 s25, s75, 14
    s_add_u32 s25, s25, 9437184
    s_waitcnt lgkmcnt(13)
    v_mfma_f32_32x32x16_bf16 v[192:207], v[236:239], v[224:227], v[192:207]
    ds_read_b128 v[228:231], v64 offset:192
    ds_read_b64_tr_b16 v[236:237], v65 offset:1696
    ds_read_b64_tr_b16 v[238:239], v65 offset:1664
    s_waitcnt lgkmcnt(14)
    v_mfma_f32_32x32x16_bf16 v[144:159], v[232:235], v[244:247], v[144:159]
    v_mov_b32 v5, 1
    s_add_u32 s82, s86, 24576
    buffer_atomic_add v5, v6, s[16:19], s82 offen offset:0 sc0 sc1
    s_waitcnt lgkmcnt(8)
    v_mfma_f32_32x32x16_bf16 v[144:159], v[216:219], v[240:243], v[144:159]
    v_mfma_f32_32x32x16_bf16 v[160:175], v[232:235], v[240:243], v[160:175]
    ds_read_b128 v[212:215], v64 offset:64
    ds_read_b64_tr_b16 v[224:225], v65 offset:2208
    ds_read_b64_tr_b16 v[226:227], v65 offset:2176
    s_waitcnt lgkmcnt(3)
    v_mfma_f32_32x32x16_bf16 v[144:159], v[228:231], v[236:239], v[144:159]
    v_mfma_f32_32x32x16_bf16 v[160:175], v[216:219], v[236:239], v[160:175]
    v_add_f32 v112, v112, v80
    v_add_f32 v113, v113, v81
    v_add_f32 v114, v114, v82
    v_add_f32 v115, v115, v83
    v_add_f32 v116, v116, v84
    v_mfma_f32_32x32x16_bf16 v[176:191], v[232:235], v[236:239], v[176:191]
    v_add_f32 v117, v117, v85
    v_add_f32 v118, v118, v86
    v_add_f32 v119, v119, v87
    v_cvt_pk_bf16_f32 v128, v112, v114
    v_cvt_pk_bf16_f32 v129, v116, v118
    s_waitcnt lgkmcnt(0)
    v_mfma_f32_32x32x16_bf16 v[144:159], v[212:215], v[224:227], v[144:159]
    ds_read_b64_tr_b16 v[244:245], v65 offset:2720
    ds_read_b64_tr_b16 v[246:247], v65 offset:2688
    v_cvt_pk_bf16_f32 v130, v113, v115
    v_cvt_pk_bf16_f32 v131, v117, v119
    v_mfma_f32_32x32x16_bf16 v[160:175], v[228:231], v[224:227], v[160:175]
    buffer_store_dwordx4 v[128:131], v62, s[16:19], s25 offen offset:0 sc1
    v_add_f32 v120, v120, v88
    v_add_f32 v121, v121, v89
    v_add_f32 v122, v122, v90
    v_add_f32 v123, v123, v91
    v_add_f32 v124, v124, v92
    v_mfma_f32_32x32x16_bf16 v[176:191], v[216:219], v[224:227], v[176:191]
    v_add_f32 v125, v125, v93
    v_add_f32 v126, v126, v94
    v_add_f32_e64 v127, v127, v95
    v_cvt_pk_bf16_f32 v132, v120, v122
    v_cvt_pk_bf16_f32 v133, v124, v126
    v_cvt_pk_bf16_f32 v134, v121, v123
    v_mfma_f32_32x32x16_bf16 v[192:207], v[232:235], v[224:227], v[192:207]
    ds_read_b64_tr_b16 v[232:233], v65 offset:3232
    ds_read_b64_tr_b16 v[234:235], v65 offset:3200
    v_cvt_pk_bf16_f32 v135, v125, v127
    s_waitcnt lgkmcnt(2)
    v_mfma_f32_32x32x16_bf16 v[160:175], v[212:215], v[244:247], v[160:175]
    buffer_store_dwordx4 v[132:135], v62, s[16:19], s25 offen offset:1024 sc1
    ds_read_b64_tr_b16 v[112:113], v65 offset:32
    ds_read_b64_tr_b16 v[114:115], v65 offset:0
    ds_read_b64_tr_b16 v[116:117], v65 offset:160
    ds_read_b64_tr_b16 v[118:119], v65 offset:128
    ds_read_b64_tr_b16 v[120:121], v65 offset:288
    v_mfma_f32_32x32x16_bf16 v[176:191], v[228:231], v[244:247], v[176:191]
    ds_read_b64_tr_b16 v[240:241], v65 offset:3744
    ds_read_b64_tr_b16 v[242:243], v65 offset:3712
    ds_read_b64_tr_b16 v[122:123], v65 offset:256
    ds_read_b64_tr_b16 v[124:125], v65 offset:416
    ds_read_b64_tr_b16 v[126:127], v65 offset:384
    ds_read_b64_tr_b16 v[128:129], v65 offset:544
    v_mfma_f32_32x32x16_bf16 v[192:207], v[216:219], v[244:247], v[192:207]
    ds_read_b128 v[216:219], v64 offset:416
    ds_read_b64_tr_b16 v[236:237], v65 offset:800
    ds_read_b64_tr_b16 v[238:239], v65 offset:768
    ds_read_b64_tr_b16 v[130:131], v65 offset:512
    ds_read_b64_tr_b16 v[132:133], v65 offset:672
    s_waitcnt lgkmcnt(15)
    v_mfma_f32_32x32x16_bf16 v[176:191], v[212:215], v[232:235], v[176:191]
    ds_read_b128 v[224:227], v64 offset:288
    ds_read_b64_tr_b16 v[244:245], v65 offset:1312
    ds_read_b64_tr_b16 v[246:247], v65 offset:1280
    ds_read_b64_tr_b16 v[134:135], v65 offset:640
    ds_read_b64_tr_b16 v[136:137], v65 offset:800
    ds_read_b64_tr_b16 v[138:139], v65 offset:768
    v_mfma_f32_32x32x16_bf16 v[192:207], v[228:231], v[232:235], v[192:207]
    ds_read_b64_tr_b16 v[140:141], v65 offset:928
    ds_read_b64_tr_b16 v[142:143], v65 offset:896
    s_waitcnt lgkmcnt(15)
    v_mfma_f32_32x32x16_bf16 v[192:207], v[212:215], v[240:243], v[192:207]
    ds_read_b128 v[228:231], v64 offset:160
    ds_read_b64_tr_b16 v[212:213], v65 offset:1824
    ds_read_b64_tr_b16 v[214:215], v65 offset:1792
    s_waitcnt vmcnt(3)
ce_31:
    v_max3_u32 v208, v248, v249, v250
    v_max3_u32 v208, v208, v251, v252
    v_max3_u32 v208, v208, v253, v254
    v_max_u32_e64 v208, v208, v255
    v_cmp_eq_u32 s[82:83], -1, v208
    v_min3_f32 v209, v96, v99, v100
    v_min3_f32 v209, v209, v103, v104
    v_min3_f32 v209, v209, v107, v108
    v_min_f32 v209, v209, v111
    v_cmp_neq_f32 vcc, 0x41000000, v209
    s_nop 0
    s_or_b64 vcc, vcc, s[82:83]
    s_cbranch_vccnz rd_32
rc_33:
    s_waitcnt lgkmcnt(13)
    v_mfma_f32_32x32x16_bf16 v[144:159], v[216:219], v[236:239], v[144:159]
    v_mul_f32 v208, 0x3acccccd, v97
    v_mul_f32 v209, 0x3acccccd, v101
    v_mul_f32 v98, 0x3acccccd, v98
    v_mul_f32 v102, 0x3acccccd, v102
    v_fma_f32 v98, -v208, v208, v98
    s_waitcnt lgkmcnt(8)
    v_mfma_f32_32x32x16_bf16 v[144:159], v[224:227], v[244:247], v[144:159]
    v_fma_f32 v102, -v209, v209, v102
    v_max_f32 v98, 0, v98
    v_max_f32 v102, 0, v102
    v_add_f32 v98, 0x3727c5ac, v98
    v_add_f32 v102, 0x3727c5ac, v102
    v_mfma_f32_32x32x16_bf16 v[160:175], v[216:219], v[244:247], v[160:175]
    ds_read_b64_tr_b16 v[232:233], v65 offset:2336
    ds_read_b64_tr_b16 v[234:235], v65 offset:2304
    v_rsq_f32 v97, v98
    s_waitcnt lgkmcnt(2)
    v_mfma_f32_32x32x16_bf16 v[144:159], v[228:231], v[212:215], v[144:159]
    v_rsq_f32_e64 v101, v102
    v_mul_f32 v98, -v208, v97
    v_mul_f32 v102, -v209, v101
    v_lshlrev_b32_e64 v80, 16, v248
    v_and_b32 v82, 0xffff0000, v248
    v_mfma_f32_32x32x16_bf16 v[160:175], v[224:227], v[212:215], v[160:175]
    v_lshlrev_b32 v84, 16, v249
    v_and_b32 v86, 0xffff0000, v249
    v_lshlrev_b32 v81, 16, v250
    v_and_b32 v83, 0xffff0000, v250
    v_lshlrev_b32_e64 v85, 16, v251
    v_and_b32 v87, 0xffff0000, v251
    v_mfma_f32_32x32x16_bf16 v[176:191], v[216:219], v[212:215], v[176:191]
    v_fma_f32 v208, v80, v97, v98
    v_fma_f32 v209, v81, v101, v102
    v_cvt_pk_bf16_f32 v248, v208, v209
    v_fma_f32 v208, v82, v97, v98
    v_fma_f32 v209, v83, v101, v102
    s_waitcnt lgkmcnt(0)
    v_mfma_f32_32x32x16_bf16 v[144:159], v[220:223], v[232:235], v[144:159]
    ds_read_b64_tr_b16 v[240:241], v65 offset:2848
    ds_read_b64_tr_b16 v[242:243], v65 offset:2816
    v_cvt_pk_bf16_f32 v249, v208, v209
    v_fma_f32 v208, v84, v97, v98
    v_fma_f32 v209, v85, v101, v102
    v_cvt_pk_bf16_f32 v250, v208, v209
    v_mfma_f32_32x32x16_bf16 v[160:175], v[228:231], v[232:235], v[160:175]
    v_fma_f32 v208, v86, v97, v98
    v_fma_f32 v209, v87, v101, v102
    v_cvt_pk_bf16_f32 v251, v208, v209
    v_mfma_f32_32x32x16_bf16 v[176:191], v[224:227], v[232:235], v[176:191]
    ds_write_b32 v63, v248 offset:512
    ds_write_b32 v63, v249 offset:5376
    ds_write_b32 v63, v250 offset:10240
    v_mfma_f32_32x32x16_bf16 v[192:207], v[216:219], v[232:235], v[192:207]
    ds_read_b64_tr_b16 v[216:217], v65 offset:3360
    ds_read_b64_tr_b16 v[218:219], v65 offset:3328
    ds_write_b32 v63, v251 offset:15104
    v_mul_f32 v208, 0x3acccccd, v105
    s_waitcnt lgkmcnt(6)
    v_mfma_f32_32x32x16_bf16 v[160:175], v[220:223], v[240:243], v[160:175]
    v_mul_f32 v209, 0x3acccccd, v109
    v_mul_f32 v106, 0x3acccccd, v106
    v_mul_f32 v110, 0x3acccccd, v110
    v_fma_f32 v106, -v208, v208, v106
    v_fma_f32 v110, -v209, v209, v110
    v_max_f32_e64 v106, 0, v106
    v_mfma_f32_32x32x16_bf16 v[176:191], v[228:231], v[240:243], v[176:191]
    ds_read_b64_tr_b16 v[236:237], v65 offset:3872
    ds_read_b64_tr_b16 v[238:239], v65 offset:3840
    v_max_f32_e64 v110, 0, v110
    v_add_f32 v106, 0x3727c5ac, v106
    v_add_f32 v110, 0x3727c5ac, v110
    v_mfma_f32_32x32x16_bf16 v[192:207], v[224:227], v[240:243], v[192:207]
    ds_read_b128 v[224:227], v64 offset:384
    ds_read_b64_tr_b16 v[244:245], v65 offset:928
    ds_read_b64_tr_b16 v[246:247], v65 offset:896
    v_rsq_f32 v105, v106
    s_waitcnt lgkmcnt(6)
    v_mfma_f32_32x32x16_bf16 v[176:191], v[220:223], v[216:219], v[176:191]
    ds_read_b128 v[212:215], v64 offset:256
    ds_read_b64_tr_b16 v[232:233], v65 offset:1440
    ds_read_b64_tr_b16 v[234:235], v65 offset:1408
    v_rsq_f32_e64 v109, v110
    v_mul_f32 v106, -v208, v105
    v_mfma_f32_32x32x16_bf16 v[192:207], v[228:231], v[216:219], v[192:207]
    v_mul_f32 v110, -v209, v109
    v_lshlrev_b32 v88, 16, v252
    v_and_b32 v90, 0xffff0000, v252
    v_lshlrev_b32 v92, 16, v253
    v_and_b32 v94, 0xffff0000, v253
    s_waitcnt lgkmcnt(6)
    v_mfma_f32_32x32x16_bf16 v[192:207], v[220:223], v[236:239], v[192:207]
    ds_read_b128 v[220:223], v64 offset:128
    ds_read_b64_tr_b16 v[228:229], v65 offset:1952
    ds_read_b64_tr_b16 v[230:231], v65 offset:1920
    v_lshlrev_b32 v89, 16, v254
    v_and_b32 v91, 0xffff0000, v254
    s_waitcnt lgkmcnt(6)
    v_mfma_f32_32x32x16_bf16 v[144:159], v[224:227], v[244:247], v[144:159]
    v_lshlrev_b32 v93, 16, v255
    v_and_b32 v95, 0xffff0000, v255
    v_fma_f32 v208, v88, v105, v106
    v_fma_f32 v209, v89, v109, v110
    v_cvt_pk_bf16_f32 v252, v208, v209
    s_waitcnt lgkmcnt(3)
    v_mfma_f32_32x32x16_bf16 v[144:159], v[212:215], v[232:235], v[144:159]
    v_fma_f32 v208, v90, v105, v106
    v_fma_f32 v209, v91, v109, v110
    v_cvt_pk_bf16_f32 v253, v208, v209
    v_fma_f32 v208, v92, v105, v106
    v_fma_f32 v209, v93, v109, v110
    v_cvt_pk_bf16_f32 v254, v208, v209
    v_mfma_f32_32x32x16_bf16 v[160:175], v[224:227], v[232:235], v[160:175]
    ds_read_b128 v[240:243], v64 offset:0
    ds_read_b64_tr_b16 v[216:217], v65 offset:2464
    ds_read_b64_tr_b16 v[218:219], v65 offset:2432
    v_fma_f32 v208, v94, v105, v106
    v_fma_f32 v209, v95, v109, v110
    s_waitcnt lgkmcnt(3)
    v_mfma_f32_32x32x16_bf16 v[144:159], v[220:223], v[228:231], v[144:159]
    v_cvt_pk_bf16_f32 v255, v208, v209
    ds_write_b32 v63, v252 offset:768
    v_mfma_f32_32x32x16_bf16 v[160:175], v[212:215], v[228:231], v[160:175]
    ds_write_b32 v63, v253 offset:5632
    ds_write_b32 v63, v254 offset:10496
    ds_write_b32 v63, v255 offset:15360
    v_mfma_f32_32x32x16_bf16 v[176:191], v[224:227], v[228:231], v[176:191]
    s_waitcnt vmcnt(2)
    v_cmp_eq_u32 vcc, 19, v5
    s_nop 0
    s_cbranch_vccnz gl_34
gc_35:
    s_lshl_b32 s25, s72, 5
    s_add_u32 s25, s25, 0
    s_sub_u32 s26, s25, 4
    s_waitcnt lgkmcnt(4)
    v_mfma_f32_32x32x16_bf16 v[144:159], v[240:243], v[216:219], v[144:159]
    ds_read_b64_tr_b16 v[236:237], v65 offset:2976
    ds_read_b64_tr_b16 v[238:239], v65 offset:2944
    s_max_i32 s26, s26, 0
    s_lshl_b32 s27, s71, 12
    s_add_u32 s27, s27, 9437184
    s_lshl_b32 s99, s25, 3
    v_mfma_f32_32x32x16_bf16 v[160:175], v[220:223], v[216:219], v[160:175]
    s_lshl_b32 s100, s26, 3
    s_lshl_b32 s92, s24, 12
    s_lshl_b32 s93, s24, 9
    s_add_u32 s99, s99, s27
    s_add_u32 s100, s100, s27
    v_mfma_f32_32x32x16_bf16 v[176:191], v[212:215], v[216:219], v[176:191]
    v_mfma_f32_32x32x16_bf16 v[192:207], v[224:227], v[216:219], v[192:207]
    ds_read_b64_tr_b16 v[224:225], v65 offset:3488
    ds_read_b64_tr_b16 v[226:227], v65 offset:3456
    s_waitcnt lgkmcnt(2)
    v_mfma_f32_32x32x16_bf16 v[160:175], v[240:243], v[236:239], v[160:175]
    v_mfma_f32_32x32x16_bf16 v[176:191], v[220:223], v[236:239], v[176:191]
    ds_read_b64_tr_b16 v[244:245], v65 offset:4000
    ds_read_b64_tr_b16 v[246:247], v65 offset:3968
    v_mfma_f32_32x32x16_bf16 v[192:207], v[212:215], v[236:239], v[192:207]
    s_waitcnt lgkmcnt(2)
    v_mfma_f32_32x32x16_bf16 v[176:191], v[240:243], v[224:227], v[176:191]
    v_mfma_f32_32x32x16_bf16 v[192:207], v[220:223], v[224:227], v[192:207]
    s_waitcnt lgkmcnt(0)
    v_mfma_f32_32x32x16_bf16 v[192:207], v[240:243], v[244:247], v[192:207]
    s_waitcnt lgkmcnt(0)
    s_barrier
    ds_read_b128 v[212:215], v64 offset:608
    ds_read_b128 v[216:219], v64 offset:576
    ds_read_b128 v[220:223], v64 offset:544
    ds_read_b128 v[224:227], v64 offset:512
    s_waitcnt lgkmcnt(3)
    v_mfma_f32_32x32x16_bf16 v[144:159], v[212:215], v[112:115], v[144:159]
    ds_read_b128 v[228:231], v64 offset:736
    s_waitcnt lgkmcnt(3)
    v_mfma_f32_32x32x16_bf16 v[144:159], v[216:219], v[116:119], v[144:159]
    ds_read_b128 v[232:235], v64 offset:704
    s_waitcnt lgkmcnt(3)
    v_mfma_f32_32x32x16_bf16 v[144:159], v[220:223], v[120:123], v[144:159]
    ds_read_b128 v[236:239], v64 offset:672
    s_waitcnt lgkmcnt(3)
    v_mfma_f32_32x32x16_bf16 v[144:159], v[224:227], v[124:127], v[144:159]
    ds_read_b128 v[240:243], v64 offset:640
    s_nop 3
    s_waitcnt lgkmcnt(3)
    v_mfma_f32_32x32x16_bf16 v[160:175], v[228:231], v[112:115], v[160:175]
    s_nop 4
    s_waitcnt lgkmcnt(2)
    v_mfma_f32_32x32x16_bf16 v[160:175], v[232:235], v[116:119], v[160:175]
    v_cndmask_b32 v208, v147, v72, s[76:77]
    v_cndmask_b32 v209, v151, v147, s[76:77]
    v_cndmask_b32 v210, v155, v151, s[76:77]
    v_cndmask_b32 v211, v159, v155, s[76:77]
    v_mov_b32_e64 v72, v159
    s_waitcnt lgkmcnt(1)
    v_mfma_f32_32x32x16_bf16 v[160:175], v[236:239], v[120:123], v[160:175]
    v_add_f32_dpp v146, v208, v146 wave_ror:1 row_mask:0xf bank_mask:0xf
    v_add_f32_dpp v150, v209, v150 wave_ror:1 row_mask:0xf bank_mask:0xf
    v_add_f32_dpp v154, v210, v154 wave_ror:1 row_mask:0xf bank_mask:0xf
    v_add_f32_dpp v158, v211, v158 wave_ror:1 row_mask:0xf bank_mask:0xf
    v_cndmask_b32 v208, v146, v71, s[76:77]
    s_waitcnt lgkmcnt(0)
    v_mfma_f32_32x32x16_bf16 v[160:175], v[240:243], v[124:127], v[160:175]
    v_cndmask_b32 v209, v150, v146, s[76:77]
    v_cndmask_b32 v210, v154, v150, s[76:77]
    v_cndmask_b32 v211, v158, v154, s[76:77]
    v_mov_b32 v71, v158
    v_add_f32_dpp v145, v208, v145 wave_ror:1 row_mask:0xf bank_mask:0xf
    v_add_f32_dpp v149, v209, v149 wave_ror:1 row_mask:0xf bank_mask:0xf
    v_mfma_f32_32x32x16_bf16 v[160:175], v[212:215], v[128:131], v[160:175]
    ds_read_b128 v[244:247], v64 offset:864
    v_add_f32_dpp v153, v210, v153 wave_ror:1 row_mask:0xf bank_mask:0xf
    v_add_f32_dpp v157, v211, v157 wave_ror:1 row_mask:0xf bank_mask:0xf
    v_cndmask_b32 v208, v145, v70, s[76:77]
    v_cndmask_b32 v209, v149, v145, s[76:77]
    v_cndmask_b32 v210, v153, v149, s[76:77]
    v_mfma_f32_32x32x16_bf16 v[160:175], v[216:219], v[132:135], v[160:175]
    ds_read_b128 v[248:251], v64 offset:832
    v_cndmask_b32 v211, v157, v153, s[76:77]
    v_mov_b32_e64 v70, v157
    v_add_f32_dpp v144, v208, v144 wave_ror:1 row_mask:0xf bank_mask:0xf
    v_add_f32_dpp v148, v209, v148 wave_ror:1 row_mask:0xf bank_mask:0xf
    v_add_f32_dpp v152, v210, v152 wave_ror:1 row_mask:0xf bank_mask:0xf
    v_mfma_f32_32x32x16_bf16 v[160:175], v[220:223], v[136:139], v[160:175]
    ds_read_b128 v[252:255], v64 offset:800
    v_add_f32_dpp v156, v211, v156 wave_ror:1 row_mask:0xf bank_mask:0xf
    ds_write_b32 v66, v144 offset:0
    v_mfma_f32_32x32x16_bf16 v[160:175], v[224:227], v[140:143], v[160:175]
    ds_read_b128 v[224:227], v64 offset:768
    ds_write_b32 v66, v148 offset:64
    ds_write_b32 v66, v152 offset:128
    s_waitcnt lgkmcnt(6)
    v_mfma_f32_32x32x16_bf16 v[176:191], v[244:247], v[112:115], v[176:191]
    ds_write_b32 v66, v156 offset:192
    buffer_load_dword v7, v4, s[16:19], s89 offen offset:0 sc1
    s_nop 1
    s_waitcnt lgkmcnt(6)
    v_mfma_f32_32x32x16_bf16 v[176:191], v[248:251], v[116:119], v[176:191]
    s_nop 2
    v_cndmask_b32 v208, v163, v72, s[76:77]
    v_cndmask_b32 v209, v167, v163, s[76:77]
    s_waitcnt lgkmcnt(5)
    v_mfma_f32_32x32x16_bf16 v[176:191], v[252:255], v[120:123], v[176:191]
    v_cndmask_b32 v210, v171, v167, s[76:77]
    v_cndmask_b32 v211, v175, v171, s[76:77]
    v_mov_b32 v72, v175
    v_add_f32_dpp v162, v208, v162 wave_ror:1 row_mask:0xf bank_mask:0xf
    v_add_f32_dpp v166, v209, v166 wave_ror:1 row_mask:0xf bank_mask:0xf
    s_waitcnt lgkmcnt(3)
    v_mfma_f32_32x32x16_bf16 v[176:191], v[224:227], v[124:127], v[176:191]
    v_add_f32_dpp v170, v210, v170 wave_ror:1 row_mask:0xf bank_mask:0xf
    v_add_f32_dpp v174, v211, v174 wave_ror:1 row_mask:0xf bank_mask:0xf
    v_cndmask_b32 v208, v162, v71, s[76:77]
    v_cndmask_b32 v209, v166, v162, s[76:77]
    v_cndmask_b32 v210, v170, v166, s[76:77]
    v_cndmask_b32 v211, v174, v170, s[76:77]
    v_mfma_f32_32x32x16_bf16 v[176:191], v[228:231], v[128:131], v[176:191]
    ds_read_b64_tr_b16 v[228:229], v65 offset:1056
    ds_read_b64_tr_b16 v[230:231], v65 offset:1024
    v_mov_b32 v71, v174
    v_add_f32_dpp v161, v208, v161 wave_ror:1 row_mask:0xf bank_mask:0xf
    v_add_f32_dpp v165, v209, v165 wave_ror:1 row_mask:0xf bank_mask:0xf
    v_add_f32_dpp v169, v210, v169 wave_ror:1 row_mask:0xf bank_mask:0xf
    v_mfma_f32_32x32x16_bf16 v[176:191], v[232:235], v[132:135], v[176:191]
    ds_read_b64_tr_b16 v[232:233], v65 offset:1184
    ds_read_b64_tr_b16 v[234:235], v65 offset:1152
    v_add_f32_dpp v173, v211, v173 wave_ror:1 row_mask:0xf bank_mask:0xf
    v_cndmask_b32 v208, v161, v70, s[76:77]
    v_cndmask_b32 v209, v165, v161, s[76:77]
    v_cndmask_b32 v210, v169, v165, s[76:77]
    v_mfma_f32_32x32x16_bf16 v[176:191], v[236:239], v[136:139], v[176:191]
    ds_read_b64_tr_b16 v[236:237], v65 offset:1312
    ds_read_b64_tr_b16 v[238:239], v65 offset:1280
    v_cndmask_b32 v211, v173, v169, s[76:77]
    v_mov_b32_e64 v70, v173
    v_add_f32_dpp v160, v208, v160 wave_ror:1 row_mask:0xf bank_mask:0xf
    v_add_f32_dpp v164, v209, v164 wave_ror:1 row_mask:0xf bank_mask:0xf
    v_mfma_f32_32x32x16_bf16 v[176:191], v[240:243], v[140:143], v[176:191]
    ds_read_b128 v[240:243], v64 offset:512
    ds_read_b64_tr_b16 v[224:225], v65 offset:1440
    ds_read_b64_tr_b16 v[226:227], v65 offset:1408
    v_add_f32_dpp v168, v210, v168 wave_ror:1 row_mask:0xf bank_mask:0xf
    v_add_f32_dpp v172, v211, v172 wave_ror:1 row_mask:0xf bank_mask:0xf
    s_waitcnt lgkmcnt(7)
    v_mfma_f32_32x32x16_bf16 v[176:191], v[212:215], v[228:231], v[176:191]
    ds_read_b128 v[212:215], v64 offset:992
    ds_write_b32 v66, v160 offset:256
    ds_write_b32 v66, v164 offset:320
    s_waitcnt lgkmcnt(8)
    v_mfma_f32_32x32x16_bf16 v[176:191], v[216:219], v[232:235], v[176:191]
    ds_read_b128 v[216:219], v64 offset:960
    ds_write_b32 v66, v168 offset:384
    ds_write_b32 v66, v172 offset:448
    s_waitcnt lgkmcnt(9)
    v_mfma_f32_32x32x16_bf16 v[176:191], v[220:223], v[236:239], v[176:191]
    ds_read_b128 v[220:223], v64 offset:928
    s_waitcnt lgkmcnt(7)
    v_mfma_f32_32x32x16_bf16 v[176:191], v[240:243], v[224:227], v[176:191]
    ds_read_b128 v[240:243], v64 offset:896
    s_waitcnt lgkmcnt(2)
    s_waitcnt vmcnt(0)
    v_cmp_gt_u32_e64 vcc, 1, v7
    s_nop 0
    s_and_b64 vcc, vcc, s[50:51]
    s_cbranch_scc1 ps_36
pc_38:
    s_barrier
    v_mfma_f32_32x32x16_bf16 v[192:207], v[212:215], v[112:115], v[192:207]
    ds_read_b64 v[144:145], v67 offset:0
    ds_read_b64 v[146:147], v67 offset:4224
    ds_read_b64 v[148:149], v67 offset:8448
    ds_read_b64 v[150:151], v67 offset:12672
    s_lshl_b32 s25, s75, 14
    v_mfma_f32_32x32x16_bf16 v[192:207], v[216:219], v[116:119], v[192:207]
    s_add_u32 s25, s25, 9437184
    s_add_u32 m0, s92, 36352
    s_nop 0
    buffer_load_dwordx4 v73, s[16:19], s99 offen offset:0 sc1 lds
    buffer_load_dwordx4 v74, s[16:19], s99 offen offset:1024 sc1 lds
    buffer_load_dwordx4 v75, s[16:19], s99 offen offset:2048 sc1 lds
    s_waitcnt lgkmcnt(5)
    v_mfma_f32_32x32x16_bf16 v[192:207], v[220:223], v[120:123], v[192:207]
    buffer_load_dwordx4 v76, s[16:19], s99 offen offset:3072 sc1 lds
    s_waitcnt lgkmcnt(4)
    v_mfma_f32_32x32x16_bf16 v[192:207], v[240:243], v[124:127], v[192:207]
    ds_read_b128 v[212:215], v64 offset:768
    s_add_u32 m0, s93, 53760
    s_add_u32 s99, s99, 524288
    s_mov_b64 exec, s[80:81]
    buffer_load_dwordx4 v77, s[16:19], s100 offen sc1 lds
    s_mov_b64 exec, -1
    s_add_u32 s100, s100, 524288
    v_mfma_f32_32x32x16_bf16 v[192:207], v[244:247], v[128:131], v[192:207]
    ds_read_b128 v[244:247], v64 offset:736
    v_cndmask_b32 v208, v179, v72, s[76:77]
    v_cndmask_b32 v209, v183, v179, s[76:77]
    v_cndmask_b32 v210, v187, v183, s[76:77]
    v_cndmask_b32 v211, v191, v187, s[76:77]
    v_mov_b32_e64 v72, v191
    v_mfma_f32_32x32x16_bf16 v[192:207], v[248:251], v[132:135], v[192:207]
    ds_read_b128 v[248:251], v64 offset:704
    v_add_f32_dpp v178, v208, v178 wave_ror:1 row_mask:0xf bank_mask:0xf
    v_add_f32_dpp v182, v209, v182 wave_ror:1 row_mask:0xf bank_mask:0xf
    v_add_f32_dpp v186, v210, v186 wave_ror:1 row_mask:0xf bank_mask:0xf
    v_add_f32_dpp v190, v211, v190 wave_ror:1 row_mask:0xf bank_mask:0xf
    v_cndmask_b32 v208, v178, v71, s[76:77]
    v_mfma_f32_32x32x16_bf16 v[192:207], v[252:255], v[136:139], v[192:207]
    ds_read_b128 v[252:255], v64 offset:672
    v_cndmask_b32 v209, v182, v178, s[76:77]
    v_cndmask_b32 v210, v186, v182, s[76:77]
    v_cndmask_b32 v211, v190, v186, s[76:77]
    v_mov_b32 v71, v190
    s_waitcnt lgkmcnt(3)
    v_mfma_f32_32x32x16_bf16 v[192:207], v[212:215], v[140:143], v[192:207]
    ds_read_b128 v[216:219], v64 offset:640
    v_add_f32_dpp v177, v208, v177 wave_ror:1 row_mask:0xf bank_mask:0xf
    v_add_f32_dpp v181, v209, v181 wave_ror:1 row_mask:0xf bank_mask:0xf
    v_add_f32_dpp v185, v210, v185 wave_ror:1 row_mask:0xf bank_mask:0xf
    v_add_f32_dpp v189, v211, v189 wave_ror:1 row_mask:0xf bank_mask:0xf
    s_waitcnt lgkmcnt(3)
    v_mfma_f32_32x32x16_bf16 v[192:207], v[244:247], v[228:231], v[192:207]
    ds_read_b128 v[228:231], v64 offset:608
    ds_read_b64_tr_b16 v[220:221], v65 offset:1568
    ds_read_b64_tr_b16 v[222:223], v65 offset:1536
    v_cndmask_b32 v208, v177, v70, s[76:77]
    v_cndmask_b32 v209, v181, v177, s[76:77]
    s_waitcnt lgkmcnt(5)
    v_mfma_f32_32x32x16_bf16 v[192:207], v[248:251], v[232:235], v[192:207]
    ds_read_b128 v[232:235], v64 offset:576
    ds_read_b64_tr_b16 v[240:241], v65 offset:1696
    ds_read_b64_tr_b16 v[242:243], v65 offset:1664
    v_cndmask_b32 v210, v185, v181, s[76:77]
    v_cndmask_b32 v211, v189, v185, s[76:77]
    s_waitcnt lgkmcnt(7)
    v_mfma_f32_32x32x16_bf16 v[192:207], v[252:255], v[236:239], v[192:207]
    ds_read_b128 v[236:239], v64 offset:544
    ds_read_b64_tr_b16 v[212:213], v65 offset:1824
    ds_read_b64_tr_b16 v[214:215], v65 offset:1792
    v_mov_b32 v70, v189
    v_add_f32_dpp v176, v208, v176 wave_ror:1 row_mask:0xf bank_mask:0xf
    s_waitcnt lgkmcnt(9)
    v_mfma_f32_32x32x16_bf16 v[192:207], v[216:219], v[224:227], v[192:207]
    ds_read_b128 v[224:227], v64 offset:512
    ds_read_b64_tr_b16 v[244:245], v65 offset:1952
    ds_read_b64_tr_b16 v[246:247], v65 offset:1920
    v_add_f32_dpp v180, v209, v180 wave_ror:1 row_mask:0xf bank_mask:0xf
    v_add_f32_dpp v184, v210, v184 wave_ror:1 row_mask:0xf bank_mask:0xf
    s_waitcnt lgkmcnt(9)
    v_mfma_f32_32x32x16_bf16 v[192:207], v[228:231], v[220:223], v[192:207]
    v_add_f32_dpp v188, v211, v188 wave_ror:1 row_mask:0xf bank_mask:0xf
    ds_write_b32 v66, v176 offset:512
    s_waitcnt lgkmcnt(7)
    v_mfma_f32_32x32x16_bf16 v[192:207], v[232:235], v[240:243], v[192:207]
    ds_write_b32 v66, v180 offset:576
    ds_write_b32 v66, v184 offset:640
    s_waitcnt lgkmcnt(6)
    v_mfma_f32_32x32x16_bf16 v[192:207], v[236:239], v[212:215], v[192:207]
    ds_write_b32 v66, v188 offset:704
    v_add_f32 v144, v144, v80
    v_add_f32 v145, v145, v81
    s_waitcnt lgkmcnt(4)
    v_mfma_f32_32x32x16_bf16 v[192:207], v[224:227], v[244:247], v[192:207]
    v_add_f32 v146, v146, v82
    v_add_f32 v147, v147, v83
    v_add_f32 v148, v148, v84
    v_add_f32 v149, v149, v85
    v_add_f32 v150, v150, v86
    v_add_f32_e64 v151, v151, v87
    v_cvt_pk_bf16_f32 v160, v144, v146
    v_cvt_pk_bf16_f32 v161, v148, v150
    v_cvt_pk_bf16_f32 v162, v145, v147
    v_cvt_pk_bf16_f32 v163, v149, v151
    buffer_store_dwordx4 v[160:163], v62, s[16:19], s25 offen offset:2048 sc1
    s_add_u32 m0, s92, 55936
    s_nop 0
    s_nop 0
    buffer_load_dwordx4 v73, s[16:19], s99 offen offset:0 sc1 lds
    buffer_load_dwordx4 v74, s[16:19], s99 offen offset:1024 sc1 lds
    buffer_load_dwordx4 v75, s[16:19], s99 offen offset:2048 sc1 lds
    buffer_load_dwordx4 v76, s[16:19], s99 offen offset:3072 sc1 lds
    s_add_u32 m0, s93, 73344
    s_add_u32 s99, s99, 524288
    s_mov_b64 exec, s[80:81]
    buffer_load_dwordx4 v77, s[16:19], s100 offen sc1 lds
    s_mov_b64 exec, -1
    s_add_u32 s100, s100, 524288
    s_add_u32 m0, s92, 75520
    s_nop 0
    s_nop 0
    buffer_load_dwordx4 v73, s[16:19], s99 offen offset:0 sc1 lds
    buffer_load_dwordx4 v74, s[16:19], s99 offen offset:1024 sc1 lds
    buffer_load_dwordx4 v75, s[16:19], s99 offen offset:2048 sc1 lds
    buffer_load_dwordx4 v76, s[16:19], s99 offen offset:3072 sc1 lds
    s_add_u32 m0, s93, 92928
    s_add_u32 s99, s99, 524288
    s_mov_b64 exec, s[80:81]
    buffer_load_dwordx4 v77, s[16:19], s100 offen sc1 lds
    s_mov_b64 exec, -1
    s_add_u32 s100, s100, 524288
    v_cndmask_b32 v208, v195, v72, s[76:77]
    v_cndmask_b32 v209, v199, v195, s[76:77]
    v_cndmask_b32 v210, v203, v199, s[76:77]
    v_cndmask_b32 v211, v207, v203, s[76:77]
    v_mov_b32_e64 v72, v207
    v_add_f32_dpp v194, v208, v194 wave_ror:1 row_mask:0xf bank_mask:0xf
    v_add_f32_dpp v198, v209, v198 wave_ror:1 row_mask:0xf bank_mask:0xf
    v_add_f32_dpp v202, v210, v202 wave_ror:1 row_mask:0xf bank_mask:0xf
    v_add_f32_dpp v206, v211, v206 wave_ror:1 row_mask:0xf bank_mask:0xf
    v_cndmask_b32 v208, v194, v71, s[76:77]
    v_cndmask_b32 v209, v198, v194, s[76:77]
    v_cndmask_b32 v210, v202, v198, s[76:77]
    v_cndmask_b32 v211, v206, v202, s[76:77]
    v_mov_b32_e64 v71, v206
    v_add_f32_dpp v193, v208, v193 wave_ror:1 row_mask:0xf bank_mask:0xf
    v_add_f32_dpp v197, v209, v197 wave_ror:1 row_mask:0xf bank_mask:0xf
    v_add_f32_dpp v201, v210, v201 wave_ror:1 row_mask:0xf bank_mask:0xf
    v_add_f32_dpp v205, v211, v205 wave_ror:1 row_mask:0xf bank_mask:0xf
    v_cndmask_b32 v208, v193, v70, s[76:77]
    v_cndmask_b32 v209, v197, v193, s[76:77]
    v_cndmask_b32 v210, v201, v197, s[76:77]
    v_cndmask_b32 v211, v205, v201, s[76:77]
    v_mov_b32_e64 v70, v205
    v_add_f32_dpp v192, v208, v192 wave_ror:1 row_mask:0xf bank_mask:0xf
    v_add_f32_dpp v196, v209, v196 wave_ror:1 row_mask:0xf bank_mask:0xf
    v_add_f32_dpp v200, v210, v200 wave_ror:1 row_mask:0xf bank_mask:0xf
    v_add_f32_dpp v204, v211, v204 wave_ror:1 row_mask:0xf bank_mask:0xf
    ds_write_b32 v66, v192 offset:768
    ds_write_b32 v66, v196 offset:832
    ds_write_b32 v66, v200 offset:896
    ds_write_b32 v66, v204 offset:960
    s_waitcnt lgkmcnt(0)
    s_barrier
    ds_read_b64 v[152:153], v67 offset:512
    ds_read_b64 v[154:155], v67 offset:4736
    ds_read_b64 v[156:157], v67 offset:8960
    ds_read_b64 v[158:159], v67 offset:13184
    s_lshl_b32 s25, s75, 14
    s_add_u32 s25, s25, 9437184
    s_waitcnt lgkmcnt(0)
    v_add_f32 v152, v152, v88
    v_add_f32 v153, v153, v89
    v_add_f32 v154, v154, v90
    v_add_f32 v155, v155, v91
    v_add_f32 v156, v156, v92
    v_add_f32 v157, v157, v93
    v_add_f32 v158, v158, v94
    v_add_f32 v159, v159, v95
    v_cvt_pk_bf16_f32 v164, v152, v154
    v_cvt_pk_bf16_f32 v165, v156, v158
    v_cvt_pk_bf16_f32 v166, v153, v155
    v_cvt_pk_bf16_f32 v167, v157, v159
    buffer_store_dwordx4 v[164:167], v62, s[16:19], s25 offen offset:3072 sc1
    v_mov_b32_e64 v5, 1
    s_add_u32 s82, s86, 24576
    buffer_atomic_add v5, v6, s[16:19], s82 offen offset:4 sc0 sc1
    s_branch ec_27
nc_26:
    v_lshlrev_b32 v2, 3, v4
    v_mov_b32_e64 v5, 1
    v_cndmask_b32 v2, v4, v2, s[50:51]
    buffer_atomic_add v5, v2, s[16:19], s86 offen offset:8 sc1
    buffer_load_dword v7, v4, s[16:19], s87 offen offset:8 sc1
    s_waitcnt vmcnt(0)
    v_cmp_gt_u32 vcc, 12, v7
    s_nop 0
    s_and_b64 vcc, vcc, s[50:51]
    s_cbranch_scc1 ps_39
pc_41:
    v_mov_b32 v100, -1
    v_mov_b32 v101, -1
    v_mov_b32 v102, -1
    v_mov_b32 v103, -1
    v_lshlrev_b32 v104, 4, v0
    s_sub_u32 s88, s2, 160
    s_mul_i32 s88, s88, 57344
    s_min_u32 s88, s88, 5185536
    s_add_u32 s88, s88, 12058624
    buffer_store_dwordx4 v[100:103], v104, s[16:19], s88 offen sc1
    s_add_u32 s88, s88, 4096
    buffer_store_dwordx4 v[100:103], v104, s[16:19], s88 offen sc1
    s_add_u32 s88, s88, 4096
    buffer_store_dwordx4 v[100:103], v104, s[16:19], s88 offen sc1
    s_add_u32 s88, s88, 4096
    buffer_store_dwordx4 v[100:103], v104, s[16:19], s88 offen sc1
    s_add_u32 s88, s88, 4096
    buffer_store_dwordx4 v[100:103], v104, s[16:19], s88 offen sc1
    s_add_u32 s88, s88, 4096
    buffer_store_dwordx4 v[100:103], v104, s[16:19], s88 offen sc1
    s_add_u32 s88, s88, 4096
    buffer_store_dwordx4 v[100:103], v104, s[16:19], s88 offen sc1
    s_add_u32 s88, s88, 4096
    buffer_store_dwordx4 v[100:103], v104, s[16:19], s88 offen sc1
    s_add_u32 s88, s88, 4096
    buffer_store_dwordx4 v[100:103], v104, s[16:19], s88 offen sc1
    s_add_u32 s88, s88, 4096
    buffer_store_dwordx4 v[100:103], v104, s[16:19], s88 offen sc1
    s_add_u32 s88, s88, 4096
    buffer_store_dwordx4 v[100:103], v104, s[16:19], s88 offen sc1
    s_add_u32 s88, s88, 4096
    buffer_store_dwordx4 v[100:103], v104, s[16:19], s88 offen sc1
    s_add_u32 s88, s88, 4096
    buffer_store_dwordx4 v[100:103], v104, s[16:19], s88 offen sc1
    s_add_u32 s88, s88, 4096
    buffer_store_dwordx4 v[100:103], v104, s[16:19], s88 offen sc1
    s_waitcnt vmcnt(0)
    s_barrier
    v_mov_b32_e64 v5, 1
    s_add_u32 s82, s86, 8192
    buffer_atomic_add v5, v6, s[16:19], s82 offen offset:12 sc0 sc1
    s_waitcnt vmcnt(0)
    v_cmp_eq_u32 vcc, 11, v5
    s_nop 0
    s_cbranch_vccnz gl_42
gc_43:
    buffer_load_dword v7, v4, s[16:19], s89 offen offset:0 sc1
    s_waitcnt vmcnt(0)
    v_cmp_gt_u32 vcc, 1, v7
    s_nop 0
    s_and_b64 vcc, vcc, s[50:51]
    s_cbranch_scc1 ps_44
pc_46:
    s_barrier
    s_sub_u32 s3, s2, 160
    s_and_b32 s3, s3, 63
    s_add_u32 s3, s3, 0
    s_and_b32 s25, s3, 3
    s_lshl_b32 s25, s25, 12
    s_lshr_b32 s26, s3, 2
    s_lshl_b32 s26, s26, 7
    s_add_u32 s3, s25, s26
    v_lshrrev_b32 v236, 3, v0
    v_and_b32 v237, 7, v0
    v_lshlrev_b32 v237, 4, v237
    v_lshl_add_u32 v236, v236, 14, v237
    s_sub_u32 s25, s2, 160
    s_cmp_lt_u32 s25, 64
    s_cselect_b32 s25, 0, 1073741824
    v_add_u32_e64 v236, s25, v236
    s_add_u32 s26, s3, 9437184
    buffer_load_dwordx4 v[216:219], v236, s[16:19], s26 offen sc1
    s_add_u32 s26, s26, 524288
    buffer_load_dwordx4 v[220:223], v236, s[16:19], s26 offen sc1
    s_add_u32 s26, s26, 524288
    buffer_load_dwordx4 v[224:227], v236, s[16:19], s26 offen sc1
    s_add_u32 s26, s26, 524288
    buffer_load_dwordx4 v[228:231], v236, s[16:19], s26 offen sc1
    s_add_u32 s26, s26, 524288
    buffer_load_dwordx4 v[232:235], v236, s[16:19], s26 offen sc1
    s_lshl_b32 s25, s72, 5
    s_add_u32 s25, s25, 0
    s_sub_u32 s26, s25, 4
    s_max_i32 s26, s26, 0
    s_lshl_b32 s27, s71, 12
    s_add_u32 s27, s27, 9437184
    s_lshl_b32 s99, s25, 3
    s_lshl_b32 s100, s26, 3
    s_lshl_b32 s92, s24, 12
    s_lshl_b32 s93, s24, 9
    s_add_u32 s99, s99, s27
    s_add_u32 s100, s100, s27
    s_add_u32 m0, s92, 36352
    s_nop 0
    buffer_load_dwordx4 v73, s[16:19], s99 offen offset:0 sc1 lds
    buffer_load_dwordx4 v74, s[16:19], s99 offen offset:1024 sc1 lds
    buffer_load_dwordx4 v75, s[16:19], s99 offen offset:2048 sc1 lds
    buffer_load_dwordx4 v76, s[16:19], s99 offen offset:3072 sc1 lds
    s_add_u32 m0, s93, 53760
    s_add_u32 s99, s99, 524288
    s_mov_b64 exec, s[80:81]
    buffer_load_dwordx4 v77, s[16:19], s100 offen sc1 lds
    s_mov_b64 exec, -1
    s_add_u32 s100, s100, 524288
    s_add_u32 m0, s92, 55936
    s_nop 0
    s_nop 0
    buffer_load_dwordx4 v73, s[16:19], s99 offen offset:0 sc1 lds
    buffer_load_dwordx4 v74, s[16:19], s99 offen offset:1024 sc1 lds
    buffer_load_dwordx4 v75, s[16:19], s99 offen offset:2048 sc1 lds
    buffer_load_dwordx4 v76, s[16:19], s99 offen offset:3072 sc1 lds
    s_add_u32 m0, s93, 73344
    s_add_u32 s99, s99, 524288
    s_mov_b64 exec, s[80:81]
    buffer_load_dwordx4 v77, s[16:19], s100 offen sc1 lds
    s_mov_b64 exec, -1
    s_add_u32 s100, s100, 524288
    s_sub_u32 s85, s2, 160
    s_cmp_ge_u32 s85, 64
    s_cbranch_scc1 s2_47
    v_mov_b32 v238, 0x3f803f80
    s_lshl_b32 s25, s24, 7
    s_add_u32 s25, s25, 134272
    v_lshrrev_b32 v239, 4, v1
    v_lshl_add_u32 v237, v239, 2, v237
    v_add_u32 v237, s25, v237
se_48:
    v_mov_b32 v240, 0
    v_mov_b32 v241, 0
    v_mov_b32 v242, 0
    v_mov_b32 v243, 0
    s_waitcnt vmcnt(14)
    v_dot2c_f32_bf16 v240, v216, v238
    v_dot2c_f32_bf16 v241, v216, v216
    v_dot2c_f32_bf16 v240, v217, v238
    v_dot2c_f32_bf16 v241, v217, v217
    v_dot2c_f32_bf16 v242, v218, v238
    v_dot2c_f32_bf16 v243, v218, v218
    v_dot2c_f32_bf16 v242, v219, v238
    v_dot2c_f32_bf16 v243, v219, v219
    s_waitcnt vmcnt(13)
    v_dot2c_f32_bf16 v240, v220, v238
    v_dot2c_f32_bf16 v241, v220, v220
    v_dot2c_f32_bf16 v240, v221, v238
    v_dot2c_f32_bf16 v241, v221, v221
    v_dot2c_f32_bf16 v242, v222, v238
    v_dot2c_f32_bf16 v243, v222, v222
    v_dot2c_f32_bf16 v242, v223, v238
    v_dot2c_f32_bf16 v243, v223, v223
    s_waitcnt vmcnt(12)
    v_dot2c_f32_bf16 v240, v224, v238
    v_dot2c_f32_bf16 v241, v224, v224
    v_dot2c_f32_bf16 v240, v225, v238
    v_dot2c_f32_bf16 v241, v225, v225
    v_dot2c_f32_bf16 v242, v226, v238
    v_dot2c_f32_bf16 v243, v226, v226
    v_dot2c_f32_bf16 v242, v227, v238
    v_dot2c_f32_bf16 v243, v227, v227
    s_waitcnt vmcnt(11)
    v_dot2c_f32_bf16 v240, v228, v238
    v_dot2c_f32_bf16 v241, v228, v228
    v_dot2c_f32_bf16 v240, v229, v238
    v_dot2c_f32_bf16 v241, v229, v229
    v_dot2c_f32_bf16 v242, v230, v238
    v_dot2c_f32_bf16 v243, v230, v230
    v_dot2c_f32_bf16 v242, v231, v238
    v_dot2c_f32_bf16 v243, v231, v231
    s_waitcnt vmcnt(10)
    v_dot2c_f32_bf16 v240, v232, v238
    v_dot2c_f32_bf16 v241, v232, v232
    v_dot2c_f32_bf16 v240, v233, v238
    v_dot2c_f32_bf16 v241, v233, v233
    v_dot2c_f32_bf16 v242, v234, v238
    v_dot2c_f32_bf16 v243, v234, v234
    v_dot2c_f32_bf16 v242, v235, v238
    v_dot2c_f32_bf16 v243, v235, v235
    s_nop 2
    v_cmp_u_f32 vcc, v241, v243
    s_nop 0
    s_cbranch_vccnz rd_49
rc_50:
    v_permlane32_swap_b32 v240, v242
    v_permlane32_swap_b32 v241, v243
    v_pk_add_f32 v[240:241], v[240:241], v[242:243]
    s_nop 1
    v_permlane16_swap_b32 v240, v241
    v_add_f32 v240, v240, v241
    s_nop 1
    v_add_f32_dpp v240, v240, v240 row_ror:8 row_mask:0xf bank_mask:0xf
    ds_write_b32 v237, v240
    v_and_b32 v236, 15, v0
    v_lshlrev_b32 v236, 3, v236
    v_add_u32 v237, 134272, v236
    v_mov_b32 v239, 1073741824
    v_cmp_gt_u32 vcc, 16, v0
    s_nop 1
    v_cndmask_b32 v236, v239, v236, vcc
    s_add_u32 s25, s3, 3457024
    s_waitcnt lgkmcnt(0)
    s_barrier
    ds_read_b64 v[216:217], v237 offset:0
    ds_read_b64 v[218:219], v237 offset:128
    ds_read_b64 v[220:221], v237 offset:256
    ds_read_b64 v[222:223], v237 offset:384
    s_waitcnt lgkmcnt(2)
    v_pk_add_f32 v[216:217], v[216:217], v[218:219]
    s_waitcnt lgkmcnt(0)
    v_pk_add_f32 v[220:221], v[220:221], v[222:223]
    v_pk_add_f32 v[216:217], v[216:217], v[220:221]
    v_mul_f32 v239, 0x3acccccd, v216
    v_mul_f32 v217, 0x3acccccd, v217
    v_fma_f32 v217, -v239, v239, v217
    v_max_f32 v217, 0, v217
    v_add_f32 v217, 0x3727c5ac, v217
    v_rsq_f32_e64 v216, v217
    s_nop 0
    v_mul_f32 v217, -v239, v216
    buffer_store_dwordx2 v[216:217], v236, s[16:19], s25 offen sc1
s2_47:
    s_add_u32 m0, s92, 75520
    s_nop 0
    s_nop 0
    buffer_load_dwordx4 v73, s[16:19], s99 offen offset:0 sc1 lds
    buffer_load_dwordx4 v74, s[16:19], s99 offen offset:1024 sc1 lds
    buffer_load_dwordx4 v75, s[16:19], s99 offen offset:2048 sc1 lds
    buffer_load_dwordx4 v76, s[16:19], s99 offen offset:3072 sc1 lds
    s_add_u32 m0, s93, 92928
    s_add_u32 s99, s99, 524288
    s_mov_b64 exec, s[80:81]
    buffer_load_dwordx4 v77, s[16:19], s100 offen sc1 lds
    s_mov_b64 exec, -1
    s_add_u32 s100, s100, 524288
ec_27:
ge_51:
    v_add_u32 v196, 36352, v78
    v_mov_b32_e64 v198, v79
    s_waitcnt vmcnt(10)
    s_barrier
    ds_read_b64 v[160:161], v198 offset:0
    ds_read_b64 v[162:163], v198 offset:64
    ds_read_b64 v[164:165], v196 offset:0
    ds_read_b64 v[166:167], v196 offset:512
    ds_read_b64 v[168:169], v196 offset:256
    ds_read_b64 v[170:171], v196 offset:768
    ds_read_b64 v[172:173], v198 offset:256
    ds_read_b64 v[174:175], v198 offset:320
    ds_read_b64 v[176:177], v196 offset:2048
    ds_read_b64 v[178:179], v196 offset:2560
    ds_read_b64 v[180:181], v196 offset:2304
    ds_read_b64 v[182:183], v196 offset:2816
    s_waitcnt lgkmcnt(6)
    v_mfma_f32_16x16x32_bf16 v[112:115], a[0:3], v[160:163], 0
    ds_read_b64 v[184:185], v198 offset:512
    v_mfma_f32_32x32x16_bf16 v[80:95], a[0:3], v[164:167], 0
    ds_read_b64 v[186:187], v198 offset:576
    ds_read_b64 v[188:189], v196 offset:4096
    ds_read_b64 v[190:191], v196 offset:4608
    v_mov_b32 v208, 0
    v_mov_b32_e64 v209, 0
    v_mfma_f32_32x32x16_bf16 v[96:111], a[0:3], v[168:171], 0
    ds_read_b64 v[192:193], v196 offset:4352
    ds_read_b64 v[194:195], v196 offset:4864
    buffer_load_dword v7, v4, s[16:19], s87 offen offset:12 sc1
    s_waitcnt lgkmcnt(6)
    v_mfma_f32_16x16x32_bf16 v[112:115], a[4:7], v[172:175], v[112:115]
    ds_read_b64 v[160:161], v198 offset:768
    v_mfma_f32_32x32x16_bf16 v[80:95], a[4:7], v[176:179], v[80:95]
    ds_read_b64 v[162:163], v198 offset:832
    ds_read_b64 v[164:165], v196 offset:6144
    ds_read_b64 v[166:167], v196 offset:6656
    v_lshrrev_b32 v210, 5, v0
    v_mul_u32_u24 v210, 1600, v210
    v_mfma_f32_32x32x16_bf16 v[96:111], a[4:7], v[180:183], v[96:111]
    ds_read_b64 v[168:169], v196 offset:6400
    ds_read_b64 v[170:171], v196 offset:6912
    s_add_u32 m0, s92, 95104
    s_nop 0
    buffer_load_dwordx4 v73, s[16:19], s99 offen offset:0 sc1 lds
    s_waitcnt lgkmcnt(6)
    v_mfma_f32_16x16x32_bf16 v[112:115], a[8:11], v[184:187], v[112:115]
    ds_read_b64 v[172:173], v198 offset:1024
    v_mfma_f32_32x32x16_bf16 v[80:95], a[8:11], v[188:191], v[80:95]
    ds_read_b64 v[174:175], v198 offset:1088
    ds_read_b64 v[176:177], v196 offset:8192
    ds_read_b64 v[178:179], v196 offset:8704
    v_and_b32 v211, 31, v0
    v_min_u32 v211, 19, v211
    v_mfma_f32_32x32x16_bf16 v[96:111], a[8:11], v[192:195], v[96:111]
    ds_read_b64 v[180:181], v196 offset:8448
    ds_read_b64 v[182:183], v196 offset:8960
    buffer_load_dwordx4 v74, s[16:19], s99 offen offset:1024 sc1 lds
    v_lshl_add_u32 v210, v211, 3, v210
    s_waitcnt lgkmcnt(6)
    v_mfma_f32_16x16x32_bf16 v[112:115], a[12:15], v[160:163], v[112:115]
    ds_read_b64 v[184:185], v198 offset:1280
    v_mfma_f32_32x32x16_bf16 v[80:95], a[12:15], v[164:167], v[80:95]
    ds_read_b64 v[186:187], v198 offset:1344
    ds_read_b64 v[188:189], v196 offset:10240
    ds_read_b64 v[190:191], v196 offset:10752
    v_add_u32 v210, 6400, v210
    ds_write_b64 v210, v[208:209]
    v_mfma_f32_32x32x16_bf16 v[96:111], a[12:15], v[168:171], v[96:111]
    ds_read_b64 v[192:193], v196 offset:10496
    ds_read_b64 v[194:195], v196 offset:11008
    buffer_load_dwordx4 v75, s[16:19], s99 offen offset:2048 sc1 lds
    s_waitcnt lgkmcnt(7)
    v_mfma_f32_16x16x32_bf16 v[112:115], a[16:19], v[172:175], v[112:115]
    ds_read_b64 v[160:161], v198 offset:1536
    v_mfma_f32_32x32x16_bf16 v[80:95], a[16:19], v[176:179], v[80:95]
    ds_read_b64 v[162:163], v198 offset:1600
    ds_read_b64 v[164:165], v196 offset:12288
    ds_read_b64 v[166:167], v196 offset:12800
    v_mfma_f32_32x32x16_bf16 v[96:111], a[16:19], v[180:183], v[96:111]
    ds_read_b64 v[168:169], v196 offset:12544
    ds_read_b64 v[170:171], v196 offset:13056
    buffer_load_dwordx4 v76, s[16:19], s99 offen offset:3072 sc1 lds
    s_waitcnt lgkmcnt(6)
    v_mfma_f32_16x16x32_bf16 v[112:115], a[20:23], v[184:187], v[112:115]
    ds_read_b64 v[172:173], v198 offset:1792
    v_mfma_f32_32x32x16_bf16 v[80:95], a[20:23], v[188:191], v[80:95]
    ds_read_b64 v[174:175], v198 offset:1856
    ds_read_b64 v[176:177], v196 offset:14336
    ds_read_b64 v[178:179], v196 offset:14848
    v_mfma_f32_32x32x16_bf16 v[96:111], a[20:23], v[192:195], v[96:111]
    ds_read_b64 v[180:181], v196 offset:14592
    ds_read_b64 v[182:183], v196 offset:15104
    s_add_u32 m0, s93, 112512
    s_add_u32 s99, s99, 524288
    s_mov_b64 exec, s[80:81]
    buffer_load_dwordx4 v77, s[16:19], s100 offen sc1 lds
    s_mov_b64 exec, -1
    s_add_u32 s100, s100, 524288
    s_waitcnt vmcnt(6)
    v_cmp_eq_u32 vcc, 19, v5
    s_nop 0
    s_cbranch_vccnz gl_52
gc_53:
    s_barrier
    s_waitcnt lgkmcnt(6)
    v_mfma_f32_16x16x32_bf16 v[112:115], a[24:27], v[160:163], v[112:115]
    v_add_u32 v198, v49, v198
    v_mfma_f32_32x32x16_bf16 v[80:95], a[24:27], v[164:167], v[80:95]
    v_add_u32 v196, 19584, v196
    ds_read_b64 v[184:185], v198 offset:0
    ds_read_b64 v[186:187], v198 offset:64
    ds_read_b64 v[188:189], v196 offset:0
    v_mfma_f32_32x32x16_bf16 v[96:111], a[24:27], v[168:171], v[96:111]
    ds_read_b64 v[190:191], v196 offset:512
    ds_read_b64 v[192:193], v196 offset:256
    ds_read_b64 v[194:195], v196 offset:768
    s_add_u32 m0, s92, 114688
    s_nop 0
    buffer_load_dwordx4 v73, s[16:19], s99 offen offset:0 sc1 lds
    s_waitcnt lgkmcnt(6)
    v_mfma_f32_16x16x32_bf16 v[112:115], a[28:31], v[172:175], v[112:115]
    ds_read_b64 v[160:161], v198 offset:256
    v_mfma_f32_32x32x16_bf16 v[80:95], a[28:31], v[176:179], v[80:95]
    ds_read_b64 v[162:163], v198 offset:320
    ds_read_b64 v[164:165], v196 offset:2048
    ds_read_b64 v[166:167], v196 offset:2560
    v_mfma_f32_32x32x16_bf16 v[96:111], a[28:31], v[180:183], v[96:111]
    ds_read_b64 v[168:169], v196 offset:2304
    ds_read_b64 v[170:171], v196 offset:2816
    buffer_load_dwordx4 v74, s[16:19], s99 offen offset:1024 sc1 lds
    s_waitcnt lgkmcnt(6)
    v_mfma_f32_16x16x32_bf16 v[112:115], a[32:35], v[184:187], v[112:115]
    ds_read_b64 v[172:173], v198 offset:512
    v_mfma_f32_32x32x16_bf16 v[80:95], a[32:35], v[188:191], v[80:95]
    ds_read_b64 v[174:175], v198 offset:576
    ds_read_b64 v[176:177], v196 offset:4096
    ds_read_b64 v[178:179], v196 offset:4608
    v_mfma_f32_32x32x16_bf16 v[96:111], a[32:35], v[192:195], v[96:111]
    ds_read_b64 v[180:181], v196 offset:4352
    ds_read_b64 v[182:183], v196 offset:4864
    buffer_load_dwordx4 v75, s[16:19], s99 offen offset:2048 sc1 lds
    s_waitcnt lgkmcnt(6)
    v_mfma_f32_16x16x32_bf16 v[112:115], a[36:39], v[160:163], v[112:115]
    ds_read_b64 v[184:185], v198 offset:768
    v_mfma_f32_32x32x16_bf16 v[80:95], a[36:39], v[164:167], v[80:95]
    ds_read_b64 v[186:187], v198 offset:832
    ds_read_b64 v[188:189], v196 offset:6144
    ds_read_b64 v[190:191], v196 offset:6656
    v_mfma_f32_32x32x16_bf16 v[96:111], a[36:39], v[168:171], v[96:111]
    ds_read_b64 v[192:193], v196 offset:6400
    ds_read_b64 v[194:195], v196 offset:6912
    buffer_load_dwordx4 v76, s[16:19], s99 offen offset:3072 sc1 lds
    s_waitcnt lgkmcnt(6)
    v_mfma_f32_16x16x32_bf16 v[112:115], a[40:43], v[172:175], v[112:115]
    ds_read_b64 v[160:161], v198 offset:1024
    v_mfma_f32_32x32x16_bf16 v[80:95], a[40:43], v[176:179], v[80:95]
    ds_read_b64 v[162:163], v198 offset:1088
    ds_read_b64 v[164:165], v196 offset:8192
    ds_read_b64 v[166:167], v196 offset:8704
    v_mfma_f32_32x32x16_bf16 v[96:111], a[40:43], v[180:183], v[96:111]
    ds_read_b64 v[168:169], v196 offset:8448
    ds_read_b64 v[170:171], v196 offset:8960
    s_add_u32 m0, s93, 132096
    s_add_u32 s99, s99, 524288
    s_mov_b64 exec, s[80:81]
    buffer_load_dwordx4 v77, s[16:19], s100 offen sc1 lds
    s_mov_b64 exec, -1
    s_add_u32 s100, s100, 524288
    s_waitcnt lgkmcnt(6)
    v_mfma_f32_16x16x32_bf16 v[112:115], a[44:47], v[184:187], v[112:115]
    ds_read_b64 v[172:173], v198 offset:1280
    v_mfma_f32_32x32x16_bf16 v[80:95], a[44:47], v[188:191], v[80:95]
    ds_read_b64 v[174:175], v198 offset:1344
    ds_read_b64 v[176:177], v196 offset:10240
    ds_read_b64 v[178:179], v196 offset:10752
    v_mfma_f32_32x32x16_bf16 v[96:111], a[44:47], v[192:195], v[96:111]
    ds_read_b64 v[180:181], v196 offset:10496
    ds_read_b64 v[182:183], v196 offset:11008
    s_lshl_b32 s25, s72, 5
    s_add_u32 s25, s25, 256
    s_sub_u32 s26, s25, 4
    s_max_i32 s26, s26, 0
    s_lshl_b32 s27, s71, 12
    s_add_u32 s27, s27, 9437184
    s_lshl_b32 s99, s25, 3
    s_lshl_b32 s100, s26, 3
    s_lshl_b32 s92, s24, 12
    s_lshl_b32 s93, s24, 9
    s_add_u32 s99, s99, s27
    s_add_u32 s100, s100, s27
    s_waitcnt lgkmcnt(6)
    v_mfma_f32_16x16x32_bf16 v[112:115], a[48:51], v[160:163], v[112:115]
    ds_read_b64 v[184:185], v198 offset:1536
    v_mfma_f32_32x32x16_bf16 v[80:95], a[48:51], v[164:167], v[80:95]
    ds_read_b64 v[186:187], v198 offset:1600
    ds_read_b64 v[188:189], v196 offset:12288
    ds_read_b64 v[190:191], v196 offset:12800
    v_mfma_f32_32x32x16_bf16 v[96:111], a[48:51], v[168:171], v[96:111]
    ds_read_b64 v[192:193], v196 offset:12544
    ds_read_b64 v[194:195], v196 offset:13056
    s_waitcnt lgkmcnt(6)
    v_mfma_f32_16x16x32_bf16 v[112:115], a[52:55], v[172:175], v[112:115]
    ds_read_b64 v[160:161], v198 offset:1792
    v_mfma_f32_32x32x16_bf16 v[80:95], a[52:55], v[176:179], v[80:95]
    ds_read_b64 v[162:163], v198 offset:1856
    ds_read_b64 v[164:165], v196 offset:14336
    ds_read_b64 v[166:167], v196 offset:14848
    v_mfma_f32_32x32x16_bf16 v[96:111], a[52:55], v[180:183], v[96:111]
    ds_read_b64 v[168:169], v196 offset:14592
    ds_read_b64 v[170:171], v196 offset:15104
    s_waitcnt vmcnt(10)
    v_cmp_gt_u32 vcc, 1, v7
    s_nop 0
    s_and_b64 vcc, vcc, s[50:51]
    s_cbranch_scc1 ps_54
pc_56:
    s_barrier
    s_waitcnt lgkmcnt(6)
    v_mfma_f32_16x16x32_bf16 v[112:115], a[56:59], v[184:187], v[112:115]
    v_add_u32 v198, v49, v198
    v_mfma_f32_32x32x16_bf16 v[80:95], a[56:59], v[188:191], v[80:95]
    v_add_u32 v196, 19584, v196
    ds_read_b64 v[172:173], v198 offset:0
    ds_read_b64 v[174:175], v198 offset:64
    ds_read_b64 v[176:177], v196 offset:0
    v_mfma_f32_32x32x16_bf16 v[96:111], a[56:59], v[192:195], v[96:111]
    ds_read_b64 v[178:179], v196 offset:512
    ds_read_b64 v[180:181], v196 offset:256
    ds_read_b64 v[182:183], v196 offset:768
    s_waitcnt lgkmcnt(6)
    v_mfma_f32_16x16x32_bf16 v[112:115], a[60:63], v[160:163], v[112:115]
    ds_read_b64 v[184:185], v198 offset:256
    v_mfma_f32_32x32x16_bf16 v[80:95], a[60:63], v[164:167], v[80:95]
    ds_read_b64 v[186:187], v198 offset:320
    ds_read_b64 v[188:189], v196 offset:2048
    ds_read_b64 v[190:191], v196 offset:2560
    v_mfma_f32_32x32x16_bf16 v[96:111], a[60:63], v[168:171], v[96:111]
    ds_read_b64 v[192:193], v196 offset:2304
    ds_read_b64 v[194:195], v196 offset:2816
    s_waitcnt lgkmcnt(6)
    v_mfma_f32_16x16x32_bf16 v[112:115], a[64:67], v[172:175], v[112:115]
    ds_read_b64 v[160:161], v198 offset:512
    v_mfma_f32_32x32x16_bf16 v[80:95], a[64:67], v[176:179], v[80:95]
    ds_read_b64 v[162:163], v198 offset:576
    ds_read_b64 v[164:165], v196 offset:4096
    ds_read_b64 v[166:167], v196 offset:4608
    v_mfma_f32_32x32x16_bf16 v[96:111], a[64:67], v[180:183], v[96:111]
    ds_read_b64 v[168:169], v196 offset:4352
    ds_read_b64 v[170:171], v196 offset:4864
    s_waitcnt lgkmcnt(6)
    v_mfma_f32_16x16x32_bf16 v[112:115], a[68:71], v[184:187], v[112:115]
    ds_read_b64 v[172:173], v198 offset:768
    v_mfma_f32_32x32x16_bf16 v[80:95], a[68:71], v[188:191], v[80:95]
    ds_read_b64 v[174:175], v198 offset:832
    ds_read_b64 v[176:177], v196 offset:6144
    ds_read_b64 v[178:179], v196 offset:6656
    v_mfma_f32_32x32x16_bf16 v[96:111], a[68:71], v[192:195], v[96:111]
    ds_read_b64 v[180:181], v196 offset:6400
    ds_read_b64 v[182:183], v196 offset:6912
    s_waitcnt lgkmcnt(6)
    v_mfma_f32_16x16x32_bf16 v[112:115], a[72:75], v[160:163], v[112:115]
    ds_read_b64 v[184:185], v198 offset:1024
    v_mfma_f32_32x32x16_bf16 v[80:95], a[72:75], v[164:167], v[80:95]
    ds_read_b64 v[186:187], v198 offset:1088
    ds_read_b64 v[188:189], v196 offset:8192
    ds_read_b64 v[190:191], v196 offset:8704
    v_mfma_f32_32x32x16_bf16 v[96:111], a[72:75], v[168:171], v[96:111]
    ds_read_b64 v[192:193], v196 offset:8448
    ds_read_b64 v[194:195], v196 offset:8960
    s_waitcnt lgkmcnt(6)
    v_mfma_f32_16x16x32_bf16 v[112:115], a[76:79], v[172:175], v[112:115]
    ds_read_b64 v[160:161], v198 offset:1280
    v_mfma_f32_32x32x16_bf16 v[80:95], a[76:79], v[176:179], v[80:95]
    ds_read_b64 v[162:163], v198 offset:1344
    ds_read_b64 v[164:165], v196 offset:10240
    ds_read_b64 v[166:167], v196 offset:10752
    v_mfma_f32_32x32x16_bf16 v[96:111], a[76:79], v[180:183], v[96:111]
    ds_read_b64 v[168:169], v196 offset:10496
    ds_read_b64 v[170:171], v196 offset:11008
    s_waitcnt lgkmcnt(6)
    v_mfma_f32_16x16x32_bf16 v[112:115], a[80:83], v[184:187], v[112:115]
    ds_read_b64 v[172:173], v198 offset:1536
    v_mfma_f32_32x32x16_bf16 v[80:95], a[80:83], v[188:191], v[80:95]
    ds_read_b64 v[174:175], v198 offset:1600
    ds_read_b64 v[176:177], v196 offset:12288
    ds_read_b64 v[178:179], v196 offset:12800
    v_mfma_f32_32x32x16_bf16 v[96:111], a[80:83], v[192:195], v[96:111]
    ds_read_b64 v[180:181], v196 offset:12544
    ds_read_b64 v[182:183], v196 offset:13056
    s_lshl_b32 s98, s72, 5
    s_add_u32 s98, s98, 0
    s_sub_u32 s95, s98, 4
    s_max_i32 s95, s95, 0
    s_lshl_b32 s94, s98, 3
    s_lshl_b32 s95, s95, 3
    s_add_u32 s94, s94, 3457024
    s_add_u32 s95, s95, 3457024
    s_add_u32 s96, s94, 8192
    buffer_load_dwordx2 v[152:153], v47, s[16:19], s94 offen sc1
    s_waitcnt lgkmcnt(6)
    v_mfma_f32_16x16x32_bf16 v[112:115], a[84:87], v[160:163], v[112:115]
    ds_read_b64 v[184:185], v198 offset:1792
    v_mfma_f32_32x32x16_bf16 v[80:95], a[84:87], v[164:167], v[80:95]
    ds_read_b64 v[186:187], v198 offset:1856
    ds_read_b64 v[188:189], v196 offset:14336
    ds_read_b64 v[190:191], v196 offset:14848
    v_mfma_f32_32x32x16_bf16 v[96:111], a[84:87], v[168:171], v[96:111]
    ds_read_b64 v[192:193], v196 offset:14592
    ds_read_b64 v[194:195], v196 offset:15104
    buffer_load_dwordx2 v[154:155], v47, s[16:19], s96 offen sc1
    s_waitcnt vmcnt(7)
    s_barrier
    s_waitcnt lgkmcnt(6)
    v_mfma_f32_16x16x32_bf16 v[112:115], a[88:91], v[172:175], v[112:115]
    v_add_u32_e64 v198, v49, v198
    v_mfma_f32_32x32x16_bf16 v[80:95], a[88:91], v[176:179], v[80:95]
    v_add_u32 v196, 19584, v196
    ds_read_b64 v[160:161], v198 offset:0
    ds_read_b64 v[162:163], v198 offset:64
    ds_read_b64 v[164:165], v196 offset:0
    v_mfma_f32_32x32x16_bf16 v[96:111], a[88:91], v[180:183], v[96:111]
    ds_read_b64 v[166:167], v196 offset:512
    ds_read_b64 v[168:169], v196 offset:256
    ds_read_b64 v[170:171], v196 offset:768
    buffer_load_dwordx2 v[156:157], v48, s[16:19], s95 offen sc1
    s_waitcnt lgkmcnt(6)
    v_mfma_f32_16x16x32_bf16 v[112:115], a[92:95], v[184:187], v[112:115]
    ds_read_b64 v[172:173], v198 offset:256
    v_mfma_f32_32x32x16_bf16 v[80:95], a[92:95], v[188:191], v[80:95]
    ds_read_b64 v[174:175], v198 offset:320
    ds_read_b64 v[176:177], v196 offset:2048
    ds_read_b64 v[178:179], v196 offset:2560
    v_mfma_f32_32x32x16_bf16 v[96:111], a[92:95], v[192:195], v[96:111]
    ds_read_b64 v[180:181], v196 offset:2304
    ds_read_b64 v[182:183], v196 offset:2816
    buffer_load_dword v7, v4, s[16:19], s89 offen offset:4 sc1
    s_waitcnt lgkmcnt(6)
    v_mfma_f32_16x16x32_bf16 v[112:115], a[96:99], v[160:163], v[112:115]
    ds_read_b64 v[184:185], v198 offset:512
    v_mfma_f32_32x32x16_bf16 v[80:95], a[96:99], v[164:167], v[80:95]
    ds_read_b64 v[186:187], v198 offset:576
    ds_read_b64 v[188:189], v196 offset:4096
    ds_read_b64 v[190:191], v196 offset:4608
    v_mfma_f32_32x32x16_bf16 v[96:111], a[96:99], v[168:171], v[96:111]
    ds_read_b64 v[192:193], v196 offset:4352
    ds_read_b64 v[194:195], v196 offset:4864
    s_waitcnt lgkmcnt(6)
    v_mfma_f32_16x16x32_bf16 v[112:115], a[100:103], v[172:175], v[112:115]
    ds_read_b64 v[160:161], v198 offset:768
    v_mfma_f32_32x32x16_bf16 v[80:95], a[100:103], v[176:179], v[80:95]
    ds_read_b64 v[162:163], v198 offset:832
    ds_read_b64 v[164:165], v196 offset:6144
    ds_read_b64 v[166:167], v196 offset:6656
    v_mfma_f32_32x32x16_bf16 v[96:111], a[100:103], v[180:183], v[96:111]
    ds_read_b64 v[168:169], v196 offset:6400
    ds_read_b64 v[170:171], v196 offset:6912
    s_waitcnt lgkmcnt(6)
    v_mfma_f32_16x16x32_bf16 v[112:115], a[104:107], v[184:187], v[112:115]
    ds_read_b64 v[172:173], v198 offset:1024
    v_mfma_f32_32x32x16_bf16 v[80:95], a[104:107], v[188:191], v[80:95]
    ds_read_b64 v[174:175], v198 offset:1088
    ds_read_b64 v[176:177], v196 offset:8192
    ds_read_b64 v[178:179], v196 offset:8704
    v_mfma_f32_32x32x16_bf16 v[96:111], a[104:107], v[192:195], v[96:111]
    ds_read_b64 v[180:181], v196 offset:8448
    ds_read_b64 v[182:183], v196 offset:8960
    s_waitcnt lgkmcnt(6)
    v_mfma_f32_16x16x32_bf16 v[112:115], a[108:111], v[160:163], v[112:115]
    ds_read_b64 v[184:185], v198 offset:1280
    v_mfma_f32_32x32x16_bf16 v[80:95], a[108:111], v[164:167], v[80:95]
    ds_read_b64 v[186:187], v198 offset:1344
    ds_read_b64 v[188:189], v196 offset:10240
    ds_read_b64 v[190:191], v196 offset:10752
    v_mfma_f32_32x32x16_bf16 v[96:111], a[108:111], v[168:171], v[96:111]
    ds_read_b64 v[192:193], v196 offset:10496
    ds_read_b64 v[194:195], v196 offset:11008
    s_waitcnt lgkmcnt(6)
    v_mfma_f32_16x16x32_bf16 v[112:115], a[112:115], v[172:175], v[112:115]
    ds_read_b64 v[160:161], v198 offset:1536
    v_mfma_f32_32x32x16_bf16 v[80:95], a[112:115], v[176:179], v[80:95]
    ds_read_b64 v[162:163], v198 offset:1600
    ds_read_b64 v[164:165], v196 offset:12288
    ds_read_b64 v[166:167], v196 offset:12800
    v_mfma_f32_32x32x16_bf16 v[96:111], a[112:115], v[180:183], v[96:111]
    ds_read_b64 v[168:169], v196 offset:12544
    ds_read_b64 v[170:171], v196 offset:13056
    s_waitcnt lgkmcnt(6)
    v_mfma_f32_16x16x32_bf16 v[112:115], a[116:119], v[184:187], v[112:115]
    ds_read_b64 v[172:173], v198 offset:1792
    v_mfma_f32_32x32x16_bf16 v[80:95], a[116:119], v[188:191], v[80:95]
    ds_read_b64 v[174:175], v198 offset:1856
    ds_read_b64 v[176:177], v196 offset:14336
    ds_read_b64 v[178:179], v196 offset:14848
    v_mfma_f32_32x32x16_bf16 v[96:111], a[116:119], v[192:195], v[96:111]
    ds_read_b64 v[180:181], v196 offset:14592
    ds_read_b64 v[182:183], v196 offset:15104
sl_57:
    s_waitcnt vmcnt(2)
    v_max3_u32 v2, v152, v153, v154
    s_waitcnt vmcnt(1)
    v_max3_u32 v2, v2, v155, v156
    v_max_u32 v2, v2, v157
    v_cmp_eq_u32 vcc, -1, v2
    s_nop 0
    s_cbranch_vccnz rd_58
rc_59:
    s_waitcnt vmcnt(0)
    v_cmp_gt_u32 vcc, 1, v7
    s_nop 0
    s_and_b64 vcc, vcc, s[50:51]
    s_cbranch_scc1 ps_60
pc_62:
    s_barrier
    s_waitcnt lgkmcnt(6)
    v_mfma_f32_16x16x32_bf16 v[112:115], a[120:123], v[160:163], v[112:115]
    v_add_u32_e64 v198, v49, v198
    v_mfma_f32_32x32x16_bf16 v[80:95], a[120:123], v[164:167], v[80:95]
    v_add_u32 v196, 19584, v196
    ds_read_b64 v[184:185], v198 offset:0
    ds_read_b64 v[186:187], v198 offset:64
    v_mul_f32 v148, v24, v157
    v_mul_f32 v149, v25, v157
    v_mfma_f32_32x32x16_bf16 v[96:111], a[120:123], v[168:171], v[96:111]
    ds_read_b64 v[188:189], v196 offset:0
    ds_read_b64 v[190:191], v196 offset:512
    s_sub_u32 s3, s2, 160
    s_and_b32 s3, s3, 63
    s_add_u32 s3, s3, 64
    s_and_b32 s25, s3, 3
    s_lshl_b32 s25, s25, 12
    s_lshr_b32 s26, s3, 2
    s_lshl_b32 s26, s26, 7
    s_add_u32 s3, s25, s26
    v_lshrrev_b32 v236, 3, v0
    v_and_b32 v237, 7, v0
    v_lshlrev_b32 v237, 4, v237
    v_lshl_add_u32 v236, v236, 14, v237
    s_sub_u32 s25, s2, 160
    s_cmp_lt_u32 s25, 64
    s_cselect_b32 s25, 0, 1073741824
    v_add_u32_e64 v236, s25, v236
    s_add_u32 s26, s3, 9437184
    buffer_load_dwordx4 v[216:219], v236, s[16:19], s26 offen sc1
    v_mul_f32 v150, v26, v157
    v_mul_f32_e64 v151, v27, v157
    s_waitcnt lgkmcnt(4)
    v_mfma_f32_16x16x32_bf16 v[112:115], a[124:127], v[172:175], v[112:115]
    ds_read_b64 v[192:193], v198 offset:256
    v_mfma_f32_32x32x16_bf16 v[80:95], a[124:127], v[176:179], v[80:95]
    ds_read_b64 v[194:195], v198 offset:320
    ds_read_b64 v[160:161], v196 offset:2048
    v_mul_f32 v116, v8, v153
    v_mul_f32 v117, v9, v153
    v_mul_f32_e64 v118, v10, v153
    v_mfma_f32_32x32x16_bf16 v[96:111], a[124:127], v[180:183], v[96:111]
    ds_read_b64 v[162:163], v196 offset:2560
    s_add_u32 s26, s26, 524288
    buffer_load_dwordx4 v[220:223], v236, s[16:19], s26 offen sc1
    v_mul_f32 v119, v11, v153
    v_mul_f32_e64 v120, v12, v153
    s_waitcnt lgkmcnt(4)
    v_mfma_f32_16x16x32_bf16 v[112:115], a[128:131], v[184:187], v[112:115]
    ds_read_b64 v[164:165], v198 offset:512
    v_mfma_f32_32x32x16_bf16 v[80:95], a[128:131], v[188:191], v[80:95]
    ds_read_b64 v[166:167], v198 offset:576
    ds_read_b64 v[168:169], v196 offset:4096
    ds_read_b64 v[170:171], v196 offset:4608
    v_mul_f32 v121, v13, v153
    v_mul_f32_e64 v122, v14, v153
    s_waitcnt lgkmcnt(4)
    v_mfma_f32_16x16x32_bf16 v[112:115], a[132:135], v[192:195], v[112:115]
    ds_read_b64 v[172:173], v198 offset:768
    v_mfma_f32_32x32x16_bf16 v[80:95], a[132:135], v[160:163], v[80:95]
    ds_read_b64 v[174:175], v198 offset:832
    ds_read_b64 v[176:177], v196 offset:6144
    ds_read_b64 v[178:179], v196 offset:6656
    s_add_u32 s26, s26, 524288
    buffer_load_dwordx4 v[224:227], v236, s[16:19], s26 offen sc1
    v_mul_f32 v123, v15, v153
    v_mul_f32_e64 v124, v16, v153
    s_waitcnt lgkmcnt(4)
    v_mfma_f32_16x16x32_bf16 v[112:115], a[136:139], v[164:167], v[112:115]
    ds_read_b64 v[180:181], v198 offset:1024
    v_mfma_f32_32x32x16_bf16 v[80:95], a[136:139], v[168:171], v[80:95]
    ds_read_b64 v[182:183], v198 offset:1088
    ds_read_b64 v[184:185], v196 offset:8192
    ds_read_b64 v[186:187], v196 offset:8704
    v_mul_f32 v125, v17, v153
    v_mul_f32_e64 v126, v18, v153
    s_waitcnt lgkmcnt(4)
    v_mfma_f32_16x16x32_bf16 v[112:115], a[140:143], v[172:175], v[112:115]
    ds_read_b64 v[188:189], v198 offset:1280
    v_mfma_f32_32x32x16_bf16 v[80:95], a[140:143], v[176:179], v[80:95]
    ds_read_b64 v[190:191], v198 offset:1344
    ds_read_b64 v[192:193], v196 offset:10240
    ds_read_b64 v[194:195], v196 offset:10752
    s_add_u32 s26, s26, 524288
    buffer_load_dwordx4 v[228:231], v236, s[16:19], s26 offen sc1
    v_mul_f32 v127, v19, v153
    v_mul_f32_e64 v128, v20, v153
    s_waitcnt lgkmcnt(4)
    v_mfma_f32_16x16x32_bf16 v[112:115], a[144:147], v[180:183], v[112:115]
    ds_read_b64 v[160:161], v198 offset:1536
    v_mfma_f32_32x32x16_bf16 v[80:95], a[144:147], v[184:187], v[80:95]
    ds_read_b64 v[162:163], v198 offset:1600
    ds_read_b64 v[164:165], v196 offset:12288
    ds_read_b64 v[166:167], v196 offset:12800
    v_mul_f32 v129, v21, v153
    v_mul_f32_e64 v130, v22, v153
    s_waitcnt lgkmcnt(4)
    v_mfma_f32_16x16x32_bf16 v[112:115], a[148:151], v[188:191], v[112:115]
    ds_read_b64 v[168:169], v198 offset:1792
    v_mfma_f32_32x32x16_bf16 v[80:95], a[148:151], v[192:195], v[80:95]
    ds_read_b64 v[170:171], v198 offset:1856
    ds_read_b64 v[172:173], v196 offset:14336
    ds_read_b64 v[174:175], v196 offset:14848
    s_add_u32 s26, s26, 524288
    buffer_load_dwordx4 v[232:235], v236, s[16:19], s26 offen sc1
    v_mul_f32 v131, v23, v153
    v_mul_f32_e64 v132, v8, v155
    s_waitcnt lgkmcnt(4)
    v_mfma_f32_16x16x32_bf16 v[112:115], a[152:155], v[160:163], v[112:115]
    ds_read_b64 v[176:177], v196 offset:256
    v_mfma_f32_32x32x16_bf16 v[80:95], a[152:155], v[164:167], v[80:95]
    ds_read_b64 v[178:179], v196 offset:768
    ds_read_b64 v[180:181], v196 offset:2304
    ds_read_b64 v[182:183], v196 offset:2816
    v_mul_f32 v133, v9, v155
    v_mul_f32_e64 v134, v10, v155
    s_waitcnt lgkmcnt(4)
    v_mfma_f32_16x16x32_bf16 v[112:115], a[156:159], v[168:171], v[112:115]
    ds_read_b64 v[184:185], v196 offset:4352
    v_mfma_f32_32x32x16_bf16 v[80:95], a[156:159], v[172:175], v[80:95]
    ds_read_b64 v[186:187], v196 offset:4864
    ds_read_b64 v[188:189], v196 offset:6400
    ds_read_b64 v[190:191], v196 offset:6912
    s_add_u32 m0, s92, 36352
    s_nop 0
    buffer_load_dwordx4 v73, s[16:19], s99 offen offset:0 sc1 lds
    v_mul_f32 v135, v11, v155
    v_mul_f32 v136, v12, v155
    v_mul_f32 v137, v13, v155
    v_mul_f32 v138, v14, v155
    v_mul_f32 v139, v15, v155
    v_mul_f32 v140, v16, v155
    v_mul_f32 v141, v17, v155
    v_mul_f32 v142, v18, v155
    v_mul_f32 v143, v19, v155
    v_mul_f32 v144, v20, v155
    v_mul_f32 v145, v21, v155
    v_mul_f32 v146, v22, v155
    v_mul_f32_e64 v147, v23, v155
    s_waitcnt lgkmcnt(4)
    v_mfma_f32_32x32x16_bf16 v[96:111], a[128:131], v[176:179], v[96:111]
    ds_read_b64 v[192:193], v196 offset:8448
    ds_read_b64 v[194:195], v196 offset:8960
    v_mfma_f32_32x32x16_bf16 v[96:111], a[132:135], v[180:183], v[96:111]
    ds_read_b64 v[160:161], v196 offset:10496
    ds_read_b64 v[162:163], v196 offset:11008
    buffer_load_dwordx4 v74, s[16:19], s99 offen offset:1024 sc1 lds
    v_fma_f32 v112, v112, v156, v148
    v_fma_f32 v113, v113, v156, v149
    s_waitcnt lgkmcnt(4)
    v_mfma_f32_32x32x16_bf16 v[96:111], a[136:139], v[184:187], v[96:111]
    ds_read_b64 v[164:165], v196 offset:12544
    ds_read_b64 v[166:167], v196 offset:13056
    v_fma_f32 v114, v114, v156, v150
    v_fma_f32 v115, v115, v156, v151
    v_cvt_pk_bf16_f32 v112, v112, v113
    v_mfma_f32_32x32x16_bf16 v[96:111], a[140:143], v[188:191], v[96:111]
    ds_read_b64 v[168:169], v196 offset:14592
    ds_read_b64 v[170:171], v196 offset:15104
    buffer_load_dwordx4 v75, s[16:19], s99 offen offset:2048 sc1 lds
    v_cvt_pk_bf16_f32 v113, v114, v115
    v_fma_f32 v80, v80, v152, v116
    s_waitcnt lgkmcnt(4)
    v_mfma_f32_32x32x16_bf16 v[96:111], a[144:147], v[192:195], v[96:111]
    v_fma_f32 v81, v81, v152, v117
    v_fma_f32 v82, v82, v152, v118
    v_fma_f32 v83, v83, v152, v119
    v_cvt_pk_bf16_f32 v80, v80, v81
    v_cvt_pk_bf16_f32 v81, v82, v83
    v_mfma_f32_32x32x16_bf16 v[96:111], a[148:151], v[160:163], v[96:111]
    ds_write_b64 v40, v[112:113] offset:0
    ds_write_b64 v38, v[80:81] offset:0
    v_fma_f32 v84, v84, v152, v120
    v_fma_f32 v85, v85, v152, v121
    s_waitcnt lgkmcnt(2)
    v_mfma_f32_32x32x16_bf16 v[96:111], a[152:155], v[164:167], v[96:111]
    v_fma_f32 v86, v86, v152, v122
    v_fma_f32 v87, v87, v152, v123
    v_cvt_pk_bf16_f32 v84, v84, v85
    v_cvt_pk_bf16_f32 v85, v86, v87
    v_fma_f32 v88, v88, v152, v124
    v_mfma_f32_32x32x16_bf16 v[96:111], a[156:159], v[168:171], v[96:111]
    buffer_load_dwordx4 v76, s[16:19], s99 offen offset:3072 sc1 lds
    v_fma_f32 v89, v89, v152, v125
    v_fma_f32 v90, v90, v152, v126
    v_fma_f32 v91, v91, v152, v127
    v_cvt_pk_bf16_f32 v88, v88, v89
    v_cvt_pk_bf16_f32 v89, v90, v91
    ds_write_b64 v38, v[84:85] offset:6400
    ds_write_b64 v38, v[88:89] offset:12800
    v_fma_f32 v92, v92, v152, v128
    v_fma_f32 v93, v93, v152, v129
    v_fma_f32 v94, v94, v152, v130
    v_fma_f32 v95, v95, v152, v131
    v_cvt_pk_bf16_f32 v92, v92, v93
    v_cvt_pk_bf16_f32 v93, v94, v95
    ds_write_b64 v39, v[92:93] offset:0
    v_pk_fma_f32 v[96:97], v[96:97], v[154:155], v[132:133] op_sel_hi:[1,0,1]
    v_pk_fma_f32 v[98:99], v[98:99], v[154:155], v[134:135] op_sel_hi:[1,0,1]
    v_cvt_pk_bf16_f32 v96, v96, v97
    v_cvt_pk_bf16_f32 v97, v98, v99
    v_pk_fma_f32 v[100:101], v[100:101], v[154:155], v[136:137] op_sel_hi:[1,0,1]
    v_pk_fma_f32 v[102:103], v[102:103], v[154:155], v[138:139] op_sel_hi:[1,0,1]
    v_cvt_pk_bf16_f32 v100, v100, v101
    v_cvt_pk_bf16_f32 v101, v102, v103
    ds_write_b64 v38, v[96:97] offset:1600
    ds_write_b64 v38, v[100:101] offset:8000
    v_pk_fma_f32 v[104:105], v[104:105], v[154:155], v[140:141] op_sel_hi:[1,0,1]
    v_pk_fma_f32 v[106:107], v[106:107], v[154:155], v[142:143] op_sel_hi:[1,0,1]
    v_cvt_pk_bf16_f32 v104, v104, v105
    v_cvt_pk_bf16_f32 v105, v106, v107
    v_pk_fma_f32 v[108:109], v[108:109], v[154:155], v[144:145] op_sel_hi:[1,0,1]
    v_pk_fma_f32 v[110:111], v[110:111], v[154:155], v[146:147] op_sel_hi:[1,0,1]
    v_cvt_pk_bf16_f32 v108, v108, v109
    v_cvt_pk_bf16_f32 v109, v110, v111
    ds_write_b64 v38, v[104:105] offset:14400
    ds_write_b64 v39, v[108:109] offset:1600
    v_cmp_u_f32 vcc, v82, v114
    v_cmp_u_f32 s[82:83], v98, v98
    s_lshl_b32 s25, s24, 2
    s_add_u32 s25, s25, 161280
    s_or_b64 vcc, vcc, s[82:83]
    s_cselect_b32 s26, 1, 0
    v_mov_b32 v196, s25
    v_mov_b32 v197, s26
    ds_write_b32 v196, v197
    s_waitcnt lgkmcnt(0)
    s_barrier
    s_sub_u32 s85, s2, 160
    s_cmp_ge_u32 s85, 64
    s_cbranch_scc1 s2_63
    v_mov_b32 v238, 0x3f803f80
    s_lshl_b32 s25, s24, 7
    s_add_u32 s25, s25, 134272
    v_lshrrev_b32 v239, 4, v1
    v_lshl_add_u32 v237, v239, 2, v237
    v_add_u32 v237, s25, v237
se_64:
    v_mov_b32 v240, 0
    v_mov_b32 v241, 0
    v_mov_b32 v242, 0
    v_mov_b32 v243, 0
    s_waitcnt vmcnt(8)
    v_dot2c_f32_bf16 v240, v216, v238
    v_dot2c_f32_bf16 v241, v216, v216
    v_dot2c_f32_bf16 v240, v217, v238
    v_dot2c_f32_bf16 v241, v217, v217
    v_dot2c_f32_bf16 v242, v218, v238
    v_dot2c_f32_bf16 v243, v218, v218
    v_dot2c_f32_bf16 v242, v219, v238
    v_dot2c_f32_bf16 v243, v219, v219
    s_waitcnt vmcnt(7)
    v_dot2c_f32_bf16 v240, v220, v238
    v_dot2c_f32_bf16 v241, v220, v220
    v_dot2c_f32_bf16 v240, v221, v238
    v_dot2c_f32_bf16 v241, v221, v221
    v_dot2c_f32_bf16 v242, v222, v238
    v_dot2c_f32_bf16 v243, v222, v222
    v_dot2c_f32_bf16 v242, v223, v238
    v_dot2c_f32_bf16 v243, v223, v223
    s_waitcnt vmcnt(6)
    v_dot2c_f32_bf16 v240, v224, v238
    v_dot2c_f32_bf16 v241, v224, v224
    v_dot2c_f32_bf16 v240, v225, v238
    v_dot2c_f32_bf16 v241, v225, v225
    v_dot2c_f32_bf16 v242, v226, v238
    v_dot2c_f32_bf16 v243, v226, v226
    v_dot2c_f32_bf16 v242, v227, v238
    v_dot2c_f32_bf16 v243, v227, v227
    s_waitcnt vmcnt(5)
    v_dot2c_f32_bf16 v240, v228, v238
    v_dot2c_f32_bf16 v241, v228, v228
    v_dot2c_f32_bf16 v240, v229, v238
    v_dot2c_f32_bf16 v241, v229, v229
    v_dot2c_f32_bf16 v242, v230, v238
    v_dot2c_f32_bf16 v243, v230, v230
    v_dot2c_f32_bf16 v242, v231, v238
    v_dot2c_f32_bf16 v243, v231, v231
    s_waitcnt vmcnt(4)
    v_dot2c_f32_bf16 v240, v232, v238
    v_dot2c_f32_bf16 v241, v232, v232
    v_dot2c_f32_bf16 v240, v233, v238
    v_dot2c_f32_bf16 v241, v233, v233
    v_dot2c_f32_bf16 v242, v234, v238
    v_dot2c_f32_bf16 v243, v234, v234
    v_dot2c_f32_bf16 v242, v235, v238
    v_dot2c_f32_bf16 v243, v235, v235
    s_nop 2
    v_cmp_u_f32 vcc, v241, v243
    s_nop 0
    s_cbranch_vccnz rd_65
rc_66:
    v_permlane32_swap_b32 v240, v242
    v_permlane32_swap_b32 v241, v243
    v_pk_add_f32 v[240:241], v[240:241], v[242:243]
    s_nop 1
    v_permlane16_swap_b32 v240, v241
    v_add_f32_e64 v240, v240, v241
    s_nop 1
    v_add_f32_dpp v240, v240, v240 row_ror:8 row_mask:0xf bank_mask:0xf
    ds_write_b32 v237, v240
    v_and_b32 v236, 15, v0
    v_lshlrev_b32 v236, 3, v236
    v_add_u32 v237, 134272, v236
    v_mov_b32 v239, 1073741824
    v_cmp_gt_u32 vcc, 16, v0
    s_nop 1
    v_cndmask_b32 v236, v239, v236, vcc
    s_add_u32 s25, s3, 3457024
    s_waitcnt lgkmcnt(0)
    s_barrier
    ds_read_b64 v[216:217], v237 offset:0
    ds_read_b64 v[218:219], v237 offset:128
    ds_read_b64 v[220:221], v237 offset:256
    ds_read_b64 v[222:223], v237 offset:384
    s_waitcnt lgkmcnt(2)
    v_pk_add_f32 v[216:217], v[216:217], v[218:219]
    s_waitcnt lgkmcnt(0)
    v_pk_add_f32 v[220:221], v[220:221], v[222:223]
    v_pk_add_f32 v[216:217], v[216:217], v[220:221]
    v_mul_f32 v239, 0x3acccccd, v216
    v_mul_f32 v217, 0x3acccccd, v217
    v_fma_f32 v217, -v239, v239, v217
    v_max_f32 v217, 0, v217
    v_add_f32 v217, 0x3727c5ac, v217
    v_rsq_f32_e64 v216, v217
    s_nop 0
    v_mul_f32 v217, -v239, v216
    buffer_store_dwordx2 v[216:217], v236, s[16:19], s25 offen sc1
s2_63:
    v_mov_b32 v158, 161280
    ds_read_b128 v[128:131], v158
    v_mov_b32 v94, 0
    v_mov_b32 v95, 0
    v_mov_b32 v98, 0
    v_mov_b32 v99, 0
    s_mov_b64 exec, 0xffff
    ds_read_b64 v[94:95], v42 offset:320
    ds_read_b64 v[98:99], v42 offset:640
    s_mov_b64 exec, -1
    s_nop 0
    ds_read_b64 v[92:93], v41 offset:320
    ds_read_b64 v[96:97], v41 offset:640
    ds_read_b64 v[84:85], v41 offset:6720
    ds_read_b64 v[86:87], v42 offset:6720
    ds_read_b64 v[80:81], v41 offset:6400
    ds_read_b64 v[82:83], v42 offset:6400
    ds_read_b64 v[88:89], v41 offset:7040
    ds_read_b64 v[90:91], v42 offset:7040
    ds_read_b64_tr_b16 v[106:107], v44 offset:0
    ds_read_b64_tr_b16 v[100:101], v43 offset:0
    s_add_u32 m0, s93, 53760
    s_add_u32 s99, s99, 524288
    s_mov_b64 exec, s[80:81]
    buffer_load_dwordx4 v77, s[16:19], s100 offen sc1 lds
    s_mov_b64 exec, -1
    s_add_u32 s100, s100, 524288
    ds_read_b64_tr_b16 v[108:109], v44 offset:320
    ds_read_b64_tr_b16 v[102:103], v43 offset:320
    ds_read_b64_tr_b16 v[110:111], v44 offset:640
    ds_read_b64_tr_b16 v[104:105], v43 offset:640
    v_mov_b32 v156, 0xf149f2ca
    v_cndmask_b32 v152, v32, v156, s[90:91]
    v_cndmask_b32 v153, v33, v156, s[90:91]
    v_cndmask_b32 v154, v34, v156, s[90:91]
    s_add_u32 m0, s92, 55936
    s_nop 0
    buffer_load_dwordx4 v73, s[16:19], s99 offen offset:0 sc1 lds
    v_cndmask_b32 v155, v35, v156, s[90:91]
    s_mov_b32 s82, 0x3ea52b5c
    s_lshl_b32 s25, s98, 4
    s_add_u32 s25, s25, 12058624
    s_lshl_b32 s26, s98, 3
    s_add_u32 s26, s26, 12058624
    s_waitcnt lgkmcnt(15)
    v_or3_b32 v128, v128, v129, v130
    v_or_b32 v128, v128, v131
    buffer_load_dwordx4 v74, s[16:19], s99 offen offset:1024 sc1 lds
    v_cmp_ne_u32_e64 vcc, 0, v128
    s_nop 0
    s_cbranch_vccnz rd_67
rc_68:
    s_waitcnt lgkmcnt(10)
    v_mfma_f32_16x16x32_bf16 v[116:119], v[84:87], v[92:95], v[28:31]
    v_mfma_f32_16x16x32_bf16 v[120:123], v[84:87], v[96:99], v[32:35]
    s_waitcnt lgkmcnt(8)
    v_mfma_f32_16x16x32_bf16 v[112:115], v[80:83], v[92:95], v[152:155]
    s_waitcnt lgkmcnt(6)
    v_mfma_f32_16x16x32_bf16 v[124:127], v[88:91], v[96:99], v[28:31]
    s_nop 5
    v_max_f32 v112, v112, v116
    v_max_f32 v113, v113, v117
    v_max_f32 v114, v114, v118
    buffer_load_dwordx4 v75, s[16:19], s99 offen offset:2048 sc1 lds
    v_max_f32 v115, v115, v119
    v_max3_f32 v156, v112, v113, v114
    v_max_f32 v156, v156, v115
    v_max_f32 v120, v120, v124
    v_max_f32 v121, v121, v125
    v_max_f32 v122, v122, v126
    v_max_f32 v123, v123, v127
    v_max3_f32 v157, v120, v121, v122
    buffer_load_dwordx4 v76, s[16:19], s99 offen offset:3072 sc1 lds
    v_max_f32 v157, v157, v123
    s_nop 1
    v_permlane16_swap_b32 v156, v157
    v_max_f32 v156, v156, v157
    v_mov_b32 v157, v156
    s_nop 1
    v_permlane32_swap_b32 v156, v157
    v_max_f32 v156, v156, v157
    v_mul_f32 v156, s82, v156
    v_mov_b32 v157, v156
    s_add_u32 m0, s93, 73344
    s_add_u32 s99, s99, 524288
    s_mov_b64 exec, s[80:81]
    buffer_load_dwordx4 v77, s[16:19], s100 offen sc1 lds
    s_mov_b64 exec, -1
    s_add_u32 s100, s100, 524288
    v_permlane16_swap_b32_e64 v156, v157
    v_fma_f32 v112, v112, s82, -v156
    v_fma_f32 v113, v113, s82, -v156
    v_fma_f32 v114, v114, s82, -v156
    v_fma_f32 v115, v115, s82, -v156
    v_exp_f32 v112, v112
    v_exp_f32 v113, v113
    v_exp_f32 v114, v114
    s_add_u32 m0, s92, 75520
    s_nop 0
    buffer_load_dwordx4 v73, s[16:19], s99 offen offset:0 sc1 lds
    v_exp_f32_e64 v115, v115
    v_cvt_pk_bf16_f32 v116, v112, v113
    v_cvt_pk_bf16_f32 v117, v114, v115
    v_bfi_b32 v128, v36, 0, v116
    v_and_b32 v130, v36, v116
    v_bfi_b32 v129, v37, 0, v117
    v_and_b32 v131, v37, v117
    s_waitcnt lgkmcnt(3)
    s_nop 0
    v_mfma_f32_16x16x32_bf16 v[144:147], v[106:109], v[128:131], 0
    buffer_load_dwordx4 v74, s[16:19], s99 offen offset:1024 sc1 lds
    s_waitcnt lgkmcnt(2)
    v_mfma_f32_16x16x32_bf16 v[136:139], v[100:103], v[128:131], 0
    v_fma_f32 v120, v120, s82, -v157
    v_fma_f32 v121, v121, s82, -v157
    v_fma_f32 v122, v122, s82, -v157
    v_fma_f32 v123, v123, s82, -v157
    v_exp_f32 v120, v120
    v_exp_f32 v121, v121
    v_exp_f32 v122, v122
    buffer_load_dwordx4 v75, s[16:19], s99 offen offset:2048 sc1 lds
    v_exp_f32_e64 v123, v123
    v_cvt_pk_bf16_f32 v124, v120, v121
    v_cvt_pk_bf16_f32 v125, v122, v123
    v_bfi_b32 v132, v36, 0, v124
    v_and_b32 v134, v36, v124
    v_bfi_b32 v133, v37, 0, v125
    v_and_b32 v135, v37, v125
    s_waitcnt lgkmcnt(1)
    s_nop 0
    v_mfma_f32_16x16x32_bf16 v[148:151], v[108:111], v[132:135], 0
    buffer_load_dwordx4 v76, s[16:19], s99 offen offset:3072 sc1 lds
    s_waitcnt lgkmcnt(0)
    v_mfma_f32_16x16x32_bf16 v[140:143], v[102:105], v[132:135], 0
    v_mov_b32 v158, v144
    s_nop 1
    v_permlane16_swap_b32 v144, v158
    v_rcp_f32 v158, v158
    s_nop 0
    v_pk_mul_f32 v[136:137], v[136:137], v[158:159] op_sel_hi:[1,0]
    v_pk_mul_f32 v[138:139], v[138:139], v[158:159] op_sel_hi:[1,0]
    v_pk_mul_f32 v[144:145], v[144:145], v[158:159] op_sel_hi:[1,0]
    v_pk_mul_f32 v[146:147], v[146:147], v[158:159] op_sel_hi:[1,0]
    s_add_u32 m0, s93, 92928
    s_add_u32 s99, s99, 524288
    s_mov_b64 exec, s[80:81]
    buffer_load_dwordx4 v77, s[16:19], s100 offen sc1 lds
    s_mov_b64 exec, -1
    s_add_u32 s100, s100, 524288
    v_cvt_pk_bf16_f32 v112, v136, v137
    v_cvt_pk_bf16_f32 v116, v144, v145
    v_cvt_pk_bf16_f32 v113, v138, v139
    v_cvt_pk_bf16_f32 v117, v146, v147
    v_mov_b32 v160, v148
    s_nop 1
    v_permlane16_swap_b32 v148, v160
    v_rcp_f32_e64 v160, v160
    s_nop 0
    v_pk_mul_f32 v[140:141], v[140:141], v[160:161] op_sel_hi:[1,0]
    v_pk_mul_f32 v[142:143], v[142:143], v[160:161] op_sel_hi:[1,0]
    v_pk_mul_f32 v[148:149], v[148:149], v[160:161] op_sel_hi:[1,0]
    v_pk_mul_f32 v[150:151], v[150:151], v[160:161] op_sel_hi:[1,0]
    v_cvt_pk_bf16_f32 v114, v140, v141
    v_cvt_pk_bf16_f32 v118, v148, v149
    v_cvt_pk_bf16_f32 v115, v142, v143
    v_cvt_pk_bf16_f32 v119, v150, v151
    v_permlane16_swap_b32 v112, v114
    v_permlane16_swap_b32 v113, v115
    v_permlane16_swap_b32 v116, v118
    v_permlane16_swap_b32 v117, v119
    buffer_store_dwordx4 v[112:115], v45, s[16:19], s25 offen sc1
    s_mov_b64 exec, s[80:81]
    buffer_store_dwordx2 v[116:117], v46, s[16:19], s26 offen sc1
    s_mov_b64 exec, -1
ge_69:
    v_add_u32 v196, 36352, v78
    v_mov_b32_e64 v198, v79
    s_waitcnt vmcnt(12)
    s_barrier
    ds_read_b64 v[160:161], v198 offset:0
    ds_read_b64 v[162:163], v198 offset:64
    ds_read_b64 v[164:165], v196 offset:0
    ds_read_b64 v[166:167], v196 offset:512
    ds_read_b64 v[168:169], v196 offset:256
    ds_read_b64 v[170:171], v196 offset:768
    ds_read_b64 v[172:173], v198 offset:256
    ds_read_b64 v[174:175], v198 offset:320
    ds_read_b64 v[176:177], v196 offset:2048
    ds_read_b64 v[178:179], v196 offset:2560
    ds_read_b64 v[180:181], v196 offset:2304
    ds_read_b64 v[182:183], v196 offset:2816
    s_waitcnt lgkmcnt(6)
    v_mfma_f32_16x16x32_bf16 v[112:115], a[0:3], v[160:163], 0
    ds_read_b64 v[184:185], v198 offset:512
    v_mfma_f32_32x32x16_bf16 v[80:95], a[0:3], v[164:167], 0
    ds_read_b64 v[186:187], v198 offset:576
    ds_read_b64 v[188:189], v196 offset:4096
    ds_read_b64 v[190:191], v196 offset:4608
    v_mfma_f32_32x32x16_bf16 v[96:111], a[0:3], v[168:171], 0
    ds_read_b64 v[192:193], v196 offset:4352
    ds_read_b64 v[194:195], v196 offset:4864
    s_add_u32 m0, s92, 95104
    s_nop 0
    buffer_load_dwordx4 v73, s[16:19], s99 offen offset:0 sc1 lds
    s_waitcnt lgkmcnt(6)
    v_mfma_f32_16x16x32_bf16 v[112:115], a[4:7], v[172:175], v[112:115]
    ds_read_b64 v[160:161], v198 offset:768
    v_mfma_f32_32x32x16_bf16 v[80:95], a[4:7], v[176:179], v[80:95]
    ds_read_b64 v[162:163], v198 offset:832
    ds_read_b64 v[164:165], v196 offset:6144
    ds_read_b64 v[166:167], v196 offset:6656
    v_mfma_f32_32x32x16_bf16 v[96:111], a[4:7], v[180:183], v[96:111]
    ds_read_b64 v[168:169], v196 offset:6400
    ds_read_b64 v[170:171], v196 offset:6912
    buffer_load_dwordx4 v74, s[16:19], s99 offen offset:1024 sc1 lds
    s_waitcnt lgkmcnt(6)
    v_mfma_f32_16x16x32_bf16 v[112:115], a[8:11], v[184:187], v[112:115]
    ds_read_b64 v[172:173], v198 offset:1024
    v_mfma_f32_32x32x16_bf16 v[80:95], a[8:11], v[188:191], v[80:95]
    ds_read_b64 v[174:175], v198 offset:1088
    ds_read_b64 v[176:177], v196 offset:8192
    ds_read_b64 v[178:179], v196 offset:8704
    v_mfma_f32_32x32x16_bf16 v[96:111], a[8:11], v[192:195], v[96:111]
    ds_read_b64 v[180:181], v196 offset:8448
    ds_read_b64 v[182:183], v196 offset:8960
    buffer_load_dwordx4 v75, s[16:19], s99 offen offset:2048 sc1 lds
    s_waitcnt lgkmcnt(6)
    v_mfma_f32_16x16x32_bf16 v[112:115], a[12:15], v[160:163], v[112:115]
    ds_read_b64 v[184:185], v198 offset:1280
    v_mfma_f32_32x32x16_bf16 v[80:95], a[12:15], v[164:167], v[80:95]
    ds_read_b64 v[186:187], v198 offset:1344
    ds_read_b64 v[188:189], v196 offset:10240
    ds_read_b64 v[190:191], v196 offset:10752
    v_mfma_f32_32x32x16_bf16 v[96:111], a[12:15], v[168:171], v[96:111]
    ds_read_b64 v[192:193], v196 offset:10496
    ds_read_b64 v[194:195], v196 offset:11008
    buffer_load_dwordx4 v76, s[16:19], s99 offen offset:3072 sc1 lds
    s_waitcnt lgkmcnt(6)
    v_mfma_f32_16x16x32_bf16 v[112:115], a[16:19], v[172:175], v[112:115]
    ds_read_b64 v[160:161], v198 offset:1536
    v_mfma_f32_32x32x16_bf16 v[80:95], a[16:19], v[176:179], v[80:95]
    ds_read_b64 v[162:163], v198 offset:1600
    ds_read_b64 v[164:165], v196 offset:12288
    ds_read_b64 v[166:167], v196 offset:12800
    v_mfma_f32_32x32x16_bf16 v[96:111], a[16:19], v[180:183], v[96:111]
    ds_read_b64 v[168:169], v196 offset:12544
    ds_read_b64 v[170:171], v196 offset:13056
    s_add_u32 m0, s93, 112512
    s_add_u32 s99, s99, 524288
    s_mov_b64 exec, s[80:81]
    buffer_load_dwordx4 v77, s[16:19], s100 offen sc1 lds
    s_mov_b64 exec, -1
    s_add_u32 s100, s100, 524288
    s_waitcnt lgkmcnt(6)
    v_mfma_f32_16x16x32_bf16 v[112:115], a[20:23], v[184:187], v[112:115]
    ds_read_b64 v[172:173], v198 offset:1792
    v_mfma_f32_32x32x16_bf16 v[80:95], a[20:23], v[188:191], v[80:95]
    ds_read_b64 v[174:175], v198 offset:1856
    ds_read_b64 v[176:177], v196 offset:14336
    ds_read_b64 v[178:179], v196 offset:14848
    v_mfma_f32_32x32x16_bf16 v[96:111], a[20:23], v[192:195], v[96:111]
    ds_read_b64 v[180:181], v196 offset:14592
    ds_read_b64 v[182:183], v196 offset:15104
    s_add_u32 m0, s92, 114688
    s_nop 0
    buffer_load_dwordx4 v73, s[16:19], s99 offen offset:0 sc1 lds
    s_waitcnt vmcnt(13)
    s_barrier
    s_waitcnt lgkmcnt(6)
    v_mfma_f32_16x16x32_bf16 v[112:115], a[24:27], v[160:163], v[112:115]
    v_add_u32 v198, v49, v198
    v_mfma_f32_32x32x16_bf16 v[80:95], a[24:27], v[164:167], v[80:95]
    v_add_u32 v196, 19584, v196
    ds_read_b64 v[184:185], v198 offset:0
    ds_read_b64 v[186:187], v198 offset:64
    ds_read_b64 v[188:189], v196 offset:0
    v_mfma_f32_32x32x16_bf16 v[96:111], a[24:27], v[168:171], v[96:111]
    ds_read_b64 v[190:191], v196 offset:512
    ds_read_b64 v[192:193], v196 offset:256
    ds_read_b64 v[194:195], v196 offset:768
    buffer_load_dwordx4 v74, s[16:19], s99 offen offset:1024 sc1 lds
    s_waitcnt lgkmcnt(6)
    v_mfma_f32_16x16x32_bf16 v[112:115], a[28:31], v[172:175], v[112:115]
    ds_read_b64 v[160:161], v198 offset:256
    v_mfma_f32_32x32x16_bf16 v[80:95], a[28:31], v[176:179], v[80:95]
    ds_read_b64 v[162:163], v198 offset:320
    ds_read_b64 v[164:165], v196 offset:2048
    ds_read_b64 v[166:167], v196 offset:2560
    v_mfma_f32_32x32x16_bf16 v[96:111], a[28:31], v[180:183], v[96:111]
    ds_read_b64 v[168:169], v196 offset:2304
    ds_read_b64 v[170:171], v196 offset:2816
    buffer_load_dwordx4 v75, s[16:19], s99 offen offset:2048 sc1 lds
    s_waitcnt lgkmcnt(6)
    v_mfma_f32_16x16x32_bf16 v[112:115], a[32:35], v[184:187], v[112:115]
    ds_read_b64 v[172:173], v198 offset:512
    v_mfma_f32_32x32x16_bf16 v[80:95], a[32:35], v[188:191], v[80:95]
    ds_read_b64 v[174:175], v198 offset:576
    ds_read_b64 v[176:177], v196 offset:4096
    ds_read_b64 v[178:179], v196 offset:4608
    v_mfma_f32_32x32x16_bf16 v[96:111], a[32:35], v[192:195], v[96:111]
    ds_read_b64 v[180:181], v196 offset:4352
    ds_read_b64 v[182:183], v196 offset:4864
    buffer_load_dwordx4 v76, s[16:19], s99 offen offset:3072 sc1 lds
    s_waitcnt lgkmcnt(6)
    v_mfma_f32_16x16x32_bf16 v[112:115], a[36:39], v[160:163], v[112:115]
    ds_read_b64 v[184:185], v198 offset:768
    v_mfma_f32_32x32x16_bf16 v[80:95], a[36:39], v[164:167], v[80:95]
    ds_read_b64 v[186:187], v198 offset:832
    ds_read_b64 v[188:189], v196 offset:6144
    ds_read_b64 v[190:191], v196 offset:6656
    v_mfma_f32_32x32x16_bf16 v[96:111], a[36:39], v[168:171], v[96:111]
    ds_read_b64 v[192:193], v196 offset:6400
    ds_read_b64 v[194:195], v196 offset:6912
    s_add_u32 m0, s93, 132096
    s_add_u32 s99, s99, 524288
    s_mov_b64 exec, s[80:81]
    buffer_load_dwordx4 v77, s[16:19], s100 offen sc1 lds
    s_mov_b64 exec, -1
    s_add_u32 s100, s100, 524288
    s_waitcnt lgkmcnt(6)
    v_mfma_f32_16x16x32_bf16 v[112:115], a[40:43], v[172:175], v[112:115]
    ds_read_b64 v[160:161], v198 offset:1024
    v_mfma_f32_32x32x16_bf16 v[80:95], a[40:43], v[176:179], v[80:95]
    ds_read_b64 v[162:163], v198 offset:1088
    ds_read_b64 v[164:165], v196 offset:8192
    ds_read_b64 v[166:167], v196 offset:8704
    v_add_u32 v199, 36352, v58
    s_lshl_b32 s32, s24, 11
    v_mfma_f32_32x32x16_bf16 v[96:111], a[40:43], v[180:183], v[96:111]
    ds_read_b64 v[168:169], v196 offset:8448
    ds_read_b64 v[170:171], v196 offset:8960
    v_add_u32 v203, s32, v199
    s_add_u32 s32, s24, 1
    s_waitcnt lgkmcnt(6)
    v_mfma_f32_16x16x32_bf16 v[112:115], a[44:47], v[184:187], v[112:115]
    ds_read_b64 v[172:173], v198 offset:1280
    v_mfma_f32_32x32x16_bf16 v[80:95], a[44:47], v[188:191], v[80:95]
    ds_read_b64 v[174:175], v198 offset:1344
    ds_read_b64 v[176:177], v196 offset:10240
    ds_read_b64 v[178:179], v196 offset:10752
    s_and_b32 s32, s32, 3
    s_mul_i32 s32, s32, 6144
    v_mfma_f32_32x32x16_bf16 v[96:111], a[44:47], v[192:195], v[96:111]
    ds_read_b64 v[180:181], v196 offset:10496
    ds_read_b64 v[182:183], v196 offset:11008
    v_add_u32 v200, s32, v199
    s_add_u32 s32, s24, 2
    s_waitcnt lgkmcnt(6)
    v_mfma_f32_16x16x32_bf16 v[112:115], a[48:51], v[160:163], v[112:115]
    ds_read_b64 v[184:185], v198 offset:1536
    v_mfma_f32_32x32x16_bf16 v[80:95], a[48:51], v[164:167], v[80:95]
    ds_read_b64 v[186:187], v198 offset:1600
    ds_read_b64 v[188:189], v196 offset:12288
    ds_read_b64 v[190:191], v196 offset:12800
    s_and_b32 s32, s32, 3
    s_mul_i32 s32, s32, 6144
    v_mfma_f32_32x32x16_bf16 v[96:111], a[48:51], v[168:171], v[96:111]
    ds_read_b64 v[192:193], v196 offset:12544
    ds_read_b64 v[194:195], v196 offset:13056
    v_add_u32 v201, s32, v199
    s_add_u32 s32, s24, 3
    s_waitcnt lgkmcnt(6)
    v_mfma_f32_16x16x32_bf16 v[112:115], a[52:55], v[172:175], v[112:115]
    ds_read_b64 v[160:161], v198 offset:1792
    v_mfma_f32_32x32x16_bf16 v[80:95], a[52:55], v[176:179], v[80:95]
    ds_read_b64 v[162:163], v198 offset:1856
    ds_read_b64 v[164:165], v196 offset:14336
    ds_read_b64 v[166:167], v196 offset:14848
    s_and_b32 s32, s32, 3
    s_mul_i32 s32, s32, 6144
    v_mfma_f32_32x32x16_bf16 v[96:111], a[52:55], v[180:183], v[96:111]
    ds_read_b64 v[168:169], v196 offset:14592
    ds_read_b64 v[170:171], v196 offset:15104
    v_add_u32 v202, s32, v199
    s_mul_i32 s32, s24, 6144
    s_waitcnt vmcnt(12)
    s_barrier
    s_waitcnt lgkmcnt(6)
    v_mfma_f32_16x16x32_bf16 v[112:115], a[56:59], v[184:187], v[112:115]
    v_add_u32 v198, v49, v198
    v_mfma_f32_32x32x16_bf16 v[80:95], a[56:59], v[188:191], v[80:95]
    v_add_u32 v196, 19584, v196
    ds_read_b64 v[172:173], v198 offset:0
    ds_read_b64 v[174:175], v198 offset:64
    ds_read_b64 v[176:177], v196 offset:0
    v_add_u32_e64 v204, s32, v199
    v_mfma_f32_32x32x16_bf16 v[96:111], a[56:59], v[192:195], v[96:111]
    ds_read_b64 v[178:179], v196 offset:512
    ds_read_b64 v[180:181], v196 offset:256
    ds_read_b64 v[182:183], v196 offset:768
    s_lshl_b32 s32, s24, 8
    s_waitcnt lgkmcnt(6)
    v_mfma_f32_16x16x32_bf16 v[112:115], a[60:63], v[160:163], v[112:115]
    ds_read_b64 v[184:185], v198 offset:256
    v_mfma_f32_32x32x16_bf16 v[80:95], a[60:63], v[164:167], v[80:95]
    ds_read_b64 v[186:187], v198 offset:320
    ds_read_b64 v[188:189], v196 offset:2048
    ds_read_b64 v[190:191], v196 offset:2560
    s_add_u32 s32, s32, 36352
    v_and_b32_e64 v214, 15, v1
    v_mfma_f32_32x32x16_bf16 v[96:111], a[60:63], v[168:171], v[96:111]
    ds_read_b64 v[192:193], v196 offset:2304
    ds_read_b64 v[194:195], v196 offset:2816
    v_lshl_add_u32 v206, v214, 4, s32
    v_lshrrev_b32 v215, 5, v1
    s_waitcnt lgkmcnt(6)
    v_mfma_f32_16x16x32_bf16 v[112:115], a[64:67], v[172:175], v[112:115]
    ds_read_b64 v[160:161], v198 offset:512
    v_mfma_f32_32x32x16_bf16 v[80:95], a[64:67], v[176:179], v[80:95]
    ds_read_b64 v[162:163], v198 offset:576
    ds_read_b64 v[164:165], v196 offset:4096
    ds_read_b64 v[166:167], v196 offset:4608
    v_lshl_add_u32 v205, v215, 10, v206
    v_bfe_u32 v215, v1, 4, 1
    v_mfma_f32_32x32x16_bf16 v[96:111], a[64:67], v[180:183], v[96:111]
    ds_read_b64 v[168:169], v196 offset:4352
    ds_read_b64 v[170:171], v196 offset:4864
    v_lshl_add_u32 v205, v215, 3, v205
    v_lshlrev_b32 v214, 2, v214
    s_waitcnt lgkmcnt(6)
    v_mfma_f32_16x16x32_bf16 v[112:115], a[68:71], v[184:187], v[112:115]
    ds_read_b64 v[172:173], v198 offset:768
    v_mfma_f32_32x32x16_bf16 v[80:95], a[68:71], v[188:191], v[80:95]
    ds_read_b64 v[174:175], v198 offset:832
    ds_read_b64 v[176:177], v196 offset:6144
    ds_read_b64 v[178:179], v196 offset:6656
    v_lshl_add_u32 v214, v215, 10, v214
    s_lshl_b32 s32, s24, 6
    v_mfma_f32_32x32x16_bf16 v[96:111], a[68:71], v[192:195], v[96:111]
    ds_read_b64 v[180:181], v196 offset:6400
    ds_read_b64 v[182:183], v196 offset:6912
    v_lshl_add_u32 v207, v215, 3, s32
    v_and_b32_e64 v215, 12, v1
    s_waitcnt lgkmcnt(6)
    v_mfma_f32_16x16x32_bf16 v[112:115], a[72:75], v[160:163], v[112:115]
    ds_read_b64 v[184:185], v198 offset:1024
    v_mfma_f32_32x32x16_bf16 v[80:95], a[72:75], v[164:167], v[80:95]
    ds_read_b64 v[186:187], v198 offset:1088
    ds_read_b64 v[188:189], v196 offset:8192
    ds_read_b64 v[190:191], v196 offset:8704
    v_lshl_add_u32 v207, v215, 2, v207
    v_and_b32_e64 v215, 2, v1
    v_mfma_f32_32x32x16_bf16 v[96:111], a[72:75], v[168:171], v[96:111]
    ds_read_b64 v[192:193], v196 offset:8448
    ds_read_b64 v[194:195], v196 offset:8960
    s_lshl_b32 s98, s72, 5
    s_add_u32 s98, s98, 256
    s_sub_u32 s95, s98, 4
    s_max_i32 s95, s95, 0
    s_lshl_b32 s94, s98, 3
    s_lshl_b32 s95, s95, 3
    s_add_u32 s94, s94, 3457024
    s_add_u32 s95, s95, 3457024
    s_add_u32 s96, s94, 8192
    buffer_load_dwordx2 v[152:153], v47, s[16:19], s94 offen sc1
    s_waitcnt lgkmcnt(6)
    v_mfma_f32_16x16x32_bf16 v[112:115], a[76:79], v[172:175], v[112:115]
    ds_read_b64 v[160:161], v198 offset:1280
    v_mfma_f32_32x32x16_bf16 v[80:95], a[76:79], v[176:179], v[80:95]
    ds_read_b64 v[162:163], v198 offset:1344
    ds_read_b64 v[164:165], v196 offset:10240
    ds_read_b64 v[166:167], v196 offset:10752
    v_lshl_add_u32 v207, v215, 1, v207
    v_add_u32 v207, 69120, v207
    v_mfma_f32_32x32x16_bf16 v[96:111], a[76:79], v[180:183], v[96:111]
    ds_read_b64 v[168:169], v196 offset:10496
    ds_read_b64 v[170:171], v196 offset:11008
    buffer_load_dwordx2 v[154:155], v47, s[16:19], s96 offen sc1
    v_lshrrev_b32 v215, 4, v1
    s_waitcnt lgkmcnt(6)
    v_mfma_f32_16x16x32_bf16 v[112:115], a[80:83], v[184:187], v[112:115]
    ds_read_b64 v[172:173], v198 offset:1536
    v_mfma_f32_32x32x16_bf16 v[80:95], a[80:83], v[188:191], v[80:95]
    ds_read_b64 v[174:175], v198 offset:1600
    ds_read_b64 v[176:177], v196 offset:12288
    ds_read_b64 v[178:179], v196 offset:12800
    v_lshl_add_u32 v206, v215, 2, v206
    v_mov_b32 v215, 0x3f803f80
    v_mfma_f32_32x32x16_bf16 v[96:111], a[80:83], v[192:195], v[96:111]
    ds_read_b64 v[180:181], v196 offset:12544
    ds_read_b64 v[182:183], v196 offset:13056
    buffer_load_dwordx2 v[156:157], v48, s[16:19], s95 offen sc1
    s_waitcnt lgkmcnt(6)
    v_mfma_f32_16x16x32_bf16 v[112:115], a[84:87], v[160:163], v[112:115]
    ds_read_b64 v[184:185], v198 offset:1792
    v_mfma_f32_32x32x16_bf16 v[80:95], a[84:87], v[164:167], v[80:95]
    ds_read_b64 v[186:187], v198 offset:1856
    ds_read_b64 v[188:189], v196 offset:14336
    ds_read_b64 v[190:191], v196 offset:14848
    v_mfma_f32_32x32x16_bf16 v[96:111], a[84:87], v[168:171], v[96:111]
    ds_read_b64 v[192:193], v196 offset:14592
    ds_read_b64 v[194:195], v196 offset:15104
    s_waitcnt vmcnt(8)
    s_barrier
    s_waitcnt lgkmcnt(6)
    v_mfma_f32_16x16x32_bf16 v[112:115], a[88:91], v[172:175], v[112:115]
    v_add_u32_e64 v198, v49, v198
    v_mfma_f32_32x32x16_bf16 v[80:95], a[88:91], v[176:179], v[80:95]
    v_add_u32 v196, 19584, v196
    ds_read_b64 v[160:161], v198 offset:0
    ds_read_b64 v[162:163], v198 offset:64
    ds_read_b64 v[164:165], v196 offset:0
    v_mfma_f32_32x32x16_bf16 v[96:111], a[88:91], v[180:183], v[96:111]
    ds_read_b64 v[166:167], v196 offset:512
    ds_read_b64 v[168:169], v196 offset:256
    ds_read_b64 v[170:171], v196 offset:768
    s_waitcnt lgkmcnt(6)
    v_mfma_f32_16x16x32_bf16 v[112:115], a[92:95], v[184:187], v[112:115]
    ds_read_b64 v[172:173], v198 offset:256
    v_mfma_f32_32x32x16_bf16 v[80:95], a[92:95], v[188:191], v[80:95]
    ds_read_b64 v[174:175], v198 offset:320
    ds_read_b64 v[176:177], v196 offset:2048
    ds_read_b64 v[178:179], v196 offset:2560
    v_mfma_f32_32x32x16_bf16 v[96:111], a[92:95], v[192:195], v[96:111]
    ds_read_b64 v[180:181], v196 offset:2304
    ds_read_b64 v[182:183], v196 offset:2816
    s_waitcnt lgkmcnt(6)
    v_mfma_f32_16x16x32_bf16 v[112:115], a[96:99], v[160:163], v[112:115]
    ds_read_b64 v[184:185], v198 offset:512
    v_mfma_f32_32x32x16_bf16 v[80:95], a[96:99], v[164:167], v[80:95]
    ds_read_b64 v[186:187], v198 offset:576
    ds_read_b64 v[188:189], v196 offset:4096
    ds_read_b64 v[190:191], v196 offset:4608
    v_mfma_f32_32x32x16_bf16 v[96:111], a[96:99], v[168:171], v[96:111]
    ds_read_b64 v[192:193], v196 offset:4352
    ds_read_b64 v[194:195], v196 offset:4864
    s_waitcnt lgkmcnt(6)
    v_mfma_f32_16x16x32_bf16 v[112:115], a[100:103], v[172:175], v[112:115]
    ds_read_b64 v[160:161], v198 offset:768
    v_mfma_f32_32x32x16_bf16 v[80:95], a[100:103], v[176:179], v[80:95]
    ds_read_b64 v[162:163], v198 offset:832
    ds_read_b64 v[164:165], v196 offset:6144
    ds_read_b64 v[166:167], v196 offset:6656
    v_mfma_f32_32x32x16_bf16 v[96:111], a[100:103], v[180:183], v[96:111]
    ds_read_b64 v[168:169], v196 offset:6400
    ds_read_b64 v[170:171], v196 offset:6912
    s_waitcnt lgkmcnt(6)
    v_mfma_f32_16x16x32_bf16 v[112:115], a[104:107], v[184:187], v[112:115]
    ds_read_b64 v[172:173], v198 offset:1024
    v_mfma_f32_32x32x16_bf16 v[80:95], a[104:107], v[188:191], v[80:95]
    ds_read_b64 v[174:175], v198 offset:1088
    ds_read_b64 v[176:177], v196 offset:8192
    ds_read_b64 v[178:179], v196 offset:8704
    v_mfma_f32_32x32x16_bf16 v[96:111], a[104:107], v[192:195], v[96:111]
    ds_read_b64 v[180:181], v196 offset:8448
    ds_read_b64 v[182:183], v196 offset:8960
    s_waitcnt lgkmcnt(6)
    v_mfma_f32_16x16x32_bf16 v[112:115], a[108:111], v[160:163], v[112:115]
    ds_read_b64 v[184:185], v198 offset:1280
    v_mfma_f32_32x32x16_bf16 v[80:95], a[108:111], v[164:167], v[80:95]
    ds_read_b64 v[186:187], v198 offset:1344
    ds_read_b64 v[188:189], v196 offset:10240
    ds_read_b64 v[190:191], v196 offset:10752
    v_mfma_f32_32x32x16_bf16 v[96:111], a[108:111], v[168:171], v[96:111]
    ds_read_b64 v[192:193], v196 offset:10496
    ds_read_b64 v[194:195], v196 offset:11008
    s_waitcnt lgkmcnt(6)
    v_mfma_f32_16x16x32_bf16 v[112:115], a[112:115], v[172:175], v[112:115]
    ds_read_b64 v[160:161], v198 offset:1536
    v_mfma_f32_32x32x16_bf16 v[80:95], a[112:115], v[176:179], v[80:95]
    ds_read_b64 v[162:163], v198 offset:1600
    ds_read_b64 v[164:165], v196 offset:12288
    ds_read_b64 v[166:167], v196 offset:12800
    v_mfma_f32_32x32x16_bf16 v[96:111], a[112:115], v[180:183], v[96:111]
    ds_read_b64 v[168:169], v196 offset:12544
    ds_read_b64 v[170:171], v196 offset:13056
    s_waitcnt lgkmcnt(6)
    v_mfma_f32_16x16x32_bf16 v[112:115], a[116:119], v[184:187], v[112:115]
    ds_read_b64 v[172:173], v198 offset:1792
    v_mfma_f32_32x32x16_bf16 v[80:95], a[116:119], v[188:191], v[80:95]
    ds_read_b64 v[174:175], v198 offset:1856
    ds_read_b64 v[176:177], v196 offset:14336
    ds_read_b64 v[178:179], v196 offset:14848
    v_mfma_f32_32x32x16_bf16 v[96:111], a[116:119], v[192:195], v[96:111]
    ds_read_b64 v[180:181], v196 offset:14592
    ds_read_b64 v[182:183], v196 offset:15104
sl_70:
    s_waitcnt vmcnt(1)
    v_max3_u32 v2, v152, v153, v154
    s_waitcnt vmcnt(0)
    v_max3_u32 v2, v2, v155, v156
    v_max_u32 v2, v2, v157
    v_cmp_eq_u32 vcc, -1, v2
    s_nop 0
    s_cbranch_vccnz rd_71
rc_72:
    s_barrier
    s_waitcnt lgkmcnt(6)
    v_mfma_f32_16x16x32_bf16 v[112:115], a[120:123], v[160:163], v[112:115]
    v_add_u32 v198, v49, v198
    v_mfma_f32_32x32x16_bf16 v[80:95], a[120:123], v[164:167], v[80:95]
    v_add_u32 v196, 19584, v196
    ds_read_b64 v[184:185], v198 offset:0
    ds_read_b64 v[186:187], v198 offset:64
    v_mul_f32 v148, v24, v157
    v_mul_f32 v149, v25, v157
    v_mfma_f32_32x32x16_bf16 v[96:111], a[120:123], v[168:171], v[96:111]
    ds_read_b64 v[188:189], v196 offset:0
    ds_read_b64 v[190:191], v196 offset:512
    s_mov_b32 s96, 12058624
    buffer_load_dwordx4 v[216:219], v56, s[16:19], s96 offen offset:0 sc1
    v_mul_f32 v150, v26, v157
    v_mul_f32_e64 v151, v27, v157
    s_waitcnt lgkmcnt(4)
    v_mfma_f32_16x16x32_bf16 v[112:115], a[124:127], v[172:175], v[112:115]
    ds_read_b64 v[192:193], v198 offset:256
    v_mfma_f32_32x32x16_bf16 v[80:95], a[124:127], v[176:179], v[80:95]
    ds_read_b64 v[194:195], v198 offset:320
    ds_read_b64 v[160:161], v196 offset:2048
    v_mul_f32 v116, v8, v153
    v_mul_f32 v117, v9, v153
    v_mul_f32_e64 v118, v10, v153
    v_mfma_f32_32x32x16_bf16 v[96:111], a[124:127], v[180:183], v[96:111]
    ds_read_b64 v[162:163], v196 offset:2560
    buffer_load_dwordx4 v[220:223], v56, s[16:19], s96 offen offset:256 sc1
    v_mul_f32 v119, v11, v153
    v_mul_f32_e64 v120, v12, v153
    s_waitcnt lgkmcnt(4)
    v_mfma_f32_16x16x32_bf16 v[112:115], a[128:131], v[184:187], v[112:115]
    ds_read_b64 v[164:165], v198 offset:512
    v_mfma_f32_32x32x16_bf16 v[80:95], a[128:131], v[188:191], v[80:95]
    ds_read_b64 v[166:167], v198 offset:576
    ds_read_b64 v[168:169], v196 offset:4096
    ds_read_b64 v[170:171], v196 offset:4608
    v_mul_f32 v121, v13, v153
    v_mul_f32_e64 v122, v14, v153
    s_waitcnt lgkmcnt(4)
    v_mfma_f32_16x16x32_bf16 v[112:115], a[132:135], v[192:195], v[112:115]
    ds_read_b64 v[172:173], v198 offset:768
    v_mfma_f32_32x32x16_bf16 v[80:95], a[132:135], v[160:163], v[80:95]
    ds_read_b64 v[174:175], v198 offset:832
    ds_read_b64 v[176:177], v196 offset:6144
    ds_read_b64 v[178:179], v196 offset:6656
    s_mov_b32 s96, 12091392
    buffer_load_dwordx4 v[224:227], v56, s[16:19], s96 offen offset:0 sc1
    v_mul_f32 v123, v15, v153
    v_mul_f32_e64 v124, v16, v153
    s_waitcnt lgkmcnt(4)
    v_mfma_f32_16x16x32_bf16 v[112:115], a[136:139], v[164:167], v[112:115]
    ds_read_b64 v[180:181], v198 offset:1024
    v_mfma_f32_32x32x16_bf16 v[80:95], a[136:139], v[168:171], v[80:95]
    ds_read_b64 v[182:183], v198 offset:1088
    ds_read_b64 v[184:185], v196 offset:8192
    ds_read_b64 v[186:187], v196 offset:8704
    v_mul_f32 v125, v17, v153
    v_mul_f32_e64 v126, v18, v153
    s_waitcnt lgkmcnt(4)
    v_mfma_f32_16x16x32_bf16 v[112:115], a[140:143], v[172:175], v[112:115]
    ds_read_b64 v[188:189], v198 offset:1280
    v_mfma_f32_32x32x16_bf16 v[80:95], a[140:143], v[176:179], v[80:95]
    ds_read_b64 v[190:191], v198 offset:1344
    ds_read_b64 v[192:193], v196 offset:10240
    ds_read_b64 v[194:195], v196 offset:10752
    buffer_load_dwordx4 v[228:231], v56, s[16:19], s96 offen offset:256 sc1
    v_mul_f32 v127, v19, v153
    v_mul_f32_e64 v128, v20, v153
    s_waitcnt lgkmcnt(4)
    v_mfma_f32_16x16x32_bf16 v[112:115], a[144:147], v[180:183], v[112:115]
    ds_read_b64 v[160:161], v198 offset:1536
    v_mfma_f32_32x32x16_bf16 v[80:95], a[144:147], v[184:187], v[80:95]
    ds_read_b64 v[162:163], v198 offset:1600
    ds_read_b64 v[164:165], v196 offset:12288
    ds_read_b64 v[166:167], v196 offset:12800
    v_mul_f32 v129, v21, v153
    v_mul_f32_e64 v130, v22, v153
    s_waitcnt lgkmcnt(4)
    v_mfma_f32_16x16x32_bf16 v[112:115], a[148:151], v[188:191], v[112:115]
    ds_read_b64 v[168:169], v198 offset:1792
    v_mfma_f32_32x32x16_bf16 v[80:95], a[148:151], v[192:195], v[80:95]
    ds_read_b64 v[170:171], v198 offset:1856
    ds_read_b64 v[172:173], v196 offset:14336
    ds_read_b64 v[174:175], v196 offset:14848
    s_mov_b32 s96, 12124160
    buffer_load_dwordx4 v[232:235], v56, s[16:19], s96 offen offset:0 sc1
    v_mul_f32 v131, v23, v153
    v_mul_f32_e64 v132, v8, v155
    s_waitcnt lgkmcnt(4)
    v_mfma_f32_16x16x32_bf16 v[112:115], a[152:155], v[160:163], v[112:115]
    ds_read_b64 v[176:177], v196 offset:256
    v_mfma_f32_32x32x16_bf16 v[80:95], a[152:155], v[164:167], v[80:95]
    ds_read_b64 v[178:179], v196 offset:768
    ds_read_b64 v[180:181], v196 offset:2304
    ds_read_b64 v[182:183], v196 offset:2816
    v_mul_f32 v133, v9, v155
    v_mul_f32_e64 v134, v10, v155
    s_waitcnt lgkmcnt(4)
    v_mfma_f32_16x16x32_bf16 v[112:115], a[156:159], v[168:171], v[112:115]
    ds_read_b64 v[184:185], v196 offset:4352
    v_mfma_f32_32x32x16_bf16 v[80:95], a[156:159], v[172:175], v[80:95]
    ds_read_b64 v[186:187], v196 offset:4864
    ds_read_b64 v[188:189], v196 offset:6400
    ds_read_b64 v[190:191], v196 offset:6912
    buffer_load_dwordx4 v[236:239], v56, s[16:19], s96 offen offset:256 sc1
    v_mul_f32 v135, v11, v155
    v_mul_f32 v136, v12, v155
    v_mul_f32 v137, v13, v155
    v_mul_f32 v138, v14, v155
    v_mul_f32 v139, v15, v155
    v_mul_f32 v140, v16, v155
    v_mul_f32 v141, v17, v155
    v_mul_f32 v142, v18, v155
    v_mul_f32 v143, v19, v155
    v_mul_f32 v144, v20, v155
    v_mul_f32 v145, v21, v155
    v_mul_f32 v146, v22, v155
    v_mul_f32 v147, v23, v155
    s_waitcnt lgkmcnt(4)
    v_mfma_f32_32x32x16_bf16 v[96:111], a[128:131], v[176:179], v[96:111]
    ds_read_b64 v[192:193], v196 offset:8448
    ds_read_b64 v[194:195], v196 offset:8960
    v_mfma_f32_32x32x16_bf16 v[96:111], a[132:135], v[180:183], v[96:111]
    ds_read_b64 v[160:161], v196 offset:10496
    ds_read_b64 v[162:163], v196 offset:11008
    s_mov_b32 s96, 12156928
    buffer_load_dwordx4 v[240:243], v56, s[16:19], s96 offen offset:0 sc1
    v_fma_f32 v112, v112, v156, v148
    v_fma_f32 v113, v113, v156, v149
    s_waitcnt lgkmcnt(4)
    v_mfma_f32_32x32x16_bf16 v[96:111], a[136:139], v[184:187], v[96:111]
    ds_read_b64 v[164:165], v196 offset:12544
    ds_read_b64 v[166:167], v196 offset:13056
    v_fma_f32 v114, v114, v156, v150
    v_fma_f32 v115, v115, v156, v151
    v_cvt_pk_bf16_f32 v112, v112, v113
    v_mfma_f32_32x32x16_bf16 v[96:111], a[140:143], v[188:191], v[96:111]
    ds_read_b64 v[168:169], v196 offset:14592
    ds_read_b64 v[170:171], v196 offset:15104
    buffer_load_dwordx4 v[244:247], v56, s[16:19], s96 offen offset:256 sc1
    v_cvt_pk_bf16_f32 v113, v114, v115
    v_fma_f32 v80, v80, v152, v116
    s_waitcnt lgkmcnt(4)
    v_mfma_f32_32x32x16_bf16 v[96:111], a[144:147], v[192:195], v[96:111]
    v_fma_f32 v81, v81, v152, v117
    v_fma_f32 v82, v82, v152, v118
    v_fma_f32 v83, v83, v152, v119
    v_cvt_pk_bf16_f32 v80, v80, v81
    v_cvt_pk_bf16_f32 v81, v82, v83
    v_mfma_f32_32x32x16_bf16 v[96:111], a[148:151], v[160:163], v[96:111]
    ds_write_b64 v40, v[112:113] offset:0
    ds_write_b64 v38, v[80:81] offset:0
    v_fma_f32 v84, v84, v152, v120
    v_fma_f32 v85, v85, v152, v121
    s_waitcnt lgkmcnt(2)
    v_mfma_f32_32x32x16_bf16 v[96:111], a[152:155], v[164:167], v[96:111]
    v_fma_f32 v86, v86, v152, v122
    v_fma_f32 v87, v87, v152, v123
    v_cvt_pk_bf16_f32 v84, v84, v85
    v_cvt_pk_bf16_f32 v85, v86, v87
    v_fma_f32 v88, v88, v152, v124
    v_mfma_f32_32x32x16_bf16 v[96:111], a[156:159], v[168:171], v[96:111]
    s_mov_b32 s96, 12058624
    buffer_load_dwordx2 v[248:249], v57, s[16:19], s96 offen offset:0 sc1
    v_fma_f32 v89, v89, v152, v125
    v_fma_f32 v90, v90, v152, v126
    v_fma_f32 v91, v91, v152, v127
    v_cvt_pk_bf16_f32 v88, v88, v89
    v_cvt_pk_bf16_f32 v89, v90, v91
    ds_write_b64 v38, v[84:85] offset:6400
    ds_write_b64 v38, v[88:89] offset:12800
    v_fma_f32 v92, v92, v152, v128
    v_fma_f32 v93, v93, v152, v129
    v_fma_f32 v94, v94, v152, v130
    v_fma_f32 v95, v95, v152, v131
    v_cvt_pk_bf16_f32 v92, v92, v93
    v_cvt_pk_bf16_f32 v93, v94, v95
    ds_write_b64 v39, v[92:93] offset:0
    v_pk_fma_f32 v[96:97], v[96:97], v[154:155], v[132:133] op_sel_hi:[1,0,1]
    v_pk_fma_f32 v[98:99], v[98:99], v[154:155], v[134:135] op_sel_hi:[1,0,1]
    v_cvt_pk_bf16_f32 v96, v96, v97
    v_cvt_pk_bf16_f32 v97, v98, v99
    v_pk_fma_f32 v[100:101], v[100:101], v[154:155], v[136:137] op_sel_hi:[1,0,1]
    v_pk_fma_f32 v[102:103], v[102:103], v[154:155], v[138:139] op_sel_hi:[1,0,1]
    v_cvt_pk_bf16_f32 v100, v100, v101
    v_cvt_pk_bf16_f32 v101, v102, v103
    ds_write_b64 v38, v[96:97] offset:1600
    ds_write_b64 v38, v[100:101] offset:8000
    v_pk_fma_f32 v[104:105], v[104:105], v[154:155], v[140:141] op_sel_hi:[1,0,1]
    v_pk_fma_f32 v[106:107], v[106:107], v[154:155], v[142:143] op_sel_hi:[1,0,1]
    v_cvt_pk_bf16_f32 v104, v104, v105
    v_cvt_pk_bf16_f32 v105, v106, v107
    v_pk_fma_f32 v[108:109], v[108:109], v[154:155], v[144:145] op_sel_hi:[1,0,1]
    v_pk_fma_f32 v[110:111], v[110:111], v[154:155], v[146:147] op_sel_hi:[1,0,1]
    v_cvt_pk_bf16_f32 v108, v108, v109
    v_cvt_pk_bf16_f32 v109, v110, v111
    ds_write_b64 v38, v[104:105] offset:14400
    ds_write_b64 v39, v[108:109] offset:1600
    v_cmp_u_f32 vcc, v82, v114
    v_cmp_u_f32 s[82:83], v98, v98
    s_lshl_b32 s25, s24, 2
    s_add_u32 s25, s25, 161280
    s_or_b64 vcc, vcc, s[82:83]
    s_cselect_b32 s26, 1, 0
    v_mov_b32 v196, s25
    v_mov_b32 v197, s26
    ds_write_b32 v196, v197
    s_waitcnt lgkmcnt(0)
    s_barrier
    v_mov_b32 v158, 161280
    ds_read_b128 v[128:131], v158
    v_mov_b32 v94, 0
    v_mov_b32 v95, 0
    v_mov_b32 v98, 0
    v_mov_b32_e64 v99, 0
    s_mov_b64 exec, 0xffff
    ds_read_b64 v[94:95], v42 offset:320
    ds_read_b64 v[98:99], v42 offset:640
    s_mov_b64 exec, -1
    s_nop 0
    ds_read_b64 v[92:93], v41 offset:320
    ds_read_b64 v[96:97], v41 offset:640
    ds_read_b64 v[84:85], v41 offset:6720
    ds_read_b64 v[86:87], v42 offset:6720
    ds_read_b64 v[80:81], v41 offset:6400
    ds_read_b64 v[82:83], v42 offset:6400
    ds_read_b64 v[88:89], v41 offset:7040
    ds_read_b64 v[90:91], v42 offset:7040
    ds_read_b64_tr_b16 v[106:107], v44 offset:0
    ds_read_b64_tr_b16 v[100:101], v43 offset:0
    buffer_load_dwordx2 v[252:253], v57, s[16:19], s96 offen offset:128 sc1
    ds_read_b64_tr_b16 v[108:109], v44 offset:320
    ds_read_b64_tr_b16 v[102:103], v43 offset:320
    ds_read_b64_tr_b16 v[110:111], v44 offset:640
    ds_read_b64_tr_b16 v[104:105], v43 offset:640
    s_mov_b32 s82, 0x3ea52b5c
    s_lshl_b32 s25, s98, 4
    s_add_u32 s25, s25, 12058624
    s_lshl_b32 s26, s98, 3
    s_mov_b32 s96, 12075008
    buffer_load_dwordx2 v[250:251], v57, s[16:19], s96 offen offset:0 sc1
    s_add_u32 s26, s26, 12058624
    s_waitcnt lgkmcnt(15)
    v_or3_b32 v128, v128, v129, v130
    v_or_b32 v128, v128, v131
    v_cmp_ne_u32 vcc, 0, v128
    s_nop 0
    s_cbranch_vccnz rd_73
rc_74:
    s_waitcnt lgkmcnt(10)
    v_mfma_f32_16x16x32_bf16 v[116:119], v[84:87], v[92:95], v[28:31]
    v_mfma_f32_16x16x32_bf16 v[120:123], v[84:87], v[96:99], v[32:35]
    s_waitcnt lgkmcnt(8)
    v_mfma_f32_16x16x32_bf16 v[112:115], v[80:83], v[92:95], v[32:35]
    s_waitcnt lgkmcnt(6)
    v_mfma_f32_16x16x32_bf16 v[124:127], v[88:91], v[96:99], v[28:31]
    buffer_load_dwordx2 v[254:255], v57, s[16:19], s96 offen offset:128 sc1
    s_nop 4
    v_max_f32 v112, v112, v116
    v_max_f32 v113, v113, v117
    v_max_f32 v114, v114, v118
    v_max_f32 v115, v115, v119
    v_max3_f32 v156, v112, v113, v114
    v_max_f32 v156, v156, v115
    v_max_f32 v120, v120, v124
    v_max_f32 v121, v121, v125
    s_mov_b32 s96, 9437184
    buffer_load_dwordx4 v[208:211], v59, s[16:19], s96 offen sc1
    v_max_f32 v122, v122, v126
    v_max_f32 v123, v123, v127
    v_max3_f32 v157, v120, v121, v122
    v_max_f32 v157, v157, v123
    s_nop 1
    v_permlane16_swap_b32 v156, v157
    v_max_f32 v156, v156, v157
    v_mov_b32 v157, v156
    s_nop 1
    v_permlane32_swap_b32_e64 v156, v157
    s_add_u32 s97, s36, 9437184
    buffer_load_dword v212, v61, s[16:19], s97 offen sc1
    v_max_f32 v156, v156, v157
    v_mul_f32 v156, s82, v156
    v_mov_b32 v157, v156
    s_nop 1
    v_permlane16_swap_b32_e64 v156, v157
    v_fma_f32 v112, v112, s82, -v156
    v_fma_f32 v113, v113, s82, -v156
    v_fma_f32 v114, v114, s82, -v156
    v_fma_f32 v115, v115, s82, -v156
    v_exp_f32 v112, v112
    v_exp_f32 v113, v113
    v_exp_f32 v114, v114
    v_exp_f32 v115, v115
    v_cvt_pk_bf16_f32 v116, v112, v113
    v_cvt_pk_bf16_f32 v117, v114, v115
    v_bfi_b32 v128, v36, 0, v116
    v_and_b32 v130, v36, v116
    v_bfi_b32 v129, v37, 0, v117
    v_and_b32 v131, v37, v117
    s_waitcnt lgkmcnt(3)
    s_nop 0
    v_mfma_f32_16x16x32_bf16 v[144:147], v[106:109], v[128:131], 0
    s_waitcnt lgkmcnt(2)
    v_mfma_f32_16x16x32_bf16 v[136:139], v[100:103], v[128:131], 0
    v_fma_f32 v120, v120, s82, -v157
    v_fma_f32 v121, v121, s82, -v157
    v_fma_f32 v122, v122, s82, -v157
    v_fma_f32 v123, v123, s82, -v157
    v_exp_f32 v120, v120
    v_exp_f32 v121, v121
    v_exp_f32 v122, v122
    v_exp_f32_e64 v123, v123
    v_cvt_pk_bf16_f32 v124, v120, v121
    v_cvt_pk_bf16_f32 v125, v122, v123
    v_bfi_b32 v132, v36, 0, v124
    v_and_b32 v134, v36, v124
    v_bfi_b32 v133, v37, 0, v125
    v_and_b32 v135, v37, v125
    s_waitcnt lgkmcnt(1)
    s_nop 0
    v_mfma_f32_16x16x32_bf16 v[148:151], v[108:111], v[132:135], 0
    s_waitcnt lgkmcnt(0)
    v_mfma_f32_16x16x32_bf16 v[140:143], v[102:105], v[132:135], 0
    v_mov_b32 v158, v144
    s_nop 1
    v_permlane16_swap_b32 v144, v158
    v_rcp_f32 v158, v158
    s_nop 0
    v_pk_mul_f32 v[136:137], v[136:137], v[158:159] op_sel_hi:[1,0]
    v_pk_mul_f32 v[138:139], v[138:139], v[158:159] op_sel_hi:[1,0]
    v_pk_mul_f32 v[144:145], v[144:145], v[158:159] op_sel_hi:[1,0]
    v_pk_mul_f32 v[146:147], v[146:147], v[158:159] op_sel_hi:[1,0]
    v_cvt_pk_bf16_f32 v112, v136, v137
    v_cvt_pk_bf16_f32 v116, v144, v145
    v_cvt_pk_bf16_f32 v113, v138, v139
    v_cvt_pk_bf16_f32 v117, v146, v147
    v_mov_b32 v160, v148
    s_nop 1
    v_permlane16_swap_b32 v148, v160
    v_rcp_f32_e64 v160, v160
    s_nop 0
    v_pk_mul_f32 v[140:141], v[140:141], v[160:161] op_sel_hi:[1,0]
    v_pk_mul_f32 v[142:143], v[142:143], v[160:161] op_sel_hi:[1,0]
    v_pk_mul_f32 v[148:149], v[148:149], v[160:161] op_sel_hi:[1,0]
    v_pk_mul_f32 v[150:151], v[150:151], v[160:161] op_sel_hi:[1,0]
    v_cvt_pk_bf16_f32 v114, v140, v141
    v_cvt_pk_bf16_f32 v118, v148, v149
    v_cvt_pk_bf16_f32 v115, v142, v143
    v_cvt_pk_bf16_f32 v119, v150, v151
    v_permlane16_swap_b32 v112, v114
    v_permlane16_swap_b32 v113, v115
    v_permlane16_swap_b32 v116, v118
    v_permlane16_swap_b32 v117, v119
    buffer_store_dwordx4 v[112:115], v45, s[16:19], s25 offen sc1
    s_mov_b64 exec, s[80:81]
    buffer_store_dwordx2 v[116:117], v46, s[16:19], s26 offen sc1
    s_mov_b64 exec, -1
oe_75:
    s_waitcnt vmcnt(15)
    v_mfma_f32_16x16x32_bf16 v[112:115], a[176:179], v[216:219], 0
    v_mov_b32 v136, 0
    v_mov_b32 v137, 0
    s_waitcnt vmcnt(14)
    v_mfma_f32_16x16x32_bf16 v[116:119], a[176:179], v[220:223], 0
    v_mov_b32 v138, 0
    v_mov_b32 v139, 0
    s_waitcnt vmcnt(13)
    v_mfma_f32_16x16x32_bf16 v[112:115], a[196:199], v[224:227], v[112:115]
    v_mov_b32 v140, 0
    v_mov_b32 v141, 0
    s_waitcnt vmcnt(12)
    v_mfma_f32_16x16x32_bf16 v[116:119], a[196:199], v[228:231], v[116:119]
    s_mov_b32 s25, 14680064
    s_add_u32 s26, s36, 14680064
    s_waitcnt vmcnt(11)
    v_mfma_f32_16x16x32_bf16 v[112:115], a[216:219], v[232:235], v[112:115]
    s_add_u32 s27, s35, 3506176
    s_mov_b32 s28, 0x99999999
    s_waitcnt vmcnt(10)
    v_mfma_f32_16x16x32_bf16 v[116:119], a[216:219], v[236:239], v[116:119]
    s_mov_b32 s29, 0x99999999
    s_waitcnt vmcnt(9)
    v_mfma_f32_16x16x32_bf16 v[112:115], a[236:239], v[240:243], v[112:115]
    s_waitcnt vmcnt(8)
    v_mfma_f32_16x16x32_bf16 v[116:119], a[236:239], v[244:247], v[116:119]
    s_waitcnt vmcnt(5)
    v_mfma_f32_16x16x32_bf16 v[112:115], v[52:55], v[248:251], v[112:115]
    s_waitcnt vmcnt(4)
    v_mfma_f32_16x16x32_bf16 v[116:119], v[52:55], v[252:255], v[116:119]
    v_mfma_f32_16x16x32_bf16 v[88:91], a[164:167], v[216:219], 0
    v_mfma_f32_16x16x32_bf16 v[92:95], a[164:167], v[220:223], 0
    v_mfma_f32_16x16x32_bf16 v[88:91], a[184:187], v[224:227], v[88:91]
    s_waitcnt vmcnt(3)
    v_max3_u32 v132, v208, v209, v210
    s_waitcnt vmcnt(2)
    v_max3_u32 v132, v132, v211, v212
    v_mfma_f32_16x16x32_bf16 v[92:95], a[184:187], v[228:231], v[92:95]
    v_cmp_eq_u32 s[82:83], -1, v132
    v_mfma_f32_16x16x32_bf16 v[88:91], a[204:207], v[232:235], v[88:91]
    v_mfma_f32_16x16x32_bf16 v[92:95], a[204:207], v[236:239], v[92:95]
    v_cmp_u_f32 vcc, v112, v116
    s_nop 0
    s_or_b64 vcc, vcc, s[82:83]
    s_cbranch_vccnz rd_76
rc_77:
    v_mfma_f32_16x16x32_bf16 v[88:91], a[224:227], v[240:243], v[88:91]
    ds_write_b128 v203, v[112:115] offset:24576
    v_mfma_f32_16x16x32_bf16 v[92:95], a[224:227], v[244:247], v[92:95]
    v_mfma_f32_16x16x32_bf16 v[88:91], a[244:247], v[248:251], v[88:91]
    ds_write_b128 v203, v[116:119] offset:25600
    v_mfma_f32_16x16x32_bf16 v[92:95], a[244:247], v[252:255], v[92:95]
    v_mfma_f32_16x16x32_bf16 v[96:99], a[168:171], v[216:219], 0
    v_lshlrev_b32_e64 v120, 16, v208
    v_and_b32 v121, 0xffff0000, v208
    v_mfma_f32_16x16x32_bf16 v[100:103], a[168:171], v[220:223], 0
    v_lshlrev_b32_e64 v122, 16, v209
    v_and_b32 v123, 0xffff0000, v209
    v_mfma_f32_16x16x32_bf16 v[96:99], a[188:191], v[224:227], v[96:99]
    v_lshlrev_b32_e64 v124, 16, v210
    v_and_b32 v125, 0xffff0000, v210
    v_mfma_f32_16x16x32_bf16 v[100:103], a[188:191], v[228:231], v[100:103]
    v_lshlrev_b32_e64 v126, 16, v211
    v_and_b32 v127, 0xffff0000, v211
    v_mfma_f32_16x16x32_bf16 v[96:99], a[208:211], v[232:235], v[96:99]
    v_lshlrev_b32_e64 v128, 16, v212
    v_and_b32 v129, 0xffff0000, v212
    v_mfma_f32_16x16x32_bf16 v[100:103], a[208:211], v[236:239], v[100:103]
    v_mfma_f32_16x16x32_bf16 v[96:99], a[228:231], v[240:243], v[96:99]
    ds_write_b128 v200, v[88:91] offset:0
    v_mfma_f32_16x16x32_bf16 v[100:103], a[228:231], v[244:247], v[100:103]
    v_mfma_f32_16x16x32_bf16 v[96:99], a[248:251], v[248:251], v[96:99]
    ds_write_b128 v200, v[92:95] offset:1024
    v_mfma_f32_16x16x32_bf16 v[100:103], a[248:251], v[252:255], v[100:103]
    v_mfma_f32_16x16x32_bf16 v[104:107], a[172:175], v[216:219], 0
    v_mfma_f32_16x16x32_bf16 v[108:111], a[172:175], v[220:223], 0
    v_mfma_f32_16x16x32_bf16 v[104:107], a[192:195], v[224:227], v[104:107]
    v_mfma_f32_16x16x32_bf16 v[108:111], a[192:195], v[228:231], v[108:111]
    v_mfma_f32_16x16x32_bf16 v[104:107], a[212:215], v[232:235], v[104:107]
    v_mfma_f32_16x16x32_bf16 v[108:111], a[212:215], v[236:239], v[108:111]
    v_mfma_f32_16x16x32_bf16 v[104:107], a[232:235], v[240:243], v[104:107]
    ds_write_b128 v201, v[96:99] offset:2048
    v_mfma_f32_16x16x32_bf16 v[108:111], a[232:235], v[244:247], v[108:111]
    v_mfma_f32_16x16x32_bf16 v[104:107], a[252:255], v[248:251], v[104:107]
    ds_write_b128 v201, v[100:103] offset:3072
    v_mfma_f32_16x16x32_bf16 v[108:111], a[252:255], v[252:255], v[108:111]
    v_mfma_f32_16x16x32_bf16 v[80:83], a[160:163], v[216:219], v[120:123]
    v_mfma_f32_16x16x32_bf16 v[84:87], a[160:163], v[220:223], v[124:127]
    v_mfma_f32_16x16x32_bf16 v[80:83], a[180:183], v[224:227], v[80:83]
    v_mfma_f32_16x16x32_bf16 v[84:87], a[180:183], v[228:231], v[84:87]
    v_mfma_f32_16x16x32_bf16 v[80:83], a[200:203], v[232:235], v[80:83]
    s_nop 0
    ds_write_b128 v202, v[104:107] offset:4096
    v_mfma_f32_16x16x32_bf16 v[84:87], a[200:203], v[236:239], v[84:87]
    ds_write_b128 v202, v[108:111] offset:5120
    v_mfma_f32_16x16x32_bf16 v[80:83], a[220:223], v[240:243], v[80:83]
    v_mfma_f32_16x16x32_bf16 v[84:87], a[220:223], v[244:247], v[84:87]
    v_mfma_f32_16x16x32_bf16 v[80:83], a[240:243], v[248:251], v[80:83]
    v_mfma_f32_16x16x32_bf16 v[84:87], a[240:243], v[252:255], v[84:87]
    s_waitcnt lgkmcnt(0)
    s_barrier
    s_nop 0
    ds_read_b128 v[88:91], v204 offset:0
    ds_read_b128 v[92:95], v204 offset:1024
    ds_read_b128 v[96:99], v204 offset:2048
    ds_read_b128 v[100:103], v204 offset:3072
    ds_read_b128 v[104:107], v204 offset:4096
    ds_read_b128 v[108:111], v204 offset:5120
    ds_read_b64 v[112:113], v205 offset:24576
    ds_read_b64 v[114:115], v205 offset:26624
    ds_read_b64 v[116:117], v205 offset:28672
    ds_read_b64 v[118:119], v205 offset:30720
    s_mov_b32 s96, 12062720
    buffer_load_dwordx4 v[216:219], v56, s[16:19], s96 offen offset:0 sc1
    buffer_load_dwordx4 v[220:223], v56, s[16:19], s96 offen offset:256 sc1
    s_mov_b32 s96, 12095488
    buffer_load_dwordx4 v[224:227], v56, s[16:19], s96 offen offset:0 sc1
    buffer_load_dwordx4 v[228:231], v56, s[16:19], s96 offen offset:256 sc1
    s_mov_b32 s96, 12128256
    buffer_load_dwordx4 v[232:235], v56, s[16:19], s96 offen offset:0 sc1
    buffer_load_dwordx4 v[236:239], v56, s[16:19], s96 offen offset:256 sc1
    s_waitcnt lgkmcnt(9)
    v_pk_add_f32 v[80:81], v[80:81], v[88:89]
    v_pk_add_f32 v[82:83], v[82:83], v[90:91]
    s_waitcnt lgkmcnt(8)
    v_pk_add_f32 v[84:85], v[84:85], v[92:93]
    v_pk_add_f32 v[86:87], v[86:87], v[94:95]
    s_waitcnt lgkmcnt(7)
    v_pk_add_f32 v[80:81], v[80:81], v[96:97]
    v_pk_add_f32 v[82:83], v[82:83], v[98:99]
    s_waitcnt lgkmcnt(6)
    v_pk_add_f32 v[84:85], v[84:85], v[100:101]
    v_pk_add_f32 v[86:87], v[86:87], v[102:103]
    s_waitcnt lgkmcnt(5)
    v_pk_add_f32 v[80:81], v[80:81], v[104:105]
    v_pk_add_f32 v[82:83], v[82:83], v[106:107]
    s_waitcnt lgkmcnt(4)
    v_pk_add_f32 v[84:85], v[84:85], v[108:109]
    v_pk_add_f32 v[86:87], v[86:87], v[110:111]
    v_cvt_pk_bf16_f32 v132, v80, v81
    v_cvt_pk_bf16_f32 v133, v82, v83
    v_cvt_pk_bf16_f32 v134, v84, v85
    v_cvt_pk_bf16_f32 v135, v86, v87
    s_waitcnt lgkmcnt(3)
    v_pk_add_f32 v[128:129], v[128:129], v[112:113]
    s_waitcnt lgkmcnt(2)
    v_pk_add_f32 v[128:129], v[128:129], v[114:115]
    s_waitcnt lgkmcnt(1)
    v_pk_add_f32 v[128:129], v[128:129], v[116:117]
    s_waitcnt lgkmcnt(0)
    v_pk_add_f32 v[128:129], v[128:129], v[118:119]
    v_cvt_pk_bf16_f32 v130, v128, v129
    buffer_store_dwordx4 v[132:135], v59, s[16:19], s25 offen sc1
    buffer_store_dword v130, v61, s[16:19], s26 offen sc1
    v_dot2c_f32_bf16 v136, v132, v215
    v_dot2c_f32_bf16 v137, v132, v132
    v_dot2c_f32_bf16 v136, v133, v215
    v_dot2c_f32_bf16 v137, v133, v133
    v_dot2c_f32_bf16 v138, v134, v215
    v_dot2c_f32_bf16 v139, v134, v134
    v_dot2c_f32_bf16 v138, v135, v215
    v_dot2c_f32_bf16 v139, v135, v135
    v_dot2c_f32_bf16 v140, v130, v215
    v_dot2c_f32_bf16 v141, v130, v130
    v_permlane32_swap_b32 v136, v138
    v_permlane32_swap_b32 v137, v139
    v_pk_add_f32 v[136:137], v[136:137], v[138:139]
    v_pk_add_f32 v[136:137], v[136:137], v[140:141]
    s_nop 1
    v_permlane16_swap_b32 v136, v137
    v_add_f32_e64 v136, v136, v137
    ds_write_b32 v206, v136 offset:32768
    s_mov_b32 s96, 12161024
    buffer_load_dwordx4 v[240:243], v56, s[16:19], s96 offen offset:0 sc1
    buffer_load_dwordx4 v[244:247], v56, s[16:19], s96 offen offset:256 sc1
    s_mov_b32 s96, 12060672
    buffer_load_dwordx2 v[248:249], v57, s[16:19], s96 offen offset:0 sc1
    buffer_load_dwordx2 v[252:253], v57, s[16:19], s96 offen offset:128 sc1
    s_mov_b32 s96, 12077056
    buffer_load_dwordx2 v[250:251], v57, s[16:19], s96 offen offset:0 sc1
    buffer_load_dwordx2 v[254:255], v57, s[16:19], s96 offen offset:128 sc1
    s_mov_b32 s96, 9439232
    buffer_load_dwordx4 v[208:211], v59, s[16:19], s96 offen sc1
    s_add_u32 s97, s36, 9439232
    buffer_load_dword v212, v61, s[16:19], s97 offen sc1
    s_waitcnt lgkmcnt(0)
    s_barrier
    ds_read2st64_b32 v[136:137], v207 offset0:0 offset1:1
    ds_read2st64_b32 v[138:139], v207 offset0:2 offset1:3
    ds_read_b64_tr_b16 v[144:145], v65 offset:32
    ds_read_b64_tr_b16 v[146:147], v65 offset:0
    ds_read_b64_tr_b16 v[148:149], v65 offset:160
    ds_read_b64_tr_b16 v[150:151], v65 offset:128
    ds_read_b64_tr_b16 v[152:153], v65 offset:288
    ds_read_b64_tr_b16 v[154:155], v65 offset:256
    ds_read_b64_tr_b16 v[156:157], v65 offset:416
    ds_read_b64_tr_b16 v[158:159], v65 offset:384
    ds_read_b64_tr_b16 v[160:161], v65 offset:544
    ds_read_b64_tr_b16 v[162:163], v65 offset:512
    ds_read_b64_tr_b16 v[164:165], v65 offset:672
    ds_read_b64_tr_b16 v[166:167], v65 offset:640
    ds_read_b64_tr_b16 v[168:169], v65 offset:800
    ds_read_b64_tr_b16 v[170:171], v65 offset:768
    ds_read_b64_tr_b16 v[172:173], v65 offset:928
    ds_read_b64_tr_b16 v[174:175], v65 offset:896
    s_waitcnt lgkmcnt(15)
    v_pk_add_f32 v[136:137], v[136:137], v[138:139]
    v_add_f32 v136, v136, v137
    v_cndmask_b32 v136, v136, 1.0, s[28:29]
    s_mov_b64 exec, s[80:81]
    buffer_atomic_add_f32 v136, v214, s[16:19], s27 offen sc1
    s_mov_b64 exec, -1
    v_lshrrev_b32 v176, 4, v0
    v_mul_u32_u24 v176, 1216, v176
    v_and_b32 v177, 15, v0
    v_lshl_add_u32 v176, v177, 3, v176
    v_add_u32 v176, 64, v176
    v_mov_b32 v178, 0
    v_mov_b32 v179, 0
    ds_write_b64 v176, v[178:179]
    v_mov_b32 v70, 0
    v_mov_b32 v71, 0
    v_mov_b32 v72, 0
oe_78:
    s_waitcnt vmcnt(16)
    v_mfma_f32_16x16x32_bf16 v[112:115], a[176:179], v[216:219], 0
    v_mov_b32 v136, 0
    v_mov_b32 v137, 0
    s_waitcnt vmcnt(15)
    v_mfma_f32_16x16x32_bf16 v[116:119], a[176:179], v[220:223], 0
    v_mov_b32 v138, 0
    v_mov_b32 v139, 0
    s_waitcnt vmcnt(14)
    v_mfma_f32_16x16x32_bf16 v[112:115], a[196:199], v[224:227], v[112:115]
    v_mov_b32 v140, 0
    v_mov_b32 v141, 0
    s_waitcnt vmcnt(13)
    v_mfma_f32_16x16x32_bf16 v[116:119], a[196:199], v[228:231], v[116:119]
    s_mov_b32 s25, 14682112
    s_add_u32 s26, s36, 14682112
    s_waitcnt vmcnt(12)
    v_mfma_f32_16x16x32_bf16 v[112:115], a[216:219], v[232:235], v[112:115]
    s_add_u32 s27, s35, 3510272
    s_mov_b32 s28, 0x99999999
    s_waitcnt vmcnt(11)
    v_mfma_f32_16x16x32_bf16 v[116:119], a[216:219], v[236:239], v[116:119]
    s_mov_b32 s29, 0x99999999
    s_waitcnt vmcnt(8)
    v_mfma_f32_16x16x32_bf16 v[112:115], a[236:239], v[240:243], v[112:115]
    s_waitcnt vmcnt(7)
    v_mfma_f32_16x16x32_bf16 v[116:119], a[236:239], v[244:247], v[116:119]
    s_waitcnt vmcnt(4)
    v_mfma_f32_16x16x32_bf16 v[112:115], v[52:55], v[248:251], v[112:115]
    s_waitcnt vmcnt(3)
    v_mfma_f32_16x16x32_bf16 v[116:119], v[52:55], v[252:255], v[116:119]
    v_mfma_f32_16x16x32_bf16 v[88:91], a[164:167], v[216:219], 0
    v_mfma_f32_16x16x32_bf16 v[92:95], a[164:167], v[220:223], 0
    v_mfma_f32_16x16x32_bf16 v[88:91], a[184:187], v[224:227], v[88:91]
    s_waitcnt vmcnt(2)
    v_max3_u32 v132, v208, v209, v210
    s_waitcnt vmcnt(1)
    v_max3_u32 v132, v132, v211, v212
    v_mfma_f32_16x16x32_bf16 v[92:95], a[184:187], v[228:231], v[92:95]
    v_cmp_eq_u32 s[82:83], -1, v132
    v_mfma_f32_16x16x32_bf16 v[88:91], a[204:207], v[232:235], v[88:91]
    v_mfma_f32_16x16x32_bf16 v[92:95], a[204:207], v[236:239], v[92:95]
    v_cmp_u_f32 vcc, v112, v116
    s_nop 0
    s_or_b64 vcc, vcc, s[82:83]
    s_cbranch_vccnz rd_79
rc_80:
    v_mfma_f32_16x16x32_bf16 v[88:91], a[224:227], v[240:243], v[88:91]
    ds_write_b128 v203, v[112:115] offset:24576
    v_mfma_f32_16x16x32_bf16 v[92:95], a[224:227], v[244:247], v[92:95]
    v_mfma_f32_16x16x32_bf16 v[88:91], a[244:247], v[248:251], v[88:91]
    ds_write_b128 v203, v[116:119] offset:25600
    v_mfma_f32_16x16x32_bf16 v[92:95], a[244:247], v[252:255], v[92:95]
    v_mfma_f32_16x16x32_bf16 v[96:99], a[168:171], v[216:219], 0
    v_lshlrev_b32_e64 v120, 16, v208
    v_and_b32 v121, 0xffff0000, v208
    v_mfma_f32_16x16x32_bf16 v[100:103], a[168:171], v[220:223], 0
    v_lshlrev_b32_e64 v122, 16, v209
    v_and_b32 v123, 0xffff0000, v209
    v_mfma_f32_16x16x32_bf16 v[96:99], a[188:191], v[224:227], v[96:99]
    v_lshlrev_b32_e64 v124, 16, v210
    v_and_b32 v125, 0xffff0000, v210
    v_mfma_f32_16x16x32_bf16 v[100:103], a[188:191], v[228:231], v[100:103]
    v_lshlrev_b32_e64 v126, 16, v211
    v_and_b32 v127, 0xffff0000, v211
    v_mfma_f32_16x16x32_bf16 v[96:99], a[208:211], v[232:235], v[96:99]
    v_lshlrev_b32_e64 v128, 16, v212
    v_and_b32 v129, 0xffff0000, v212
    v_mfma_f32_16x16x32_bf16 v[100:103], a[208:211], v[236:239], v[100:103]
    v_mfma_f32_16x16x32_bf16 v[96:99], a[228:231], v[240:243], v[96:99]
    ds_write_b128 v200, v[88:91] offset:0
    v_mfma_f32_16x16x32_bf16 v[100:103], a[228:231], v[244:247], v[100:103]
    v_mfma_f32_16x16x32_bf16 v[96:99], a[248:251], v[248:251], v[96:99]
    ds_write_b128 v200, v[92:95] offset:1024
    v_mfma_f32_16x16x32_bf16 v[100:103], a[248:251], v[252:255], v[100:103]
    v_mfma_f32_16x16x32_bf16 v[104:107], a[172:175], v[216:219], 0
    v_mfma_f32_16x16x32_bf16 v[108:111], a[172:175], v[220:223], 0
    v_mfma_f32_16x16x32_bf16 v[104:107], a[192:195], v[224:227], v[104:107]
    v_mfma_f32_16x16x32_bf16 v[108:111], a[192:195], v[228:231], v[108:111]
    v_mfma_f32_16x16x32_bf16 v[104:107], a[212:215], v[232:235], v[104:107]
    v_mfma_f32_16x16x32_bf16 v[108:111], a[212:215], v[236:239], v[108:111]
    v_mfma_f32_16x16x32_bf16 v[104:107], a[232:235], v[240:243], v[104:107]
    ds_write_b128 v201, v[96:99] offset:2048
    v_mfma_f32_16x16x32_bf16 v[108:111], a[232:235], v[244:247], v[108:111]
    v_mfma_f32_16x16x32_bf16 v[104:107], a[252:255], v[248:251], v[104:107]
    ds_write_b128 v201, v[100:103] offset:3072
    v_mfma_f32_16x16x32_bf16 v[108:111], a[252:255], v[252:255], v[108:111]
    v_mfma_f32_16x16x32_bf16 v[80:83], a[160:163], v[216:219], v[120:123]
    v_mfma_f32_16x16x32_bf16 v[84:87], a[160:163], v[220:223], v[124:127]
    v_mfma_f32_16x16x32_bf16 v[80:83], a[180:183], v[224:227], v[80:83]
    v_mfma_f32_16x16x32_bf16 v[84:87], a[180:183], v[228:231], v[84:87]
    v_mfma_f32_16x16x32_bf16 v[80:83], a[200:203], v[232:235], v[80:83]
    s_nop 0
    ds_write_b128 v202, v[104:107] offset:4096
    v_mfma_f32_16x16x32_bf16 v[84:87], a[200:203], v[236:239], v[84:87]
    ds_write_b128 v202, v[108:111] offset:5120
    v_mfma_f32_16x16x32_bf16 v[80:83], a[220:223], v[240:243], v[80:83]
    v_mfma_f32_16x16x32_bf16 v[84:87], a[220:223], v[244:247], v[84:87]
    v_mfma_f32_16x16x32_bf16 v[80:83], a[240:243], v[248:251], v[80:83]
    v_mfma_f32_16x16x32_bf16 v[84:87], a[240:243], v[252:255], v[84:87]
    s_waitcnt lgkmcnt(0)
    s_barrier
    s_nop 0
    ds_read_b128 v[88:91], v204 offset:0
    ds_read_b128 v[92:95], v204 offset:1024
    ds_read_b128 v[96:99], v204 offset:2048
    ds_read_b128 v[100:103], v204 offset:3072
    ds_read_b128 v[104:107], v204 offset:4096
    ds_read_b128 v[108:111], v204 offset:5120
    ds_read_b64 v[112:113], v205 offset:24576
    ds_read_b64 v[114:115], v205 offset:26624
    ds_read_b64 v[116:117], v205 offset:28672
    ds_read_b64 v[118:119], v205 offset:30720
    s_lshl_b32 s96, s75, 14
    s_add_u32 s96, s96, 14680064
    s_lshl_b32 s97, s24, 12
    s_add_u32 s97, s97, 3506176
    buffer_load_dwordx4 v[176:179], v62, s[16:19], s96 offen offset:0 sc1
    buffer_load_dwordx4 v[180:183], v62, s[16:19], s96 offen offset:1024 sc1
    buffer_load_dwordx4 v[184:187], v62, s[16:19], s97 offen offset:0 sc1
    buffer_load_dwordx4 v[188:191], v62, s[16:19], s97 offen offset:1024 sc1
    buffer_load_dwordx4 v[192:195], v62, s[16:19], s97 offen offset:2048 sc1
    buffer_load_dwordx4 v[196:199], v62, s[16:19], s97 offen offset:3072 sc1
    s_waitcnt lgkmcnt(9)
    v_pk_add_f32 v[80:81], v[80:81], v[88:89]
    v_pk_add_f32 v[82:83], v[82:83], v[90:91]
    s_waitcnt lgkmcnt(8)
    v_pk_add_f32 v[84:85], v[84:85], v[92:93]
    v_pk_add_f32 v[86:87], v[86:87], v[94:95]
    s_waitcnt lgkmcnt(7)
    v_pk_add_f32 v[80:81], v[80:81], v[96:97]
    v_pk_add_f32 v[82:83], v[82:83], v[98:99]
    s_waitcnt lgkmcnt(6)
    v_pk_add_f32 v[84:85], v[84:85], v[100:101]
    v_pk_add_f32 v[86:87], v[86:87], v[102:103]
    s_waitcnt lgkmcnt(5)
    v_pk_add_f32 v[80:81], v[80:81], v[104:105]
    v_pk_add_f32 v[82:83], v[82:83], v[106:107]
    s_waitcnt lgkmcnt(4)
    v_pk_add_f32 v[84:85], v[84:85], v[108:109]
    v_pk_add_f32 v[86:87], v[86:87], v[110:111]
    v_cvt_pk_bf16_f32 v132, v80, v81
    v_cvt_pk_bf16_f32 v133, v82, v83
    v_cvt_pk_bf16_f32 v134, v84, v85
    v_cvt_pk_bf16_f32 v135, v86, v87
    s_waitcnt lgkmcnt(3)
    v_pk_add_f32 v[128:129], v[128:129], v[112:113]
    s_waitcnt lgkmcnt(2)
    v_pk_add_f32 v[128:129], v[128:129], v[114:115]
    s_waitcnt lgkmcnt(1)
    v_pk_add_f32 v[128:129], v[128:129], v[116:117]
    s_waitcnt lgkmcnt(0)
    v_pk_add_f32 v[128:129], v[128:129], v[118:119]
    v_cvt_pk_bf16_f32 v130, v128, v129
    buffer_store_dwordx4 v[132:135], v59, s[16:19], s25 offen sc1
    buffer_store_dword v130, v61, s[16:19], s26 offen sc1
    v_dot2c_f32_bf16 v136, v132, v215
    v_dot2c_f32_bf16 v137, v132, v132
    v_dot2c_f32_bf16 v136, v133, v215
    v_dot2c_f32_bf16 v137, v133, v133
    v_dot2c_f32_bf16 v138, v134, v215
    v_dot2c_f32_bf16 v139, v134, v134
    v_dot2c_f32_bf16 v138, v135, v215
    v_dot2c_f32_bf16 v139, v135, v135
    v_dot2c_f32_bf16 v140, v130, v215
    v_dot2c_f32_bf16 v141, v130, v130
    v_permlane32_swap_b32 v136, v138
    v_permlane32_swap_b32 v137, v139
    v_pk_add_f32 v[136:137], v[136:137], v[138:139]
    v_pk_add_f32 v[136:137], v[136:137], v[140:141]
    s_nop 1
    v_permlane16_swap_b32 v136, v137
    v_add_f32 v136, v136, v137
    ds_write_b32 v206, v136 offset:32768
    s_waitcnt lgkmcnt(0)
    s_barrier
    ds_read2st64_b32 v[136:137], v207 offset0:0 offset1:1
    ds_read2st64_b32 v[138:139], v207 offset0:2 offset1:3
    s_waitcnt lgkmcnt(0)
    v_pk_add_f32 v[136:137], v[136:137], v[138:139]
    v_add_f32 v136, v136, v137
    v_cndmask_b32 v136, v136, 1.0, s[28:29]
    s_mov_b64 exec, s[80:81]
    buffer_atomic_add_f32 v136, v214, s[16:19], s27 offen sc1
    s_mov_b64 exec, -1
    s_cmp_ge_u32 s2, 160
    s_cbranch_scc1 nc_81
    s_waitcnt vmcnt(3)
ce_83:
    v_max3_u32 v208, v176, v177, v178
    v_max3_u32 v208, v208, v179, v180
    v_max3_u32 v208, v208, v181, v182
    v_max_u32 v208, v208, v183
    v_cmp_eq_u32 s[82:83], -1, v208
    v_min3_f32 v209, v184, v187, v188
    v_min3_f32 v209, v209, v191, v192
    v_min3_f32 v209, v209, v195, v196
    v_min_f32 v209, v209, v199
    v_cmp_neq_f32 vcc, 0x41000000, v209
    s_nop 0
    s_or_b64 vcc, vcc, s[82:83]
    s_cbranch_vccnz rd_84
rc_85:
    v_mul_f32 v208, 0x3acccccd, v185
    v_mul_f32 v209, 0x3acccccd, v189
    v_mul_f32 v186, 0x3acccccd, v186
    v_mul_f32 v190, 0x3acccccd, v190
    v_fma_f32 v186, -v208, v208, v186
    v_fma_f32 v190, -v209, v209, v190
    v_max_f32 v186, 0, v186
    v_max_f32 v190, 0, v190
    v_add_f32 v186, 0x3727c5ac, v186
    v_add_f32 v190, 0x3727c5ac, v190
    v_rsq_f32 v185, v186
    v_rsq_f32 v189, v190
    v_mul_f32 v186, -v208, v185
    v_mul_f32 v190, -v209, v189
    v_lshlrev_b32 v80, 16, v176
    v_and_b32 v82, 0xffff0000, v176
    v_lshlrev_b32 v84, 16, v177
    v_and_b32 v86, 0xffff0000, v177
    v_lshlrev_b32 v81, 16, v178
    v_and_b32 v83, 0xffff0000, v178
    v_lshlrev_b32 v85, 16, v179
    v_and_b32 v87, 0xffff0000, v179
    v_fma_f32 v208, v80, v185, v186
    v_fma_f32 v209, v81, v189, v190
    v_cvt_pk_bf16_f32 v176, v208, v209
    v_fma_f32 v208, v82, v185, v186
    v_fma_f32 v209, v83, v189, v190
    v_cvt_pk_bf16_f32 v177, v208, v209
    v_fma_f32 v208, v84, v185, v186
    v_fma_f32 v209, v85, v189, v190
    v_cvt_pk_bf16_f32 v178, v208, v209
    v_fma_f32 v208, v86, v185, v186
    v_fma_f32 v209, v87, v189, v190
    v_cvt_pk_bf16_f32 v179, v208, v209
    ds_write_b32 v63, v176 offset:0
    ds_write_b32 v63, v177 offset:4864
    ds_write_b32 v63, v178 offset:9728
    ds_write_b32 v63, v179 offset:14592
    v_mul_f32 v208, 0x3acccccd, v193
    v_mul_f32 v209, 0x3acccccd, v197
    v_mul_f32 v194, 0x3acccccd, v194
    v_mul_f32 v198, 0x3acccccd, v198
    v_fma_f32 v194, -v208, v208, v194
    v_fma_f32 v198, -v209, v209, v198
    v_max_f32 v194, 0, v194
    v_max_f32 v198, 0, v198
    v_add_f32 v194, 0x3727c5ac, v194
    v_add_f32 v198, 0x3727c5ac, v198
    v_rsq_f32 v193, v194
    v_rsq_f32 v197, v198
    v_mul_f32 v194, -v208, v193
    v_mul_f32 v198, -v209, v197
    v_lshlrev_b32 v88, 16, v180
    v_and_b32 v90, 0xffff0000, v180
    v_lshlrev_b32 v92, 16, v181
    v_and_b32 v94, 0xffff0000, v181
    v_lshlrev_b32 v89, 16, v182
    v_and_b32 v91, 0xffff0000, v182
    v_lshlrev_b32 v93, 16, v183
    v_and_b32 v95, 0xffff0000, v183
    v_fma_f32 v208, v88, v193, v194
    v_fma_f32 v209, v89, v197, v198
    v_cvt_pk_bf16_f32 v180, v208, v209
    v_fma_f32 v208, v90, v193, v194
    v_fma_f32 v209, v91, v197, v198
    v_cvt_pk_bf16_f32 v181, v208, v209
    v_fma_f32 v208, v92, v193, v194
    v_fma_f32 v209, v93, v197, v198
    v_cvt_pk_bf16_f32 v182, v208, v209
    v_fma_f32 v208, v94, v193, v194
    v_fma_f32 v209, v95, v197, v198
    v_cvt_pk_bf16_f32 v183, v208, v209
    ds_write_b32 v63, v180 offset:256
    ds_write_b32 v63, v181 offset:5120
    ds_write_b32 v63, v182 offset:9984
    ds_write_b32 v63, v183 offset:14848
    s_waitcnt lgkmcnt(0)
    s_barrier
    ds_read_b128 v[212:215], v64 offset:96
    ds_read_b128 v[216:219], v64 offset:64
    ds_read_b128 v[220:223], v64 offset:32
    ds_read_b128 v[224:227], v64 offset:0
    s_waitcnt lgkmcnt(3)
    v_mfma_f32_32x32x16_bf16 v[96:111], v[212:215], v[144:147], 0
    ds_read_b128 v[228:231], v64 offset:224
    ds_read_b64_tr_b16 v[176:177], v65 offset:1056
    ds_read_b64_tr_b16 v[178:179], v65 offset:1024
    ds_read_b64_tr_b16 v[180:181], v65 offset:1184
    ds_read_b64_tr_b16 v[182:183], v65 offset:1152
    s_waitcnt lgkmcnt(7)
    v_mfma_f32_32x32x16_bf16 v[96:111], v[216:219], v[148:151], v[96:111]
    ds_read_b128 v[232:235], v64 offset:192
    ds_read_b64_tr_b16 v[184:185], v65 offset:1312
    ds_read_b64_tr_b16 v[186:187], v65 offset:1280
    ds_read_b64_tr_b16 v[188:189], v65 offset:1440
    ds_read_b64_tr_b16 v[190:191], v65 offset:1408
    s_waitcnt lgkmcnt(11)
    v_mfma_f32_32x32x16_bf16 v[96:111], v[220:223], v[152:155], v[96:111]
    ds_read_b128 v[236:239], v64 offset:160
    ds_read_b64_tr_b16 v[192:193], v65 offset:1568
    ds_read_b64_tr_b16 v[194:195], v65 offset:1536
    ds_read_b64_tr_b16 v[196:197], v65 offset:1696
    ds_read_b64_tr_b16 v[198:199], v65 offset:1664
    s_waitcnt lgkmcnt(15)
    v_mfma_f32_32x32x16_bf16 v[96:111], v[224:227], v[156:159], v[96:111]
    ds_read_b128 v[240:243], v64 offset:128
    ds_read_b64_tr_b16 v[200:201], v65 offset:1824
    ds_read_b64_tr_b16 v[202:203], v65 offset:1792
    ds_read_b64_tr_b16 v[204:205], v65 offset:1952
    ds_read_b64_tr_b16 v[206:207], v65 offset:1920
    s_waitcnt lgkmcnt(15)
    v_mfma_f32_32x32x16_bf16 v[112:127], v[228:231], v[144:147], 0
    s_nop 4
    s_waitcnt lgkmcnt(14)
    v_mfma_f32_32x32x16_bf16 v[112:127], v[232:235], v[148:151], v[112:127]
    v_cndmask_b32 v208, v99, v72, s[76:77]
    v_cndmask_b32 v209, v103, v99, s[76:77]
    v_cndmask_b32 v210, v107, v103, s[76:77]
    v_cndmask_b32 v211, v111, v107, s[76:77]
    v_mov_b32_e64 v72, v111
    s_waitcnt lgkmcnt(9)
    v_mfma_f32_32x32x16_bf16 v[112:127], v[236:239], v[152:155], v[112:127]
    v_add_f32_dpp v98, v208, v98 wave_ror:1 row_mask:0xf bank_mask:0xf
    v_add_f32_dpp v102, v209, v102 wave_ror:1 row_mask:0xf bank_mask:0xf
    v_add_f32_dpp v106, v210, v106 wave_ror:1 row_mask:0xf bank_mask:0xf
    v_add_f32_dpp v110, v211, v110 wave_ror:1 row_mask:0xf bank_mask:0xf
    v_cndmask_b32 v208, v98, v71, s[76:77]
    s_waitcnt lgkmcnt(4)
    v_mfma_f32_32x32x16_bf16 v[112:127], v[240:243], v[156:159], v[112:127]
    v_cndmask_b32 v209, v102, v98, s[76:77]
    v_cndmask_b32 v210, v106, v102, s[76:77]
    v_cndmask_b32 v211, v110, v106, s[76:77]
    v_mov_b32 v71, v110
    v_add_f32_dpp v97, v208, v97 wave_ror:1 row_mask:0xf bank_mask:0xf
    v_add_f32_dpp v101, v209, v101 wave_ror:1 row_mask:0xf bank_mask:0xf
    v_mfma_f32_32x32x16_bf16 v[112:127], v[212:215], v[160:163], v[112:127]
    ds_read_b128 v[244:247], v64 offset:352
    v_add_f32_dpp v105, v210, v105 wave_ror:1 row_mask:0xf bank_mask:0xf
    v_add_f32_dpp v109, v211, v109 wave_ror:1 row_mask:0xf bank_mask:0xf
    v_cndmask_b32 v208, v97, v70, s[76:77]
    v_cndmask_b32 v209, v101, v97, s[76:77]
    v_cndmask_b32 v210, v105, v101, s[76:77]
    v_mfma_f32_32x32x16_bf16 v[112:127], v[216:219], v[164:167], v[112:127]
    ds_read_b128 v[216:219], v64 offset:320
    v_cndmask_b32 v211, v109, v105, s[76:77]
    v_mov_b32_e64 v70, v109
    v_add_f32_dpp v96, v208, v96 wave_ror:1 row_mask:0xf bank_mask:0xf
    v_add_f32_dpp v100, v209, v100 wave_ror:1 row_mask:0xf bank_mask:0xf
    v_add_f32_dpp v104, v210, v104 wave_ror:1 row_mask:0xf bank_mask:0xf
    v_mfma_f32_32x32x16_bf16 v[112:127], v[220:223], v[168:171], v[112:127]
    ds_read_b128 v[220:223], v64 offset:288
    v_add_f32_dpp v108, v211, v108 wave_ror:1 row_mask:0xf bank_mask:0xf
    ds_write_b32 v66, v96 offset:0
    v_mfma_f32_32x32x16_bf16 v[112:127], v[224:227], v[172:175], v[112:127]
    ds_read_b128 v[224:227], v64 offset:256
    ds_write_b32 v66, v100 offset:64
    ds_write_b32 v66, v104 offset:128
    s_waitcnt lgkmcnt(6)
    v_mfma_f32_32x32x16_bf16 v[128:143], v[244:247], v[144:147], 0
    ds_write_b32 v66, v108 offset:192
    s_nop 2
    s_waitcnt lgkmcnt(6)
    v_mfma_f32_32x32x16_bf16 v[128:143], v[216:219], v[148:151], v[128:143]
    s_nop 2
    v_cndmask_b32 v208, v115, v72, s[76:77]
    v_cndmask_b32 v209, v119, v115, s[76:77]
    s_waitcnt lgkmcnt(5)
    v_mfma_f32_32x32x16_bf16 v[128:143], v[220:223], v[152:155], v[128:143]
    v_cndmask_b32 v210, v123, v119, s[76:77]
    v_cndmask_b32 v211, v127, v123, s[76:77]
    v_mov_b32 v72, v127
    v_add_f32_dpp v114, v208, v114 wave_ror:1 row_mask:0xf bank_mask:0xf
    v_add_f32_dpp v118, v209, v118 wave_ror:1 row_mask:0xf bank_mask:0xf
    s_waitcnt lgkmcnt(3)
    v_mfma_f32_32x32x16_bf16 v[128:143], v[224:227], v[156:159], v[128:143]
    v_add_f32_dpp v122, v210, v122 wave_ror:1 row_mask:0xf bank_mask:0xf
    v_add_f32_dpp v126, v211, v126 wave_ror:1 row_mask:0xf bank_mask:0xf
    v_cndmask_b32 v208, v114, v71, s[76:77]
    v_cndmask_b32 v209, v118, v114, s[76:77]
    v_cndmask_b32 v210, v122, v118, s[76:77]
    v_cndmask_b32 v211, v126, v122, s[76:77]
    v_mfma_f32_32x32x16_bf16 v[128:143], v[228:231], v[160:163], v[128:143]
    v_mov_b32 v71, v126
    v_add_f32_dpp v113, v208, v113 wave_ror:1 row_mask:0xf bank_mask:0xf
    v_add_f32_dpp v117, v209, v117 wave_ror:1 row_mask:0xf bank_mask:0xf
    v_add_f32_dpp v121, v210, v121 wave_ror:1 row_mask:0xf bank_mask:0xf
    v_add_f32_dpp v125, v211, v125 wave_ror:1 row_mask:0xf bank_mask:0xf
    v_cndmask_b32 v208, v113, v70, s[76:77]
    v_mfma_f32_32x32x16_bf16 v[128:143], v[232:235], v[164:167], v[128:143]
    ds_read_b128 v[232:235], v64 offset:64
    v_cndmask_b32 v209, v117, v113, s[76:77]
    v_cndmask_b32 v210, v121, v117, s[76:77]
    v_cndmask_b32 v211, v125, v121, s[76:77]
    v_mov_b32_e64 v70, v125
    v_add_f32_dpp v112, v208, v112 wave_ror:1 row_mask:0xf bank_mask:0xf
    v_mfma_f32_32x32x16_bf16 v[128:143], v[236:239], v[168:171], v[128:143]
    ds_read_b128 v[236:239], v64 offset:32
    v_add_f32_dpp v116, v209, v116 wave_ror:1 row_mask:0xf bank_mask:0xf
    v_add_f32_dpp v120, v210, v120 wave_ror:1 row_mask:0xf bank_mask:0xf
    v_add_f32_dpp v124, v211, v124 wave_ror:1 row_mask:0xf bank_mask:0xf
    v_mfma_f32_32x32x16_bf16 v[128:143], v[240:243], v[172:175], v[128:143]
    ds_read_b128 v[240:243], v64 offset:0
    ds_write_b32 v66, v112 offset:256
    ds_write_b32 v66, v116 offset:320
    v_mfma_f32_32x32x16_bf16 v[128:143], v[212:215], v[176:179], v[128:143]
    ds_read_b128 v[212:215], v64 offset:480
    ds_write_b32 v66, v120 offset:384
    ds_write_b32 v66, v124 offset:448
    s_waitcnt lgkmcnt(7)
    v_mfma_f32_32x32x16_bf16 v[128:143], v[232:235], v[180:183], v[128:143]
    ds_read_b128 v[232:235], v64 offset:448
    s_waitcnt lgkmcnt(7)
    v_mfma_f32_32x32x16_bf16 v[128:143], v[236:239], v[184:187], v[128:143]
    ds_read_b128 v[236:239], v64 offset:416
    s_waitcnt lgkmcnt(7)
    v_mfma_f32_32x32x16_bf16 v[128:143], v[240:243], v[188:191], v[128:143]
    ds_read_b128 v[240:243], v64 offset:384
    s_nop 3
    s_waitcnt lgkmcnt(5)
    v_mfma_f32_32x32x16_bf16 v[112:127], v[212:215], v[144:147], 0
    s_nop 4
    s_waitcnt lgkmcnt(2)
    v_mfma_f32_32x32x16_bf16 v[112:127], v[232:235], v[148:151], v[112:127]
    v_cndmask_b32 v208, v131, v72, s[76:77]
    v_cndmask_b32 v209, v135, v131, s[76:77]
    v_cndmask_b32 v210, v139, v135, s[76:77]
    v_cndmask_b32 v211, v143, v139, s[76:77]
    v_mov_b32_e64 v72, v143
    s_waitcnt lgkmcnt(1)
    v_mfma_f32_32x32x16_bf16 v[112:127], v[236:239], v[152:155], v[112:127]
    v_add_f32_dpp v130, v208, v130 wave_ror:1 row_mask:0xf bank_mask:0xf
    v_add_f32_dpp v134, v209, v134 wave_ror:1 row_mask:0xf bank_mask:0xf
    v_add_f32_dpp v138, v210, v138 wave_ror:1 row_mask:0xf bank_mask:0xf
    v_add_f32_dpp v142, v211, v142 wave_ror:1 row_mask:0xf bank_mask:0xf
    v_cndmask_b32 v208, v130, v71, s[76:77]
    s_waitcnt lgkmcnt(0)
    v_mfma_f32_32x32x16_bf16 v[112:127], v[240:243], v[156:159], v[112:127]
    v_cndmask_b32 v209, v134, v130, s[76:77]
    v_cndmask_b32 v210, v138, v134, s[76:77]
    v_cndmask_b32 v211, v142, v138, s[76:77]
    v_mov_b32 v71, v142
    v_add_f32_dpp v129, v208, v129 wave_ror:1 row_mask:0xf bank_mask:0xf
    v_add_f32_dpp v133, v209, v133 wave_ror:1 row_mask:0xf bank_mask:0xf
    v_mfma_f32_32x32x16_bf16 v[112:127], v[244:247], v[160:163], v[112:127]
    v_add_f32_dpp v137, v210, v137 wave_ror:1 row_mask:0xf bank_mask:0xf
    v_add_f32_dpp v141, v211, v141 wave_ror:1 row_mask:0xf bank_mask:0xf
    v_cndmask_b32 v208, v129, v70, s[76:77]
    v_cndmask_b32 v209, v133, v129, s[76:77]
    v_cndmask_b32 v210, v137, v133, s[76:77]
    v_cndmask_b32 v211, v141, v137, s[76:77]
    v_mfma_f32_32x32x16_bf16 v[112:127], v[216:219], v[164:167], v[112:127]
    ds_read_b128 v[240:243], v64 offset:192
    v_mov_b32_e64 v70, v141
    v_add_f32_dpp v128, v208, v128 wave_ror:1 row_mask:0xf bank_mask:0xf
    v_add_f32_dpp v132, v209, v132 wave_ror:1 row_mask:0xf bank_mask:0xf
    v_add_f32_dpp v136, v210, v136 wave_ror:1 row_mask:0xf bank_mask:0xf
    v_add_f32_dpp v140, v211, v140 wave_ror:1 row_mask:0xf bank_mask:0xf
    v_mfma_f32_32x32x16_bf16 v[112:127], v[220:223], v[168:171], v[112:127]
    ds_read_b128 v[220:223], v64 offset:160
    ds_write_b32 v66, v128 offset:512
    ds_write_b32 v66, v132 offset:576
    v_mfma_f32_32x32x16_bf16 v[112:127], v[224:227], v[172:175], v[112:127]
    ds_read_b128 v[224:227], v64 offset:128
    ds_write_b32 v66, v136 offset:640
    ds_write_b32 v66, v140 offset:704
    v_mfma_f32_32x32x16_bf16 v[112:127], v[228:231], v[176:179], v[112:127]
    ds_read_b128 v[236:239], v64 offset:96
    s_waitcnt lgkmcnt(7)
    v_mfma_f32_32x32x16_bf16 v[112:127], v[240:243], v[180:183], v[112:127]
    ds_read_b128 v[240:243], v64 offset:64
    s_waitcnt lgkmcnt(7)
    v_mfma_f32_32x32x16_bf16 v[112:127], v[220:223], v[184:187], v[112:127]
    ds_read_b128 v[220:223], v64 offset:32
    s_waitcnt lgkmcnt(5)
    v_mfma_f32_32x32x16_bf16 v[112:127], v[224:227], v[188:191], v[112:127]
    ds_read_b128 v[224:227], v64 offset:0
    s_waitcnt lgkmcnt(3)
    v_mfma_f32_32x32x16_bf16 v[112:127], v[236:239], v[192:195], v[112:127]
    ds_read_b64_tr_b16 v[216:217], v65 offset:544
    ds_read_b64_tr_b16 v[218:219], v65 offset:512
    s_waitcnt lgkmcnt(4)
    v_mfma_f32_32x32x16_bf16 v[112:127], v[240:243], v[196:199], v[112:127]
    ds_read_b64_tr_b16 v[240:241], v65 offset:1056
    ds_read_b64_tr_b16 v[242:243], v65 offset:1024
    s_waitcnt lgkmcnt(5)
    v_mfma_f32_32x32x16_bf16 v[112:127], v[220:223], v[200:203], v[112:127]
    s_waitcnt lgkmcnt(4)
    v_mfma_f32_32x32x16_bf16 v[112:127], v[224:227], v[204:207], v[112:127]
    ds_read_b64_tr_b16 v[224:225], v65 offset:1568
    ds_read_b64_tr_b16 v[226:227], v65 offset:1536
    s_lshl_b32 s96, s75, 14
    s_add_u32 s96, s96, 14680064
    s_lshl_b32 s97, s24, 12
    s_add_u32 s97, s97, 3510272
    buffer_load_dwordx4 v[248:251], v62, s[16:19], s96 offen offset:2048 sc1
    s_waitcnt lgkmcnt(4)
    v_mfma_f32_32x32x16_bf16 v[144:159], v[212:215], v[216:219], 0
    s_nop 3
    v_cndmask_b32 v208, v115, v72, s[76:77]
    s_waitcnt lgkmcnt(2)
    v_mfma_f32_32x32x16_bf16 v[144:159], v[244:247], v[240:243], v[144:159]
    buffer_load_dwordx4 v[252:255], v62, s[16:19], s96 offen offset:3072 sc1
    v_cndmask_b32 v209, v119, v115, s[76:77]
    v_cndmask_b32 v210, v123, v119, s[76:77]
    v_cndmask_b32 v211, v127, v123, s[76:77]
    v_mov_b32_e64 v72, v127
    v_add_f32_dpp v114, v208, v114 wave_ror:1 row_mask:0xf bank_mask:0xf
    v_mfma_f32_32x32x16_bf16 v[160:175], v[212:215], v[240:243], 0
    ds_read_b64_tr_b16 v[216:217], v65 offset:2080
    ds_read_b64_tr_b16 v[218:219], v65 offset:2048
    v_add_f32_dpp v118, v209, v118 wave_ror:1 row_mask:0xf bank_mask:0xf
    v_add_f32_dpp v122, v210, v122 wave_ror:1 row_mask:0xf bank_mask:0xf
    v_add_f32_dpp v126, v211, v126 wave_ror:1 row_mask:0xf bank_mask:0xf
    s_waitcnt lgkmcnt(2)
    v_mfma_f32_32x32x16_bf16 v[144:159], v[228:231], v[224:227], v[144:159]
    buffer_load_dwordx4 v[96:99], v62, s[16:19], s97 offen offset:0 sc1
    v_cndmask_b32 v208, v114, v71, s[76:77]
    v_cndmask_b32 v209, v118, v114, s[76:77]
    v_cndmask_b32 v210, v122, v118, s[76:77]
    v_cndmask_b32 v211, v126, v122, s[76:77]
    v_mov_b32 v71, v126
    v_mfma_f32_32x32x16_bf16 v[160:175], v[244:247], v[224:227], v[160:175]
    v_add_f32_dpp v113, v208, v113 wave_ror:1 row_mask:0xf bank_mask:0xf
    v_add_f32_dpp v117, v209, v117 wave_ror:1 row_mask:0xf bank_mask:0xf
    v_add_f32_dpp v121, v210, v121 wave_ror:1 row_mask:0xf bank_mask:0xf
    v_add_f32_dpp v125, v211, v125 wave_ror:1 row_mask:0xf bank_mask:0xf
    v_cndmask_b32 v208, v113, v70, s[76:77]
    v_cndmask_b32 v209, v117, v113, s[76:77]
    v_mfma_f32_32x32x16_bf16 v[176:191], v[212:215], v[224:227], 0
    buffer_load_dwordx4 v[100:103], v62, s[16:19], s97 offen offset:1024 sc1
    v_cndmask_b32 v210, v121, v117, s[76:77]
    v_cndmask_b32 v211, v125, v121, s[76:77]
    v_mov_b32 v70, v125
    v_add_f32_dpp v112, v208, v112 wave_ror:1 row_mask:0xf bank_mask:0xf
    s_waitcnt lgkmcnt(0)
    v_mfma_f32_32x32x16_bf16 v[144:159], v[236:239], v[216:219], v[144:159]
    ds_read_b64_tr_b16 v[240:241], v65 offset:2592
    ds_read_b64_tr_b16 v[242:243], v65 offset:2560
    v_add_f32_dpp v116, v209, v116 wave_ror:1 row_mask:0xf bank_mask:0xf
    v_add_f32_dpp v120, v210, v120 wave_ror:1 row_mask:0xf bank_mask:0xf
    v_add_f32_dpp v124, v211, v124 wave_ror:1 row_mask:0xf bank_mask:0xf
    v_mfma_f32_32x32x16_bf16 v[160:175], v[228:231], v[216:219], v[160:175]
    buffer_load_dwordx4 v[104:107], v62, s[16:19], s97 offen offset:2048 sc1
    ds_write_b32 v66, v112 offset:768
    ds_write_b32 v66, v116 offset:832
    v_mfma_f32_32x32x16_bf16 v[176:191], v[244:247], v[216:219], v[176:191]
    ds_write_b32 v66, v120 offset:896
    ds_write_b32 v66, v124 offset:960
    v_mfma_f32_32x32x16_bf16 v[192:207], v[212:215], v[216:219], 0
    ds_read_b64_tr_b16 v[212:213], v65 offset:3104
    ds_read_b64_tr_b16 v[214:215], v65 offset:3072
    buffer_load_dwordx4 v[108:111], v62, s[16:19], s97 offen offset:3072 sc1
    s_waitcnt lgkmcnt(6)
    v_mfma_f32_32x32x16_bf16 v[160:175], v[236:239], v[240:243], v[160:175]
    v_mfma_f32_32x32x16_bf16 v[176:191], v[228:231], v[240:243], v[176:191]
    ds_read_b64_tr_b16 v[224:225], v65 offset:3616
    ds_read_b64_tr_b16 v[226:227], v65 offset:3584
    s_waitcnt lgkmcnt(4)
    s_barrier
    v_mfma_f32_32x32x16_bf16 v[192:207], v[244:247], v[240:243], v[192:207]
    ds_read_b64_tr_b16 v[244:245], v65 offset:672
    ds_read_b64_tr_b16 v[246:247], v65 offset:640
    ds_read_b64 v[112:113], v67 offset:0
    ds_read_b64 v[114:115], v67 offset:4224
    ds_read_b64 v[116:117], v67 offset:8448
    s_waitcnt lgkmcnt(7)
    v_mfma_f32_32x32x16_bf16 v[176:191], v[236:239], v[212:215], v[176:191]
    ds_read_b128 v[216:219], v64 offset:320
    ds_read_b64_tr_b16 v[240:241], v65 offset:1184
    ds_read_b64_tr_b16 v[242:243], v65 offset:1152
    ds_read_b64 v[118:119], v67 offset:12672
    ds_read_b64 v[120:121], v67 offset:512
    ds_read_b64 v[122:123], v67 offset:4736
    v_mfma_f32_32x32x16_bf16 v[192:207], v[228:231], v[212:215], v[192:207]
    ds_read_b64 v[124:125], v67 offset:8960
    ds_read_b64 v[126:127], v67 offset:13184
    s_waitcnt lgkmcnt(13)
    v_mfma_f32_32x32x16_bf16 v[192:207], v[236:239], v[224:227], v[192:207]
    ds_read_b128 v[228:231], v64 offset:192
    ds_read_b64_tr_b16 v[236:237], v65 offset:1696
    ds_read_b64_tr_b16 v[238:239], v65 offset:1664
    s_waitcnt lgkmcnt(14)
    v_mfma_f32_32x32x16_bf16 v[144:159], v[232:235], v[244:247], v[144:159]
    s_waitcnt lgkmcnt(8)
    v_mfma_f32_32x32x16_bf16 v[144:159], v[216:219], v[240:243], v[144:159]
    v_mfma_f32_32x32x16_bf16 v[160:175], v[232:235], v[240:243], v[160:175]
    ds_read_b128 v[212:215], v64 offset:64
    ds_read_b64_tr_b16 v[224:225], v65 offset:2208
    ds_read_b64_tr_b16 v[226:227], v65 offset:2176
    s_waitcnt lgkmcnt(6)
    v_add_f32 v112, v112, v80
    s_waitcnt lgkmcnt(3)
    v_mfma_f32_32x32x16_bf16 v[144:159], v[228:231], v[236:239], v[144:159]
    v_add_f32 v113, v113, v81
    v_add_f32 v114, v114, v82
    v_add_f32 v115, v115, v83
    v_add_f32 v116, v116, v84
    v_add_f32 v117, v117, v85
    v_add_f32 v118, v118, v86
    v_mfma_f32_32x32x16_bf16 v[160:175], v[216:219], v[236:239], v[160:175]
    v_add_f32_e64 v119, v119, v87
    v_cvt_pk_bf16_f32 v128, v112, v114
    v_cvt_pk_bf16_f32 v129, v116, v118
    v_cvt_pk_bf16_f32 v130, v113, v115
    v_cvt_pk_bf16_f32 v131, v117, v119
    s_mov_b32 s25, 0
    v_mfma_f32_32x32x16_bf16 v[176:191], v[232:235], v[236:239], v[176:191]
    buffer_store_dwordx2 v[128:129], v68, s[20:23], s25 offen
    s_mov_b32 s25, 5120
    buffer_store_dwordx2 v[130:131], v68, s[20:23], s25 offen
    v_add_f32 v120, v120, v88
    v_add_f32 v121, v121, v89
    s_waitcnt lgkmcnt(0)
    v_mfma_f32_32x32x16_bf16 v[144:159], v[212:215], v[224:227], v[144:159]
    ds_read_b64_tr_b16 v[244:245], v65 offset:2720
    ds_read_b64_tr_b16 v[246:247], v65 offset:2688
    v_add_f32 v122, v122, v90
    v_add_f32 v123, v123, v91
    v_add_f32 v124, v124, v92
    v_add_f32 v125, v125, v93
    v_mfma_f32_32x32x16_bf16 v[160:175], v[228:231], v[224:227], v[160:175]
    v_add_f32 v126, v126, v94
    v_add_f32 v127, v127, v95
    v_cvt_pk_bf16_f32 v132, v120, v122
    v_cvt_pk_bf16_f32 v133, v124, v126
    v_cvt_pk_bf16_f32 v134, v121, v123
    v_cvt_pk_bf16_f32 v135, v125, v127
    v_mfma_f32_32x32x16_bf16 v[176:191], v[216:219], v[224:227], v[176:191]
    s_mov_b32 s25, 655360
    buffer_store_dwordx2 v[132:133], v68, s[20:23], s25 offen
    s_mov_b32 s25, 660480
    buffer_store_dwordx2 v[134:135], v68, s[20:23], s25 offen
    ds_read_b64_tr_b16 v[112:113], v65 offset:32
    ds_read_b64_tr_b16 v[114:115], v65 offset:0
    v_mfma_f32_32x32x16_bf16 v[192:207], v[232:235], v[224:227], v[192:207]
    ds_read_b64_tr_b16 v[232:233], v65 offset:3232
    ds_read_b64_tr_b16 v[234:235], v65 offset:3200
    ds_read_b64_tr_b16 v[116:117], v65 offset:160
    ds_read_b64_tr_b16 v[118:119], v65 offset:128
    ds_read_b64_tr_b16 v[120:121], v65 offset:288
    s_waitcnt lgkmcnt(7)
    v_mfma_f32_32x32x16_bf16 v[160:175], v[212:215], v[244:247], v[160:175]
    ds_read_b64_tr_b16 v[122:123], v65 offset:256
    ds_read_b64_tr_b16 v[124:125], v65 offset:416
    ds_read_b64_tr_b16 v[126:127], v65 offset:384
    ds_read_b64_tr_b16 v[128:129], v65 offset:544
    ds_read_b64_tr_b16 v[130:131], v65 offset:512
    ds_read_b64_tr_b16 v[132:133], v65 offset:672
    v_mfma_f32_32x32x16_bf16 v[176:191], v[228:231], v[244:247], v[176:191]
    ds_read_b64_tr_b16 v[240:241], v65 offset:3744
    ds_read_b64_tr_b16 v[242:243], v65 offset:3712
    ds_read_b64_tr_b16 v[134:135], v65 offset:640
    ds_read_b64_tr_b16 v[136:137], v65 offset:800
    ds_read_b64_tr_b16 v[138:139], v65 offset:768
    ds_read_b64_tr_b16 v[140:141], v65 offset:928
    v_mfma_f32_32x32x16_bf16 v[192:207], v[216:219], v[244:247], v[192:207]
    ds_read_b128 v[216:219], v64 offset:416
    ds_read_b64_tr_b16 v[236:237], v65 offset:800
    ds_read_b64_tr_b16 v[238:239], v65 offset:768
    ds_read_b64_tr_b16 v[142:143], v65 offset:896
    s_waitcnt lgkmcnt(15)
    v_mfma_f32_32x32x16_bf16 v[176:191], v[212:215], v[232:235], v[176:191]
    ds_read_b128 v[224:227], v64 offset:288
    ds_read_b64_tr_b16 v[244:245], v65 offset:1312
    ds_read_b64_tr_b16 v[246:247], v65 offset:1280
    s_waitcnt vmcnt(4)
ce_86:
    v_max3_u32 v208, v248, v249, v250
    v_max3_u32 v208, v208, v251, v252
    v_max3_u32 v208, v208, v253, v254
    v_max_u32 v208, v208, v255
    v_cmp_eq_u32 s[82:83], -1, v208
    v_min3_f32 v209, v96, v99, v100
    v_min3_f32 v209, v209, v103, v104
    v_min3_f32 v209, v209, v107, v108
    v_min_f32 v209, v209, v111
    v_cmp_neq_f32 vcc, 0x41000000, v209
    s_nop 0
    s_or_b64 vcc, vcc, s[82:83]
    s_cbranch_vccnz rd_87
rc_88:
    v_mfma_f32_32x32x16_bf16 v[192:207], v[228:231], v[232:235], v[192:207]
    v_mul_f32 v208, 0x3acccccd, v97
    v_mul_f32 v209, 0x3acccccd, v101
    v_mul_f32 v98, 0x3acccccd, v98
    v_mul_f32 v102, 0x3acccccd, v102
    v_fma_f32 v98, -v208, v208, v98
    s_waitcnt lgkmcnt(11)
    v_mfma_f32_32x32x16_bf16 v[192:207], v[212:215], v[240:243], v[192:207]
    ds_read_b128 v[228:231], v64 offset:160
    ds_read_b64_tr_b16 v[212:213], v65 offset:1824
    ds_read_b64_tr_b16 v[214:215], v65 offset:1792
    v_fma_f32 v102, -v209, v209, v102
    v_max_f32 v98, 0, v98
    s_waitcnt lgkmcnt(7)
    v_mfma_f32_32x32x16_bf16 v[144:159], v[216:219], v[236:239], v[144:159]
    v_max_f32 v102, 0, v102
    v_add_f32 v98, 0x3727c5ac, v98
    v_add_f32 v102, 0x3727c5ac, v102
    v_rsq_f32 v97, v98
    s_waitcnt lgkmcnt(3)
    v_mfma_f32_32x32x16_bf16 v[144:159], v[224:227], v[244:247], v[144:159]
    v_rsq_f32_e64 v101, v102
    v_mul_f32 v98, -v208, v97
    v_mul_f32 v102, -v209, v101
    v_lshlrev_b32_e64 v80, 16, v248
    v_and_b32 v82, 0xffff0000, v248
    v_mfma_f32_32x32x16_bf16 v[160:175], v[216:219], v[244:247], v[160:175]
    ds_read_b64_tr_b16 v[232:233], v65 offset:2336
    ds_read_b64_tr_b16 v[234:235], v65 offset:2304
    v_lshlrev_b32 v84, 16, v249
    v_and_b32 v86, 0xffff0000, v249
    v_lshlrev_b32_e64 v81, 16, v250
    s_waitcnt lgkmcnt(2)
    v_mfma_f32_32x32x16_bf16 v[144:159], v[228:231], v[212:215], v[144:159]
    v_and_b32 v83, 0xffff0000, v250
    v_lshlrev_b32_e64 v85, 16, v251
    v_and_b32 v87, 0xffff0000, v251
    v_fma_f32 v208, v80, v97, v98
    v_fma_f32 v209, v81, v101, v102
    v_cvt_pk_bf16_f32 v248, v208, v209
    v_mfma_f32_32x32x16_bf16 v[160:175], v[224:227], v[212:215], v[160:175]
    v_fma_f32 v208, v82, v97, v98
    v_fma_f32 v209, v83, v101, v102
    v_cvt_pk_bf16_f32 v249, v208, v209
    v_fma_f32 v208, v84, v97, v98
    v_fma_f32 v209, v85, v101, v102
    v_cvt_pk_bf16_f32 v250, v208, v209
    v_mfma_f32_32x32x16_bf16 v[176:191], v[216:219], v[212:215], v[176:191]
    v_fma_f32 v208, v86, v97, v98
    v_fma_f32 v209, v87, v101, v102
    v_cvt_pk_bf16_f32 v251, v208, v209
    s_waitcnt lgkmcnt(0)
    v_mfma_f32_32x32x16_bf16 v[144:159], v[220:223], v[232:235], v[144:159]
    ds_read_b64_tr_b16 v[240:241], v65 offset:2848
    ds_read_b64_tr_b16 v[242:243], v65 offset:2816
    ds_write_b32 v63, v248 offset:512
    ds_write_b32 v63, v249 offset:5376
    v_mfma_f32_32x32x16_bf16 v[160:175], v[228:231], v[232:235], v[160:175]
    ds_write_b32 v63, v250 offset:10240
    ds_write_b32 v63, v251 offset:15104
    v_mul_f32 v208, 0x3acccccd, v105
    v_mul_f32 v209, 0x3acccccd, v109
    v_mfma_f32_32x32x16_bf16 v[176:191], v[224:227], v[232:235], v[176:191]
    v_mul_f32 v106, 0x3acccccd, v106
    v_mul_f32 v110, 0x3acccccd, v110
    v_fma_f32 v106, -v208, v208, v106
    v_fma_f32 v110, -v209, v209, v110
    v_max_f32 v106, 0, v106
    v_max_f32_e64 v110, 0, v110
    v_mfma_f32_32x32x16_bf16 v[192:207], v[216:219], v[232:235], v[192:207]
    ds_read_b64_tr_b16 v[216:217], v65 offset:3360
    ds_read_b64_tr_b16 v[218:219], v65 offset:3328
    v_add_f32 v106, 0x3727c5ac, v106
    v_add_f32 v110, 0x3727c5ac, v110
    s_waitcnt lgkmcnt(6)
    v_mfma_f32_32x32x16_bf16 v[160:175], v[220:223], v[240:243], v[160:175]
    v_rsq_f32 v105, v106
    v_rsq_f32_e64 v109, v110
    v_mul_f32 v106, -v208, v105
    v_mul_f32 v110, -v209, v109
    v_mfma_f32_32x32x16_bf16 v[176:191], v[228:231], v[240:243], v[176:191]
    ds_read_b64_tr_b16 v[236:237], v65 offset:3872
    ds_read_b64_tr_b16 v[238:239], v65 offset:3840
    v_lshlrev_b32 v88, 16, v252
    v_and_b32 v90, 0xffff0000, v252
    v_lshlrev_b32 v92, 16, v253
    v_and_b32 v94, 0xffff0000, v253
    v_mfma_f32_32x32x16_bf16 v[192:207], v[224:227], v[240:243], v[192:207]
    ds_read_b128 v[224:227], v64 offset:384
    ds_read_b64_tr_b16 v[244:245], v65 offset:928
    ds_read_b64_tr_b16 v[246:247], v65 offset:896
    v_lshlrev_b32 v89, 16, v254
    v_and_b32 v91, 0xffff0000, v254
    s_waitcnt lgkmcnt(5)
    v_mfma_f32_32x32x16_bf16 v[176:191], v[220:223], v[216:219], v[176:191]
    ds_read_b128 v[212:215], v64 offset:256
    ds_read_b64_tr_b16 v[232:233], v65 offset:1440
    ds_read_b64_tr_b16 v[234:235], v65 offset:1408
    v_lshlrev_b32_e64 v93, 16, v255
    v_and_b32 v95, 0xffff0000, v255
    v_fma_f32 v208, v88, v105, v106
    v_mfma_f32_32x32x16_bf16 v[192:207], v[228:231], v[216:219], v[192:207]
    v_fma_f32 v209, v89, v109, v110
    v_cvt_pk_bf16_f32 v252, v208, v209
    v_fma_f32 v208, v90, v105, v106
    v_fma_f32 v209, v91, v109, v110
    v_cvt_pk_bf16_f32 v253, v208, v209
    s_waitcnt lgkmcnt(6)
    v_mfma_f32_32x32x16_bf16 v[192:207], v[220:223], v[236:239], v[192:207]
    ds_read_b128 v[220:223], v64 offset:128
    ds_read_b64_tr_b16 v[228:229], v65 offset:1952
    ds_read_b64_tr_b16 v[230:231], v65 offset:1920
    v_fma_f32 v208, v92, v105, v106
    v_fma_f32 v209, v93, v109, v110
    s_waitcnt lgkmcnt(6)
    v_mfma_f32_32x32x16_bf16 v[144:159], v[224:227], v[244:247], v[144:159]
    v_cvt_pk_bf16_f32 v254, v208, v209
    v_fma_f32 v208, v94, v105, v106
    v_fma_f32 v209, v95, v109, v110
    v_cvt_pk_bf16_f32 v255, v208, v209
    s_waitcnt lgkmcnt(3)
    v_mfma_f32_32x32x16_bf16 v[144:159], v[212:215], v[232:235], v[144:159]
    ds_write_b32 v63, v252 offset:768
    ds_write_b32 v63, v253 offset:5632
    ds_write_b32 v63, v254 offset:10496
    v_mfma_f32_32x32x16_bf16 v[160:175], v[224:227], v[232:235], v[160:175]
    ds_read_b128 v[240:243], v64 offset:0
    ds_read_b64_tr_b16 v[216:217], v65 offset:2464
    ds_read_b64_tr_b16 v[218:219], v65 offset:2432
    ds_write_b32 v63, v255 offset:15360
    s_waitcnt lgkmcnt(7)
    v_mfma_f32_32x32x16_bf16 v[144:159], v[220:223], v[228:231], v[144:159]
    v_mfma_f32_32x32x16_bf16 v[160:175], v[212:215], v[228:231], v[160:175]
    v_mfma_f32_32x32x16_bf16 v[176:191], v[224:227], v[228:231], v[176:191]
    s_waitcnt lgkmcnt(1)
    v_mfma_f32_32x32x16_bf16 v[144:159], v[240:243], v[216:219], v[144:159]
    ds_read_b64_tr_b16 v[236:237], v65 offset:2976
    ds_read_b64_tr_b16 v[238:239], v65 offset:2944
    v_mfma_f32_32x32x16_bf16 v[160:175], v[220:223], v[216:219], v[160:175]
    v_mfma_f32_32x32x16_bf16 v[176:191], v[212:215], v[216:219], v[176:191]
    v_mfma_f32_32x32x16_bf16 v[192:207], v[224:227], v[216:219], v[192:207]
    ds_read_b64_tr_b16 v[224:225], v65 offset:3488
    ds_read_b64_tr_b16 v[226:227], v65 offset:3456
    s_waitcnt lgkmcnt(2)
    v_mfma_f32_32x32x16_bf16 v[160:175], v[240:243], v[236:239], v[160:175]
    v_mfma_f32_32x32x16_bf16 v[176:191], v[220:223], v[236:239], v[176:191]
    ds_read_b64_tr_b16 v[244:245], v65 offset:4000
    ds_read_b64_tr_b16 v[246:247], v65 offset:3968
    v_mfma_f32_32x32x16_bf16 v[192:207], v[212:215], v[236:239], v[192:207]
    s_waitcnt lgkmcnt(2)
    v_mfma_f32_32x32x16_bf16 v[176:191], v[240:243], v[224:227], v[176:191]
    v_mfma_f32_32x32x16_bf16 v[192:207], v[220:223], v[224:227], v[192:207]
    s_waitcnt lgkmcnt(0)
    v_mfma_f32_32x32x16_bf16 v[192:207], v[240:243], v[244:247], v[192:207]
    s_waitcnt lgkmcnt(0)
    s_barrier
    ds_read_b128 v[212:215], v64 offset:608
    ds_read_b128 v[216:219], v64 offset:576
    ds_read_b128 v[220:223], v64 offset:544
    ds_read_b128 v[224:227], v64 offset:512
    s_waitcnt lgkmcnt(3)
    v_mfma_f32_32x32x16_bf16 v[144:159], v[212:215], v[112:115], v[144:159]
    ds_read_b128 v[228:231], v64 offset:736
    s_waitcnt lgkmcnt(3)
    v_mfma_f32_32x32x16_bf16 v[144:159], v[216:219], v[116:119], v[144:159]
    ds_read_b128 v[232:235], v64 offset:704
    s_waitcnt lgkmcnt(3)
    v_mfma_f32_32x32x16_bf16 v[144:159], v[220:223], v[120:123], v[144:159]
    ds_read_b128 v[236:239], v64 offset:672
    s_waitcnt lgkmcnt(3)
    v_mfma_f32_32x32x16_bf16 v[144:159], v[224:227], v[124:127], v[144:159]
    ds_read_b128 v[240:243], v64 offset:640
    s_nop 3
    s_waitcnt lgkmcnt(3)
    v_mfma_f32_32x32x16_bf16 v[160:175], v[228:231], v[112:115], v[160:175]
    s_nop 4
    s_waitcnt lgkmcnt(2)
    v_mfma_f32_32x32x16_bf16 v[160:175], v[232:235], v[116:119], v[160:175]
    v_cndmask_b32 v208, v147, v72, s[76:77]
    v_cndmask_b32 v209, v151, v147, s[76:77]
    v_cndmask_b32 v210, v155, v151, s[76:77]
    v_cndmask_b32 v211, v159, v155, s[76:77]
    v_mov_b32 v72, v159
    s_waitcnt lgkmcnt(1)
    v_mfma_f32_32x32x16_bf16 v[160:175], v[236:239], v[120:123], v[160:175]
    v_add_f32_dpp v146, v208, v146 wave_ror:1 row_mask:0xf bank_mask:0xf
    v_add_f32_dpp v150, v209, v150 wave_ror:1 row_mask:0xf bank_mask:0xf
    v_add_f32_dpp v154, v210, v154 wave_ror:1 row_mask:0xf bank_mask:0xf
    v_add_f32_dpp v158, v211, v158 wave_ror:1 row_mask:0xf bank_mask:0xf
    v_cndmask_b32 v208, v146, v71, s[76:77]
    s_waitcnt lgkmcnt(0)
    v_mfma_f32_32x32x16_bf16 v[160:175], v[240:243], v[124:127], v[160:175]
    v_cndmask_b32 v209, v150, v146, s[76:77]
    v_cndmask_b32 v210, v154, v150, s[76:77]
    v_cndmask_b32 v211, v158, v154, s[76:77]
    v_mov_b32 v71, v158
    v_add_f32_dpp v145, v208, v145 wave_ror:1 row_mask:0xf bank_mask:0xf
    v_add_f32_dpp v149, v209, v149 wave_ror:1 row_mask:0xf bank_mask:0xf
    v_mfma_f32_32x32x16_bf16 v[160:175], v[212:215], v[128:131], v[160:175]
    ds_read_b128 v[244:247], v64 offset:864
    v_add_f32_dpp v153, v210, v153 wave_ror:1 row_mask:0xf bank_mask:0xf
    v_add_f32_dpp v157, v211, v157 wave_ror:1 row_mask:0xf bank_mask:0xf
    v_cndmask_b32 v208, v145, v70, s[76:77]
    v_cndmask_b32 v209, v149, v145, s[76:77]
    v_cndmask_b32 v210, v153, v149, s[76:77]
    v_mfma_f32_32x32x16_bf16 v[160:175], v[216:219], v[132:135], v[160:175]
    ds_read_b128 v[248:251], v64 offset:832
    v_cndmask_b32 v211, v157, v153, s[76:77]
    v_mov_b32_e64 v70, v157
    v_add_f32_dpp v144, v208, v144 wave_ror:1 row_mask:0xf bank_mask:0xf
    v_add_f32_dpp v148, v209, v148 wave_ror:1 row_mask:0xf bank_mask:0xf
    v_add_f32_dpp v152, v210, v152 wave_ror:1 row_mask:0xf bank_mask:0xf
    v_mfma_f32_32x32x16_bf16 v[160:175], v[220:223], v[136:139], v[160:175]
    ds_read_b128 v[252:255], v64 offset:800
    v_add_f32_dpp v156, v211, v156 wave_ror:1 row_mask:0xf bank_mask:0xf
    ds_write_b32 v66, v144 offset:0
    v_mfma_f32_32x32x16_bf16 v[160:175], v[224:227], v[140:143], v[160:175]
    ds_read_b128 v[224:227], v64 offset:768
    ds_write_b32 v66, v148 offset:64
    ds_write_b32 v66, v152 offset:128
    s_waitcnt lgkmcnt(6)
    v_mfma_f32_32x32x16_bf16 v[176:191], v[244:247], v[112:115], v[176:191]
    ds_write_b32 v66, v156 offset:192
    s_nop 2
    s_waitcnt lgkmcnt(6)
    v_mfma_f32_32x32x16_bf16 v[176:191], v[248:251], v[116:119], v[176:191]
    s_nop 2
    v_cndmask_b32 v208, v163, v72, s[76:77]
    v_cndmask_b32 v209, v167, v163, s[76:77]
    s_waitcnt lgkmcnt(5)
    v_mfma_f32_32x32x16_bf16 v[176:191], v[252:255], v[120:123], v[176:191]
    v_cndmask_b32 v210, v171, v167, s[76:77]
    v_cndmask_b32 v211, v175, v171, s[76:77]
    v_mov_b32 v72, v175
    v_add_f32_dpp v162, v208, v162 wave_ror:1 row_mask:0xf bank_mask:0xf
    v_add_f32_dpp v166, v209, v166 wave_ror:1 row_mask:0xf bank_mask:0xf
    s_waitcnt lgkmcnt(3)
    v_mfma_f32_32x32x16_bf16 v[176:191], v[224:227], v[124:127], v[176:191]
    v_add_f32_dpp v170, v210, v170 wave_ror:1 row_mask:0xf bank_mask:0xf
    v_add_f32_dpp v174, v211, v174 wave_ror:1 row_mask:0xf bank_mask:0xf
    v_cndmask_b32 v208, v162, v71, s[76:77]
    v_cndmask_b32 v209, v166, v162, s[76:77]
    v_cndmask_b32 v210, v170, v166, s[76:77]
    v_cndmask_b32 v211, v174, v170, s[76:77]
    v_mfma_f32_32x32x16_bf16 v[176:191], v[228:231], v[128:131], v[176:191]
    ds_read_b64_tr_b16 v[228:229], v65 offset:1056
    ds_read_b64_tr_b16 v[230:231], v65 offset:1024
    v_mov_b32 v71, v174
    v_add_f32_dpp v161, v208, v161 wave_ror:1 row_mask:0xf bank_mask:0xf
    v_add_f32_dpp v165, v209, v165 wave_ror:1 row_mask:0xf bank_mask:0xf
    v_add_f32_dpp v169, v210, v169 wave_ror:1 row_mask:0xf bank_mask:0xf
    v_mfma_f32_32x32x16_bf16 v[176:191], v[232:235], v[132:135], v[176:191]
    ds_read_b64_tr_b16 v[232:233], v65 offset:1184
    ds_read_b64_tr_b16 v[234:235], v65 offset:1152
    v_add_f32_dpp v173, v211, v173 wave_ror:1 row_mask:0xf bank_mask:0xf
    v_cndmask_b32 v208, v161, v70, s[76:77]
    v_cndmask_b32 v209, v165, v161, s[76:77]
    v_cndmask_b32 v210, v169, v165, s[76:77]
    v_mfma_f32_32x32x16_bf16 v[176:191], v[236:239], v[136:139], v[176:191]
    ds_read_b64_tr_b16 v[236:237], v65 offset:1312
    ds_read_b64_tr_b16 v[238:239], v65 offset:1280
    v_cndmask_b32 v211, v173, v169, s[76:77]
    v_mov_b32_e64 v70, v173
    v_add_f32_dpp v160, v208, v160 wave_ror:1 row_mask:0xf bank_mask:0xf
    v_add_f32_dpp v164, v209, v164 wave_ror:1 row_mask:0xf bank_mask:0xf
    v_mfma_f32_32x32x16_bf16 v[176:191], v[240:243], v[140:143], v[176:191]
    ds_read_b128 v[240:243], v64 offset:512
    ds_read_b64_tr_b16 v[224:225], v65 offset:1440
    ds_read_b64_tr_b16 v[226:227], v65 offset:1408
    v_add_f32_dpp v168, v210, v168 wave_ror:1 row_mask:0xf bank_mask:0xf
    v_add_f32_dpp v172, v211, v172 wave_ror:1 row_mask:0xf bank_mask:0xf
    s_waitcnt lgkmcnt(7)
    v_mfma_f32_32x32x16_bf16 v[176:191], v[212:215], v[228:231], v[176:191]
    ds_read_b128 v[212:215], v64 offset:992
    ds_write_b32 v66, v160 offset:256
    ds_write_b32 v66, v164 offset:320
    s_waitcnt lgkmcnt(8)
    v_mfma_f32_32x32x16_bf16 v[176:191], v[216:219], v[232:235], v[176:191]
    ds_read_b128 v[216:219], v64 offset:960
    ds_write_b32 v66, v168 offset:384
    ds_write_b32 v66, v172 offset:448
    s_waitcnt lgkmcnt(9)
    v_mfma_f32_32x32x16_bf16 v[176:191], v[220:223], v[236:239], v[176:191]
    ds_read_b128 v[220:223], v64 offset:928
    s_waitcnt lgkmcnt(7)
    v_mfma_f32_32x32x16_bf16 v[176:191], v[240:243], v[224:227], v[176:191]
    ds_read_b128 v[240:243], v64 offset:896
    s_waitcnt lgkmcnt(2)
    s_barrier
    v_mfma_f32_32x32x16_bf16 v[192:207], v[212:215], v[112:115], v[192:207]
    ds_read_b64 v[144:145], v67 offset:0
    ds_read_b64 v[146:147], v67 offset:4224
    ds_read_b64 v[148:149], v67 offset:8448
    ds_read_b64 v[150:151], v67 offset:12672
    s_nop 0
    v_mfma_f32_32x32x16_bf16 v[192:207], v[216:219], v[116:119], v[192:207]
    s_nop 2
    v_cndmask_b32 v208, v179, v72, s[76:77]
    v_cndmask_b32 v209, v183, v179, s[76:77]
    s_waitcnt lgkmcnt(5)
    v_mfma_f32_32x32x16_bf16 v[192:207], v[220:223], v[120:123], v[192:207]
    v_cndmask_b32 v210, v187, v183, s[76:77]
    v_cndmask_b32 v211, v191, v187, s[76:77]
    v_mov_b32 v72, v191
    v_add_f32_dpp v178, v208, v178 wave_ror:1 row_mask:0xf bank_mask:0xf
    v_add_f32_dpp v182, v209, v182 wave_ror:1 row_mask:0xf bank_mask:0xf
    s_waitcnt lgkmcnt(4)
    v_mfma_f32_32x32x16_bf16 v[192:207], v[240:243], v[124:127], v[192:207]
    ds_read_b128 v[212:215], v64 offset:768
    v_add_f32_dpp v186, v210, v186 wave_ror:1 row_mask:0xf bank_mask:0xf
    v_add_f32_dpp v190, v211, v190 wave_ror:1 row_mask:0xf bank_mask:0xf
    v_cndmask_b32 v208, v178, v71, s[76:77]
    v_cndmask_b32 v209, v182, v178, s[76:77]
    v_cndmask_b32 v210, v186, v182, s[76:77]
    v_mfma_f32_32x32x16_bf16 v[192:207], v[244:247], v[128:131], v[192:207]
    ds_read_b128 v[244:247], v64 offset:736
    v_cndmask_b32 v211, v190, v186, s[76:77]
    v_mov_b32 v71, v190
    v_add_f32_dpp v177, v208, v177 wave_ror:1 row_mask:0xf bank_mask:0xf
    v_add_f32_dpp v181, v209, v181 wave_ror:1 row_mask:0xf bank_mask:0xf
    v_add_f32_dpp v185, v210, v185 wave_ror:1 row_mask:0xf bank_mask:0xf
    v_mfma_f32_32x32x16_bf16 v[192:207], v[248:251], v[132:135], v[192:207]
    ds_read_b128 v[248:251], v64 offset:704
    v_add_f32_dpp v189, v211, v189 wave_ror:1 row_mask:0xf bank_mask:0xf
    v_cndmask_b32 v208, v177, v70, s[76:77]
    v_cndmask_b32 v209, v181, v177, s[76:77]
    v_cndmask_b32 v210, v185, v181, s[76:77]
    v_cndmask_b32 v211, v189, v185, s[76:77]
    v_mfma_f32_32x32x16_bf16 v[192:207], v[252:255], v[136:139], v[192:207]
    ds_read_b128 v[252:255], v64 offset:672
    v_mov_b32_e64 v70, v189
    v_add_f32_dpp v176, v208, v176 wave_ror:1 row_mask:0xf bank_mask:0xf
    v_add_f32_dpp v180, v209, v180 wave_ror:1 row_mask:0xf bank_mask:0xf
    v_add_f32_dpp v184, v210, v184 wave_ror:1 row_mask:0xf bank_mask:0xf
    s_waitcnt lgkmcnt(3)
    v_mfma_f32_32x32x16_bf16 v[192:207], v[212:215], v[140:143], v[192:207]
    ds_read_b128 v[216:219], v64 offset:640
    v_add_f32_dpp v188, v211, v188 wave_ror:1 row_mask:0xf bank_mask:0xf
    s_waitcnt lgkmcnt(3)
    v_mfma_f32_32x32x16_bf16 v[192:207], v[244:247], v[228:231], v[192:207]
    ds_read_b128 v[228:231], v64 offset:608
    ds_read_b64_tr_b16 v[220:221], v65 offset:1568
    ds_read_b64_tr_b16 v[222:223], v65 offset:1536
    ds_write_b32 v66, v176 offset:512
    s_waitcnt lgkmcnt(6)
    v_mfma_f32_32x32x16_bf16 v[192:207], v[248:251], v[232:235], v[192:207]
    ds_read_b128 v[232:235], v64 offset:576
    ds_read_b64_tr_b16 v[240:241], v65 offset:1696
    ds_read_b64_tr_b16 v[242:243], v65 offset:1664
    ds_write_b32 v66, v180 offset:576
    s_waitcnt lgkmcnt(9)
    v_mfma_f32_32x32x16_bf16 v[192:207], v[252:255], v[236:239], v[192:207]
    ds_read_b128 v[236:239], v64 offset:544
    ds_read_b64_tr_b16 v[212:213], v65 offset:1824
    ds_read_b64_tr_b16 v[214:215], v65 offset:1792
    ds_write_b32 v66, v184 offset:640
    s_waitcnt lgkmcnt(12)
    v_mfma_f32_32x32x16_bf16 v[192:207], v[216:219], v[224:227], v[192:207]
    ds_read_b128 v[224:227], v64 offset:512
    ds_read_b64_tr_b16 v[244:245], v65 offset:1952
    ds_read_b64_tr_b16 v[246:247], v65 offset:1920
    ds_write_b32 v66, v188 offset:704
    s_waitcnt lgkmcnt(13)
    v_mfma_f32_32x32x16_bf16 v[192:207], v[228:231], v[220:223], v[192:207]
    v_add_f32 v144, v144, v80
    v_add_f32 v145, v145, v81
    v_add_f32 v146, v146, v82
    v_add_f32 v147, v147, v83
    s_waitcnt lgkmcnt(9)
    v_mfma_f32_32x32x16_bf16 v[192:207], v[232:235], v[240:243], v[192:207]
    v_add_f32 v148, v148, v84
    v_add_f32 v149, v149, v85
    v_add_f32 v150, v150, v86
    v_add_f32 v151, v151, v87
    v_cvt_pk_bf16_f32 v160, v144, v146
    s_waitcnt lgkmcnt(5)
    v_mfma_f32_32x32x16_bf16 v[192:207], v[236:239], v[212:215], v[192:207]
    v_cvt_pk_bf16_f32 v161, v148, v150
    v_cvt_pk_bf16_f32 v162, v145, v147
    v_cvt_pk_bf16_f32 v163, v149, v151
    s_mov_b32 s25, 1310720
    s_waitcnt lgkmcnt(1)
    v_mfma_f32_32x32x16_bf16 v[192:207], v[224:227], v[244:247], v[192:207]
    buffer_store_dwordx2 v[160:161], v68, s[20:23], s25 offen
    s_mov_b32 s25, 1315840
    buffer_store_dwordx2 v[162:163], v68, s[20:23], s25 offen
    s_nop 8
    v_cndmask_b32 v208, v195, v72, s[76:77]
    v_cndmask_b32 v209, v199, v195, s[76:77]
    v_cndmask_b32 v210, v203, v199, s[76:77]
    v_cndmask_b32 v211, v207, v203, s[76:77]
    v_mov_b32_e64 v72, v207
    v_add_f32_dpp v194, v208, v194 wave_ror:1 row_mask:0xf bank_mask:0xf
    v_add_f32_dpp v198, v209, v198 wave_ror:1 row_mask:0xf bank_mask:0xf
    v_add_f32_dpp v202, v210, v202 wave_ror:1 row_mask:0xf bank_mask:0xf
    v_add_f32_dpp v206, v211, v206 wave_ror:1 row_mask:0xf bank_mask:0xf
    v_cndmask_b32 v208, v194, v71, s[76:77]
    v_cndmask_b32 v209, v198, v194, s[76:77]
    v_cndmask_b32 v210, v202, v198, s[76:77]
    v_cndmask_b32 v211, v206, v202, s[76:77]
    v_mov_b32_e64 v71, v206
    v_add_f32_dpp v193, v208, v193 wave_ror:1 row_mask:0xf bank_mask:0xf
    v_add_f32_dpp v197, v209, v197 wave_ror:1 row_mask:0xf bank_mask:0xf
    v_add_f32_dpp v201, v210, v201 wave_ror:1 row_mask:0xf bank_mask:0xf
    v_add_f32_dpp v205, v211, v205 wave_ror:1 row_mask:0xf bank_mask:0xf
    v_cndmask_b32 v208, v193, v70, s[76:77]
    v_cndmask_b32 v209, v197, v193, s[76:77]
    v_cndmask_b32 v210, v201, v197, s[76:77]
    v_cndmask_b32 v211, v205, v201, s[76:77]
    v_mov_b32_e64 v70, v205
    v_add_f32_dpp v192, v208, v192 wave_ror:1 row_mask:0xf bank_mask:0xf
    v_add_f32_dpp v196, v209, v196 wave_ror:1 row_mask:0xf bank_mask:0xf
    v_add_f32_dpp v200, v210, v200 wave_ror:1 row_mask:0xf bank_mask:0xf
    v_add_f32_dpp v204, v211, v204 wave_ror:1 row_mask:0xf bank_mask:0xf
    ds_write_b32 v66, v192 offset:768
    ds_write_b32 v66, v196 offset:832
    ds_write_b32 v66, v200 offset:896
    ds_write_b32 v66, v204 offset:960
    s_waitcnt lgkmcnt(0)
    s_barrier
    ds_read_b64 v[152:153], v67 offset:512
    ds_read_b64 v[154:155], v67 offset:4736
    ds_read_b64 v[156:157], v67 offset:8960
    ds_read_b64 v[158:159], v67 offset:13184
    s_waitcnt lgkmcnt(0)
    v_add_f32 v152, v152, v88
    v_add_f32 v153, v153, v89
    v_add_f32 v154, v154, v90
    v_add_f32 v155, v155, v91
    v_add_f32 v156, v156, v92
    v_add_f32 v157, v157, v93
    v_add_f32 v158, v158, v94
    v_add_f32_e64 v159, v159, v95
    v_cvt_pk_bf16_f32 v164, v152, v154
    v_cvt_pk_bf16_f32 v165, v156, v158
    v_cvt_pk_bf16_f32 v166, v153, v155
    v_cvt_pk_bf16_f32 v167, v157, v159
    s_mov_b32 s25, 1966080
    buffer_store_dwordx2 v[164:165], v68, s[20:23], s25 offen
    s_mov_b32 s25, 1971200
    buffer_store_dwordx2 v[166:167], v68, s[20:23], s25 offen
    s_branch ec_82
nc_81:
ec_82:
L_end:
    s_endpgm
ps_5:
    s_mov_b32 s84, 1048576
pl_6:
    global_load_dword v7, v5, s[66:67] sc1
    s_waitcnt vmcnt(0)
    s_sub_u32 s84, s84, 1
    s_cbranch_scc1 pc_7
    v_cmp_gt_u32_e64 vcc, 1, v7
    s_nop 0
    s_and_b64 vcc, vcc, s[50:51]
    s_and_b64 vcc, vcc, 1
    s_cbranch_scc1 pl_6
    s_branch pc_7
ps_8:
    s_mov_b32 s84, 1048576
pl_9:
    buffer_load_dword v7, v4, s[16:19], s87 offen offset:0 sc1
    s_waitcnt vmcnt(0)
    s_sub_u32 s84, s84, 1
    s_cbranch_scc1 pc_10
    v_cmp_gt_u32 vcc, 32, v7
    s_nop 0
    s_and_b64 vcc, vcc, s[50:51]
    s_cbranch_scc1 pl_9
    s_branch pc_10
ps_11:
    s_mov_b32 s84, 1048576
pl_12:
    global_load_dword v7, v5, s[66:67] sc1
    s_waitcnt vmcnt(0)
    s_sub_u32 s84, s84, 1
    s_cbranch_scc1 pc_13
    v_cmp_gt_u32_e64 vcc, 1, v7
    s_nop 0
    s_and_b64 vcc, vcc, s[50:51]
    s_and_b64 vcc, vcc, 1
    s_cbranch_scc1 pl_12
    s_branch pc_13
ps_14:
    s_mov_b32 s84, 1048576
pl_15:
    buffer_load_dword v7, v4, s[16:19], s87 offen offset:0 sc1
    s_waitcnt vmcnt(0)
    s_sub_u32 s84, s84, 1
    s_cbranch_scc1 pc_16
    v_cmp_gt_u32 vcc, 32, v7
    s_nop 0
    s_and_b64 vcc, vcc, s[50:51]
    s_cbranch_scc1 pl_15
    s_branch pc_16
ps_17:
    s_mov_b32 s84, 1048576
pl_18:
    buffer_load_dword v7, v4, s[16:19], s89 offen offset:8 sc1
    s_waitcnt vmcnt(0)
    s_sub_u32 s84, s84, 1
    s_cbranch_scc1 pc_19
    v_cmp_gt_u32_e64 vcc, 32, v7
    s_nop 0
    s_and_b64 vcc, vcc, s[50:51]
    s_cbranch_scc1 pl_18
    s_branch pc_19
rd_21:
    s_cmp_eq_u32 s38, 0
    s_cbranch_scc1 rc_22
    s_sub_u32 s38, s38, 1
    s_nop 7
    s_nop 7
    s_sleep 4
    s_mov_b64 exec, vcc
    s_mov_b32 s96, 4194304
    buffer_load_dwordx4 v[216:219], v56, s[16:19], s96 offen offset:0 sc1
    buffer_load_dwordx4 v[220:223], v56, s[16:19], s96 offen offset:256 sc1
    s_mov_b32 s96, 4227072
    buffer_load_dwordx4 v[224:227], v56, s[16:19], s96 offen offset:0 sc1
    buffer_load_dwordx4 v[228:231], v56, s[16:19], s96 offen offset:256 sc1
    s_mov_b32 s96, 4259840
    buffer_load_dwordx4 v[232:235], v56, s[16:19], s96 offen offset:0 sc1
    buffer_load_dwordx4 v[236:239], v56, s[16:19], s96 offen offset:256 sc1
    s_mov_b32 s96, 4292608
    buffer_load_dwordx4 v[240:243], v56, s[16:19], s96 offen offset:0 sc1
    buffer_load_dwordx4 v[244:247], v56, s[16:19], s96 offen offset:256 sc1
    s_mov_b32 s96, 4194304
    buffer_load_dwordx2 v[248:249], v57, s[16:19], s96 offen offset:0 sc1
    buffer_load_dwordx2 v[252:253], v57, s[16:19], s96 offen offset:128 sc1
    s_mov_b32 s96, 4210688
    buffer_load_dwordx2 v[250:251], v57, s[16:19], s96 offen offset:0 sc1
    buffer_load_dwordx2 v[254:255], v57, s[16:19], s96 offen offset:128 sc1
    s_mov_b32 s96, 0
    s_mov_b32 s97, 5120
    s_waitcnt vmcnt(16)
    buffer_load_dwordx2 v[208:209], v60, s[4:7], s96 offen
    s_waitcnt vmcnt(16)
    buffer_load_dwordx2 v[210:211], v60, s[4:7], s97 offen
    s_waitcnt vmcnt(16)
    v_lshrrev_b32_e64 v212, 5, v1
    v_mul_u32_u24 v212, 5104, v212
    v_bfe_u32 v213, v1, 4, 1
    v_lshlrev_b32 v213, 2, v213
    v_sub_u32 v212, v212, v213
    v_add_u32 v212, v212, v60
    s_mul_i32 s97, s24, 24
    s_sub_u32 s97, 128, s97
    buffer_load_dword v212, v212, s[4:7], s97 offen
    s_mov_b64 exec, -1
    s_waitcnt vmcnt(0) lgkmcnt(0)
    s_branch oe_20
rd_24:
    s_cmp_eq_u32 s38, 0
    s_cbranch_scc1 rc_25
    s_sub_u32 s38, s38, 1
    s_nop 7
    s_nop 7
    s_sleep 4
    s_mov_b64 exec, vcc
    s_mov_b32 s96, 4198400
    buffer_load_dwordx4 v[216:219], v56, s[16:19], s96 offen offset:0 sc1
    buffer_load_dwordx4 v[220:223], v56, s[16:19], s96 offen offset:256 sc1
    s_mov_b32 s96, 4231168
    buffer_load_dwordx4 v[224:227], v56, s[16:19], s96 offen offset:0 sc1
    buffer_load_dwordx4 v[228:231], v56, s[16:19], s96 offen offset:256 sc1
    s_mov_b32 s96, 4263936
    buffer_load_dwordx4 v[232:235], v56, s[16:19], s96 offen offset:0 sc1
    buffer_load_dwordx4 v[236:239], v56, s[16:19], s96 offen offset:256 sc1
    s_mov_b32 s96, 4296704
    buffer_load_dwordx4 v[240:243], v56, s[16:19], s96 offen offset:0 sc1
    buffer_load_dwordx4 v[244:247], v56, s[16:19], s96 offen offset:256 sc1
    s_mov_b32 s96, 4196352
    buffer_load_dwordx2 v[248:249], v57, s[16:19], s96 offen offset:0 sc1
    buffer_load_dwordx2 v[252:253], v57, s[16:19], s96 offen offset:128 sc1
    s_mov_b32 s96, 4212736
    buffer_load_dwordx2 v[250:251], v57, s[16:19], s96 offen offset:0 sc1
    buffer_load_dwordx2 v[254:255], v57, s[16:19], s96 offen offset:128 sc1
    s_mov_b32 s96, 1310720
    s_mov_b32 s97, 1315840
    s_waitcnt vmcnt(15)
    buffer_load_dwordx2 v[208:209], v60, s[4:7], s96 offen
    s_waitcnt vmcnt(15)
    buffer_load_dwordx2 v[210:211], v60, s[4:7], s97 offen
    s_waitcnt vmcnt(15)
    v_lshrrev_b32 v212, 5, v1
    v_mul_u32_u24 v212, 5104, v212
    v_bfe_u32 v213, v1, 4, 1
    v_lshlrev_b32 v213, 2, v213
    v_sub_u32 v212, v212, v213
    v_add_u32 v212, v212, v60
    s_mul_i32 s97, s24, 24
    s_sub_u32 s97, 1310848, s97
    buffer_load_dword v212, v212, s[4:7], s97 offen
    s_mov_b64 exec, -1
    s_waitcnt vmcnt(0) lgkmcnt(0)
    s_branch oe_23
rd_29:
    s_cmp_eq_u32 s38, 0
    s_cbranch_scc1 rc_30
    s_sub_u32 s38, s38, 1
    s_nop 7
    s_nop 7
    s_sleep 4
    s_mov_b64 exec, vcc
    s_lshl_b32 s96, s75, 14
    s_add_u32 s96, s96, 6815744
    s_lshl_b32 s97, s24, 12
    s_add_u32 s97, s97, 3473408
    buffer_load_dwordx4 v[176:179], v62, s[16:19], s96 offen offset:0 sc1
    buffer_load_dwordx4 v[180:183], v62, s[16:19], s96 offen offset:1024 sc1
    buffer_load_dwordx4 v[184:187], v62, s[16:19], s97 offen offset:0 sc1
    buffer_load_dwordx4 v[188:191], v62, s[16:19], s97 offen offset:1024 sc1
    buffer_load_dwordx4 v[192:195], v62, s[16:19], s97 offen offset:2048 sc1
    buffer_load_dwordx4 v[196:199], v62, s[16:19], s97 offen offset:3072 sc1
    s_mov_b64 exec, -1
    s_waitcnt vmcnt(0) lgkmcnt(0)
    s_branch ce_28
rd_32:
    s_cmp_eq_u32 s38, 0
    s_cbranch_scc1 rc_33
    s_sub_u32 s38, s38, 1
    s_nop 7
    s_nop 7
    s_sleep 4
    s_mov_b64 exec, vcc
    s_lshl_b32 s96, s75, 14
    s_add_u32 s96, s96, 6815744
    s_lshl_b32 s97, s24, 12
    s_add_u32 s97, s97, 3477504
    buffer_load_dwordx4 v[248:251], v62, s[16:19], s96 offen offset:2048 sc1
    buffer_load_dwordx4 v[252:255], v62, s[16:19], s96 offen offset:3072 sc1
    buffer_load_dwordx4 v[96:99], v62, s[16:19], s97 offen offset:0 sc1
    buffer_load_dwordx4 v[100:103], v62, s[16:19], s97 offen offset:1024 sc1
    buffer_load_dwordx4 v[104:107], v62, s[16:19], s97 offen offset:2048 sc1
    buffer_load_dwordx4 v[108:111], v62, s[16:19], s97 offen offset:3072 sc1
    s_mov_b64 exec, -1
    s_waitcnt vmcnt(0) lgkmcnt(0)
    s_branch ce_31
gl_34:
    s_add_u32 s82, s86, 16384
    v_lshlrev_b32 v2, 10, v1
    v_mov_b32_e64 v5, 1
    s_mov_b64 exec, 255
    buffer_store_dword v5, v2, s[16:19], s82 offen offset:0 sc1
    s_mov_b64 exec, -1
    s_branch gc_35
ps_36:
    s_mov_b32 s84, 1048576
pl_37:
    buffer_load_dword v7, v4, s[16:19], s89 offen offset:0 sc1
    s_waitcnt vmcnt(0)
    s_sub_u32 s84, s84, 1
    s_cbranch_scc1 pc_38
    v_cmp_gt_u32 vcc, 1, v7
    s_nop 0
    s_and_b64 vcc, vcc, s[50:51]
    s_cbranch_scc1 pl_37
    s_branch pc_38
ps_39:
    s_mov_b32 s84, 1048576
pl_40:
    buffer_load_dword v7, v4, s[16:19], s87 offen offset:8 sc1
    s_waitcnt vmcnt(0)
    s_sub_u32 s84, s84, 1
    s_cbranch_scc1 pc_41
    v_cmp_gt_u32 vcc, 12, v7
    s_nop 0
    s_and_b64 vcc, vcc, s[50:51]
    s_cbranch_scc1 pl_40
    s_branch pc_41
gl_42:
    s_add_u32 s82, s86, 0
    v_lshlrev_b32 v2, 10, v1
    v_mov_b32_e64 v5, 1
    s_mov_b64 exec, 255
    buffer_store_dword v5, v2, s[16:19], s82 offen offset:12 sc1
    s_mov_b64 exec, -1
    s_branch gc_43
ps_44:
    s_mov_b32 s84, 1048576
pl_45:
    buffer_load_dword v7, v4, s[16:19], s89 offen offset:0 sc1
    s_waitcnt vmcnt(0)
    s_sub_u32 s84, s84, 1
    s_cbranch_scc1 pc_46
    v_cmp_gt_u32_e64 vcc, 1, v7
    s_nop 0
    s_and_b64 vcc, vcc, s[50:51]
    s_cbranch_scc1 pl_45
    s_branch pc_46
rd_49:
    s_cmp_eq_u32 s38, 0
    s_cbranch_scc1 rc_50
    s_sub_u32 s38, s38, 1
    s_nop 7
    s_nop 7
    s_sleep 4
    s_mov_b64 exec, vcc
    s_add_u32 s26, s3, 9437184
    buffer_load_dwordx4 v[216:219], v236, s[16:19], s26 offen sc1
    s_add_u32 s26, s26, 524288
    buffer_load_dwordx4 v[220:223], v236, s[16:19], s26 offen sc1
    s_add_u32 s26, s26, 524288
    buffer_load_dwordx4 v[224:227], v236, s[16:19], s26 offen sc1
    s_add_u32 s26, s26, 524288
    buffer_load_dwordx4 v[228:231], v236, s[16:19], s26 offen sc1
    s_add_u32 s26, s26, 524288
    buffer_load_dwordx4 v[232:235], v236, s[16:19], s26 offen sc1
    s_mov_b64 exec, -1
    s_waitcnt vmcnt(0) lgkmcnt(0)
    s_branch se_48
gl_52:
    s_add_u32 s82, s86, 16384
    v_lshlrev_b32 v2, 10, v1
    v_mov_b32_e64 v5, 1
    s_mov_b64 exec, 255
    buffer_store_dword v5, v2, s[16:19], s82 offen offset:4 sc1
    s_mov_b64 exec, -1
    s_branch gc_53
ps_54:
    s_mov_b32 s84, 1048576
pl_55:
    buffer_load_dword v7, v4, s[16:19], s87 offen offset:12 sc1
    s_waitcnt vmcnt(0)
    s_sub_u32 s84, s84, 1
    s_cbranch_scc1 pc_56
    v_cmp_gt_u32_e64 vcc, 1, v7
    s_nop 0
    s_and_b64 vcc, vcc, s[50:51]
    s_cbranch_scc1 pl_55
    s_branch pc_56
rd_58:
    s_cmp_eq_u32 s38, 0
    s_cbranch_scc1 rc_59
    s_sub_u32 s38, s38, 1
    s_nop 7
    s_nop 7
    s_sleep 4
    s_mov_b64 exec, vcc
    s_lshl_b32 s98, s72, 5
    s_add_u32 s98, s98, 0
    s_sub_u32 s95, s98, 4
    s_max_i32 s95, s95, 0
    s_lshl_b32 s94, s98, 3
    s_lshl_b32 s95, s95, 3
    s_add_u32 s94, s94, 3457024
    s_add_u32 s95, s95, 3457024
    s_add_u32 s96, s94, 8192
    buffer_load_dwordx2 v[152:153], v47, s[16:19], s94 offen sc1
    buffer_load_dwordx2 v[154:155], v47, s[16:19], s96 offen sc1
    buffer_load_dwordx2 v[156:157], v48, s[16:19], s95 offen sc1
    s_mov_b64 exec, -1
    s_waitcnt vmcnt(0) lgkmcnt(0)
    s_branch sl_57
ps_60:
    s_mov_b32 s84, 1048576
pl_61:
    buffer_load_dword v7, v4, s[16:19], s89 offen offset:4 sc1
    s_waitcnt vmcnt(0)
    s_sub_u32 s84, s84, 1
    s_cbranch_scc1 pc_62
    v_cmp_gt_u32 vcc, 1, v7
    s_nop 0
    s_and_b64 vcc, vcc, s[50:51]
    s_cbranch_scc1 pl_61
    s_branch pc_62
rd_65:
    s_cmp_eq_u32 s38, 0
    s_cbranch_scc1 rc_66
    s_sub_u32 s38, s38, 1
    s_nop 7
    s_nop 7
    s_sleep 4
    s_mov_b64 exec, vcc
    s_add_u32 s26, s3, 9437184
    buffer_load_dwordx4 v[216:219], v236, s[16:19], s26 offen sc1
    s_add_u32 s26, s26, 524288
    buffer_load_dwordx4 v[220:223], v236, s[16:19], s26 offen sc1
    s_add_u32 s26, s26, 524288
    buffer_load_dwordx4 v[224:227], v236, s[16:19], s26 offen sc1
    s_add_u32 s26, s26, 524288
    buffer_load_dwordx4 v[228:231], v236, s[16:19], s26 offen sc1
    s_add_u32 s26, s26, 524288
    buffer_load_dwordx4 v[232:235], v236, s[16:19], s26 offen sc1
    s_mov_b64 exec, -1
    s_waitcnt vmcnt(0) lgkmcnt(0)
    s_branch se_64
rd_67:
    s_cmp_eq_u32 s39, 0
    s_cbranch_scc1 rc_68
    s_sub_u32 s39, s39, 1
    s_nop 7
    s_nop 7
    s_waitcnt vmcnt(0) lgkmcnt(0)
    s_barrier
    s_lshl_b32 s25, s72, 5
    s_add_u32 s25, s25, 0
    s_sub_u32 s26, s25, 4
    s_max_i32 s26, s26, 0
    s_lshl_b32 s27, s71, 12
    s_add_u32 s27, s27, 9437184
    s_lshl_b32 s99, s25, 3
    s_lshl_b32 s100, s26, 3
    s_lshl_b32 s92, s24, 12
    s_lshl_b32 s93, s24, 9
    s_add_u32 s99, s99, s27
    s_add_u32 s100, s100, s27
    s_add_u32 m0, s92, 36352
    s_nop 0
    buffer_load_dwordx4 v73, s[16:19], s99 offen offset:0 sc1 lds
    buffer_load_dwordx4 v74, s[16:19], s99 offen offset:1024 sc1 lds
    buffer_load_dwordx4 v75, s[16:19], s99 offen offset:2048 sc1 lds
    buffer_load_dwordx4 v76, s[16:19], s99 offen offset:3072 sc1 lds
    s_add_u32 m0, s93, 53760
    s_add_u32 s99, s99, 524288
    s_mov_b64 exec, s[80:81]
    buffer_load_dwordx4 v77, s[16:19], s100 offen sc1 lds
    s_mov_b64 exec, -1
    s_add_u32 s100, s100, 524288
    s_add_u32 m0, s92, 55936
    s_nop 0
    s_nop 0
    buffer_load_dwordx4 v73, s[16:19], s99 offen offset:0 sc1 lds
    buffer_load_dwordx4 v74, s[16:19], s99 offen offset:1024 sc1 lds
    buffer_load_dwordx4 v75, s[16:19], s99 offen offset:2048 sc1 lds
    buffer_load_dwordx4 v76, s[16:19], s99 offen offset:3072 sc1 lds
    s_add_u32 m0, s93, 73344
    s_add_u32 s99, s99, 524288
    s_mov_b64 exec, s[80:81]
    buffer_load_dwordx4 v77, s[16:19], s100 offen sc1 lds
    s_mov_b64 exec, -1
    s_add_u32 s100, s100, 524288
    s_add_u32 m0, s92, 75520
    s_nop 0
    s_nop 0
    buffer_load_dwordx4 v73, s[16:19], s99 offen offset:0 sc1 lds
    buffer_load_dwordx4 v74, s[16:19], s99 offen offset:1024 sc1 lds
    buffer_load_dwordx4 v75, s[16:19], s99 offen offset:2048 sc1 lds
    buffer_load_dwordx4 v76, s[16:19], s99 offen offset:3072 sc1 lds
    s_add_u32 m0, s93, 92928
    s_add_u32 s99, s99, 524288
    s_mov_b64 exec, s[80:81]
    buffer_load_dwordx4 v77, s[16:19], s100 offen sc1 lds
    s_mov_b64 exec, -1
    s_add_u32 s100, s100, 524288
    s_mov_b64 exec, -1
    s_waitcnt vmcnt(0) lgkmcnt(0)
    s_branch ge_51
rd_71:
    s_cmp_eq_u32 s38, 0
    s_cbranch_scc1 rc_72
    s_sub_u32 s38, s38, 1
    s_nop 7
    s_nop 7
    s_sleep 4
    s_mov_b64 exec, vcc
    s_lshl_b32 s98, s72, 5
    s_add_u32 s98, s98, 256
    s_sub_u32 s95, s98, 4
    s_max_i32 s95, s95, 0
    s_lshl_b32 s94, s98, 3
    s_lshl_b32 s95, s95, 3
    s_nop 0
    s_add_u32 s94, s94, 3457024
    s_add_u32 s95, s95, 3457024
    s_add_u32 s96, s94, 8192
    buffer_load_dwordx2 v[152:153], v47, s[16:19], s94 offen sc1
    buffer_load_dwordx2 v[154:155], v47, s[16:19], s96 offen sc1
    buffer_load_dwordx2 v[156:157], v48, s[16:19], s95 offen sc1
    s_mov_b64 exec, -1
    s_waitcnt vmcnt(0) lgkmcnt(0)
    s_branch sl_70
rd_73:
    s_cmp_eq_u32 s39, 0
    s_cbranch_scc1 rc_74
    s_sub_u32 s39, s39, 1
    s_nop 7
    s_nop 7
    s_waitcnt vmcnt(0) lgkmcnt(0)
    s_barrier
    s_lshl_b32 s25, s72, 5
    s_add_u32 s25, s25, 256
    s_sub_u32 s26, s25, 4
    s_max_i32 s26, s26, 0
    s_lshl_b32 s27, s71, 12
    s_add_u32 s27, s27, 9437184
    s_lshl_b32 s99, s25, 3
    s_lshl_b32 s100, s26, 3
    s_lshl_b32 s92, s24, 12
    s_lshl_b32 s93, s24, 9
    s_add_u32 s99, s99, s27
    s_add_u32 s100, s100, s27
    s_add_u32 m0, s92, 36352
    s_nop 0
    s_nop 0
    buffer_load_dwordx4 v73, s[16:19], s99 offen offset:0 sc1 lds
    buffer_load_dwordx4 v74, s[16:19], s99 offen offset:1024 sc1 lds
    buffer_load_dwordx4 v75, s[16:19], s99 offen offset:2048 sc1 lds
    buffer_load_dwordx4 v76, s[16:19], s99 offen offset:3072 sc1 lds
    s_add_u32 m0, s93, 53760
    s_add_u32 s99, s99, 524288
    s_mov_b64 exec, s[80:81]
    buffer_load_dwordx4 v77, s[16:19], s100 offen sc1 lds
    s_mov_b64 exec, -1
    s_add_u32 s100, s100, 524288
    s_add_u32 m0, s92, 55936
    s_nop 0
    s_nop 0
    buffer_load_dwordx4 v73, s[16:19], s99 offen offset:0 sc1 lds
    buffer_load_dwordx4 v74, s[16:19], s99 offen offset:1024 sc1 lds
    buffer_load_dwordx4 v75, s[16:19], s99 offen offset:2048 sc1 lds
    buffer_load_dwordx4 v76, s[16:19], s99 offen offset:3072 sc1 lds
    s_add_u32 m0, s93, 73344
    s_add_u32 s99, s99, 524288
    s_mov_b64 exec, s[80:81]
    buffer_load_dwordx4 v77, s[16:19], s100 offen sc1 lds
    s_mov_b64 exec, -1
    s_add_u32 s100, s100, 524288
    s_add_u32 m0, s92, 75520
    s_nop 0
    s_nop 0
    buffer_load_dwordx4 v73, s[16:19], s99 offen offset:0 sc1 lds
    buffer_load_dwordx4 v74, s[16:19], s99 offen offset:1024 sc1 lds
    buffer_load_dwordx4 v75, s[16:19], s99 offen offset:2048 sc1 lds
    buffer_load_dwordx4 v76, s[16:19], s99 offen offset:3072 sc1 lds
    s_add_u32 m0, s93, 92928
    s_add_u32 s99, s99, 524288
    s_mov_b64 exec, s[80:81]
    buffer_load_dwordx4 v77, s[16:19], s100 offen sc1 lds
    s_mov_b64 exec, -1
    s_add_u32 s100, s100, 524288
    s_mov_b64 exec, -1
    s_waitcnt vmcnt(0) lgkmcnt(0)
    s_branch ge_69
rd_76:
    s_cmp_eq_u32 s38, 0
    s_cbranch_scc1 rc_77
    s_sub_u32 s38, s38, 1
    s_nop 7
    s_nop 7
    s_sleep 4
    s_mov_b64 exec, vcc
    s_mov_b32 s96, 12058624
    buffer_load_dwordx4 v[216:219], v56, s[16:19], s96 offen offset:0 sc1
    buffer_load_dwordx4 v[220:223], v56, s[16:19], s96 offen offset:256 sc1
    s_mov_b32 s96, 12091392
    buffer_load_dwordx4 v[224:227], v56, s[16:19], s96 offen offset:0 sc1
    buffer_load_dwordx4 v[228:231], v56, s[16:19], s96 offen offset:256 sc1
    s_mov_b32 s96, 12124160
    buffer_load_dwordx4 v[232:235], v56, s[16:19], s96 offen offset:0 sc1
    buffer_load_dwordx4 v[236:239], v56, s[16:19], s96 offen offset:256 sc1
    s_mov_b32 s96, 12156928
    buffer_load_dwordx4 v[240:243], v56, s[16:19], s96 offen offset:0 sc1
    buffer_load_dwordx4 v[244:247], v56, s[16:19], s96 offen offset:256 sc1
    s_mov_b32 s96, 12058624
    buffer_load_dwordx2 v[248:249], v57, s[16:19], s96 offen offset:0 sc1
    buffer_load_dwordx2 v[252:253], v57, s[16:19], s96 offen offset:128 sc1
    s_mov_b32 s96, 12075008
    buffer_load_dwordx2 v[250:251], v57, s[16:19], s96 offen offset:0 sc1
    buffer_load_dwordx2 v[254:255], v57, s[16:19], s96 offen offset:128 sc1
    s_mov_b32 s96, 9437184
    buffer_load_dwordx4 v[208:211], v59, s[16:19], s96 offen sc1
    s_add_u32 s97, s36, 9437184
    buffer_load_dword v212, v61, s[16:19], s97 offen sc1
    s_mov_b64 exec, -1
    s_waitcnt vmcnt(0) lgkmcnt(0)
    s_branch oe_75
rd_79:
    s_cmp_eq_u32 s38, 0
    s_cbranch_scc1 rc_80
    s_sub_u32 s38, s38, 1
    s_nop 7
    s_nop 7
    s_sleep 4
    s_mov_b64 exec, vcc
    s_mov_b32 s96, 12062720
    buffer_load_dwordx4 v[216:219], v56, s[16:19], s96 offen offset:0 sc1
    buffer_load_dwordx4 v[220:223], v56, s[16:19], s96 offen offset:256 sc1
    s_mov_b32 s96, 12095488
    buffer_load_dwordx4 v[224:227], v56, s[16:19], s96 offen offset:0 sc1
    buffer_load_dwordx4 v[228:231], v56, s[16:19], s96 offen offset:256 sc1
    s_mov_b32 s96, 12128256
    buffer_load_dwordx4 v[232:235], v56, s[16:19], s96 offen offset:0 sc1
    buffer_load_dwordx4 v[236:239], v56, s[16:19], s96 offen offset:256 sc1
    s_mov_b32 s96, 12161024
    buffer_load_dwordx4 v[240:243], v56, s[16:19], s96 offen offset:0 sc1
    buffer_load_dwordx4 v[244:247], v56, s[16:19], s96 offen offset:256 sc1
    s_mov_b32 s96, 12060672
    buffer_load_dwordx2 v[248:249], v57, s[16:19], s96 offen offset:0 sc1
    buffer_load_dwordx2 v[252:253], v57, s[16:19], s96 offen offset:128 sc1
    s_mov_b32 s96, 12077056
    buffer_load_dwordx2 v[250:251], v57, s[16:19], s96 offen offset:0 sc1
    buffer_load_dwordx2 v[254:255], v57, s[16:19], s96 offen offset:128 sc1
    s_mov_b32 s96, 9439232
    buffer_load_dwordx4 v[208:211], v59, s[16:19], s96 offen sc1
    s_add_u32 s97, s36, 9439232
    buffer_load_dword v212, v61, s[16:19], s97 offen sc1
    s_mov_b64 exec, -1
    s_waitcnt vmcnt(0) lgkmcnt(0)
    s_branch oe_78
rd_84:
    s_cmp_eq_u32 s38, 0
    s_cbranch_scc1 rc_85
    s_sub_u32 s38, s38, 1
    s_nop 7
    s_nop 7
    s_sleep 4
    s_mov_b64 exec, vcc
    s_lshl_b32 s96, s75, 14
    s_add_u32 s96, s96, 14680064
    s_lshl_b32 s97, s24, 12
    s_add_u32 s97, s97, 3506176
    buffer_load_dwordx4 v[176:179], v62, s[16:19], s96 offen offset:0 sc1
    buffer_load_dwordx4 v[180:183], v62, s[16:19], s96 offen offset:1024 sc1
    buffer_load_dwordx4 v[184:187], v62, s[16:19], s97 offen offset:0 sc1
    buffer_load_dwordx4 v[188:191], v62, s[16:19], s97 offen offset:1024 sc1
    buffer_load_dwordx4 v[192:195], v62, s[16:19], s97 offen offset:2048 sc1
    buffer_load_dwordx4 v[196:199], v62, s[16:19], s97 offen offset:3072 sc1
    s_mov_b64 exec, -1
    s_waitcnt vmcnt(0) lgkmcnt(0)
    s_branch ce_83
rd_87:
    s_cmp_eq_u32 s38, 0
    s_cbranch_scc1 rc_88
    s_sub_u32 s38, s38, 1
    s_nop 7
    s_nop 7
    s_sleep 4
    s_mov_b64 exec, vcc
    s_lshl_b32 s96, s75, 14
    s_add_u32 s96, s96, 14680064
    s_lshl_b32 s97, s24, 12
    s_add_u32 s97, s97, 3510272
    buffer_load_dwordx4 v[248:251], v62, s[16:19], s96 offen offset:2048 sc1
    buffer_load_dwordx4 v[252:255], v62, s[16:19], s96 offen offset:3072 sc1
    buffer_load_dwordx4 v[96:99], v62, s[16:19], s97 offen offset:0 sc1
    buffer_load_dwordx4 v[100:103], v62, s[16:19], s97 offen offset:1024 sc1
    buffer_load_dwordx4 v[104:107], v62, s[16:19], s97 offen offset:2048 sc1
    buffer_load_dwordx4 v[108:111], v62, s[16:19], s97 offen offset:3072 sc1
    s_mov_b64 exec, -1
    s_waitcnt vmcnt(0) lgkmcnt(0)
    s_branch ce_86
L_last:
    s_endpgm
.section .rodata,"a"
.p2align 6
.amdhsa_kernel interleave_layers__sliding_local_dilated__ssm_conv_s4d__prompt_kernel
  .amdhsa_next_free_vgpr 512
  .amdhsa_next_free_sgpr 102
  .amdhsa_accum_offset 256
  .amdhsa_group_segment_fixed_size 0
  .amdhsa_kernarg_size 104
  .amdhsa_user_sgpr_count 2
  .amdhsa_user_sgpr_kernarg_segment_ptr 1
  .amdhsa_system_sgpr_workgroup_id_x 1
.end_amdhsa_kernel
```

```asm
; @launch grid=(256,1,1) block=(256,1,1) lds=163840
.amdgcn_target "amdgcn-amd-amdhsa--gfx950"
.text
.globl interleave_layers__sliding_local_dilated__ssm_conv_s4d__prompt_kernel
.p2align 8
.type interleave_layers__sliding_local_dilated__ssm_conv_s4d__prompt_kernel,@function
interleave_layers__sliding_local_dilated__ssm_conv_s4d__prompt_kernel:
    s_getpc_b64 s[42:43]
L_start:
    s_cmp_ge_u32 s2, 256
    s_cbranch_scc1 L_end
    s_load_dwordx16 s[44:59], s[0:1], 0
    s_load_dwordx8 s[60:67], s[0:1], 64
    s_load_dwordx2 s[68:69], s[0:1], 96
    v_and_b32 v1, 63, v0
    v_lshrrev_b32 v2, 6, v0
    s_nop 0
    v_readfirstlane_b32 s24, v2
    s_bfe_u32 s82, s2, 0x40003
    s_lshl_b32 s82, s82, 13
    v_lshrrev_b32 v159, 2, v0
    v_lshl_add_u32 v159, v159, 7, s82
    v_min_u32 v159, L_last-L_start, v159
    global_load_dword v159, v159, s[42:43]
    s_and_b32 s25, s2, 7
    s_lshr_b32 s26, s2, 3
    s_and_b32 s27, s26, 3
    s_lshr_b32 s28, s26, 4
    s_lshl_b32 s28, s28, 2
    s_add_u32 s3, s27, s28
    s_lshl_b32 s27, s3, 2
    s_lshr_b32 s70, 0x75206431, s27
    s_and_b32 s70, s70, 7
    s_and_b32 s27, s25, 1
    s_lshl_b32 s27, s27, 3
    s_add_u32 s70, s70, s27
    s_bfe_u32 s71, s26, 0x10002
    s_bfe_u32 s28, s26, 0x10003
    s_and_b32 s72, s25, 6
    s_add_u32 s72, s72, s28
    s_and_b32 s73, s26, 7
    s_lshr_b32 s28, s26, 3
    s_lshl_b32 s74, s25, 2
    s_add_u32 s74, s74, s28
    s_mul_i32 s75, s25, 20
    s_add_u32 s75, s75, s26
    s_min_u32 s27, s2, 239
    s_mul_i32 s25, s27, 10923
    s_lshr_b32 s25, s25, 16
    s_mul_i32 s26, s25, 6
    s_sub_u32 s26, s27, s26
    s_mul_i32 s27, s25, 61440
    s_mul_i32 s28, s26, 640
    s_add_u32 s27, s27, s28
    s_lshl_b32 s28, s24, 10
    v_add_u32 v85, 0, v0
    v_mul_u32_u24 v84, 1639, v85
    v_lshrrev_b32 v84, 16, v84
    v_mul_u32_u24 v84, 3200, v84
    v_lshl_add_u32 v85, v85, 4, v84
    v_add_u32 v86, 256, v0
    v_mul_u32_u24 v84, 1639, v86
    v_lshrrev_b32_e64 v84, 16, v84
    v_mul_u32_u24 v84, 3200, v84
    v_lshl_add_u32 v86, v86, 4, v84
    v_add_u32 v87, 512, v0
    v_min_u32 v87, 639, v87
    v_mul_u32_u24 v84, 1639, v87
    v_lshrrev_b32_e64 v84, 16, v84
    v_mul_u32_u24 v84, 3200, v84
    v_lshl_add_u32 v87, v87, 4, v84
    s_mov_b32 s76, 0
    s_mov_b32 s77, 0x80000000
    s_mov_b32 s80, -1
    s_mov_b32 s81, 0
    s_nop 0
    s_mov_b32 s78, 0xfe0000fe
    s_mov_b32 s79, 0xfe0000fe
    s_mov_b32 s6, 2621440
    s_mov_b32 s7, 0x20000
    s_mov_b32 s10, 2457600
    s_mov_b32 s11, 0x20000
    s_mov_b32 s14, 819200
    s_mov_b32 s15, 0x20000
    s_mov_b32 s18, 22061056
    s_mov_b32 s19, 0x20000
    s_mov_b32 s22, 2621440
    s_mov_b32 s23, 0x20000
    s_waitcnt lgkmcnt(0)
    s_mov_b32 s4, s44
    s_and_b32 s5, s45, 0xffff
    s_mov_b32 s8, s46
    s_and_b32 s9, s47, 0xffff
    s_mov_b32 s12, s48
    s_and_b32 s13, s49, 0xffff
    s_mov_b32 s16, s68
    s_and_b32 s17, s69, 0xffff
    s_mov_b32 s20, s64
    s_and_b32 s21, s65, 0xffff
    s_cmp_lg_u32 s2, 255
    s_cbranch_scc1 fz_1
    v_mov_b32 v120, 0
    v_mov_b32 v121, 0
    v_mov_b32 v122, 0
    v_mov_b32 v123, 0
    v_lshlrev_b32 v124, 4, v0
    s_mov_b32 s88, 3538944
    buffer_store_dwordx4 v[120:123], v124, s[16:19], s88 offen sc1
    s_mov_b32 s88, 3543040
    buffer_store_dwordx4 v[120:123], v124, s[16:19], s88 offen sc1
    s_mov_b32 s88, 3547136
    buffer_store_dwordx4 v[120:123], v124, s[16:19], s88 offen sc1
    s_mov_b32 s88, 3555328
    buffer_store_dwordx4 v[120:123], v124, s[16:19], s88 offen sc1
    s_mov_b32 s88, 3559424
    buffer_store_dwordx4 v[120:123], v124, s[16:19], s88 offen sc1
    s_mov_b32 s88, 3563520
    buffer_store_dwordx4 v[120:123], v124, s[16:19], s88 offen sc1
fz_1:
    s_min_u32 s96, s75, 159
    s_lshl_b32 s96, s96, 2
    s_add_u32 s96, s96, s24
    s_mul_i32 s97, s96, 384
    s_lshl_b32 s96, s96, 1
    v_lshl_add_u32 v2, v1, 2, s97
    v_mov_b32 v241, s96
    global_load_dword v232, v2, s[52:53]
    global_load_dword v233, v2, s[54:55]
    global_load_dword v234, v2, s[56:57]
    global_load_dword v235, v2, s[58:59]
    global_load_ushort v240, v241, s[60:61]
    s_add_u32 m0, s28, 134272
    s_nop 0
    buffer_load_dwordx4 v85, s[8:11], s27 offen lds
    s_add_u32 m0, s28, 138368
    s_nop 0
    buffer_load_dwordx4 v86, s[8:11], s27 offen lds
    s_add_u32 m0, s28, 142464
    s_nop 0
    buffer_load_dwordx4 v87, s[8:11], s27 offen lds
    s_lshr_b32 s29, s26, 1
    s_and_b32 s30, s26, 1
    s_lshl_b32 s30, s30, 3
    s_lshl_b32 s31, s25, 10
    s_add_u32 s31, s31, 0
    s_cmp_ge_u32 s2, 240
    s_cselect_b32 s31, 1073741824, s31
    v_bfe_u32 v93, v0, 2, 2
    v_bfe_u32 v92, v0, 1, 1
    v_lshl_add_u32 v92, v92, 3, v93
    v_mul_u32_u24 v92, 640, v92
    v_and_b32 v93, 1, v0
    v_mul_u32_u24 v93, 40, v93
    v_add_u32 v91, v92, v93
    v_add_u32 v91, 134272, v91
    v_lshrrev_b32 v88, 4, v0
    v_add_u32 v88, 0, v88
    v_cmp_gt_u32 vcc, 40, v88
    v_min_u32 v88, 39, v88
    v_mul_u32_u24 v89, 13108, v88
    v_lshrrev_b32 v89, 16, v89
    v_mul_u32_u24 v90, 5, v89
    v_sub_u32_e64 v90, v88, v90
    v_mul_u32_u24 v92, 80, v89
    v_lshl_add_u32 v92, v90, 3, v92
    v_add_u32 v111, v92, v91
    v_add_u32 v89, s30, v89
    v_cmp_eq_u32 s[82:83], 4, v90
    v_mov_b32 v92, s29
    s_nop 0
    v_cndmask_b32 v93, v90, v92, s[82:83]
    v_cndmask_b32 v92, v92, 3, s[82:83]
    v_lshl_add_u32 v89, v89, 2, v93
    v_mul_u32_u24 v89, 40960, v89
    v_lshl_add_u32 v89, v92, 8, v89
    v_and_b32 v92, 15, v0
    v_lshl_add_u32 v89, v92, 4, v89
    v_mov_b32 v92, 1073741824
    v_cndmask_b32 v89, v92, v89, vcc
    v_add_u32 v108, s31, v89
    v_lshrrev_b32 v88, 4, v0
    v_add_u32 v88, 16, v88
    v_cmp_gt_u32 vcc, 40, v88
    v_min_u32 v88, 39, v88
    v_mul_u32_u24 v89, 13108, v88
    v_lshrrev_b32 v89, 16, v89
    v_mul_u32_u24 v90, 5, v89
    v_sub_u32_e64 v90, v88, v90
    v_mul_u32_u24 v92, 80, v89
    v_lshl_add_u32 v92, v90, 3, v92
    v_add_u32 v112, v92, v91
    v_add_u32 v89, s30, v89
    v_cmp_eq_u32 s[82:83], 4, v90
    v_mov_b32 v92, s29
    s_nop 0
    v_cndmask_b32 v93, v90, v92, s[82:83]
    v_cndmask_b32 v92, v92, 3, s[82:83]
    v_lshl_add_u32 v89, v89, 2, v93
    v_mul_u32_u24 v89, 40960, v89
    v_lshl_add_u32 v89, v92, 8, v89
    v_and_b32 v92, 15, v0
    v_lshl_add_u32 v89, v92, 4, v89
    v_mov_b32 v92, 1073741824
    v_cndmask_b32 v89, v92, v89, vcc
    v_add_u32 v109, s31, v89
    v_lshrrev_b32 v88, 4, v0
    v_add_u32 v88, 32, v88
    v_cmp_gt_u32 vcc, 40, v88
    v_min_u32 v88, 39, v88
    v_mul_u32_u24 v89, 13108, v88
    v_lshrrev_b32 v89, 16, v89
    v_mul_u32_u24 v90, 5, v89
    v_sub_u32_e64 v90, v88, v90
    v_mul_u32_u24 v92, 80, v89
    v_lshl_add_u32 v92, v90, 3, v92
    v_add_u32 v113, v92, v91
    v_add_u32 v89, s30, v89
    v_cmp_eq_u32 s[82:83], 4, v90
    v_mov_b32 v92, s29
    s_nop 0
    v_cndmask_b32 v93, v90, v92, s[82:83]
    v_cndmask_b32 v92, v92, 3, s[82:83]
    v_lshl_add_u32 v89, v89, 2, v93
    v_mul_u32_u24 v89, 40960, v89
    v_lshl_add_u32 v89, v92, 8, v89
    v_and_b32 v92, 15, v0
    v_lshl_add_u32 v89, v92, 4, v89
    v_mov_b32 v92, 1073741824
    v_cndmask_b32 v89, v92, v89, vcc
    v_add_u32 v110, s31, v89
    s_mul_i32 s25, s3, 18
    s_lshl_b32 s26, s72, 7
    s_add_u32 s25, s25, s26
    s_add_u32 s25, s25, s71
    s_add_u32 s25, s25, -16
    s_max_i32 s25, s25, 0
    s_mul_i32 s25, s25, 1280
    v_lshrrev_b32_e64 v204, 1, v0
    v_min_u32 v204, 89, v204
    v_mul_u32_u24 v205, 6554, v204
    v_lshrrev_b32_e64 v205, 16, v205
    v_mul_u32_u24 v205, 1280, v205
    v_lshl_add_u32 v204, v204, 7, v205
    buffer_load_dword v204, v204, s[4:7], s25 offen
    s_and_b32 s25, s2, 7
    s_lshl_b32 s86, s25, 7
    s_add_u32 s86, s86, 3538944
    s_lshl_b32 s87, s25, 10
    s_add_u32 s87, s87, 3538944
    s_add_u32 s89, s87, 16384
    v_cmp_gt_u32 s[50:51], 8, v0
    v_cmp_eq_u32 vcc, 0, v0
    v_lshlrev_b32 v4, 7, v1
    v_mov_b32 v6, 1073741824
    v_cndmask_b32 v4, v6, v4, s[50:51]
    v_cndmask_b32 v6, v6, 0, vcc
    v_mov_b32 v5, 0
    s_cmp_lg_u32 s2, 255
    s_cbranch_scc1 fr_2
    v_mov_b32 v2, 1
    s_waitcnt vmcnt(9)
    s_barrier
    s_mov_b64 exec, 1
    global_store_dword v5, v2, s[66:67] sc1
    s_mov_b64 exec, -1
fr_2:
    v_mov_b32 v140, 0
    v_mov_b32_e64 v141, 0
    v_mov_b32 v142, 0x3f803f80
    v_mov_b32 v143, 0x3f803f80
    v_lshlrev_b32_e64 v144, 3, v0
    v_add_u32 v144, 155648, v144
    ds_write_b64 v144, v[140:141]
    ds_write_b64 v144, v[140:141] offset:512
    ds_write_b64 v144, v[142:143] offset:2560
    ds_write_b64 v144, v[142:143] offset:3072
    v_and_b32 v50, 31, v1
    v_lshrrev_b32 v51, 5, v1
    v_mul_u32_u24 v52, 40, v50
    v_mul_u32_u24 v53, 3200, v51
    v_add_u32 v53, v52, v53
    s_lshl_b32 s25, s24, 3
    s_add_u32 s25, s25, 320
    v_add_u32 v38, s25, v53
    s_mul_i32 s25, s24, 6400
    s_add_u32 s25, s25, 352
    v_add_u32 v39, s25, v53
    s_lshl_b32 s31, s71, 12
    v_lshl_add_u32 v47, v50, 3, s31
    v_bfe_u32 v52, v1, 2, 1
    v_and_b32 v53, 3, v1
    v_lshlrev_b32 v54, 13, v52
    v_lshl_add_u32 v54, v53, 3, v54
    v_add_u32_e64 v48, s31, v54
    v_bfe_u32 v54, v1, 4, 1
    v_lshl_add_u32 v52, v54, 1, v52
    v_mul_u32_u24 v52, 40, v52
    v_add_u32 v52, v52, v53
    v_mul_u32_u24_e64 v52, 40, v52
    v_bfe_u32 v53, v1, 3, 1
    v_cmp_eq_u32 s[82:83], v53, v54
    v_lshl_add_u32 v53, v53, 1, v51
    v_cmp_eq_u32 vcc, 3, v53
    v_mov_b32 v54, s24
    s_nop 0
    v_cndmask_b32 v53, v53, v54, vcc
    v_cndmask_b32 v54, v54, 4, vcc
    v_mul_u32_u24 v53, 6400, v53
    v_lshl_add_u32 v52, v54, 3, v52
    v_add_u32_e64 v52, v52, v53
    v_add_u32 v40, 160, v52
    v_mov_b32 v52, 19584
    v_mov_b32 v53, 128
    v_cndmask_b32 v49, v53, v52, s[78:79]
    v_and_b32 v50, 15, v1
    v_lshrrev_b32 v51, 4, v1
    s_and_b32 s25, s24, 1
    s_and_b32 s26, s24, 2
    s_mul_i32 s27, s25, 3200
    s_mul_i32 s28, s26, 320
    s_add_u32 s27, s27, s28
    s_add_u32 s27, s27, 0
    v_and_b32 v52, 1, v1
    v_mul_u32_u24 v52, 1600, v52
    v_lshrrev_b32 v53, 1, v50
    v_mul_u32_u24_e64 v54, 40, v53
    v_add3_u32 v52, v52, v54, s27
    v_lshl_add_u32 v41, v51, 3, v52
    v_add_u32_e64 v42, 32, v52
    v_bfe_u32 v52, v1, 2, 1
    v_mul_u32_u24 v52, 1600, v52
    v_lshrrev_b32 v54, 3, v1
    v_mul_u32_u24 v54, 40, v54
    v_add3_u32 v52, v52, v54, s27
    v_add_u32 v52, 12800, v52
    v_and_b32 v54, 3, v1
    v_lshl_add_u32 v43, v54, 3, v52
    v_add_u32 v52, 32, v52
    v_cmp_eq_u32 vcc, 0, v54
    v_mov_b32 v54, 158208
    s_nop 0
    v_cndmask_b32 v44, v54, v52, vcc
    v_and_b32 v52, 1, v51
    v_add_u32 v52, s26, v52
    v_lshrrev_b32 v54, 2, v50
    v_lshl_add_u32 v52, v52, 2, v54
    v_and_b32 v53, 1, v53
    v_lshl_add_u32 v52, v53, 4, v52
    v_and_b32 v53, 1, v50
    v_lshl_add_u32 v52, v53, 10, v52
    s_lshl_b32 s30, s70, 1
    s_add_u32 s30, s30, s25
    s_lshl_b32 s29, s30, 3
    s_add_u32 s29, s29, s71
    s_lshl_b32 s29, s29, 13
    v_lshrrev_b32 v53, 1, v51
    v_lshlrev_b32 v53, 15, v53
    v_lshl_add_u32 v53, v52, 4, v53
    v_add_u32_e64 v45, s29, v53
    s_lshl_b32 s29, s30, 2
    s_add_u32 s29, s29, s71
    s_lshl_b32 s29, s29, 12
    s_add_u32 s29, s29, 2097152
    v_lshl_add_u32 v46, v52, 3, s29
    s_or_b32 s29, s26, s72
    s_cmp_eq_u32 s29, 0
    s_cselect_b64 s[90:91], -1, 0
    v_lshlrev_b32 v52, 2, v51
    v_sub_u32 v52, v50, v52
    v_mov_b32 v55, 0xf149f2ca
    v_subrev_u32 v53, 0, v52
    v_cmp_lt_u32 vcc, 7, v53
    s_nop 1
    v_cndmask_b32 v28, 0, v55, vcc
    v_cmp_lt_i32 vcc, -9, v53
    s_nop 1
    v_cndmask_b32 v32, 0, v55, vcc
    v_cmp_le_i32 vcc, 0, v53
    v_mov_b32 v54, 0xffff
    s_nop 0
    v_cndmask_b32 v54, 0, v54, vcc
    v_mov_b32 v36, v54
    v_subrev_u32 v53, 1, v52
    v_cmp_lt_u32 vcc, 7, v53
    s_nop 1
    v_cndmask_b32 v29, 0, v55, vcc
    v_cmp_lt_i32 vcc, -9, v53
    s_nop 1
    v_cndmask_b32 v33, 0, v55, vcc
    v_cmp_le_i32 vcc, 0, v53
    v_mov_b32 v54, 0xffff0000
    s_nop 0
    v_cndmask_b32 v54, 0, v54, vcc
    v_or_b32 v36, v36, v54
    v_subrev_u32 v53, 2, v52
    v_cmp_lt_u32 vcc, 7, v53
    s_nop 1
    v_cndmask_b32 v30, 0, v55, vcc
    v_cmp_lt_i32 vcc, -9, v53
    s_nop 1
    v_cndmask_b32 v34, 0, v55, vcc
    v_cmp_le_i32 vcc, 0, v53
    v_mov_b32 v54, 0xffff
    s_nop 0
    v_cndmask_b32 v54, 0, v54, vcc
    v_mov_b32 v37, v54
    v_subrev_u32 v53, 3, v52
    v_cmp_lt_u32 vcc, 7, v53
    s_nop 1
    v_cndmask_b32 v31, 0, v55, vcc
    v_cmp_lt_i32 vcc, -9, v53
    s_nop 1
    v_cndmask_b32 v35, 0, v55, vcc
    v_cmp_le_i32 vcc, 0, v53
    v_mov_b32 v54, 0xffff0000
    s_nop 0
    v_cndmask_b32 v54, 0, v54, vcc
    v_or_b32 v37, v37, v54
    v_and_b32 v62, 15, v1
    v_lshrrev_b32 v63, 4, v1
    s_and_b32 s25, s74, 3
    s_lshr_b32 s26, s74, 2
    s_lshl_b32 s27, s24, 6
    s_add_u32 s27, s27, s25
    s_lshl_b32 s27, s27, 13
    s_lshl_b32 s28, s26, 9
    s_add_u32 s27, s27, s28
    v_lshl_add_u32 v64, v63, 17, s27
    v_lshl_add_u32 v56, v62, 4, v64
    s_lshl_b32 s27, s24, 5
    s_add_u32 s27, s27, s25
    s_lshl_b32 s27, s27, 12
    s_lshl_b32 s28, s26, 8
    s_add_u32 s27, s27, s28
    s_add_u32 s27, s27, 2097152
    v_lshl_add_u32 v64, v63, 15, s27
    v_lshl_add_u32 v57, v62, 3, v64
    v_lshlrev_b32 v58, 4, v1
    s_lshl_b32 s29, s25, 12
    s_add_u32 s29, s29, s28
    v_lshl_add_u32 v64, v62, 4, s29
    v_lshl_add_u32 v61, v63, 2, v64
    s_mul_i32 s30, s73, 20
    s_lshl_b32 s31, s24, 2
    s_add_u32 s30, s30, s31
    s_lshl_b32 s31, s30, 14
    v_lshl_add_u32 v64, v63, 14, v64
    v_add_u32 v59, s31, v64
    s_lshl_b32 s31, s26, 7
    s_add_u32 s31, s31, s25
    s_mul_i32 s31, s31, 1280
    s_lshl_b32 s30, s30, 3
    s_add_u32 s31, s31, s30
    v_mul_u32_u24 v64, 10240, v62
    v_lshl_add_u32 v64, v63, 3, v64
    v_add_u32_e64 v60, s31, v64
    s_lshl_b32 s25, s24, 12
    v_lshl_add_u32 v62, v1, 4, s25
    s_mul_i32 s25, s24, 1216
    s_add_u32 s25, s25, 192
    v_lshl_add_u32 v63, v1, 2, s25
    s_mul_i32 s25, s24, 4864
    s_add_u32 s25, s25, 80
    v_and_b32_e64 v70, 3, v1
    v_mul_u32_u24 v70, 1216, v70
    v_bfe_u32 v71, v1, 2, 3
    v_lshl_add_u32 v70, v71, 4, v70
    v_lshrrev_b32 v71, 5, v1
    v_lshl_add_u32 v70, v71, 4, v70
    v_add_u32 v64, s25, v70
    s_mul_i32 s25, s24, 4160
    s_add_u32 s25, s25, 134368
    v_lshlrev_b32 v71, 6, v71
    v_sub_u32 v71, s25, v71
    v_bfe_u32 v70, v1, 4, 1
    v_lshl_add_u32 v71, v70, 5, v71
    v_and_b32_e64 v70, 3, v1
    v_lshl_add_u32 v71, v70, 3, v71
    v_bfe_u32 v70, v1, 2, 2
    v_lshlrev_b32 v70, 3, v70
    v_sub_u32 v65, v71, v70
    s_mul_i32 s25, s24, 4224
    s_add_u32 s25, s25, 19456
    v_and_b32 v70, 3, v1
    v_mul_u32_u24 v70, 1056, v70
    v_and_b32 v71, 60, v1
    v_add3_u32 v66, v70, v71, s25
    s_mul_i32 s25, s24, 1056
    s_add_u32 s25, s25, 19456
    v_lshl_add_u32 v67, v1, 3, s25
    s_mul_i32 s25, s24, 1280
    s_lshl_b32 s26, s75, 3
    s_add_u32 s25, s25, s26
    v_mul_u32_u24 v70, 10240, v1
    v_add_u32 v68, s25, v70
    s_and_b32 s25, s24, 1
    s_lshl_b32 s25, s25, 6
    s_and_b32 s26, s24, 2
    s_add_u32 s25, s25, s26
    s_mul_i32 s25, s25, 1280
    v_lshrrev_b32 v140, 4, v1
    v_and_b32 v141, 15, v1
    v_xor_b32 v141, v140, v141
    v_lshlrev_b32_e64 v141, 4, v141
    v_mul_u32_u24 v142, 5120, v140
    v_add3_u32 v73, v141, v142, s25
    s_and_b32 s25, s24, 1
    s_lshl_b32 s25, s25, 3
    s_add_u32 s25, s25, s26
    s_mul_i32 s25, s25, 1280
    v_add3_u32 v77, v141, v142, s25
    v_lshrrev_b32 v141, 5, v1
    v_and_b32 v140, 3, v1
    v_xor_b32 v142, v140, v141
    v_lshlrev_b32_e64 v142, 4, v142
    v_lshl_add_u32 v142, v140, 8, v142
    v_bfe_u32 v140, v1, 2, 3
    v_mul_u32_u24 v140, 1088, v140
    v_add_u32 v78, v140, v142
    v_and_b32 v140, 1, v1
    v_xor_b32 v142, v140, v141
    v_lshlrev_b32 v142, 4, v142
    v_lshl_add_u32 v142, v140, 8, v142
    v_bfe_u32 v140, v1, 1, 2
    v_mul_u32_u24 v140, 544, v140
    v_add_u32_e64 v142, v140, v142
    v_add_u32 v74, 19392, v73
    v_add_u32 v75, 38784, v73
    v_add_u32 v76, 58176, v73
    v_add_u32 v142, 53760, v142
    v_and_b32 v140, 31, v1
    v_cmp_eq_u32 vcc, 0, v140
    v_cmp_eq_u32 s[82:83], 24, v140
    s_nop 0
    s_or_b64 vcc, vcc, s[82:83]
    v_mov_b32 v140, 155776
    v_mov_b32 v141, 158400
    v_cndmask_b32_e64 v140, v140, v141, vcc
    v_cndmask_b32 v79, v140, v142, s[78:79]
    v_bfe_u32 v201, v1, 3, 2
    v_and_b32 v202, s24, v201
    v_cmp_eq_u32 vcc, 3, v202
    v_lshrrev_b32 v202, 5, v1
    v_lshl_add_u32 v201, v201, 1, v202
    v_and_b32 v202, 7, v1
    v_lshl_add_u32 v201, v201, 3, v202
    v_lshlrev_b32 v200, 4, v201
    v_mov_b32 v201, 1073741824
    v_cndmask_b32 v200, v200, v201, vcc
    s_lshl_b32 s101, s70, 2
    s_add_u32 s101, s101, s24
    s_mul_i32 s101, s101, 40960
    s_add_u32 s101, s101, 0
    s_lshl_b32 s25, s72, 5
    s_add_u32 s25, s25, 0
    s_sub_u32 s26, s25, 4
    s_max_i32 s26, s26, 0
    s_mul_i32 s27, s71, 1280
    s_mul_i32 s99, s25, 5120
    s_mul_i32 s100, s26, 5120
    s_mul_i32 s92, s24, 4352
    s_mul_i32 s93, s24, 544
    s_add_u32 s99, s99, s27
    s_add_u32 s100, s100, s27
    s_mov_b32 s38, 0x10000
    s_mov_b32 s39, 0x1000
    s_cmp_ge_u32 s2, 160
    s_cbranch_scc1 nc_3
    s_mul_i32 s37, s24, 8704
    s_add_u32 s25, s37, 0
    s_add_u32 s37, s37, 0
    s_mov_b32 m0, s37
    v_and_b32 v199, 31, v1
    v_mul_u32_u24 v199, 272, v199
    v_lshrrev_b32 v215, 5, v1
    v_lshl_add_u32 v199, v215, 4, v199
    v_add_u32 v252, s25, v199
    s_waitcnt vmcnt(4)
    v_lshlrev_b32 v253, 16, v240
    v_mul_f32 v253, 0x3fb8aa3b, v253
    v_exp_f32 v253, v253
    s_nop 0
    v_cvt_pk_bf16_f32 v253, v253, v253
    v_lshlrev_b32 v253, 16, v253
    v_lshlrev_b32 v199, 16, v232
    v_mul_f32 v199, 0x3fb8aa3b, v199
    v_exp_f32 v199, v199
    v_lshlrev_b32 v255, 16, v233
    v_mul_f32 v255, v255, v253
    v_mul_f32 v255, 0x3e22f983, v255
    v_cvt_pk_bf16_f32 v199, v199, v199
    v_lshlrev_b32 v199, 16, v199
    v_mul_f32_e64 v254, v199, v253
    v_mul_f32 v254, 0xbfb8aa3b, v254
    v_mul_f32 v182, 0x41000000, v254
    v_mul_f32 v185, 0x41000000, v255
    v_mul_f32 v184, 0x43800000, v254
    v_mul_f32 v189, 0x43800000, v255
    v_fract_f32 v185, v185
    v_fract_f32 v188, v255
    s_waitcnt vmcnt(1)
    s_barrier
    ds_read_b64_tr_b16 v[96:97], v111
    ds_read_b64_tr_b16 v[98:99], v111 offset:2560
    ds_read_b64_tr_b16 v[100:101], v112
    ds_read_b64_tr_b16 v[102:103], v112 offset:2560
    ds_read_b64_tr_b16 v[104:105], v113
    ds_read_b64_tr_b16 v[106:107], v113 offset:2560
    s_waitcnt lgkmcnt(4)
    buffer_store_dwordx4 v[96:99], v108, s[16:19], 0 offen sc1
    s_waitcnt lgkmcnt(2)
    buffer_store_dwordx4 v[100:103], v109, s[16:19], 0 offen sc1
    s_waitcnt lgkmcnt(0)
    buffer_store_dwordx4 v[104:107], v110, s[16:19], 0 offen sc1
    global_load_dword v7, v5, s[66:67] sc1
    v_fract_f32 v189, v189
    v_exp_f32 v182, v182
    v_exp_f32 v183, v254
    v_exp_f32 v184, v184
    v_cos_f32 v186, v185
    v_sin_f32 v187, v185
    v_cos_f32 v180, v188
    v_sin_f32 v181, v188
    v_cos_f32 v190, v189
    v_sin_f32 v191, v189
    v_lshlrev_b32 v192, 16, v234
    v_lshlrev_b32 v193, 16, v235
    v_add_f32 v199, v253, v253
    v_mul_f32 v192, v192, v199
    v_mul_f32 v193, v193, v199
    v_mul_f32 v186, v186, v182
    v_mul_f32 v187, v187, v182
    v_mul_f32 v180, v180, v183
    v_mul_f32 v181, v181, v183
    v_mul_f32 v190, v190, v184
    v_mul_f32 v191, v191, v184
    v_mov_b32 v242, 0x3f80
    v_cvt_pk_bf16_f32 v243, v186, v187
    v_pk_mul_f32 v[194:195], v[186:187], v[186:187] op_sel:[0,0] op_sel_hi:[0,1]
    v_pk_fma_f32 v[172:173], v[186:187], v[186:187], v[194:195] op_sel:[1,1,0] op_sel_hi:[1,0,1] neg_lo:[0,1,0]
    v_cvt_pk_bf16_f32 v244, v172, v173
    v_pk_mul_f32 v[194:195], v[172:173], v[186:187] op_sel:[0,0] op_sel_hi:[0,1]
    v_pk_fma_f32 v[174:175], v[172:173], v[186:187], v[194:195] op_sel:[1,1,0] op_sel_hi:[1,0,1] neg_lo:[0,1,0]
    v_cvt_pk_bf16_f32 v245, v174, v175
    v_pk_mul_f32 v[194:195], v[174:175], v[186:187] op_sel:[0,0] op_sel_hi:[0,1]
    v_pk_fma_f32 v[172:173], v[174:175], v[186:187], v[194:195] op_sel:[1,1,0] op_sel_hi:[1,0,1] neg_lo:[0,1,0]
    v_cvt_pk_bf16_f32 v246, v172, v173
    v_pk_mul_f32 v[194:195], v[172:173], v[186:187] op_sel:[0,0] op_sel_hi:[0,1]
    v_pk_fma_f32 v[174:175], v[172:173], v[186:187], v[194:195] op_sel:[1,1,0] op_sel_hi:[1,0,1] neg_lo:[0,1,0]
    v_cvt_pk_bf16_f32 v247, v174, v175
    v_pk_mul_f32 v[194:195], v[174:175], v[186:187] op_sel:[0,0] op_sel_hi:[0,1]
    v_pk_fma_f32 v[172:173], v[174:175], v[186:187], v[194:195] op_sel:[1,1,0] op_sel_hi:[1,0,1] neg_lo:[0,1,0]
    v_cvt_pk_bf16_f32 v248, v172, v173
    v_pk_mul_f32 v[194:195], v[172:173], v[186:187] op_sel:[0,0] op_sel_hi:[0,1]
    v_pk_fma_f32 v[174:175], v[172:173], v[186:187], v[194:195] op_sel:[1,1,0] op_sel_hi:[1,0,1] neg_lo:[0,1,0]
    s_min_u32 s96, s75, 159
    s_lshl_b32 s96, s96, 2
    s_add_u32 s96, s96, s24
    s_mul_i32 s97, s96, 384
    s_lshl_b32 s96, s96, 1
    v_lshl_add_u32 v2, v1, 1, s97
    v_mov_b32 v241, s96
    global_load_ushort v236, v2, s[52:53] offset:256
    global_load_ushort v237, v2, s[54:55] offset:256
    global_load_ushort v238, v2, s[56:57] offset:256
    global_load_ushort v239, v2, s[58:59] offset:256
    global_load_ushort v241, v241, s[62:63]
    v_cvt_pk_bf16_f32 v249, v174, v175
    v_pk_mul_f32 v[194:195], v[174:175], v[186:187] op_sel:[0,0] op_sel_hi:[0,1]
    v_pk_fma_f32 v[172:173], v[174:175], v[186:187], v[194:195] op_sel:[1,1,0] op_sel_hi:[1,0,1] neg_lo:[0,1,0]
    v_cvt_pk_bf16_f32 v250, v172, v173
    v_pk_mul_f32 v[194:195], v[172:173], v[186:187] op_sel:[0,0] op_sel_hi:[0,1]
    v_pk_fma_f32 v[174:175], v[172:173], v[186:187], v[194:195] op_sel:[1,1,0] op_sel_hi:[1,0,1] neg_lo:[0,1,0]
    v_cvt_pk_bf16_f32 v251, v174, v175
    ds_write_addtid_b32 v242 offset:0
    ds_write_addtid_b32 v243 offset:272
    ds_write_addtid_b32 v244 offset:544
    ds_write_addtid_b32 v245 offset:816
    ds_write_addtid_b32 v246 offset:1088
    ds_write_addtid_b32 v247 offset:1360
    ds_write_addtid_b32 v248 offset:1632
    ds_write_addtid_b32 v249 offset:1904
    ds_write_addtid_b32 v250 offset:2176
    ds_write_addtid_b32 v251 offset:2448
    v_pk_mul_f32 v[194:195], v[174:175], v[186:187] op_sel:[0,0] op_sel_hi:[0,1]
    v_pk_fma_f32 v[172:173], v[174:175], v[186:187], v[194:195] op_sel:[1,1,0] op_sel_hi:[1,0,1] neg_lo:[0,1,0]
    v_cvt_pk_bf16_f32 v242, v172, v173
    v_pk_mul_f32 v[194:195], v[172:173], v[186:187] op_sel:[0,0] op_sel_hi:[0,1]
    v_pk_fma_f32 v[174:175], v[172:173], v[186:187], v[194:195] op_sel:[1,1,0] op_sel_hi:[1,0,1] neg_lo:[0,1,0]
    v_cvt_pk_bf16_f32 v243, v174, v175
    v_pk_mul_f32 v[194:195], v[174:175], v[186:187] op_sel:[0,0] op_sel_hi:[0,1]
    v_pk_fma_f32 v[172:173], v[174:175], v[186:187], v[194:195] op_sel:[1,1,0] op_sel_hi:[1,0,1] neg_lo:[0,1,0]
    v_cvt_pk_bf16_f32 v244, v172, v173
    v_pk_mul_f32 v[194:195], v[172:173], v[186:187] op_sel:[0,0] op_sel_hi:[0,1]
    v_pk_fma_f32 v[174:175], v[172:173], v[186:187], v[194:195] op_sel:[1,1,0] op_sel_hi:[1,0,1] neg_lo:[0,1,0]
    v_cvt_pk_bf16_f32 v245, v174, v175
    v_pk_mul_f32 v[194:195], v[174:175], v[186:187] op_sel:[0,0] op_sel_hi:[0,1]
    v_pk_fma_f32 v[172:173], v[174:175], v[186:187], v[194:195] op_sel:[1,1,0] op_sel_hi:[1,0,1] neg_lo:[0,1,0]
    v_cvt_pk_bf16_f32 v246, v172, v173
    v_pk_mul_f32 v[194:195], v[172:173], v[186:187] op_sel:[0,0] op_sel_hi:[0,1]
    v_pk_fma_f32 v[174:175], v[172:173], v[186:187], v[194:195] op_sel:[1,1,0] op_sel_hi:[1,0,1] neg_lo:[0,1,0]
    v_cvt_pk_bf16_f32 v247, v174, v175
    v_pk_mul_f32 v[194:195], v[174:175], v[186:187] op_sel:[0,0] op_sel_hi:[0,1]
    v_pk_fma_f32 v[172:173], v[174:175], v[186:187], v[194:195] op_sel:[1,1,0] op_sel_hi:[1,0,1] neg_lo:[0,1,0]
    v_cvt_pk_bf16_f32 v248, v172, v173
    v_pk_mul_f32 v[194:195], v[172:173], v[186:187] op_sel:[0,0] op_sel_hi:[0,1]
    v_pk_fma_f32 v[174:175], v[172:173], v[186:187], v[194:195] op_sel:[1,1,0] op_sel_hi:[1,0,1] neg_lo:[0,1,0]
    v_lshrrev_b32 v132, 5, v0
    v_and_b32 v133, 31, v0
    v_mul_u32_u24 v132, 1280, v132
    v_lshl_add_u32 v134, v133, 4, v132
    v_mov_b32 v135, 1073741824
    v_cmp_gt_u32 vcc, 16, v133
    s_mul_i32 s96, s2, 10240
    buffer_load_dwordx4 v[120:123], v134, s[4:7], s96 offen
    v_cndmask_b32_e64 v135, v135, v134, vcc
    buffer_load_dwordx4 v[124:127], v134, s[4:7], s96 offen offset:512
    buffer_load_dwordx4 v[128:131], v135, s[4:7], s96 offen offset:1024
    v_cvt_pk_bf16_f32 v249, v174, v175
    v_pk_mul_f32 v[194:195], v[174:175], v[186:187] op_sel:[0,0] op_sel_hi:[0,1]
    v_pk_fma_f32 v[172:173], v[174:175], v[186:187], v[194:195] op_sel:[1,1,0] op_sel_hi:[1,0,1] neg_lo:[0,1,0]
    v_cvt_pk_bf16_f32 v250, v172, v173
    v_pk_mul_f32 v[194:195], v[172:173], v[186:187] op_sel:[0,0] op_sel_hi:[0,1]
    v_pk_fma_f32 v[174:175], v[172:173], v[186:187], v[194:195] op_sel:[1,1,0] op_sel_hi:[1,0,1] neg_lo:[0,1,0]
    v_cvt_pk_bf16_f32 v251, v174, v175
    ds_write_addtid_b32 v242 offset:2720
    ds_write_addtid_b32 v243 offset:2992
    ds_write_addtid_b32 v244 offset:3264
    ds_write_addtid_b32 v245 offset:3536
    ds_write_addtid_b32 v246 offset:3808
    ds_write_addtid_b32 v247 offset:4080
    ds_write_addtid_b32 v248 offset:4352
    ds_write_addtid_b32 v249 offset:4624
    ds_write_addtid_b32 v250 offset:4896
    ds_write_addtid_b32 v251 offset:5168
    v_pk_mul_f32 v[194:195], v[174:175], v[186:187] op_sel:[0,0] op_sel_hi:[0,1]
    v_pk_fma_f32 v[172:173], v[174:175], v[186:187], v[194:195] op_sel:[1,1,0] op_sel_hi:[1,0,1] neg_lo:[0,1,0]
    v_cvt_pk_bf16_f32 v242, v172, v173
    v_pk_mul_f32 v[194:195], v[172:173], v[186:187] op_sel:[0,0] op_sel_hi:[0,1]
    v_pk_fma_f32 v[174:175], v[172:173], v[186:187], v[194:195] op_sel:[1,1,0] op_sel_hi:[1,0,1] neg_lo:[0,1,0]
    v_cvt_pk_bf16_f32 v243, v174, v175
    v_pk_mul_f32 v[194:195], v[174:175], v[186:187] op_sel:[0,0] op_sel_hi:[0,1]
    v_pk_fma_f32 v[172:173], v[174:175], v[186:187], v[194:195] op_sel:[1,1,0] op_sel_hi:[1,0,1] neg_lo:[0,1,0]
    v_cvt_pk_bf16_f32 v244, v172, v173
    v_pk_mul_f32 v[194:195], v[172:173], v[186:187] op_sel:[0,0] op_sel_hi:[0,1]
    v_pk_fma_f32 v[174:175], v[172:173], v[186:187], v[194:195] op_sel:[1,1,0] op_sel_hi:[1,0,1] neg_lo:[0,1,0]
    v_cvt_pk_bf16_f32 v245, v174, v175
    v_pk_mul_f32 v[194:195], v[174:175], v[186:187] op_sel:[0,0] op_sel_hi:[0,1]
    v_pk_fma_f32 v[172:173], v[174:175], v[186:187], v[194:195] op_sel:[1,1,0] op_sel_hi:[1,0,1] neg_lo:[0,1,0]
    v_cvt_pk_bf16_f32 v246, v172, v173
    v_pk_mul_f32 v[194:195], v[172:173], v[186:187] op_sel:[0,0] op_sel_hi:[0,1]
    v_pk_fma_f32 v[174:175], v[172:173], v[186:187], v[194:195] op_sel:[1,1,0] op_sel_hi:[1,0,1] neg_lo:[0,1,0]
    v_cvt_pk_bf16_f32 v247, v174, v175
    v_pk_mul_f32 v[194:195], v[174:175], v[186:187] op_sel:[0,0] op_sel_hi:[0,1]
    v_pk_fma_f32 v[172:173], v[174:175], v[186:187], v[194:195] op_sel:[1,1,0] op_sel_hi:[1,0,1] neg_lo:[0,1,0]
    v_cvt_pk_bf16_f32 v248, v172, v173
    v_pk_mul_f32 v[194:195], v[172:173], v[186:187] op_sel:[0,0] op_sel_hi:[0,1]
    v_pk_fma_f32 v[174:175], v[172:173], v[186:187], v[194:195] op_sel:[1,1,0] op_sel_hi:[1,0,1] neg_lo:[0,1,0]
    v_mov_b32 v140, 1073741824
    v_lshlrev_b32 v141, 2, v0
    v_cmp_gt_u32 vcc, 64, v0
    s_nop 1
    v_cndmask_b32 v141, v140, v141, vcc
    v_mov_b32_e64 v140, 0
    s_lshl_b32 s97, s2, 8
    s_add_u32 s97, s97, 3473408
    buffer_store_dword v140, v141, s[16:19], s97 offen sc1
    v_cvt_pk_bf16_f32 v249, v174, v175
    v_pk_mul_f32 v[194:195], v[174:175], v[186:187] op_sel:[0,0] op_sel_hi:[0,1]
    v_pk_fma_f32 v[172:173], v[174:175], v[186:187], v[194:195] op_sel:[1,1,0] op_sel_hi:[1,0,1] neg_lo:[0,1,0]
    v_cvt_pk_bf16_f32 v250, v172, v173
    v_pk_mul_f32 v[194:195], v[172:173], v[186:187] op_sel:[0,0] op_sel_hi:[0,1]
    v_pk_fma_f32 v[174:175], v[172:173], v[186:187], v[194:195] op_sel:[1,1,0] op_sel_hi:[1,0,1] neg_lo:[0,1,0]
    v_cvt_pk_bf16_f32 v251, v174, v175
    ds_write_addtid_b32 v242 offset:5440
    ds_write_addtid_b32 v243 offset:5712
    ds_write_addtid_b32 v244 offset:5984
    ds_write_addtid_b32 v245 offset:6256
    ds_write_addtid_b32 v246 offset:6528
    ds_write_addtid_b32 v247 offset:6800
    ds_write_addtid_b32 v248 offset:7072
    ds_write_addtid_b32 v249 offset:7344
    ds_write_addtid_b32 v250 offset:7616
    ds_write_addtid_b32 v251 offset:7888
    v_pk_mul_f32 v[194:195], v[174:175], v[186:187] op_sel:[0,0] op_sel_hi:[0,1]
    v_pk_fma_f32 v[172:173], v[174:175], v[186:187], v[194:195] op_sel:[1,1,0] op_sel_hi:[1,0,1] neg_lo:[0,1,0]
    v_cvt_pk_bf16_f32 v242, v172, v173
    v_pk_mul_f32 v[194:195], v[172:173], v[186:187] op_sel:[0,0] op_sel_hi:[0,1]
    v_pk_fma_f32 v[174:175], v[172:173], v[186:187], v[194:195] op_sel:[1,1,0] op_sel_hi:[1,0,1] neg_lo:[0,1,0]
    v_cvt_pk_bf16_f32 v243, v174, v175
    ds_write_addtid_b32 v242 offset:8160
    ds_write_addtid_b32 v243 offset:8432
    ds_read_b128 a[160:163], v252 offset:0
    ds_read_b128 a[164:167], v252 offset:32
    ds_read_b128 a[168:171], v252 offset:64
    ds_read_b128 a[172:175], v252 offset:96
    ds_read_b128 a[176:179], v252 offset:128
    ds_read_b128 a[180:183], v252 offset:160
    ds_read_b128 a[184:187], v252 offset:192
    ds_read_b128 a[188:191], v252 offset:224
    v_pk_mul_f32 v[194:195], v[180:181], v[180:181] op_sel:[0,0] op_sel_hi:[0,1]
    v_pk_fma_f32 v[182:183], v[180:181], v[180:181], v[194:195] op_sel:[1,1,0] op_sel_hi:[1,0,1] neg_lo:[0,1,0]
    v_pk_mul_f32 v[194:195], v[182:183], v[182:183] op_sel:[0,0] op_sel_hi:[0,1]
    v_pk_fma_f32 v[184:185], v[182:183], v[182:183], v[194:195] op_sel:[1,1,0] op_sel_hi:[1,0,1] neg_lo:[0,1,0]
    v_cvt_pk_bf16_f32 v242, v192, -v193
    v_pk_mul_f32 v[194:195], v[192:193], v[180:181] op_sel:[0,0] op_sel_hi:[0,1]
    v_pk_fma_f32 v[174:175], v[192:193], v[180:181], v[194:195] op_sel:[1,1,0] op_sel_hi:[1,0,1] neg_lo:[0,1,0]
    v_mov_b32 v142, 1073741824
    v_lshlrev_b32 v143, 2, v0
    v_cmp_gt_u32 vcc, 16, v0
    s_nop 1
    v_cndmask_b32 v143, v142, v143, vcc
    v_mov_b32_e64 v142, -1
    s_lshl_b32 s97, s2, 6
    s_add_u32 s97, s97, 3457024
    buffer_store_dword v142, v143, s[16:19], s97 offen sc1
    v_cvt_pk_bf16_f32 v243, v174, -v175
    v_pk_mul_f32 v[194:195], v[174:175], v[180:181] op_sel:[0,0] op_sel_hi:[0,1]
    v_pk_fma_f32 v[172:173], v[174:175], v[180:181], v[194:195] op_sel:[1,1,0] op_sel_hi:[1,0,1] neg_lo:[0,1,0]
    v_cvt_pk_bf16_f32 v244, v172, -v173
    v_pk_mul_f32 v[194:195], v[172:173], v[180:181] op_sel:[0,0] op_sel_hi:[0,1]
    v_pk_fma_f32 v[174:175], v[172:173], v[180:181], v[194:195] op_sel:[1,1,0] op_sel_hi:[1,0,1] neg_lo:[0,1,0]
    v_cvt_pk_bf16_f32 v245, v174, -v175
    v_pk_mul_f32 v[194:195], v[174:175], v[180:181] op_sel:[0,0] op_sel_hi:[0,1]
    v_pk_fma_f32 v[172:173], v[174:175], v[180:181], v[194:195] op_sel:[1,1,0] op_sel_hi:[1,0,1] neg_lo:[0,1,0]
    v_cvt_pk_bf16_f32 v246, v172, -v173
    v_pk_mul_f32 v[194:195], v[172:173], v[180:181] op_sel:[0,0] op_sel_hi:[0,1]
    v_pk_fma_f32 v[174:175], v[172:173], v[180:181], v[194:195] op_sel:[1,1,0] op_sel_hi:[1,0,1] neg_lo:[0,1,0]
    v_cvt_pk_bf16_f32 v247, v174, -v175
    v_pk_mul_f32 v[194:195], v[174:175], v[180:181] op_sel:[0,0] op_sel_hi:[0,1]
    v_pk_fma_f32 v[172:173], v[174:175], v[180:181], v[194:195] op_sel:[1,1,0] op_sel_hi:[1,0,1] neg_lo:[0,1,0]
    v_cvt_pk_bf16_f32 v248, v172, -v173
    v_pk_mul_f32 v[194:195], v[172:173], v[180:181] op_sel:[0,0] op_sel_hi:[0,1]
    v_pk_fma_f32 v[174:175], v[172:173], v[180:181], v[194:195] op_sel:[1,1,0] op_sel_hi:[1,0,1] neg_lo:[0,1,0]
    v_cvt_pk_bf16_f32 v249, v174, -v175
    v_pk_mul_f32 v[194:195], v[192:193], v[190:191] op_sel:[0,0] op_sel_hi:[0,1]
    v_pk_fma_f32 v[176:177], v[192:193], v[190:191], v[194:195] op_sel:[1,1,0] op_sel_hi:[1,0,1] neg_lo:[0,1,0]
    v_cvt_pk_bf16_f32 v250, v176, -v177
    v_pk_mul_f32 v[194:195], v[176:177], v[182:183] op_sel:[0,0] op_sel_hi:[0,1]
    v_pk_fma_f32 v[174:175], v[176:177], v[182:183], v[194:195] op_sel:[1,1,0] op_sel_hi:[1,0,1] neg_lo:[0,1,0]
    v_cvt_pk_bf16_f32 v251, v174, -v175
    ds_write_addtid_b32 v242 offset:0
    ds_write_addtid_b32 v243 offset:272
    ds_write_addtid_b32 v244 offset:544
    ds_write_addtid_b32 v245 offset:816
    ds_write_addtid_b32 v246 offset:1088
    ds_write_addtid_b32 v247 offset:1360
    ds_write_addtid_b32 v248 offset:1632
    ds_write_addtid_b32 v249 offset:1904
    ds_write_addtid_b32 v250 offset:2176
    ds_write_addtid_b32 v251 offset:2448
    v_pk_mul_f32 v[194:195], v[174:175], v[182:183] op_sel:[0,0] op_sel_hi:[0,1]
    v_pk_fma_f32 v[172:173], v[174:175], v[182:183], v[194:195] op_sel:[1,1,0] op_sel_hi:[1,0,1] neg_lo:[0,1,0]
    v_cvt_pk_bf16_f32 v242, v172, -v173
    v_pk_mul_f32 v[194:195], v[172:173], v[182:183] op_sel:[0,0] op_sel_hi:[0,1]
    v_pk_fma_f32 v[174:175], v[172:173], v[182:183], v[194:195] op_sel:[1,1,0] op_sel_hi:[1,0,1] neg_lo:[0,1,0]
    s_waitcnt vmcnt(11)
    s_waitcnt vmcnt(10)
    v_cmp_gt_u32 vcc, 1, v7
    s_nop 0
    s_and_b64 vcc, vcc, s[50:51]
    s_and_b64 vcc, vcc, 1
    s_cbranch_scc1 ps_5
pc_7:
    s_barrier
    v_lshlrev_b32 v2, 3, v4
    v_mov_b32 v5, 1
    v_cndmask_b32 v2, v4, v2, s[50:51]
    buffer_atomic_add v5, v2, s[16:19], s86 offen offset:0 sc1
    v_cvt_pk_bf16_f32 v243, v174, -v175
    v_pk_mul_f32 v[194:195], v[174:175], v[182:183] op_sel:[0,0] op_sel_hi:[0,1]
    v_pk_fma_f32 v[172:173], v[174:175], v[182:183], v[194:195] op_sel:[1,1,0] op_sel_hi:[1,0,1] neg_lo:[0,1,0]
    v_cvt_pk_bf16_f32 v244, v172, -v173
    v_pk_mul_f32 v[194:195], v[176:177], v[190:191] op_sel:[0,0] op_sel_hi:[0,1]
    v_pk_fma_f32 v[178:179], v[176:177], v[190:191], v[194:195] op_sel:[1,1,0] op_sel_hi:[1,0,1] neg_lo:[0,1,0]
    v_cvt_pk_bf16_f32 v245, v178, -v179
    v_pk_mul_f32 v[194:195], v[178:179], v[184:185] op_sel:[0,0] op_sel_hi:[0,1]
    v_pk_fma_f32 v[174:175], v[178:179], v[184:185], v[194:195] op_sel:[1,1,0] op_sel_hi:[1,0,1] neg_lo:[0,1,0]
    v_cvt_pk_bf16_f32 v246, v174, -v175
    v_pk_mul_f32 v[194:195], v[174:175], v[184:185] op_sel:[0,0] op_sel_hi:[0,1]
    v_pk_fma_f32 v[172:173], v[174:175], v[184:185], v[194:195] op_sel:[1,1,0] op_sel_hi:[1,0,1] neg_lo:[0,1,0]
    v_cvt_pk_bf16_f32 v247, v172, -v173
    v_pk_mul_f32 v[194:195], v[178:179], v[190:191] op_sel:[0,0] op_sel_hi:[0,1]
    v_pk_fma_f32 v[176:177], v[178:179], v[190:191], v[194:195] op_sel:[1,1,0] op_sel_hi:[1,0,1] neg_lo:[0,1,0]
    v_cvt_pk_bf16_f32 v248, v176, -v177
    v_pk_mul_f32 v[194:195], v[176:177], v[184:185] op_sel:[0,0] op_sel_hi:[0,1]
    v_pk_fma_f32 v[174:175], v[176:177], v[184:185], v[194:195] op_sel:[1,1,0] op_sel_hi:[1,0,1] neg_lo:[0,1,0]
    v_cvt_pk_bf16_f32 v249, v174, -v175
    v_pk_mul_f32 v[194:195], v[174:175], v[184:185] op_sel:[0,0] op_sel_hi:[0,1]
    v_pk_fma_f32 v[172:173], v[174:175], v[184:185], v[194:195] op_sel:[1,1,0] op_sel_hi:[1,0,1] neg_lo:[0,1,0]
    v_cvt_pk_bf16_f32 v250, v172, -v173
    v_pk_mul_f32 v[194:195], v[176:177], v[190:191] op_sel:[0,0] op_sel_hi:[0,1]
    v_pk_fma_f32 v[178:179], v[176:177], v[190:191], v[194:195] op_sel:[1,1,0] op_sel_hi:[1,0,1] neg_lo:[0,1,0]
    v_cvt_pk_bf16_f32 v251, v178, -v179
    ds_write_addtid_b32 v242 offset:2720
    ds_write_addtid_b32 v242 offset:3264
    ds_write_addtid_b32 v243 offset:3536
    ds_write_addtid_b32 v244 offset:3808
    ds_write_addtid_b32 v245 offset:4352
    ds_write_addtid_b32 v246 offset:4624
    ds_write_addtid_b32 v247 offset:4896
    ds_write_addtid_b32 v248 offset:5440
    ds_write_addtid_b32 v249 offset:5712
    ds_write_addtid_b32 v250 offset:5984
    v_mov_b32 v144, -1
    v_mov_b32 v145, -1
    v_mov_b32 v146, -1
    v_mov_b32 v147, -1
    v_lshlrev_b32 v148, 4, v0
    s_sub_u32 s88, s2, 0
    s_mul_i32 s88, s88, 20480
    s_min_u32 s88, s88, 5222400
    s_add_u32 s88, s88, 4194304
    buffer_store_dwordx4 v[144:147], v148, s[16:19], s88 offen sc1
    ds_write_addtid_b32 v251 offset:6528
    v_pk_mul_f32 v[194:195], v[178:179], v[186:187] op_sel:[0,0] op_sel_hi:[0,1]
    v_pk_fma_f32 v[174:175], v[178:179], v[186:187], v[194:195] op_sel:[1,1,0] op_sel_hi:[1,0,1] neg_lo:[0,1,0]
    v_cvt_pk_bf16_f32 v242, v174, -v175
    v_pk_mul_f32 v[194:195], v[178:179], v[190:191] op_sel:[0,0] op_sel_hi:[0,1]
    v_pk_fma_f32 v[176:177], v[178:179], v[190:191], v[194:195] op_sel:[1,1,0] op_sel_hi:[1,0,1] neg_lo:[0,1,0]
    v_cvt_pk_bf16_f32 v243, v176, -v177
    v_pk_mul_f32 v[194:195], v[176:177], v[186:187] op_sel:[0,0] op_sel_hi:[0,1]
    v_pk_fma_f32 v[174:175], v[176:177], v[186:187], v[194:195] op_sel:[1,1,0] op_sel_hi:[1,0,1] neg_lo:[0,1,0]
    v_cvt_pk_bf16_f32 v244, v174, -v175
    v_pk_mul_f32 v[194:195], v[176:177], v[190:191] op_sel:[0,0] op_sel_hi:[0,1]
    v_pk_fma_f32 v[178:179], v[176:177], v[190:191], v[194:195] op_sel:[1,1,0] op_sel_hi:[1,0,1] neg_lo:[0,1,0]
    v_cvt_pk_bf16_f32 v245, v178, -v179
    v_pk_mul_f32 v[194:195], v[178:179], v[186:187] op_sel:[0,0] op_sel_hi:[0,1]
    v_pk_fma_f32 v[174:175], v[178:179], v[186:187], v[194:195] op_sel:[1,1,0] op_sel_hi:[1,0,1] neg_lo:[0,1,0]
    v_cvt_pk_bf16_f32 v246, v174, -v175
    v_pk_mul_f32 v[194:195], v[178:179], v[190:191] op_sel:[0,0] op_sel_hi:[0,1]
    v_pk_fma_f32 v[176:177], v[178:179], v[190:191], v[194:195] op_sel:[1,1,0] op_sel_hi:[1,0,1] neg_lo:[0,1,0]
    v_cvt_pk_bf16_f32 v247, v176, -v177
    v_pk_mul_f32 v[194:195], v[176:177], v[186:187] op_sel:[0,0] op_sel_hi:[0,1]
    v_pk_fma_f32 v[174:175], v[176:177], v[186:187], v[194:195] op_sel:[1,1,0] op_sel_hi:[1,0,1] neg_lo:[0,1,0]
    v_cvt_pk_bf16_f32 v248, v174, -v175
    ds_write_addtid_b32 v242 offset:6800
    ds_write_addtid_b32 v243 offset:7072
    ds_write_addtid_b32 v244 offset:7344
    ds_write_addtid_b32 v245 offset:7616
    ds_write_addtid_b32 v246 offset:7888
    ds_write_addtid_b32 v247 offset:8160
    ds_write_addtid_b32 v248 offset:8432
    ds_read_b128 a[192:195], v252 offset:0
    ds_read_b128 a[196:199], v252 offset:32
    ds_read_b128 a[200:203], v252 offset:64
    ds_read_b128 a[204:207], v252 offset:96
    ds_read_b128 a[208:211], v252 offset:128
    ds_read_b128 a[212:215], v252 offset:160
    s_add_u32 s88, s88, 4096
    buffer_store_dwordx4 v[144:147], v148, s[16:19], s88 offen sc1
    ds_read_b128 a[216:219], v252 offset:192
    ds_read_b128 a[220:223], v252 offset:224
    v_and_b32 v199, 0xffff0000, v232
    v_mul_f32 v199, 0x3fb8aa3b, v199
    v_exp_f32 v199, v199
    v_and_b32 v255, 0xffff0000, v233
    v_mul_f32 v255, v255, v253
    v_mul_f32 v255, 0x3e22f983, v255
    v_cvt_pk_bf16_f32 v199, v199, v199
    v_lshlrev_b32 v199, 16, v199
    v_mul_f32 v254, v199, v253
    v_mul_f32 v254, 0xbfb8aa3b, v254
    s_waitcnt lgkmcnt(7)
    v_mfma_f32_32x32x16_bf16 v[216:231], a[192:195], a[160:163], 0
    v_mul_f32 v182, 0x41000000, v254
    v_mul_f32 v185, 0x41000000, v255
    v_mul_f32 v184, 0x43800000, v254
    v_mul_f32 v189, 0x43800000, v255
    s_waitcnt lgkmcnt(6)
    v_mfma_f32_32x32x16_bf16 v[216:231], a[196:199], a[164:167], v[216:231]
    v_fract_f32 v185, v185
    v_fract_f32 v188, v255
    v_fract_f32 v189, v189
    v_exp_f32 v182, v182
    s_waitcnt lgkmcnt(5)
    v_mfma_f32_32x32x16_bf16 v[216:231], a[200:203], a[168:171], v[216:231]
    v_exp_f32 v183, v254
    v_exp_f32 v184, v184
    v_cos_f32 v186, v185
    v_sin_f32 v187, v185
    s_waitcnt lgkmcnt(4)
    v_mfma_f32_32x32x16_bf16 v[216:231], a[204:207], a[172:175], v[216:231]
    v_cos_f32 v180, v188
    v_sin_f32 v181, v188
    v_cos_f32 v190, v189
    v_sin_f32 v191, v189
    s_waitcnt lgkmcnt(3)
    v_mfma_f32_32x32x16_bf16 v[216:231], a[208:211], a[176:179], v[216:231]
    v_and_b32 v192, 0xffff0000, v234
    v_and_b32 v193, 0xffff0000, v235
    s_add_u32 s88, s88, 4096
    buffer_store_dwordx4 v[144:147], v148, s[16:19], s88 offen sc1
    v_add_f32 v199, v253, v253
    v_mul_f32 v192, v192, v199
    s_waitcnt lgkmcnt(2)
    v_mfma_f32_32x32x16_bf16 v[216:231], a[212:215], a[180:183], v[216:231]
    v_mul_f32 v193, v193, v199
    v_mul_f32 v186, v186, v182
    v_mul_f32 v187, v187, v182
    v_mul_f32 v180, v180, v183
    s_waitcnt lgkmcnt(1)
    v_mfma_f32_32x32x16_bf16 v[216:231], a[216:219], a[184:187], v[216:231]
    v_mul_f32 v181, v181, v183
    v_mul_f32 v190, v190, v184
    v_mul_f32 v191, v191, v184
    s_waitcnt lgkmcnt(0)
    v_mfma_f32_32x32x16_bf16 v[216:231], a[220:223], a[188:191], v[216:231]
    v_mov_b32 v242, 0x3f80
    v_cvt_pk_bf16_f32 v243, v186, v187
    v_pk_mul_f32 v[194:195], v[186:187], v[186:187] op_sel:[0,0] op_sel_hi:[0,1]
    v_pk_fma_f32 v[172:173], v[186:187], v[186:187], v[194:195] op_sel:[1,1,0] op_sel_hi:[1,0,1] neg_lo:[0,1,0]
    v_cvt_pk_bf16_f32 v244, v172, v173
    v_pk_mul_f32 v[194:195], v[172:173], v[186:187] op_sel:[0,0] op_sel_hi:[0,1]
    v_pk_fma_f32 v[174:175], v[172:173], v[186:187], v[194:195] op_sel:[1,1,0] op_sel_hi:[1,0,1] neg_lo:[0,1,0]
    v_cvt_pk_bf16_f32 v245, v174, v175
    v_pk_mul_f32 v[194:195], v[174:175], v[186:187] op_sel:[0,0] op_sel_hi:[0,1]
    v_pk_fma_f32 v[172:173], v[174:175], v[186:187], v[194:195] op_sel:[1,1,0] op_sel_hi:[1,0,1] neg_lo:[0,1,0]
    v_cvt_pk_bf16_f32 v246, v172, v173
    v_pk_mul_f32 v[194:195], v[172:173], v[186:187] op_sel:[0,0] op_sel_hi:[0,1]
    v_pk_fma_f32 v[174:175], v[172:173], v[186:187], v[194:195] op_sel:[1,1,0] op_sel_hi:[1,0,1] neg_lo:[0,1,0]
    v_cvt_pk_bf16_f32 v247, v174, v175
    v_pk_mul_f32 v[194:195], v[174:175], v[186:187] op_sel:[0,0] op_sel_hi:[0,1]
    v_pk_fma_f32 v[172:173], v[174:175], v[186:187], v[194:195] op_sel:[1,1,0] op_sel_hi:[1,0,1] neg_lo:[0,1,0]
    v_cvt_pk_bf16_f32 v248, v172, v173
    v_pk_mul_f32 v[194:195], v[172:173], v[186:187] op_sel:[0,0] op_sel_hi:[0,1]
    v_pk_fma_f32 v[174:175], v[172:173], v[186:187], v[194:195] op_sel:[1,1,0] op_sel_hi:[1,0,1] neg_lo:[0,1,0]
    v_cvt_pk_bf16_f32 v249, v174, v175
    v_pk_mul_f32 v[194:195], v[174:175], v[186:187] op_sel:[0,0] op_sel_hi:[0,1]
    v_pk_fma_f32 v[172:173], v[174:175], v[186:187], v[194:195] op_sel:[1,1,0] op_sel_hi:[1,0,1] neg_lo:[0,1,0]
    v_cvt_pk_bf16_f32 v250, v172, v173
    s_add_u32 s88, s88, 4096
    buffer_store_dwordx4 v[144:147], v148, s[16:19], s88 offen sc1
    v_pk_mul_f32 v[194:195], v[172:173], v[186:187] op_sel:[0,0] op_sel_hi:[0,1]
    v_pk_fma_f32 v[174:175], v[172:173], v[186:187], v[194:195] op_sel:[1,1,0] op_sel_hi:[1,0,1] neg_lo:[0,1,0]
    v_cvt_pk_bf16_f32 v251, v174, v175
    ds_write_addtid_b32 v242 offset:0
    ds_write_addtid_b32 v243 offset:272
    ds_write_addtid_b32 v244 offset:544
    ds_write_addtid_b32 v245 offset:816
    ds_write_addtid_b32 v246 offset:1088
    ds_write_addtid_b32 v247 offset:1360
    ds_write_addtid_b32 v248 offset:1632
    ds_write_addtid_b32 v249 offset:1904
    ds_write_addtid_b32 v250 offset:2176
    ds_write_addtid_b32 v251 offset:2448
    v_pk_mul_f32 v[194:195], v[174:175], v[186:187] op_sel:[0,0] op_sel_hi:[0,1]
    v_pk_fma_f32 v[172:173], v[174:175], v[186:187], v[194:195] op_sel:[1,1,0] op_sel_hi:[1,0,1] neg_lo:[0,1,0]
    v_cvt_pk_bf16_f32 v242, v172, v173
    v_pk_mul_f32 v[194:195], v[172:173], v[186:187] op_sel:[0,0] op_sel_hi:[0,1]
    v_pk_fma_f32 v[174:175], v[172:173], v[186:187], v[194:195] op_sel:[1,1,0] op_sel_hi:[1,0,1] neg_lo:[0,1,0]
    v_cvt_pk_bf16_f32 v243, v174, v175
    v_pk_mul_f32 v[194:195], v[174:175], v[186:187] op_sel:[0,0] op_sel_hi:[0,1]
    v_pk_fma_f32 v[172:173], v[174:175], v[186:187], v[194:195] op_sel:[1,1,0] op_sel_hi:[1,0,1] neg_lo:[0,1,0]
    v_cvt_pk_bf16_f32 v244, v172, v173
    v_pk_mul_f32 v[194:195], v[172:173], v[186:187] op_sel:[0,0] op_sel_hi:[0,1]
    v_pk_fma_f32 v[174:175], v[172:173], v[186:187], v[194:195] op_sel:[1,1,0] op_sel_hi:[1,0,1] neg_lo:[0,1,0]
    v_cvt_pk_bf16_f32 v245, v174, v175
    v_pk_mul_f32 v[194:195], v[174:175], v[186:187] op_sel:[0,0] op_sel_hi:[0,1]
    v_pk_fma_f32 v[172:173], v[174:175], v[186:187], v[194:195] op_sel:[1,1,0] op_sel_hi:[1,0,1] neg_lo:[0,1,0]
    v_cvt_pk_bf16_f32 v246, v172, v173
    v_pk_mul_f32 v[194:195], v[172:173], v[186:187] op_sel:[0,0] op_sel_hi:[0,1]
    v_pk_fma_f32 v[174:175], v[172:173], v[186:187], v[194:195] op_sel:[1,1,0] op_sel_hi:[1,0,1] neg_lo:[0,1,0]
    v_cvt_pk_bf16_f32 v247, v174, v175
    v_pk_mul_f32 v[194:195], v[174:175], v[186:187] op_sel:[0,0] op_sel_hi:[0,1]
    v_pk_fma_f32 v[172:173], v[174:175], v[186:187], v[194:195] op_sel:[1,1,0] op_sel_hi:[1,0,1] neg_lo:[0,1,0]
    v_cvt_pk_bf16_f32 v248, v172, v173
    v_pk_mul_f32 v[194:195], v[172:173], v[186:187] op_sel:[0,0] op_sel_hi:[0,1]
    s_add_u32 s88, s88, 4096
    buffer_store_dwordx4 v[144:147], v148, s[16:19], s88 offen sc1
    v_pk_fma_f32 v[174:175], v[172:173], v[186:187], v[194:195] op_sel:[1,1,0] op_sel_hi:[1,0,1] neg_lo:[0,1,0]
    v_cvt_pk_bf16_f32 v249, v174, v175
    v_pk_mul_f32 v[194:195], v[174:175], v[186:187] op_sel:[0,0] op_sel_hi:[0,1]
    v_pk_fma_f32 v[172:173], v[174:175], v[186:187], v[194:195] op_sel:[1,1,0] op_sel_hi:[1,0,1] neg_lo:[0,1,0]
    v_cvt_pk_bf16_f32 v250, v172, v173
    v_pk_mul_f32 v[194:195], v[172:173], v[186:187] op_sel:[0,0] op_sel_hi:[0,1]
    v_pk_fma_f32 v[174:175], v[172:173], v[186:187], v[194:195] op_sel:[1,1,0] op_sel_hi:[1,0,1] neg_lo:[0,1,0]
    v_cvt_pk_bf16_f32 v251, v174, v175
    ds_write_addtid_b32 v242 offset:2720
    ds_write_addtid_b32 v243 offset:2992
    ds_write_addtid_b32 v244 offset:3264
    ds_write_addtid_b32 v245 offset:3536
    ds_write_addtid_b32 v246 offset:3808
    ds_write_addtid_b32 v247 offset:4080
    ds_write_addtid_b32 v248 offset:4352
    ds_write_addtid_b32 v249 offset:4624
    ds_write_addtid_b32 v250 offset:4896
    ds_write_addtid_b32 v251 offset:5168
    v_pk_mul_f32 v[194:195], v[174:175], v[186:187] op_sel:[0,0] op_sel_hi:[0,1]
    v_pk_fma_f32 v[172:173], v[174:175], v[186:187], v[194:195] op_sel:[1,1,0] op_sel_hi:[1,0,1] neg_lo:[0,1,0]
    v_cvt_pk_bf16_f32 v242, v172, v173
    v_pk_mul_f32 v[194:195], v[172:173], v[186:187] op_sel:[0,0] op_sel_hi:[0,1]
    v_pk_fma_f32 v[174:175], v[172:173], v[186:187], v[194:195] op_sel:[1,1,0] op_sel_hi:[1,0,1] neg_lo:[0,1,0]
    v_cvt_pk_bf16_f32 v243, v174, v175
    v_pk_mul_f32 v[194:195], v[174:175], v[186:187] op_sel:[0,0] op_sel_hi:[0,1]
    v_pk_fma_f32 v[172:173], v[174:175], v[186:187], v[194:195] op_sel:[1,1,0] op_sel_hi:[1,0,1] neg_lo:[0,1,0]
    v_cvt_pk_bf16_f32 v244, v172, v173
    v_pk_mul_f32 v[194:195], v[172:173], v[186:187] op_sel:[0,0] op_sel_hi:[0,1]
    v_pk_fma_f32 v[174:175], v[172:173], v[186:187], v[194:195] op_sel:[1,1,0] op_sel_hi:[1,0,1] neg_lo:[0,1,0]
    v_cvt_pk_bf16_f32 v245, v174, v175
    v_pk_mul_f32 v[194:195], v[174:175], v[186:187] op_sel:[0,0] op_sel_hi:[0,1]
    v_pk_fma_f32 v[172:173], v[174:175], v[186:187], v[194:195] op_sel:[1,1,0] op_sel_hi:[1,0,1] neg_lo:[0,1,0]
    v_cvt_pk_bf16_f32 v246, v172, v173
    v_pk_mul_f32 v[194:195], v[172:173], v[186:187] op_sel:[0,0] op_sel_hi:[0,1]
    v_pk_fma_f32 v[174:175], v[172:173], v[186:187], v[194:195] op_sel:[1,1,0] op_sel_hi:[1,0,1] neg_lo:[0,1,0]
    v_mov_b32 v134, 0x3f803f80
    v_mov_b32 v132, 0
    v_mov_b32 v133, 0
    s_waitcnt vmcnt(10)
    v_dot2c_f32_bf16 v132, v120, v134
    v_dot2c_f32_bf16 v133, v120, v120
    v_dot2c_f32_bf16 v132, v121, v134
    v_dot2c_f32_bf16 v133, v121, v121
    v_dot2c_f32_bf16 v132, v122, v134
    v_dot2c_f32_bf16 v133, v122, v122
    v_dot2c_f32_bf16 v132, v123, v134
    v_dot2c_f32_bf16 v133, v123, v123
    s_waitcnt vmcnt(9)
    v_dot2c_f32_bf16 v132, v124, v134
    v_dot2c_f32_bf16 v133, v124, v124
    v_dot2c_f32_bf16 v132, v125, v134
    v_dot2c_f32_bf16 v133, v125, v125
    v_dot2c_f32_bf16 v132, v126, v134
    v_dot2c_f32_bf16 v133, v126, v126
    v_dot2c_f32_bf16 v132, v127, v134
    v_dot2c_f32_bf16 v133, v127, v127
    s_waitcnt vmcnt(8)
    v_dot2c_f32_bf16 v132, v128, v134
    v_dot2c_f32_bf16 v133, v128, v128
    v_dot2c_f32_bf16 v132, v129, v134
    v_dot2c_f32_bf16 v133, v129, v129
    v_dot2c_f32_bf16 v132, v130, v134
    v_dot2c_f32_bf16 v133, v130, v130
    v_dot2c_f32_bf16 v132, v131, v134
    v_dot2c_f32_bf16 v133, v131, v131
    v_lshrrev_b32 v135, 5, v0
    v_and_b32 v121, 3, v135
    v_lshrrev_b32 v135, 2, v135
    v_add_f32_dpp v132, v132, v132 row_shr:1 row_mask:0xf bank_mask:0xf bound_ctrl:0
    v_add_f32_dpp v133, v133, v133 row_shr:1 row_mask:0xf bank_mask:0xf bound_ctrl:0
    v_lshlrev_b32_e64 v135, 3, v135
    v_add_f32_dpp v132, v132, v132 row_shr:2 row_mask:0xf bank_mask:0xf bound_ctrl:0
    v_add_f32_dpp v133, v133, v133 row_shr:2 row_mask:0xf bank_mask:0xf bound_ctrl:0
    v_lshl_add_u32 v135, v121, 12, v135
    v_add_f32_dpp v132, v132, v132 row_shr:4 row_mask:0xf bank_mask:0xf bound_ctrl:0
    v_add_f32_dpp v133, v133, v133 row_shr:4 row_mask:0xf bank_mask:0xf bound_ctrl:0
    v_and_b32_e64 v121, 31, v0
    v_add_f32_dpp v132, v132, v132 row_shr:8 row_mask:0xf bank_mask:0xf bound_ctrl:0
    v_add_f32_dpp v133, v133, v133 row_shr:8 row_mask:0xf bank_mask:0xf bound_ctrl:0
    v_cmp_eq_u32_e64 vcc, 31, v121
    v_add_f32_dpp v132, v132, v132 row_bcast:15 row_mask:0xa bank_mask:0xf
    v_add_f32_dpp v133, v133, v133 row_bcast:15 row_mask:0xa bank_mask:0xf
    v_mov_b32 v121, 1073741824
    v_cndmask_b32_e64 v120, v121, v135, vcc
    s_lshl_b32 s96, s2, 4
    s_add_u32 s96, s96, 3440640
    v_mul_f32 v135, 0x3acccccd, v132
    v_mul_f32 v133, 0x3acccccd, v133
    v_fma_f32 v133, -v135, v135, v133
    v_max_f32 v133, 0, v133
    v_add_f32 v133, 0x3727c5ac, v133
    v_rsq_f32_e64 v132, v133
    s_nop 0
    v_mul_f32 v133, -v135, v132
    buffer_store_dwordx2 v[132:133], v120, s[16:19], s96 offen sc1
    v_cvt_pk_bf16_f32 v247, v174, v175
    v_pk_mul_f32 v[194:195], v[174:175], v[186:187] op_sel:[0,0] op_sel_hi:[0,1]
    v_pk_fma_f32 v[172:173], v[174:175], v[186:187], v[194:195] op_sel:[1,1,0] op_sel_hi:[1,0,1] neg_lo:[0,1,0]
    v_cvt_pk_bf16_f32 v248, v172, v173
    v_pk_mul_f32 v[194:195], v[172:173], v[186:187] op_sel:[0,0] op_sel_hi:[0,1]
    v_pk_fma_f32 v[174:175], v[172:173], v[186:187], v[194:195] op_sel:[1,1,0] op_sel_hi:[1,0,1] neg_lo:[0,1,0]
    v_cvt_pk_bf16_f32 v249, v174, v175
    v_pk_mul_f32 v[194:195], v[174:175], v[186:187] op_sel:[0,0] op_sel_hi:[0,1]
    v_pk_fma_f32 v[172:173], v[174:175], v[186:187], v[194:195] op_sel:[1,1,0] op_sel_hi:[1,0,1] neg_lo:[0,1,0]
    v_cvt_pk_bf16_f32 v250, v172, v173
    v_pk_mul_f32 v[194:195], v[172:173], v[186:187] op_sel:[0,0] op_sel_hi:[0,1]
    v_pk_fma_f32 v[174:175], v[172:173], v[186:187], v[194:195] op_sel:[1,1,0] op_sel_hi:[1,0,1] neg_lo:[0,1,0]
    v_cvt_pk_bf16_f32 v251, v174, v175
    ds_write_addtid_b32 v242 offset:5440
    ds_write_addtid_b32 v243 offset:5712
    ds_write_addtid_b32 v244 offset:5984
    ds_write_addtid_b32 v245 offset:6256
    ds_write_addtid_b32 v246 offset:6528
    ds_write_addtid_b32 v247 offset:6800
    ds_write_addtid_b32 v248 offset:7072
    ds_write_addtid_b32 v249 offset:7344
    ds_write_addtid_b32 v250 offset:7616
    ds_write_addtid_b32 v251 offset:7888
    v_pk_mul_f32 v[194:195], v[174:175], v[186:187] op_sel:[0,0] op_sel_hi:[0,1]
    v_pk_fma_f32 v[172:173], v[174:175], v[186:187], v[194:195] op_sel:[1,1,0] op_sel_hi:[1,0,1] neg_lo:[0,1,0]
    v_cvt_pk_bf16_f32 v242, v172, v173
    v_pk_mul_f32 v[194:195], v[172:173], v[186:187] op_sel:[0,0] op_sel_hi:[0,1]
    v_pk_fma_f32 v[174:175], v[172:173], v[186:187], v[194:195] op_sel:[1,1,0] op_sel_hi:[1,0,1] neg_lo:[0,1,0]
    v_cvt_pk_bf16_f32 v243, v174, v175
    ds_write_addtid_b32 v242 offset:8160
    ds_write_addtid_b32 v243 offset:8432
    ds_read_b128 a[160:163], v252 offset:0
    ds_read_b128 a[164:167], v252 offset:32
    ds_read_b128 a[168:171], v252 offset:64
    ds_read_b128 a[172:175], v252 offset:96
    ds_read_b128 a[176:179], v252 offset:128
    ds_read_b128 a[180:183], v252 offset:160
    ds_read_b128 a[184:187], v252 offset:192
    ds_read_b128 a[188:191], v252 offset:224
    v_pk_mul_f32 v[194:195], v[180:181], v[180:181] op_sel:[0,0] op_sel_hi:[0,1]
    v_pk_fma_f32 v[182:183], v[180:181], v[180:181], v[194:195] op_sel:[1,1,0] op_sel_hi:[1,0,1] neg_lo:[0,1,0]
    v_pk_mul_f32 v[194:195], v[182:183], v[182:183] op_sel:[0,0] op_sel_hi:[0,1]
    v_pk_fma_f32 v[184:185], v[182:183], v[182:183], v[194:195] op_sel:[1,1,0] op_sel_hi:[1,0,1] neg_lo:[0,1,0]
    v_cvt_pk_bf16_f32 v242, v192, -v193
    v_pk_mul_f32 v[194:195], v[192:193], v[180:181] op_sel:[0,0] op_sel_hi:[0,1]
    v_pk_fma_f32 v[174:175], v[192:193], v[180:181], v[194:195] op_sel:[1,1,0] op_sel_hi:[1,0,1] neg_lo:[0,1,0]
    v_cvt_pk_bf16_f32 v243, v174, -v175
    v_pk_mul_f32 v[194:195], v[174:175], v[180:181] op_sel:[0,0] op_sel_hi:[0,1]
    v_pk_fma_f32 v[172:173], v[174:175], v[180:181], v[194:195] op_sel:[1,1,0] op_sel_hi:[1,0,1] neg_lo:[0,1,0]
    v_cvt_pk_bf16_f32 v244, v172, -v173
    v_pk_mul_f32 v[194:195], v[172:173], v[180:181] op_sel:[0,0] op_sel_hi:[0,1]
    v_pk_fma_f32 v[174:175], v[172:173], v[180:181], v[194:195] op_sel:[1,1,0] op_sel_hi:[1,0,1] neg_lo:[0,1,0]
    v_cvt_pk_bf16_f32 v245, v174, -v175
    v_pk_mul_f32 v[194:195], v[174:175], v[180:181] op_sel:[0,0] op_sel_hi:[0,1]
    v_pk_fma_f32 v[172:173], v[174:175], v[180:181], v[194:195] op_sel:[1,1,0] op_sel_hi:[1,0,1] neg_lo:[0,1,0]
    v_cvt_pk_bf16_f32 v246, v172, -v173
    v_pk_mul_f32 v[194:195], v[172:173], v[180:181] op_sel:[0,0] op_sel_hi:[0,1]
    v_pk_fma_f32 v[174:175], v[172:173], v[180:181], v[194:195] op_sel:[1,1,0] op_sel_hi:[1,0,1] neg_lo:[0,1,0]
    v_cvt_pk_bf16_f32 v247, v174, -v175
    v_pk_mul_f32 v[194:195], v[174:175], v[180:181] op_sel:[0,0] op_sel_hi:[0,1]
    buffer_load_dword v7, v4, s[16:19], s87 offen offset:0 sc1
    v_pk_fma_f32 v[172:173], v[174:175], v[180:181], v[194:195] op_sel:[1,1,0] op_sel_hi:[1,0,1] neg_lo:[0,1,0]
    v_cvt_pk_bf16_f32 v248, v172, -v173
    v_pk_mul_f32 v[194:195], v[172:173], v[180:181] op_sel:[0,0] op_sel_hi:[0,1]
    v_pk_fma_f32 v[174:175], v[172:173], v[180:181], v[194:195] op_sel:[1,1,0] op_sel_hi:[1,0,1] neg_lo:[0,1,0]
    v_cvt_pk_bf16_f32 v249, v174, -v175
    v_pk_mul_f32 v[194:195], v[192:193], v[190:191] op_sel:[0,0] op_sel_hi:[0,1]
    v_pk_fma_f32 v[176:177], v[192:193], v[190:191], v[194:195] op_sel:[1,1,0] op_sel_hi:[1,0,1] neg_lo:[0,1,0]
    v_cvt_pk_bf16_f32 v250, v176, -v177
    v_pk_mul_f32 v[194:195], v[176:177], v[182:183] op_sel:[0,0] op_sel_hi:[0,1]
    v_pk_fma_f32 v[174:175], v[176:177], v[182:183], v[194:195] op_sel:[1,1,0] op_sel_hi:[1,0,1] neg_lo:[0,1,0]
    v_cvt_pk_bf16_f32 v251, v174, -v175
    ds_write_addtid_b32 v242 offset:0
    ds_write_addtid_b32 v243 offset:272
    ds_write_addtid_b32 v244 offset:544
    ds_write_addtid_b32 v245 offset:816
    ds_write_addtid_b32 v246 offset:1088
    ds_write_addtid_b32 v247 offset:1360
    ds_write_addtid_b32 v248 offset:1632
    ds_write_addtid_b32 v249 offset:1904
    ds_write_addtid_b32 v250 offset:2176
    ds_write_addtid_b32 v251 offset:2448
    v_pk_mul_f32 v[194:195], v[174:175], v[182:183] op_sel:[0,0] op_sel_hi:[0,1]
    v_pk_fma_f32 v[172:173], v[174:175], v[182:183], v[194:195] op_sel:[1,1,0] op_sel_hi:[1,0,1] neg_lo:[0,1,0]
    v_cvt_pk_bf16_f32 v242, v172, -v173
    v_pk_mul_f32 v[194:195], v[172:173], v[182:183] op_sel:[0,0] op_sel_hi:[0,1]
    v_pk_fma_f32 v[174:175], v[172:173], v[182:183], v[194:195] op_sel:[1,1,0] op_sel_hi:[1,0,1] neg_lo:[0,1,0]
    v_cvt_pk_bf16_f32 v243, v174, -v175
    v_pk_mul_f32 v[194:195], v[174:175], v[182:183] op_sel:[0,0] op_sel_hi:[0,1]
    v_pk_fma_f32 v[172:173], v[174:175], v[182:183], v[194:195] op_sel:[1,1,0] op_sel_hi:[1,0,1] neg_lo:[0,1,0]
    v_cvt_pk_bf16_f32 v244, v172, -v173
    v_pk_mul_f32 v[194:195], v[176:177], v[190:191] op_sel:[0,0] op_sel_hi:[0,1]
    v_pk_fma_f32 v[178:179], v[176:177], v[190:191], v[194:195] op_sel:[1,1,0] op_sel_hi:[1,0,1] neg_lo:[0,1,0]
    v_cvt_pk_bf16_f32 v245, v178, -v179
    v_pk_mul_f32 v[194:195], v[178:179], v[184:185] op_sel:[0,0] op_sel_hi:[0,1]
    v_pk_fma_f32 v[174:175], v[178:179], v[184:185], v[194:195] op_sel:[1,1,0] op_sel_hi:[1,0,1] neg_lo:[0,1,0]
    v_cvt_pk_bf16_f32 v246, v174, -v175
    v_pk_mul_f32 v[194:195], v[174:175], v[184:185] op_sel:[0,0] op_sel_hi:[0,1]
    v_pk_fma_f32 v[172:173], v[174:175], v[184:185], v[194:195] op_sel:[1,1,0] op_sel_hi:[1,0,1] neg_lo:[0,1,0]
    v_cvt_pk_bf16_f32 v247, v172, -v173
    v_pk_mul_f32 v[194:195], v[178:179], v[190:191] op_sel:[0,0] op_sel_hi:[0,1]
    v_pk_fma_f32 v[176:177], v[178:179], v[190:191], v[194:195] op_sel:[1,1,0] op_sel_hi:[1,0,1] neg_lo:[0,1,0]
    v_cvt_pk_bf16_f32 v248, v176, -v177
    v_pk_mul_f32 v[194:195], v[176:177], v[184:185] op_sel:[0,0] op_sel_hi:[0,1]
    v_pk_fma_f32 v[174:175], v[176:177], v[184:185], v[194:195] op_sel:[1,1,0] op_sel_hi:[1,0,1] neg_lo:[0,1,0]
    v_cvt_pk_bf16_f32 v249, v174, -v175
    v_pk_mul_f32 v[194:195], v[174:175], v[184:185] op_sel:[0,0] op_sel_hi:[0,1]
    v_pk_fma_f32 v[172:173], v[174:175], v[184:185], v[194:195] op_sel:[1,1,0] op_sel_hi:[1,0,1] neg_lo:[0,1,0]
    v_cvt_pk_bf16_f32 v250, v172, -v173
    v_pk_mul_f32 v[194:195], v[176:177], v[190:191] op_sel:[0,0] op_sel_hi:[0,1]
    v_pk_fma_f32 v[178:179], v[176:177], v[190:191], v[194:195] op_sel:[1,1,0] op_sel_hi:[1,0,1] neg_lo:[0,1,0]
    v_cvt_pk_bf16_f32 v251, v178, -v179
    ds_write_addtid_b32 v242 offset:2720
    ds_write_addtid_b32 v242 offset:3264
    ds_write_addtid_b32 v243 offset:3536
    ds_write_addtid_b32 v244 offset:3808
    ds_write_addtid_b32 v245 offset:4352
    ds_write_addtid_b32 v246 offset:4624
    ds_write_addtid_b32 v247 offset:4896
    ds_write_addtid_b32 v248 offset:5440
    ds_write_addtid_b32 v249 offset:5712
    ds_write_addtid_b32 v250 offset:5984
    ds_write_addtid_b32 v251 offset:6528
    v_pk_mul_f32 v[194:195], v[178:179], v[186:187] op_sel:[0,0] op_sel_hi:[0,1]
    v_pk_fma_f32 v[174:175], v[178:179], v[186:187], v[194:195] op_sel:[1,1,0] op_sel_hi:[1,0,1] neg_lo:[0,1,0]
    v_cvt_pk_bf16_f32 v242, v174, -v175
    v_pk_mul_f32 v[194:195], v[178:179], v[190:191] op_sel:[0,0] op_sel_hi:[0,1]
    v_pk_fma_f32 v[176:177], v[178:179], v[190:191], v[194:195] op_sel:[1,1,0] op_sel_hi:[1,0,1] neg_lo:[0,1,0]
    v_cvt_pk_bf16_f32 v243, v176, -v177
    v_pk_mul_f32 v[194:195], v[176:177], v[186:187] op_sel:[0,0] op_sel_hi:[0,1]
    v_pk_fma_f32 v[174:175], v[176:177], v[186:187], v[194:195] op_sel:[1,1,0] op_sel_hi:[1,0,1] neg_lo:[0,1,0]
    v_cvt_pk_bf16_f32 v244, v174, -v175
    v_pk_mul_f32 v[194:195], v[176:177], v[190:191] op_sel:[0,0] op_sel_hi:[0,1]
    v_pk_fma_f32 v[178:179], v[176:177], v[190:191], v[194:195] op_sel:[1,1,0] op_sel_hi:[1,0,1] neg_lo:[0,1,0]
    v_cvt_pk_bf16_f32 v245, v178, -v179
    v_pk_mul_f32 v[194:195], v[178:179], v[186:187] op_sel:[0,0] op_sel_hi:[0,1]
    v_pk_fma_f32 v[174:175], v[178:179], v[186:187], v[194:195] op_sel:[1,1,0] op_sel_hi:[1,0,1] neg_lo:[0,1,0]
    v_cvt_pk_bf16_f32 v246, v174, -v175
    v_pk_mul_f32 v[194:195], v[178:179], v[190:191] op_sel:[0,0] op_sel_hi:[0,1]
    v_pk_fma_f32 v[176:177], v[178:179], v[190:191], v[194:195] op_sel:[1,1,0] op_sel_hi:[1,0,1] neg_lo:[0,1,0]
    v_cvt_pk_bf16_f32 v247, v176, -v177
    v_pk_mul_f32 v[194:195], v[176:177], v[186:187] op_sel:[0,0] op_sel_hi:[0,1]
    v_pk_fma_f32 v[174:175], v[176:177], v[186:187], v[194:195] op_sel:[1,1,0] op_sel_hi:[1,0,1] neg_lo:[0,1,0]
    v_cvt_pk_bf16_f32 v248, v174, -v175
    ds_write_addtid_b32 v242 offset:6800
    ds_write_addtid_b32 v243 offset:7072
    ds_write_addtid_b32 v244 offset:7344
    ds_write_addtid_b32 v245 offset:7616
    ds_write_addtid_b32 v246 offset:7888
    ds_write_addtid_b32 v247 offset:8160
    ds_write_addtid_b32 v248 offset:8432
    ds_read_b128 a[192:195], v252 offset:0
    ds_read_b128 a[196:199], v252 offset:32
    ds_read_b128 a[200:203], v252 offset:64
    ds_read_b128 a[204:207], v252 offset:96
    ds_read_b128 a[208:211], v252 offset:128
    ds_read_b128 a[212:215], v252 offset:160
    ds_read_b128 a[216:219], v252 offset:192
    ds_read_b128 a[220:223], v252 offset:224
    s_add_u32 m0, s92, 36352
    s_nop 0
    buffer_load_dwordx4 v73, s[4:7], s99 offen offset:0  lds
    v_lshlrev_b32 v199, 16, v236
    v_mul_f32 v199, 0x3fb8aa3b, v199
    v_exp_f32 v199, v199
    v_lshlrev_b32 v255, 16, v237
    v_mul_f32 v255, v255, v253
    v_mul_f32 v255, 0x3e22f983, v255
    v_cvt_pk_bf16_f32 v199, v199, v199
    v_lshlrev_b32 v199, 16, v199
    v_mul_f32 v254, v199, v253
    v_mul_f32 v254, 0xbfb8aa3b, v254
    s_waitcnt lgkmcnt(7)
    v_mfma_f32_32x32x16_bf16 v[216:231], a[192:195], a[160:163], v[216:231]
    s_add_u32 m0, s92, 36352
    s_nop 0
    buffer_load_dwordx4 v74, s[4:7], s99 offen offset:1088  lds
    v_mul_f32 v182, 0x41000000, v254
    v_mul_f32 v185, 0x41000000, v255
    v_mul_f32 v184, 0x43800000, v254
    v_mul_f32 v189, 0x43800000, v255
    s_waitcnt lgkmcnt(6)
    v_mfma_f32_32x32x16_bf16 v[216:231], a[196:199], a[164:167], v[216:231]
    s_add_u32 m0, s92, 36352
    s_nop 0
    buffer_load_dwordx4 v75, s[4:7], s99 offen offset:2176  lds
    v_fract_f32 v185, v185
    v_fract_f32 v188, v255
    v_fract_f32 v189, v189
    v_exp_f32_e64 v182, v182
    s_waitcnt lgkmcnt(5)
    v_mfma_f32_32x32x16_bf16 v[216:231], a[200:203], a[168:171], v[216:231]
    s_add_u32 m0, s92, 36352
    s_nop 0
    buffer_load_dwordx4 v76, s[4:7], s99 offen offset:3264  lds
    v_exp_f32 v183, v254
    v_exp_f32 v184, v184
    v_cos_f32 v186, v185
    v_sin_f32 v187, v185
    s_waitcnt lgkmcnt(4)
    v_mfma_f32_32x32x16_bf16 v[216:231], a[204:207], a[172:175], v[216:231]
    s_add_u32 m0, s93, 53760
    s_add_u32 s99, s99, 256
    s_mov_b64 exec, s[80:81]
    buffer_load_dwordx4 v77, s[4:7], s100 offen  lds
    s_mov_b64 exec, -1
    s_add_u32 s100, s100, 256
    v_cos_f32 v180, v188
    v_sin_f32 v181, v188
    v_cos_f32 v190, v189
    v_sin_f32_e64 v191, v189
    s_waitcnt lgkmcnt(3)
    v_mfma_f32_32x32x16_bf16 v[216:231], a[208:211], a[176:179], v[216:231]
    s_add_u32 m0, s92, 55936
    s_nop 0
    buffer_load_dwordx4 v73, s[4:7], s99 offen offset:0  lds
    v_lshlrev_b32 v192, 16, v238
    v_lshlrev_b32 v193, 16, v239
    v_add_f32 v199, v253, v253
    v_mul_f32 v192, v192, v199
    s_waitcnt lgkmcnt(2)
    v_mfma_f32_32x32x16_bf16 v[216:231], a[212:215], a[180:183], v[216:231]
    s_add_u32 m0, s92, 55936
    s_nop 0
    buffer_load_dwordx4 v74, s[4:7], s99 offen offset:1088  lds
    v_mul_f32 v193, v193, v199
    v_mul_f32 v186, v186, v182
    v_mul_f32 v187, v187, v182
    v_mul_f32 v180, v180, v183
    s_waitcnt lgkmcnt(1)
    v_mfma_f32_32x32x16_bf16 v[216:231], a[216:219], a[184:187], v[216:231]
    s_add_u32 m0, s92, 55936
    s_nop 0
    buffer_load_dwordx4 v75, s[4:7], s99 offen offset:2176  lds
    v_mul_f32 v181, v181, v183
    v_mul_f32 v190, v190, v184
    v_mul_f32_e64 v191, v191, v184
    s_waitcnt lgkmcnt(0)
    v_mfma_f32_32x32x16_bf16 v[216:231], a[220:223], a[188:191], v[216:231]
    s_add_u32 m0, s92, 55936
    s_nop 0
    buffer_load_dwordx4 v76, s[4:7], s99 offen offset:3264  lds
    s_add_u32 m0, s93, 73344
    s_add_u32 s99, s99, 256
    s_mov_b64 exec, s[80:81]
    buffer_load_dwordx4 v77, s[4:7], s100 offen  lds
    s_mov_b64 exec, -1
    s_add_u32 s100, s100, 256
    s_add_u32 m0, s92, 75520
    s_nop 0
    buffer_load_dwordx4 v73, s[4:7], s99 offen offset:0  lds
    s_add_u32 m0, s92, 75520
    s_nop 0
    buffer_load_dwordx4 v74, s[4:7], s99 offen offset:1088  lds
    s_mov_b32 m0, s37
    v_mov_b32 v242, 0x3f80
    v_cvt_pk_bf16_f32 v243, v186, v187
    v_pk_mul_f32 v[194:195], v[186:187], v[186:187] op_sel:[0,0] op_sel_hi:[0,1]
    v_pk_fma_f32 v[172:173], v[186:187], v[186:187], v[194:195] op_sel:[1,1,0] op_sel_hi:[1,0,1] neg_lo:[0,1,0]
    v_cvt_pk_bf16_f32 v244, v172, v173
    v_pk_mul_f32 v[194:195], v[172:173], v[186:187] op_sel:[0,0] op_sel_hi:[0,1]
    v_pk_fma_f32 v[174:175], v[172:173], v[186:187], v[194:195] op_sel:[1,1,0] op_sel_hi:[1,0,1] neg_lo:[0,1,0]
    v_cvt_pk_bf16_f32 v245, v174, v175
    v_pk_mul_f32 v[194:195], v[174:175], v[186:187] op_sel:[0,0] op_sel_hi:[0,1]
    v_pk_fma_f32 v[172:173], v[174:175], v[186:187], v[194:195] op_sel:[1,1,0] op_sel_hi:[1,0,1] neg_lo:[0,1,0]
    v_cvt_pk_bf16_f32 v246, v172, v173
    v_pk_mul_f32 v[194:195], v[172:173], v[186:187] op_sel:[0,0] op_sel_hi:[0,1]
    v_pk_fma_f32 v[174:175], v[172:173], v[186:187], v[194:195] op_sel:[1,1,0] op_sel_hi:[1,0,1] neg_lo:[0,1,0]
    v_cvt_pk_bf16_f32 v247, v174, v175
    v_pk_mul_f32 v[194:195], v[174:175], v[186:187] op_sel:[0,0] op_sel_hi:[0,1]
    v_pk_fma_f32 v[172:173], v[174:175], v[186:187], v[194:195] op_sel:[1,1,0] op_sel_hi:[1,0,1] neg_lo:[0,1,0]
    v_cvt_pk_bf16_f32 v248, v172, v173
    v_pk_mul_f32 v[194:195], v[172:173], v[186:187] op_sel:[0,0] op_sel_hi:[0,1]
    v_pk_fma_f32 v[174:175], v[172:173], v[186:187], v[194:195] op_sel:[1,1,0] op_sel_hi:[1,0,1] neg_lo:[0,1,0]
    v_cvt_pk_bf16_f32 v249, v174, v175
    v_pk_mul_f32 v[194:195], v[174:175], v[186:187] op_sel:[0,0] op_sel_hi:[0,1]
    v_pk_fma_f32 v[172:173], v[174:175], v[186:187], v[194:195] op_sel:[1,1,0] op_sel_hi:[1,0,1] neg_lo:[0,1,0]
    v_cvt_pk_bf16_f32 v250, v172, v173
    v_pk_mul_f32 v[194:195], v[172:173], v[186:187] op_sel:[0,0] op_sel_hi:[0,1]
    s_waitcnt vmcnt(12)
    v_cmp_gt_u32 vcc, 32, v7
    s_nop 0
    s_and_b64 vcc, vcc, s[50:51]
    s_cbranch_scc1 ps_8
pc_10:
    s_barrier
    v_pk_fma_f32 v[174:175], v[172:173], v[186:187], v[194:195] op_sel:[1,1,0] op_sel_hi:[1,0,1] neg_lo:[0,1,0]
    v_cvt_pk_bf16_f32 v251, v174, v175
    ds_write_addtid_b32 v242 offset:0
    ds_write_addtid_b32 v243 offset:272
    ds_write_addtid_b32 v244 offset:544
    ds_write_addtid_b32 v245 offset:816
    ds_write_addtid_b32 v246 offset:1088
    ds_write_addtid_b32 v247 offset:1360
    ds_write_addtid_b32 v248 offset:1632
    ds_write_addtid_b32 v249 offset:1904
    ds_write_addtid_b32 v250 offset:2176
    ds_write_addtid_b32 v251 offset:2448
    v_pk_mul_f32 v[194:195], v[174:175], v[186:187] op_sel:[0,0] op_sel_hi:[0,1]
    v_pk_fma_f32 v[172:173], v[174:175], v[186:187], v[194:195] op_sel:[1,1,0] op_sel_hi:[1,0,1] neg_lo:[0,1,0]
    v_cvt_pk_bf16_f32 v242, v172, v173
    v_pk_mul_f32 v[194:195], v[172:173], v[186:187] op_sel:[0,0] op_sel_hi:[0,1]
    v_pk_fma_f32 v[174:175], v[172:173], v[186:187], v[194:195] op_sel:[1,1,0] op_sel_hi:[1,0,1] neg_lo:[0,1,0]
    v_cvt_pk_bf16_f32 v243, v174, v175
    buffer_load_dwordx4 a[0:3], v200, s[16:19], s101 offen offset:0 sc1
    v_pk_mul_f32 v[194:195], v[174:175], v[186:187] op_sel:[0,0] op_sel_hi:[0,1]
    v_pk_fma_f32 v[172:173], v[174:175], v[186:187], v[194:195] op_sel:[1,1,0] op_sel_hi:[1,0,1] neg_lo:[0,1,0]
    v_cvt_pk_bf16_f32 v244, v172, v173
    v_pk_mul_f32 v[194:195], v[172:173], v[186:187] op_sel:[0,0] op_sel_hi:[0,1]
    v_pk_fma_f32 v[174:175], v[172:173], v[186:187], v[194:195] op_sel:[1,1,0] op_sel_hi:[1,0,1] neg_lo:[0,1,0]
    v_cvt_pk_bf16_f32 v245, v174, v175
    v_pk_mul_f32 v[194:195], v[174:175], v[186:187] op_sel:[0,0] op_sel_hi:[0,1]
    v_pk_fma_f32 v[172:173], v[174:175], v[186:187], v[194:195] op_sel:[1,1,0] op_sel_hi:[1,0,1] neg_lo:[0,1,0]
    v_cvt_pk_bf16_f32 v246, v172, v173
    v_pk_mul_f32 v[194:195], v[172:173], v[186:187] op_sel:[0,0] op_sel_hi:[0,1]
    v_pk_fma_f32 v[174:175], v[172:173], v[186:187], v[194:195] op_sel:[1,1,0] op_sel_hi:[1,0,1] neg_lo:[0,1,0]
    v_cvt_pk_bf16_f32 v247, v174, v175
    v_pk_mul_f32 v[194:195], v[174:175], v[186:187] op_sel:[0,0] op_sel_hi:[0,1]
    v_pk_fma_f32 v[172:173], v[174:175], v[186:187], v[194:195] op_sel:[1,1,0] op_sel_hi:[1,0,1] neg_lo:[0,1,0]
    v_cvt_pk_bf16_f32 v248, v172, v173
    v_pk_mul_f32 v[194:195], v[172:173], v[186:187] op_sel:[0,0] op_sel_hi:[0,1]
    v_pk_fma_f32 v[174:175], v[172:173], v[186:187], v[194:195] op_sel:[1,1,0] op_sel_hi:[1,0,1] neg_lo:[0,1,0]
    v_cvt_pk_bf16_f32 v249, v174, v175
    buffer_load_dwordx4 a[4:7], v200, s[16:19], s101 offen offset:1024 sc1
    v_pk_mul_f32 v[194:195], v[174:175], v[186:187] op_sel:[0,0] op_sel_hi:[0,1]
    v_pk_fma_f32 v[172:173], v[174:175], v[186:187], v[194:195] op_sel:[1,1,0] op_sel_hi:[1,0,1] neg_lo:[0,1,0]
    v_cvt_pk_bf16_f32 v250, v172, v173
    v_pk_mul_f32 v[194:195], v[172:173], v[186:187] op_sel:[0,0] op_sel_hi:[0,1]
    v_pk_fma_f32 v[174:175], v[172:173], v[186:187], v[194:195] op_sel:[1,1,0] op_sel_hi:[1,0,1] neg_lo:[0,1,0]
    v_cvt_pk_bf16_f32 v251, v174, v175
    ds_write_addtid_b32 v242 offset:2720
    ds_write_addtid_b32 v243 offset:2992
    ds_write_addtid_b32 v244 offset:3264
    ds_write_addtid_b32 v245 offset:3536
    ds_write_addtid_b32 v246 offset:3808
    ds_write_addtid_b32 v247 offset:4080
    ds_write_addtid_b32 v248 offset:4352
    ds_write_addtid_b32 v249 offset:4624
    ds_write_addtid_b32 v250 offset:4896
    ds_write_addtid_b32 v251 offset:5168
    v_pk_mul_f32 v[194:195], v[174:175], v[186:187] op_sel:[0,0] op_sel_hi:[0,1]
    v_pk_fma_f32 v[172:173], v[174:175], v[186:187], v[194:195] op_sel:[1,1,0] op_sel_hi:[1,0,1] neg_lo:[0,1,0]
    buffer_load_dwordx4 a[8:11], v200, s[16:19], s101 offen offset:2048 sc1
    v_cvt_pk_bf16_f32 v242, v172, v173
    v_pk_mul_f32 v[194:195], v[172:173], v[186:187] op_sel:[0,0] op_sel_hi:[0,1]
    v_pk_fma_f32 v[174:175], v[172:173], v[186:187], v[194:195] op_sel:[1,1,0] op_sel_hi:[1,0,1] neg_lo:[0,1,0]
    v_cvt_pk_bf16_f32 v243, v174, v175
    v_pk_mul_f32 v[194:195], v[174:175], v[186:187] op_sel:[0,0] op_sel_hi:[0,1]
    v_pk_fma_f32 v[172:173], v[174:175], v[186:187], v[194:195] op_sel:[1,1,0] op_sel_hi:[1,0,1] neg_lo:[0,1,0]
    v_cvt_pk_bf16_f32 v244, v172, v173
    v_pk_mul_f32 v[194:195], v[172:173], v[186:187] op_sel:[0,0] op_sel_hi:[0,1]
    v_pk_fma_f32 v[174:175], v[172:173], v[186:187], v[194:195] op_sel:[1,1,0] op_sel_hi:[1,0,1] neg_lo:[0,1,0]
    v_cvt_pk_bf16_f32 v245, v174, v175
    v_pk_mul_f32 v[194:195], v[174:175], v[186:187] op_sel:[0,0] op_sel_hi:[0,1]
    v_pk_fma_f32 v[172:173], v[174:175], v[186:187], v[194:195] op_sel:[1,1,0] op_sel_hi:[1,0,1] neg_lo:[0,1,0]
    v_cvt_pk_bf16_f32 v246, v172, v173
    v_pk_mul_f32 v[194:195], v[172:173], v[186:187] op_sel:[0,0] op_sel_hi:[0,1]
    v_pk_fma_f32 v[174:175], v[172:173], v[186:187], v[194:195] op_sel:[1,1,0] op_sel_hi:[1,0,1] neg_lo:[0,1,0]
    v_cvt_pk_bf16_f32 v247, v174, v175
    v_pk_mul_f32 v[194:195], v[174:175], v[186:187] op_sel:[0,0] op_sel_hi:[0,1]
    v_pk_fma_f32 v[172:173], v[174:175], v[186:187], v[194:195] op_sel:[1,1,0] op_sel_hi:[1,0,1] neg_lo:[0,1,0]
    buffer_load_dwordx4 a[12:15], v200, s[16:19], s101 offen offset:3072 sc1
    v_cvt_pk_bf16_f32 v248, v172, v173
    v_pk_mul_f32 v[194:195], v[172:173], v[186:187] op_sel:[0,0] op_sel_hi:[0,1]
    v_pk_fma_f32 v[174:175], v[172:173], v[186:187], v[194:195] op_sel:[1,1,0] op_sel_hi:[1,0,1] neg_lo:[0,1,0]
    v_cvt_pk_bf16_f32 v249, v174, v175
    v_pk_mul_f32 v[194:195], v[174:175], v[186:187] op_sel:[0,0] op_sel_hi:[0,1]
    v_pk_fma_f32 v[172:173], v[174:175], v[186:187], v[194:195] op_sel:[1,1,0] op_sel_hi:[1,0,1] neg_lo:[0,1,0]
    v_cvt_pk_bf16_f32 v250, v172, v173
    v_pk_mul_f32 v[194:195], v[172:173], v[186:187] op_sel:[0,0] op_sel_hi:[0,1]
    v_pk_fma_f32 v[174:175], v[172:173], v[186:187], v[194:195] op_sel:[1,1,0] op_sel_hi:[1,0,1] neg_lo:[0,1,0]
    v_cvt_pk_bf16_f32 v251, v174, v175
    ds_write_addtid_b32 v242 offset:5440
    ds_write_addtid_b32 v243 offset:5712
    ds_write_addtid_b32 v244 offset:5984
    ds_write_addtid_b32 v245 offset:6256
    ds_write_addtid_b32 v246 offset:6528
    ds_write_addtid_b32 v247 offset:6800
    ds_write_addtid_b32 v248 offset:7072
    ds_write_addtid_b32 v249 offset:7344
    s_add_u32 s101, s101, 4096
    buffer_load_dwordx4 a[16:19], v200, s[16:19], s101 offen offset:0 sc1
    ds_write_addtid_b32 v250 offset:7616
    ds_write_addtid_b32 v251 offset:7888
    v_pk_mul_f32 v[194:195], v[174:175], v[186:187] op_sel:[0,0] op_sel_hi:[0,1]
    v_pk_fma_f32 v[172:173], v[174:175], v[186:187], v[194:195] op_sel:[1,1,0] op_sel_hi:[1,0,1] neg_lo:[0,1,0]
    v_cvt_pk_bf16_f32 v242, v172, v173
    v_pk_mul_f32 v[194:195], v[172:173], v[186:187] op_sel:[0,0] op_sel_hi:[0,1]
    v_pk_fma_f32 v[174:175], v[172:173], v[186:187], v[194:195] op_sel:[1,1,0] op_sel_hi:[1,0,1] neg_lo:[0,1,0]
    v_cvt_pk_bf16_f32 v243, v174, v175
    ds_write_addtid_b32 v242 offset:8160
    ds_write_addtid_b32 v243 offset:8432
    ds_read_b128 a[160:163], v252 offset:0
    ds_read_b128 a[164:167], v252 offset:32
    ds_read_b128 a[168:171], v252 offset:64
    ds_read_b128 a[172:175], v252 offset:96
    ds_read_b128 a[176:179], v252 offset:128
    ds_read_b128 a[180:183], v252 offset:160
    ds_read_b128 a[184:187], v252 offset:192
    ds_read_b128 a[188:191], v252 offset:224
    buffer_load_dwordx4 a[20:23], v200, s[16:19], s101 offen offset:1024 sc1
    v_pk_mul_f32 v[194:195], v[180:181], v[180:181] op_sel:[0,0] op_sel_hi:[0,1]
    v_pk_fma_f32 v[182:183], v[180:181], v[180:181], v[194:195] op_sel:[1,1,0] op_sel_hi:[1,0,1] neg_lo:[0,1,0]
    v_pk_mul_f32 v[194:195], v[182:183], v[182:183] op_sel:[0,0] op_sel_hi:[0,1]
    v_pk_fma_f32 v[184:185], v[182:183], v[182:183], v[194:195] op_sel:[1,1,0] op_sel_hi:[1,0,1] neg_lo:[0,1,0]
    v_cvt_pk_bf16_f32 v242, v192, -v193
    v_pk_mul_f32 v[194:195], v[192:193], v[180:181] op_sel:[0,0] op_sel_hi:[0,1]
    v_pk_fma_f32 v[174:175], v[192:193], v[180:181], v[194:195] op_sel:[1,1,0] op_sel_hi:[1,0,1] neg_lo:[0,1,0]
    v_cvt_pk_bf16_f32 v243, v174, -v175
    v_pk_mul_f32 v[194:195], v[174:175], v[180:181] op_sel:[0,0] op_sel_hi:[0,1]
    v_pk_fma_f32 v[172:173], v[174:175], v[180:181], v[194:195] op_sel:[1,1,0] op_sel_hi:[1,0,1] neg_lo:[0,1,0]
    v_cvt_pk_bf16_f32 v244, v172, -v173
    v_pk_mul_f32 v[194:195], v[172:173], v[180:181] op_sel:[0,0] op_sel_hi:[0,1]
    v_pk_fma_f32 v[174:175], v[172:173], v[180:181], v[194:195] op_sel:[1,1,0] op_sel_hi:[1,0,1] neg_lo:[0,1,0]
    v_cvt_pk_bf16_f32 v245, v174, -v175
    v_pk_mul_f32 v[194:195], v[174:175], v[180:181] op_sel:[0,0] op_sel_hi:[0,1]
    v_pk_fma_f32 v[172:173], v[174:175], v[180:181], v[194:195] op_sel:[1,1,0] op_sel_hi:[1,0,1] neg_lo:[0,1,0]
    v_cvt_pk_bf16_f32 v246, v172, -v173
    v_pk_mul_f32 v[194:195], v[172:173], v[180:181] op_sel:[0,0] op_sel_hi:[0,1]
    buffer_load_dwordx4 a[24:27], v200, s[16:19], s101 offen offset:2048 sc1
    v_pk_fma_f32 v[174:175], v[172:173], v[180:181], v[194:195] op_sel:[1,1,0] op_sel_hi:[1,0,1] neg_lo:[0,1,0]
    v_cvt_pk_bf16_f32 v247, v174, -v175
    v_pk_mul_f32 v[194:195], v[174:175], v[180:181] op_sel:[0,0] op_sel_hi:[0,1]
    v_pk_fma_f32 v[172:173], v[174:175], v[180:181], v[194:195] op_sel:[1,1,0] op_sel_hi:[1,0,1] neg_lo:[0,1,0]
    v_cvt_pk_bf16_f32 v248, v172, -v173
    v_pk_mul_f32 v[194:195], v[172:173], v[180:181] op_sel:[0,0] op_sel_hi:[0,1]
    v_pk_fma_f32 v[174:175], v[172:173], v[180:181], v[194:195] op_sel:[1,1,0] op_sel_hi:[1,0,1] neg_lo:[0,1,0]
    v_cvt_pk_bf16_f32 v249, v174, -v175
    v_pk_mul_f32 v[194:195], v[192:193], v[190:191] op_sel:[0,0] op_sel_hi:[0,1]
    v_pk_fma_f32 v[176:177], v[192:193], v[190:191], v[194:195] op_sel:[1,1,0] op_sel_hi:[1,0,1] neg_lo:[0,1,0]
    v_cvt_pk_bf16_f32 v250, v176, -v177
    v_pk_mul_f32 v[194:195], v[176:177], v[182:183] op_sel:[0,0] op_sel_hi:[0,1]
    v_pk_fma_f32 v[174:175], v[176:177], v[182:183], v[194:195] op_sel:[1,1,0] op_sel_hi:[1,0,1] neg_lo:[0,1,0]
    v_cvt_pk_bf16_f32 v251, v174, -v175
    ds_write_addtid_b32 v242 offset:0
    ds_write_addtid_b32 v243 offset:272
    ds_write_addtid_b32 v244 offset:544
    ds_write_addtid_b32 v245 offset:816
    buffer_load_dwordx4 a[28:31], v200, s[16:19], s101 offen offset:3072 sc1
    ds_write_addtid_b32 v246 offset:1088
    ds_write_addtid_b32 v247 offset:1360
    ds_write_addtid_b32 v248 offset:1632
    ds_write_addtid_b32 v249 offset:1904
    ds_write_addtid_b32 v250 offset:2176
    ds_write_addtid_b32 v251 offset:2448
    v_pk_mul_f32 v[194:195], v[174:175], v[182:183] op_sel:[0,0] op_sel_hi:[0,1]
    v_pk_fma_f32 v[172:173], v[174:175], v[182:183], v[194:195] op_sel:[1,1,0] op_sel_hi:[1,0,1] neg_lo:[0,1,0]
    v_cvt_pk_bf16_f32 v242, v172, -v173
    v_pk_mul_f32 v[194:195], v[172:173], v[182:183] op_sel:[0,0] op_sel_hi:[0,1]
    v_pk_fma_f32 v[174:175], v[172:173], v[182:183], v[194:195] op_sel:[1,1,0] op_sel_hi:[1,0,1] neg_lo:[0,1,0]
    v_cvt_pk_bf16_f32 v243, v174, -v175
    v_pk_mul_f32 v[194:195], v[174:175], v[182:183] op_sel:[0,0] op_sel_hi:[0,1]
    v_pk_fma_f32 v[172:173], v[174:175], v[182:183], v[194:195] op_sel:[1,1,0] op_sel_hi:[1,0,1] neg_lo:[0,1,0]
    v_cvt_pk_bf16_f32 v244, v172, -v173
    v_pk_mul_f32 v[194:195], v[176:177], v[190:191] op_sel:[0,0] op_sel_hi:[0,1]
    v_pk_fma_f32 v[178:179], v[176:177], v[190:191], v[194:195] op_sel:[1,1,0] op_sel_hi:[1,0,1] neg_lo:[0,1,0]
    v_cvt_pk_bf16_f32 v245, v178, -v179
    s_add_u32 s101, s101, 4096
    buffer_load_dwordx4 a[32:35], v200, s[16:19], s101 offen offset:0 sc1
    v_pk_mul_f32 v[194:195], v[178:179], v[184:185] op_sel:[0,0] op_sel_hi:[0,1]
    v_pk_fma_f32 v[174:175], v[178:179], v[184:185], v[194:195] op_sel:[1,1,0] op_sel_hi:[1,0,1] neg_lo:[0,1,0]
    v_cvt_pk_bf16_f32 v246, v174, -v175
    v_pk_mul_f32 v[194:195], v[174:175], v[184:185] op_sel:[0,0] op_sel_hi:[0,1]
    v_pk_fma_f32 v[172:173], v[174:175], v[184:185], v[194:195] op_sel:[1,1,0] op_sel_hi:[1,0,1] neg_lo:[0,1,0]
    v_cvt_pk_bf16_f32 v247, v172, -v173
    v_pk_mul_f32 v[194:195], v[178:179], v[190:191] op_sel:[0,0] op_sel_hi:[0,1]
    v_pk_fma_f32 v[176:177], v[178:179], v[190:191], v[194:195] op_sel:[1,1,0] op_sel_hi:[1,0,1] neg_lo:[0,1,0]
    v_cvt_pk_bf16_f32 v248, v176, -v177
    v_pk_mul_f32 v[194:195], v[176:177], v[184:185] op_sel:[0,0] op_sel_hi:[0,1]
    v_pk_fma_f32 v[174:175], v[176:177], v[184:185], v[194:195] op_sel:[1,1,0] op_sel_hi:[1,0,1] neg_lo:[0,1,0]
    v_cvt_pk_bf16_f32 v249, v174, -v175
    v_pk_mul_f32 v[194:195], v[174:175], v[184:185] op_sel:[0,0] op_sel_hi:[0,1]
    v_pk_fma_f32 v[172:173], v[174:175], v[184:185], v[194:195] op_sel:[1,1,0] op_sel_hi:[1,0,1] neg_lo:[0,1,0]
    v_cvt_pk_bf16_f32 v250, v172, -v173
    v_pk_mul_f32 v[194:195], v[176:177], v[190:191] op_sel:[0,0] op_sel_hi:[0,1]
    v_pk_fma_f32 v[178:179], v[176:177], v[190:191], v[194:195] op_sel:[1,1,0] op_sel_hi:[1,0,1] neg_lo:[0,1,0]
    v_cvt_pk_bf16_f32 v251, v178, -v179
    buffer_load_dwordx4 a[36:39], v200, s[16:19], s101 offen offset:1024 sc1
    ds_write_addtid_b32 v242 offset:2720
    ds_write_addtid_b32 v242 offset:3264
    ds_write_addtid_b32 v243 offset:3536
    ds_write_addtid_b32 v244 offset:3808
    ds_write_addtid_b32 v245 offset:4352
    ds_write_addtid_b32 v246 offset:4624
    ds_write_addtid_b32 v247 offset:4896
    ds_write_addtid_b32 v248 offset:5440
    ds_write_addtid_b32 v249 offset:5712
    ds_write_addtid_b32 v250 offset:5984
    ds_write_addtid_b32 v251 offset:6528
    v_pk_mul_f32 v[194:195], v[178:179], v[186:187] op_sel:[0,0] op_sel_hi:[0,1]
    v_pk_fma_f32 v[174:175], v[178:179], v[186:187], v[194:195] op_sel:[1,1,0] op_sel_hi:[1,0,1] neg_lo:[0,1,0]
    v_cvt_pk_bf16_f32 v242, v174, -v175
    v_pk_mul_f32 v[194:195], v[178:179], v[190:191] op_sel:[0,0] op_sel_hi:[0,1]
    v_pk_fma_f32 v[176:177], v[178:179], v[190:191], v[194:195] op_sel:[1,1,0] op_sel_hi:[1,0,1] neg_lo:[0,1,0]
    v_cvt_pk_bf16_f32 v243, v176, -v177
    v_pk_mul_f32 v[194:195], v[176:177], v[186:187] op_sel:[0,0] op_sel_hi:[0,1]
    buffer_load_dwordx4 a[40:43], v200, s[16:19], s101 offen offset:2048 sc1
    v_pk_fma_f32 v[174:175], v[176:177], v[186:187], v[194:195] op_sel:[1,1,0] op_sel_hi:[1,0,1] neg_lo:[0,1,0]
    v_cvt_pk_bf16_f32 v244, v174, -v175
    v_pk_mul_f32 v[194:195], v[176:177], v[190:191] op_sel:[0,0] op_sel_hi:[0,1]
    v_pk_fma_f32 v[178:179], v[176:177], v[190:191], v[194:195] op_sel:[1,1,0] op_sel_hi:[1,0,1] neg_lo:[0,1,0]
    v_cvt_pk_bf16_f32 v245, v178, -v179
    v_pk_mul_f32 v[194:195], v[178:179], v[186:187] op_sel:[0,0] op_sel_hi:[0,1]
    v_pk_fma_f32 v[174:175], v[178:179], v[186:187], v[194:195] op_sel:[1,1,0] op_sel_hi:[1,0,1] neg_lo:[0,1,0]
    v_cvt_pk_bf16_f32 v246, v174, -v175
    v_pk_mul_f32 v[194:195], v[178:179], v[190:191] op_sel:[0,0] op_sel_hi:[0,1]
    v_pk_fma_f32 v[176:177], v[178:179], v[190:191], v[194:195] op_sel:[1,1,0] op_sel_hi:[1,0,1] neg_lo:[0,1,0]
    v_cvt_pk_bf16_f32 v247, v176, -v177
    v_pk_mul_f32 v[194:195], v[176:177], v[186:187] op_sel:[0,0] op_sel_hi:[0,1]
    v_pk_fma_f32 v[174:175], v[176:177], v[186:187], v[194:195] op_sel:[1,1,0] op_sel_hi:[1,0,1] neg_lo:[0,1,0]
    v_cvt_pk_bf16_f32 v248, v174, -v175
    ds_write_addtid_b32 v242 offset:6800
    ds_write_addtid_b32 v243 offset:7072
    ds_write_addtid_b32 v244 offset:7344
    ds_write_addtid_b32 v245 offset:7616
    buffer_load_dwordx4 a[44:47], v200, s[16:19], s101 offen offset:3072 sc1
    ds_write_addtid_b32 v246 offset:7888
    ds_write_addtid_b32 v247 offset:8160
    ds_write_addtid_b32 v248 offset:8432
    ds_read_b128 a[192:195], v252 offset:0
    ds_read_b128 a[196:199], v252 offset:32
    ds_read_b128 a[200:203], v252 offset:64
    ds_read_b128 a[204:207], v252 offset:96
    ds_read_b128 a[208:211], v252 offset:128
    ds_read_b128 a[212:215], v252 offset:160
    ds_read_b128 a[216:219], v252 offset:192
    ds_read_b128 a[220:223], v252 offset:224
    s_add_u32 m0, s92, 75520
    s_nop 0
    buffer_load_dwordx4 v75, s[4:7], s99 offen offset:2176  lds
    s_waitcnt lgkmcnt(7)
    v_mfma_f32_32x32x16_bf16 v[216:231], a[192:195], a[160:163], v[216:231]
    s_add_u32 m0, s92, 75520
    s_nop 0
    buffer_load_dwordx4 v76, s[4:7], s99 offen offset:3264  lds
    s_waitcnt lgkmcnt(6)
    v_mfma_f32_32x32x16_bf16 v[216:231], a[196:199], a[164:167], v[216:231]
    s_add_u32 m0, s93, 92928
    s_add_u32 s101, s101, 4096
    buffer_load_dwordx4 a[48:51], v200, s[16:19], s101 offen offset:0 sc1
    s_add_u32 s99, s99, 256
    s_mov_b64 exec, s[80:81]
    buffer_load_dwordx4 v77, s[4:7], s100 offen  lds
    s_mov_b64 exec, -1
    s_add_u32 s100, s100, 256
    s_waitcnt lgkmcnt(5)
    v_mfma_f32_32x32x16_bf16 v[216:231], a[200:203], a[168:171], v[216:231]
    s_add_u32 m0, s92, 95104
    s_nop 0
    buffer_load_dwordx4 v73, s[4:7], s99 offen offset:0  lds
    s_waitcnt lgkmcnt(4)
    v_mfma_f32_32x32x16_bf16 v[216:231], a[204:207], a[172:175], v[216:231]
    s_add_u32 m0, s92, 95104
    s_nop 0
    buffer_load_dwordx4 v74, s[4:7], s99 offen offset:1088  lds
    s_waitcnt lgkmcnt(3)
    v_mfma_f32_32x32x16_bf16 v[216:231], a[208:211], a[176:179], v[216:231]
    s_add_u32 m0, s92, 95104
    s_nop 0
    buffer_load_dwordx4 v75, s[4:7], s99 offen offset:2176  lds
    s_waitcnt lgkmcnt(2)
    v_mfma_f32_32x32x16_bf16 v[216:231], a[212:215], a[180:183], v[216:231]
    s_add_u32 m0, s92, 95104
    s_nop 0
    buffer_load_dwordx4 v76, s[4:7], s99 offen offset:3264  lds
    s_waitcnt lgkmcnt(1)
    v_mfma_f32_32x32x16_bf16 v[216:231], a[216:219], a[184:187], v[216:231]
    buffer_load_dwordx4 a[52:55], v200, s[16:19], s101 offen offset:1024 sc1
    s_add_u32 m0, s93, 112512
    s_add_u32 s99, s99, 256
    s_mov_b64 exec, s[80:81]
    buffer_load_dwordx4 v77, s[4:7], s100 offen  lds
    s_mov_b64 exec, -1
    s_add_u32 s100, s100, 256
    s_waitcnt lgkmcnt(0)
    v_mfma_f32_32x32x16_bf16 v[216:231], a[220:223], a[188:191], v[216:231]
    s_add_u32 m0, s92, 114688
    s_nop 0
    buffer_load_dwordx4 v73, s[4:7], s99 offen offset:0  lds
    s_add_u32 m0, s92, 114688
    s_nop 0
    buffer_load_dwordx4 v74, s[4:7], s99 offen offset:1088  lds
    s_add_u32 m0, s92, 114688
    s_nop 0
    buffer_load_dwordx4 v75, s[4:7], s99 offen offset:2176  lds
    s_add_u32 m0, s92, 114688
    s_nop 0
    buffer_load_dwordx4 v76, s[4:7], s99 offen offset:3264  lds
    s_add_u32 m0, s93, 132096
    s_add_u32 s99, s99, 256
    s_mov_b64 exec, s[80:81]
    buffer_load_dwordx4 v77, s[4:7], s100 offen  lds
    s_mov_b64 exec, -1
    s_add_u32 s100, s100, 256
    s_mov_b32 m0, s37
    s_branch ec_4
nc_3:
    s_sub_u32 s33, s2, 160
    s_min_u32 s33, s33, 159
    s_mul_i32 s29, s33, 3277
    s_lshr_b32 s29, s29, 16
    s_mul_i32 s30, s29, 20
    s_sub_u32 s30, s33, s30
    s_mul_i32 s31, s30, 13108
    s_lshr_b32 s31, s31, 16
    s_mul_i32 s32, s31, 5
    s_sub_u32 s32, s30, s32
    s_lshl_b32 s28, s24, 10
    s_lshr_b32 s34, s32, 1
    s_mul_i32 s34, s34, 20
    s_and_b32 s35, s32, 1
    s_lshl_b32 s35, s35, 3
    s_add_u32 s34, s34, s35
    s_cmp_eq_u32 s32, 4
    s_cselect_b32 s34, 16, s34
    s_cselect_b32 s35, 20, 4
    s_mul_i32 s36, s31, 160
    s_add_u32 s34, s34, s36
    s_mul_i32 s34, s34, 1280
    s_mul_i32 s36, s29, 160
    s_add_u32 s34, s34, s36
    v_add_u32 v162, 0, v0
    v_mul_u32_u24 v160, 6554, v162
    v_lshrrev_b32 v160, 16, v160
    v_mul_u32_u24 v161, 10, v160
    v_sub_u32 v161, v162, v161
    v_lshrrev_b32 v163, 3, v160
    v_mul_u32_u24 v163, 40, v163
    v_bfe_u32 v164, v160, 2, 1
    v_mul_u32_u24 v164, s35, v164
    v_and_b32_e64 v160, 3, v160
    v_add3_u32 v160, v160, v163, v164
    v_mul_u32_u24 v160, 1280, v160
    v_lshl_add_u32 v162, v161, 4, v160
    s_add_u32 m0, s28, 0
    s_nop 0
    buffer_load_dwordx4 v162, s[12:15], s34 offen lds
    v_add_u32 v162, 256, v0
    v_min_u32 v162, 319, v162
    v_mul_u32_u24 v160, 6554, v162
    v_lshrrev_b32 v160, 16, v160
    v_mul_u32_u24 v161, 10, v160
    v_sub_u32 v161, v162, v161
    v_lshrrev_b32 v163, 3, v160
    v_mul_u32_u24 v163, 40, v163
    v_bfe_u32 v164, v160, 2, 1
    v_mul_u32_u24 v164, s35, v164
    v_and_b32_e64 v160, 3, v160
    v_add3_u32 v160, v160, v163, v164
    v_mul_u32_u24 v160, 1280, v160
    v_lshl_add_u32 v162, v161, 4, v160
    s_add_u32 m0, s28, 4096
    s_nop 0
    buffer_load_dwordx4 v162, s[12:15], s34 offen lds
    v_bfe_u32 v163, v0, 4, 2
    v_bfe_u32 v164, v0, 2, 2
    v_lshl_add_u32 v163, v163, 3, v164
    v_mul_u32_u24 v163, 160, v163
    v_and_b32 v164, 3, v0
    v_lshl_add_u32 v165, v164, 3, v163
    v_add_u32 v165, 0, v165
    s_lshl_b32 s36, s24, 5
    v_add_u32_e64 v166, s36, v165
    s_mul_i32 s33, s33, 5120
    s_add_u32 s33, s33, 2621440
    v_lshl_add_u32 v167, v1, 4, s33
    v_add_u32 v164, 4096, v167
    v_mov_b32 v163, 1073741824
    v_cmp_gt_u32 vcc, 64, v0
    s_sub_u32 s36, s24, s31
    s_and_b32 s36, s36, 3
    s_lshl_b32 s36, s36, 10
    v_cndmask_b32 v168, v163, v164, vcc
    v_add_u32 v167, s36, v167
    s_sub_u32 s33, s2, 64
    s_min_u32 s33, s33, 159
    s_mul_i32 s29, s33, 3277
    s_lshr_b32 s29, s29, 16
    s_mul_i32 s30, s29, 20
    s_sub_u32 s30, s33, s30
    s_mul_i32 s31, s30, 13108
    s_lshr_b32 s31, s31, 16
    s_mul_i32 s32, s31, 5
    s_sub_u32 s32, s30, s32
    s_lshl_b32 s28, s24, 10
    s_lshr_b32 s34, s32, 1
    s_mul_i32 s34, s34, 20
    s_and_b32 s35, s32, 1
    s_lshl_b32 s35, s35, 3
    s_add_u32 s34, s34, s35
    s_cmp_eq_u32 s32, 4
    s_cselect_b32 s34, 16, s34
    s_cselect_b32 s35, 20, 4
    s_mul_i32 s36, s31, 160
    s_add_u32 s34, s34, s36
    s_mul_i32 s34, s34, 1280
    s_mul_i32 s36, s29, 160
    s_add_u32 s34, s34, s36
    v_add_u32 v182, 0, v0
    v_mul_u32_u24 v180, 6554, v182
    v_lshrrev_b32 v180, 16, v180
    v_mul_u32_u24 v181, 10, v180
    v_sub_u32 v181, v182, v181
    v_lshrrev_b32 v183, 3, v180
    v_mul_u32_u24 v183, 40, v183
    v_bfe_u32 v184, v180, 2, 1
    v_mul_u32_u24 v184, s35, v184
    v_and_b32_e64 v180, 3, v180
    v_add3_u32 v180, v180, v183, v184
    v_mul_u32_u24 v180, 1280, v180
    v_lshl_add_u32 v182, v181, 4, v180
    s_add_u32 m0, s28, 8192
    s_nop 0
    buffer_load_dwordx4 v182, s[12:15], s34 offen lds
    v_add_u32 v182, 256, v0
    v_min_u32 v182, 319, v182
    v_mul_u32_u24 v180, 6554, v182
    v_lshrrev_b32 v180, 16, v180
    v_mul_u32_u24 v181, 10, v180
    v_sub_u32 v181, v182, v181
    v_lshrrev_b32 v183, 3, v180
    v_mul_u32_u24 v183, 40, v183
    v_bfe_u32 v184, v180, 2, 1
    v_mul_u32_u24 v184, s35, v184
    v_and_b32 v180, 3, v180
    v_add3_u32 v180, v180, v183, v184
    v_mul_u32_u24 v180, 1280, v180
    v_lshl_add_u32 v182, v181, 4, v180
    s_add_u32 m0, s28, 12288
    s_nop 0
    buffer_load_dwordx4 v182, s[12:15], s34 offen lds
    v_bfe_u32 v183, v0, 4, 2
    v_bfe_u32 v184, v0, 2, 2
    v_lshl_add_u32 v183, v183, 3, v184
    v_mul_u32_u24 v183, 160, v183
    v_and_b32 v184, 3, v0
    v_lshl_add_u32 v185, v184, 3, v183
    v_add_u32 v185, 8192, v185
    s_lshl_b32 s36, s24, 5
    v_add_u32 v186, s36, v185
    s_mul_i32 s33, s33, 5120
    s_add_u32 s33, s33, 2621440
    v_lshl_add_u32 v187, v1, 4, s33
    v_add_u32 v184, 4096, v187
    v_mov_b32 v183, 1073741824
    v_cmp_gt_u32 vcc, 64, v0
    s_sub_u32 s36, s24, s31
    s_and_b32 s36, s36, 3
    s_lshl_b32 s36, s36, 10
    v_cndmask_b32 v188, v183, v184, vcc
    v_add_u32 v187, s36, v187
    v_mov_b32 v216, 0
    v_mov_b32 v217, 0
    v_mov_b32 v218, 0
    v_mov_b32 v219, 0
    v_mov_b32 v220, 0
    v_mov_b32 v221, 0
    v_mov_b32 v222, 0
    v_mov_b32 v223, 0
    v_mov_b32 v224, 0
    v_mov_b32 v225, 0
    v_mov_b32 v226, 0
    v_mov_b32 v227, 0
    v_mov_b32 v228, 0
    v_mov_b32 v229, 0
    v_mov_b32 v230, 0
    v_mov_b32_e64 v231, 0
    s_waitcnt vmcnt(5)
    s_barrier
    ds_read_b64_tr_b16 v[96:97], v111
    ds_read_b64_tr_b16 v[98:99], v111 offset:2560
    ds_read_b64_tr_b16 v[100:101], v112
    ds_read_b64_tr_b16 v[102:103], v112 offset:2560
    ds_read_b64_tr_b16 v[104:105], v113
    ds_read_b64_tr_b16 v[106:107], v113 offset:2560
    s_waitcnt lgkmcnt(4)
    buffer_store_dwordx4 v[96:99], v108, s[16:19], 0 offen sc1
    s_waitcnt lgkmcnt(2)
    buffer_store_dwordx4 v[100:103], v109, s[16:19], 0 offen sc1
    s_waitcnt lgkmcnt(0)
    buffer_store_dwordx4 v[104:107], v110, s[16:19], 0 offen sc1
    global_load_dword v7, v5, s[66:67] sc1
    v_lshrrev_b32 v132, 5, v0
    v_and_b32_e64 v133, 31, v0
    v_mul_u32_u24 v132, 1280, v132
    v_lshl_add_u32 v134, v133, 4, v132
    v_mov_b32 v135, 1073741824
    v_cmp_gt_u32 vcc, 16, v133
    s_mul_i32 s96, s2, 10240
    buffer_load_dwordx4 v[120:123], v134, s[4:7], s96 offen
    v_cndmask_b32_e64 v135, v135, v134, vcc
    buffer_load_dwordx4 v[124:127], v134, s[4:7], s96 offen offset:512
    buffer_load_dwordx4 v[128:131], v135, s[4:7], s96 offen offset:1024
    s_waitcnt vmcnt(4)
    s_waitcnt vmcnt(3)
    v_cmp_gt_u32 vcc, 1, v7
    s_nop 0
    s_and_b64 vcc, vcc, s[50:51]
    s_and_b64 vcc, vcc, 1
    s_cbranch_scc1 ps_11
pc_13:
    s_barrier
    v_lshlrev_b32 v2, 3, v4
    v_mov_b32 v5, 1
    v_cndmask_b32 v2, v4, v2, s[50:51]
    buffer_atomic_add v5, v2, s[16:19], s86 offen offset:0 sc1
    ds_read_b64_tr_b16 v[172:173], v166
    ds_read_b64_tr_b16 v[174:175], v166 offset:640
    ds_read_b64_tr_b16 v[176:177], v165 offset:128
    ds_read_b64_tr_b16 v[178:179], v165 offset:768
    s_waitcnt lgkmcnt(2)
    buffer_store_dwordx4 v[172:175], v167, s[16:19], 0 offen sc1
    s_waitcnt lgkmcnt(0)
    buffer_store_dwordx4 v[176:179], v168, s[16:19], 0 offen sc1
    ds_read_b64_tr_b16 v[192:193], v186
    ds_read_b64_tr_b16 v[194:195], v186 offset:640
    ds_read_b64_tr_b16 v[196:197], v185 offset:128
    ds_read_b64_tr_b16 v[198:199], v185 offset:768
    s_waitcnt lgkmcnt(2)
    buffer_store_dwordx4 v[192:195], v187, s[16:19], 0 offen sc1
    s_waitcnt lgkmcnt(0)
    buffer_store_dwordx4 v[196:199], v188, s[16:19], 0 offen sc1
    v_mov_b32 v134, 0x3f803f80
    v_mov_b32 v132, 0
    v_mov_b32 v133, 0
    s_waitcnt vmcnt(7)
    v_dot2c_f32_bf16 v132, v120, v134
    v_dot2c_f32_bf16 v133, v120, v120
    v_dot2c_f32_bf16 v132, v121, v134
    v_dot2c_f32_bf16 v133, v121, v121
    v_dot2c_f32_bf16 v132, v122, v134
    v_dot2c_f32_bf16 v133, v122, v122
    v_dot2c_f32_bf16 v132, v123, v134
    v_dot2c_f32_bf16 v133, v123, v123
    s_waitcnt vmcnt(6)
    v_dot2c_f32_bf16 v132, v124, v134
    v_dot2c_f32_bf16 v133, v124, v124
    v_dot2c_f32_bf16 v132, v125, v134
    v_dot2c_f32_bf16 v133, v125, v125
    v_dot2c_f32_bf16 v132, v126, v134
    v_dot2c_f32_bf16 v133, v126, v126
    v_dot2c_f32_bf16 v132, v127, v134
    v_dot2c_f32_bf16 v133, v127, v127
    s_waitcnt vmcnt(5)
    v_dot2c_f32_bf16 v132, v128, v134
    v_dot2c_f32_bf16 v133, v128, v128
    v_dot2c_f32_bf16 v132, v129, v134
    v_dot2c_f32_bf16 v133, v129, v129
    v_dot2c_f32_bf16 v132, v130, v134
    v_dot2c_f32_bf16 v133, v130, v130
    v_dot2c_f32_bf16 v132, v131, v134
    v_dot2c_f32_bf16 v133, v131, v131
    v_lshrrev_b32 v135, 5, v0
    v_and_b32 v121, 3, v135
    v_lshrrev_b32 v135, 2, v135
    v_add_f32_dpp v132, v132, v132 row_shr:1 row_mask:0xf bank_mask:0xf bound_ctrl:0
    v_add_f32_dpp v133, v133, v133 row_shr:1 row_mask:0xf bank_mask:0xf bound_ctrl:0
    v_lshlrev_b32_e64 v135, 3, v135
    v_add_f32_dpp v132, v132, v132 row_shr:2 row_mask:0xf bank_mask:0xf bound_ctrl:0
    v_add_f32_dpp v133, v133, v133 row_shr:2 row_mask:0xf bank_mask:0xf bound_ctrl:0
    v_lshl_add_u32 v135, v121, 12, v135
    v_add_f32_dpp v132, v132, v132 row_shr:4 row_mask:0xf bank_mask:0xf bound_ctrl:0
    v_add_f32_dpp v133, v133, v133 row_shr:4 row_mask:0xf bank_mask:0xf bound_ctrl:0
    v_and_b32_e64 v121, 31, v0
    v_add_f32_dpp v132, v132, v132 row_shr:8 row_mask:0xf bank_mask:0xf bound_ctrl:0
    v_add_f32_dpp v133, v133, v133 row_shr:8 row_mask:0xf bank_mask:0xf bound_ctrl:0
    v_cmp_eq_u32_e64 vcc, 31, v121
    v_add_f32_dpp v132, v132, v132 row_bcast:15 row_mask:0xa bank_mask:0xf
    v_add_f32_dpp v133, v133, v133 row_bcast:15 row_mask:0xa bank_mask:0xf
    v_mov_b32 v121, 1073741824
    v_cndmask_b32_e64 v120, v121, v135, vcc
    s_lshl_b32 s96, s2, 4
    s_add_u32 s96, s96, 3440640
    v_mul_f32 v135, 0x3acccccd, v132
    v_mul_f32 v133, 0x3acccccd, v133
    v_fma_f32 v133, -v135, v135, v133
    v_max_f32 v133, 0, v133
    v_add_f32 v133, 0x3727c5ac, v133
    v_rsq_f32_e64 v132, v133
    s_nop 0
    v_mul_f32 v133, -v135, v132
    buffer_store_dwordx2 v[132:133], v120, s[16:19], s96 offen sc1
    s_add_u32 m0, s92, 36352
    s_nop 0
    s_nop 0
    buffer_load_dwordx4 v73, s[4:7], s99 offen offset:0  lds
    buffer_load_dwordx4 v74, s[4:7], s99 offen offset:1088  lds
    buffer_load_dwordx4 v75, s[4:7], s99 offen offset:2176  lds
    buffer_load_dwordx4 v76, s[4:7], s99 offen offset:3264  lds
    s_add_u32 m0, s93, 53760
    s_add_u32 s99, s99, 256
    s_mov_b64 exec, s[80:81]
    buffer_load_dwordx4 v77, s[4:7], s100 offen  lds
    s_mov_b64 exec, -1
    s_add_u32 s100, s100, 256
    s_add_u32 m0, s92, 55936
    s_nop 0
    s_nop 0
    buffer_load_dwordx4 v73, s[4:7], s99 offen offset:0  lds
    buffer_load_dwordx4 v74, s[4:7], s99 offen offset:1088  lds
    buffer_load_dwordx4 v75, s[4:7], s99 offen offset:2176  lds
    buffer_load_dwordx4 v76, s[4:7], s99 offen offset:3264  lds
    s_add_u32 m0, s93, 73344
    s_add_u32 s99, s99, 256
    s_mov_b64 exec, s[80:81]
    buffer_load_dwordx4 v77, s[4:7], s100 offen  lds
    s_mov_b64 exec, -1
    s_add_u32 s100, s100, 256
    v_mov_b32 v140, 1073741824
    v_lshlrev_b32 v141, 2, v0
    v_cmp_gt_u32 vcc, 64, v0
    s_nop 1
    v_cndmask_b32 v141, v140, v141, vcc
    v_mov_b32_e64 v140, 0
    s_lshl_b32 s97, s2, 8
    s_add_u32 s97, s97, 3473408
    buffer_store_dword v140, v141, s[16:19], s97 offen sc1
    v_mov_b32 v142, 1073741824
    v_lshlrev_b32 v143, 2, v0
    v_cmp_gt_u32 vcc, 16, v0
    s_nop 1
    v_cndmask_b32 v143, v142, v143, vcc
    v_mov_b32_e64 v142, -1
    s_lshl_b32 s97, s2, 6
    s_add_u32 s97, s97, 3457024
    buffer_store_dword v142, v143, s[16:19], s97 offen sc1
    v_mov_b32 v144, -1
    v_mov_b32 v145, -1
    v_mov_b32 v146, -1
    v_mov_b32 v147, -1
    v_lshlrev_b32 v148, 4, v0
    s_sub_u32 s88, s2, 0
    s_mul_i32 s88, s88, 20480
    s_min_u32 s88, s88, 5222400
    s_add_u32 s88, s88, 4194304
    buffer_store_dwordx4 v[144:147], v148, s[16:19], s88 offen sc1
    s_add_u32 s88, s88, 4096
    buffer_store_dwordx4 v[144:147], v148, s[16:19], s88 offen sc1
    s_add_u32 s88, s88, 4096
    buffer_store_dwordx4 v[144:147], v148, s[16:19], s88 offen sc1
    s_add_u32 s88, s88, 4096
    buffer_store_dwordx4 v[144:147], v148, s[16:19], s88 offen sc1
    s_add_u32 s88, s88, 4096
    buffer_store_dwordx4 v[144:147], v148, s[16:19], s88 offen sc1
    s_add_u32 m0, s92, 75520
    s_nop 0
    s_nop 0
    buffer_load_dwordx4 v73, s[4:7], s99 offen offset:0  lds
    buffer_load_dwordx4 v74, s[4:7], s99 offen offset:1088  lds
    buffer_load_dwordx4 v75, s[4:7], s99 offen offset:2176  lds
    buffer_load_dwordx4 v76, s[4:7], s99 offen offset:3264  lds
    s_add_u32 m0, s93, 92928
    s_add_u32 s99, s99, 256
    s_mov_b64 exec, s[80:81]
    buffer_load_dwordx4 v77, s[4:7], s100 offen  lds
    s_mov_b64 exec, -1
    s_add_u32 s100, s100, 256
    s_add_u32 m0, s92, 95104
    s_nop 0
    s_nop 0
    buffer_load_dwordx4 v73, s[4:7], s99 offen offset:0  lds
    buffer_load_dwordx4 v74, s[4:7], s99 offen offset:1088  lds
    buffer_load_dwordx4 v75, s[4:7], s99 offen offset:2176  lds
    buffer_load_dwordx4 v76, s[4:7], s99 offen offset:3264  lds
    s_add_u32 m0, s93, 112512
    s_add_u32 s99, s99, 256
    s_mov_b64 exec, s[80:81]
    buffer_load_dwordx4 v77, s[4:7], s100 offen  lds
    s_mov_b64 exec, -1
    s_add_u32 s100, s100, 256
    s_add_u32 m0, s92, 114688
    s_nop 0
    s_nop 0
    buffer_load_dwordx4 v73, s[4:7], s99 offen offset:0  lds
    buffer_load_dwordx4 v74, s[4:7], s99 offen offset:1088  lds
    buffer_load_dwordx4 v75, s[4:7], s99 offen offset:2176  lds
    buffer_load_dwordx4 v76, s[4:7], s99 offen offset:3264  lds
    s_add_u32 m0, s93, 132096
    s_add_u32 s99, s99, 256
    s_mov_b64 exec, s[80:81]
    buffer_load_dwordx4 v77, s[4:7], s100 offen  lds
    s_mov_b64 exec, -1
    s_add_u32 s100, s100, 256
    s_waitcnt vmcnt(15)
    buffer_load_dword v7, v4, s[16:19], s87 offen offset:0 sc1
    s_waitcnt vmcnt(0)
    v_cmp_gt_u32_e64 vcc, 32, v7
    s_nop 0
    s_and_b64 vcc, vcc, s[50:51]
    s_cbranch_scc1 ps_14
pc_16:
    s_barrier
    buffer_load_dwordx4 a[0:3], v200, s[16:19], s101 offen offset:0 sc1
    buffer_load_dwordx4 a[4:7], v200, s[16:19], s101 offen offset:1024 sc1
    buffer_load_dwordx4 a[8:11], v200, s[16:19], s101 offen offset:2048 sc1
    buffer_load_dwordx4 a[12:15], v200, s[16:19], s101 offen offset:3072 sc1
    s_add_u32 s101, s101, 4096
    buffer_load_dwordx4 a[16:19], v200, s[16:19], s101 offen offset:0 sc1
    buffer_load_dwordx4 a[20:23], v200, s[16:19], s101 offen offset:1024 sc1
    buffer_load_dwordx4 a[24:27], v200, s[16:19], s101 offen offset:2048 sc1
    buffer_load_dwordx4 a[28:31], v200, s[16:19], s101 offen offset:3072 sc1
    s_add_u32 s101, s101, 4096
    buffer_load_dwordx4 a[32:35], v200, s[16:19], s101 offen offset:0 sc1
    buffer_load_dwordx4 a[36:39], v200, s[16:19], s101 offen offset:1024 sc1
    buffer_load_dwordx4 a[40:43], v200, s[16:19], s101 offen offset:2048 sc1
    buffer_load_dwordx4 a[44:47], v200, s[16:19], s101 offen offset:3072 sc1
    s_add_u32 s101, s101, 4096
    buffer_load_dwordx4 a[48:51], v200, s[16:19], s101 offen offset:0 sc1
    buffer_load_dwordx4 a[52:55], v200, s[16:19], s101 offen offset:1024 sc1
ec_4:
    v_add_u32 v196, 36352, v78
    v_mov_b32 v198, v79
    v_xor_b32 v197, 32, v196
    s_waitcnt vmcnt(34)
    s_barrier
    s_add_u32 s82, s86, 16384
    v_lshlrev_b32 v2, 3, v4
    v_mov_b32 v5, 1
    v_cndmask_b32 v2, v4, v2, s[50:51]
    buffer_atomic_add v5, v2, s[16:19], s82 offen offset:8 sc1
    ds_read_b128 v[160:163], v198 offset:0
    ds_read_b128 v[164:167], v196 offset:0
    ds_read_b128 v[168:171], v196 offset:8704
    ds_read_b128 v[172:175], v198 offset:32
    ds_read_b128 v[176:179], v197 offset:0
    ds_read_b128 v[180:183], v197 offset:8704
    s_waitcnt lgkmcnt(3)
    s_waitcnt vmcnt(14)
    v_mfma_f32_16x16x32_bf16 v[112:115], a[0:3], v[160:163], 0
    ds_read_b128 v[184:187], v198 offset:64
    v_mfma_f32_32x32x16_bf16 v[80:95], a[0:3], v[164:167], 0
    ds_read_b128 v[188:191], v196 offset:64
    v_mov_b32 v208, 0
    v_mov_b32 v209, 0
    v_lshrrev_b32_e64 v210, 5, v0
    v_mul_u32_u24 v210, 1600, v210
    v_mfma_f32_32x32x16_bf16 v[96:111], a[0:3], v[168:171], 0
    ds_read_b128 v[192:195], v196 offset:8768
    buffer_load_dwordx4 a[56:59], v200, s[16:19], s101 offen offset:2048 sc1
    v_and_b32 v211, 31, v0
    v_min_u32 v211, 19, v211
    s_waitcnt lgkmcnt(3)
    s_waitcnt vmcnt(14)
    v_mfma_f32_16x16x32_bf16 v[112:115], a[4:7], v[172:175], v[112:115]
    ds_read_b128 v[160:163], v198 offset:96
    v_mfma_f32_32x32x16_bf16 v[80:95], a[4:7], v[176:179], v[80:95]
    ds_read_b128 v[164:167], v197 offset:64
    v_lshl_add_u32 v210, v211, 3, v210
    v_add_u32 v210, 6400, v210
    ds_write_b64 v210, v[208:209]
    s_mul_i32 s33, s24, 4160
    v_mfma_f32_32x32x16_bf16 v[96:111], a[4:7], v[180:183], v[96:111]
    ds_read_b128 v[168:171], v197 offset:8768
    buffer_load_dwordx4 a[60:63], v200, s[16:19], s101 offen offset:3072 sc1
    s_add_u32 s33, s33, 134272
    v_and_b32_e64 v250, 31, v1
    s_waitcnt lgkmcnt(4)
    s_waitcnt vmcnt(14)
    v_mfma_f32_16x16x32_bf16 v[112:115], a[8:11], v[184:187], v[112:115]
    ds_read_b128 v[172:175], v198 offset:128
    v_mfma_f32_32x32x16_bf16 v[80:95], a[8:11], v[188:191], v[80:95]
    ds_read_b128 v[176:179], v196 offset:128
    v_lshl_add_u32 v250, v250, 4, s33
    v_lshrrev_b32_e64 v253, 5, v1
    v_lshl_add_u32 v251, v253, 3, v250
    v_lshl_add_u32 v252, v253, 9, v250
    v_mfma_f32_32x32x16_bf16 v[96:111], a[8:11], v[192:195], v[96:111]
    ds_read_b128 v[180:183], v196 offset:8832
    s_add_u32 s101, s101, 4096
    buffer_load_dwordx4 a[64:67], v200, s[16:19], s101 offen offset:0 sc1
    v_lshl_add_u32 v250, v253, 10, v250
    s_waitcnt lgkmcnt(3)
    s_waitcnt vmcnt(14)
    v_mfma_f32_16x16x32_bf16 v[112:115], a[12:15], v[160:163], v[112:115]
    ds_read_b128 v[184:187], v198 offset:160
    v_mfma_f32_32x32x16_bf16 v[80:95], a[12:15], v[164:167], v[80:95]
    ds_read_b128 v[188:191], v197 offset:128
    v_cmp_eq_u32 vcc, 0, v1
    v_lshlrev_b32 v254, 16, v241
    v_min_u32 v253, 15, v1
    v_cndmask_b32 v254, 0, v254, vcc
    v_mfma_f32_32x32x16_bf16 v[96:111], a[12:15], v[168:171], v[96:111]
    ds_read_b128 v[192:195], v197 offset:8832
    buffer_load_dwordx4 a[68:71], v200, s[16:19], s101 offen offset:1024 sc1
    v_lshl_add_u32 v253, v253, 2, s33
    v_add_f32_e64 v216, v216, v254
    s_waitcnt lgkmcnt(3)
    s_waitcnt vmcnt(14)
    v_mfma_f32_16x16x32_bf16 v[112:115], a[16:19], v[172:175], v[112:115]
    ds_read_b128 v[160:163], v198 offset:192
    v_mfma_f32_32x32x16_bf16 v[80:95], a[16:19], v[176:179], v[80:95]
    ds_read_b128 v[164:167], v196 offset:192
    v_and_b32 v254, 1, v1
    v_cmp_eq_u32 vcc, 1, v254
    v_mov_b32_e64 v254, 0
    v_cvt_pk_bf16_f32 v242, v216, v217
    v_mfma_f32_32x32x16_bf16 v[96:111], a[16:19], v[180:183], v[96:111]
    ds_read_b128 v[168:171], v196 offset:8896
    buffer_load_dwordx4 a[72:75], v200, s[16:19], s101 offen offset:2048 sc1
    v_cvt_pk_bf16_f32 v243, v218, v219
    v_cvt_pk_bf16_f32 v244, v220, v220
    s_waitcnt lgkmcnt(3)
    s_waitcnt vmcnt(14)
    v_mfma_f32_16x16x32_bf16 v[112:115], a[20:23], v[184:187], v[112:115]
    ds_read_b128 v[172:175], v198 offset:224
    v_mfma_f32_32x32x16_bf16 v[80:95], a[20:23], v[188:191], v[80:95]
    ds_read_b128 v[176:179], v197 offset:192
    v_cvt_pk_bf16_f32 v245, v221, v222
    v_cvt_pk_bf16_f32 v246, v224, v224
    v_cvt_pk_bf16_f32 v247, v224, v225
    v_cvt_pk_bf16_f32 v248, v225, v225
    v_mfma_f32_32x32x16_bf16 v[96:111], a[20:23], v[192:195], v[96:111]
    ds_read_b128 v[180:183], v197 offset:8896
    buffer_load_dwordx4 a[76:79], v200, s[16:19], s101 offen offset:3072 sc1
    v_cvt_pk_bf16_f32 v249, v226, v226
    ds_write_b32 v253, v254
    s_barrier
    s_waitcnt lgkmcnt(4)
    s_waitcnt vmcnt(14)
    v_mfma_f32_16x16x32_bf16 v[112:115], a[24:27], v[160:163], v[112:115]
    v_add_u32 v198, v49, v198
    v_mfma_f32_32x32x16_bf16 v[80:95], a[24:27], v[164:167], v[80:95]
    v_add_u32 v196, 19584, v196
    v_add_u32 v197, 19584, v197
    ds_read_b128 v[184:187], v198 offset:0
    ds_write_b64 v251, v[242:243] offset:64
    ds_write_b64 v251, v[244:245] offset:576
    v_mfma_f32_32x32x16_bf16 v[96:111], a[24:27], v[168:171], v[96:111]
    ds_read_b128 v[188:191], v196 offset:0
    ds_read_b128 v[192:195], v196 offset:8704
    s_add_u32 s101, s101, 4096
    buffer_load_dwordx4 a[80:83], v200, s[16:19], s101 offen offset:0 sc1
    s_waitcnt lgkmcnt(6)
    s_waitcnt vmcnt(14)
    v_mfma_f32_16x16x32_bf16 v[112:115], a[28:31], v[172:175], v[112:115]
    ds_read_b128 v[160:163], v198 offset:32
    v_mfma_f32_32x32x16_bf16 v[80:95], a[28:31], v[176:179], v[80:95]
    ds_read_b128 v[164:167], v197 offset:0
    ds_write_b128 v252, v[246:249] offset:1088
    v_cndmask_b32 v255, v228, v229, vcc
    v_cvt_pk_bf16_f32 v216, v228, v228
    v_mov_b32 v217, v216
    v_mfma_f32_32x32x16_bf16 v[96:111], a[28:31], v[180:183], v[96:111]
    ds_read_b128 v[168:171], v197 offset:8704
    buffer_load_dwordx4 a[84:87], v200, s[16:19], s101 offen offset:1024 sc1
    v_cvt_pk_bf16_f32 v218, v255, v229
    v_cvt_pk_bf16_f32 v219, v229, v229
    s_waitcnt lgkmcnt(4)
    s_waitcnt vmcnt(14)
    v_mfma_f32_16x16x32_bf16 v[112:115], a[32:35], v[184:187], v[112:115]
    ds_read_b128 v[172:175], v198 offset:64
    v_mfma_f32_32x32x16_bf16 v[80:95], a[32:35], v[188:191], v[80:95]
    ds_read_b128 v[176:179], v196 offset:64
    ds_write_b128 v250, v[216:219] offset:2112
    v_cndmask_b32 v255, v230, v231, vcc
    v_cvt_pk_bf16_f32 v220, v230, v230
    v_mov_b32 v221, v220
    v_mfma_f32_32x32x16_bf16 v[96:111], a[32:35], v[192:195], v[96:111]
    ds_read_b128 v[180:183], v196 offset:8768
    buffer_load_dwordx4 a[88:91], v200, s[16:19], s101 offen offset:2048 sc1
    v_cvt_pk_bf16_f32 v222, v255, v231
    v_cvt_pk_bf16_f32 v223, v231, v231
    s_waitcnt lgkmcnt(4)
    s_waitcnt vmcnt(14)
    v_mfma_f32_16x16x32_bf16 v[112:115], a[36:39], v[160:163], v[112:115]
    ds_read_b128 v[184:187], v198 offset:96
    v_mfma_f32_32x32x16_bf16 v[80:95], a[36:39], v[164:167], v[80:95]
    ds_read_b128 v[188:191], v197 offset:64
    ds_write_b128 v250, v[220:223] offset:2624
    v_mfma_f32_32x32x16_bf16 v[96:111], a[36:39], v[168:171], v[96:111]
    ds_read_b128 v[192:195], v197 offset:8768
    buffer_load_dwordx4 a[92:95], v200, s[16:19], s101 offen offset:3072 sc1
    s_waitcnt lgkmcnt(4)
    s_waitcnt vmcnt(14)
    v_mfma_f32_16x16x32_bf16 v[112:115], a[40:43], v[172:175], v[112:115]
    ds_read_b128 v[160:163], v198 offset:128
    v_mfma_f32_32x32x16_bf16 v[80:95], a[40:43], v[176:179], v[80:95]
    ds_read_b128 v[164:167], v196 offset:128
    v_mfma_f32_32x32x16_bf16 v[96:111], a[40:43], v[180:183], v[96:111]
    ds_read_b128 v[168:171], v196 offset:8832
    s_add_u32 s101, s101, 4096
    buffer_load_dwordx4 a[96:99], v200, s[16:19], s101 offen offset:0 sc1
    s_waitcnt lgkmcnt(3)
    s_waitcnt vmcnt(14)
    v_mfma_f32_16x16x32_bf16 v[112:115], a[44:47], v[184:187], v[112:115]
    ds_read_b128 v[172:175], v198 offset:160
    v_mfma_f32_32x32x16_bf16 v[80:95], a[44:47], v[188:191], v[80:95]
    ds_read_b128 v[176:179], v197 offset:128
    v_mfma_f32_32x32x16_bf16 v[96:111], a[44:47], v[192:195], v[96:111]
    ds_read_b128 v[180:183], v197 offset:8832
    buffer_load_dwordx4 a[100:103], v200, s[16:19], s101 offen offset:1024 sc1
    s_waitcnt lgkmcnt(3)
    s_waitcnt vmcnt(14)
    v_mfma_f32_16x16x32_bf16 v[112:115], a[48:51], v[160:163], v[112:115]
    ds_read_b128 v[184:187], v198 offset:192
    v_mfma_f32_32x32x16_bf16 v[80:95], a[48:51], v[164:167], v[80:95]
    ds_read_b128 v[188:191], v196 offset:192
    v_mfma_f32_32x32x16_bf16 v[96:111], a[48:51], v[168:171], v[96:111]
    ds_read_b128 v[192:195], v196 offset:8896
    buffer_load_dwordx4 a[104:107], v200, s[16:19], s101 offen offset:2048 sc1
    s_waitcnt lgkmcnt(3)
    s_waitcnt vmcnt(14)
    v_mfma_f32_16x16x32_bf16 v[112:115], a[52:55], v[172:175], v[112:115]
    ds_read_b128 v[160:163], v198 offset:224
    v_mfma_f32_32x32x16_bf16 v[80:95], a[52:55], v[176:179], v[80:95]
    ds_read_b128 v[164:167], v197 offset:192
    v_mfma_f32_32x32x16_bf16 v[96:111], a[52:55], v[180:183], v[96:111]
    ds_read_b128 v[168:171], v197 offset:8896
    buffer_load_dwordx4 a[108:111], v200, s[16:19], s101 offen offset:3072 sc1
    s_barrier
    s_waitcnt lgkmcnt(3)
    s_waitcnt vmcnt(13)
    v_mfma_f32_16x16x32_bf16 v[112:115], a[56:59], v[184:187], v[112:115]
    v_add_u32 v198, v49, v198
    v_mfma_f32_32x32x16_bf16 v[80:95], a[56:59], v[188:191], v[80:95]
    v_add_u32 v196, 19584, v196
    v_add_u32 v197, 19584, v197
    ds_read_b128 v[172:175], v198 offset:0
    v_mfma_f32_32x32x16_bf16 v[96:111], a[56:59], v[192:195], v[96:111]
    ds_read_b128 v[176:179], v196 offset:0
    ds_read_b128 v[180:183], v196 offset:8704
    s_add_u32 s101, s101, 4096
    buffer_load_dwordx4 a[112:115], v200, s[16:19], s101 offen offset:0 sc1
    s_waitcnt lgkmcnt(3)
    s_waitcnt vmcnt(13)
    v_mfma_f32_16x16x32_bf16 v[112:115], a[60:63], v[160:163], v[112:115]
    ds_read_b128 v[184:187], v198 offset:32
    v_mfma_f32_32x32x16_bf16 v[80:95], a[60:63], v[164:167], v[80:95]
    ds_read_b128 v[188:191], v197 offset:0
    v_mfma_f32_32x32x16_bf16 v[96:111], a[60:63], v[168:171], v[96:111]
    ds_read_b128 v[192:195], v197 offset:8704
    buffer_load_dwordx4 a[116:119], v200, s[16:19], s101 offen offset:1024 sc1
    s_waitcnt lgkmcnt(3)
    s_waitcnt vmcnt(13)
    v_mfma_f32_16x16x32_bf16 v[112:115], a[64:67], v[172:175], v[112:115]
    ds_read_b128 v[160:163], v198 offset:64
    v_mfma_f32_32x32x16_bf16 v[80:95], a[64:67], v[176:179], v[80:95]
    ds_read_b128 v[164:167], v196 offset:64
    v_mfma_f32_32x32x16_bf16 v[96:111], a[64:67], v[180:183], v[96:111]
    ds_read_b128 v[168:171], v196 offset:8768
    buffer_load_dwordx4 a[120:123], v200, s[16:19], s101 offen offset:2048 sc1
    s_waitcnt lgkmcnt(3)
    s_waitcnt vmcnt(13)
    v_mfma_f32_16x16x32_bf16 v[112:115], a[68:71], v[184:187], v[112:115]
    ds_read_b128 v[172:175], v198 offset:96
    v_mfma_f32_32x32x16_bf16 v[80:95], a[68:71], v[188:191], v[80:95]
    ds_read_b128 v[176:179], v197 offset:64
    v_mfma_f32_32x32x16_bf16 v[96:111], a[68:71], v[192:195], v[96:111]
    ds_read_b128 v[180:183], v197 offset:8768
    buffer_load_dwordx4 a[124:127], v200, s[16:19], s101 offen offset:3072 sc1
    s_waitcnt lgkmcnt(3)
    s_waitcnt vmcnt(13)
    v_mfma_f32_16x16x32_bf16 v[112:115], a[72:75], v[160:163], v[112:115]
    ds_read_b128 v[184:187], v198 offset:128
    v_mfma_f32_32x32x16_bf16 v[80:95], a[72:75], v[164:167], v[80:95]
    ds_read_b128 v[188:191], v196 offset:128
    v_mfma_f32_32x32x16_bf16 v[96:111], a[72:75], v[168:171], v[96:111]
    ds_read_b128 v[192:195], v196 offset:8832
    s_add_u32 s101, s101, 4096
    buffer_load_dwordx4 a[128:131], v200, s[16:19], s101 offen offset:0 sc1
    s_waitcnt lgkmcnt(3)
    s_waitcnt vmcnt(13)
    v_mfma_f32_16x16x32_bf16 v[112:115], a[76:79], v[172:175], v[112:115]
    ds_read_b128 v[160:163], v198 offset:160
    v_mfma_f32_32x32x16_bf16 v[80:95], a[76:79], v[176:179], v[80:95]
    ds_read_b128 v[164:167], v197 offset:128
    v_mfma_f32_32x32x16_bf16 v[96:111], a[76:79], v[180:183], v[96:111]
    ds_read_b128 v[168:171], v197 offset:8832
    buffer_load_dwordx4 a[132:135], v200, s[16:19], s101 offen offset:1024 sc1
    s_waitcnt lgkmcnt(3)
    s_waitcnt vmcnt(13)
    v_mfma_f32_16x16x32_bf16 v[112:115], a[80:83], v[184:187], v[112:115]
    ds_read_b128 v[172:175], v198 offset:192
    v_mfma_f32_32x32x16_bf16 v[80:95], a[80:83], v[188:191], v[80:95]
    ds_read_b128 v[176:179], v196 offset:192
    v_mfma_f32_32x32x16_bf16 v[96:111], a[80:83], v[192:195], v[96:111]
    ds_read_b128 v[180:183], v196 offset:8896
    buffer_load_dwordx4 a[136:139], v200, s[16:19], s101 offen offset:2048 sc1
    s_waitcnt lgkmcnt(3)
    s_waitcnt vmcnt(13)
    v_mfma_f32_16x16x32_bf16 v[112:115], a[84:87], v[160:163], v[112:115]
    ds_read_b128 v[184:187], v198 offset:224
    v_mfma_f32_32x32x16_bf16 v[80:95], a[84:87], v[164:167], v[80:95]
    ds_read_b128 v[188:191], v197 offset:192
    v_mfma_f32_32x32x16_bf16 v[96:111], a[84:87], v[168:171], v[96:111]
    ds_read_b128 v[192:195], v197 offset:8896
    buffer_load_dwordx4 a[140:143], v200, s[16:19], s101 offen offset:3072 sc1
    s_barrier
    s_waitcnt lgkmcnt(3)
    s_waitcnt vmcnt(13)
    v_mfma_f32_16x16x32_bf16 v[112:115], a[88:91], v[172:175], v[112:115]
    v_add_u32 v198, v49, v198
    v_mfma_f32_32x32x16_bf16 v[80:95], a[88:91], v[176:179], v[80:95]
    v_add_u32 v196, 19584, v196
    v_add_u32 v197, 19584, v197
    ds_read_b128 v[160:163], v198 offset:0
    v_mfma_f32_32x32x16_bf16 v[96:111], a[88:91], v[180:183], v[96:111]
    ds_read_b128 v[164:167], v196 offset:0
    ds_read_b128 v[168:171], v196 offset:8704
    s_add_u32 s101, s101, 4096
    buffer_load_dword v7, v4, s[16:19], s89 offen offset:8 sc1
    s_waitcnt lgkmcnt(3)
    s_waitcnt vmcnt(13)
    v_mfma_f32_16x16x32_bf16 v[112:115], a[92:95], v[184:187], v[112:115]
    ds_read_b128 v[172:175], v198 offset:32
    v_mfma_f32_32x32x16_bf16 v[80:95], a[92:95], v[188:191], v[80:95]
    ds_read_b128 v[176:179], v197 offset:0
    v_mfma_f32_32x32x16_bf16 v[96:111], a[92:95], v[192:195], v[96:111]
    ds_read_b128 v[180:183], v197 offset:8704
    buffer_load_dwordx4 a[144:147], v200, s[16:19], s101 offen offset:0 sc1
    s_waitcnt lgkmcnt(3)
    s_waitcnt vmcnt(13)
    v_mfma_f32_16x16x32_bf16 v[112:115], a[96:99], v[160:163], v[112:115]
    ds_read_b128 v[184:187], v198 offset:64
    v_mfma_f32_32x32x16_bf16 v[80:95], a[96:99], v[164:167], v[80:95]
    ds_read_b128 v[188:191], v196 offset:64
    v_mfma_f32_32x32x16_bf16 v[96:111], a[96:99], v[168:171], v[96:111]
    ds_read_b128 v[192:195], v196 offset:8768
    buffer_load_dwordx4 a[148:151], v200, s[16:19], s101 offen offset:1024 sc1
    s_waitcnt lgkmcnt(3)
    s_waitcnt vmcnt(13)
    v_mfma_f32_16x16x32_bf16 v[112:115], a[100:103], v[172:175], v[112:115]
    ds_read_b128 v[160:163], v198 offset:96
    v_mfma_f32_32x32x16_bf16 v[80:95], a[100:103], v[176:179], v[80:95]
    ds_read_b128 v[164:167], v197 offset:64
    v_mfma_f32_32x32x16_bf16 v[96:111], a[100:103], v[180:183], v[96:111]
    ds_read_b128 v[168:171], v197 offset:8768
    buffer_load_dwordx4 a[152:155], v200, s[16:19], s101 offen offset:2048 sc1
    s_waitcnt lgkmcnt(3)
    s_waitcnt vmcnt(13)
    v_mfma_f32_16x16x32_bf16 v[112:115], a[104:107], v[184:187], v[112:115]
    ds_read_b128 v[172:175], v198 offset:128
    v_mfma_f32_32x32x16_bf16 v[80:95], a[104:107], v[188:191], v[80:95]
    ds_read_b128 v[176:179], v196 offset:128
    v_mfma_f32_32x32x16_bf16 v[96:111], a[104:107], v[192:195], v[96:111]
    ds_read_b128 v[180:183], v196 offset:8832
    buffer_load_dwordx4 a[156:159], v200, s[16:19], s101 offen offset:3072 sc1
    s_waitcnt lgkmcnt(3)
    s_waitcnt vmcnt(13)
    v_mfma_f32_16x16x32_bf16 v[112:115], a[108:111], v[160:163], v[112:115]
    ds_read_b128 v[184:187], v198 offset:160
    v_mfma_f32_32x32x16_bf16 v[80:95], a[108:111], v[164:167], v[80:95]
    ds_read_b128 v[188:191], v197 offset:128
    v_mfma_f32_32x32x16_bf16 v[96:111], a[108:111], v[168:171], v[96:111]
    ds_read_b128 v[192:195], v197 offset:8832
    s_add_u32 s101, s101, 4096
    s_lshl_b32 s25, s72, 5
    s_add_u32 s25, s25, 256
    s_sub_u32 s26, s25, 4
    s_max_i32 s26, s26, 0
    s_mul_i32 s27, s71, 1280
    s_mul_i32 s99, s25, 5120
    s_mul_i32 s100, s26, 5120
    s_mul_i32 s92, s24, 4352
    s_mul_i32 s93, s24, 544
    s_add_u32 s99, s99, s27
    s_add_u32 s100, s100, s27
    s_waitcnt lgkmcnt(3)
    s_waitcnt vmcnt(12)
    v_mfma_f32_16x16x32_bf16 v[112:115], a[112:115], v[172:175], v[112:115]
    ds_read_b128 v[160:163], v198 offset:192
    v_mfma_f32_32x32x16_bf16 v[80:95], a[112:115], v[176:179], v[80:95]
    ds_read_b128 v[164:167], v196 offset:192
    v_mfma_f32_32x32x16_bf16 v[96:111], a[112:115], v[180:183], v[96:111]
    ds_read_b128 v[168:171], v196 offset:8896
    s_waitcnt lgkmcnt(3)
    s_waitcnt vmcnt(11)
    v_mfma_f32_16x16x32_bf16 v[112:115], a[116:119], v[184:187], v[112:115]
    ds_read_b128 v[172:175], v198 offset:224
    v_mfma_f32_32x32x16_bf16 v[80:95], a[116:119], v[188:191], v[80:95]
    ds_read_b128 v[176:179], v197 offset:192
    v_mfma_f32_32x32x16_bf16 v[96:111], a[116:119], v[192:195], v[96:111]
    ds_read_b128 v[180:183], v197 offset:8896
    s_waitcnt vmcnt(4)
    v_cmp_gt_u32 vcc, 32, v7
    s_nop 0
    s_and_b64 vcc, vcc, s[50:51]
    s_cbranch_scc1 ps_17
pc_19:
    s_barrier
    s_waitcnt lgkmcnt(3)
    v_mfma_f32_16x16x32_bf16 v[112:115], a[120:123], v[160:163], v[112:115]
    v_add_u32_e64 v198, v49, v198
    v_mfma_f32_32x32x16_bf16 v[80:95], a[120:123], v[164:167], v[80:95]
    v_add_u32 v196, 19584, v196
    v_add_u32 v197, 19584, v197
    s_lshl_b32 s31, s24, 7
    s_add_u32 s31, s31, 160768
    v_bfe_u32 v132, v1, 3, 1
    v_mfma_f32_32x32x16_bf16 v[96:111], a[120:123], v[168:171], v[96:111]
    ds_read_b128 v[184:187], v198 offset:0
    ds_read_b128 v[188:191], v196 offset:0
    s_lshl_b32 s98, s72, 5
    s_add_u32 s98, s98, 0
    s_sub_u32 s95, s98, 4
    s_max_i32 s95, s95, 0
    s_lshl_b32 s94, s98, 3
    s_lshl_b32 s95, s95, 3
    s_add_u32 s94, s94, 3440640
    s_add_u32 s95, s95, 3440640
    s_add_u32 s96, s94, 8192
    buffer_load_dwordx2 v[152:153], v47, s[16:19], s94 offen sc1
    v_lshrrev_b32 v133, 4, v1
    v_lshl_add_u32 v132, v132, 2, v133
    s_waitcnt lgkmcnt(2)
    v_mfma_f32_16x16x32_bf16 v[112:115], a[124:127], v[172:175], v[112:115]
    ds_read_b128 v[192:195], v198 offset:32
    v_mfma_f32_32x32x16_bf16 v[80:95], a[124:127], v[176:179], v[80:95]
    ds_read_b128 v[160:163], v197 offset:0
    v_lshl_add_u32 v132, v132, 4, s31
    v_lshrrev_b32 v133, 5, v1
    v_lshl_add_u32 v133, v133, 4, s31
    v_mfma_f32_32x32x16_bf16 v[96:111], a[124:127], v[180:183], v[96:111]
    buffer_load_dwordx2 v[154:155], v47, s[16:19], s96 offen sc1
    s_waitcnt lgkmcnt(2)
    v_mfma_f32_16x16x32_bf16 v[112:115], a[128:131], v[184:187], v[112:115]
    ds_read_b128 v[164:167], v198 offset:64
    v_mfma_f32_32x32x16_bf16 v[80:95], a[128:131], v[188:191], v[80:95]
    ds_read_b128 v[168:171], v196 offset:64
    s_waitcnt lgkmcnt(2)
    v_mfma_f32_16x16x32_bf16 v[112:115], a[132:135], v[192:195], v[112:115]
    ds_read_b128 v[172:175], v198 offset:96
    v_mfma_f32_32x32x16_bf16 v[80:95], a[132:135], v[160:163], v[80:95]
    ds_read_b128 v[176:179], v197 offset:64
    buffer_load_dwordx2 v[156:157], v48, s[16:19], s95 offen sc1
    s_waitcnt lgkmcnt(2)
    v_mfma_f32_16x16x32_bf16 v[112:115], a[136:139], v[164:167], v[112:115]
    ds_read_b128 v[180:183], v198 offset:128
    v_mfma_f32_32x32x16_bf16 v[80:95], a[136:139], v[168:171], v[80:95]
    ds_read_b128 v[184:187], v196 offset:128
    s_waitcnt lgkmcnt(2)
    v_mfma_f32_16x16x32_bf16 v[112:115], a[140:143], v[172:175], v[112:115]
    ds_read_b128 v[188:191], v198 offset:160
    v_mfma_f32_32x32x16_bf16 v[80:95], a[140:143], v[176:179], v[80:95]
    ds_read_b128 v[192:195], v197 offset:128
    s_add_u32 m0, s92, 36352
    s_nop 0
    buffer_load_dwordx4 v73, s[4:7], s99 offen offset:0  lds
    s_waitcnt lgkmcnt(2)
    s_waitcnt vmcnt(7)
    v_mfma_f32_16x16x32_bf16 v[112:115], a[144:147], v[180:183], v[112:115]
    ds_read_b128 v[160:163], v198 offset:192
    v_mfma_f32_32x32x16_bf16 v[80:95], a[144:147], v[184:187], v[80:95]
    ds_read_b128 v[164:167], v196 offset:192
    s_waitcnt lgkmcnt(2)
    s_waitcnt vmcnt(6)
    v_mfma_f32_16x16x32_bf16 v[112:115], a[148:151], v[188:191], v[112:115]
    ds_read_b128 v[168:171], v198 offset:224
    v_mfma_f32_32x32x16_bf16 v[80:95], a[148:151], v[192:195], v[80:95]
    ds_read_b128 v[172:175], v197 offset:192
    buffer_load_dwordx4 v74, s[4:7], s99 offen offset:1088  lds
    s_waitcnt lgkmcnt(2)
    s_waitcnt vmcnt(6)
    v_mfma_f32_16x16x32_bf16 v[112:115], a[152:155], v[160:163], v[112:115]
    ds_read_b128 v[176:179], v196 offset:8704
    v_mfma_f32_32x32x16_bf16 v[80:95], a[152:155], v[164:167], v[80:95]
    ds_read_b128 v[180:183], v197 offset:8704
    s_waitcnt lgkmcnt(2)
    s_waitcnt vmcnt(5)
    v_mfma_f32_16x16x32_bf16 v[112:115], a[156:159], v[168:171], v[112:115]
    ds_read_b128 v[184:187], v196 offset:8768
    v_mfma_f32_32x32x16_bf16 v[80:95], a[156:159], v[172:175], v[80:95]
    ds_read_b128 v[188:191], v197 offset:8768
    buffer_load_dwordx4 v75, s[4:7], s99 offen offset:2176  lds
    s_waitcnt lgkmcnt(2)
    v_mfma_f32_32x32x16_bf16 v[96:111], a[128:131], v[176:179], v[96:111]
    ds_read_b128 v[192:195], v196 offset:8832
    v_mfma_f32_32x32x16_bf16 v[96:111], a[132:135], v[180:183], v[96:111]
    ds_read_b128 v[160:163], v197 offset:8832
    buffer_load_dwordx4 v76, s[4:7], s99 offen offset:3264  lds
    s_mov_b32 exec_lo, 0x01010101
    s_mov_b32 exec_hi, 0x01010101
    ds_write_b128 v132, v[112:115]
    s_mov_b64 exec, -1
    s_waitcnt lgkmcnt(3)
    v_mfma_f32_32x32x16_bf16 v[96:111], a[136:139], v[184:187], v[96:111]
    ds_read_b128 v[164:167], v196 offset:8896
    ds_read_b128 v[24:27], v132
    ds_read_b128 v[8:11], v133 offset:0
    ds_read_b128 v[12:15], v133 offset:32
    ds_read_b128 v[16:19], v133 offset:64
    v_mfma_f32_32x32x16_bf16 v[96:111], a[140:143], v[188:191], v[96:111]
    ds_read_b128 v[168:171], v197 offset:8896
    s_add_u32 m0, s93, 53760
    s_add_u32 s99, s99, 256
    s_mov_b64 exec, s[80:81]
    buffer_load_dwordx4 v77, s[4:7], s100 offen  lds
    s_mov_b64 exec, -1
    s_add_u32 s100, s100, 256
    ds_read_b128 v[20:23], v133 offset:96
    s_waitcnt vmcnt(5) lgkmcnt(5)
    v_mul_f32 v148, v24, v157
    v_mfma_f32_32x32x16_bf16 v[96:111], a[144:147], v[192:195], v[96:111]
    v_mul_f32 v149, v25, v157
    v_mul_f32 v150, v26, v157
    v_mul_f32 v151, v27, v157
    s_waitcnt lgkmcnt(4)
    v_mul_f32 v116, v8, v153
    v_mul_f32 v117, v9, v153
    v_mfma_f32_32x32x16_bf16 v[96:111], a[148:151], v[160:163], v[96:111]
    v_mul_f32 v118, v10, v153
    v_mul_f32 v119, v11, v153
    s_waitcnt lgkmcnt(3)
    v_mul_f32 v120, v12, v153
    v_mul_f32 v121, v13, v153
    s_waitcnt lgkmcnt(1)
    v_mfma_f32_32x32x16_bf16 v[96:111], a[152:155], v[164:167], v[96:111]
    v_mul_f32 v122, v14, v153
    v_mul_f32 v123, v15, v153
    v_mul_f32 v124, v16, v153
    v_mul_f32 v125, v17, v153
    v_mul_f32_e64 v126, v18, v153
    v_mfma_f32_32x32x16_bf16 v[96:111], a[156:159], v[168:171], v[96:111]
    s_add_u32 m0, s92, 55936
    s_nop 0
    buffer_load_dwordx4 v73, s[4:7], s99 offen offset:0  lds
    v_mul_f32 v127, v19, v153
    s_waitcnt lgkmcnt(0)
    v_mul_f32 v128, v20, v153
    v_mul_f32 v129, v21, v153
    v_mul_f32 v130, v22, v153
    v_mul_f32_e64 v131, v23, v153
    v_fma_f32 v112, v112, v156, v148
    v_fma_f32 v113, v113, v156, v149
    v_fma_f32 v114, v114, v156, v150
    v_fma_f32 v115, v115, v156, v151
    v_cvt_pk_bf16_f32 v112, v112, v113
    v_cvt_pk_bf16_f32 v113, v114, v115
    v_fma_f32 v80, v80, v152, v116
    v_fma_f32 v81, v81, v152, v117
    v_fma_f32 v82, v82, v152, v118
    v_fma_f32 v83, v83, v152, v119
    v_cvt_pk_bf16_f32 v80, v80, v81
    v_cvt_pk_bf16_f32 v81, v82, v83
    ds_write_b64 v40, v[112:113] offset:0
    ds_write_b64 v38, v[80:81] offset:0
    v_fma_f32 v84, v84, v152, v120
    v_fma_f32 v85, v85, v152, v121
    v_fma_f32 v86, v86, v152, v122
    v_fma_f32 v87, v87, v152, v123
    v_cvt_pk_bf16_f32 v84, v84, v85
    v_cvt_pk_bf16_f32 v85, v86, v87
    v_fma_f32 v88, v88, v152, v124
    v_fma_f32 v89, v89, v152, v125
    v_fma_f32 v90, v90, v152, v126
    v_fma_f32 v91, v91, v152, v127
    v_cvt_pk_bf16_f32 v88, v88, v89
    v_cvt_pk_bf16_f32 v89, v90, v91
    ds_write_b64 v38, v[84:85] offset:6400
    ds_write_b64 v38, v[88:89] offset:12800
    v_fma_f32 v92, v92, v152, v128
    v_fma_f32 v93, v93, v152, v129
    v_fma_f32 v94, v94, v152, v130
    v_fma_f32 v95, v95, v152, v131
    v_cvt_pk_bf16_f32 v92, v92, v93
    v_cvt_pk_bf16_f32 v93, v94, v95
    ds_write_b64 v39, v[92:93] offset:0
    v_mul_f32 v132, v8, v155
    v_mul_f32 v133, v9, v155
    v_mul_f32 v134, v10, v155
    v_mul_f32 v135, v11, v155
    v_mul_f32 v136, v12, v155
    v_mul_f32 v137, v13, v155
    v_mul_f32 v138, v14, v155
    v_mul_f32 v139, v15, v155
    v_mul_f32 v140, v16, v155
    v_mul_f32 v141, v17, v155
    v_mul_f32 v142, v18, v155
    v_mul_f32 v143, v19, v155
    v_mul_f32 v144, v20, v155
    v_mul_f32 v145, v21, v155
    v_mul_f32 v146, v22, v155
    v_mul_f32 v147, v23, v155
    v_pk_fma_f32 v[96:97], v[96:97], v[154:155], v[132:133] op_sel_hi:[1,0,1]
    v_pk_fma_f32 v[98:99], v[98:99], v[154:155], v[134:135] op_sel_hi:[1,0,1]
    v_cvt_pk_bf16_f32 v96, v96, v97
    v_cvt_pk_bf16_f32 v97, v98, v99
    v_pk_fma_f32 v[100:101], v[100:101], v[154:155], v[136:137] op_sel_hi:[1,0,1]
    v_pk_fma_f32 v[102:103], v[102:103], v[154:155], v[138:139] op_sel_hi:[1,0,1]
    v_cvt_pk_bf16_f32 v100, v100, v101
    v_cvt_pk_bf16_f32 v101, v102, v103
    ds_write_b64 v38, v[96:97] offset:1600
    ds_write_b64 v38, v[100:101] offset:8000
    v_pk_fma_f32 v[104:105], v[104:105], v[154:155], v[140:141] op_sel_hi:[1,0,1]
    v_pk_fma_f32 v[106:107], v[106:107], v[154:155], v[142:143] op_sel_hi:[1,0,1]
    v_cvt_pk_bf16_f32 v104, v104, v105
    v_cvt_pk_bf16_f32 v105, v106, v107
    v_pk_fma_f32 v[108:109], v[108:109], v[154:155], v[144:145] op_sel_hi:[1,0,1]
    v_pk_fma_f32 v[110:111], v[110:111], v[154:155], v[146:147] op_sel_hi:[1,0,1]
    v_cvt_pk_bf16_f32 v108, v108, v109
    v_cvt_pk_bf16_f32 v109, v110, v111
    ds_write_b64 v38, v[104:105] offset:14400
    ds_write_b64 v39, v[108:109] offset:1600
    s_waitcnt lgkmcnt(0)
    s_barrier
    v_mov_b32 v94, 0
    v_mov_b32 v95, 0
    v_mov_b32 v98, 0
    v_mov_b32 v99, 0
    s_mov_b64 exec, 0xffff
    ds_read_b64 v[94:95], v42 offset:320
    ds_read_b64 v[98:99], v42 offset:640
    s_mov_b64 exec, -1
    s_nop 0
    ds_read_b64 v[92:93], v41 offset:320
    ds_read_b64 v[96:97], v41 offset:640
    ds_read_b64 v[84:85], v41 offset:6720
    ds_read_b64 v[86:87], v42 offset:6720
    ds_read_b64 v[80:81], v41 offset:6400
    ds_read_b64 v[82:83], v42 offset:6400
    ds_read_b64 v[88:89], v41 offset:7040
    ds_read_b64 v[90:91], v42 offset:7040
    ds_read_b64_tr_b16 v[106:107], v44 offset:0
    ds_read_b64_tr_b16 v[100:101], v43 offset:0
    ds_read_b64_tr_b16 v[108:109], v44 offset:320
    ds_read_b64_tr_b16 v[102:103], v43 offset:320
    buffer_load_dwordx4 v74, s[4:7], s99 offen offset:1088  lds
    ds_read_b64_tr_b16 v[110:111], v44 offset:640
    ds_read_b64_tr_b16 v[104:105], v43 offset:640
    v_mov_b32 v156, 0xf149f2ca
    v_cndmask_b32 v152, v32, v156, s[90:91]
    v_cndmask_b32 v153, v33, v156, s[90:91]
    v_cndmask_b32 v154, v34, v156, s[90:91]
    v_cndmask_b32 v155, v35, v156, s[90:91]
    s_mov_b32 s82, 0x3ea52b5c
    buffer_load_dwordx4 v75, s[4:7], s99 offen offset:2176  lds
    s_lshl_b32 s25, s98, 4
    s_add_u32 s25, s25, 4194304
    s_lshl_b32 s26, s98, 3
    s_add_u32 s26, s26, 4194304
    s_waitcnt lgkmcnt(10)
    v_mfma_f32_16x16x32_bf16 v[116:119], v[84:87], v[92:95], v[28:31]
    v_mfma_f32_16x16x32_bf16 v[120:123], v[84:87], v[96:99], v[32:35]
    s_waitcnt lgkmcnt(8)
    v_mfma_f32_16x16x32_bf16 v[112:115], v[80:83], v[92:95], v[152:155]
    s_waitcnt lgkmcnt(6)
    v_mfma_f32_16x16x32_bf16 v[124:127], v[88:91], v[96:99], v[28:31]
    buffer_load_dwordx4 v76, s[4:7], s99 offen offset:3264  lds
    s_nop 4
    v_max_f32 v112, v112, v116
    v_max_f32 v113, v113, v117
    v_max_f32 v114, v114, v118
    v_max_f32 v115, v115, v119
    v_max3_f32 v156, v112, v113, v114
    v_max_f32 v156, v156, v115
    v_max_f32 v120, v120, v124
    v_max_f32_e64 v121, v121, v125
    s_add_u32 m0, s93, 73344
    s_add_u32 s99, s99, 256
    s_mov_b64 exec, s[80:81]
    buffer_load_dwordx4 v77, s[4:7], s100 offen  lds
    s_mov_b64 exec, -1
    s_add_u32 s100, s100, 256
    v_max_f32 v122, v122, v126
    v_max_f32 v123, v123, v127
    v_max3_f32 v157, v120, v121, v122
    v_max_f32 v157, v157, v123
    s_nop 1
    v_permlane16_swap_b32 v156, v157
    v_max_f32 v156, v156, v157
    v_mov_b32 v157, v156
    s_nop 1
    v_permlane32_swap_b32 v156, v157
    s_add_u32 m0, s92, 75520
    s_nop 0
    buffer_load_dwordx4 v73, s[4:7], s99 offen offset:0  lds
    v_max_f32 v156, v156, v157
    v_mul_f32 v156, s82, v156
    v_mov_b32 v157, v156
    s_nop 1
    v_permlane16_swap_b32_e64 v156, v157
    v_fma_f32 v112, v112, s82, -v156
    v_fma_f32 v113, v113, s82, -v156
    v_fma_f32 v114, v114, s82, -v156
    v_fma_f32 v115, v115, s82, -v156
    buffer_load_dwordx4 v74, s[4:7], s99 offen offset:1088  lds
    v_exp_f32 v112, v112
    v_exp_f32 v113, v113
    v_exp_f32 v114, v114
    v_exp_f32 v115, v115
    v_cvt_pk_bf16_f32 v116, v112, v113
    v_cvt_pk_bf16_f32 v117, v114, v115
    v_bfi_b32 v128, v36, 0, v116
    v_and_b32_e64 v130, v36, v116
    buffer_load_dwordx4 v75, s[4:7], s99 offen offset:2176  lds
    v_bfi_b32 v129, v37, 0, v117
    v_and_b32 v131, v37, v117
    s_waitcnt lgkmcnt(3)
    s_nop 0
    v_mfma_f32_16x16x32_bf16 v[144:147], v[106:109], v[128:131], 0
    s_waitcnt lgkmcnt(2)
    v_mfma_f32_16x16x32_bf16 v[136:139], v[100:103], v[128:131], 0
    v_fma_f32 v120, v120, s82, -v157
    v_fma_f32 v121, v121, s82, -v157
    v_fma_f32 v122, v122, s82, -v157
    v_fma_f32 v123, v123, s82, -v157
    buffer_load_dwordx4 v76, s[4:7], s99 offen offset:3264  lds
    v_exp_f32 v120, v120
    v_exp_f32 v121, v121
    v_exp_f32 v122, v122
    v_exp_f32 v123, v123
    v_cvt_pk_bf16_f32 v124, v120, v121
    v_cvt_pk_bf16_f32 v125, v122, v123
    v_bfi_b32 v132, v36, 0, v124
    v_and_b32_e64 v134, v36, v124
    s_add_u32 m0, s93, 92928
    s_add_u32 s99, s99, 256
    s_mov_b64 exec, s[80:81]
    buffer_load_dwordx4 v77, s[4:7], s100 offen  lds
    s_mov_b64 exec, -1
    s_add_u32 s100, s100, 256
    v_bfi_b32 v133, v37, 0, v125
    v_and_b32 v135, v37, v125
    s_waitcnt lgkmcnt(1)
    s_nop 0
    v_mfma_f32_16x16x32_bf16 v[148:151], v[108:111], v[132:135], 0
    s_waitcnt lgkmcnt(0)
    v_mfma_f32_16x16x32_bf16 v[140:143], v[102:105], v[132:135], 0
    v_mov_b32 v158, v144
    s_nop 1
    v_permlane16_swap_b32 v144, v158
    v_rcp_f32 v158, v158
    s_nop 0
    v_pk_mul_f32 v[136:137], v[136:137], v[158:159] op_sel_hi:[1,0]
    s_lshl_b32 s97, s73, 2
    s_add_u32 s97, s97, s24
    s_nop 0
    s_mul_i32 s97, s97, 25600
    s_add_u32 s97, s97, 2621440
    buffer_load_dwordx4 a[160:163], v58, s[16:19], s97 offen offset:0 sc1
    v_pk_mul_f32 v[138:139], v[138:139], v[158:159] op_sel_hi:[1,0]
    v_pk_mul_f32 v[144:145], v[144:145], v[158:159] op_sel_hi:[1,0]
    v_pk_mul_f32 v[146:147], v[146:147], v[158:159] op_sel_hi:[1,0]
    v_cvt_pk_bf16_f32 v112, v136, v137
    v_cvt_pk_bf16_f32 v116, v144, v145
    v_cvt_pk_bf16_f32 v113, v138, v139
    v_cvt_pk_bf16_f32 v117, v146, v147
    v_mov_b32 v160, v148
    buffer_load_dwordx4 a[164:167], v58, s[16:19], s97 offen offset:1024 sc1
    s_nop 0
    v_permlane16_swap_b32 v148, v160
    v_rcp_f32_e64 v160, v160
    s_nop 0
    v_pk_mul_f32 v[140:141], v[140:141], v[160:161] op_sel_hi:[1,0]
    v_pk_mul_f32 v[142:143], v[142:143], v[160:161] op_sel_hi:[1,0]
    v_pk_mul_f32 v[148:149], v[148:149], v[160:161] op_sel_hi:[1,0]
    v_pk_mul_f32 v[150:151], v[150:151], v[160:161] op_sel_hi:[1,0]
    v_cvt_pk_bf16_f32 v114, v140, v141
    v_cvt_pk_bf16_f32 v118, v148, v149
    buffer_load_dwordx4 a[168:171], v58, s[16:19], s97 offen offset:2048 sc1
    v_cvt_pk_bf16_f32 v115, v142, v143
    v_cvt_pk_bf16_f32 v119, v150, v151
    v_permlane16_swap_b32 v112, v114
    v_permlane16_swap_b32 v113, v115
    v_permlane16_swap_b32 v116, v118
    v_permlane16_swap_b32 v117, v119
    buffer_store_dwordx4 v[112:115], v45, s[16:19], s25 offen sc1
    s_mov_b64 exec, s[80:81]
    buffer_store_dwordx2 v[116:117], v46, s[16:19], s26 offen sc1
    s_mov_b64 exec, -1
    buffer_load_dwordx4 a[172:175], v58, s[16:19], s97 offen offset:3072 sc1
    s_add_u32 s97, s97, 4096
    buffer_load_dwordx4 a[176:179], v58, s[16:19], s97 offen offset:0 sc1
    v_add_u32 v196, 36352, v78
    v_mov_b32 v198, v79
    v_xor_b32 v197, 32, v196
    s_waitcnt vmcnt(17)
    s_barrier
    ds_read_b128 v[160:163], v198 offset:0
    ds_read_b128 v[164:167], v196 offset:0
    ds_read_b128 v[168:171], v196 offset:8704
    ds_read_b128 v[172:175], v198 offset:32
    ds_read_b128 v[176:179], v197 offset:0
    ds_read_b128 v[180:183], v197 offset:8704
    s_waitcnt lgkmcnt(3)
    v_mfma_f32_16x16x32_bf16 v[112:115], a[0:3], v[160:163], 0
    ds_read_b128 v[184:187], v198 offset:64
    v_mfma_f32_32x32x16_bf16 v[80:95], a[0:3], v[164:167], 0
    ds_read_b128 v[188:191], v196 offset:64
    v_mfma_f32_32x32x16_bf16 v[96:111], a[0:3], v[168:171], 0
    ds_read_b128 v[192:195], v196 offset:8768
    s_add_u32 m0, s92, 95104
    s_nop 0
    buffer_load_dwordx4 v73, s[4:7], s99 offen offset:0  lds
    s_waitcnt lgkmcnt(3)
    v_mfma_f32_16x16x32_bf16 v[112:115], a[4:7], v[172:175], v[112:115]
    ds_read_b128 v[160:163], v198 offset:96
    v_mfma_f32_32x32x16_bf16 v[80:95], a[4:7], v[176:179], v[80:95]
    ds_read_b128 v[164:167], v197 offset:64
    v_mfma_f32_32x32x16_bf16 v[96:111], a[4:7], v[180:183], v[96:111]
    ds_read_b128 v[168:171], v197 offset:8768
    buffer_load_dwordx4 v74, s[4:7], s99 offen offset:1088  lds
    s_waitcnt lgkmcnt(3)
    v_mfma_f32_16x16x32_bf16 v[112:115], a[8:11], v[184:187], v[112:115]
    ds_read_b128 v[172:175], v198 offset:128
    v_mfma_f32_32x32x16_bf16 v[80:95], a[8:11], v[188:191], v[80:95]
    ds_read_b128 v[176:179], v196 offset:128
    v_mfma_f32_32x32x16_bf16 v[96:111], a[8:11], v[192:195], v[96:111]
    ds_read_b128 v[180:183], v196 offset:8832
    buffer_load_dwordx4 v75, s[4:7], s99 offen offset:2176  lds
    s_waitcnt lgkmcnt(3)
    v_mfma_f32_16x16x32_bf16 v[112:115], a[12:15], v[160:163], v[112:115]
    ds_read_b128 v[184:187], v198 offset:160
    v_mfma_f32_32x32x16_bf16 v[80:95], a[12:15], v[164:167], v[80:95]
    ds_read_b128 v[188:191], v197 offset:128
    v_mfma_f32_32x32x16_bf16 v[96:111], a[12:15], v[168:171], v[96:111]
    ds_read_b128 v[192:195], v197 offset:8832
    buffer_load_dwordx4 v76, s[4:7], s99 offen offset:3264  lds
    s_waitcnt lgkmcnt(3)
    v_mfma_f32_16x16x32_bf16 v[112:115], a[16:19], v[172:175], v[112:115]
    ds_read_b128 v[160:163], v198 offset:192
    v_mfma_f32_32x32x16_bf16 v[80:95], a[16:19], v[176:179], v[80:95]
    ds_read_b128 v[164:167], v196 offset:192
    v_mfma_f32_32x32x16_bf16 v[96:111], a[16:19], v[180:183], v[96:111]
    ds_read_b128 v[168:171], v196 offset:8896
    s_add_u32 m0, s93, 112512
    s_add_u32 s99, s99, 256
    s_mov_b64 exec, s[80:81]
    buffer_load_dwordx4 v77, s[4:7], s100 offen  lds
    s_mov_b64 exec, -1
    s_add_u32 s100, s100, 256
    s_waitcnt lgkmcnt(3)
    v_mfma_f32_16x16x32_bf16 v[112:115], a[20:23], v[184:187], v[112:115]
    ds_read_b128 v[172:175], v198 offset:224
    v_mfma_f32_32x32x16_bf16 v[80:95], a[20:23], v[188:191], v[80:95]
    ds_read_b128 v[176:179], v197 offset:192
    v_mfma_f32_32x32x16_bf16 v[96:111], a[20:23], v[192:195], v[96:111]
    ds_read_b128 v[180:183], v197 offset:8896
    s_add_u32 m0, s92, 114688
    s_nop 0
    buffer_load_dwordx4 v73, s[4:7], s99 offen offset:0  lds
    s_waitcnt vmcnt(18)
    s_barrier
    s_waitcnt lgkmcnt(3)
    v_mfma_f32_16x16x32_bf16 v[112:115], a[24:27], v[160:163], v[112:115]
    v_add_u32 v198, v49, v198
    v_mfma_f32_32x32x16_bf16 v[80:95], a[24:27], v[164:167], v[80:95]
    v_add_u32 v196, 19584, v196
    v_add_u32 v197, 19584, v197
    ds_read_b128 v[184:187], v198 offset:0
    v_mfma_f32_32x32x16_bf16 v[96:111], a[24:27], v[168:171], v[96:111]
    ds_read_b128 v[188:191], v196 offset:0
    ds_read_b128 v[192:195], v196 offset:8704
    buffer_load_dwordx4 v74, s[4:7], s99 offen offset:1088  lds
    s_waitcnt lgkmcnt(3)
    v_mfma_f32_16x16x32_bf16 v[112:115], a[28:31], v[172:175], v[112:115]
    ds_read_b128 v[160:163], v198 offset:32
    v_mfma_f32_32x32x16_bf16 v[80:95], a[28:31], v[176:179], v[80:95]
    ds_read_b128 v[164:167], v197 offset:0
    v_mfma_f32_32x32x16_bf16 v[96:111], a[28:31], v[180:183], v[96:111]
    ds_read_b128 v[168:171], v197 offset:8704
    buffer_load_dwordx4 v75, s[4:7], s99 offen offset:2176  lds
    s_waitcnt lgkmcnt(3)
    v_mfma_f32_16x16x32_bf16 v[112:115], a[32:35], v[184:187], v[112:115]
    ds_read_b128 v[172:175], v198 offset:64
    v_mfma_f32_32x32x16_bf16 v[80:95], a[32:35], v[188:191], v[80:95]
    ds_read_b128 v[176:179], v196 offset:64
    v_mfma_f32_32x32x16_bf16 v[96:111], a[32:35], v[192:195], v[96:111]
    ds_read_b128 v[180:183], v196 offset:8768
    buffer_load_dwordx4 v76, s[4:7], s99 offen offset:3264  lds
    s_waitcnt lgkmcnt(3)
    v_mfma_f32_16x16x32_bf16 v[112:115], a[36:39], v[160:163], v[112:115]
    ds_read_b128 v[184:187], v198 offset:96
    v_mfma_f32_32x32x16_bf16 v[80:95], a[36:39], v[164:167], v[80:95]
    ds_read_b128 v[188:191], v197 offset:64
    v_mfma_f32_32x32x16_bf16 v[96:111], a[36:39], v[168:171], v[96:111]
    ds_read_b128 v[192:195], v197 offset:8768
    s_add_u32 m0, s93, 132096
    s_add_u32 s99, s99, 256
    s_mov_b64 exec, s[80:81]
    buffer_load_dwordx4 v77, s[4:7], s100 offen  lds
    s_mov_b64 exec, -1
    s_add_u32 s100, s100, 256
    s_waitcnt lgkmcnt(3)
    v_mfma_f32_16x16x32_bf16 v[112:115], a[40:43], v[172:175], v[112:115]
    ds_read_b128 v[160:163], v198 offset:128
    v_mfma_f32_32x32x16_bf16 v[80:95], a[40:43], v[176:179], v[80:95]
    ds_read_b128 v[164:167], v196 offset:128
    s_lshl_b32 s25, s24, 6
    s_and_b32 s35, s74, 3
    s_lshl_b32 s35, s35, 13
    s_add_u32 s35, s35, s25
    v_mfma_f32_32x32x16_bf16 v[96:111], a[40:43], v[180:183], v[96:111]
    ds_read_b128 v[168:171], v196 offset:8832
    s_lshl_b32 s98, s72, 5
    s_add_u32 s98, s98, 256
    s_sub_u32 s95, s98, 4
    s_max_i32 s95, s95, 0
    s_lshl_b32 s94, s98, 3
    s_lshl_b32 s95, s95, 3
    s_add_u32 s94, s94, 3440640
    s_add_u32 s95, s95, 3440640
    s_add_u32 s96, s94, 8192
    buffer_load_dwordx2 v[152:153], v47, s[16:19], s94 offen sc1
    s_waitcnt lgkmcnt(3)
    v_mfma_f32_16x16x32_bf16 v[112:115], a[44:47], v[184:187], v[112:115]
    ds_read_b128 v[172:175], v198 offset:160
    v_mfma_f32_32x32x16_bf16 v[80:95], a[44:47], v[188:191], v[80:95]
    ds_read_b128 v[176:179], v197 offset:128
    s_lshr_b32 s25, s74, 4
    s_lshl_b32 s25, s25, 11
    s_add_u32 s35, s35, s25
    s_and_b32 s25, s74, 12
    v_mfma_f32_32x32x16_bf16 v[96:111], a[44:47], v[192:195], v[96:111]
    ds_read_b128 v[180:183], v197 offset:8832
    buffer_load_dwordx2 v[154:155], v47, s[16:19], s96 offen sc1
    s_lshl_b32 s25, s25, 6
    s_add_u32 s35, s35, s25
    s_waitcnt lgkmcnt(3)
    v_mfma_f32_16x16x32_bf16 v[112:115], a[48:51], v[160:163], v[112:115]
    ds_read_b128 v[184:187], v198 offset:192
    v_mfma_f32_32x32x16_bf16 v[80:95], a[48:51], v[164:167], v[80:95]
    ds_read_b128 v[188:191], v196 offset:192
    s_mul_i32 s36, s73, 20
    s_add_u32 s36, s36, s24
    s_add_u32 s36, s36, 16
    s_lshl_b32 s36, s36, 14
    v_mfma_f32_32x32x16_bf16 v[96:111], a[48:51], v[168:171], v[96:111]
    ds_read_b128 v[192:195], v196 offset:8896
    buffer_load_dwordx2 v[156:157], v48, s[16:19], s95 offen sc1
    v_add_u32 v199, 36352, v58
    s_lshl_b32 s32, s24, 11
    s_waitcnt lgkmcnt(3)
    v_mfma_f32_16x16x32_bf16 v[112:115], a[52:55], v[172:175], v[112:115]
    ds_read_b128 v[160:163], v198 offset:224
    v_mfma_f32_32x32x16_bf16 v[80:95], a[52:55], v[176:179], v[80:95]
    ds_read_b128 v[164:167], v197 offset:192
    v_add_u32 v203, s32, v199
    s_add_u32 s32, s24, 1
    s_and_b32 s32, s32, 3
    s_mul_i32 s32, s32, 6144
    v_mfma_f32_32x32x16_bf16 v[96:111], a[52:55], v[180:183], v[96:111]
    ds_read_b128 v[168:171], v197 offset:8896
    buffer_load_dwordx4 a[180:183], v58, s[16:19], s97 offen offset:1024 sc1
    v_add_u32 v200, s32, v199
    s_add_u32 s32, s24, 2
    s_waitcnt vmcnt(21)
    s_barrier
    s_waitcnt lgkmcnt(3)
    v_mfma_f32_16x16x32_bf16 v[112:115], a[56:59], v[184:187], v[112:115]
    v_add_u32 v198, v49, v198
    v_mfma_f32_32x32x16_bf16 v[80:95], a[56:59], v[188:191], v[80:95]
    v_add_u32 v196, 19584, v196
    v_add_u32 v197, 19584, v197
    ds_read_b128 v[172:175], v198 offset:0
    s_and_b32 s32, s32, 3
    s_mul_i32 s32, s32, 6144
    v_mfma_f32_32x32x16_bf16 v[96:111], a[56:59], v[192:195], v[96:111]
    ds_read_b128 v[176:179], v196 offset:0
    ds_read_b128 v[180:183], v196 offset:8704
    buffer_load_dwordx4 a[184:187], v58, s[16:19], s97 offen offset:2048 sc1
    v_add_u32_e64 v201, s32, v199
    s_waitcnt lgkmcnt(3)
    v_mfma_f32_16x16x32_bf16 v[112:115], a[60:63], v[160:163], v[112:115]
    ds_read_b128 v[184:187], v198 offset:32
    v_mfma_f32_32x32x16_bf16 v[80:95], a[60:63], v[164:167], v[80:95]
    ds_read_b128 v[188:191], v197 offset:0
    s_add_u32 s32, s24, 3
    s_and_b32 s32, s32, 3
    s_mul_i32 s32, s32, 6144
    v_add_u32_e64 v202, s32, v199
    v_mfma_f32_32x32x16_bf16 v[96:111], a[60:63], v[168:171], v[96:111]
    ds_read_b128 v[192:195], v197 offset:8704
    buffer_load_dwordx4 a[188:191], v58, s[16:19], s97 offen offset:3072 sc1
    s_mul_i32 s32, s24, 6144
    v_add_u32 v204, s32, v199
    s_waitcnt lgkmcnt(3)
    v_mfma_f32_16x16x32_bf16 v[112:115], a[64:67], v[172:175], v[112:115]
    ds_read_b128 v[160:163], v198 offset:64
    v_mfma_f32_32x32x16_bf16 v[80:95], a[64:67], v[176:179], v[80:95]
    ds_read_b128 v[164:167], v196 offset:64
    s_lshl_b32 s32, s24, 8
    s_add_u32 s32, s32, 36352
    v_and_b32 v214, 15, v1
    v_lshl_add_u32 v206, v214, 4, s32
    v_mfma_f32_32x32x16_bf16 v[96:111], a[64:67], v[180:183], v[96:111]
    ds_read_b128 v[168:171], v196 offset:8768
    s_add_u32 s97, s97, 4096
    buffer_load_dwordx4 a[192:195], v58, s[16:19], s97 offen offset:0 sc1
    v_lshrrev_b32 v215, 5, v1
    s_waitcnt lgkmcnt(3)
    v_mfma_f32_16x16x32_bf16 v[112:115], a[68:71], v[184:187], v[112:115]
    ds_read_b128 v[172:175], v198 offset:96
    v_mfma_f32_32x32x16_bf16 v[80:95], a[68:71], v[188:191], v[80:95]
    ds_read_b128 v[176:179], v197 offset:64
    v_lshl_add_u32 v205, v215, 10, v206
    v_bfe_u32 v215, v1, 4, 1
    v_lshl_add_u32 v205, v215, 3, v205
    v_lshlrev_b32_e64 v214, 2, v214
    v_mfma_f32_32x32x16_bf16 v[96:111], a[68:71], v[192:195], v[96:111]
    ds_read_b128 v[180:183], v197 offset:8768
    buffer_load_dwordx4 a[196:199], v58, s[16:19], s97 offen offset:1024 sc1
    v_lshl_add_u32 v214, v215, 10, v214
    s_lshl_b32 s32, s24, 6
    s_waitcnt lgkmcnt(3)
    v_mfma_f32_16x16x32_bf16 v[112:115], a[72:75], v[160:163], v[112:115]
    ds_read_b128 v[184:187], v198 offset:128
    v_mfma_f32_32x32x16_bf16 v[80:95], a[72:75], v[164:167], v[80:95]
    ds_read_b128 v[188:191], v196 offset:128
    v_lshl_add_u32 v207, v215, 3, s32
    v_and_b32 v215, 12, v1
    v_lshl_add_u32 v207, v215, 2, v207
    v_and_b32 v215, 2, v1
    v_mfma_f32_32x32x16_bf16 v[96:111], a[72:75], v[168:171], v[96:111]
    ds_read_b128 v[192:195], v196 offset:8832
    buffer_load_dwordx4 a[200:203], v58, s[16:19], s97 offen offset:2048 sc1
    v_lshl_add_u32 v207, v215, 1, v207
    v_add_u32 v207, 69120, v207
    s_waitcnt lgkmcnt(3)
    v_mfma_f32_16x16x32_bf16 v[112:115], a[76:79], v[172:175], v[112:115]
    ds_read_b128 v[160:163], v198 offset:160
    v_mfma_f32_32x32x16_bf16 v[80:95], a[76:79], v[176:179], v[80:95]
    ds_read_b128 v[164:167], v197 offset:128
    v_lshrrev_b32 v215, 4, v1
    v_lshl_add_u32 v206, v215, 2, v206
    v_mov_b32 v215, 0x3f803f80
    v_mfma_f32_32x32x16_bf16 v[96:111], a[76:79], v[180:183], v[96:111]
    ds_read_b128 v[168:171], v197 offset:8832
    buffer_load_dwordx4 a[204:207], v58, s[16:19], s97 offen offset:3072 sc1
    s_waitcnt lgkmcnt(3)
    v_mfma_f32_16x16x32_bf16 v[112:115], a[80:83], v[184:187], v[112:115]
    ds_read_b128 v[172:175], v198 offset:192
    v_mfma_f32_32x32x16_bf16 v[80:95], a[80:83], v[188:191], v[80:95]
    ds_read_b128 v[176:179], v196 offset:192
    v_mfma_f32_32x32x16_bf16 v[96:111], a[80:83], v[192:195], v[96:111]
    ds_read_b128 v[180:183], v196 offset:8896
    s_add_u32 s97, s97, 4096
    buffer_load_dwordx4 a[208:211], v58, s[16:19], s97 offen offset:0 sc1
    s_waitcnt lgkmcnt(3)
    v_mfma_f32_16x16x32_bf16 v[112:115], a[84:87], v[160:163], v[112:115]
    ds_read_b128 v[184:187], v198 offset:224
    v_mfma_f32_32x32x16_bf16 v[80:95], a[84:87], v[164:167], v[80:95]
    ds_read_b128 v[188:191], v197 offset:192
    v_mfma_f32_32x32x16_bf16 v[96:111], a[84:87], v[168:171], v[96:111]
    ds_read_b128 v[192:195], v197 offset:8896
    buffer_load_dwordx4 a[212:215], v58, s[16:19], s97 offen offset:1024 sc1
    s_waitcnt vmcnt(17)
    s_barrier
    s_waitcnt lgkmcnt(3)
    v_mfma_f32_16x16x32_bf16 v[112:115], a[88:91], v[172:175], v[112:115]
    v_add_u32 v198, v49, v198
    v_mfma_f32_32x32x16_bf16 v[80:95], a[88:91], v[176:179], v[80:95]
    v_add_u32 v196, 19584, v196
    v_add_u32 v197, 19584, v197
    ds_read_b128 v[160:163], v198 offset:0
    v_mfma_f32_32x32x16_bf16 v[96:111], a[88:91], v[180:183], v[96:111]
    ds_read_b128 v[164:167], v196 offset:0
    ds_read_b128 v[168:171], v196 offset:8704
    buffer_load_dwordx4 a[216:219], v58, s[16:19], s97 offen offset:2048 sc1
    s_waitcnt lgkmcnt(3)
    v_mfma_f32_16x16x32_bf16 v[112:115], a[92:95], v[184:187], v[112:115]
    ds_read_b128 v[172:175], v198 offset:32
    v_mfma_f32_32x32x16_bf16 v[80:95], a[92:95], v[188:191], v[80:95]
    ds_read_b128 v[176:179], v197 offset:0
    v_mfma_f32_32x32x16_bf16 v[96:111], a[92:95], v[192:195], v[96:111]
    ds_read_b128 v[180:183], v197 offset:8704
    buffer_load_dwordx4 a[220:223], v58, s[16:19], s97 offen offset:3072 sc1
    s_waitcnt lgkmcnt(3)
    v_mfma_f32_16x16x32_bf16 v[112:115], a[96:99], v[160:163], v[112:115]
    ds_read_b128 v[184:187], v198 offset:64
    v_mfma_f32_32x32x16_bf16 v[80:95], a[96:99], v[164:167], v[80:95]
    ds_read_b128 v[188:191], v196 offset:64
    v_mfma_f32_32x32x16_bf16 v[96:111], a[96:99], v[168:171], v[96:111]
    ds_read_b128 v[192:195], v196 offset:8768
    s_add_u32 s97, s97, 4096
    buffer_load_dwordx4 a[224:227], v58, s[16:19], s97 offen offset:0 sc1
    s_waitcnt lgkmcnt(3)
    v_mfma_f32_16x16x32_bf16 v[112:115], a[100:103], v[172:175], v[112:115]
    ds_read_b128 v[160:163], v198 offset:96
    v_mfma_f32_32x32x16_bf16 v[80:95], a[100:103], v[176:179], v[80:95]
    ds_read_b128 v[164:167], v197 offset:64
    v_mfma_f32_32x32x16_bf16 v[96:111], a[100:103], v[180:183], v[96:111]
    ds_read_b128 v[168:171], v197 offset:8768
    buffer_load_dwordx4 a[228:231], v58, s[16:19], s97 offen offset:1024 sc1
    s_waitcnt lgkmcnt(3)
    v_mfma_f32_16x16x32_bf16 v[112:115], a[104:107], v[184:187], v[112:115]
    ds_read_b128 v[172:175], v198 offset:128
    v_mfma_f32_32x32x16_bf16 v[80:95], a[104:107], v[188:191], v[80:95]
    ds_read_b128 v[176:179], v196 offset:128
    v_mfma_f32_32x32x16_bf16 v[96:111], a[104:107], v[192:195], v[96:111]
    ds_read_b128 v[180:183], v196 offset:8832
    buffer_load_dwordx4 a[232:235], v58, s[16:19], s97 offen offset:2048 sc1
    s_waitcnt lgkmcnt(3)
    v_mfma_f32_16x16x32_bf16 v[112:115], a[108:111], v[160:163], v[112:115]
    ds_read_b128 v[184:187], v198 offset:160
    v_mfma_f32_32x32x16_bf16 v[80:95], a[108:111], v[164:167], v[80:95]
    ds_read_b128 v[188:191], v197 offset:128
    v_mfma_f32_32x32x16_bf16 v[96:111], a[108:111], v[168:171], v[96:111]
    ds_read_b128 v[192:195], v197 offset:8832
    buffer_load_dwordx4 a[236:239], v58, s[16:19], s97 offen offset:3072 sc1
    s_waitcnt lgkmcnt(3)
    v_mfma_f32_16x16x32_bf16 v[112:115], a[112:115], v[172:175], v[112:115]
    ds_read_b128 v[160:163], v198 offset:192
    v_mfma_f32_32x32x16_bf16 v[80:95], a[112:115], v[176:179], v[80:95]
    ds_read_b128 v[164:167], v196 offset:192
    v_mfma_f32_32x32x16_bf16 v[96:111], a[112:115], v[180:183], v[96:111]
    ds_read_b128 v[168:171], v196 offset:8896
    s_add_u32 s97, s97, 4096
    buffer_load_dwordx4 a[240:243], v58, s[16:19], s97 offen offset:0 sc1
    s_waitcnt lgkmcnt(3)
    v_mfma_f32_16x16x32_bf16 v[112:115], a[116:119], v[184:187], v[112:115]
    ds_read_b128 v[172:175], v198 offset:224
    v_mfma_f32_32x32x16_bf16 v[80:95], a[116:119], v[188:191], v[80:95]
    ds_read_b128 v[176:179], v197 offset:192
    v_mfma_f32_32x32x16_bf16 v[96:111], a[116:119], v[192:195], v[96:111]
    ds_read_b128 v[180:183], v197 offset:8896
    buffer_load_dwordx4 a[244:247], v58, s[16:19], s97 offen offset:1024 sc1
    s_waitcnt vmcnt(20)
    s_barrier
    s_waitcnt lgkmcnt(3)
    v_mfma_f32_16x16x32_bf16 v[112:115], a[120:123], v[160:163], v[112:115]
    v_add_u32_e64 v198, v49, v198
    v_mfma_f32_32x32x16_bf16 v[80:95], a[120:123], v[164:167], v[80:95]
    v_add_u32 v196, 19584, v196
    v_add_u32 v197, 19584, v197
    s_waitcnt vmcnt(17)
    v_mul_f32 v148, v24, v157
    v_mul_f32 v149, v25, v157
    v_mul_f32 v150, v26, v157
    v_mfma_f32_32x32x16_bf16 v[96:111], a[120:123], v[168:171], v[96:111]
    ds_read_b128 v[184:187], v198 offset:0
    ds_read_b128 v[188:191], v196 offset:0
    buffer_load_dwordx4 a[248:251], v58, s[16:19], s97 offen offset:2048 sc1
    v_mul_f32 v151, v27, v157
    v_mul_f32_e64 v116, v8, v153
    s_waitcnt lgkmcnt(2)
    v_mfma_f32_16x16x32_bf16 v[112:115], a[124:127], v[172:175], v[112:115]
    ds_read_b128 v[192:195], v198 offset:32
    v_mfma_f32_32x32x16_bf16 v[80:95], a[124:127], v[176:179], v[80:95]
    ds_read_b128 v[160:163], v197 offset:0
    v_mul_f32 v117, v9, v153
    v_mul_f32 v118, v10, v153
    v_mul_f32 v119, v11, v153
    v_mul_f32 v120, v12, v153
    v_mfma_f32_32x32x16_bf16 v[96:111], a[124:127], v[180:183], v[96:111]
    buffer_load_dwordx4 a[252:255], v58, s[16:19], s97 offen offset:3072 sc1
    v_mul_f32 v121, v13, v153
    v_mul_f32 v122, v14, v153
    v_mul_f32 v123, v15, v153
    s_waitcnt lgkmcnt(2)
    v_mfma_f32_16x16x32_bf16 v[112:115], a[128:131], v[184:187], v[112:115]
    ds_read_b128 v[164:167], v198 offset:64
    v_mfma_f32_32x32x16_bf16 v[80:95], a[128:131], v[188:191], v[80:95]
    ds_read_b128 v[168:171], v196 offset:64
    v_mul_f32 v124, v16, v153
    v_mul_f32 v125, v17, v153
    v_mul_f32 v126, v18, v153
    s_waitcnt lgkmcnt(2)
    v_mfma_f32_16x16x32_bf16 v[112:115], a[132:135], v[192:195], v[112:115]
    ds_read_b128 v[172:175], v198 offset:96
    v_mfma_f32_32x32x16_bf16 v[80:95], a[132:135], v[160:163], v[80:95]
    ds_read_b128 v[176:179], v197 offset:64
    s_add_u32 s97, s97, 4096
    buffer_load_dwordx4 v[52:55], v58, s[16:19], s97 offen offset:0 sc1
    v_mul_f32 v127, v19, v153
    v_mul_f32_e64 v128, v20, v153
    s_waitcnt lgkmcnt(2)
    v_mfma_f32_16x16x32_bf16 v[112:115], a[136:139], v[164:167], v[112:115]
    ds_read_b128 v[180:183], v198 offset:128
    v_mfma_f32_32x32x16_bf16 v[80:95], a[136:139], v[168:171], v[80:95]
    ds_read_b128 v[184:187], v196 offset:128
    v_mul_f32 v129, v21, v153
    v_mul_f32 v130, v22, v153
    v_mul_f32 v131, v23, v153
    s_waitcnt lgkmcnt(2)
    v_mfma_f32_16x16x32_bf16 v[112:115], a[140:143], v[172:175], v[112:115]
    ds_read_b128 v[188:191], v198 offset:160
    v_mfma_f32_32x32x16_bf16 v[80:95], a[140:143], v[176:179], v[80:95]
    ds_read_b128 v[192:195], v197 offset:128
    s_mov_b32 s96, 4194304
    buffer_load_dwordx4 v[216:219], v56, s[16:19], s96 offen offset:0 sc1
    v_mul_f32 v132, v8, v155
    v_mul_f32_e64 v133, v9, v155
    s_waitcnt lgkmcnt(2)
    v_mfma_f32_16x16x32_bf16 v[112:115], a[144:147], v[180:183], v[112:115]
    ds_read_b128 v[160:163], v198 offset:192
    v_mfma_f32_32x32x16_bf16 v[80:95], a[144:147], v[184:187], v[80:95]
    ds_read_b128 v[164:167], v196 offset:192
    v_mul_f32 v134, v10, v155
    v_mul_f32 v135, v11, v155
    v_mul_f32 v136, v12, v155
    s_waitcnt lgkmcnt(2)
    v_mfma_f32_16x16x32_bf16 v[112:115], a[148:151], v[188:191], v[112:115]
    ds_read_b128 v[168:171], v198 offset:224
    v_mfma_f32_32x32x16_bf16 v[80:95], a[148:151], v[192:195], v[80:95]
    ds_read_b128 v[172:175], v197 offset:192
    buffer_load_dwordx4 v[220:223], v56, s[16:19], s96 offen offset:256 sc1
    v_mul_f32 v137, v13, v155
    v_mul_f32_e64 v138, v14, v155
    s_waitcnt lgkmcnt(2)
    v_mfma_f32_16x16x32_bf16 v[112:115], a[152:155], v[160:163], v[112:115]
    ds_read_b128 v[176:179], v196 offset:8704
    v_mfma_f32_32x32x16_bf16 v[80:95], a[152:155], v[164:167], v[80:95]
    ds_read_b128 v[180:183], v197 offset:8704
    v_mul_f32 v139, v15, v155
    v_mul_f32 v140, v16, v155
    v_mul_f32 v141, v17, v155
    s_waitcnt lgkmcnt(2)
    v_mfma_f32_16x16x32_bf16 v[112:115], a[156:159], v[168:171], v[112:115]
    ds_read_b128 v[184:187], v196 offset:8768
    v_mfma_f32_32x32x16_bf16 v[80:95], a[156:159], v[172:175], v[80:95]
    ds_read_b128 v[188:191], v197 offset:8768
    s_mov_b32 s96, 4227072
    buffer_load_dwordx4 v[224:227], v56, s[16:19], s96 offen offset:0 sc1
    v_mul_f32 v142, v18, v155
    v_mul_f32 v143, v19, v155
    v_mul_f32 v144, v20, v155
    v_mul_f32 v145, v21, v155
    v_mul_f32 v146, v22, v155
    v_mul_f32_e64 v147, v23, v155
    s_waitcnt lgkmcnt(2)
    v_mfma_f32_32x32x16_bf16 v[96:111], a[128:131], v[176:179], v[96:111]
    ds_read_b128 v[192:195], v196 offset:8832
    v_mfma_f32_32x32x16_bf16 v[96:111], a[132:135], v[180:183], v[96:111]
    ds_read_b128 v[160:163], v197 offset:8832
    buffer_load_dwordx4 v[228:231], v56, s[16:19], s96 offen offset:256 sc1
    v_fma_f32 v112, v112, v156, v148
    v_fma_f32 v113, v113, v156, v149
    s_waitcnt lgkmcnt(2)
    v_mfma_f32_32x32x16_bf16 v[96:111], a[136:139], v[184:187], v[96:111]
    ds_read_b128 v[164:167], v196 offset:8896
    v_fma_f32 v114, v114, v156, v150
    v_fma_f32 v115, v115, v156, v151
    v_cvt_pk_bf16_f32 v112, v112, v113
    v_cvt_pk_bf16_f32 v113, v114, v115
    v_mfma_f32_32x32x16_bf16 v[96:111], a[140:143], v[188:191], v[96:111]
    ds_read_b128 v[168:171], v197 offset:8896
    s_mov_b32 s96, 4259840
    buffer_load_dwordx4 v[232:235], v56, s[16:19], s96 offen offset:0 sc1
    v_fma_f32 v80, v80, v152, v116
    v_fma_f32 v81, v81, v152, v117
    s_waitcnt lgkmcnt(2)
    v_mfma_f32_32x32x16_bf16 v[96:111], a[144:147], v[192:195], v[96:111]
    v_fma_f32 v82, v82, v152, v118
    v_fma_f32 v83, v83, v152, v119
    v_cvt_pk_bf16_f32 v80, v80, v81
    v_cvt_pk_bf16_f32 v81, v82, v83
    ds_write_b64 v40, v[112:113] offset:0
    v_mfma_f32_32x32x16_bf16 v[96:111], a[148:151], v[160:163], v[96:111]
    ds_write_b64 v38, v[80:81] offset:0
    v_fma_f32 v84, v84, v152, v120
    v_fma_f32 v85, v85, v152, v121
    v_fma_f32 v86, v86, v152, v122
    s_waitcnt lgkmcnt(2)
    v_mfma_f32_32x32x16_bf16 v[96:111], a[152:155], v[164:167], v[96:111]
    v_fma_f32 v87, v87, v152, v123
    v_cvt_pk_bf16_f32 v84, v84, v85
    v_cvt_pk_bf16_f32 v85, v86, v87
    v_fma_f32 v88, v88, v152, v124
    v_fma_f32 v89, v89, v152, v125
    v_mfma_f32_32x32x16_bf16 v[96:111], a[156:159], v[168:171], v[96:111]
    buffer_load_dwordx4 v[236:239], v56, s[16:19], s96 offen offset:256 sc1
    v_fma_f32 v90, v90, v152, v126
    v_fma_f32 v91, v91, v152, v127
    v_cvt_pk_bf16_f32 v88, v88, v89
    v_cvt_pk_bf16_f32 v89, v90, v91
    ds_write_b64 v38, v[84:85] offset:6400
    ds_write_b64 v38, v[88:89] offset:12800
    v_fma_f32 v92, v92, v152, v128
    v_fma_f32 v93, v93, v152, v129
    v_fma_f32 v94, v94, v152, v130
    v_fma_f32 v95, v95, v152, v131
    v_cvt_pk_bf16_f32 v92, v92, v93
    v_cvt_pk_bf16_f32 v93, v94, v95
    ds_write_b64 v39, v[92:93] offset:0
    v_pk_fma_f32 v[96:97], v[96:97], v[154:155], v[132:133] op_sel_hi:[1,0,1]
    v_pk_fma_f32 v[98:99], v[98:99], v[154:155], v[134:135] op_sel_hi:[1,0,1]
    v_cvt_pk_bf16_f32 v96, v96, v97
    v_cvt_pk_bf16_f32 v97, v98, v99
    v_pk_fma_f32 v[100:101], v[100:101], v[154:155], v[136:137] op_sel_hi:[1,0,1]
    v_pk_fma_f32 v[102:103], v[102:103], v[154:155], v[138:139] op_sel_hi:[1,0,1]
    v_cvt_pk_bf16_f32 v100, v100, v101
    v_cvt_pk_bf16_f32 v101, v102, v103
    ds_write_b64 v38, v[96:97] offset:1600
    ds_write_b64 v38, v[100:101] offset:8000
    v_pk_fma_f32 v[104:105], v[104:105], v[154:155], v[140:141] op_sel_hi:[1,0,1]
    v_pk_fma_f32 v[106:107], v[106:107], v[154:155], v[142:143] op_sel_hi:[1,0,1]
    v_cvt_pk_bf16_f32 v104, v104, v105
    v_cvt_pk_bf16_f32 v105, v106, v107
    v_pk_fma_f32 v[108:109], v[108:109], v[154:155], v[144:145] op_sel_hi:[1,0,1]
    v_pk_fma_f32 v[110:111], v[110:111], v[154:155], v[146:147] op_sel_hi:[1,0,1]
    v_cvt_pk_bf16_f32 v108, v108, v109
    v_cvt_pk_bf16_f32 v109, v110, v111
    ds_write_b64 v38, v[104:105] offset:14400
    ds_write_b64 v39, v[108:109] offset:1600
    s_waitcnt lgkmcnt(0)
    s_barrier
    v_mov_b32 v94, 0
    v_mov_b32 v95, 0
    v_mov_b32 v98, 0
    v_mov_b32_e64 v99, 0
    s_mov_b64 exec, 0xffff
    ds_read_b64 v[94:95], v42 offset:320
    ds_read_b64 v[98:99], v42 offset:640
    s_mov_b64 exec, -1
    s_nop 0
    ds_read_b64 v[92:93], v41 offset:320
    ds_read_b64 v[96:97], v41 offset:640
    ds_read_b64 v[84:85], v41 offset:6720
    ds_read_b64 v[86:87], v42 offset:6720
    ds_read_b64 v[80:81], v41 offset:6400
    ds_read_b64 v[82:83], v42 offset:6400
    ds_read_b64 v[88:89], v41 offset:7040
    ds_read_b64 v[90:91], v42 offset:7040
    ds_read_b64_tr_b16 v[106:107], v44 offset:0
    ds_read_b64_tr_b16 v[100:101], v43 offset:0
    ds_read_b64_tr_b16 v[108:109], v44 offset:320
    ds_read_b64_tr_b16 v[102:103], v43 offset:320
    s_mov_b32 s96, 4292608
    buffer_load_dwordx4 v[240:243], v56, s[16:19], s96 offen offset:0 sc1
    ds_read_b64_tr_b16 v[110:111], v44 offset:640
    ds_read_b64_tr_b16 v[104:105], v43 offset:640
    s_mov_b32 s82, 0x3ea52b5c
    s_lshl_b32 s25, s98, 4
    s_add_u32 s25, s25, 4194304
    s_lshl_b32 s26, s98, 3
    s_add_u32 s26, s26, 4194304
    s_waitcnt lgkmcnt(10)
    v_mfma_f32_16x16x32_bf16 v[116:119], v[84:87], v[92:95], v[28:31]
    buffer_load_dwordx4 v[244:247], v56, s[16:19], s96 offen offset:256 sc1
    v_mfma_f32_16x16x32_bf16 v[120:123], v[84:87], v[96:99], v[32:35]
    s_waitcnt lgkmcnt(8)
    v_mfma_f32_16x16x32_bf16 v[112:115], v[80:83], v[92:95], v[32:35]
    s_waitcnt lgkmcnt(6)
    v_mfma_f32_16x16x32_bf16 v[124:127], v[88:91], v[96:99], v[28:31]
    s_nop 5
    v_max_f32 v112, v112, v116
    v_max_f32 v113, v113, v117
    v_max_f32 v114, v114, v118
    v_max_f32 v115, v115, v119
    v_max3_f32 v156, v112, v113, v114
    s_mov_b32 s96, 4194304
    buffer_load_dwordx2 v[248:249], v57, s[16:19], s96 offen offset:0 sc1
    v_max_f32 v156, v156, v115
    v_max_f32 v120, v120, v124
    v_max_f32 v121, v121, v125
    v_max_f32 v122, v122, v126
    v_max_f32 v123, v123, v127
    v_max3_f32 v157, v120, v121, v122
    v_max_f32 v157, v157, v123
    s_nop 1
    v_permlane16_swap_b32 v156, v157
    buffer_load_dwordx2 v[252:253], v57, s[16:19], s96 offen offset:128 sc1
    v_max_f32 v156, v156, v157
    v_mov_b32 v157, v156
    s_nop 1
    v_permlane32_swap_b32 v156, v157
    v_max_f32 v156, v156, v157
    v_mul_f32 v156, s82, v156
    v_mov_b32 v157, v156
    s_nop 1
    v_permlane16_swap_b32_e64 v156, v157
    v_fma_f32 v112, v112, s82, -v156
    s_mov_b32 s96, 4210688
    buffer_load_dwordx2 v[250:251], v57, s[16:19], s96 offen offset:0 sc1
    v_fma_f32 v113, v113, s82, -v156
    v_fma_f32 v114, v114, s82, -v156
    v_fma_f32 v115, v115, s82, -v156
    v_exp_f32 v112, v112
    v_exp_f32 v113, v113
    v_exp_f32 v114, v114
    v_exp_f32 v115, v115
    v_cvt_pk_bf16_f32 v116, v112, v113
    buffer_load_dwordx2 v[254:255], v57, s[16:19], s96 offen offset:128 sc1
    v_cvt_pk_bf16_f32 v117, v114, v115
    v_bfi_b32 v128, v36, 0, v116
    v_and_b32 v130, v36, v116
    v_bfi_b32 v129, v37, 0, v117
    v_and_b32 v131, v37, v117
    s_waitcnt lgkmcnt(3)
    s_nop 0
    v_mfma_f32_16x16x32_bf16 v[144:147], v[106:109], v[128:131], 0
    s_waitcnt lgkmcnt(2)
    v_mfma_f32_16x16x32_bf16 v[136:139], v[100:103], v[128:131], 0
    v_fma_f32 v120, v120, s82, -v157
    s_mov_b32 s96, 0
    s_mov_b32 s97, 5120
    buffer_load_dwordx2 v[208:209], v60, s[4:7], s96 offen
    v_fma_f32 v121, v121, s82, -v157
    v_fma_f32 v122, v122, s82, -v157
    v_fma_f32 v123, v123, s82, -v157
    v_exp_f32 v120, v120
    v_exp_f32 v121, v121
    v_exp_f32 v122, v122
    v_exp_f32 v123, v123
    v_cvt_pk_bf16_f32 v124, v120, v121
    buffer_load_dwordx2 v[210:211], v60, s[4:7], s97 offen
    v_cvt_pk_bf16_f32 v125, v122, v123
    v_bfi_b32 v132, v36, 0, v124
    v_and_b32 v134, v36, v124
    v_bfi_b32 v133, v37, 0, v125
    v_and_b32 v135, v37, v125
    s_waitcnt lgkmcnt(1)
    s_nop 0
    v_mfma_f32_16x16x32_bf16 v[148:151], v[108:111], v[132:135], 0
    s_waitcnt lgkmcnt(0)
    v_mfma_f32_16x16x32_bf16 v[140:143], v[102:105], v[132:135], 0
    v_mov_b32 v158, v144
    v_lshrrev_b32_e64 v212, 5, v1
    v_mul_u32_u24 v212, 5104, v212
    v_bfe_u32 v213, v1, 4, 1
    v_lshlrev_b32 v213, 2, v213
    v_sub_u32 v212, v212, v213
    v_add_u32 v212, v212, v60
    s_mul_i32 s97, s24, 24
    s_sub_u32 s97, 128, s97
    buffer_load_dword v212, v212, s[4:7], s97 offen
    v_permlane16_swap_b32 v144, v158
    v_rcp_f32_e64 v158, v158
    s_nop 0
    v_pk_mul_f32 v[136:137], v[136:137], v[158:159] op_sel_hi:[1,0]
    v_pk_mul_f32 v[138:139], v[138:139], v[158:159] op_sel_hi:[1,0]
    v_pk_mul_f32 v[144:145], v[144:145], v[158:159] op_sel_hi:[1,0]
    v_pk_mul_f32 v[146:147], v[146:147], v[158:159] op_sel_hi:[1,0]
    v_cvt_pk_bf16_f32 v112, v136, v137
    v_cvt_pk_bf16_f32 v116, v144, v145
    v_cvt_pk_bf16_f32 v113, v138, v139
    v_cvt_pk_bf16_f32 v117, v146, v147
    v_mov_b32 v160, v148
    s_nop 1
    v_permlane16_swap_b32 v148, v160
    v_rcp_f32_e64 v160, v160
    s_nop 0
    v_pk_mul_f32 v[140:141], v[140:141], v[160:161] op_sel_hi:[1,0]
    v_pk_mul_f32 v[142:143], v[142:143], v[160:161] op_sel_hi:[1,0]
    v_pk_mul_f32 v[148:149], v[148:149], v[160:161] op_sel_hi:[1,0]
    v_pk_mul_f32 v[150:151], v[150:151], v[160:161] op_sel_hi:[1,0]
    v_cvt_pk_bf16_f32 v114, v140, v141
    v_cvt_pk_bf16_f32 v118, v148, v149
    v_cvt_pk_bf16_f32 v115, v142, v143
    v_cvt_pk_bf16_f32 v119, v150, v151
    v_permlane16_swap_b32 v112, v114
    v_permlane16_swap_b32 v113, v115
    v_permlane16_swap_b32 v116, v118
    v_permlane16_swap_b32 v117, v119
    buffer_store_dwordx4 v[112:115], v45, s[16:19], s25 offen sc1
    s_mov_b64 exec, s[80:81]
    buffer_store_dwordx2 v[116:117], v46, s[16:19], s26 offen sc1
    s_mov_b64 exec, -1
oe_20:
    s_waitcnt vmcnt(16)
    v_mfma_f32_16x16x32_bf16 v[112:115], a[176:179], v[216:219], 0
    v_mov_b32 v136, 0
    v_mov_b32 v137, 0
    s_waitcnt vmcnt(15)
    v_mfma_f32_16x16x32_bf16 v[116:119], a[176:179], v[220:223], 0
    v_mov_b32 v138, 0
    v_mov_b32 v139, 0
    s_waitcnt vmcnt(14)
    v_mfma_f32_16x16x32_bf16 v[112:115], a[196:199], v[224:227], v[112:115]
    v_mov_b32 v140, 0
    v_mov_b32 v141, 0
    s_waitcnt vmcnt(13)
    v_mfma_f32_16x16x32_bf16 v[116:119], a[196:199], v[228:231], v[116:119]
    s_mov_b32 s25, 6815744
    s_add_u32 s26, s36, 6815744
    s_waitcnt vmcnt(12)
    v_mfma_f32_16x16x32_bf16 v[112:115], a[216:219], v[232:235], v[112:115]
    s_add_u32 s27, s35, 3473408
    s_mov_b32 s28, 0x99999999
    s_waitcnt vmcnt(11)
    v_mfma_f32_16x16x32_bf16 v[116:119], a[216:219], v[236:239], v[116:119]
    s_mov_b32 s29, 0x99999999
    s_waitcnt vmcnt(10)
    v_mfma_f32_16x16x32_bf16 v[112:115], a[236:239], v[240:243], v[112:115]
    s_waitcnt vmcnt(9)
    v_mfma_f32_16x16x32_bf16 v[116:119], a[236:239], v[244:247], v[116:119]
    s_waitcnt vmcnt(6)
    v_mfma_f32_16x16x32_bf16 v[112:115], v[52:55], v[248:251], v[112:115]
    s_waitcnt vmcnt(5)
    v_mfma_f32_16x16x32_bf16 v[116:119], v[52:55], v[252:255], v[116:119]
    v_mfma_f32_16x16x32_bf16 v[88:91], a[164:167], v[216:219], 0
    v_mfma_f32_16x16x32_bf16 v[92:95], a[164:167], v[220:223], 0
    v_mfma_f32_16x16x32_bf16 v[88:91], a[184:187], v[224:227], v[88:91]
    v_mfma_f32_16x16x32_bf16 v[92:95], a[184:187], v[228:231], v[92:95]
    v_mfma_f32_16x16x32_bf16 v[88:91], a[204:207], v[232:235], v[88:91]
    v_mfma_f32_16x16x32_bf16 v[92:95], a[204:207], v[236:239], v[92:95]
    s_nop 1
    v_cmp_u_f32 vcc, v112, v116
    s_nop 0
    s_cbranch_vccnz rd_21
rc_22:
    v_mfma_f32_16x16x32_bf16 v[88:91], a[224:227], v[240:243], v[88:91]
    ds_write_b128 v203, v[112:115] offset:24576
    v_mfma_f32_16x16x32_bf16 v[92:95], a[224:227], v[244:247], v[92:95]
    v_mfma_f32_16x16x32_bf16 v[88:91], a[244:247], v[248:251], v[88:91]
    ds_write_b128 v203, v[116:119] offset:25600
    v_mfma_f32_16x16x32_bf16 v[92:95], a[244:247], v[252:255], v[92:95]
    v_mfma_f32_16x16x32_bf16 v[96:99], a[168:171], v[216:219], 0
    s_waitcnt vmcnt(4)
    v_lshlrev_b32 v120, 16, v208
    v_and_b32 v121, 0xffff0000, v208
    v_mfma_f32_16x16x32_bf16 v[100:103], a[168:171], v[220:223], 0
    v_lshlrev_b32_e64 v122, 16, v209
    v_and_b32 v123, 0xffff0000, v209
    v_mfma_f32_16x16x32_bf16 v[96:99], a[188:191], v[224:227], v[96:99]
    s_waitcnt vmcnt(3)
    v_lshlrev_b32 v124, 16, v210
    v_and_b32 v125, 0xffff0000, v210
    v_mfma_f32_16x16x32_bf16 v[100:103], a[188:191], v[228:231], v[100:103]
    v_lshlrev_b32_e64 v126, 16, v211
    v_and_b32 v127, 0xffff0000, v211
    v_mfma_f32_16x16x32_bf16 v[96:99], a[208:211], v[232:235], v[96:99]
    s_waitcnt vmcnt(2)
    v_lshlrev_b32 v128, 16, v212
    v_and_b32 v129, 0xffff0000, v212
    v_mfma_f32_16x16x32_bf16 v[100:103], a[208:211], v[236:239], v[100:103]
    v_mfma_f32_16x16x32_bf16 v[96:99], a[228:231], v[240:243], v[96:99]
    ds_write_b128 v200, v[88:91] offset:0
    v_mfma_f32_16x16x32_bf16 v[100:103], a[228:231], v[244:247], v[100:103]
    v_mfma_f32_16x16x32_bf16 v[96:99], a[248:251], v[248:251], v[96:99]
    ds_write_b128 v200, v[92:95] offset:1024
    v_mfma_f32_16x16x32_bf16 v[100:103], a[248:251], v[252:255], v[100:103]
    v_mfma_f32_16x16x32_bf16 v[104:107], a[172:175], v[216:219], 0
    v_mfma_f32_16x16x32_bf16 v[108:111], a[172:175], v[220:223], 0
    v_mfma_f32_16x16x32_bf16 v[104:107], a[192:195], v[224:227], v[104:107]
    v_mfma_f32_16x16x32_bf16 v[108:111], a[192:195], v[228:231], v[108:111]
    v_mfma_f32_16x16x32_bf16 v[104:107], a[212:215], v[232:235], v[104:107]
    v_mfma_f32_16x16x32_bf16 v[108:111], a[212:215], v[236:239], v[108:111]
    v_mfma_f32_16x16x32_bf16 v[104:107], a[232:235], v[240:243], v[104:107]
    ds_write_b128 v201, v[96:99] offset:2048
    v_mfma_f32_16x16x32_bf16 v[108:111], a[232:235], v[244:247], v[108:111]
    v_mfma_f32_16x16x32_bf16 v[104:107], a[252:255], v[248:251], v[104:107]
    ds_write_b128 v201, v[100:103] offset:3072
    v_mfma_f32_16x16x32_bf16 v[108:111], a[252:255], v[252:255], v[108:111]
    v_mfma_f32_16x16x32_bf16 v[80:83], a[160:163], v[216:219], v[120:123]
    v_mfma_f32_16x16x32_bf16 v[84:87], a[160:163], v[220:223], v[124:127]
    v_mfma_f32_16x16x32_bf16 v[80:83], a[180:183], v[224:227], v[80:83]
    v_mfma_f32_16x16x32_bf16 v[84:87], a[180:183], v[228:231], v[84:87]
    v_mfma_f32_16x16x32_bf16 v[80:83], a[200:203], v[232:235], v[80:83]
    s_nop 0
    ds_write_b128 v202, v[104:107] offset:4096
    v_mfma_f32_16x16x32_bf16 v[84:87], a[200:203], v[236:239], v[84:87]
    ds_write_b128 v202, v[108:111] offset:5120
    v_mfma_f32_16x16x32_bf16 v[80:83], a[220:223], v[240:243], v[80:83]
    v_mfma_f32_16x16x32_bf16 v[84:87], a[220:223], v[244:247], v[84:87]
    v_mfma_f32_16x16x32_bf16 v[80:83], a[240:243], v[248:251], v[80:83]
    v_mfma_f32_16x16x32_bf16 v[84:87], a[240:243], v[252:255], v[84:87]
    s_waitcnt lgkmcnt(0)
    s_barrier
    s_nop 0
    ds_read_b128 v[88:91], v204 offset:0
    ds_read_b128 v[92:95], v204 offset:1024
    ds_read_b128 v[96:99], v204 offset:2048
    ds_read_b128 v[100:103], v204 offset:3072
    ds_read_b128 v[104:107], v204 offset:4096
    ds_read_b128 v[108:111], v204 offset:5120
    ds_read_b64 v[112:113], v205 offset:24576
    ds_read_b64 v[114:115], v205 offset:26624
    ds_read_b64 v[116:117], v205 offset:28672
    ds_read_b64 v[118:119], v205 offset:30720
    s_mov_b32 s96, 4198400
    buffer_load_dwordx4 v[216:219], v56, s[16:19], s96 offen offset:0 sc1
    buffer_load_dwordx4 v[220:223], v56, s[16:19], s96 offen offset:256 sc1
    s_mov_b32 s96, 4231168
    buffer_load_dwordx4 v[224:227], v56, s[16:19], s96 offen offset:0 sc1
    buffer_load_dwordx4 v[228:231], v56, s[16:19], s96 offen offset:256 sc1
    s_mov_b32 s96, 4263936
    buffer_load_dwordx4 v[232:235], v56, s[16:19], s96 offen offset:0 sc1
    buffer_load_dwordx4 v[236:239], v56, s[16:19], s96 offen offset:256 sc1
    s_waitcnt lgkmcnt(9)
    v_pk_add_f32 v[80:81], v[80:81], v[88:89]
    v_pk_add_f32 v[82:83], v[82:83], v[90:91]
    s_waitcnt lgkmcnt(8)
    v_pk_add_f32 v[84:85], v[84:85], v[92:93]
    v_pk_add_f32 v[86:87], v[86:87], v[94:95]
    s_waitcnt lgkmcnt(7)
    v_pk_add_f32 v[80:81], v[80:81], v[96:97]
    v_pk_add_f32 v[82:83], v[82:83], v[98:99]
    s_waitcnt lgkmcnt(6)
    v_pk_add_f32 v[84:85], v[84:85], v[100:101]
    v_pk_add_f32 v[86:87], v[86:87], v[102:103]
    s_waitcnt lgkmcnt(5)
    v_pk_add_f32 v[80:81], v[80:81], v[104:105]
    v_pk_add_f32 v[82:83], v[82:83], v[106:107]
    s_waitcnt lgkmcnt(4)
    v_pk_add_f32 v[84:85], v[84:85], v[108:109]
    v_pk_add_f32 v[86:87], v[86:87], v[110:111]
    v_cvt_pk_bf16_f32 v132, v80, v81
    v_cvt_pk_bf16_f32 v133, v82, v83
    v_cvt_pk_bf16_f32 v134, v84, v85
    v_cvt_pk_bf16_f32 v135, v86, v87
    s_waitcnt lgkmcnt(3)
    v_pk_add_f32 v[128:129], v[128:129], v[112:113]
    s_waitcnt lgkmcnt(2)
    v_pk_add_f32 v[128:129], v[128:129], v[114:115]
    s_waitcnt lgkmcnt(1)
    v_pk_add_f32 v[128:129], v[128:129], v[116:117]
    s_waitcnt lgkmcnt(0)
    v_pk_add_f32 v[128:129], v[128:129], v[118:119]
    v_cvt_pk_bf16_f32 v130, v128, v129
    buffer_store_dwordx4 v[132:135], v59, s[16:19], s25 offen sc1
    buffer_store_dword v130, v61, s[16:19], s26 offen sc1
    v_dot2c_f32_bf16 v136, v132, v215
    v_dot2c_f32_bf16 v137, v132, v132
    v_dot2c_f32_bf16 v136, v133, v215
    v_dot2c_f32_bf16 v137, v133, v133
    v_dot2c_f32_bf16 v138, v134, v215
    v_dot2c_f32_bf16 v139, v134, v134
    v_dot2c_f32_bf16 v138, v135, v215
    v_dot2c_f32_bf16 v139, v135, v135
    v_dot2c_f32_bf16 v140, v130, v215
    v_dot2c_f32_bf16 v141, v130, v130
    v_permlane32_swap_b32 v136, v138
    v_permlane32_swap_b32 v137, v139
    v_pk_add_f32 v[136:137], v[136:137], v[138:139]
    v_pk_add_f32 v[136:137], v[136:137], v[140:141]
    s_nop 1
    v_permlane16_swap_b32 v136, v137
    v_add_f32_e64 v136, v136, v137
    ds_write_b32 v206, v136 offset:32768
    s_mov_b32 s96, 4296704
    buffer_load_dwordx4 v[240:243], v56, s[16:19], s96 offen offset:0 sc1
    buffer_load_dwordx4 v[244:247], v56, s[16:19], s96 offen offset:256 sc1
    s_mov_b32 s96, 4196352
    buffer_load_dwordx2 v[248:249], v57, s[16:19], s96 offen offset:0 sc1
    buffer_load_dwordx2 v[252:253], v57, s[16:19], s96 offen offset:128 sc1
    s_mov_b32 s96, 4212736
    buffer_load_dwordx2 v[250:251], v57, s[16:19], s96 offen offset:0 sc1
    buffer_load_dwordx2 v[254:255], v57, s[16:19], s96 offen offset:128 sc1
    s_mov_b32 s96, 1310720
    s_mov_b32 s97, 1315840
    buffer_load_dwordx2 v[208:209], v60, s[4:7], s96 offen
    buffer_load_dwordx2 v[210:211], v60, s[4:7], s97 offen
    v_lshrrev_b32_e64 v212, 5, v1
    v_mul_u32_u24 v212, 5104, v212
    v_bfe_u32 v213, v1, 4, 1
    v_lshlrev_b32 v213, 2, v213
    v_sub_u32 v212, v212, v213
    v_add_u32 v212, v212, v60
    s_mul_i32 s97, s24, 24
    s_sub_u32 s97, 1310848, s97
    buffer_load_dword v212, v212, s[4:7], s97 offen
    s_waitcnt lgkmcnt(0)
    s_barrier
    ds_read2st64_b32 v[136:137], v207 offset0:0 offset1:1
    ds_read2st64_b32 v[138:139], v207 offset0:2 offset1:3
    ds_read_b64_tr_b16 v[144:145], v65 offset:32
    ds_read_b64_tr_b16 v[146:147], v65 offset:0
    ds_read_b64_tr_b16 v[148:149], v65 offset:160
    ds_read_b64_tr_b16 v[150:151], v65 offset:128
    ds_read_b64_tr_b16 v[152:153], v65 offset:288
    ds_read_b64_tr_b16 v[154:155], v65 offset:256
    ds_read_b64_tr_b16 v[156:157], v65 offset:416
    ds_read_b64_tr_b16 v[158:159], v65 offset:384
    ds_read_b64_tr_b16 v[160:161], v65 offset:544
    ds_read_b64_tr_b16 v[162:163], v65 offset:512
    ds_read_b64_tr_b16 v[164:165], v65 offset:672
    ds_read_b64_tr_b16 v[166:167], v65 offset:640
    ds_read_b64_tr_b16 v[168:169], v65 offset:800
    ds_read_b64_tr_b16 v[170:171], v65 offset:768
    ds_read_b64_tr_b16 v[172:173], v65 offset:928
    ds_read_b64_tr_b16 v[174:175], v65 offset:896
    s_waitcnt lgkmcnt(15)
    v_pk_add_f32 v[136:137], v[136:137], v[138:139]
    v_add_f32 v136, v136, v137
    v_cndmask_b32 v136, v136, 1.0, s[28:29]
    s_mov_b64 exec, s[80:81]
    buffer_atomic_add_f32 v136, v214, s[16:19], s27 offen sc1
    s_mov_b64 exec, -1
    v_lshrrev_b32 v176, 4, v0
    v_mul_u32_u24 v176, 1216, v176
    v_and_b32 v177, 15, v0
    v_lshl_add_u32 v176, v177, 3, v176
    v_add_u32 v176, 64, v176
    v_mov_b32 v178, 0
    v_mov_b32 v179, 0
    ds_write_b64 v176, v[178:179]
    v_mov_b32 v70, 0
    v_mov_b32 v71, 0
    v_mov_b32 v72, 0
    s_lshl_b32 s25, s24, 17
    v_lshrrev_b32 v176, 5, v1
    v_lshl_add_u32 v176, v176, 14, s25
    v_bfe_u32 v177, v1, 4, 1
    v_lshl_add_u32 v176, v177, 13, v176
    v_and_b32_e64 v177, 15, v1
    v_lshl_add_u32 v73, v177, 4, v176
    v_bfe_u32 v176, v1, 2, 3
    v_lshl_add_u32 v176, v176, 14, s25
    v_bfe_u32 v177, v1, 1, 1
    v_lshl_add_u32 v176, v177, 13, v176
    v_and_b32 v177, 1, v1
    v_lshl_add_u32 v77, v177, 4, v176
    v_lshrrev_b32 v177, 5, v1
    v_and_b32 v176, 31, v1
    v_lshlrev_b32 v176, 3, v176
    v_lshl_add_u32 v78, v177, 10, v176
    v_and_b32 v176, 7, v1
    v_lshlrev_b32 v176, 3, v176
    v_lshl_add_u32 v178, v177, 7, v176
    v_add_u32 v74, 31744, v73
    v_add_u32 v75, 63488, v73
    v_add_u32 v76, 95232, v73
    v_add_u32 v178, 53760, v178
    v_and_b32 v176, 31, v1
    v_cmp_eq_u32 vcc, 0, v176
    v_cmp_eq_u32 s[82:83], 24, v176
    s_nop 0
    s_or_b64 vcc, vcc, s[82:83]
    v_mov_b32 v176, 155712
    v_mov_b32 v177, 158288
    v_cndmask_b32 v176, v176, v177, vcc
    v_cndmask_b32 v79, v176, v178, s[78:79]
oe_23:
    s_waitcnt vmcnt(17)
    v_mfma_f32_16x16x32_bf16 v[112:115], a[176:179], v[216:219], 0
    v_mov_b32 v136, 0
    v_mov_b32 v137, 0
    s_waitcnt vmcnt(16)
    v_mfma_f32_16x16x32_bf16 v[116:119], a[176:179], v[220:223], 0
    v_mov_b32 v138, 0
    v_mov_b32 v139, 0
    s_waitcnt vmcnt(15)
    v_mfma_f32_16x16x32_bf16 v[112:115], a[196:199], v[224:227], v[112:115]
    v_mov_b32 v140, 0
    v_mov_b32_e64 v141, 0
    s_waitcnt vmcnt(14)
    v_mfma_f32_16x16x32_bf16 v[116:119], a[196:199], v[228:231], v[116:119]
    s_mov_b32 s25, 6817792
    s_add_u32 s26, s36, 6817792
    s_waitcnt vmcnt(13)
    v_mfma_f32_16x16x32_bf16 v[112:115], a[216:219], v[232:235], v[112:115]
    s_add_u32 s27, s35, 3477504
    s_mov_b32 s28, 0x99999999
    s_waitcnt vmcnt(12)
    v_mfma_f32_16x16x32_bf16 v[116:119], a[216:219], v[236:239], v[116:119]
    s_mov_b32 s29, 0x99999999
    s_waitcnt vmcnt(9)
    v_mfma_f32_16x16x32_bf16 v[112:115], a[236:239], v[240:243], v[112:115]
    s_waitcnt vmcnt(8)
    v_mfma_f32_16x16x32_bf16 v[116:119], a[236:239], v[244:247], v[116:119]
    s_waitcnt vmcnt(5)
    v_mfma_f32_16x16x32_bf16 v[112:115], v[52:55], v[248:251], v[112:115]
    s_waitcnt vmcnt(4)
    v_mfma_f32_16x16x32_bf16 v[116:119], v[52:55], v[252:255], v[116:119]
    v_mfma_f32_16x16x32_bf16 v[88:91], a[164:167], v[216:219], 0
    v_mfma_f32_16x16x32_bf16 v[92:95], a[164:167], v[220:223], 0
    v_mfma_f32_16x16x32_bf16 v[88:91], a[184:187], v[224:227], v[88:91]
    v_mfma_f32_16x16x32_bf16 v[92:95], a[184:187], v[228:231], v[92:95]
    v_mfma_f32_16x16x32_bf16 v[88:91], a[204:207], v[232:235], v[88:91]
    v_mfma_f32_16x16x32_bf16 v[92:95], a[204:207], v[236:239], v[92:95]
    s_nop 1
    v_cmp_u_f32 vcc, v112, v116
    s_nop 0
    s_cbranch_vccnz rd_24
rc_25:
    v_mfma_f32_16x16x32_bf16 v[88:91], a[224:227], v[240:243], v[88:91]
    ds_write_b128 v203, v[112:115] offset:24576
    v_mfma_f32_16x16x32_bf16 v[92:95], a[224:227], v[244:247], v[92:95]
    v_mfma_f32_16x16x32_bf16 v[88:91], a[244:247], v[248:251], v[88:91]
    ds_write_b128 v203, v[116:119] offset:25600
    v_mfma_f32_16x16x32_bf16 v[92:95], a[244:247], v[252:255], v[92:95]
    v_mfma_f32_16x16x32_bf16 v[96:99], a[168:171], v[216:219], 0
    s_waitcnt vmcnt(3)
    v_lshlrev_b32 v120, 16, v208
    v_and_b32 v121, 0xffff0000, v208
    v_mfma_f32_16x16x32_bf16 v[100:103], a[168:171], v[220:223], 0
    v_lshlrev_b32_e64 v122, 16, v209
    v_and_b32 v123, 0xffff0000, v209
    v_mfma_f32_16x16x32_bf16 v[96:99], a[188:191], v[224:227], v[96:99]
    s_waitcnt vmcnt(2)
    v_lshlrev_b32 v124, 16, v210
    v_and_b32 v125, 0xffff0000, v210
    v_mfma_f32_16x16x32_bf16 v[100:103], a[188:191], v[228:231], v[100:103]
    v_lshlrev_b32_e64 v126, 16, v211
    v_and_b32 v127, 0xffff0000, v211
    v_mfma_f32_16x16x32_bf16 v[96:99], a[208:211], v[232:235], v[96:99]
    s_waitcnt vmcnt(1)
    v_lshlrev_b32 v128, 16, v212
    v_and_b32 v129, 0xffff0000, v212
    v_mfma_f32_16x16x32_bf16 v[100:103], a[208:211], v[236:239], v[100:103]
    v_mfma_f32_16x16x32_bf16 v[96:99], a[228:231], v[240:243], v[96:99]
    ds_write_b128 v200, v[88:91] offset:0
    v_mfma_f32_16x16x32_bf16 v[100:103], a[228:231], v[244:247], v[100:103]
    v_mfma_f32_16x16x32_bf16 v[96:99], a[248:251], v[248:251], v[96:99]
    ds_write_b128 v200, v[92:95] offset:1024
    v_mfma_f32_16x16x32_bf16 v[100:103], a[248:251], v[252:255], v[100:103]
    v_mfma_f32_16x16x32_bf16 v[104:107], a[172:175], v[216:219], 0
    v_mfma_f32_16x16x32_bf16 v[108:111], a[172:175], v[220:223], 0
    v_mfma_f32_16x16x32_bf16 v[104:107], a[192:195], v[224:227], v[104:107]
    v_mfma_f32_16x16x32_bf16 v[108:111], a[192:195], v[228:231], v[108:111]
    v_mfma_f32_16x16x32_bf16 v[104:107], a[212:215], v[232:235], v[104:107]
    v_mfma_f32_16x16x32_bf16 v[108:111], a[212:215], v[236:239], v[108:111]
    v_mfma_f32_16x16x32_bf16 v[104:107], a[232:235], v[240:243], v[104:107]
    ds_write_b128 v201, v[96:99] offset:2048
    v_mfma_f32_16x16x32_bf16 v[108:111], a[232:235], v[244:247], v[108:111]
    v_mfma_f32_16x16x32_bf16 v[104:107], a[252:255], v[248:251], v[104:107]
    ds_write_b128 v201, v[100:103] offset:3072
    v_mfma_f32_16x16x32_bf16 v[108:111], a[252:255], v[252:255], v[108:111]
    v_mfma_f32_16x16x32_bf16 v[80:83], a[160:163], v[216:219], v[120:123]
    v_mfma_f32_16x16x32_bf16 v[84:87], a[160:163], v[220:223], v[124:127]
    v_mfma_f32_16x16x32_bf16 v[80:83], a[180:183], v[224:227], v[80:83]
    v_mfma_f32_16x16x32_bf16 v[84:87], a[180:183], v[228:231], v[84:87]
    v_mfma_f32_16x16x32_bf16 v[80:83], a[200:203], v[232:235], v[80:83]
    s_nop 0
    ds_write_b128 v202, v[104:107] offset:4096
    v_mfma_f32_16x16x32_bf16 v[84:87], a[200:203], v[236:239], v[84:87]
    ds_write_b128 v202, v[108:111] offset:5120
    v_mfma_f32_16x16x32_bf16 v[80:83], a[220:223], v[240:243], v[80:83]
    v_mfma_f32_16x16x32_bf16 v[84:87], a[220:223], v[244:247], v[84:87]
    v_mfma_f32_16x16x32_bf16 v[80:83], a[240:243], v[248:251], v[80:83]
    v_mfma_f32_16x16x32_bf16 v[84:87], a[240:243], v[252:255], v[84:87]
    s_waitcnt lgkmcnt(0)
    s_barrier
    s_nop 0
    ds_read_b128 v[88:91], v204 offset:0
    ds_read_b128 v[92:95], v204 offset:1024
    ds_read_b128 v[96:99], v204 offset:2048
    ds_read_b128 v[100:103], v204 offset:3072
    ds_read_b128 v[104:107], v204 offset:4096
    ds_read_b128 v[108:111], v204 offset:5120
    ds_read_b64 v[112:113], v205 offset:24576
    ds_read_b64 v[114:115], v205 offset:26624
    ds_read_b64 v[116:117], v205 offset:28672
    ds_read_b64 v[118:119], v205 offset:30720
    s_lshl_b32 s96, s75, 14
    s_add_u32 s96, s96, 6815744
    s_lshl_b32 s97, s24, 12
    s_add_u32 s97, s97, 3473408
    buffer_load_dwordx4 v[176:179], v62, s[16:19], s96 offen offset:0 sc1
    buffer_load_dwordx4 v[180:183], v62, s[16:19], s96 offen offset:1024 sc1
    s_waitcnt lgkmcnt(9)
    v_pk_add_f32 v[80:81], v[80:81], v[88:89]
    v_pk_add_f32 v[82:83], v[82:83], v[90:91]
    s_waitcnt lgkmcnt(8)
    v_pk_add_f32 v[84:85], v[84:85], v[92:93]
    v_pk_add_f32 v[86:87], v[86:87], v[94:95]
    s_waitcnt lgkmcnt(7)
    v_pk_add_f32 v[80:81], v[80:81], v[96:97]
    v_pk_add_f32 v[82:83], v[82:83], v[98:99]
    s_waitcnt lgkmcnt(6)
    v_pk_add_f32 v[84:85], v[84:85], v[100:101]
    v_pk_add_f32 v[86:87], v[86:87], v[102:103]
    s_waitcnt lgkmcnt(5)
    v_pk_add_f32 v[80:81], v[80:81], v[104:105]
    v_pk_add_f32 v[82:83], v[82:83], v[106:107]
    s_waitcnt lgkmcnt(4)
    v_pk_add_f32 v[84:85], v[84:85], v[108:109]
    v_pk_add_f32 v[86:87], v[86:87], v[110:111]
    v_cvt_pk_bf16_f32 v132, v80, v81
    v_cvt_pk_bf16_f32 v133, v82, v83
    v_cvt_pk_bf16_f32 v134, v84, v85
    v_cvt_pk_bf16_f32 v135, v86, v87
    s_waitcnt lgkmcnt(3)
    v_pk_add_f32 v[128:129], v[128:129], v[112:113]
    s_waitcnt lgkmcnt(2)
    v_pk_add_f32 v[128:129], v[128:129], v[114:115]
    s_waitcnt lgkmcnt(1)
    v_pk_add_f32 v[128:129], v[128:129], v[116:117]
    s_waitcnt lgkmcnt(0)
    v_pk_add_f32 v[128:129], v[128:129], v[118:119]
    v_cvt_pk_bf16_f32 v130, v128, v129
    buffer_store_dwordx4 v[132:135], v59, s[16:19], s25 offen sc1
    buffer_store_dword v130, v61, s[16:19], s26 offen sc1
    v_dot2c_f32_bf16 v136, v132, v215
    v_dot2c_f32_bf16 v137, v132, v132
    v_dot2c_f32_bf16 v136, v133, v215
    v_dot2c_f32_bf16 v137, v133, v133
    v_dot2c_f32_bf16 v138, v134, v215
    v_dot2c_f32_bf16 v139, v134, v134
    v_dot2c_f32_bf16 v138, v135, v215
    v_dot2c_f32_bf16 v139, v135, v135
    v_dot2c_f32_bf16 v140, v130, v215
    v_dot2c_f32_bf16 v141, v130, v130
    v_permlane32_swap_b32 v136, v138
    v_permlane32_swap_b32 v137, v139
    v_pk_add_f32 v[136:137], v[136:137], v[138:139]
    v_pk_add_f32 v[136:137], v[136:137], v[140:141]
    s_nop 1
    v_permlane16_swap_b32 v136, v137
    v_add_f32_e64 v136, v136, v137
    ds_write_b32 v206, v136 offset:32768
    buffer_load_dwordx4 v[184:187], v62, s[16:19], s97 offen offset:0 sc1
    buffer_load_dwordx4 v[188:191], v62, s[16:19], s97 offen offset:1024 sc1
    buffer_load_dwordx4 v[192:195], v62, s[16:19], s97 offen offset:2048 sc1
    buffer_load_dwordx4 v[196:199], v62, s[16:19], s97 offen offset:3072 sc1
    s_waitcnt lgkmcnt(0)
    s_barrier
    ds_read2st64_b32 v[136:137], v207 offset0:0 offset1:1
    ds_read2st64_b32 v[138:139], v207 offset0:2 offset1:3
    s_waitcnt lgkmcnt(0)
    v_pk_add_f32 v[136:137], v[136:137], v[138:139]
    v_add_f32 v136, v136, v137
    v_cndmask_b32 v136, v136, 1.0, s[28:29]
    s_mov_b64 exec, s[80:81]
    buffer_atomic_add_f32 v136, v214, s[16:19], s27 offen sc1
    s_mov_b64 exec, -1
    s_cmp_ge_u32 s2, 160
    s_cbranch_scc1 nc_26
    v_mov_b32 v248, -1
    v_mov_b32 v249, -1
    v_mov_b32 v250, -1
    v_mov_b32 v251, -1
    s_lshl_b32 s88, s75, 14
    s_add_u32 s88, s88, 9437184
    buffer_store_dwordx4 v[248:251], v62, s[16:19], s88 offen offset:0 sc1
    s_waitcnt vmcnt(2)
ce_28:
    v_max3_u32 v208, v176, v177, v178
    v_max3_u32 v208, v208, v179, v180
    v_max3_u32 v208, v208, v181, v182
    v_max_u32 v208, v208, v183
    v_cmp_eq_u32 s[82:83], -1, v208
    v_min3_f32 v209, v184, v187, v188
    v_min3_f32 v209, v209, v191, v192
    v_min3_f32 v209, v209, v195, v196
    v_min_f32 v209, v209, v199
    v_cmp_neq_f32 vcc, 0x41000000, v209
    s_nop 0
    s_or_b64 vcc, vcc, s[82:83]
    s_cbranch_vccnz rd_29
rc_30:
    v_mul_f32 v208, 0x3acccccd, v185
    v_mul_f32 v209, 0x3acccccd, v189
    v_mul_f32 v186, 0x3acccccd, v186
    v_mul_f32 v190, 0x3acccccd, v190
    v_fma_f32 v186, -v208, v208, v186
    v_fma_f32 v190, -v209, v209, v190
    v_max_f32 v186, 0, v186
    v_max_f32 v190, 0, v190
    v_add_f32 v186, 0x3727c5ac, v186
    v_add_f32 v190, 0x3727c5ac, v190
    v_rsq_f32 v185, v186
    v_rsq_f32 v189, v190
    v_mul_f32 v186, -v208, v185
    v_mul_f32 v190, -v209, v189
    v_lshlrev_b32 v80, 16, v176
    v_and_b32 v82, 0xffff0000, v176
    v_lshlrev_b32 v84, 16, v177
    v_and_b32 v86, 0xffff0000, v177
    v_lshlrev_b32 v81, 16, v178
    v_and_b32 v83, 0xffff0000, v178
    v_lshlrev_b32 v85, 16, v179
    v_and_b32 v87, 0xffff0000, v179
    v_fma_f32 v208, v80, v185, v186
    v_fma_f32 v209, v81, v189, v190
    v_cvt_pk_bf16_f32 v176, v208, v209
    v_fma_f32 v208, v82, v185, v186
    v_fma_f32 v209, v83, v189, v190
    v_cvt_pk_bf16_f32 v177, v208, v209
    v_fma_f32 v208, v84, v185, v186
    v_fma_f32 v209, v85, v189, v190
    v_cvt_pk_bf16_f32 v178, v208, v209
    v_fma_f32 v208, v86, v185, v186
    v_fma_f32 v209, v87, v189, v190
    v_cvt_pk_bf16_f32 v179, v208, v209
    ds_write_b32 v63, v176 offset:0
    ds_write_b32 v63, v177 offset:4864
    ds_write_b32 v63, v178 offset:9728
    ds_write_b32 v63, v179 offset:14592
    v_mul_f32 v208, 0x3acccccd, v193
    v_mul_f32 v209, 0x3acccccd, v197
    v_mul_f32 v194, 0x3acccccd, v194
    v_mul_f32 v198, 0x3acccccd, v198
    v_fma_f32 v194, -v208, v208, v194
    v_fma_f32 v198, -v209, v209, v198
    v_max_f32 v194, 0, v194
    v_max_f32 v198, 0, v198
    v_add_f32 v194, 0x3727c5ac, v194
    v_add_f32 v198, 0x3727c5ac, v198
    v_rsq_f32 v193, v194
    v_rsq_f32 v197, v198
    v_mul_f32 v194, -v208, v193
    v_mul_f32 v198, -v209, v197
    v_lshlrev_b32 v88, 16, v180
    v_and_b32 v90, 0xffff0000, v180
    v_lshlrev_b32 v92, 16, v181
    v_and_b32 v94, 0xffff0000, v181
    v_lshlrev_b32 v89, 16, v182
    v_and_b32 v91, 0xffff0000, v182
    v_lshlrev_b32 v93, 16, v183
    v_and_b32 v95, 0xffff0000, v183
    v_fma_f32 v208, v88, v193, v194
    v_fma_f32 v209, v89, v197, v198
    v_cvt_pk_bf16_f32 v180, v208, v209
    v_fma_f32 v208, v90, v193, v194
    v_fma_f32 v209, v91, v197, v198
    v_cvt_pk_bf16_f32 v181, v208, v209
    v_fma_f32 v208, v92, v193, v194
    v_fma_f32 v209, v93, v197, v198
    v_cvt_pk_bf16_f32 v182, v208, v209
    v_fma_f32 v208, v94, v193, v194
    v_fma_f32 v209, v95, v197, v198
    v_cvt_pk_bf16_f32 v183, v208, v209
    ds_write_b32 v63, v180 offset:256
    ds_write_b32 v63, v181 offset:5120
    ds_write_b32 v63, v182 offset:9984
    ds_write_b32 v63, v183 offset:14848
    s_waitcnt lgkmcnt(0)
    s_barrier
    ds_read_b128 v[212:215], v64 offset:96
    ds_read_b128 v[216:219], v64 offset:64
    ds_read_b128 v[220:223], v64 offset:32
    ds_read_b128 v[224:227], v64 offset:0
    s_waitcnt lgkmcnt(3)
    v_mfma_f32_32x32x16_bf16 v[96:111], v[212:215], v[144:147], 0
    ds_read_b128 v[228:231], v64 offset:224
    ds_read_b64_tr_b16 v[176:177], v65 offset:1056
    ds_read_b64_tr_b16 v[178:179], v65 offset:1024
    ds_read_b64_tr_b16 v[180:181], v65 offset:1184
    ds_read_b64_tr_b16 v[182:183], v65 offset:1152
    s_waitcnt lgkmcnt(7)
    v_mfma_f32_32x32x16_bf16 v[96:111], v[216:219], v[148:151], v[96:111]
    ds_read_b128 v[232:235], v64 offset:192
    ds_read_b64_tr_b16 v[184:185], v65 offset:1312
    ds_read_b64_tr_b16 v[186:187], v65 offset:1280
    ds_read_b64_tr_b16 v[188:189], v65 offset:1440
    ds_read_b64_tr_b16 v[190:191], v65 offset:1408
    s_waitcnt lgkmcnt(11)
    v_mfma_f32_32x32x16_bf16 v[96:111], v[220:223], v[152:155], v[96:111]
    ds_read_b128 v[236:239], v64 offset:160
    ds_read_b64_tr_b16 v[192:193], v65 offset:1568
    ds_read_b64_tr_b16 v[194:195], v65 offset:1536
    ds_read_b64_tr_b16 v[196:197], v65 offset:1696
    ds_read_b64_tr_b16 v[198:199], v65 offset:1664
    s_waitcnt lgkmcnt(15)
    v_mfma_f32_32x32x16_bf16 v[96:111], v[224:227], v[156:159], v[96:111]
    ds_read_b128 v[240:243], v64 offset:128
    ds_read_b64_tr_b16 v[200:201], v65 offset:1824
    ds_read_b64_tr_b16 v[202:203], v65 offset:1792
    ds_read_b64_tr_b16 v[204:205], v65 offset:1952
    ds_read_b64_tr_b16 v[206:207], v65 offset:1920
    s_waitcnt lgkmcnt(15)
    v_mfma_f32_32x32x16_bf16 v[112:127], v[228:231], v[144:147], 0
    buffer_store_dwordx4 v[248:251], v62, s[16:19], s88 offen offset:1024 sc1
    s_nop 3
    s_waitcnt lgkmcnt(14)
    v_mfma_f32_32x32x16_bf16 v[112:127], v[232:235], v[148:151], v[112:127]
    v_cndmask_b32 v208, v99, v72, s[76:77]
    v_cndmask_b32 v209, v103, v99, s[76:77]
    v_cndmask_b32 v210, v107, v103, s[76:77]
    v_cndmask_b32 v211, v111, v107, s[76:77]
    v_mov_b32_e64 v72, v111
    s_waitcnt lgkmcnt(9)
    v_mfma_f32_32x32x16_bf16 v[112:127], v[236:239], v[152:155], v[112:127]
    v_add_f32_dpp v98, v208, v98 wave_ror:1 row_mask:0xf bank_mask:0xf
    v_add_f32_dpp v102, v209, v102 wave_ror:1 row_mask:0xf bank_mask:0xf
    v_add_f32_dpp v106, v210, v106 wave_ror:1 row_mask:0xf bank_mask:0xf
    v_add_f32_dpp v110, v211, v110 wave_ror:1 row_mask:0xf bank_mask:0xf
    v_cndmask_b32 v208, v98, v71, s[76:77]
    s_waitcnt lgkmcnt(4)
    v_mfma_f32_32x32x16_bf16 v[112:127], v[240:243], v[156:159], v[112:127]
    v_cndmask_b32 v209, v102, v98, s[76:77]
    v_cndmask_b32 v210, v106, v102, s[76:77]
    v_cndmask_b32 v211, v110, v106, s[76:77]
    v_mov_b32 v71, v110
    v_add_f32_dpp v97, v208, v97 wave_ror:1 row_mask:0xf bank_mask:0xf
    v_add_f32_dpp v101, v209, v101 wave_ror:1 row_mask:0xf bank_mask:0xf
    v_mfma_f32_32x32x16_bf16 v[112:127], v[212:215], v[160:163], v[112:127]
    ds_read_b128 v[244:247], v64 offset:352
    v_add_f32_dpp v105, v210, v105 wave_ror:1 row_mask:0xf bank_mask:0xf
    v_add_f32_dpp v109, v211, v109 wave_ror:1 row_mask:0xf bank_mask:0xf
    v_cndmask_b32 v208, v97, v70, s[76:77]
    v_cndmask_b32 v209, v101, v97, s[76:77]
    v_cndmask_b32 v210, v105, v101, s[76:77]
    v_mfma_f32_32x32x16_bf16 v[112:127], v[216:219], v[164:167], v[112:127]
    ds_read_b128 v[216:219], v64 offset:320
    v_cndmask_b32 v211, v109, v105, s[76:77]
    v_mov_b32_e64 v70, v109
    v_add_f32_dpp v96, v208, v96 wave_ror:1 row_mask:0xf bank_mask:0xf
    v_add_f32_dpp v100, v209, v100 wave_ror:1 row_mask:0xf bank_mask:0xf
    v_add_f32_dpp v104, v210, v104 wave_ror:1 row_mask:0xf bank_mask:0xf
    v_mfma_f32_32x32x16_bf16 v[112:127], v[220:223], v[168:171], v[112:127]
    ds_read_b128 v[220:223], v64 offset:288
    buffer_store_dwordx4 v[248:251], v62, s[16:19], s88 offen offset:2048 sc1
    v_add_f32_dpp v108, v211, v108 wave_ror:1 row_mask:0xf bank_mask:0xf
    v_mfma_f32_32x32x16_bf16 v[112:127], v[224:227], v[172:175], v[112:127]
    ds_read_b128 v[224:227], v64 offset:256
    ds_write_b32 v66, v96 offset:0
    ds_write_b32 v66, v100 offset:64
    s_waitcnt lgkmcnt(5)
    v_mfma_f32_32x32x16_bf16 v[128:143], v[244:247], v[144:147], 0
    ds_write_b32 v66, v104 offset:128
    ds_write_b32 v66, v108 offset:192
    s_nop 0
    s_waitcnt lgkmcnt(6)
    v_mfma_f32_32x32x16_bf16 v[128:143], v[216:219], v[148:151], v[128:143]
    s_nop 3
    v_cndmask_b32 v208, v115, v72, s[76:77]
    s_waitcnt lgkmcnt(5)
    v_mfma_f32_32x32x16_bf16 v[128:143], v[220:223], v[152:155], v[128:143]
    v_cndmask_b32 v209, v119, v115, s[76:77]
    v_cndmask_b32 v210, v123, v119, s[76:77]
    v_cndmask_b32 v211, v127, v123, s[76:77]
    v_mov_b32 v72, v127
    v_add_f32_dpp v114, v208, v114 wave_ror:1 row_mask:0xf bank_mask:0xf
    s_waitcnt lgkmcnt(4)
    v_mfma_f32_32x32x16_bf16 v[128:143], v[224:227], v[156:159], v[128:143]
    v_add_f32_dpp v118, v209, v118 wave_ror:1 row_mask:0xf bank_mask:0xf
    v_add_f32_dpp v122, v210, v122 wave_ror:1 row_mask:0xf bank_mask:0xf
    v_add_f32_dpp v126, v211, v126 wave_ror:1 row_mask:0xf bank_mask:0xf
    v_cndmask_b32 v208, v114, v71, s[76:77]
    v_cndmask_b32 v209, v118, v114, s[76:77]
    v_cndmask_b32 v210, v122, v118, s[76:77]
    v_mfma_f32_32x32x16_bf16 v[128:143], v[228:231], v[160:163], v[128:143]
    buffer_store_dwordx4 v[248:251], v62, s[16:19], s88 offen offset:3072 sc1
    v_cndmask_b32 v211, v126, v122, s[76:77]
    v_mov_b32 v71, v126
    v_add_f32_dpp v113, v208, v113 wave_ror:1 row_mask:0xf bank_mask:0xf
    v_add_f32_dpp v117, v209, v117 wave_ror:1 row_mask:0xf bank_mask:0xf
    v_add_f32_dpp v121, v210, v121 wave_ror:1 row_mask:0xf bank_mask:0xf
    v_mfma_f32_32x32x16_bf16 v[128:143], v[232:235], v[164:167], v[128:143]
    ds_read_b128 v[232:235], v64 offset:64
    v_add_f32_dpp v125, v211, v125 wave_ror:1 row_mask:0xf bank_mask:0xf
    v_cndmask_b32 v208, v113, v70, s[76:77]
    v_cndmask_b32 v209, v117, v113, s[76:77]
    v_cndmask_b32 v210, v121, v117, s[76:77]
    v_cndmask_b32 v211, v125, v121, s[76:77]
    v_mfma_f32_32x32x16_bf16 v[128:143], v[236:239], v[168:171], v[128:143]
    ds_read_b128 v[236:239], v64 offset:32
    v_mov_b32_e64 v70, v125
    v_add_f32_dpp v112, v208, v112 wave_ror:1 row_mask:0xf bank_mask:0xf
    v_add_f32_dpp v116, v209, v116 wave_ror:1 row_mask:0xf bank_mask:0xf
    v_add_f32_dpp v120, v210, v120 wave_ror:1 row_mask:0xf bank_mask:0xf
    v_add_f32_dpp v124, v211, v124 wave_ror:1 row_mask:0xf bank_mask:0xf
    v_mfma_f32_32x32x16_bf16 v[128:143], v[240:243], v[172:175], v[128:143]
    ds_read_b128 v[240:243], v64 offset:0
    ds_write_b32 v66, v112 offset:256
    ds_write_b32 v66, v116 offset:320
    v_mfma_f32_32x32x16_bf16 v[128:143], v[212:215], v[176:179], v[128:143]
    ds_read_b128 v[212:215], v64 offset:480
    ds_write_b32 v66, v120 offset:384
    ds_write_b32 v66, v124 offset:448
    s_waitcnt lgkmcnt(7)
    v_mfma_f32_32x32x16_bf16 v[128:143], v[232:235], v[180:183], v[128:143]
    ds_read_b128 v[232:235], v64 offset:448
    s_waitcnt lgkmcnt(7)
    v_mfma_f32_32x32x16_bf16 v[128:143], v[236:239], v[184:187], v[128:143]
    ds_read_b128 v[236:239], v64 offset:416
    s_waitcnt lgkmcnt(7)
    v_mfma_f32_32x32x16_bf16 v[128:143], v[240:243], v[188:191], v[128:143]
    ds_read_b128 v[240:243], v64 offset:384
    s_nop 3
    s_waitcnt lgkmcnt(5)
    v_mfma_f32_32x32x16_bf16 v[112:127], v[212:215], v[144:147], 0
    s_nop 4
    s_waitcnt lgkmcnt(2)
    v_mfma_f32_32x32x16_bf16 v[112:127], v[232:235], v[148:151], v[112:127]
    v_cndmask_b32 v208, v131, v72, s[76:77]
    v_cndmask_b32 v209, v135, v131, s[76:77]
    v_cndmask_b32 v210, v139, v135, s[76:77]
    v_cndmask_b32 v211, v143, v139, s[76:77]
    v_mov_b32_e64 v72, v143
    s_waitcnt lgkmcnt(1)
    v_mfma_f32_32x32x16_bf16 v[112:127], v[236:239], v[152:155], v[112:127]
    v_add_f32_dpp v130, v208, v130 wave_ror:1 row_mask:0xf bank_mask:0xf
    v_add_f32_dpp v134, v209, v134 wave_ror:1 row_mask:0xf bank_mask:0xf
    v_add_f32_dpp v138, v210, v138 wave_ror:1 row_mask:0xf bank_mask:0xf
    v_add_f32_dpp v142, v211, v142 wave_ror:1 row_mask:0xf bank_mask:0xf
    v_cndmask_b32 v208, v130, v71, s[76:77]
    s_waitcnt lgkmcnt(0)
    v_mfma_f32_32x32x16_bf16 v[112:127], v[240:243], v[156:159], v[112:127]
    v_cndmask_b32 v209, v134, v130, s[76:77]
    v_cndmask_b32 v210, v138, v134, s[76:77]
    v_cndmask_b32 v211, v142, v138, s[76:77]
    v_mov_b32 v71, v142
    v_add_f32_dpp v129, v208, v129 wave_ror:1 row_mask:0xf bank_mask:0xf
    v_add_f32_dpp v133, v209, v133 wave_ror:1 row_mask:0xf bank_mask:0xf
    v_mfma_f32_32x32x16_bf16 v[112:127], v[244:247], v[160:163], v[112:127]
    v_add_f32_dpp v137, v210, v137 wave_ror:1 row_mask:0xf bank_mask:0xf
    v_add_f32_dpp v141, v211, v141 wave_ror:1 row_mask:0xf bank_mask:0xf
    v_cndmask_b32 v208, v129, v70, s[76:77]
    v_cndmask_b32 v209, v133, v129, s[76:77]
    v_cndmask_b32 v210, v137, v133, s[76:77]
    v_cndmask_b32 v211, v141, v137, s[76:77]
    v_mfma_f32_32x32x16_bf16 v[112:127], v[216:219], v[164:167], v[112:127]
    ds_read_b128 v[240:243], v64 offset:192
    v_mov_b32_e64 v70, v141
    v_add_f32_dpp v128, v208, v128 wave_ror:1 row_mask:0xf bank_mask:0xf
    v_add_f32_dpp v132, v209, v132 wave_ror:1 row_mask:0xf bank_mask:0xf
    v_add_f32_dpp v136, v210, v136 wave_ror:1 row_mask:0xf bank_mask:0xf
    v_add_f32_dpp v140, v211, v140 wave_ror:1 row_mask:0xf bank_mask:0xf
    v_mfma_f32_32x32x16_bf16 v[112:127], v[220:223], v[168:171], v[112:127]
    ds_read_b128 v[220:223], v64 offset:160
    ds_write_b32 v66, v128 offset:512
    ds_write_b32 v66, v132 offset:576
    v_mfma_f32_32x32x16_bf16 v[112:127], v[224:227], v[172:175], v[112:127]
    ds_read_b128 v[224:227], v64 offset:128
    ds_write_b32 v66, v136 offset:640
    ds_write_b32 v66, v140 offset:704
    v_mfma_f32_32x32x16_bf16 v[112:127], v[228:231], v[176:179], v[112:127]
    ds_read_b128 v[236:239], v64 offset:96
    s_waitcnt lgkmcnt(7)
    v_mfma_f32_32x32x16_bf16 v[112:127], v[240:243], v[180:183], v[112:127]
    ds_read_b128 v[240:243], v64 offset:64
    s_waitcnt lgkmcnt(7)
    v_mfma_f32_32x32x16_bf16 v[112:127], v[220:223], v[184:187], v[112:127]
    ds_read_b128 v[220:223], v64 offset:32
    s_waitcnt lgkmcnt(5)
    v_mfma_f32_32x32x16_bf16 v[112:127], v[224:227], v[188:191], v[112:127]
    ds_read_b128 v[224:227], v64 offset:0
    s_waitcnt lgkmcnt(3)
    v_mfma_f32_32x32x16_bf16 v[112:127], v[236:239], v[192:195], v[112:127]
    ds_read_b64_tr_b16 v[216:217], v65 offset:544
    ds_read_b64_tr_b16 v[218:219], v65 offset:512
    s_waitcnt lgkmcnt(4)
    v_mfma_f32_32x32x16_bf16 v[112:127], v[240:243], v[196:199], v[112:127]
    ds_read_b64_tr_b16 v[240:241], v65 offset:1056
    ds_read_b64_tr_b16 v[242:243], v65 offset:1024
    s_waitcnt lgkmcnt(5)
    v_mfma_f32_32x32x16_bf16 v[112:127], v[220:223], v[200:203], v[112:127]
    s_waitcnt lgkmcnt(4)
    v_mfma_f32_32x32x16_bf16 v[112:127], v[224:227], v[204:207], v[112:127]
    ds_read_b64_tr_b16 v[224:225], v65 offset:1568
    ds_read_b64_tr_b16 v[226:227], v65 offset:1536
    s_lshl_b32 s96, s75, 14
    s_add_u32 s96, s96, 6815744
    s_lshl_b32 s97, s24, 12
    s_add_u32 s97, s97, 3477504
    buffer_load_dwordx4 v[248:251], v62, s[16:19], s96 offen offset:2048 sc1
    s_waitcnt lgkmcnt(4)
    v_mfma_f32_32x32x16_bf16 v[144:159], v[212:215], v[216:219], 0
    s_nop 3
    v_cndmask_b32 v208, v115, v72, s[76:77]
    s_waitcnt lgkmcnt(2)
    v_mfma_f32_32x32x16_bf16 v[144:159], v[244:247], v[240:243], v[144:159]
    buffer_load_dwordx4 v[252:255], v62, s[16:19], s96 offen offset:3072 sc1
    v_cndmask_b32 v209, v119, v115, s[76:77]
    v_cndmask_b32 v210, v123, v119, s[76:77]
    v_cndmask_b32 v211, v127, v123, s[76:77]
    v_mov_b32_e64 v72, v127
    v_add_f32_dpp v114, v208, v114 wave_ror:1 row_mask:0xf bank_mask:0xf
    v_mfma_f32_32x32x16_bf16 v[160:175], v[212:215], v[240:243], 0
    ds_read_b64_tr_b16 v[216:217], v65 offset:2080
    ds_read_b64_tr_b16 v[218:219], v65 offset:2048
    v_add_f32_dpp v118, v209, v118 wave_ror:1 row_mask:0xf bank_mask:0xf
    v_add_f32_dpp v122, v210, v122 wave_ror:1 row_mask:0xf bank_mask:0xf
    v_add_f32_dpp v126, v211, v126 wave_ror:1 row_mask:0xf bank_mask:0xf
    s_waitcnt lgkmcnt(2)
    v_mfma_f32_32x32x16_bf16 v[144:159], v[228:231], v[224:227], v[144:159]
    buffer_load_dwordx4 v[96:99], v62, s[16:19], s97 offen offset:0 sc1
    v_cndmask_b32 v208, v114, v71, s[76:77]
    v_cndmask_b32 v209, v118, v114, s[76:77]
    v_cndmask_b32 v210, v122, v118, s[76:77]
    v_cndmask_b32 v211, v126, v122, s[76:77]
    v_mov_b32 v71, v126
    v_mfma_f32_32x32x16_bf16 v[160:175], v[244:247], v[224:227], v[160:175]
    v_add_f32_dpp v113, v208, v113 wave_ror:1 row_mask:0xf bank_mask:0xf
    v_add_f32_dpp v117, v209, v117 wave_ror:1 row_mask:0xf bank_mask:0xf
    v_add_f32_dpp v121, v210, v121 wave_ror:1 row_mask:0xf bank_mask:0xf
    v_add_f32_dpp v125, v211, v125 wave_ror:1 row_mask:0xf bank_mask:0xf
    v_cndmask_b32 v208, v113, v70, s[76:77]
    v_cndmask_b32 v209, v117, v113, s[76:77]
    v_mfma_f32_32x32x16_bf16 v[176:191], v[212:215], v[224:227], 0
    buffer_load_dwordx4 v[100:103], v62, s[16:19], s97 offen offset:1024 sc1
    v_cndmask_b32 v210, v121, v117, s[76:77]
    v_cndmask_b32 v211, v125, v121, s[76:77]
    v_mov_b32 v70, v125
    v_add_f32_dpp v112, v208, v112 wave_ror:1 row_mask:0xf bank_mask:0xf
    s_waitcnt lgkmcnt(0)
    v_mfma_f32_32x32x16_bf16 v[144:159], v[236:239], v[216:219], v[144:159]
    ds_read_b64_tr_b16 v[240:241], v65 offset:2592
    ds_read_b64_tr_b16 v[242:243], v65 offset:2560
    v_add_f32_dpp v116, v209, v116 wave_ror:1 row_mask:0xf bank_mask:0xf
    v_add_f32_dpp v120, v210, v120 wave_ror:1 row_mask:0xf bank_mask:0xf
    v_add_f32_dpp v124, v211, v124 wave_ror:1 row_mask:0xf bank_mask:0xf
    v_mfma_f32_32x32x16_bf16 v[160:175], v[228:231], v[216:219], v[160:175]
    buffer_load_dwordx4 v[104:107], v62, s[16:19], s97 offen offset:2048 sc1
    ds_write_b32 v66, v112 offset:768
    ds_write_b32 v66, v116 offset:832
    v_mfma_f32_32x32x16_bf16 v[176:191], v[244:247], v[216:219], v[176:191]
    ds_write_b32 v66, v120 offset:896
    ds_write_b32 v66, v124 offset:960
    v_mfma_f32_32x32x16_bf16 v[192:207], v[212:215], v[216:219], 0
    ds_read_b64_tr_b16 v[212:213], v65 offset:3104
    ds_read_b64_tr_b16 v[214:215], v65 offset:3072
    buffer_load_dwordx4 v[108:111], v62, s[16:19], s97 offen offset:3072 sc1
    s_waitcnt lgkmcnt(6)
    v_mfma_f32_32x32x16_bf16 v[160:175], v[236:239], v[240:243], v[160:175]
    v_mfma_f32_32x32x16_bf16 v[176:191], v[228:231], v[240:243], v[176:191]
    ds_read_b64_tr_b16 v[224:225], v65 offset:3616
    ds_read_b64_tr_b16 v[226:227], v65 offset:3584
    s_waitcnt vmcnt(6) lgkmcnt(4)
    s_barrier
    v_mfma_f32_32x32x16_bf16 v[192:207], v[244:247], v[240:243], v[192:207]
    ds_read_b64_tr_b16 v[244:245], v65 offset:672
    ds_read_b64_tr_b16 v[246:247], v65 offset:640
    ds_read_b64 v[112:113], v67 offset:0
    ds_read_b64 v[114:115], v67 offset:4224
    ds_read_b64 v[116:117], v67 offset:8448
    s_waitcnt lgkmcnt(7)
    v_mfma_f32_32x32x16_bf16 v[176:191], v[236:239], v[212:215], v[176:191]
    ds_read_b128 v[216:219], v64 offset:320
    ds_read_b64_tr_b16 v[240:241], v65 offset:1184
    ds_read_b64_tr_b16 v[242:243], v65 offset:1152
    ds_read_b64 v[118:119], v67 offset:12672
    ds_read_b64 v[120:121], v67 offset:512
    ds_read_b64 v[122:123], v67 offset:4736
    v_mfma_f32_32x32x16_bf16 v[192:207], v[228:231], v[212:215], v[192:207]
    ds_read_b64 v[124:125], v67 offset:8960
    ds_read_b64 v[126:127], v67 offset:13184
    s_lshl_b32 s25, s75, 14
    s_add_u32 s25, s25, 9437184
    s_waitcnt lgkmcnt(13)
    v_mfma_f32_32x32x16_bf16 v[192:207], v[236:239], v[224:227], v[192:207]
    ds_read_b128 v[228:231], v64 offset:192
    ds_read_b64_tr_b16 v[236:237], v65 offset:1696
    ds_read_b64_tr_b16 v[238:239], v65 offset:1664
    s_waitcnt lgkmcnt(14)
    v_mfma_f32_32x32x16_bf16 v[144:159], v[232:235], v[244:247], v[144:159]
    v_mov_b32 v5, 1
    s_add_u32 s82, s86, 24576
    buffer_atomic_add v5, v6, s[16:19], s82 offen offset:0 sc0 sc1
    s_waitcnt lgkmcnt(8)
    v_mfma_f32_32x32x16_bf16 v[144:159], v[216:219], v[240:243], v[144:159]
    v_mfma_f32_32x32x16_bf16 v[160:175], v[232:235], v[240:243], v[160:175]
    ds_read_b128 v[212:215], v64 offset:64
    ds_read_b64_tr_b16 v[224:225], v65 offset:2208
    ds_read_b64_tr_b16 v[226:227], v65 offset:2176
    s_waitcnt lgkmcnt(3)
    v_mfma_f32_32x32x16_bf16 v[144:159], v[228:231], v[236:239], v[144:159]
    v_mfma_f32_32x32x16_bf16 v[160:175], v[216:219], v[236:239], v[160:175]
    v_add_f32 v112, v112, v80
    v_add_f32 v113, v113, v81
    v_add_f32 v114, v114, v82
    v_add_f32 v115, v115, v83
    v_add_f32 v116, v116, v84
    v_mfma_f32_32x32x16_bf16 v[176:191], v[232:235], v[236:239], v[176:191]
    v_add_f32 v117, v117, v85
    v_add_f32 v118, v118, v86
    v_add_f32 v119, v119, v87
    v_cvt_pk_bf16_f32 v128, v112, v114
    v_cvt_pk_bf16_f32 v129, v116, v118
    s_waitcnt lgkmcnt(0)
    v_mfma_f32_32x32x16_bf16 v[144:159], v[212:215], v[224:227], v[144:159]
    ds_read_b64_tr_b16 v[244:245], v65 offset:2720
    ds_read_b64_tr_b16 v[246:247], v65 offset:2688
    v_cvt_pk_bf16_f32 v130, v113, v115
    v_cvt_pk_bf16_f32 v131, v117, v119
    v_mfma_f32_32x32x16_bf16 v[160:175], v[228:231], v[224:227], v[160:175]
    buffer_store_dwordx4 v[128:131], v62, s[16:19], s25 offen offset:0 sc1
    v_add_f32 v120, v120, v88
    v_add_f32 v121, v121, v89
    v_add_f32 v122, v122, v90
    v_add_f32 v123, v123, v91
    v_add_f32 v124, v124, v92
    v_mfma_f32_32x32x16_bf16 v[176:191], v[216:219], v[224:227], v[176:191]
    v_add_f32 v125, v125, v93
    v_add_f32 v126, v126, v94
    v_add_f32_e64 v127, v127, v95
    v_cvt_pk_bf16_f32 v132, v120, v122
    v_cvt_pk_bf16_f32 v133, v124, v126
    v_cvt_pk_bf16_f32 v134, v121, v123
    v_mfma_f32_32x32x16_bf16 v[192:207], v[232:235], v[224:227], v[192:207]
    ds_read_b64_tr_b16 v[232:233], v65 offset:3232
    ds_read_b64_tr_b16 v[234:235], v65 offset:3200
    v_cvt_pk_bf16_f32 v135, v125, v127
    s_waitcnt lgkmcnt(2)
    v_mfma_f32_32x32x16_bf16 v[160:175], v[212:215], v[244:247], v[160:175]
    buffer_store_dwordx4 v[132:135], v62, s[16:19], s25 offen offset:1024 sc1
    ds_read_b64_tr_b16 v[112:113], v65 offset:32
    ds_read_b64_tr_b16 v[114:115], v65 offset:0
    ds_read_b64_tr_b16 v[116:117], v65 offset:160
    ds_read_b64_tr_b16 v[118:119], v65 offset:128
    ds_read_b64_tr_b16 v[120:121], v65 offset:288
    v_mfma_f32_32x32x16_bf16 v[176:191], v[228:231], v[244:247], v[176:191]
    ds_read_b64_tr_b16 v[240:241], v65 offset:3744
    ds_read_b64_tr_b16 v[242:243], v65 offset:3712
    ds_read_b64_tr_b16 v[122:123], v65 offset:256
    ds_read_b64_tr_b16 v[124:125], v65 offset:416
    ds_read_b64_tr_b16 v[126:127], v65 offset:384
    ds_read_b64_tr_b16 v[128:129], v65 offset:544
    v_mfma_f32_32x32x16_bf16 v[192:207], v[216:219], v[244:247], v[192:207]
    ds_read_b128 v[216:219], v64 offset:416
    ds_read_b64_tr_b16 v[236:237], v65 offset:800
    ds_read_b64_tr_b16 v[238:239], v65 offset:768
    ds_read_b64_tr_b16 v[130:131], v65 offset:512
    ds_read_b64_tr_b16 v[132:133], v65 offset:672
    s_waitcnt lgkmcnt(15)
    v_mfma_f32_32x32x16_bf16 v[176:191], v[212:215], v[232:235], v[176:191]
    ds_read_b128 v[224:227], v64 offset:288
    ds_read_b64_tr_b16 v[244:245], v65 offset:1312
    ds_read_b64_tr_b16 v[246:247], v65 offset:1280
    ds_read_b64_tr_b16 v[134:135], v65 offset:640
    ds_read_b64_tr_b16 v[136:137], v65 offset:800
    ds_read_b64_tr_b16 v[138:139], v65 offset:768
    v_mfma_f32_32x32x16_bf16 v[192:207], v[228:231], v[232:235], v[192:207]
    ds_read_b64_tr_b16 v[140:141], v65 offset:928
    ds_read_b64_tr_b16 v[142:143], v65 offset:896
    s_waitcnt lgkmcnt(15)
    v_mfma_f32_32x32x16_bf16 v[192:207], v[212:215], v[240:243], v[192:207]
    ds_read_b128 v[228:231], v64 offset:160
    ds_read_b64_tr_b16 v[212:213], v65 offset:1824
    ds_read_b64_tr_b16 v[214:215], v65 offset:1792
    s_waitcnt vmcnt(3)
ce_31:
    v_max3_u32 v208, v248, v249, v250
    v_max3_u32 v208, v208, v251, v252
    v_max3_u32 v208, v208, v253, v254
    v_max_u32_e64 v208, v208, v255
    v_cmp_eq_u32 s[82:83], -1, v208
    v_min3_f32 v209, v96, v99, v100
    v_min3_f32 v209, v209, v103, v104
    v_min3_f32 v209, v209, v107, v108
    v_min_f32 v209, v209, v111
    v_cmp_neq_f32 vcc, 0x41000000, v209
    s_nop 0
    s_or_b64 vcc, vcc, s[82:83]
    s_cbranch_vccnz rd_32
rc_33:
    s_waitcnt lgkmcnt(13)
    v_mfma_f32_32x32x16_bf16 v[144:159], v[216:219], v[236:239], v[144:159]
    v_mul_f32 v208, 0x3acccccd, v97
    v_mul_f32 v209, 0x3acccccd, v101
    v_mul_f32 v98, 0x3acccccd, v98
    v_mul_f32 v102, 0x3acccccd, v102
    v_fma_f32 v98, -v208, v208, v98
    s_waitcnt lgkmcnt(8)
    v_mfma_f32_32x32x16_bf16 v[144:159], v[224:227], v[244:247], v[144:159]
    v_fma_f32 v102, -v209, v209, v102
    v_max_f32 v98, 0, v98
    v_max_f32 v102, 0, v102
    v_add_f32 v98, 0x3727c5ac, v98
    v_add_f32 v102, 0x3727c5ac, v102
    v_mfma_f32_32x32x16_bf16 v[160:175], v[216:219], v[244:247], v[160:175]
    ds_read_b64_tr_b16 v[232:233], v65 offset:2336
    ds_read_b64_tr_b16 v[234:235], v65 offset:2304
    v_rsq_f32 v97, v98
    s_waitcnt lgkmcnt(2)
    v_mfma_f32_32x32x16_bf16 v[144:159], v[228:231], v[212:215], v[144:159]
    v_rsq_f32_e64 v101, v102
    v_mul_f32 v98, -v208, v97
    v_mul_f32 v102, -v209, v101
    v_lshlrev_b32_e64 v80, 16, v248
    v_and_b32 v82, 0xffff0000, v248
    v_mfma_f32_32x32x16_bf16 v[160:175], v[224:227], v[212:215], v[160:175]
    v_lshlrev_b32 v84, 16, v249
    v_and_b32 v86, 0xffff0000, v249
    v_lshlrev_b32 v81, 16, v250
    v_and_b32 v83, 0xffff0000, v250
    v_lshlrev_b32_e64 v85, 16, v251
    v_and_b32 v87, 0xffff0000, v251
    v_mfma_f32_32x32x16_bf16 v[176:191], v[216:219], v[212:215], v[176:191]
    v_fma_f32 v208, v80, v97, v98
    v_fma_f32 v209, v81, v101, v102
    v_cvt_pk_bf16_f32 v248, v208, v209
    v_fma_f32 v208, v82, v97, v98
    v_fma_f32 v209, v83, v101, v102
    s_waitcnt lgkmcnt(0)
    v_mfma_f32_32x32x16_bf16 v[144:159], v[220:223], v[232:235], v[144:159]
    ds_read_b64_tr_b16 v[240:241], v65 offset:2848
    ds_read_b64_tr_b16 v[242:243], v65 offset:2816
    v_cvt_pk_bf16_f32 v249, v208, v209
    v_fma_f32 v208, v84, v97, v98
    v_fma_f32 v209, v85, v101, v102
    v_cvt_pk_bf16_f32 v250, v208, v209
    v_mfma_f32_32x32x16_bf16 v[160:175], v[228:231], v[232:235], v[160:175]
    v_fma_f32 v208, v86, v97, v98
    v_fma_f32 v209, v87, v101, v102
    v_cvt_pk_bf16_f32 v251, v208, v209
    v_mfma_f32_32x32x16_bf16 v[176:191], v[224:227], v[232:235], v[176:191]
    ds_write_b32 v63, v248 offset:512
    ds_write_b32 v63, v249 offset:5376
    ds_write_b32 v63, v250 offset:10240
    v_mfma_f32_32x32x16_bf16 v[192:207], v[216:219], v[232:235], v[192:207]
    ds_read_b64_tr_b16 v[216:217], v65 offset:3360
    ds_read_b64_tr_b16 v[218:219], v65 offset:3328
    ds_write_b32 v63, v251 offset:15104
    v_mul_f32 v208, 0x3acccccd, v105
    s_waitcnt lgkmcnt(6)
    v_mfma_f32_32x32x16_bf16 v[160:175], v[220:223], v[240:243], v[160:175]
    v_mul_f32 v209, 0x3acccccd, v109
    v_mul_f32 v106, 0x3acccccd, v106
    v_mul_f32 v110, 0x3acccccd, v110
    v_fma_f32 v106, -v208, v208, v106
    v_fma_f32 v110, -v209, v209, v110
    v_max_f32_e64 v106, 0, v106
    v_mfma_f32_32x32x16_bf16 v[176:191], v[228:231], v[240:243], v[176:191]
    ds_read_b64_tr_b16 v[236:237], v65 offset:3872
    ds_read_b64_tr_b16 v[238:239], v65 offset:3840
    v_max_f32_e64 v110, 0, v110
    v_add_f32 v106, 0x3727c5ac, v106
    v_add_f32 v110, 0x3727c5ac, v110
    v_mfma_f32_32x32x16_bf16 v[192:207], v[224:227], v[240:243], v[192:207]
    ds_read_b128 v[224:227], v64 offset:384
    ds_read_b64_tr_b16 v[244:245], v65 offset:928
    ds_read_b64_tr_b16 v[246:247], v65 offset:896
    v_rsq_f32 v105, v106
    s_waitcnt lgkmcnt(6)
    v_mfma_f32_32x32x16_bf16 v[176:191], v[220:223], v[216:219], v[176:191]
    ds_read_b128 v[212:215], v64 offset:256
    ds_read_b64_tr_b16 v[232:233], v65 offset:1440
    ds_read_b64_tr_b16 v[234:235], v65 offset:1408
    v_rsq_f32_e64 v109, v110
    v_mul_f32 v106, -v208, v105
    v_mfma_f32_32x32x16_bf16 v[192:207], v[228:231], v[216:219], v[192:207]
    v_mul_f32 v110, -v209, v109
    v_lshlrev_b32 v88, 16, v252
    v_and_b32 v90, 0xffff0000, v252
    v_lshlrev_b32 v92, 16, v253
    v_and_b32 v94, 0xffff0000, v253
    s_waitcnt lgkmcnt(6)
    v_mfma_f32_32x32x16_bf16 v[192:207], v[220:223], v[236:239], v[192:207]
    ds_read_b128 v[220:223], v64 offset:128
    ds_read_b64_tr_b16 v[228:229], v65 offset:1952
    ds_read_b64_tr_b16 v[230:231], v65 offset:1920
    v_lshlrev_b32 v89, 16, v254
    v_and_b32 v91, 0xffff0000, v254
    s_waitcnt lgkmcnt(6)
    v_mfma_f32_32x32x16_bf16 v[144:159], v[224:227], v[244:247], v[144:159]
    v_lshlrev_b32 v93, 16, v255
    v_and_b32 v95, 0xffff0000, v255
    v_fma_f32 v208, v88, v105, v106
    v_fma_f32 v209, v89, v109, v110
    v_cvt_pk_bf16_f32 v252, v208, v209
    s_waitcnt lgkmcnt(3)
    v_mfma_f32_32x32x16_bf16 v[144:159], v[212:215], v[232:235], v[144:159]
    v_fma_f32 v208, v90, v105, v106
    v_fma_f32 v209, v91, v109, v110
    v_cvt_pk_bf16_f32 v253, v208, v209
    v_fma_f32 v208, v92, v105, v106
    v_fma_f32 v209, v93, v109, v110
    v_cvt_pk_bf16_f32 v254, v208, v209
    v_mfma_f32_32x32x16_bf16 v[160:175], v[224:227], v[232:235], v[160:175]
    ds_read_b128 v[240:243], v64 offset:0
    ds_read_b64_tr_b16 v[216:217], v65 offset:2464
    ds_read_b64_tr_b16 v[218:219], v65 offset:2432
    v_fma_f32 v208, v94, v105, v106
    v_fma_f32 v209, v95, v109, v110
    s_waitcnt lgkmcnt(3)
    v_mfma_f32_32x32x16_bf16 v[144:159], v[220:223], v[228:231], v[144:159]
    v_cvt_pk_bf16_f32 v255, v208, v209
    ds_write_b32 v63, v252 offset:768
    v_mfma_f32_32x32x16_bf16 v[160:175], v[212:215], v[228:231], v[160:175]
    ds_write_b32 v63, v253 offset:5632
    ds_write_b32 v63, v254 offset:10496
    ds_write_b32 v63, v255 offset:15360
    v_mfma_f32_32x32x16_bf16 v[176:191], v[224:227], v[228:231], v[176:191]
    s_waitcnt vmcnt(2)
    v_cmp_eq_u32 vcc, 19, v5
    s_nop 0
    s_cbranch_vccnz gl_34
gc_35:
    s_lshl_b32 s25, s72, 5
    s_add_u32 s25, s25, 0
    s_sub_u32 s26, s25, 4
    s_waitcnt lgkmcnt(4)
    v_mfma_f32_32x32x16_bf16 v[144:159], v[240:243], v[216:219], v[144:159]
    ds_read_b64_tr_b16 v[236:237], v65 offset:2976
    ds_read_b64_tr_b16 v[238:239], v65 offset:2944
    s_max_i32 s26, s26, 0
    s_lshl_b32 s27, s71, 12
    s_add_u32 s27, s27, 9437184
    s_lshl_b32 s99, s25, 3
    v_mfma_f32_32x32x16_bf16 v[160:175], v[220:223], v[216:219], v[160:175]
    s_lshl_b32 s100, s26, 3
    s_lshl_b32 s92, s24, 12
    s_lshl_b32 s93, s24, 9
    s_add_u32 s99, s99, s27
    s_add_u32 s100, s100, s27
    v_mfma_f32_32x32x16_bf16 v[176:191], v[212:215], v[216:219], v[176:191]
    v_mfma_f32_32x32x16_bf16 v[192:207], v[224:227], v[216:219], v[192:207]
    ds_read_b64_tr_b16 v[224:225], v65 offset:3488
    ds_read_b64_tr_b16 v[226:227], v65 offset:3456
    s_waitcnt lgkmcnt(2)
    v_mfma_f32_32x32x16_bf16 v[160:175], v[240:243], v[236:239], v[160:175]
    v_mfma_f32_32x32x16_bf16 v[176:191], v[220:223], v[236:239], v[176:191]
    ds_read_b64_tr_b16 v[244:245], v65 offset:4000
    ds_read_b64_tr_b16 v[246:247], v65 offset:3968
    v_mfma_f32_32x32x16_bf16 v[192:207], v[212:215], v[236:239], v[192:207]
    s_waitcnt lgkmcnt(2)
    v_mfma_f32_32x32x16_bf16 v[176:191], v[240:243], v[224:227], v[176:191]
    v_mfma_f32_32x32x16_bf16 v[192:207], v[220:223], v[224:227], v[192:207]
    s_waitcnt lgkmcnt(0)
    v_mfma_f32_32x32x16_bf16 v[192:207], v[240:243], v[244:247], v[192:207]
    s_waitcnt lgkmcnt(0)
    s_barrier
    ds_read_b128 v[212:215], v64 offset:608
    ds_read_b128 v[216:219], v64 offset:576
    ds_read_b128 v[220:223], v64 offset:544
    ds_read_b128 v[224:227], v64 offset:512
    s_waitcnt lgkmcnt(3)
    v_mfma_f32_32x32x16_bf16 v[144:159], v[212:215], v[112:115], v[144:159]
    ds_read_b128 v[228:231], v64 offset:736
    s_waitcnt lgkmcnt(3)
    v_mfma_f32_32x32x16_bf16 v[144:159], v[216:219], v[116:119], v[144:159]
    ds_read_b128 v[232:235], v64 offset:704
    s_waitcnt lgkmcnt(3)
    v_mfma_f32_32x32x16_bf16 v[144:159], v[220:223], v[120:123], v[144:159]
    ds_read_b128 v[236:239], v64 offset:672
    s_waitcnt lgkmcnt(3)
    v_mfma_f32_32x32x16_bf16 v[144:159], v[224:227], v[124:127], v[144:159]
    ds_read_b128 v[240:243], v64 offset:640
    s_nop 3
    s_waitcnt lgkmcnt(3)
    v_mfma_f32_32x32x16_bf16 v[160:175], v[228:231], v[112:115], v[160:175]
    s_nop 4
    s_waitcnt lgkmcnt(2)
    v_mfma_f32_32x32x16_bf16 v[160:175], v[232:235], v[116:119], v[160:175]
    v_cndmask_b32 v208, v147, v72, s[76:77]
    v_cndmask_b32 v209, v151, v147, s[76:77]
    v_cndmask_b32 v210, v155, v151, s[76:77]
    v_cndmask_b32 v211, v159, v155, s[76:77]
    v_mov_b32_e64 v72, v159
    s_waitcnt lgkmcnt(1)
    v_mfma_f32_32x32x16_bf16 v[160:175], v[236:239], v[120:123], v[160:175]
    v_add_f32_dpp v146, v208, v146 wave_ror:1 row_mask:0xf bank_mask:0xf
    v_add_f32_dpp v150, v209, v150 wave_ror:1 row_mask:0xf bank_mask:0xf
    v_add_f32_dpp v154, v210, v154 wave_ror:1 row_mask:0xf bank_mask:0xf
    v_add_f32_dpp v158, v211, v158 wave_ror:1 row_mask:0xf bank_mask:0xf
    v_cndmask_b32 v208, v146, v71, s[76:77]
    s_waitcnt lgkmcnt(0)
    v_mfma_f32_32x32x16_bf16 v[160:175], v[240:243], v[124:127], v[160:175]
    v_cndmask_b32 v209, v150, v146, s[76:77]
    v_cndmask_b32 v210, v154, v150, s[76:77]
    v_cndmask_b32 v211, v158, v154, s[76:77]
    v_mov_b32 v71, v158
    v_add_f32_dpp v145, v208, v145 wave_ror:1 row_mask:0xf bank_mask:0xf
    v_add_f32_dpp v149, v209, v149 wave_ror:1 row_mask:0xf bank_mask:0xf
    v_mfma_f32_32x32x16_bf16 v[160:175], v[212:215], v[128:131], v[160:175]
    ds_read_b128 v[244:247], v64 offset:864
    v_add_f32_dpp v153, v210, v153 wave_ror:1 row_mask:0xf bank_mask:0xf
    v_add_f32_dpp v157, v211, v157 wave_ror:1 row_mask:0xf bank_mask:0xf
    v_cndmask_b32 v208, v145, v70, s[76:77]
    v_cndmask_b32 v209, v149, v145, s[76:77]
    v_cndmask_b32 v210, v153, v149, s[76:77]
    v_mfma_f32_32x32x16_bf16 v[160:175], v[216:219], v[132:135], v[160:175]
    ds_read_b128 v[248:251], v64 offset:832
    v_cndmask_b32 v211, v157, v153, s[76:77]
    v_mov_b32_e64 v70, v157
    v_add_f32_dpp v144, v208, v144 wave_ror:1 row_mask:0xf bank_mask:0xf
    v_add_f32_dpp v148, v209, v148 wave_ror:1 row_mask:0xf bank_mask:0xf
    v_add_f32_dpp v152, v210, v152 wave_ror:1 row_mask:0xf bank_mask:0xf
    v_mfma_f32_32x32x16_bf16 v[160:175], v[220:223], v[136:139], v[160:175]
    ds_read_b128 v[252:255], v64 offset:800
    v_add_f32_dpp v156, v211, v156 wave_ror:1 row_mask:0xf bank_mask:0xf
    ds_write_b32 v66, v144 offset:0
    v_mfma_f32_32x32x16_bf16 v[160:175], v[224:227], v[140:143], v[160:175]
    ds_read_b128 v[224:227], v64 offset:768
    ds_write_b32 v66, v148 offset:64
    ds_write_b32 v66, v152 offset:128
    s_waitcnt lgkmcnt(6)
    v_mfma_f32_32x32x16_bf16 v[176:191], v[244:247], v[112:115], v[176:191]
    ds_write_b32 v66, v156 offset:192
    buffer_load_dword v7, v4, s[16:19], s89 offen offset:0 sc1
    s_nop 1
    s_waitcnt lgkmcnt(6)
    v_mfma_f32_32x32x16_bf16 v[176:191], v[248:251], v[116:119], v[176:191]
    s_nop 2
    v_cndmask_b32 v208, v163, v72, s[76:77]
    v_cndmask_b32 v209, v167, v163, s[76:77]
    s_waitcnt lgkmcnt(5)
    v_mfma_f32_32x32x16_bf16 v[176:191], v[252:255], v[120:123], v[176:191]
    v_cndmask_b32 v210, v171, v167, s[76:77]
    v_cndmask_b32 v211, v175, v171, s[76:77]
    v_mov_b32 v72, v175
    v_add_f32_dpp v162, v208, v162 wave_ror:1 row_mask:0xf bank_mask:0xf
    v_add_f32_dpp v166, v209, v166 wave_ror:1 row_mask:0xf bank_mask:0xf
    s_waitcnt lgkmcnt(3)
    v_mfma_f32_32x32x16_bf16 v[176:191], v[224:227], v[124:127], v[176:191]
    v_add_f32_dpp v170, v210, v170 wave_ror:1 row_mask:0xf bank_mask:0xf
    v_add_f32_dpp v174, v211, v174 wave_ror:1 row_mask:0xf bank_mask:0xf
    v_cndmask_b32 v208, v162, v71, s[76:77]
    v_cndmask_b32 v209, v166, v162, s[76:77]
    v_cndmask_b32 v210, v170, v166, s[76:77]
    v_cndmask_b32 v211, v174, v170, s[76:77]
    v_mfma_f32_32x32x16_bf16 v[176:191], v[228:231], v[128:131], v[176:191]
    ds_read_b64_tr_b16 v[228:229], v65 offset:1056
    ds_read_b64_tr_b16 v[230:231], v65 offset:1024
    v_mov_b32 v71, v174
    v_add_f32_dpp v161, v208, v161 wave_ror:1 row_mask:0xf bank_mask:0xf
    v_add_f32_dpp v165, v209, v165 wave_ror:1 row_mask:0xf bank_mask:0xf
    v_add_f32_dpp v169, v210, v169 wave_ror:1 row_mask:0xf bank_mask:0xf
    v_mfma_f32_32x32x16_bf16 v[176:191], v[232:235], v[132:135], v[176:191]
    ds_read_b64_tr_b16 v[232:233], v65 offset:1184
    ds_read_b64_tr_b16 v[234:235], v65 offset:1152
    v_add_f32_dpp v173, v211, v173 wave_ror:1 row_mask:0xf bank_mask:0xf
    v_cndmask_b32 v208, v161, v70, s[76:77]
    v_cndmask_b32 v209, v165, v161, s[76:77]
    v_cndmask_b32 v210, v169, v165, s[76:77]
    v_mfma_f32_32x32x16_bf16 v[176:191], v[236:239], v[136:139], v[176:191]
    ds_read_b64_tr_b16 v[236:237], v65 offset:1312
    ds_read_b64_tr_b16 v[238:239], v65 offset:1280
    v_cndmask_b32 v211, v173, v169, s[76:77]
    v_mov_b32_e64 v70, v173
    v_add_f32_dpp v160, v208, v160 wave_ror:1 row_mask:0xf bank_mask:0xf
    v_add_f32_dpp v164, v209, v164 wave_ror:1 row_mask:0xf bank_mask:0xf
    v_mfma_f32_32x32x16_bf16 v[176:191], v[240:243], v[140:143], v[176:191]
    ds_read_b128 v[240:243], v64 offset:512
    ds_read_b64_tr_b16 v[224:225], v65 offset:1440
    ds_read_b64_tr_b16 v[226:227], v65 offset:1408
    v_add_f32_dpp v168, v210, v168 wave_ror:1 row_mask:0xf bank_mask:0xf
    v_add_f32_dpp v172, v211, v172 wave_ror:1 row_mask:0xf bank_mask:0xf
    s_waitcnt lgkmcnt(7)
    v_mfma_f32_32x32x16_bf16 v[176:191], v[212:215], v[228:231], v[176:191]
    ds_read_b128 v[212:215], v64 offset:992
    ds_write_b32 v66, v160 offset:256
    ds_write_b32 v66, v164 offset:320
    s_waitcnt lgkmcnt(8)
    v_mfma_f32_32x32x16_bf16 v[176:191], v[216:219], v[232:235], v[176:191]
    ds_read_b128 v[216:219], v64 offset:960
    ds_write_b32 v66, v168 offset:384
    ds_write_b32 v66, v172 offset:448
    s_waitcnt lgkmcnt(9)
    v_mfma_f32_32x32x16_bf16 v[176:191], v[220:223], v[236:239], v[176:191]
    ds_read_b128 v[220:223], v64 offset:928
    s_waitcnt lgkmcnt(7)
    v_mfma_f32_32x32x16_bf16 v[176:191], v[240:243], v[224:227], v[176:191]
    ds_read_b128 v[240:243], v64 offset:896
    s_waitcnt lgkmcnt(2)
    s_waitcnt vmcnt(0)
    v_cmp_gt_u32_e64 vcc, 1, v7
    s_nop 0
    s_and_b64 vcc, vcc, s[50:51]
    s_cbranch_scc1 ps_36
pc_38:
    s_barrier
    v_mfma_f32_32x32x16_bf16 v[192:207], v[212:215], v[112:115], v[192:207]
    ds_read_b64 v[144:145], v67 offset:0
    ds_read_b64 v[146:147], v67 offset:4224
    ds_read_b64 v[148:149], v67 offset:8448
    ds_read_b64 v[150:151], v67 offset:12672
    s_lshl_b32 s25, s75, 14
    v_mfma_f32_32x32x16_bf16 v[192:207], v[216:219], v[116:119], v[192:207]
    s_add_u32 s25, s25, 9437184
    s_add_u32 m0, s92, 36352
    s_nop 0
    buffer_load_dwordx4 v73, s[16:19], s99 offen offset:0 sc1 lds
    buffer_load_dwordx4 v74, s[16:19], s99 offen offset:1024 sc1 lds
    buffer_load_dwordx4 v75, s[16:19], s99 offen offset:2048 sc1 lds
    s_waitcnt lgkmcnt(5)
    v_mfma_f32_32x32x16_bf16 v[192:207], v[220:223], v[120:123], v[192:207]
    buffer_load_dwordx4 v76, s[16:19], s99 offen offset:3072 sc1 lds
    s_waitcnt lgkmcnt(4)
    v_mfma_f32_32x32x16_bf16 v[192:207], v[240:243], v[124:127], v[192:207]
    ds_read_b128 v[212:215], v64 offset:768
    s_add_u32 m0, s93, 53760
    s_add_u32 s99, s99, 524288
    s_mov_b64 exec, s[80:81]
    buffer_load_dwordx4 v77, s[16:19], s100 offen sc1 lds
    s_mov_b64 exec, -1
    s_add_u32 s100, s100, 524288
    v_mfma_f32_32x32x16_bf16 v[192:207], v[244:247], v[128:131], v[192:207]
    ds_read_b128 v[244:247], v64 offset:736
    v_cndmask_b32 v208, v179, v72, s[76:77]
    v_cndmask_b32 v209, v183, v179, s[76:77]
    v_cndmask_b32 v210, v187, v183, s[76:77]
    v_cndmask_b32 v211, v191, v187, s[76:77]
    v_mov_b32_e64 v72, v191
    v_mfma_f32_32x32x16_bf16 v[192:207], v[248:251], v[132:135], v[192:207]
    ds_read_b128 v[248:251], v64 offset:704
    v_add_f32_dpp v178, v208, v178 wave_ror:1 row_mask:0xf bank_mask:0xf
    v_add_f32_dpp v182, v209, v182 wave_ror:1 row_mask:0xf bank_mask:0xf
    v_add_f32_dpp v186, v210, v186 wave_ror:1 row_mask:0xf bank_mask:0xf
    v_add_f32_dpp v190, v211, v190 wave_ror:1 row_mask:0xf bank_mask:0xf
    v_cndmask_b32 v208, v178, v71, s[76:77]
    v_mfma_f32_32x32x16_bf16 v[192:207], v[252:255], v[136:139], v[192:207]
    ds_read_b128 v[252:255], v64 offset:672
    v_cndmask_b32 v209, v182, v178, s[76:77]
    v_cndmask_b32 v210, v186, v182, s[76:77]
    v_cndmask_b32 v211, v190, v186, s[76:77]
    v_mov_b32 v71, v190
    s_waitcnt lgkmcnt(3)
    v_mfma_f32_32x32x16_bf16 v[192:207], v[212:215], v[140:143], v[192:207]
    ds_read_b128 v[216:219], v64 offset:640
    v_add_f32_dpp v177, v208, v177 wave_ror:1 row_mask:0xf bank_mask:0xf
    v_add_f32_dpp v181, v209, v181 wave_ror:1 row_mask:0xf bank_mask:0xf
    v_add_f32_dpp v185, v210, v185 wave_ror:1 row_mask:0xf bank_mask:0xf
    v_add_f32_dpp v189, v211, v189 wave_ror:1 row_mask:0xf bank_mask:0xf
    s_waitcnt lgkmcnt(3)
    v_mfma_f32_32x32x16_bf16 v[192:207], v[244:247], v[228:231], v[192:207]
    ds_read_b128 v[228:231], v64 offset:608
    ds_read_b64_tr_b16 v[220:221], v65 offset:1568
    ds_read_b64_tr_b16 v[222:223], v65 offset:1536
    v_cndmask_b32 v208, v177, v70, s[76:77]
    v_cndmask_b32 v209, v181, v177, s[76:77]
    s_waitcnt lgkmcnt(5)
    v_mfma_f32_32x32x16_bf16 v[192:207], v[248:251], v[232:235], v[192:207]
    ds_read_b128 v[232:235], v64 offset:576
    ds_read_b64_tr_b16 v[240:241], v65 offset:1696
    ds_read_b64_tr_b16 v[242:243], v65 offset:1664
    v_cndmask_b32 v210, v185, v181, s[76:77]
    v_cndmask_b32 v211, v189, v185, s[76:77]
    s_waitcnt lgkmcnt(7)
    v_mfma_f32_32x32x16_bf16 v[192:207], v[252:255], v[236:239], v[192:207]
    ds_read_b128 v[236:239], v64 offset:544
    ds_read_b64_tr_b16 v[212:213], v65 offset:1824
    ds_read_b64_tr_b16 v[214:215], v65 offset:1792
    v_mov_b32 v70, v189
    v_add_f32_dpp v176, v208, v176 wave_ror:1 row_mask:0xf bank_mask:0xf
    s_waitcnt lgkmcnt(9)
    v_mfma_f32_32x32x16_bf16 v[192:207], v[216:219], v[224:227], v[192:207]
    ds_read_b128 v[224:227], v64 offset:512
    ds_read_b64_tr_b16 v[244:245], v65 offset:1952
    ds_read_b64_tr_b16 v[246:247], v65 offset:1920
    v_add_f32_dpp v180, v209, v180 wave_ror:1 row_mask:0xf bank_mask:0xf
    v_add_f32_dpp v184, v210, v184 wave_ror:1 row_mask:0xf bank_mask:0xf
    s_waitcnt lgkmcnt(9)
    v_mfma_f32_32x32x16_bf16 v[192:207], v[228:231], v[220:223], v[192:207]
    v_add_f32_dpp v188, v211, v188 wave_ror:1 row_mask:0xf bank_mask:0xf
    ds_write_b32 v66, v176 offset:512
    s_waitcnt lgkmcnt(7)
    v_mfma_f32_32x32x16_bf16 v[192:207], v[232:235], v[240:243], v[192:207]
    ds_write_b32 v66, v180 offset:576
    ds_write_b32 v66, v184 offset:640
    s_waitcnt lgkmcnt(6)
    v_mfma_f32_32x32x16_bf16 v[192:207], v[236:239], v[212:215], v[192:207]
    ds_write_b32 v66, v188 offset:704
    v_add_f32 v144, v144, v80
    v_add_f32 v145, v145, v81
    s_waitcnt lgkmcnt(4)
    v_mfma_f32_32x32x16_bf16 v[192:207], v[224:227], v[244:247], v[192:207]
    v_add_f32 v146, v146, v82
    v_add_f32 v147, v147, v83
    v_add_f32 v148, v148, v84
    v_add_f32 v149, v149, v85
    v_add_f32 v150, v150, v86
    v_add_f32_e64 v151, v151, v87
    v_cvt_pk_bf16_f32 v160, v144, v146
    v_cvt_pk_bf16_f32 v161, v148, v150
    v_cvt_pk_bf16_f32 v162, v145, v147
    v_cvt_pk_bf16_f32 v163, v149, v151
    buffer_store_dwordx4 v[160:163], v62, s[16:19], s25 offen offset:2048 sc1
    s_add_u32 m0, s92, 55936
    s_nop 0
    s_nop 0
    buffer_load_dwordx4 v73, s[16:19], s99 offen offset:0 sc1 lds
    buffer_load_dwordx4 v74, s[16:19], s99 offen offset:1024 sc1 lds
    buffer_load_dwordx4 v75, s[16:19], s99 offen offset:2048 sc1 lds
    buffer_load_dwordx4 v76, s[16:19], s99 offen offset:3072 sc1 lds
    s_add_u32 m0, s93, 73344
    s_add_u32 s99, s99, 524288
    s_mov_b64 exec, s[80:81]
    buffer_load_dwordx4 v77, s[16:19], s100 offen sc1 lds
    s_mov_b64 exec, -1
    s_add_u32 s100, s100, 524288
    s_add_u32 m0, s92, 75520
    s_nop 0
    s_nop 0
    buffer_load_dwordx4 v73, s[16:19], s99 offen offset:0 sc1 lds
    buffer_load_dwordx4 v74, s[16:19], s99 offen offset:1024 sc1 lds
    buffer_load_dwordx4 v75, s[16:19], s99 offen offset:2048 sc1 lds
    buffer_load_dwordx4 v76, s[16:19], s99 offen offset:3072 sc1 lds
    s_add_u32 m0, s93, 92928
    s_add_u32 s99, s99, 524288
    s_mov_b64 exec, s[80:81]
    buffer_load_dwordx4 v77, s[16:19], s100 offen sc1 lds
    s_mov_b64 exec, -1
    s_add_u32 s100, s100, 524288
    v_cndmask_b32 v208, v195, v72, s[76:77]
    v_cndmask_b32 v209, v199, v195, s[76:77]
    v_cndmask_b32 v210, v203, v199, s[76:77]
    v_cndmask_b32 v211, v207, v203, s[76:77]
    v_mov_b32_e64 v72, v207
    v_add_f32_dpp v194, v208, v194 wave_ror:1 row_mask:0xf bank_mask:0xf
    v_add_f32_dpp v198, v209, v198 wave_ror:1 row_mask:0xf bank_mask:0xf
    v_add_f32_dpp v202, v210, v202 wave_ror:1 row_mask:0xf bank_mask:0xf
    v_add_f32_dpp v206, v211, v206 wave_ror:1 row_mask:0xf bank_mask:0xf
    v_cndmask_b32 v208, v194, v71, s[76:77]
    v_cndmask_b32 v209, v198, v194, s[76:77]
    v_cndmask_b32 v210, v202, v198, s[76:77]
    v_cndmask_b32 v211, v206, v202, s[76:77]
    v_mov_b32_e64 v71, v206
    v_add_f32_dpp v193, v208, v193 wave_ror:1 row_mask:0xf bank_mask:0xf
    v_add_f32_dpp v197, v209, v197 wave_ror:1 row_mask:0xf bank_mask:0xf
    v_add_f32_dpp v201, v210, v201 wave_ror:1 row_mask:0xf bank_mask:0xf
    v_add_f32_dpp v205, v211, v205 wave_ror:1 row_mask:0xf bank_mask:0xf
    v_cndmask_b32 v208, v193, v70, s[76:77]
    v_cndmask_b32 v209, v197, v193, s[76:77]
    v_cndmask_b32 v210, v201, v197, s[76:77]
    v_cndmask_b32 v211, v205, v201, s[76:77]
    v_mov_b32_e64 v70, v205
    v_add_f32_dpp v192, v208, v192 wave_ror:1 row_mask:0xf bank_mask:0xf
    v_add_f32_dpp v196, v209, v196 wave_ror:1 row_mask:0xf bank_mask:0xf
    v_add_f32_dpp v200, v210, v200 wave_ror:1 row_mask:0xf bank_mask:0xf
    v_add_f32_dpp v204, v211, v204 wave_ror:1 row_mask:0xf bank_mask:0xf
    ds_write_b32 v66, v192 offset:768
    ds_write_b32 v66, v196 offset:832
    ds_write_b32 v66, v200 offset:896
    ds_write_b32 v66, v204 offset:960
    s_waitcnt lgkmcnt(0)
    s_barrier
    ds_read_b64 v[152:153], v67 offset:512
    ds_read_b64 v[154:155], v67 offset:4736
    ds_read_b64 v[156:157], v67 offset:8960
    ds_read_b64 v[158:159], v67 offset:13184
    s_lshl_b32 s25, s75, 14
    s_add_u32 s25, s25, 9437184
    s_waitcnt lgkmcnt(0)
    v_add_f32 v152, v152, v88
    v_add_f32 v153, v153, v89
    v_add_f32 v154, v154, v90
    v_add_f32 v155, v155, v91
    v_add_f32 v156, v156, v92
    v_add_f32 v157, v157, v93
    v_add_f32 v158, v158, v94
    v_add_f32 v159, v159, v95
    v_cvt_pk_bf16_f32 v164, v152, v154
    v_cvt_pk_bf16_f32 v165, v156, v158
    v_cvt_pk_bf16_f32 v166, v153, v155
    v_cvt_pk_bf16_f32 v167, v157, v159
    buffer_store_dwordx4 v[164:167], v62, s[16:19], s25 offen offset:3072 sc1
    v_mov_b32_e64 v5, 1
    s_add_u32 s82, s86, 24576
    buffer_atomic_add v5, v6, s[16:19], s82 offen offset:4 sc0 sc1
    s_branch ec_27
nc_26:
    v_lshlrev_b32 v2, 3, v4
    v_mov_b32_e64 v5, 1
    v_cndmask_b32 v2, v4, v2, s[50:51]
    buffer_atomic_add v5, v2, s[16:19], s86 offen offset:8 sc1
    buffer_load_dword v7, v4, s[16:19], s87 offen offset:8 sc1
    s_waitcnt vmcnt(0)
    v_cmp_gt_u32 vcc, 12, v7
    s_nop 0
    s_and_b64 vcc, vcc, s[50:51]
    s_cbranch_scc1 ps_39
pc_41:
    v_mov_b32 v100, -1
    v_mov_b32 v101, -1
    v_mov_b32 v102, -1
    v_mov_b32 v103, -1
    v_lshlrev_b32 v104, 4, v0
    s_sub_u32 s88, s2, 160
    s_mul_i32 s88, s88, 57344
    s_min_u32 s88, s88, 5185536
    s_add_u32 s88, s88, 12058624
    buffer_store_dwordx4 v[100:103], v104, s[16:19], s88 offen sc1
    s_add_u32 s88, s88, 4096
    buffer_store_dwordx4 v[100:103], v104, s[16:19], s88 offen sc1
    s_add_u32 s88, s88, 4096
    buffer_store_dwordx4 v[100:103], v104, s[16:19], s88 offen sc1
    s_add_u32 s88, s88, 4096
    buffer_store_dwordx4 v[100:103], v104, s[16:19], s88 offen sc1
    s_add_u32 s88, s88, 4096
    buffer_store_dwordx4 v[100:103], v104, s[16:19], s88 offen sc1
    s_add_u32 s88, s88, 4096
    buffer_store_dwordx4 v[100:103], v104, s[16:19], s88 offen sc1
    s_add_u32 s88, s88, 4096
    buffer_store_dwordx4 v[100:103], v104, s[16:19], s88 offen sc1
    s_add_u32 s88, s88, 4096
    buffer_store_dwordx4 v[100:103], v104, s[16:19], s88 offen sc1
    s_add_u32 s88, s88, 4096
    buffer_store_dwordx4 v[100:103], v104, s[16:19], s88 offen sc1
    s_add_u32 s88, s88, 4096
    buffer_store_dwordx4 v[100:103], v104, s[16:19], s88 offen sc1
    s_add_u32 s88, s88, 4096
    buffer_store_dwordx4 v[100:103], v104, s[16:19], s88 offen sc1
    s_add_u32 s88, s88, 4096
    buffer_store_dwordx4 v[100:103], v104, s[16:19], s88 offen sc1
    s_add_u32 s88, s88, 4096
    buffer_store_dwordx4 v[100:103], v104, s[16:19], s88 offen sc1
    s_add_u32 s88, s88, 4096
    buffer_store_dwordx4 v[100:103], v104, s[16:19], s88 offen sc1
    s_waitcnt vmcnt(0)
    s_barrier
    v_mov_b32_e64 v5, 1
    s_add_u32 s82, s86, 8192
    buffer_atomic_add v5, v6, s[16:19], s82 offen offset:12 sc0 sc1
    s_waitcnt vmcnt(0)
    v_cmp_eq_u32 vcc, 11, v5
    s_nop 0
    s_cbranch_vccnz gl_42
gc_43:
    buffer_load_dword v7, v4, s[16:19], s89 offen offset:0 sc1
    s_waitcnt vmcnt(0)
    v_cmp_gt_u32 vcc, 1, v7
    s_nop 0
    s_and_b64 vcc, vcc, s[50:51]
    s_cbranch_scc1 ps_44
pc_46:
    s_barrier
    s_sub_u32 s3, s2, 160
    s_and_b32 s3, s3, 63
    s_add_u32 s3, s3, 0
    s_and_b32 s25, s3, 3
    s_lshl_b32 s25, s25, 12
    s_lshr_b32 s26, s3, 2
    s_lshl_b32 s26, s26, 7
    s_add_u32 s3, s25, s26
    v_lshrrev_b32 v236, 3, v0
    v_and_b32 v237, 7, v0
    v_lshlrev_b32 v237, 4, v237
    v_lshl_add_u32 v236, v236, 14, v237
    s_sub_u32 s25, s2, 160
    s_cmp_lt_u32 s25, 64
    s_cselect_b32 s25, 0, 1073741824
    v_add_u32_e64 v236, s25, v236
    s_add_u32 s26, s3, 9437184
    buffer_load_dwordx4 v[216:219], v236, s[16:19], s26 offen sc1
    s_add_u32 s26, s26, 524288
    buffer_load_dwordx4 v[220:223], v236, s[16:19], s26 offen sc1
    s_add_u32 s26, s26, 524288
    buffer_load_dwordx4 v[224:227], v236, s[16:19], s26 offen sc1
    s_add_u32 s26, s26, 524288
    buffer_load_dwordx4 v[228:231], v236, s[16:19], s26 offen sc1
    s_add_u32 s26, s26, 524288
    buffer_load_dwordx4 v[232:235], v236, s[16:19], s26 offen sc1
    s_lshl_b32 s25, s72, 5
    s_add_u32 s25, s25, 0
    s_sub_u32 s26, s25, 4
    s_max_i32 s26, s26, 0
    s_lshl_b32 s27, s71, 12
    s_add_u32 s27, s27, 9437184
    s_lshl_b32 s99, s25, 3
    s_lshl_b32 s100, s26, 3
    s_lshl_b32 s92, s24, 12
    s_lshl_b32 s93, s24, 9
    s_add_u32 s99, s99, s27
    s_add_u32 s100, s100, s27
    s_add_u32 m0, s92, 36352
    s_nop 0
    buffer_load_dwordx4 v73, s[16:19], s99 offen offset:0 sc1 lds
    buffer_load_dwordx4 v74, s[16:19], s99 offen offset:1024 sc1 lds
    buffer_load_dwordx4 v75, s[16:19], s99 offen offset:2048 sc1 lds
    buffer_load_dwordx4 v76, s[16:19], s99 offen offset:3072 sc1 lds
    s_add_u32 m0, s93, 53760
    s_add_u32 s99, s99, 524288
    s_mov_b64 exec, s[80:81]
    buffer_load_dwordx4 v77, s[16:19], s100 offen sc1 lds
    s_mov_b64 exec, -1
    s_add_u32 s100, s100, 524288
    s_add_u32 m0, s92, 55936
    s_nop 0
    s_nop 0
    buffer_load_dwordx4 v73, s[16:19], s99 offen offset:0 sc1 lds
    buffer_load_dwordx4 v74, s[16:19], s99 offen offset:1024 sc1 lds
    buffer_load_dwordx4 v75, s[16:19], s99 offen offset:2048 sc1 lds
    buffer_load_dwordx4 v76, s[16:19], s99 offen offset:3072 sc1 lds
    s_add_u32 m0, s93, 73344
    s_add_u32 s99, s99, 524288
    s_mov_b64 exec, s[80:81]
    buffer_load_dwordx4 v77, s[16:19], s100 offen sc1 lds
    s_mov_b64 exec, -1
    s_add_u32 s100, s100, 524288
    s_sub_u32 s85, s2, 160
    s_cmp_ge_u32 s85, 64
    s_cbranch_scc1 s2_47
    v_mov_b32 v238, 0x3f803f80
    s_lshl_b32 s25, s24, 7
    s_add_u32 s25, s25, 134272
    v_lshrrev_b32 v239, 4, v1
    v_lshl_add_u32 v237, v239, 2, v237
    v_add_u32 v237, s25, v237
se_48:
    v_mov_b32 v240, 0
    v_mov_b32 v241, 0
    v_mov_b32 v242, 0
    v_mov_b32 v243, 0
    s_waitcnt vmcnt(14)
    v_dot2c_f32_bf16 v240, v216, v238
    v_dot2c_f32_bf16 v241, v216, v216
    v_dot2c_f32_bf16 v240, v217, v238
    v_dot2c_f32_bf16 v241, v217, v217
    v_dot2c_f32_bf16 v242, v218, v238
    v_dot2c_f32_bf16 v243, v218, v218
    v_dot2c_f32_bf16 v242, v219, v238
    v_dot2c_f32_bf16 v243, v219, v219
    s_waitcnt vmcnt(13)
    v_dot2c_f32_bf16 v240, v220, v238
    v_dot2c_f32_bf16 v241, v220, v220
    v_dot2c_f32_bf16 v240, v221, v238
    v_dot2c_f32_bf16 v241, v221, v221
    v_dot2c_f32_bf16 v242, v222, v238
    v_dot2c_f32_bf16 v243, v222, v222
    v_dot2c_f32_bf16 v242, v223, v238
    v_dot2c_f32_bf16 v243, v223, v223
    s_waitcnt vmcnt(12)
    v_dot2c_f32_bf16 v240, v224, v238
    v_dot2c_f32_bf16 v241, v224, v224
    v_dot2c_f32_bf16 v240, v225, v238
    v_dot2c_f32_bf16 v241, v225, v225
    v_dot2c_f32_bf16 v242, v226, v238
    v_dot2c_f32_bf16 v243, v226, v226
    v_dot2c_f32_bf16 v242, v227, v238
    v_dot2c_f32_bf16 v243, v227, v227
    s_waitcnt vmcnt(11)
    v_dot2c_f32_bf16 v240, v228, v238
    v_dot2c_f32_bf16 v241, v228, v228
    v_dot2c_f32_bf16 v240, v229, v238
    v_dot2c_f32_bf16 v241, v229, v229
    v_dot2c_f32_bf16 v242, v230, v238
    v_dot2c_f32_bf16 v243, v230, v230
    v_dot2c_f32_bf16 v242, v231, v238
    v_dot2c_f32_bf16 v243, v231, v231
    s_waitcnt vmcnt(10)
    v_dot2c_f32_bf16 v240, v232, v238
    v_dot2c_f32_bf16 v241, v232, v232
    v_dot2c_f32_bf16 v240, v233, v238
    v_dot2c_f32_bf16 v241, v233, v233
    v_dot2c_f32_bf16 v242, v234, v238
    v_dot2c_f32_bf16 v243, v234, v234
    v_dot2c_f32_bf16 v242, v235, v238
    v_dot2c_f32_bf16 v243, v235, v235
    s_nop 2
    v_cmp_u_f32 vcc, v241, v243
    s_nop 0
    s_cbranch_vccnz rd_49
rc_50:
    v_permlane32_swap_b32 v240, v242
    v_permlane32_swap_b32 v241, v243
    v_pk_add_f32 v[240:241], v[240:241], v[242:243]
    s_nop 1
    v_permlane16_swap_b32 v240, v241
    v_add_f32 v240, v240, v241
    s_nop 1
    v_add_f32_dpp v240, v240, v240 row_ror:8 row_mask:0xf bank_mask:0xf
    ds_write_b32 v237, v240
    v_and_b32 v236, 15, v0
    v_lshlrev_b32 v236, 3, v236
    v_add_u32 v237, 134272, v236
    v_mov_b32 v239, 1073741824
    v_cmp_gt_u32 vcc, 16, v0
    s_nop 1
    v_cndmask_b32 v236, v239, v236, vcc
    s_add_u32 s25, s3, 3457024
    s_waitcnt lgkmcnt(0)
    s_barrier
    ds_read_b64 v[216:217], v237 offset:0
    ds_read_b64 v[218:219], v237 offset:128
    ds_read_b64 v[220:221], v237 offset:256
    ds_read_b64 v[222:223], v237 offset:384
    s_waitcnt lgkmcnt(2)
    v_pk_add_f32 v[216:217], v[216:217], v[218:219]
    s_waitcnt lgkmcnt(0)
    v_pk_add_f32 v[220:221], v[220:221], v[222:223]
    v_pk_add_f32 v[216:217], v[216:217], v[220:221]
    v_mul_f32 v239, 0x3acccccd, v216
    v_mul_f32 v217, 0x3acccccd, v217
    v_fma_f32 v217, -v239, v239, v217
    v_max_f32 v217, 0, v217
    v_add_f32 v217, 0x3727c5ac, v217
    v_rsq_f32_e64 v216, v217
    s_nop 0
    v_mul_f32 v217, -v239, v216
    buffer_store_dwordx2 v[216:217], v236, s[16:19], s25 offen sc1
s2_47:
    s_add_u32 m0, s92, 75520
    s_nop 0
    s_nop 0
    buffer_load_dwordx4 v73, s[16:19], s99 offen offset:0 sc1 lds
    buffer_load_dwordx4 v74, s[16:19], s99 offen offset:1024 sc1 lds
    buffer_load_dwordx4 v75, s[16:19], s99 offen offset:2048 sc1 lds
    buffer_load_dwordx4 v76, s[16:19], s99 offen offset:3072 sc1 lds
    s_add_u32 m0, s93, 92928
    s_add_u32 s99, s99, 524288
    s_mov_b64 exec, s[80:81]
    buffer_load_dwordx4 v77, s[16:19], s100 offen sc1 lds
    s_mov_b64 exec, -1
    s_add_u32 s100, s100, 524288
ec_27:
ge_51:
    v_add_u32 v196, 36352, v78
    v_mov_b32_e64 v198, v79
    s_waitcnt vmcnt(10)
    s_barrier
    ds_read_b64 v[160:161], v198 offset:0
    ds_read_b64 v[162:163], v198 offset:64
    ds_read_b64 v[164:165], v196 offset:0
    ds_read_b64 v[166:167], v196 offset:512
    ds_read_b64 v[168:169], v196 offset:256
    ds_read_b64 v[170:171], v196 offset:768
    ds_read_b64 v[172:173], v198 offset:256
    ds_read_b64 v[174:175], v198 offset:320
    ds_read_b64 v[176:177], v196 offset:2048
    ds_read_b64 v[178:179], v196 offset:2560
    ds_read_b64 v[180:181], v196 offset:2304
    ds_read_b64 v[182:183], v196 offset:2816
    s_waitcnt lgkmcnt(6)
    v_mfma_f32_16x16x32_bf16 v[112:115], a[0:3], v[160:163], 0
    ds_read_b64 v[184:185], v198 offset:512
    v_mfma_f32_32x32x16_bf16 v[80:95], a[0:3], v[164:167], 0
    ds_read_b64 v[186:187], v198 offset:576
    ds_read_b64 v[188:189], v196 offset:4096
    ds_read_b64 v[190:191], v196 offset:4608
    v_mov_b32 v208, 0
    v_mov_b32_e64 v209, 0
    v_mfma_f32_32x32x16_bf16 v[96:111], a[0:3], v[168:171], 0
    ds_read_b64 v[192:193], v196 offset:4352
    ds_read_b64 v[194:195], v196 offset:4864
    buffer_load_dword v7, v4, s[16:19], s87 offen offset:12 sc1
    s_waitcnt lgkmcnt(6)
    v_mfma_f32_16x16x32_bf16 v[112:115], a[4:7], v[172:175], v[112:115]
    ds_read_b64 v[160:161], v198 offset:768
    v_mfma_f32_32x32x16_bf16 v[80:95], a[4:7], v[176:179], v[80:95]
    ds_read_b64 v[162:163], v198 offset:832
    ds_read_b64 v[164:165], v196 offset:6144
    ds_read_b64 v[166:167], v196 offset:6656
    v_lshrrev_b32 v210, 5, v0
    v_mul_u32_u24 v210, 1600, v210
    v_mfma_f32_32x32x16_bf16 v[96:111], a[4:7], v[180:183], v[96:111]
    ds_read_b64 v[168:169], v196 offset:6400
    ds_read_b64 v[170:171], v196 offset:6912
    s_add_u32 m0, s92, 95104
    s_nop 0
    buffer_load_dwordx4 v73, s[16:19], s99 offen offset:0 sc1 lds
    s_waitcnt lgkmcnt(6)
    v_mfma_f32_16x16x32_bf16 v[112:115], a[8:11], v[184:187], v[112:115]
    ds_read_b64 v[172:173], v198 offset:1024
    v_mfma_f32_32x32x16_bf16 v[80:95], a[8:11], v[188:191], v[80:95]
    ds_read_b64 v[174:175], v198 offset:1088
    ds_read_b64 v[176:177], v196 offset:8192
    ds_read_b64 v[178:179], v196 offset:8704
    v_and_b32 v211, 31, v0
    v_min_u32 v211, 19, v211
    v_mfma_f32_32x32x16_bf16 v[96:111], a[8:11], v[192:195], v[96:111]
    ds_read_b64 v[180:181], v196 offset:8448
    ds_read_b64 v[182:183], v196 offset:8960
    buffer_load_dwordx4 v74, s[16:19], s99 offen offset:1024 sc1 lds
    v_lshl_add_u32 v210, v211, 3, v210
    s_waitcnt lgkmcnt(6)
    v_mfma_f32_16x16x32_bf16 v[112:115], a[12:15], v[160:163], v[112:115]
    ds_read_b64 v[184:185], v198 offset:1280
    v_mfma_f32_32x32x16_bf16 v[80:95], a[12:15], v[164:167], v[80:95]
    ds_read_b64 v[186:187], v198 offset:1344
    ds_read_b64 v[188:189], v196 offset:10240
    ds_read_b64 v[190:191], v196 offset:10752
    v_add_u32 v210, 6400, v210
    ds_write_b64 v210, v[208:209]
    v_mfma_f32_32x32x16_bf16 v[96:111], a[12:15], v[168:171], v[96:111]
    ds_read_b64 v[192:193], v196 offset:10496
    ds_read_b64 v[194:195], v196 offset:11008
    buffer_load_dwordx4 v75, s[16:19], s99 offen offset:2048 sc1 lds
    s_waitcnt lgkmcnt(7)
    v_mfma_f32_16x16x32_bf16 v[112:115], a[16:19], v[172:175], v[112:115]
    ds_read_b64 v[160:161], v198 offset:1536
    v_mfma_f32_32x32x16_bf16 v[80:95], a[16:19], v[176:179], v[80:95]
    ds_read_b64 v[162:163], v198 offset:1600
    ds_read_b64 v[164:165], v196 offset:12288
    ds_read_b64 v[166:167], v196 offset:12800
    v_mfma_f32_32x32x16_bf16 v[96:111], a[16:19], v[180:183], v[96:111]
    ds_read_b64 v[168:169], v196 offset:12544
    ds_read_b64 v[170:171], v196 offset:13056
    buffer_load_dwordx4 v76, s[16:19], s99 offen offset:3072 sc1 lds
    s_waitcnt lgkmcnt(6)
    v_mfma_f32_16x16x32_bf16 v[112:115], a[20:23], v[184:187], v[112:115]
    ds_read_b64 v[172:173], v198 offset:1792
    v_mfma_f32_32x32x16_bf16 v[80:95], a[20:23], v[188:191], v[80:95]
    ds_read_b64 v[174:175], v198 offset:1856
    ds_read_b64 v[176:177], v196 offset:14336
    ds_read_b64 v[178:179], v196 offset:14848
    v_mfma_f32_32x32x16_bf16 v[96:111], a[20:23], v[192:195], v[96:111]
    ds_read_b64 v[180:181], v196 offset:14592
    ds_read_b64 v[182:183], v196 offset:15104
    s_add_u32 m0, s93, 112512
    s_add_u32 s99, s99, 524288
    s_mov_b64 exec, s[80:81]
    buffer_load_dwordx4 v77, s[16:19], s100 offen sc1 lds
    s_mov_b64 exec, -1
    s_add_u32 s100, s100, 524288
    s_waitcnt vmcnt(6)
    v_cmp_eq_u32 vcc, 19, v5
    s_nop 0
    s_cbranch_vccnz gl_52
gc_53:
    s_barrier
    s_waitcnt lgkmcnt(6)
    v_mfma_f32_16x16x32_bf16 v[112:115], a[24:27], v[160:163], v[112:115]
    v_add_u32 v198, v49, v198
    v_mfma_f32_32x32x16_bf16 v[80:95], a[24:27], v[164:167], v[80:95]
    v_add_u32 v196, 19584, v196
    ds_read_b64 v[184:185], v198 offset:0
    ds_read_b64 v[186:187], v198 offset:64
    ds_read_b64 v[188:189], v196 offset:0
    v_mfma_f32_32x32x16_bf16 v[96:111], a[24:27], v[168:171], v[96:111]
    ds_read_b64 v[190:191], v196 offset:512
    ds_read_b64 v[192:193], v196 offset:256
    ds_read_b64 v[194:195], v196 offset:768
    s_add_u32 m0, s92, 114688
    s_nop 0
    buffer_load_dwordx4 v73, s[16:19], s99 offen offset:0 sc1 lds
    s_waitcnt lgkmcnt(6)
    v_mfma_f32_16x16x32_bf16 v[112:115], a[28:31], v[172:175], v[112:115]
    ds_read_b64 v[160:161], v198 offset:256
    v_mfma_f32_32x32x16_bf16 v[80:95], a[28:31], v[176:179], v[80:95]
    ds_read_b64 v[162:163], v198 offset:320
    ds_read_b64 v[164:165], v196 offset:2048
    ds_read_b64 v[166:167], v196 offset:2560
    v_mfma_f32_32x32x16_bf16 v[96:111], a[28:31], v[180:183], v[96:111]
    ds_read_b64 v[168:169], v196 offset:2304
    ds_read_b64 v[170:171], v196 offset:2816
    buffer_load_dwordx4 v74, s[16:19], s99 offen offset:1024 sc1 lds
    s_waitcnt lgkmcnt(6)
    v_mfma_f32_16x16x32_bf16 v[112:115], a[32:35], v[184:187], v[112:115]
    ds_read_b64 v[172:173], v198 offset:512
    v_mfma_f32_32x32x16_bf16 v[80:95], a[32:35], v[188:191], v[80:95]
    ds_read_b64 v[174:175], v198 offset:576
    ds_read_b64 v[176:177], v196 offset:4096
    ds_read_b64 v[178:179], v196 offset:4608
    v_mfma_f32_32x32x16_bf16 v[96:111], a[32:35], v[192:195], v[96:111]
    ds_read_b64 v[180:181], v196 offset:4352
    ds_read_b64 v[182:183], v196 offset:4864
    buffer_load_dwordx4 v75, s[16:19], s99 offen offset:2048 sc1 lds
    s_waitcnt lgkmcnt(6)
    v_mfma_f32_16x16x32_bf16 v[112:115], a[36:39], v[160:163], v[112:115]
    ds_read_b64 v[184:185], v198 offset:768
    v_mfma_f32_32x32x16_bf16 v[80:95], a[36:39], v[164:167], v[80:95]
    ds_read_b64 v[186:187], v198 offset:832
    ds_read_b64 v[188:189], v196 offset:6144
    ds_read_b64 v[190:191], v196 offset:6656
    v_mfma_f32_32x32x16_bf16 v[96:111], a[36:39], v[168:171], v[96:111]
    ds_read_b64 v[192:193], v196 offset:6400
    ds_read_b64 v[194:195], v196 offset:6912
    buffer_load_dwordx4 v76, s[16:19], s99 offen offset:3072 sc1 lds
    s_waitcnt lgkmcnt(6)
    v_mfma_f32_16x16x32_bf16 v[112:115], a[40:43], v[172:175], v[112:115]
    ds_read_b64 v[160:161], v198 offset:1024
    v_mfma_f32_32x32x16_bf16 v[80:95], a[40:43], v[176:179], v[80:95]
    ds_read_b64 v[162:163], v198 offset:1088
    ds_read_b64 v[164:165], v196 offset:8192
    ds_read_b64 v[166:167], v196 offset:8704
    v_mfma_f32_32x32x16_bf16 v[96:111], a[40:43], v[180:183], v[96:111]
    ds_read_b64 v[168:169], v196 offset:8448
    ds_read_b64 v[170:171], v196 offset:8960
    s_add_u32 m0, s93, 132096
    s_add_u32 s99, s99, 524288
    s_mov_b64 exec, s[80:81]
    buffer_load_dwordx4 v77, s[16:19], s100 offen sc1 lds
    s_mov_b64 exec, -1
    s_add_u32 s100, s100, 524288
    s_waitcnt lgkmcnt(6)
    v_mfma_f32_16x16x32_bf16 v[112:115], a[44:47], v[184:187], v[112:115]
    ds_read_b64 v[172:173], v198 offset:1280
    v_mfma_f32_32x32x16_bf16 v[80:95], a[44:47], v[188:191], v[80:95]
    ds_read_b64 v[174:175], v198 offset:1344
    ds_read_b64 v[176:177], v196 offset:10240
    ds_read_b64 v[178:179], v196 offset:10752
    v_mfma_f32_32x32x16_bf16 v[96:111], a[44:47], v[192:195], v[96:111]
    ds_read_b64 v[180:181], v196 offset:10496
    ds_read_b64 v[182:183], v196 offset:11008
    s_lshl_b32 s25, s72, 5
    s_add_u32 s25, s25, 256
    s_sub_u32 s26, s25, 4
    s_max_i32 s26, s26, 0
    s_lshl_b32 s27, s71, 12
    s_add_u32 s27, s27, 9437184
    s_lshl_b32 s99, s25, 3
    s_lshl_b32 s100, s26, 3
    s_lshl_b32 s92, s24, 12
    s_lshl_b32 s93, s24, 9
    s_add_u32 s99, s99, s27
    s_add_u32 s100, s100, s27
    s_waitcnt lgkmcnt(6)
    v_mfma_f32_16x16x32_bf16 v[112:115], a[48:51], v[160:163], v[112:115]
    ds_read_b64 v[184:185], v198 offset:1536
    v_mfma_f32_32x32x16_bf16 v[80:95], a[48:51], v[164:167], v[80:95]
    ds_read_b64 v[186:187], v198 offset:1600
    ds_read_b64 v[188:189], v196 offset:12288
    ds_read_b64 v[190:191], v196 offset:12800
    v_mfma_f32_32x32x16_bf16 v[96:111], a[48:51], v[168:171], v[96:111]
    ds_read_b64 v[192:193], v196 offset:12544
    ds_read_b64 v[194:195], v196 offset:13056
    s_waitcnt lgkmcnt(6)
    v_mfma_f32_16x16x32_bf16 v[112:115], a[52:55], v[172:175], v[112:115]
    ds_read_b64 v[160:161], v198 offset:1792
    v_mfma_f32_32x32x16_bf16 v[80:95], a[52:55], v[176:179], v[80:95]
    ds_read_b64 v[162:163], v198 offset:1856
    ds_read_b64 v[164:165], v196 offset:14336
    ds_read_b64 v[166:167], v196 offset:14848
    v_mfma_f32_32x32x16_bf16 v[96:111], a[52:55], v[180:183], v[96:111]
    ds_read_b64 v[168:169], v196 offset:14592
    ds_read_b64 v[170:171], v196 offset:15104
    s_waitcnt vmcnt(10)
    v_cmp_gt_u32 vcc, 1, v7
    s_nop 0
    s_and_b64 vcc, vcc, s[50:51]
    s_cbranch_scc1 ps_54
pc_56:
    s_barrier
    s_waitcnt lgkmcnt(6)
    v_mfma_f32_16x16x32_bf16 v[112:115], a[56:59], v[184:187], v[112:115]
    v_add_u32 v198, v49, v198
    v_mfma_f32_32x32x16_bf16 v[80:95], a[56:59], v[188:191], v[80:95]
    v_add_u32 v196, 19584, v196
    ds_read_b64 v[172:173], v198 offset:0
    ds_read_b64 v[174:175], v198 offset:64
    ds_read_b64 v[176:177], v196 offset:0
    v_mfma_f32_32x32x16_bf16 v[96:111], a[56:59], v[192:195], v[96:111]
    ds_read_b64 v[178:179], v196 offset:512
    ds_read_b64 v[180:181], v196 offset:256
    ds_read_b64 v[182:183], v196 offset:768
    s_waitcnt lgkmcnt(6)
    v_mfma_f32_16x16x32_bf16 v[112:115], a[60:63], v[160:163], v[112:115]
    ds_read_b64 v[184:185], v198 offset:256
    v_mfma_f32_32x32x16_bf16 v[80:95], a[60:63], v[164:167], v[80:95]
    ds_read_b64 v[186:187], v198 offset:320
    ds_read_b64 v[188:189], v196 offset:2048
    ds_read_b64 v[190:191], v196 offset:2560
    v_mfma_f32_32x32x16_bf16 v[96:111], a[60:63], v[168:171], v[96:111]
    ds_read_b64 v[192:193], v196 offset:2304
    ds_read_b64 v[194:195], v196 offset:2816
    s_waitcnt lgkmcnt(6)
    v_mfma_f32_16x16x32_bf16 v[112:115], a[64:67], v[172:175], v[112:115]
    ds_read_b64 v[160:161], v198 offset:512
    v_mfma_f32_32x32x16_bf16 v[80:95], a[64:67], v[176:179], v[80:95]
    ds_read_b64 v[162:163], v198 offset:576
    ds_read_b64 v[164:165], v196 offset:4096
    ds_read_b64 v[166:167], v196 offset:4608
    v_mfma_f32_32x32x16_bf16 v[96:111], a[64:67], v[180:183], v[96:111]
    ds_read_b64 v[168:169], v196 offset:4352
    ds_read_b64 v[170:171], v196 offset:4864
    s_waitcnt lgkmcnt(6)
    v_mfma_f32_16x16x32_bf16 v[112:115], a[68:71], v[184:187], v[112:115]
    ds_read_b64 v[172:173], v198 offset:768
    v_mfma_f32_32x32x16_bf16 v[80:95], a[68:71], v[188:191], v[80:95]
    ds_read_b64 v[174:175], v198 offset:832
    ds_read_b64 v[176:177], v196 offset:6144
    ds_read_b64 v[178:179], v196 offset:6656
    v_mfma_f32_32x32x16_bf16 v[96:111], a[68:71], v[192:195], v[96:111]
    ds_read_b64 v[180:181], v196 offset:6400
    ds_read_b64 v[182:183], v196 offset:6912
    s_waitcnt lgkmcnt(6)
    v_mfma_f32_16x16x32_bf16 v[112:115], a[72:75], v[160:163], v[112:115]
    ds_read_b64 v[184:185], v198 offset:1024
    v_mfma_f32_32x32x16_bf16 v[80:95], a[72:75], v[164:167], v[80:95]
    ds_read_b64 v[186:187], v198 offset:1088
    ds_read_b64 v[188:189], v196 offset:8192
    ds_read_b64 v[190:191], v196 offset:8704
    v_mfma_f32_32x32x16_bf16 v[96:111], a[72:75], v[168:171], v[96:111]
    ds_read_b64 v[192:193], v196 offset:8448
    ds_read_b64 v[194:195], v196 offset:8960
    s_waitcnt lgkmcnt(6)
    v_mfma_f32_16x16x32_bf16 v[112:115], a[76:79], v[172:175], v[112:115]
    ds_read_b64 v[160:161], v198 offset:1280
    v_mfma_f32_32x32x16_bf16 v[80:95], a[76:79], v[176:179], v[80:95]
    ds_read_b64 v[162:163], v198 offset:1344
    ds_read_b64 v[164:165], v196 offset:10240
    ds_read_b64 v[166:167], v196 offset:10752
    v_mfma_f32_32x32x16_bf16 v[96:111], a[76:79], v[180:183], v[96:111]
    ds_read_b64 v[168:169], v196 offset:10496
    ds_read_b64 v[170:171], v196 offset:11008
    s_waitcnt lgkmcnt(6)
    v_mfma_f32_16x16x32_bf16 v[112:115], a[80:83], v[184:187], v[112:115]
    ds_read_b64 v[172:173], v198 offset:1536
    v_mfma_f32_32x32x16_bf16 v[80:95], a[80:83], v[188:191], v[80:95]
    ds_read_b64 v[174:175], v198 offset:1600
    ds_read_b64 v[176:177], v196 offset:12288
    ds_read_b64 v[178:179], v196 offset:12800
    v_mfma_f32_32x32x16_bf16 v[96:111], a[80:83], v[192:195], v[96:111]
    ds_read_b64 v[180:181], v196 offset:12544
    ds_read_b64 v[182:183], v196 offset:13056
    s_lshl_b32 s98, s72, 5
    s_add_u32 s98, s98, 0
    s_sub_u32 s95, s98, 4
    s_max_i32 s95, s95, 0
    s_lshl_b32 s94, s98, 3
    s_lshl_b32 s95, s95, 3
    s_add_u32 s94, s94, 3457024
    s_add_u32 s95, s95, 3457024
    s_add_u32 s96, s94, 8192
    buffer_load_dwordx2 v[152:153], v47, s[16:19], s94 offen sc1
    s_waitcnt lgkmcnt(6)
    v_mfma_f32_16x16x32_bf16 v[112:115], a[84:87], v[160:163], v[112:115]
    ds_read_b64 v[184:185], v198 offset:1792
    v_mfma_f32_32x32x16_bf16 v[80:95], a[84:87], v[164:167], v[80:95]
    ds_read_b64 v[186:187], v198 offset:1856
    ds_read_b64 v[188:189], v196 offset:14336
    ds_read_b64 v[190:191], v196 offset:14848
    v_mfma_f32_32x32x16_bf16 v[96:111], a[84:87], v[168:171], v[96:111]
    ds_read_b64 v[192:193], v196 offset:14592
    ds_read_b64 v[194:195], v196 offset:15104
    buffer_load_dwordx2 v[154:155], v47, s[16:19], s96 offen sc1
    s_waitcnt vmcnt(7)
    s_barrier
    s_waitcnt lgkmcnt(6)
    v_mfma_f32_16x16x32_bf16 v[112:115], a[88:91], v[172:175], v[112:115]
    v_add_u32_e64 v198, v49, v198
    v_mfma_f32_32x32x16_bf16 v[80:95], a[88:91], v[176:179], v[80:95]
    v_add_u32 v196, 19584, v196
    ds_read_b64 v[160:161], v198 offset:0
    ds_read_b64 v[162:163], v198 offset:64
    ds_read_b64 v[164:165], v196 offset:0
    v_mfma_f32_32x32x16_bf16 v[96:111], a[88:91], v[180:183], v[96:111]
    ds_read_b64 v[166:167], v196 offset:512
    ds_read_b64 v[168:169], v196 offset:256
    ds_read_b64 v[170:171], v196 offset:768
    buffer_load_dwordx2 v[156:157], v48, s[16:19], s95 offen sc1
    s_waitcnt lgkmcnt(6)
    v_mfma_f32_16x16x32_bf16 v[112:115], a[92:95], v[184:187], v[112:115]
    ds_read_b64 v[172:173], v198 offset:256
    v_mfma_f32_32x32x16_bf16 v[80:95], a[92:95], v[188:191], v[80:95]
    ds_read_b64 v[174:175], v198 offset:320
    ds_read_b64 v[176:177], v196 offset:2048
    ds_read_b64 v[178:179], v196 offset:2560
    v_mfma_f32_32x32x16_bf16 v[96:111], a[92:95], v[192:195], v[96:111]
    ds_read_b64 v[180:181], v196 offset:2304
    ds_read_b64 v[182:183], v196 offset:2816
    buffer_load_dword v7, v4, s[16:19], s89 offen offset:4 sc1
    s_waitcnt lgkmcnt(6)
    v_mfma_f32_16x16x32_bf16 v[112:115], a[96:99], v[160:163], v[112:115]
    ds_read_b64 v[184:185], v198 offset:512
    v_mfma_f32_32x32x16_bf16 v[80:95], a[96:99], v[164:167], v[80:95]
    ds_read_b64 v[186:187], v198 offset:576
    ds_read_b64 v[188:189], v196 offset:4096
    ds_read_b64 v[190:191], v196 offset:4608
    v_mfma_f32_32x32x16_bf16 v[96:111], a[96:99], v[168:171], v[96:111]
    ds_read_b64 v[192:193], v196 offset:4352
    ds_read_b64 v[194:195], v196 offset:4864
    s_waitcnt lgkmcnt(6)
    v_mfma_f32_16x16x32_bf16 v[112:115], a[100:103], v[172:175], v[112:115]
    ds_read_b64 v[160:161], v198 offset:768
    v_mfma_f32_32x32x16_bf16 v[80:95], a[100:103], v[176:179], v[80:95]
    ds_read_b64 v[162:163], v198 offset:832
    ds_read_b64 v[164:165], v196 offset:6144
    ds_read_b64 v[166:167], v196 offset:6656
    v_mfma_f32_32x32x16_bf16 v[96:111], a[100:103], v[180:183], v[96:111]
    ds_read_b64 v[168:169], v196 offset:6400
    ds_read_b64 v[170:171], v196 offset:6912
    s_waitcnt lgkmcnt(6)
    v_mfma_f32_16x16x32_bf16 v[112:115], a[104:107], v[184:187], v[112:115]
    ds_read_b64 v[172:173], v198 offset:1024
    v_mfma_f32_32x32x16_bf16 v[80:95], a[104:107], v[188:191], v[80:95]
    ds_read_b64 v[174:175], v198 offset:1088
    ds_read_b64 v[176:177], v196 offset:8192
    ds_read_b64 v[178:179], v196 offset:8704
    v_mfma_f32_32x32x16_bf16 v[96:111], a[104:107], v[192:195], v[96:111]
    ds_read_b64 v[180:181], v196 offset:8448
    ds_read_b64 v[182:183], v196 offset:8960
    s_waitcnt lgkmcnt(6)
    v_mfma_f32_16x16x32_bf16 v[112:115], a[108:111], v[160:163], v[112:115]
    ds_read_b64 v[184:185], v198 offset:1280
    v_mfma_f32_32x32x16_bf16 v[80:95], a[108:111], v[164:167], v[80:95]
    ds_read_b64 v[186:187], v198 offset:1344
    ds_read_b64 v[188:189], v196 offset:10240
    ds_read_b64 v[190:191], v196 offset:10752
    v_mfma_f32_32x32x16_bf16 v[96:111], a[108:111], v[168:171], v[96:111]
    ds_read_b64 v[192:193], v196 offset:10496
    ds_read_b64 v[194:195], v196 offset:11008
    s_waitcnt lgkmcnt(6)
    v_mfma_f32_16x16x32_bf16 v[112:115], a[112:115], v[172:175], v[112:115]
    ds_read_b64 v[160:161], v198 offset:1536
    v_mfma_f32_32x32x16_bf16 v[80:95], a[112:115], v[176:179], v[80:95]
    ds_read_b64 v[162:163], v198 offset:1600
    ds_read_b64 v[164:165], v196 offset:12288
    ds_read_b64 v[166:167], v196 offset:12800
    v_mfma_f32_32x32x16_bf16 v[96:111], a[112:115], v[180:183], v[96:111]
    ds_read_b64 v[168:169], v196 offset:12544
    ds_read_b64 v[170:171], v196 offset:13056
    s_waitcnt lgkmcnt(6)
    v_mfma_f32_16x16x32_bf16 v[112:115], a[116:119], v[184:187], v[112:115]
    ds_read_b64 v[172:173], v198 offset:1792
    v_mfma_f32_32x32x16_bf16 v[80:95], a[116:119], v[188:191], v[80:95]
    ds_read_b64 v[174:175], v198 offset:1856
    ds_read_b64 v[176:177], v196 offset:14336
    ds_read_b64 v[178:179], v196 offset:14848
    v_mfma_f32_32x32x16_bf16 v[96:111], a[116:119], v[192:195], v[96:111]
    ds_read_b64 v[180:181], v196 offset:14592
    ds_read_b64 v[182:183], v196 offset:15104
sl_57:
    s_waitcnt vmcnt(2)
    v_max3_u32 v2, v152, v153, v154
    s_waitcnt vmcnt(1)
    v_max3_u32 v2, v2, v155, v156
    v_max_u32 v2, v2, v157
    v_cmp_eq_u32 vcc, -1, v2
    s_nop 0
    s_cbranch_vccnz rd_58
rc_59:
    s_waitcnt vmcnt(0)
    v_cmp_gt_u32 vcc, 1, v7
    s_nop 0
    s_and_b64 vcc, vcc, s[50:51]
    s_cbranch_scc1 ps_60
pc_62:
    s_barrier
    s_waitcnt lgkmcnt(6)
    v_mfma_f32_16x16x32_bf16 v[112:115], a[120:123], v[160:163], v[112:115]
    v_add_u32_e64 v198, v49, v198
    v_mfma_f32_32x32x16_bf16 v[80:95], a[120:123], v[164:167], v[80:95]
    v_add_u32 v196, 19584, v196
    ds_read_b64 v[184:185], v198 offset:0
    ds_read_b64 v[186:187], v198 offset:64
    v_mul_f32 v148, v24, v157
    v_mul_f32 v149, v25, v157
    v_mfma_f32_32x32x16_bf16 v[96:111], a[120:123], v[168:171], v[96:111]
    ds_read_b64 v[188:189], v196 offset:0
    ds_read_b64 v[190:191], v196 offset:512
    s_sub_u32 s3, s2, 160
    s_and_b32 s3, s3, 63
    s_add_u32 s3, s3, 64
    s_and_b32 s25, s3, 3
    s_lshl_b32 s25, s25, 12
    s_lshr_b32 s26, s3, 2
    s_lshl_b32 s26, s26, 7
    s_add_u32 s3, s25, s26
    v_lshrrev_b32 v236, 3, v0
    v_and_b32 v237, 7, v0
    v_lshlrev_b32 v237, 4, v237
    v_lshl_add_u32 v236, v236, 14, v237
    s_sub_u32 s25, s2, 160
    s_cmp_lt_u32 s25, 64
    s_cselect_b32 s25, 0, 1073741824
    v_add_u32_e64 v236, s25, v236
    s_add_u32 s26, s3, 9437184
    buffer_load_dwordx4 v[216:219], v236, s[16:19], s26 offen sc1
    v_mul_f32 v150, v26, v157
    v_mul_f32_e64 v151, v27, v157
    s_waitcnt lgkmcnt(4)
    v_mfma_f32_16x16x32_bf16 v[112:115], a[124:127], v[172:175], v[112:115]
    ds_read_b64 v[192:193], v198 offset:256
    v_mfma_f32_32x32x16_bf16 v[80:95], a[124:127], v[176:179], v[80:95]
    ds_read_b64 v[194:195], v198 offset:320
    ds_read_b64 v[160:161], v196 offset:2048
    v_mul_f32 v116, v8, v153
    v_mul_f32 v117, v9, v153
    v_mul_f32_e64 v118, v10, v153
    v_mfma_f32_32x32x16_bf16 v[96:111], a[124:127], v[180:183], v[96:111]
    ds_read_b64 v[162:163], v196 offset:2560
    s_add_u32 s26, s26, 524288
    buffer_load_dwordx4 v[220:223], v236, s[16:19], s26 offen sc1
    v_mul_f32 v119, v11, v153
    v_mul_f32_e64 v120, v12, v153
    s_waitcnt lgkmcnt(4)
    v_mfma_f32_16x16x32_bf16 v[112:115], a[128:131], v[184:187], v[112:115]
    ds_read_b64 v[164:165], v198 offset:512
    v_mfma_f32_32x32x16_bf16 v[80:95], a[128:131], v[188:191], v[80:95]
    ds_read_b64 v[166:167], v198 offset:576
    ds_read_b64 v[168:169], v196 offset:4096
    ds_read_b64 v[170:171], v196 offset:4608
    v_mul_f32 v121, v13, v153
    v_mul_f32_e64 v122, v14, v153
    s_waitcnt lgkmcnt(4)
    v_mfma_f32_16x16x32_bf16 v[112:115], a[132:135], v[192:195], v[112:115]
    ds_read_b64 v[172:173], v198 offset:768
    v_mfma_f32_32x32x16_bf16 v[80:95], a[132:135], v[160:163], v[80:95]
    ds_read_b64 v[174:175], v198 offset:832
    ds_read_b64 v[176:177], v196 offset:6144
    ds_read_b64 v[178:179], v196 offset:6656
    s_add_u32 s26, s26, 524288
    buffer_load_dwordx4 v[224:227], v236, s[16:19], s26 offen sc1
    v_mul_f32 v123, v15, v153
    v_mul_f32_e64 v124, v16, v153
    s_waitcnt lgkmcnt(4)
    v_mfma_f32_16x16x32_bf16 v[112:115], a[136:139], v[164:167], v[112:115]
    ds_read_b64 v[180:181], v198 offset:1024
    v_mfma_f32_32x32x16_bf16 v[80:95], a[136:139], v[168:171], v[80:95]
    ds_read_b64 v[182:183], v198 offset:1088
    ds_read_b64 v[184:185], v196 offset:8192
    ds_read_b64 v[186:187], v196 offset:8704
    v_mul_f32 v125, v17, v153
    v_mul_f32_e64 v126, v18, v153
    s_waitcnt lgkmcnt(4)
    v_mfma_f32_16x16x32_bf16 v[112:115], a[140:143], v[172:175], v[112:115]
    ds_read_b64 v[188:189], v198 offset:1280
    v_mfma_f32_32x32x16_bf16 v[80:95], a[140:143], v[176:179], v[80:95]
    ds_read_b64 v[190:191], v198 offset:1344
    ds_read_b64 v[192:193], v196 offset:10240
    ds_read_b64 v[194:195], v196 offset:10752
    s_add_u32 s26, s26, 524288
    buffer_load_dwordx4 v[228:231], v236, s[16:19], s26 offen sc1
    v_mul_f32 v127, v19, v153
    v_mul_f32_e64 v128, v20, v153
    s_waitcnt lgkmcnt(4)
    v_mfma_f32_16x16x32_bf16 v[112:115], a[144:147], v[180:183], v[112:115]
    ds_read_b64 v[160:161], v198 offset:1536
    v_mfma_f32_32x32x16_bf16 v[80:95], a[144:147], v[184:187], v[80:95]
    ds_read_b64 v[162:163], v198 offset:1600
    ds_read_b64 v[164:165], v196 offset:12288
    ds_read_b64 v[166:167], v196 offset:12800
    v_mul_f32 v129, v21, v153
    v_mul_f32_e64 v130, v22, v153
    s_waitcnt lgkmcnt(4)
    v_mfma_f32_16x16x32_bf16 v[112:115], a[148:151], v[188:191], v[112:115]
    ds_read_b64 v[168:169], v198 offset:1792
    v_mfma_f32_32x32x16_bf16 v[80:95], a[148:151], v[192:195], v[80:95]
    ds_read_b64 v[170:171], v198 offset:1856
    ds_read_b64 v[172:173], v196 offset:14336
    ds_read_b64 v[174:175], v196 offset:14848
    s_add_u32 s26, s26, 524288
    buffer_load_dwordx4 v[232:235], v236, s[16:19], s26 offen sc1
    v_mul_f32 v131, v23, v153
    v_mul_f32_e64 v132, v8, v155
    s_waitcnt lgkmcnt(4)
    v_mfma_f32_16x16x32_bf16 v[112:115], a[152:155], v[160:163], v[112:115]
    ds_read_b64 v[176:177], v196 offset:256
    v_mfma_f32_32x32x16_bf16 v[80:95], a[152:155], v[164:167], v[80:95]
    ds_read_b64 v[178:179], v196 offset:768
    ds_read_b64 v[180:181], v196 offset:2304
    ds_read_b64 v[182:183], v196 offset:2816
    v_mul_f32 v133, v9, v155
    v_mul_f32_e64 v134, v10, v155
    s_waitcnt lgkmcnt(4)
    v_mfma_f32_16x16x32_bf16 v[112:115], a[156:159], v[168:171], v[112:115]
    ds_read_b64 v[184:185], v196 offset:4352
    v_mfma_f32_32x32x16_bf16 v[80:95], a[156:159], v[172:175], v[80:95]
    ds_read_b64 v[186:187], v196 offset:4864
    ds_read_b64 v[188:189], v196 offset:6400
    ds_read_b64 v[190:191], v196 offset:6912
    s_add_u32 m0, s92, 36352
    s_nop 0
    buffer_load_dwordx4 v73, s[16:19], s99 offen offset:0 sc1 lds
    v_mul_f32 v135, v11, v155
    v_mul_f32 v136, v12, v155
    v_mul_f32 v137, v13, v155
    v_mul_f32 v138, v14, v155
    v_mul_f32 v139, v15, v155
    v_mul_f32 v140, v16, v155
    v_mul_f32 v141, v17, v155
    v_mul_f32 v142, v18, v155
    v_mul_f32 v143, v19, v155
    v_mul_f32 v144, v20, v155
    v_mul_f32 v145, v21, v155
    v_mul_f32 v146, v22, v155
    v_mul_f32_e64 v147, v23, v155
    s_waitcnt lgkmcnt(4)
    v_mfma_f32_32x32x16_bf16 v[96:111], a[128:131], v[176:179], v[96:111]
    ds_read_b64 v[192:193], v196 offset:8448
    ds_read_b64 v[194:195], v196 offset:8960
    v_mfma_f32_32x32x16_bf16 v[96:111], a[132:135], v[180:183], v[96:111]
    ds_read_b64 v[160:161], v196 offset:10496
    ds_read_b64 v[162:163], v196 offset:11008
    buffer_load_dwordx4 v74, s[16:19], s99 offen offset:1024 sc1 lds
    v_fma_f32 v112, v112, v156, v148
    v_fma_f32 v113, v113, v156, v149
    s_waitcnt lgkmcnt(4)
    v_mfma_f32_32x32x16_bf16 v[96:111], a[136:139], v[184:187], v[96:111]
    ds_read_b64 v[164:165], v196 offset:12544
    ds_read_b64 v[166:167], v196 offset:13056
    v_fma_f32 v114, v114, v156, v150
    v_fma_f32 v115, v115, v156, v151
    v_cvt_pk_bf16_f32 v112, v112, v113
    v_mfma_f32_32x32x16_bf16 v[96:111], a[140:143], v[188:191], v[96:111]
    ds_read_b64 v[168:169], v196 offset:14592
    ds_read_b64 v[170:171], v196 offset:15104
    buffer_load_dwordx4 v75, s[16:19], s99 offen offset:2048 sc1 lds
    v_cvt_pk_bf16_f32 v113, v114, v115
    v_fma_f32 v80, v80, v152, v116
    s_waitcnt lgkmcnt(4)
    v_mfma_f32_32x32x16_bf16 v[96:111], a[144:147], v[192:195], v[96:111]
    v_fma_f32 v81, v81, v152, v117
    v_fma_f32 v82, v82, v152, v118
    v_fma_f32 v83, v83, v152, v119
    v_cvt_pk_bf16_f32 v80, v80, v81
    v_cvt_pk_bf16_f32 v81, v82, v83
    v_mfma_f32_32x32x16_bf16 v[96:111], a[148:151], v[160:163], v[96:111]
    ds_write_b64 v40, v[112:113] offset:0
    ds_write_b64 v38, v[80:81] offset:0
    v_fma_f32 v84, v84, v152, v120
    v_fma_f32 v85, v85, v152, v121
    s_waitcnt lgkmcnt(2)
    v_mfma_f32_32x32x16_bf16 v[96:111], a[152:155], v[164:167], v[96:111]
    v_fma_f32 v86, v86, v152, v122
    v_fma_f32 v87, v87, v152, v123
    v_cvt_pk_bf16_f32 v84, v84, v85
    v_cvt_pk_bf16_f32 v85, v86, v87
    v_fma_f32 v88, v88, v152, v124
    v_mfma_f32_32x32x16_bf16 v[96:111], a[156:159], v[168:171], v[96:111]
    buffer_load_dwordx4 v76, s[16:19], s99 offen offset:3072 sc1 lds
    v_fma_f32 v89, v89, v152, v125
    v_fma_f32 v90, v90, v152, v126
    v_fma_f32 v91, v91, v152, v127
    v_cvt_pk_bf16_f32 v88, v88, v89
    v_cvt_pk_bf16_f32 v89, v90, v91
    ds_write_b64 v38, v[84:85] offset:6400
    ds_write_b64 v38, v[88:89] offset:12800
    v_fma_f32 v92, v92, v152, v128
    v_fma_f32 v93, v93, v152, v129
    v_fma_f32 v94, v94, v152, v130
    v_fma_f32 v95, v95, v152, v131
    v_cvt_pk_bf16_f32 v92, v92, v93
    v_cvt_pk_bf16_f32 v93, v94, v95
    ds_write_b64 v39, v[92:93] offset:0
    v_pk_fma_f32 v[96:97], v[96:97], v[154:155], v[132:133] op_sel_hi:[1,0,1]
    v_pk_fma_f32 v[98:99], v[98:99], v[154:155], v[134:135] op_sel_hi:[1,0,1]
    v_cvt_pk_bf16_f32 v96, v96, v97
    v_cvt_pk_bf16_f32 v97, v98, v99
    v_pk_fma_f32 v[100:101], v[100:101], v[154:155], v[136:137] op_sel_hi:[1,0,1]
    v_pk_fma_f32 v[102:103], v[102:103], v[154:155], v[138:139] op_sel_hi:[1,0,1]
    v_cvt_pk_bf16_f32 v100, v100, v101
    v_cvt_pk_bf16_f32 v101, v102, v103
    ds_write_b64 v38, v[96:97] offset:1600
    ds_write_b64 v38, v[100:101] offset:8000
    v_pk_fma_f32 v[104:105], v[104:105], v[154:155], v[140:141] op_sel_hi:[1,0,1]
    v_pk_fma_f32 v[106:107], v[106:107], v[154:155], v[142:143] op_sel_hi:[1,0,1]
    v_cvt_pk_bf16_f32 v104, v104, v105
    v_cvt_pk_bf16_f32 v105, v106, v107
    v_pk_fma_f32 v[108:109], v[108:109], v[154:155], v[144:145] op_sel_hi:[1,0,1]
    v_pk_fma_f32 v[110:111], v[110:111], v[154:155], v[146:147] op_sel_hi:[1,0,1]
    v_cvt_pk_bf16_f32 v108, v108, v109
    v_cvt_pk_bf16_f32 v109, v110, v111
    ds_write_b64 v38, v[104:105] offset:14400
    ds_write_b64 v39, v[108:109] offset:1600
    v_cmp_u_f32 vcc, v82, v114
    v_cmp_u_f32 s[82:83], v98, v98
    s_lshl_b32 s25, s24, 2
    s_add_u32 s25, s25, 161280
    s_or_b64 vcc, vcc, s[82:83]
    s_cselect_b32 s26, 1, 0
    v_mov_b32 v196, s25
    v_mov_b32 v197, s26
    ds_write_b32 v196, v197
    s_waitcnt lgkmcnt(0)
    s_barrier
    s_sub_u32 s85, s2, 160
    s_cmp_ge_u32 s85, 64
    s_cbranch_scc1 s2_63
    v_mov_b32 v238, 0x3f803f80
    s_lshl_b32 s25, s24, 7
    s_add_u32 s25, s25, 134272
    v_lshrrev_b32 v239, 4, v1
    v_lshl_add_u32 v237, v239, 2, v237
    v_add_u32 v237, s25, v237
se_64:
    v_mov_b32 v240, 0
    v_mov_b32 v241, 0
    v_mov_b32 v242, 0
    v_mov_b32 v243, 0
    s_waitcnt vmcnt(8)
    v_dot2c_f32_bf16 v240, v216, v238
    v_dot2c_f32_bf16 v241, v216, v216
    v_dot2c_f32_bf16 v240, v217, v238
    v_dot2c_f32_bf16 v241, v217, v217
    v_dot2c_f32_bf16 v242, v218, v238
    v_dot2c_f32_bf16 v243, v218, v218
    v_dot2c_f32_bf16 v242, v219, v238
    v_dot2c_f32_bf16 v243, v219, v219
    s_waitcnt vmcnt(7)
    v_dot2c_f32_bf16 v240, v220, v238
    v_dot2c_f32_bf16 v241, v220, v220
    v_dot2c_f32_bf16 v240, v221, v238
    v_dot2c_f32_bf16 v241, v221, v221
    v_dot2c_f32_bf16 v242, v222, v238
    v_dot2c_f32_bf16 v243, v222, v222
    v_dot2c_f32_bf16 v242, v223, v238
    v_dot2c_f32_bf16 v243, v223, v223
    s_waitcnt vmcnt(6)
    v_dot2c_f32_bf16 v240, v224, v238
    v_dot2c_f32_bf16 v241, v224, v224
    v_dot2c_f32_bf16 v240, v225, v238
    v_dot2c_f32_bf16 v241, v225, v225
    v_dot2c_f32_bf16 v242, v226, v238
    v_dot2c_f32_bf16 v243, v226, v226
    v_dot2c_f32_bf16 v242, v227, v238
    v_dot2c_f32_bf16 v243, v227, v227
    s_waitcnt vmcnt(5)
    v_dot2c_f32_bf16 v240, v228, v238
    v_dot2c_f32_bf16 v241, v228, v228
    v_dot2c_f32_bf16 v240, v229, v238
    v_dot2c_f32_bf16 v241, v229, v229
    v_dot2c_f32_bf16 v242, v230, v238
    v_dot2c_f32_bf16 v243, v230, v230
    v_dot2c_f32_bf16 v242, v231, v238
    v_dot2c_f32_bf16 v243, v231, v231
    s_waitcnt vmcnt(4)
    v_dot2c_f32_bf16 v240, v232, v238
    v_dot2c_f32_bf16 v241, v232, v232
    v_dot2c_f32_bf16 v240, v233, v238
    v_dot2c_f32_bf16 v241, v233, v233
    v_dot2c_f32_bf16 v242, v234, v238
    v_dot2c_f32_bf16 v243, v234, v234
    v_dot2c_f32_bf16 v242, v235, v238
    v_dot2c_f32_bf16 v243, v235, v235
    s_nop 2
    v_cmp_u_f32 vcc, v241, v243
    s_nop 0
    s_cbranch_vccnz rd_65
rc_66:
    v_permlane32_swap_b32 v240, v242
    v_permlane32_swap_b32 v241, v243
    v_pk_add_f32 v[240:241], v[240:241], v[242:243]
    s_nop 1
    v_permlane16_swap_b32 v240, v241
    v_add_f32_e64 v240, v240, v241
    s_nop 1
    v_add_f32_dpp v240, v240, v240 row_ror:8 row_mask:0xf bank_mask:0xf
    ds_write_b32 v237, v240
    v_and_b32 v236, 15, v0
    v_lshlrev_b32 v236, 3, v236
    v_add_u32 v237, 134272, v236
    v_mov_b32 v239, 1073741824
    v_cmp_gt_u32 vcc, 16, v0
    s_nop 1
    v_cndmask_b32 v236, v239, v236, vcc
    s_add_u32 s25, s3, 3457024
    s_waitcnt lgkmcnt(0)
    s_barrier
    ds_read_b64 v[216:217], v237 offset:0
    ds_read_b64 v[218:219], v237 offset:128
    ds_read_b64 v[220:221], v237 offset:256
    ds_read_b64 v[222:223], v237 offset:384
    s_waitcnt lgkmcnt(2)
    v_pk_add_f32 v[216:217], v[216:217], v[218:219]
    s_waitcnt lgkmcnt(0)
    v_pk_add_f32 v[220:221], v[220:221], v[222:223]
    v_pk_add_f32 v[216:217], v[216:217], v[220:221]
    v_mul_f32 v239, 0x3acccccd, v216
    v_mul_f32 v217, 0x3acccccd, v217
    v_fma_f32 v217, -v239, v239, v217
    v_max_f32 v217, 0, v217
    v_add_f32 v217, 0x3727c5ac, v217
    v_rsq_f32_e64 v216, v217
    s_nop 0
    v_mul_f32 v217, -v239, v216
    buffer_store_dwordx2 v[216:217], v236, s[16:19], s25 offen sc1
s2_63:
    v_mov_b32 v158, 161280
    ds_read_b128 v[128:131], v158
    v_mov_b32 v94, 0
    v_mov_b32 v95, 0
    v_mov_b32 v98, 0
    v_mov_b32 v99, 0
    s_mov_b64 exec, 0xffff
    ds_read_b64 v[94:95], v42 offset:320
    ds_read_b64 v[98:99], v42 offset:640
    s_mov_b64 exec, -1
    s_nop 0
    ds_read_b64 v[92:93], v41 offset:320
    ds_read_b64 v[96:97], v41 offset:640
    ds_read_b64 v[84:85], v41 offset:6720
    ds_read_b64 v[86:87], v42 offset:6720
    ds_read_b64 v[80:81], v41 offset:6400
    ds_read_b64 v[82:83], v42 offset:6400
    ds_read_b64 v[88:89], v41 offset:7040
    ds_read_b64 v[90:91], v42 offset:7040
    ds_read_b64_tr_b16 v[106:107], v44 offset:0
    ds_read_b64_tr_b16 v[100:101], v43 offset:0
    s_add_u32 m0, s93, 53760
    s_add_u32 s99, s99, 524288
    s_mov_b64 exec, s[80:81]
    buffer_load_dwordx4 v77, s[16:19], s100 offen sc1 lds
    s_mov_b64 exec, -1
    s_add_u32 s100, s100, 524288
    ds_read_b64_tr_b16 v[108:109], v44 offset:320
    ds_read_b64_tr_b16 v[102:103], v43 offset:320
    ds_read_b64_tr_b16 v[110:111], v44 offset:640
    ds_read_b64_tr_b16 v[104:105], v43 offset:640
    v_mov_b32 v156, 0xf149f2ca
    v_cndmask_b32 v152, v32, v156, s[90:91]
    v_cndmask_b32 v153, v33, v156, s[90:91]
    v_cndmask_b32 v154, v34, v156, s[90:91]
    s_add_u32 m0, s92, 55936
    s_nop 0
    buffer_load_dwordx4 v73, s[16:19], s99 offen offset:0 sc1 lds
    v_cndmask_b32 v155, v35, v156, s[90:91]
    s_mov_b32 s82, 0x3ea52b5c
    s_lshl_b32 s25, s98, 4
    s_add_u32 s25, s25, 12058624
    s_lshl_b32 s26, s98, 3
    s_add_u32 s26, s26, 12058624
    s_waitcnt lgkmcnt(15)
    v_or3_b32 v128, v128, v129, v130
    v_or_b32 v128, v128, v131
    buffer_load_dwordx4 v74, s[16:19], s99 offen offset:1024 sc1 lds
    v_cmp_ne_u32_e64 vcc, 0, v128
    s_nop 0
    s_cbranch_vccnz rd_67
rc_68:
    s_waitcnt lgkmcnt(10)
    v_mfma_f32_16x16x32_bf16 v[116:119], v[84:87], v[92:95], v[28:31]
    v_mfma_f32_16x16x32_bf16 v[120:123], v[84:87], v[96:99], v[32:35]
    s_waitcnt lgkmcnt(8)
    v_mfma_f32_16x16x32_bf16 v[112:115], v[80:83], v[92:95], v[152:155]
    s_waitcnt lgkmcnt(6)
    v_mfma_f32_16x16x32_bf16 v[124:127], v[88:91], v[96:99], v[28:31]
    s_nop 5
    v_max_f32 v112, v112, v116
    v_max_f32 v113, v113, v117
    v_max_f32 v114, v114, v118
    buffer_load_dwordx4 v75, s[16:19], s99 offen offset:2048 sc1 lds
    v_max_f32 v115, v115, v119
    v_max3_f32 v156, v112, v113, v114
    v_max_f32 v156, v156, v115
    v_max_f32 v120, v120, v124
    v_max_f32 v121, v121, v125
    v_max_f32 v122, v122, v126
    v_max_f32 v123, v123, v127
    v_max3_f32 v157, v120, v121, v122
    buffer_load_dwordx4 v76, s[16:19], s99 offen offset:3072 sc1 lds
    v_max_f32 v157, v157, v123
    s_nop 1
    v_permlane16_swap_b32 v156, v157
    v_max_f32 v156, v156, v157
    v_mov_b32 v157, v156
    s_nop 1
    v_permlane32_swap_b32 v156, v157
    v_max_f32 v156, v156, v157
    v_mul_f32 v156, s82, v156
    v_mov_b32 v157, v156
    s_add_u32 m0, s93, 73344
    s_add_u32 s99, s99, 524288
    s_mov_b64 exec, s[80:81]
    buffer_load_dwordx4 v77, s[16:19], s100 offen sc1 lds
    s_mov_b64 exec, -1
    s_add_u32 s100, s100, 524288
    v_permlane16_swap_b32_e64 v156, v157
    v_fma_f32 v112, v112, s82, -v156
    v_fma_f32 v113, v113, s82, -v156
    v_fma_f32 v114, v114, s82, -v156
    v_fma_f32 v115, v115, s82, -v156
    v_exp_f32 v112, v112
    v_exp_f32 v113, v113
    v_exp_f32 v114, v114
    s_add_u32 m0, s92, 75520
    s_nop 0
    buffer_load_dwordx4 v73, s[16:19], s99 offen offset:0 sc1 lds
    v_exp_f32_e64 v115, v115
    v_cvt_pk_bf16_f32 v116, v112, v113
    v_cvt_pk_bf16_f32 v117, v114, v115
    v_bfi_b32 v128, v36, 0, v116
    v_and_b32 v130, v36, v116
    v_bfi_b32 v129, v37, 0, v117
    v_and_b32 v131, v37, v117
    s_waitcnt lgkmcnt(3)
    s_nop 0
    v_mfma_f32_16x16x32_bf16 v[144:147], v[106:109], v[128:131], 0
    buffer_load_dwordx4 v74, s[16:19], s99 offen offset:1024 sc1 lds
    s_waitcnt lgkmcnt(2)
    v_mfma_f32_16x16x32_bf16 v[136:139], v[100:103], v[128:131], 0
    v_fma_f32 v120, v120, s82, -v157
    v_fma_f32 v121, v121, s82, -v157
    v_fma_f32 v122, v122, s82, -v157
    v_fma_f32 v123, v123, s82, -v157
    v_exp_f32 v120, v120
    v_exp_f32 v121, v121
    v_exp_f32 v122, v122
    buffer_load_dwordx4 v75, s[16:19], s99 offen offset:2048 sc1 lds
    v_exp_f32_e64 v123, v123
    v_cvt_pk_bf16_f32 v124, v120, v121
    v_cvt_pk_bf16_f32 v125, v122, v123
    v_bfi_b32 v132, v36, 0, v124
    v_and_b32 v134, v36, v124
    v_bfi_b32 v133, v37, 0, v125
    v_and_b32 v135, v37, v125
    s_waitcnt lgkmcnt(1)
    s_nop 0
    v_mfma_f32_16x16x32_bf16 v[148:151], v[108:111], v[132:135], 0
    buffer_load_dwordx4 v76, s[16:19], s99 offen offset:3072 sc1 lds
    s_waitcnt lgkmcnt(0)
    v_mfma_f32_16x16x32_bf16 v[140:143], v[102:105], v[132:135], 0
    v_mov_b32 v158, v144
    s_nop 1
    v_permlane16_swap_b32 v144, v158
    v_rcp_f32 v158, v158
    s_nop 0
    v_pk_mul_f32 v[136:137], v[136:137], v[158:159] op_sel_hi:[1,0]
    v_pk_mul_f32 v[138:139], v[138:139], v[158:159] op_sel_hi:[1,0]
    v_pk_mul_f32 v[144:145], v[144:145], v[158:159] op_sel_hi:[1,0]
    v_pk_mul_f32 v[146:147], v[146:147], v[158:159] op_sel_hi:[1,0]
    s_add_u32 m0, s93, 92928
    s_add_u32 s99, s99, 524288
    s_mov_b64 exec, s[80:81]
    buffer_load_dwordx4 v77, s[16:19], s100 offen sc1 lds
    s_mov_b64 exec, -1
    s_add_u32 s100, s100, 524288
    v_cvt_pk_bf16_f32 v112, v136, v137
    v_cvt_pk_bf16_f32 v116, v144, v145
    v_cvt_pk_bf16_f32 v113, v138, v139
    v_cvt_pk_bf16_f32 v117, v146, v147
    v_mov_b32 v160, v148
    s_nop 1
    v_permlane16_swap_b32 v148, v160
    v_rcp_f32_e64 v160, v160
    s_nop 0
    v_pk_mul_f32 v[140:141], v[140:141], v[160:161] op_sel_hi:[1,0]
    v_pk_mul_f32 v[142:143], v[142:143], v[160:161] op_sel_hi:[1,0]
    v_pk_mul_f32 v[148:149], v[148:149], v[160:161] op_sel_hi:[1,0]
    v_pk_mul_f32 v[150:151], v[150:151], v[160:161] op_sel_hi:[1,0]
    v_cvt_pk_bf16_f32 v114, v140, v141
    v_cvt_pk_bf16_f32 v118, v148, v149
    v_cvt_pk_bf16_f32 v115, v142, v143
    v_cvt_pk_bf16_f32 v119, v150, v151
    v_permlane16_swap_b32 v112, v114
    v_permlane16_swap_b32 v113, v115
    v_permlane16_swap_b32 v116, v118
    v_permlane16_swap_b32 v117, v119
    buffer_store_dwordx4 v[112:115], v45, s[16:19], s25 offen sc1
    s_mov_b64 exec, s[80:81]
    buffer_store_dwordx2 v[116:117], v46, s[16:19], s26 offen sc1
    s_mov_b64 exec, -1
ge_69:
    v_add_u32 v196, 36352, v78
    v_mov_b32_e64 v198, v79
    s_waitcnt vmcnt(12)
    s_barrier
    ds_read_b64 v[160:161], v198 offset:0
    ds_read_b64 v[162:163], v198 offset:64
    ds_read_b64 v[164:165], v196 offset:0
    ds_read_b64 v[166:167], v196 offset:512
    ds_read_b64 v[168:169], v196 offset:256
    ds_read_b64 v[170:171], v196 offset:768
    ds_read_b64 v[172:173], v198 offset:256
    ds_read_b64 v[174:175], v198 offset:320
    ds_read_b64 v[176:177], v196 offset:2048
    ds_read_b64 v[178:179], v196 offset:2560
    ds_read_b64 v[180:181], v196 offset:2304
    ds_read_b64 v[182:183], v196 offset:2816
    s_waitcnt lgkmcnt(6)
    v_mfma_f32_16x16x32_bf16 v[112:115], a[0:3], v[160:163], 0
    ds_read_b64 v[184:185], v198 offset:512
    v_mfma_f32_32x32x16_bf16 v[80:95], a[0:3], v[164:167], 0
    ds_read_b64 v[186:187], v198 offset:576
    ds_read_b64 v[188:189], v196 offset:4096
    ds_read_b64 v[190:191], v196 offset:4608
    v_mfma_f32_32x32x16_bf16 v[96:111], a[0:3], v[168:171], 0
    ds_read_b64 v[192:193], v196 offset:4352
    ds_read_b64 v[194:195], v196 offset:4864
    s_add_u32 m0, s92, 95104
    s_nop 0
    buffer_load_dwordx4 v73, s[16:19], s99 offen offset:0 sc1 lds
    s_waitcnt lgkmcnt(6)
    v_mfma_f32_16x16x32_bf16 v[112:115], a[4:7], v[172:175], v[112:115]
    ds_read_b64 v[160:161], v198 offset:768
    v_mfma_f32_32x32x16_bf16 v[80:95], a[4:7], v[176:179], v[80:95]
    ds_read_b64 v[162:163], v198 offset:832
    ds_read_b64 v[164:165], v196 offset:6144
    ds_read_b64 v[166:167], v196 offset:6656
    v_mfma_f32_32x32x16_bf16 v[96:111], a[4:7], v[180:183], v[96:111]
    ds_read_b64 v[168:169], v196 offset:6400
    ds_read_b64 v[170:171], v196 offset:6912
    buffer_load_dwordx4 v74, s[16:19], s99 offen offset:1024 sc1 lds
    s_waitcnt lgkmcnt(6)
    v_mfma_f32_16x16x32_bf16 v[112:115], a[8:11], v[184:187], v[112:115]
    ds_read_b64 v[172:173], v198 offset:1024
    v_mfma_f32_32x32x16_bf16 v[80:95], a[8:11], v[188:191], v[80:95]
    ds_read_b64 v[174:175], v198 offset:1088
    ds_read_b64 v[176:177], v196 offset:8192
    ds_read_b64 v[178:179], v196 offset:8704
    v_mfma_f32_32x32x16_bf16 v[96:111], a[8:11], v[192:195], v[96:111]
    ds_read_b64 v[180:181], v196 offset:8448
    ds_read_b64 v[182:183], v196 offset:8960
    buffer_load_dwordx4 v75, s[16:19], s99 offen offset:2048 sc1 lds
    s_waitcnt lgkmcnt(6)
    v_mfma_f32_16x16x32_bf16 v[112:115], a[12:15], v[160:163], v[112:115]
    ds_read_b64 v[184:185], v198 offset:1280
    v_mfma_f32_32x32x16_bf16 v[80:95], a[12:15], v[164:167], v[80:95]
    ds_read_b64 v[186:187], v198 offset:1344
    ds_read_b64 v[188:189], v196 offset:10240
    ds_read_b64 v[190:191], v196 offset:10752
    v_mfma_f32_32x32x16_bf16 v[96:111], a[12:15], v[168:171], v[96:111]
    ds_read_b64 v[192:193], v196 offset:10496
    ds_read_b64 v[194:195], v196 offset:11008
    buffer_load_dwordx4 v76, s[16:19], s99 offen offset:3072 sc1 lds
    s_waitcnt lgkmcnt(6)
    v_mfma_f32_16x16x32_bf16 v[112:115], a[16:19], v[172:175], v[112:115]
    ds_read_b64 v[160:161], v198 offset:1536
    v_mfma_f32_32x32x16_bf16 v[80:95], a[16:19], v[176:179], v[80:95]
    ds_read_b64 v[162:163], v198 offset:1600
    ds_read_b64 v[164:165], v196 offset:12288
    ds_read_b64 v[166:167], v196 offset:12800
    v_mfma_f32_32x32x16_bf16 v[96:111], a[16:19], v[180:183], v[96:111]
    ds_read_b64 v[168:169], v196 offset:12544
    ds_read_b64 v[170:171], v196 offset:13056
    s_add_u32 m0, s93, 112512
    s_add_u32 s99, s99, 524288
    s_mov_b64 exec, s[80:81]
    buffer_load_dwordx4 v77, s[16:19], s100 offen sc1 lds
    s_mov_b64 exec, -1
    s_add_u32 s100, s100, 524288
    s_waitcnt lgkmcnt(6)
    v_mfma_f32_16x16x32_bf16 v[112:115], a[20:23], v[184:187], v[112:115]
    ds_read_b64 v[172:173], v198 offset:1792
    v_mfma_f32_32x32x16_bf16 v[80:95], a[20:23], v[188:191], v[80:95]
    ds_read_b64 v[174:175], v198 offset:1856
    ds_read_b64 v[176:177], v196 offset:14336
    ds_read_b64 v[178:179], v196 offset:14848
    v_mfma_f32_32x32x16_bf16 v[96:111], a[20:23], v[192:195], v[96:111]
    ds_read_b64 v[180:181], v196 offset:14592
    ds_read_b64 v[182:183], v196 offset:15104
    s_add_u32 m0, s92, 114688
    s_nop 0
    buffer_load_dwordx4 v73, s[16:19], s99 offen offset:0 sc1 lds
    s_waitcnt vmcnt(13)
    s_barrier
    s_waitcnt lgkmcnt(6)
    v_mfma_f32_16x16x32_bf16 v[112:115], a[24:27], v[160:163], v[112:115]
    v_add_u32 v198, v49, v198
    v_mfma_f32_32x32x16_bf16 v[80:95], a[24:27], v[164:167], v[80:95]
    v_add_u32 v196, 19584, v196
    ds_read_b64 v[184:185], v198 offset:0
    ds_read_b64 v[186:187], v198 offset:64
    ds_read_b64 v[188:189], v196 offset:0
    v_mfma_f32_32x32x16_bf16 v[96:111], a[24:27], v[168:171], v[96:111]
    ds_read_b64 v[190:191], v196 offset:512
    ds_read_b64 v[192:193], v196 offset:256
    ds_read_b64 v[194:195], v196 offset:768
    buffer_load_dwordx4 v74, s[16:19], s99 offen offset:1024 sc1 lds
    s_waitcnt lgkmcnt(6)
    v_mfma_f32_16x16x32_bf16 v[112:115], a[28:31], v[172:175], v[112:115]
    ds_read_b64 v[160:161], v198 offset:256
    v_mfma_f32_32x32x16_bf16 v[80:95], a[28:31], v[176:179], v[80:95]
    ds_read_b64 v[162:163], v198 offset:320
    ds_read_b64 v[164:165], v196 offset:2048
    ds_read_b64 v[166:167], v196 offset:2560
    v_mfma_f32_32x32x16_bf16 v[96:111], a[28:31], v[180:183], v[96:111]
    ds_read_b64 v[168:169], v196 offset:2304
    ds_read_b64 v[170:171], v196 offset:2816
    buffer_load_dwordx4 v75, s[16:19], s99 offen offset:2048 sc1 lds
    s_waitcnt lgkmcnt(6)
    v_mfma_f32_16x16x32_bf16 v[112:115], a[32:35], v[184:187], v[112:115]
    ds_read_b64 v[172:173], v198 offset:512
    v_mfma_f32_32x32x16_bf16 v[80:95], a[32:35], v[188:191], v[80:95]
    ds_read_b64 v[174:175], v198 offset:576
    ds_read_b64 v[176:177], v196 offset:4096
    ds_read_b64 v[178:179], v196 offset:4608
    v_mfma_f32_32x32x16_bf16 v[96:111], a[32:35], v[192:195], v[96:111]
    ds_read_b64 v[180:181], v196 offset:4352
    ds_read_b64 v[182:183], v196 offset:4864
    buffer_load_dwordx4 v76, s[16:19], s99 offen offset:3072 sc1 lds
    s_waitcnt lgkmcnt(6)
    v_mfma_f32_16x16x32_bf16 v[112:115], a[36:39], v[160:163], v[112:115]
    ds_read_b64 v[184:185], v198 offset:768
    v_mfma_f32_32x32x16_bf16 v[80:95], a[36:39], v[164:167], v[80:95]
    ds_read_b64 v[186:187], v198 offset:832
    ds_read_b64 v[188:189], v196 offset:6144
    ds_read_b64 v[190:191], v196 offset:6656
    v_mfma_f32_32x32x16_bf16 v[96:111], a[36:39], v[168:171], v[96:111]
    ds_read_b64 v[192:193], v196 offset:6400
    ds_read_b64 v[194:195], v196 offset:6912
    s_add_u32 m0, s93, 132096
    s_add_u32 s99, s99, 524288
    s_mov_b64 exec, s[80:81]
    buffer_load_dwordx4 v77, s[16:19], s100 offen sc1 lds
    s_mov_b64 exec, -1
    s_add_u32 s100, s100, 524288
    s_waitcnt lgkmcnt(6)
    v_mfma_f32_16x16x32_bf16 v[112:115], a[40:43], v[172:175], v[112:115]
    ds_read_b64 v[160:161], v198 offset:1024
    v_mfma_f32_32x32x16_bf16 v[80:95], a[40:43], v[176:179], v[80:95]
    ds_read_b64 v[162:163], v198 offset:1088
    ds_read_b64 v[164:165], v196 offset:8192
    ds_read_b64 v[166:167], v196 offset:8704
    v_add_u32 v199, 36352, v58
    s_lshl_b32 s32, s24, 11
    v_mfma_f32_32x32x16_bf16 v[96:111], a[40:43], v[180:183], v[96:111]
    ds_read_b64 v[168:169], v196 offset:8448
    ds_read_b64 v[170:171], v196 offset:8960
    v_add_u32 v203, s32, v199
    s_add_u32 s32, s24, 1
    s_waitcnt lgkmcnt(6)
    v_mfma_f32_16x16x32_bf16 v[112:115], a[44:47], v[184:187], v[112:115]
    ds_read_b64 v[172:173], v198 offset:1280
    v_mfma_f32_32x32x16_bf16 v[80:95], a[44:47], v[188:191], v[80:95]
    ds_read_b64 v[174:175], v198 offset:1344
    ds_read_b64 v[176:177], v196 offset:10240
    ds_read_b64 v[178:179], v196 offset:10752
    s_and_b32 s32, s32, 3
    s_mul_i32 s32, s32, 6144
    v_mfma_f32_32x32x16_bf16 v[96:111], a[44:47], v[192:195], v[96:111]
    ds_read_b64 v[180:181], v196 offset:10496
    ds_read_b64 v[182:183], v196 offset:11008
    v_add_u32 v200, s32, v199
    s_add_u32 s32, s24, 2
    s_waitcnt lgkmcnt(6)
    v_mfma_f32_16x16x32_bf16 v[112:115], a[48:51], v[160:163], v[112:115]
    ds_read_b64 v[184:185], v198 offset:1536
    v_mfma_f32_32x32x16_bf16 v[80:95], a[48:51], v[164:167], v[80:95]
    ds_read_b64 v[186:187], v198 offset:1600
    ds_read_b64 v[188:189], v196 offset:12288
    ds_read_b64 v[190:191], v196 offset:12800
    s_and_b32 s32, s32, 3
    s_mul_i32 s32, s32, 6144
    v_mfma_f32_32x32x16_bf16 v[96:111], a[48:51], v[168:171], v[96:111]
    ds_read_b64 v[192:193], v196 offset:12544
    ds_read_b64 v[194:195], v196 offset:13056
    v_add_u32 v201, s32, v199
    s_add_u32 s32, s24, 3
    s_waitcnt lgkmcnt(6)
    v_mfma_f32_16x16x32_bf16 v[112:115], a[52:55], v[172:175], v[112:115]
    ds_read_b64 v[160:161], v198 offset:1792
    v_mfma_f32_32x32x16_bf16 v[80:95], a[52:55], v[176:179], v[80:95]
    ds_read_b64 v[162:163], v198 offset:1856
    ds_read_b64 v[164:165], v196 offset:14336
    ds_read_b64 v[166:167], v196 offset:14848
    s_and_b32 s32, s32, 3
    s_mul_i32 s32, s32, 6144
    v_mfma_f32_32x32x16_bf16 v[96:111], a[52:55], v[180:183], v[96:111]
    ds_read_b64 v[168:169], v196 offset:14592
    ds_read_b64 v[170:171], v196 offset:15104
    v_add_u32 v202, s32, v199
    s_mul_i32 s32, s24, 6144
    s_waitcnt vmcnt(12)
    s_barrier
    s_waitcnt lgkmcnt(6)
    v_mfma_f32_16x16x32_bf16 v[112:115], a[56:59], v[184:187], v[112:115]
    v_add_u32 v198, v49, v198
    v_mfma_f32_32x32x16_bf16 v[80:95], a[56:59], v[188:191], v[80:95]
    v_add_u32 v196, 19584, v196
    ds_read_b64 v[172:173], v198 offset:0
    ds_read_b64 v[174:175], v198 offset:64
    ds_read_b64 v[176:177], v196 offset:0
    v_add_u32_e64 v204, s32, v199
    v_mfma_f32_32x32x16_bf16 v[96:111], a[56:59], v[192:195], v[96:111]
    ds_read_b64 v[178:179], v196 offset:512
    ds_read_b64 v[180:181], v196 offset:256
    ds_read_b64 v[182:183], v196 offset:768
    s_lshl_b32 s32, s24, 8
    s_waitcnt lgkmcnt(6)
    v_mfma_f32_16x16x32_bf16 v[112:115], a[60:63], v[160:163], v[112:115]
    ds_read_b64 v[184:185], v198 offset:256
    v_mfma_f32_32x32x16_bf16 v[80:95], a[60:63], v[164:167], v[80:95]
    ds_read_b64 v[186:187], v198 offset:320
    ds_read_b64 v[188:189], v196 offset:2048
    ds_read_b64 v[190:191], v196 offset:2560
    s_add_u32 s32, s32, 36352
    v_and_b32_e64 v214, 15, v1
    v_mfma_f32_32x32x16_bf16 v[96:111], a[60:63], v[168:171], v[96:111]
    ds_read_b64 v[192:193], v196 offset:2304
    ds_read_b64 v[194:195], v196 offset:2816
    v_lshl_add_u32 v206, v214, 4, s32
    v_lshrrev_b32 v215, 5, v1
    s_waitcnt lgkmcnt(6)
    v_mfma_f32_16x16x32_bf16 v[112:115], a[64:67], v[172:175], v[112:115]
    ds_read_b64 v[160:161], v198 offset:512
    v_mfma_f32_32x32x16_bf16 v[80:95], a[64:67], v[176:179], v[80:95]
    ds_read_b64 v[162:163], v198 offset:576
    ds_read_b64 v[164:165], v196 offset:4096
    ds_read_b64 v[166:167], v196 offset:4608
    v_lshl_add_u32 v205, v215, 10, v206
    v_bfe_u32 v215, v1, 4, 1
    v_mfma_f32_32x32x16_bf16 v[96:111], a[64:67], v[180:183], v[96:111]
    ds_read_b64 v[168:169], v196 offset:4352
    ds_read_b64 v[170:171], v196 offset:4864
    v_lshl_add_u32 v205, v215, 3, v205
    v_lshlrev_b32 v214, 2, v214
    s_waitcnt lgkmcnt(6)
    v_mfma_f32_16x16x32_bf16 v[112:115], a[68:71], v[184:187], v[112:115]
    ds_read_b64 v[172:173], v198 offset:768
    v_mfma_f32_32x32x16_bf16 v[80:95], a[68:71], v[188:191], v[80:95]
    ds_read_b64 v[174:175], v198 offset:832
    ds_read_b64 v[176:177], v196 offset:6144
    ds_read_b64 v[178:179], v196 offset:6656
    v_lshl_add_u32 v214, v215, 10, v214
    s_lshl_b32 s32, s24, 6
    v_mfma_f32_32x32x16_bf16 v[96:111], a[68:71], v[192:195], v[96:111]
    ds_read_b64 v[180:181], v196 offset:6400
    ds_read_b64 v[182:183], v196 offset:6912
    v_lshl_add_u32 v207, v215, 3, s32
    v_and_b32_e64 v215, 12, v1
    s_waitcnt lgkmcnt(6)
    v_mfma_f32_16x16x32_bf16 v[112:115], a[72:75], v[160:163], v[112:115]
    ds_read_b64 v[184:185], v198 offset:1024
    v_mfma_f32_32x32x16_bf16 v[80:95], a[72:75], v[164:167], v[80:95]
    ds_read_b64 v[186:187], v198 offset:1088
    ds_read_b64 v[188:189], v196 offset:8192
    ds_read_b64 v[190:191], v196 offset:8704
    v_lshl_add_u32 v207, v215, 2, v207
    v_and_b32_e64 v215, 2, v1
    v_mfma_f32_32x32x16_bf16 v[96:111], a[72:75], v[168:171], v[96:111]
    ds_read_b64 v[192:193], v196 offset:8448
    ds_read_b64 v[194:195], v196 offset:8960
    s_lshl_b32 s98, s72, 5
    s_add_u32 s98, s98, 256
    s_sub_u32 s95, s98, 4
    s_max_i32 s95, s95, 0
    s_lshl_b32 s94, s98, 3
    s_lshl_b32 s95, s95, 3
    s_add_u32 s94, s94, 3457024
    s_add_u32 s95, s95, 3457024
    s_add_u32 s96, s94, 8192
    buffer_load_dwordx2 v[152:153], v47, s[16:19], s94 offen sc1
    s_waitcnt lgkmcnt(6)
    v_mfma_f32_16x16x32_bf16 v[112:115], a[76:79], v[172:175], v[112:115]
    ds_read_b64 v[160:161], v198 offset:1280
    v_mfma_f32_32x32x16_bf16 v[80:95], a[76:79], v[176:179], v[80:95]
    ds_read_b64 v[162:163], v198 offset:1344
    ds_read_b64 v[164:165], v196 offset:10240
    ds_read_b64 v[166:167], v196 offset:10752
    v_lshl_add_u32 v207, v215, 1, v207
    v_add_u32 v207, 69120, v207
    v_mfma_f32_32x32x16_bf16 v[96:111], a[76:79], v[180:183], v[96:111]
    ds_read_b64 v[168:169], v196 offset:10496
    ds_read_b64 v[170:171], v196 offset:11008
    buffer_load_dwordx2 v[154:155], v47, s[16:19], s96 offen sc1
    v_lshrrev_b32 v215, 4, v1
    s_waitcnt lgkmcnt(6)
    v_mfma_f32_16x16x32_bf16 v[112:115], a[80:83], v[184:187], v[112:115]
    ds_read_b64 v[172:173], v198 offset:1536
    v_mfma_f32_32x32x16_bf16 v[80:95], a[80:83], v[188:191], v[80:95]
    ds_read_b64 v[174:175], v198 offset:1600
    ds_read_b64 v[176:177], v196 offset:12288
    ds_read_b64 v[178:179], v196 offset:12800
    v_lshl_add_u32 v206, v215, 2, v206
    v_mov_b32 v215, 0x3f803f80
    v_mfma_f32_32x32x16_bf16 v[96:111], a[80:83], v[192:195], v[96:111]
    ds_read_b64 v[180:181], v196 offset:12544
    ds_read_b64 v[182:183], v196 offset:13056
    buffer_load_dwordx2 v[156:157], v48, s[16:19], s95 offen sc1
    s_waitcnt lgkmcnt(6)
    v_mfma_f32_16x16x32_bf16 v[112:115], a[84:87], v[160:163], v[112:115]
    ds_read_b64 v[184:185], v198 offset:1792
    v_mfma_f32_32x32x16_bf16 v[80:95], a[84:87], v[164:167], v[80:95]
    ds_read_b64 v[186:187], v198 offset:1856
    ds_read_b64 v[188:189], v196 offset:14336
    ds_read_b64 v[190:191], v196 offset:14848
    v_mfma_f32_32x32x16_bf16 v[96:111], a[84:87], v[168:171], v[96:111]
    ds_read_b64 v[192:193], v196 offset:14592
    ds_read_b64 v[194:195], v196 offset:15104
    s_waitcnt vmcnt(8)
    s_barrier
    s_waitcnt lgkmcnt(6)
    v_mfma_f32_16x16x32_bf16 v[112:115], a[88:91], v[172:175], v[112:115]
    v_add_u32_e64 v198, v49, v198
    v_mfma_f32_32x32x16_bf16 v[80:95], a[88:91], v[176:179], v[80:95]
    v_add_u32 v196, 19584, v196
    ds_read_b64 v[160:161], v198 offset:0
    ds_read_b64 v[162:163], v198 offset:64
    ds_read_b64 v[164:165], v196 offset:0
    v_mfma_f32_32x32x16_bf16 v[96:111], a[88:91], v[180:183], v[96:111]
    ds_read_b64 v[166:167], v196 offset:512
    ds_read_b64 v[168:169], v196 offset:256
    ds_read_b64 v[170:171], v196 offset:768
    s_waitcnt lgkmcnt(6)
    v_mfma_f32_16x16x32_bf16 v[112:115], a[92:95], v[184:187], v[112:115]
    ds_read_b64 v[172:173], v198 offset:256
    v_mfma_f32_32x32x16_bf16 v[80:95], a[92:95], v[188:191], v[80:95]
    ds_read_b64 v[174:175], v198 offset:320
    ds_read_b64 v[176:177], v196 offset:2048
    ds_read_b64 v[178:179], v196 offset:2560
    v_mfma_f32_32x32x16_bf16 v[96:111], a[92:95], v[192:195], v[96:111]
    ds_read_b64 v[180:181], v196 offset:2304
    ds_read_b64 v[182:183], v196 offset:2816
    s_waitcnt lgkmcnt(6)
    v_mfma_f32_16x16x32_bf16 v[112:115], a[96:99], v[160:163], v[112:115]
    ds_read_b64 v[184:185], v198 offset:512
    v_mfma_f32_32x32x16_bf16 v[80:95], a[96:99], v[164:167], v[80:95]
    ds_read_b64 v[186:187], v198 offset:576
    ds_read_b64 v[188:189], v196 offset:4096
    ds_read_b64 v[190:191], v196 offset:4608
    v_mfma_f32_32x32x16_bf16 v[96:111], a[96:99], v[168:171], v[96:111]
    ds_read_b64 v[192:193], v196 offset:4352
    ds_read_b64 v[194:195], v196 offset:4864
    s_waitcnt lgkmcnt(6)
    v_mfma_f32_16x16x32_bf16 v[112:115], a[100:103], v[172:175], v[112:115]
    ds_read_b64 v[160:161], v198 offset:768
    v_mfma_f32_32x32x16_bf16 v[80:95], a[100:103], v[176:179], v[80:95]
    ds_read_b64 v[162:163], v198 offset:832
    ds_read_b64 v[164:165], v196 offset:6144
    ds_read_b64 v[166:167], v196 offset:6656
    v_mfma_f32_32x32x16_bf16 v[96:111], a[100:103], v[180:183], v[96:111]
    ds_read_b64 v[168:169], v196 offset:6400
    ds_read_b64 v[170:171], v196 offset:6912
    s_waitcnt lgkmcnt(6)
    v_mfma_f32_16x16x32_bf16 v[112:115], a[104:107], v[184:187], v[112:115]
    ds_read_b64 v[172:173], v198 offset:1024
    v_mfma_f32_32x32x16_bf16 v[80:95], a[104:107], v[188:191], v[80:95]
    ds_read_b64 v[174:175], v198 offset:1088
    ds_read_b64 v[176:177], v196 offset:8192
    ds_read_b64 v[178:179], v196 offset:8704
    v_mfma_f32_32x32x16_bf16 v[96:111], a[104:107], v[192:195], v[96:111]
    ds_read_b64 v[180:181], v196 offset:8448
    ds_read_b64 v[182:183], v196 offset:8960
    s_waitcnt lgkmcnt(6)
    v_mfma_f32_16x16x32_bf16 v[112:115], a[108:111], v[160:163], v[112:115]
    ds_read_b64 v[184:185], v198 offset:1280
    v_mfma_f32_32x32x16_bf16 v[80:95], a[108:111], v[164:167], v[80:95]
    ds_read_b64 v[186:187], v198 offset:1344
    ds_read_b64 v[188:189], v196 offset:10240
    ds_read_b64 v[190:191], v196 offset:10752
    v_mfma_f32_32x32x16_bf16 v[96:111], a[108:111], v[168:171], v[96:111]
    ds_read_b64 v[192:193], v196 offset:10496
    ds_read_b64 v[194:195], v196 offset:11008
    s_waitcnt lgkmcnt(6)
    v_mfma_f32_16x16x32_bf16 v[112:115], a[112:115], v[172:175], v[112:115]
    ds_read_b64 v[160:161], v198 offset:1536
    v_mfma_f32_32x32x16_bf16 v[80:95], a[112:115], v[176:179], v[80:95]
    ds_read_b64 v[162:163], v198 offset:1600
    ds_read_b64 v[164:165], v196 offset:12288
    ds_read_b64 v[166:167], v196 offset:12800
    v_mfma_f32_32x32x16_bf16 v[96:111], a[112:115], v[180:183], v[96:111]
    ds_read_b64 v[168:169], v196 offset:12544
    ds_read_b64 v[170:171], v196 offset:13056
    s_waitcnt lgkmcnt(6)
    v_mfma_f32_16x16x32_bf16 v[112:115], a[116:119], v[184:187], v[112:115]
    ds_read_b64 v[172:173], v198 offset:1792
    v_mfma_f32_32x32x16_bf16 v[80:95], a[116:119], v[188:191], v[80:95]
    ds_read_b64 v[174:175], v198 offset:1856
    ds_read_b64 v[176:177], v196 offset:14336
    ds_read_b64 v[178:179], v196 offset:14848
    v_mfma_f32_32x32x16_bf16 v[96:111], a[116:119], v[192:195], v[96:111]
    ds_read_b64 v[180:181], v196 offset:14592
    ds_read_b64 v[182:183], v196 offset:15104
sl_70:
    s_waitcnt vmcnt(1)
    v_max3_u32 v2, v152, v153, v154
    s_waitcnt vmcnt(0)
    v_max3_u32 v2, v2, v155, v156
    v_max_u32 v2, v2, v157
    v_cmp_eq_u32 vcc, -1, v2
    s_nop 0
    s_cbranch_vccnz rd_71
rc_72:
    s_barrier
    s_waitcnt lgkmcnt(6)
    v_mfma_f32_16x16x32_bf16 v[112:115], a[120:123], v[160:163], v[112:115]
    v_add_u32 v198, v49, v198
    v_mfma_f32_32x32x16_bf16 v[80:95], a[120:123], v[164:167], v[80:95]
    v_add_u32 v196, 19584, v196
    ds_read_b64 v[184:185], v198 offset:0
    ds_read_b64 v[186:187], v198 offset:64
    v_mul_f32 v148, v24, v157
    v_mul_f32 v149, v25, v157
    v_mfma_f32_32x32x16_bf16 v[96:111], a[120:123], v[168:171], v[96:111]
    ds_read_b64 v[188:189], v196 offset:0
    ds_read_b64 v[190:191], v196 offset:512
    s_mov_b32 s96, 12058624
    buffer_load_dwordx4 v[216:219], v56, s[16:19], s96 offen offset:0 sc1
    v_mul_f32 v150, v26, v157
    v_mul_f32_e64 v151, v27, v157
    s_waitcnt lgkmcnt(4)
    v_mfma_f32_16x16x32_bf16 v[112:115], a[124:127], v[172:175], v[112:115]
    ds_read_b64 v[192:193], v198 offset:256
    v_mfma_f32_32x32x16_bf16 v[80:95], a[124:127], v[176:179], v[80:95]
    ds_read_b64 v[194:195], v198 offset:320
    ds_read_b64 v[160:161], v196 offset:2048
    v_mul_f32 v116, v8, v153
    v_mul_f32 v117, v9, v153
    v_mul_f32_e64 v118, v10, v153
    v_mfma_f32_32x32x16_bf16 v[96:111], a[124:127], v[180:183], v[96:111]
    ds_read_b64 v[162:163], v196 offset:2560
    buffer_load_dwordx4 v[220:223], v56, s[16:19], s96 offen offset:256 sc1
    v_mul_f32 v119, v11, v153
    v_mul_f32_e64 v120, v12, v153
    s_waitcnt lgkmcnt(4)
    v_mfma_f32_16x16x32_bf16 v[112:115], a[128:131], v[184:187], v[112:115]
    ds_read_b64 v[164:165], v198 offset:512
    v_mfma_f32_32x32x16_bf16 v[80:95], a[128:131], v[188:191], v[80:95]
    ds_read_b64 v[166:167], v198 offset:576
    ds_read_b64 v[168:169], v196 offset:4096
    ds_read_b64 v[170:171], v196 offset:4608
    v_mul_f32 v121, v13, v153
    v_mul_f32_e64 v122, v14, v153
    s_waitcnt lgkmcnt(4)
    v_mfma_f32_16x16x32_bf16 v[112:115], a[132:135], v[192:195], v[112:115]
    ds_read_b64 v[172:173], v198 offset:768
    v_mfma_f32_32x32x16_bf16 v[80:95], a[132:135], v[160:163], v[80:95]
    ds_read_b64 v[174:175], v198 offset:832
    ds_read_b64 v[176:177], v196 offset:6144
    ds_read_b64 v[178:179], v196 offset:6656
    s_mov_b32 s96, 12091392
    buffer_load_dwordx4 v[224:227], v56, s[16:19], s96 offen offset:0 sc1
    v_mul_f32 v123, v15, v153
    v_mul_f32_e64 v124, v16, v153
    s_waitcnt lgkmcnt(4)
    v_mfma_f32_16x16x32_bf16 v[112:115], a[136:139], v[164:167], v[112:115]
    ds_read_b64 v[180:181], v198 offset:1024
    v_mfma_f32_32x32x16_bf16 v[80:95], a[136:139], v[168:171], v[80:95]
    ds_read_b64 v[182:183], v198 offset:1088
    ds_read_b64 v[184:185], v196 offset:8192
    ds_read_b64 v[186:187], v196 offset:8704
    v_mul_f32 v125, v17, v153
    v_mul_f32_e64 v126, v18, v153
    s_waitcnt lgkmcnt(4)
    v_mfma_f32_16x16x32_bf16 v[112:115], a[140:143], v[172:175], v[112:115]
    ds_read_b64 v[188:189], v198 offset:1280
    v_mfma_f32_32x32x16_bf16 v[80:95], a[140:143], v[176:179], v[80:95]
    ds_read_b64 v[190:191], v198 offset:1344
    ds_read_b64 v[192:193], v196 offset:10240
    ds_read_b64 v[194:195], v196 offset:10752
    buffer_load_dwordx4 v[228:231], v56, s[16:19], s96 offen offset:256 sc1
    v_mul_f32 v127, v19, v153
    v_mul_f32_e64 v128, v20, v153
    s_waitcnt lgkmcnt(4)
    v_mfma_f32_16x16x32_bf16 v[112:115], a[144:147], v[180:183], v[112:115]
    ds_read_b64 v[160:161], v198 offset:1536
    v_mfma_f32_32x32x16_bf16 v[80:95], a[144:147], v[184:187], v[80:95]
    ds_read_b64 v[162:163], v198 offset:1600
    ds_read_b64 v[164:165], v196 offset:12288
    ds_read_b64 v[166:167], v196 offset:12800
    v_mul_f32 v129, v21, v153
    v_mul_f32_e64 v130, v22, v153
    s_waitcnt lgkmcnt(4)
    v_mfma_f32_16x16x32_bf16 v[112:115], a[148:151], v[188:191], v[112:115]
    ds_read_b64 v[168:169], v198 offset:1792
    v_mfma_f32_32x32x16_bf16 v[80:95], a[148:151], v[192:195], v[80:95]
    ds_read_b64 v[170:171], v198 offset:1856
    ds_read_b64 v[172:173], v196 offset:14336
    ds_read_b64 v[174:175], v196 offset:14848
    s_mov_b32 s96, 12124160
    buffer_load_dwordx4 v[232:235], v56, s[16:19], s96 offen offset:0 sc1
    v_mul_f32 v131, v23, v153
    v_mul_f32_e64 v132, v8, v155
    s_waitcnt lgkmcnt(4)
    v_mfma_f32_16x16x32_bf16 v[112:115], a[152:155], v[160:163], v[112:115]
    ds_read_b64 v[176:177], v196 offset:256
    v_mfma_f32_32x32x16_bf16 v[80:95], a[152:155], v[164:167], v[80:95]
    ds_read_b64 v[178:179], v196 offset:768
    ds_read_b64 v[180:181], v196 offset:2304
    ds_read_b64 v[182:183], v196 offset:2816
    v_mul_f32 v133, v9, v155
    v_mul_f32_e64 v134, v10, v155
    s_waitcnt lgkmcnt(4)
    v_mfma_f32_16x16x32_bf16 v[112:115], a[156:159], v[168:171], v[112:115]
    ds_read_b64 v[184:185], v196 offset:4352
    v_mfma_f32_32x32x16_bf16 v[80:95], a[156:159], v[172:175], v[80:95]
    ds_read_b64 v[186:187], v196 offset:4864
    ds_read_b64 v[188:189], v196 offset:6400
    ds_read_b64 v[190:191], v196 offset:6912
    buffer_load_dwordx4 v[236:239], v56, s[16:19], s96 offen offset:256 sc1
    v_mul_f32 v135, v11, v155
    v_mul_f32 v136, v12, v155
    v_mul_f32 v137, v13, v155
    v_mul_f32 v138, v14, v155
    v_mul_f32 v139, v15, v155
    v_mul_f32 v140, v16, v155
    v_mul_f32 v141, v17, v155
    v_mul_f32 v142, v18, v155
    v_mul_f32 v143, v19, v155
    v_mul_f32 v144, v20, v155
    v_mul_f32 v145, v21, v155
    v_mul_f32 v146, v22, v155
    v_mul_f32 v147, v23, v155
    s_waitcnt lgkmcnt(4)
    v_mfma_f32_32x32x16_bf16 v[96:111], a[128:131], v[176:179], v[96:111]
    ds_read_b64 v[192:193], v196 offset:8448
    ds_read_b64 v[194:195], v196 offset:8960
    v_mfma_f32_32x32x16_bf16 v[96:111], a[132:135], v[180:183], v[96:111]
    ds_read_b64 v[160:161], v196 offset:10496
    ds_read_b64 v[162:163], v196 offset:11008
    s_mov_b32 s96, 12156928
    buffer_load_dwordx4 v[240:243], v56, s[16:19], s96 offen offset:0 sc1
    v_fma_f32 v112, v112, v156, v148
    v_fma_f32 v113, v113, v156, v149
    s_waitcnt lgkmcnt(4)
    v_mfma_f32_32x32x16_bf16 v[96:111], a[136:139], v[184:187], v[96:111]
    ds_read_b64 v[164:165], v196 offset:12544
    ds_read_b64 v[166:167], v196 offset:13056
    v_fma_f32 v114, v114, v156, v150
    v_fma_f32 v115, v115, v156, v151
    v_cvt_pk_bf16_f32 v112, v112, v113
    v_mfma_f32_32x32x16_bf16 v[96:111], a[140:143], v[188:191], v[96:111]
    ds_read_b64 v[168:169], v196 offset:14592
    ds_read_b64 v[170:171], v196 offset:15104
    buffer_load_dwordx4 v[244:247], v56, s[16:19], s96 offen offset:256 sc1
    v_cvt_pk_bf16_f32 v113, v114, v115
    v_fma_f32 v80, v80, v152, v116
    s_waitcnt lgkmcnt(4)
    v_mfma_f32_32x32x16_bf16 v[96:111], a[144:147], v[192:195], v[96:111]
    v_fma_f32 v81, v81, v152, v117
    v_fma_f32 v82, v82, v152, v118
    v_fma_f32 v83, v83, v152, v119
    v_cvt_pk_bf16_f32 v80, v80, v81
    v_cvt_pk_bf16_f32 v81, v82, v83
    v_mfma_f32_32x32x16_bf16 v[96:111], a[148:151], v[160:163], v[96:111]
    ds_write_b64 v40, v[112:113] offset:0
    ds_write_b64 v38, v[80:81] offset:0
    v_fma_f32 v84, v84, v152, v120
    v_fma_f32 v85, v85, v152, v121
    s_waitcnt lgkmcnt(2)
    v_mfma_f32_32x32x16_bf16 v[96:111], a[152:155], v[164:167], v[96:111]
    v_fma_f32 v86, v86, v152, v122
    v_fma_f32 v87, v87, v152, v123
    v_cvt_pk_bf16_f32 v84, v84, v85
    v_cvt_pk_bf16_f32 v85, v86, v87
    v_fma_f32 v88, v88, v152, v124
    v_mfma_f32_32x32x16_bf16 v[96:111], a[156:159], v[168:171], v[96:111]
    s_mov_b32 s96, 12058624
    buffer_load_dwordx2 v[248:249], v57, s[16:19], s96 offen offset:0 sc1
    v_fma_f32 v89, v89, v152, v125
    v_fma_f32 v90, v90, v152, v126
    v_fma_f32 v91, v91, v152, v127
    v_cvt_pk_bf16_f32 v88, v88, v89
    v_cvt_pk_bf16_f32 v89, v90, v91
    ds_write_b64 v38, v[84:85] offset:6400
    ds_write_b64 v38, v[88:89] offset:12800
    v_fma_f32 v92, v92, v152, v128
    v_fma_f32 v93, v93, v152, v129
    v_fma_f32 v94, v94, v152, v130
    v_fma_f32 v95, v95, v152, v131
    v_cvt_pk_bf16_f32 v92, v92, v93
    v_cvt_pk_bf16_f32 v93, v94, v95
    ds_write_b64 v39, v[92:93] offset:0
    v_pk_fma_f32 v[96:97], v[96:97], v[154:155], v[132:133] op_sel_hi:[1,0,1]
    v_pk_fma_f32 v[98:99], v[98:99], v[154:155], v[134:135] op_sel_hi:[1,0,1]
    v_cvt_pk_bf16_f32 v96, v96, v97
    v_cvt_pk_bf16_f32 v97, v98, v99
    v_pk_fma_f32 v[100:101], v[100:101], v[154:155], v[136:137] op_sel_hi:[1,0,1]
    v_pk_fma_f32 v[102:103], v[102:103], v[154:155], v[138:139] op_sel_hi:[1,0,1]
    v_cvt_pk_bf16_f32 v100, v100, v101
    v_cvt_pk_bf16_f32 v101, v102, v103
    ds_write_b64 v38, v[96:97] offset:1600
    ds_write_b64 v38, v[100:101] offset:8000
    v_pk_fma_f32 v[104:105], v[104:105], v[154:155], v[140:141] op_sel_hi:[1,0,1]
    v_pk_fma_f32 v[106:107], v[106:107], v[154:155], v[142:143] op_sel_hi:[1,0,1]
    v_cvt_pk_bf16_f32 v104, v104, v105
    v_cvt_pk_bf16_f32 v105, v106, v107
    v_pk_fma_f32 v[108:109], v[108:109], v[154:155], v[144:145] op_sel_hi:[1,0,1]
    v_pk_fma_f32 v[110:111], v[110:111], v[154:155], v[146:147] op_sel_hi:[1,0,1]
    v_cvt_pk_bf16_f32 v108, v108, v109
    v_cvt_pk_bf16_f32 v109, v110, v111
    ds_write_b64 v38, v[104:105] offset:14400
    ds_write_b64 v39, v[108:109] offset:1600
    v_cmp_u_f32 vcc, v82, v114
    v_cmp_u_f32 s[82:83], v98, v98
    s_lshl_b32 s25, s24, 2
    s_add_u32 s25, s25, 161280
    s_or_b64 vcc, vcc, s[82:83]
    s_cselect_b32 s26, 1, 0
    v_mov_b32 v196, s25
    v_mov_b32 v197, s26
    ds_write_b32 v196, v197
    s_waitcnt lgkmcnt(0)
    s_barrier
    v_mov_b32 v158, 161280
    ds_read_b128 v[128:131], v158
    v_mov_b32 v94, 0
    v_mov_b32 v95, 0
    v_mov_b32 v98, 0
    v_mov_b32_e64 v99, 0
    s_mov_b64 exec, 0xffff
    ds_read_b64 v[94:95], v42 offset:320
    ds_read_b64 v[98:99], v42 offset:640
    s_mov_b64 exec, -1
    s_nop 0
    ds_read_b64 v[92:93], v41 offset:320
    ds_read_b64 v[96:97], v41 offset:640
    ds_read_b64 v[84:85], v41 offset:6720
    ds_read_b64 v[86:87], v42 offset:6720
    ds_read_b64 v[80:81], v41 offset:6400
    ds_read_b64 v[82:83], v42 offset:6400
    ds_read_b64 v[88:89], v41 offset:7040
    ds_read_b64 v[90:91], v42 offset:7040
    ds_read_b64_tr_b16 v[106:107], v44 offset:0
    ds_read_b64_tr_b16 v[100:101], v43 offset:0
    buffer_load_dwordx2 v[252:253], v57, s[16:19], s96 offen offset:128 sc1
    ds_read_b64_tr_b16 v[108:109], v44 offset:320
    ds_read_b64_tr_b16 v[102:103], v43 offset:320
    ds_read_b64_tr_b16 v[110:111], v44 offset:640
    ds_read_b64_tr_b16 v[104:105], v43 offset:640
    s_mov_b32 s82, 0x3ea52b5c
    s_lshl_b32 s25, s98, 4
    s_add_u32 s25, s25, 12058624
    s_lshl_b32 s26, s98, 3
    s_mov_b32 s96, 12075008
    buffer_load_dwordx2 v[250:251], v57, s[16:19], s96 offen offset:0 sc1
    s_add_u32 s26, s26, 12058624
    s_waitcnt lgkmcnt(15)
    v_or3_b32 v128, v128, v129, v130
    v_or_b32 v128, v128, v131
    v_cmp_ne_u32 vcc, 0, v128
    s_nop 0
    s_cbranch_vccnz rd_73
rc_74:
    s_waitcnt lgkmcnt(10)
    v_mfma_f32_16x16x32_bf16 v[116:119], v[84:87], v[92:95], v[28:31]
    v_mfma_f32_16x16x32_bf16 v[120:123], v[84:87], v[96:99], v[32:35]
    s_waitcnt lgkmcnt(8)
    v_mfma_f32_16x16x32_bf16 v[112:115], v[80:83], v[92:95], v[32:35]
    s_waitcnt lgkmcnt(6)
    v_mfma_f32_16x16x32_bf16 v[124:127], v[88:91], v[96:99], v[28:31]
    buffer_load_dwordx2 v[254:255], v57, s[16:19], s96 offen offset:128 sc1
    s_nop 4
    v_max_f32 v112, v112, v116
    v_max_f32 v113, v113, v117
    v_max_f32 v114, v114, v118
    v_max_f32 v115, v115, v119
    v_max3_f32 v156, v112, v113, v114
    v_max_f32 v156, v156, v115
    v_max_f32 v120, v120, v124
    v_max_f32 v121, v121, v125
    s_mov_b32 s96, 9437184
    buffer_load_dwordx4 v[208:211], v59, s[16:19], s96 offen sc1
    v_max_f32 v122, v122, v126
    v_max_f32 v123, v123, v127
    v_max3_f32 v157, v120, v121, v122
    v_max_f32 v157, v157, v123
    s_nop 1
    v_permlane16_swap_b32 v156, v157
    v_max_f32 v156, v156, v157
    v_mov_b32 v157, v156
    s_nop 1
    v_permlane32_swap_b32_e64 v156, v157
    s_add_u32 s97, s36, 9437184
    buffer_load_dword v212, v61, s[16:19], s97 offen sc1
    v_max_f32 v156, v156, v157
    v_mul_f32 v156, s82, v156
    v_mov_b32 v157, v156
    s_nop 1
    v_permlane16_swap_b32_e64 v156, v157
    v_fma_f32 v112, v112, s82, -v156
    v_fma_f32 v113, v113, s82, -v156
    v_fma_f32 v114, v114, s82, -v156
    v_fma_f32 v115, v115, s82, -v156
    v_exp_f32 v112, v112
    v_exp_f32 v113, v113
    v_exp_f32 v114, v114
    v_exp_f32 v115, v115
    v_cvt_pk_bf16_f32 v116, v112, v113
    v_cvt_pk_bf16_f32 v117, v114, v115
    v_bfi_b32 v128, v36, 0, v116
    v_and_b32 v130, v36, v116
    v_bfi_b32 v129, v37, 0, v117
    v_and_b32 v131, v37, v117
    s_waitcnt lgkmcnt(3)
    s_nop 0
    v_mfma_f32_16x16x32_bf16 v[144:147], v[106:109], v[128:131], 0
    s_waitcnt lgkmcnt(2)
    v_mfma_f32_16x16x32_bf16 v[136:139], v[100:103], v[128:131], 0
    v_fma_f32 v120, v120, s82, -v157
    v_fma_f32 v121, v121, s82, -v157
    v_fma_f32 v122, v122, s82, -v157
    v_fma_f32 v123, v123, s82, -v157
    v_exp_f32 v120, v120
    v_exp_f32 v121, v121
    v_exp_f32 v122, v122
    v_exp_f32_e64 v123, v123
    v_cvt_pk_bf16_f32 v124, v120, v121
    v_cvt_pk_bf16_f32 v125, v122, v123
    v_bfi_b32 v132, v36, 0, v124
    v_and_b32 v134, v36, v124
    v_bfi_b32 v133, v37, 0, v125
    v_and_b32 v135, v37, v125
    s_waitcnt lgkmcnt(1)
    s_nop 0
    v_mfma_f32_16x16x32_bf16 v[148:151], v[108:111], v[132:135], 0
    s_waitcnt lgkmcnt(0)
    v_mfma_f32_16x16x32_bf16 v[140:143], v[102:105], v[132:135], 0
    v_mov_b32 v158, v144
    s_nop 1
    v_permlane16_swap_b32 v144, v158
    v_rcp_f32 v158, v158
    s_nop 0
    v_pk_mul_f32 v[136:137], v[136:137], v[158:159] op_sel_hi:[1,0]
    v_pk_mul_f32 v[138:139], v[138:139], v[158:159] op_sel_hi:[1,0]
    v_pk_mul_f32 v[144:145], v[144:145], v[158:159] op_sel_hi:[1,0]
    v_pk_mul_f32 v[146:147], v[146:147], v[158:159] op_sel_hi:[1,0]
    v_cvt_pk_bf16_f32 v112, v136, v137
    v_cvt_pk_bf16_f32 v116, v144, v145
    v_cvt_pk_bf16_f32 v113, v138, v139
    v_cvt_pk_bf16_f32 v117, v146, v147
    v_mov_b32 v160, v148
    s_nop 1
    v_permlane16_swap_b32 v148, v160
    v_rcp_f32_e64 v160, v160
    s_nop 0
    v_pk_mul_f32 v[140:141], v[140:141], v[160:161] op_sel_hi:[1,0]
    v_pk_mul_f32 v[142:143], v[142:143], v[160:161] op_sel_hi:[1,0]
    v_pk_mul_f32 v[148:149], v[148:149], v[160:161] op_sel_hi:[1,0]
    v_pk_mul_f32 v[150:151], v[150:151], v[160:161] op_sel_hi:[1,0]
    v_cvt_pk_bf16_f32 v114, v140, v141
    v_cvt_pk_bf16_f32 v118, v148, v149
    v_cvt_pk_bf16_f32 v115, v142, v143
    v_cvt_pk_bf16_f32 v119, v150, v151
    v_permlane16_swap_b32 v112, v114
    v_permlane16_swap_b32 v113, v115
    v_permlane16_swap_b32 v116, v118
    v_permlane16_swap_b32 v117, v119
    buffer_store_dwordx4 v[112:115], v45, s[16:19], s25 offen sc1
    s_mov_b64 exec, s[80:81]
    buffer_store_dwordx2 v[116:117], v46, s[16:19], s26 offen sc1
    s_mov_b64 exec, -1
oe_75:
    s_waitcnt vmcnt(15)
    v_mfma_f32_16x16x32_bf16 v[112:115], a[176:179], v[216:219], 0
    v_mov_b32 v136, 0
    v_mov_b32 v137, 0
    s_waitcnt vmcnt(14)
    v_mfma_f32_16x16x32_bf16 v[116:119], a[176:179], v[220:223], 0
    v_mov_b32 v138, 0
    v_mov_b32 v139, 0
    s_waitcnt vmcnt(13)
    v_mfma_f32_16x16x32_bf16 v[112:115], a[196:199], v[224:227], v[112:115]
    v_mov_b32 v140, 0
    v_mov_b32 v141, 0
    s_waitcnt vmcnt(12)
    v_mfma_f32_16x16x32_bf16 v[116:119], a[196:199], v[228:231], v[116:119]
    s_mov_b32 s25, 14680064
    s_add_u32 s26, s36, 14680064
    s_waitcnt vmcnt(11)
    v_mfma_f32_16x16x32_bf16 v[112:115], a[216:219], v[232:235], v[112:115]
    s_add_u32 s27, s35, 3506176
    s_mov_b32 s28, 0x99999999
    s_waitcnt vmcnt(10)
    v_mfma_f32_16x16x32_bf16 v[116:119], a[216:219], v[236:239], v[116:119]
    s_mov_b32 s29, 0x99999999
    s_waitcnt vmcnt(9)
    v_mfma_f32_16x16x32_bf16 v[112:115], a[236:239], v[240:243], v[112:115]
    s_waitcnt vmcnt(8)
    v_mfma_f32_16x16x32_bf16 v[116:119], a[236:239], v[244:247], v[116:119]
    s_waitcnt vmcnt(5)
    v_mfma_f32_16x16x32_bf16 v[112:115], v[52:55], v[248:251], v[112:115]
    s_waitcnt vmcnt(4)
    v_mfma_f32_16x16x32_bf16 v[116:119], v[52:55], v[252:255], v[116:119]
    v_mfma_f32_16x16x32_bf16 v[88:91], a[164:167], v[216:219], 0
    v_mfma_f32_16x16x32_bf16 v[92:95], a[164:167], v[220:223], 0
    v_mfma_f32_16x16x32_bf16 v[88:91], a[184:187], v[224:227], v[88:91]
    s_waitcnt vmcnt(3)
    v_max3_u32 v132, v208, v209, v210
    s_waitcnt vmcnt(2)
    v_max3_u32 v132, v132, v211, v212
    v_mfma_f32_16x16x32_bf16 v[92:95], a[184:187], v[228:231], v[92:95]
    v_cmp_eq_u32 s[82:83], -1, v132
    v_mfma_f32_16x16x32_bf16 v[88:91], a[204:207], v[232:235], v[88:91]
    v_mfma_f32_16x16x32_bf16 v[92:95], a[204:207], v[236:239], v[92:95]
    v_cmp_u_f32 vcc, v112, v116
    s_nop 0
    s_or_b64 vcc, vcc, s[82:83]
    s_cbranch_vccnz rd_76
rc_77:
    v_mfma_f32_16x16x32_bf16 v[88:91], a[224:227], v[240:243], v[88:91]
    ds_write_b128 v203, v[112:115] offset:24576
    v_mfma_f32_16x16x32_bf16 v[92:95], a[224:227], v[244:247], v[92:95]
    v_mfma_f32_16x16x32_bf16 v[88:91], a[244:247], v[248:251], v[88:91]
    ds_write_b128 v203, v[116:119] offset:25600
    v_mfma_f32_16x16x32_bf16 v[92:95], a[244:247], v[252:255], v[92:95]
    v_mfma_f32_16x16x32_bf16 v[96:99], a[168:171], v[216:219], 0
    v_lshlrev_b32_e64 v120, 16, v208
    v_and_b32 v121, 0xffff0000, v208
    v_mfma_f32_16x16x32_bf16 v[100:103], a[168:171], v[220:223], 0
    v_lshlrev_b32_e64 v122, 16, v209
    v_and_b32 v123, 0xffff0000, v209
    v_mfma_f32_16x16x32_bf16 v[96:99], a[188:191], v[224:227], v[96:99]
    v_lshlrev_b32_e64 v124, 16, v210
    v_and_b32 v125, 0xffff0000, v210
    v_mfma_f32_16x16x32_bf16 v[100:103], a[188:191], v[228:231], v[100:103]
    v_lshlrev_b32_e64 v126, 16, v211
    v_and_b32 v127, 0xffff0000, v211
    v_mfma_f32_16x16x32_bf16 v[96:99], a[208:211], v[232:235], v[96:99]
    v_lshlrev_b32_e64 v128, 16, v212
    v_and_b32 v129, 0xffff0000, v212
    v_mfma_f32_16x16x32_bf16 v[100:103], a[208:211], v[236:239], v[100:103]
    v_mfma_f32_16x16x32_bf16 v[96:99], a[228:231], v[240:243], v[96:99]
    ds_write_b128 v200, v[88:91] offset:0
    v_mfma_f32_16x16x32_bf16 v[100:103], a[228:231], v[244:247], v[100:103]
    v_mfma_f32_16x16x32_bf16 v[96:99], a[248:251], v[248:251], v[96:99]
    ds_write_b128 v200, v[92:95] offset:1024
    v_mfma_f32_16x16x32_bf16 v[100:103], a[248:251], v[252:255], v[100:103]
    v_mfma_f32_16x16x32_bf16 v[104:107], a[172:175], v[216:219], 0
    v_mfma_f32_16x16x32_bf16 v[108:111], a[172:175], v[220:223], 0
    v_mfma_f32_16x16x32_bf16 v[104:107], a[192:195], v[224:227], v[104:107]
    v_mfma_f32_16x16x32_bf16 v[108:111], a[192:195], v[228:231], v[108:111]
    v_mfma_f32_16x16x32_bf16 v[104:107], a[212:215], v[232:235], v[104:107]
    v_mfma_f32_16x16x32_bf16 v[108:111], a[212:215], v[236:239], v[108:111]
    v_mfma_f32_16x16x32_bf16 v[104:107], a[232:235], v[240:243], v[104:107]
    ds_write_b128 v201, v[96:99] offset:2048
    v_mfma_f32_16x16x32_bf16 v[108:111], a[232:235], v[244:247], v[108:111]
    v_mfma_f32_16x16x32_bf16 v[104:107], a[252:255], v[248:251], v[104:107]
    ds_write_b128 v201, v[100:103] offset:3072
    v_mfma_f32_16x16x32_bf16 v[108:111], a[252:255], v[252:255], v[108:111]
    v_mfma_f32_16x16x32_bf16 v[80:83], a[160:163], v[216:219], v[120:123]
    v_mfma_f32_16x16x32_bf16 v[84:87], a[160:163], v[220:223], v[124:127]
    v_mfma_f32_16x16x32_bf16 v[80:83], a[180:183], v[224:227], v[80:83]
    v_mfma_f32_16x16x32_bf16 v[84:87], a[180:183], v[228:231], v[84:87]
    v_mfma_f32_16x16x32_bf16 v[80:83], a[200:203], v[232:235], v[80:83]
    s_nop 0
    ds_write_b128 v202, v[104:107] offset:4096
    v_mfma_f32_16x16x32_bf16 v[84:87], a[200:203], v[236:239], v[84:87]
    ds_write_b128 v202, v[108:111] offset:5120
    v_mfma_f32_16x16x32_bf16 v[80:83], a[220:223], v[240:243], v[80:83]
    v_mfma_f32_16x16x32_bf16 v[84:87], a[220:223], v[244:247], v[84:87]
    v_mfma_f32_16x16x32_bf16 v[80:83], a[240:243], v[248:251], v[80:83]
    v_mfma_f32_16x16x32_bf16 v[84:87], a[240:243], v[252:255], v[84:87]
    s_waitcnt lgkmcnt(0)
    s_barrier
    s_nop 0
    ds_read_b128 v[88:91], v204 offset:0
    ds_read_b128 v[92:95], v204 offset:1024
    ds_read_b128 v[96:99], v204 offset:2048
    ds_read_b128 v[100:103], v204 offset:3072
    ds_read_b128 v[104:107], v204 offset:4096
    ds_read_b128 v[108:111], v204 offset:5120
    ds_read_b64 v[112:113], v205 offset:24576
    ds_read_b64 v[114:115], v205 offset:26624
    ds_read_b64 v[116:117], v205 offset:28672
    ds_read_b64 v[118:119], v205 offset:30720
    s_mov_b32 s96, 12062720
    buffer_load_dwordx4 v[216:219], v56, s[16:19], s96 offen offset:0 sc1
    buffer_load_dwordx4 v[220:223], v56, s[16:19], s96 offen offset:256 sc1
    s_mov_b32 s96, 12095488
    buffer_load_dwordx4 v[224:227], v56, s[16:19], s96 offen offset:0 sc1
    buffer_load_dwordx4 v[228:231], v56, s[16:19], s96 offen offset:256 sc1
    s_mov_b32 s96, 12128256
    buffer_load_dwordx4 v[232:235], v56, s[16:19], s96 offen offset:0 sc1
    buffer_load_dwordx4 v[236:239], v56, s[16:19], s96 offen offset:256 sc1
    s_waitcnt lgkmcnt(9)
    v_pk_add_f32 v[80:81], v[80:81], v[88:89]
    v_pk_add_f32 v[82:83], v[82:83], v[90:91]
    s_waitcnt lgkmcnt(8)
    v_pk_add_f32 v[84:85], v[84:85], v[92:93]
    v_pk_add_f32 v[86:87], v[86:87], v[94:95]
    s_waitcnt lgkmcnt(7)
    v_pk_add_f32 v[80:81], v[80:81], v[96:97]
    v_pk_add_f32 v[82:83], v[82:83], v[98:99]
    s_waitcnt lgkmcnt(6)
    v_pk_add_f32 v[84:85], v[84:85], v[100:101]
    v_pk_add_f32 v[86:87], v[86:87], v[102:103]
    s_waitcnt lgkmcnt(5)
    v_pk_add_f32 v[80:81], v[80:81], v[104:105]
    v_pk_add_f32 v[82:83], v[82:83], v[106:107]
    s_waitcnt lgkmcnt(4)
    v_pk_add_f32 v[84:85], v[84:85], v[108:109]
    v_pk_add_f32 v[86:87], v[86:87], v[110:111]
    v_cvt_pk_bf16_f32 v132, v80, v81
    v_cvt_pk_bf16_f32 v133, v82, v83
    v_cvt_pk_bf16_f32 v134, v84, v85
    v_cvt_pk_bf16_f32 v135, v86, v87
    s_waitcnt lgkmcnt(3)
    v_pk_add_f32 v[128:129], v[128:129], v[112:113]
    s_waitcnt lgkmcnt(2)
    v_pk_add_f32 v[128:129], v[128:129], v[114:115]
    s_waitcnt lgkmcnt(1)
    v_pk_add_f32 v[128:129], v[128:129], v[116:117]
    s_waitcnt lgkmcnt(0)
    v_pk_add_f32 v[128:129], v[128:129], v[118:119]
    v_cvt_pk_bf16_f32 v130, v128, v129
    buffer_store_dwordx4 v[132:135], v59, s[16:19], s25 offen sc1
    buffer_store_dword v130, v61, s[16:19], s26 offen sc1
    v_dot2c_f32_bf16 v136, v132, v215
    v_dot2c_f32_bf16 v137, v132, v132
    v_dot2c_f32_bf16 v136, v133, v215
    v_dot2c_f32_bf16 v137, v133, v133
    v_dot2c_f32_bf16 v138, v134, v215
    v_dot2c_f32_bf16 v139, v134, v134
    v_dot2c_f32_bf16 v138, v135, v215
    v_dot2c_f32_bf16 v139, v135, v135
    v_dot2c_f32_bf16 v140, v130, v215
    v_dot2c_f32_bf16 v141, v130, v130
    v_permlane32_swap_b32 v136, v138
    v_permlane32_swap_b32 v137, v139
    v_pk_add_f32 v[136:137], v[136:137], v[138:139]
    v_pk_add_f32 v[136:137], v[136:137], v[140:141]
    s_nop 1
    v_permlane16_swap_b32 v136, v137
    v_add_f32_e64 v136, v136, v137
    ds_write_b32 v206, v136 offset:32768
    s_mov_b32 s96, 12161024
    buffer_load_dwordx4 v[240:243], v56, s[16:19], s96 offen offset:0 sc1
    buffer_load_dwordx4 v[244:247], v56, s[16:19], s96 offen offset:256 sc1
    s_mov_b32 s96, 12060672
    buffer_load_dwordx2 v[248:249], v57, s[16:19], s96 offen offset:0 sc1
    buffer_load_dwordx2 v[252:253], v57, s[16:19], s96 offen offset:128 sc1
    s_mov_b32 s96, 12077056
    buffer_load_dwordx2 v[250:251], v57, s[16:19], s96 offen offset:0 sc1
    buffer_load_dwordx2 v[254:255], v57, s[16:19], s96 offen offset:128 sc1
    s_mov_b32 s96, 9439232
    buffer_load_dwordx4 v[208:211], v59, s[16:19], s96 offen sc1
    s_add_u32 s97, s36, 9439232
    buffer_load_dword v212, v61, s[16:19], s97 offen sc1
    s_waitcnt lgkmcnt(0)
    s_barrier
    ds_read2st64_b32 v[136:137], v207 offset0:0 offset1:1
    ds_read2st64_b32 v[138:139], v207 offset0:2 offset1:3
    ds_read_b64_tr_b16 v[144:145], v65 offset:32
    ds_read_b64_tr_b16 v[146:147], v65 offset:0
    ds_read_b64_tr_b16 v[148:149], v65 offset:160
    ds_read_b64_tr_b16 v[150:151], v65 offset:128
    ds_read_b64_tr_b16 v[152:153], v65 offset:288
    ds_read_b64_tr_b16 v[154:155], v65 offset:256
    ds_read_b64_tr_b16 v[156:157], v65 offset:416
    ds_read_b64_tr_b16 v[158:159], v65 offset:384
    ds_read_b64_tr_b16 v[160:161], v65 offset:544
    ds_read_b64_tr_b16 v[162:163], v65 offset:512
    ds_read_b64_tr_b16 v[164:165], v65 offset:672
    ds_read_b64_tr_b16 v[166:167], v65 offset:640
    ds_read_b64_tr_b16 v[168:169], v65 offset:800
    ds_read_b64_tr_b16 v[170:171], v65 offset:768
    ds_read_b64_tr_b16 v[172:173], v65 offset:928
    ds_read_b64_tr_b16 v[174:175], v65 offset:896
    s_waitcnt lgkmcnt(15)
    v_pk_add_f32 v[136:137], v[136:137], v[138:139]
    v_add_f32 v136, v136, v137
    v_cndmask_b32 v136, v136, 1.0, s[28:29]
    s_mov_b64 exec, s[80:81]
    buffer_atomic_add_f32 v136, v214, s[16:19], s27 offen sc1
    s_mov_b64 exec, -1
    v_lshrrev_b32 v176, 4, v0
    v_mul_u32_u24 v176, 1216, v176
    v_and_b32 v177, 15, v0
    v_lshl_add_u32 v176, v177, 3, v176
    v_add_u32 v176, 64, v176
    v_mov_b32 v178, 0
    v_mov_b32 v179, 0
    ds_write_b64 v176, v[178:179]
    v_mov_b32 v70, 0
    v_mov_b32 v71, 0
    v_mov_b32 v72, 0
oe_78:
    s_waitcnt vmcnt(16)
    v_mfma_f32_16x16x32_bf16 v[112:115], a[176:179], v[216:219], 0
    v_mov_b32 v136, 0
    v_mov_b32 v137, 0
    s_waitcnt vmcnt(15)
    v_mfma_f32_16x16x32_bf16 v[116:119], a[176:179], v[220:223], 0
    v_mov_b32 v138, 0
    v_mov_b32 v139, 0
    s_waitcnt vmcnt(14)
    v_mfma_f32_16x16x32_bf16 v[112:115], a[196:199], v[224:227], v[112:115]
    v_mov_b32 v140, 0
    v_mov_b32 v141, 0
    s_waitcnt vmcnt(13)
    v_mfma_f32_16x16x32_bf16 v[116:119], a[196:199], v[228:231], v[116:119]
    s_mov_b32 s25, 14682112
    s_add_u32 s26, s36, 14682112
    s_waitcnt vmcnt(12)
    v_mfma_f32_16x16x32_bf16 v[112:115], a[216:219], v[232:235], v[112:115]
    s_add_u32 s27, s35, 3510272
    s_mov_b32 s28, 0x99999999
    s_waitcnt vmcnt(11)
    v_mfma_f32_16x16x32_bf16 v[116:119], a[216:219], v[236:239], v[116:119]
    s_mov_b32 s29, 0x99999999
    s_waitcnt vmcnt(8)
    v_mfma_f32_16x16x32_bf16 v[112:115], a[236:239], v[240:243], v[112:115]
    s_waitcnt vmcnt(7)
    v_mfma_f32_16x16x32_bf16 v[116:119], a[236:239], v[244:247], v[116:119]
    s_waitcnt vmcnt(4)
    v_mfma_f32_16x16x32_bf16 v[112:115], v[52:55], v[248:251], v[112:115]
    s_waitcnt vmcnt(3)
    v_mfma_f32_16x16x32_bf16 v[116:119], v[52:55], v[252:255], v[116:119]
    v_mfma_f32_16x16x32_bf16 v[88:91], a[164:167], v[216:219], 0
    v_mfma_f32_16x16x32_bf16 v[92:95], a[164:167], v[220:223], 0
    v_mfma_f32_16x16x32_bf16 v[88:91], a[184:187], v[224:227], v[88:91]
    s_waitcnt vmcnt(2)
    v_max3_u32 v132, v208, v209, v210
    s_waitcnt vmcnt(1)
    v_max3_u32 v132, v132, v211, v212
    v_mfma_f32_16x16x32_bf16 v[92:95], a[184:187], v[228:231], v[92:95]
    v_cmp_eq_u32 s[82:83], -1, v132
    v_mfma_f32_16x16x32_bf16 v[88:91], a[204:207], v[232:235], v[88:91]
    v_mfma_f32_16x16x32_bf16 v[92:95], a[204:207], v[236:239], v[92:95]
    v_cmp_u_f32 vcc, v112, v116
    s_nop 0
    s_or_b64 vcc, vcc, s[82:83]
    s_cbranch_vccnz rd_79
rc_80:
    v_mfma_f32_16x16x32_bf16 v[88:91], a[224:227], v[240:243], v[88:91]
    ds_write_b128 v203, v[112:115] offset:24576
    v_mfma_f32_16x16x32_bf16 v[92:95], a[224:227], v[244:247], v[92:95]
    v_mfma_f32_16x16x32_bf16 v[88:91], a[244:247], v[248:251], v[88:91]
    ds_write_b128 v203, v[116:119] offset:25600
    v_mfma_f32_16x16x32_bf16 v[92:95], a[244:247], v[252:255], v[92:95]
    v_mfma_f32_16x16x32_bf16 v[96:99], a[168:171], v[216:219], 0
    v_lshlrev_b32_e64 v120, 16, v208
    v_and_b32 v121, 0xffff0000, v208
    v_mfma_f32_16x16x32_bf16 v[100:103], a[168:171], v[220:223], 0
    v_lshlrev_b32_e64 v122, 16, v209
    v_and_b32 v123, 0xffff0000, v209
    v_mfma_f32_16x16x32_bf16 v[96:99], a[188:191], v[224:227], v[96:99]
    v_lshlrev_b32_e64 v124, 16, v210
    v_and_b32 v125, 0xffff0000, v210
    v_mfma_f32_16x16x32_bf16 v[100:103], a[188:191], v[228:231], v[100:103]
    v_lshlrev_b32_e64 v126, 16, v211
    v_and_b32 v127, 0xffff0000, v211
    v_mfma_f32_16x16x32_bf16 v[96:99], a[208:211], v[232:235], v[96:99]
    v_lshlrev_b32_e64 v128, 16, v212
    v_and_b32 v129, 0xffff0000, v212
    v_mfma_f32_16x16x32_bf16 v[100:103], a[208:211], v[236:239], v[100:103]
    v_mfma_f32_16x16x32_bf16 v[96:99], a[228:231], v[240:243], v[96:99]
    ds_write_b128 v200, v[88:91] offset:0
    v_mfma_f32_16x16x32_bf16 v[100:103], a[228:231], v[244:247], v[100:103]
    v_mfma_f32_16x16x32_bf16 v[96:99], a[248:251], v[248:251], v[96:99]
    ds_write_b128 v200, v[92:95] offset:1024
    v_mfma_f32_16x16x32_bf16 v[100:103], a[248:251], v[252:255], v[100:103]
    v_mfma_f32_16x16x32_bf16 v[104:107], a[172:175], v[216:219], 0
    v_mfma_f32_16x16x32_bf16 v[108:111], a[172:175], v[220:223], 0
    v_mfma_f32_16x16x32_bf16 v[104:107], a[192:195], v[224:227], v[104:107]
    v_mfma_f32_16x16x32_bf16 v[108:111], a[192:195], v[228:231], v[108:111]
    v_mfma_f32_16x16x32_bf16 v[104:107], a[212:215], v[232:235], v[104:107]
    v_mfma_f32_16x16x32_bf16 v[108:111], a[212:215], v[236:239], v[108:111]
    v_mfma_f32_16x16x32_bf16 v[104:107], a[232:235], v[240:243], v[104:107]
    ds_write_b128 v201, v[96:99] offset:2048
    v_mfma_f32_16x16x32_bf16 v[108:111], a[232:235], v[244:247], v[108:111]
    v_mfma_f32_16x16x32_bf16 v[104:107], a[252:255], v[248:251], v[104:107]
    ds_write_b128 v201, v[100:103] offset:3072
    v_mfma_f32_16x16x32_bf16 v[108:111], a[252:255], v[252:255], v[108:111]
    v_mfma_f32_16x16x32_bf16 v[80:83], a[160:163], v[216:219], v[120:123]
    v_mfma_f32_16x16x32_bf16 v[84:87], a[160:163], v[220:223], v[124:127]
    v_mfma_f32_16x16x32_bf16 v[80:83], a[180:183], v[224:227], v[80:83]
    v_mfma_f32_16x16x32_bf16 v[84:87], a[180:183], v[228:231], v[84:87]
    v_mfma_f32_16x16x32_bf16 v[80:83], a[200:203], v[232:235], v[80:83]
    s_nop 0
    ds_write_b128 v202, v[104:107] offset:4096
    v_mfma_f32_16x16x32_bf16 v[84:87], a[200:203], v[236:239], v[84:87]
    ds_write_b128 v202, v[108:111] offset:5120
    v_mfma_f32_16x16x32_bf16 v[80:83], a[220:223], v[240:243], v[80:83]
    v_mfma_f32_16x16x32_bf16 v[84:87], a[220:223], v[244:247], v[84:87]
    v_mfma_f32_16x16x32_bf16 v[80:83], a[240:243], v[248:251], v[80:83]
    v_mfma_f32_16x16x32_bf16 v[84:87], a[240:243], v[252:255], v[84:87]
    s_waitcnt lgkmcnt(0)
    s_barrier
    s_nop 0
    ds_read_b128 v[88:91], v204 offset:0
    ds_read_b128 v[92:95], v204 offset:1024
    ds_read_b128 v[96:99], v204 offset:2048
    ds_read_b128 v[100:103], v204 offset:3072
    ds_read_b128 v[104:107], v204 offset:4096
    ds_read_b128 v[108:111], v204 offset:5120
    ds_read_b64 v[112:113], v205 offset:24576
    ds_read_b64 v[114:115], v205 offset:26624
    ds_read_b64 v[116:117], v205 offset:28672
    ds_read_b64 v[118:119], v205 offset:30720
    s_lshl_b32 s96, s75, 14
    s_add_u32 s96, s96, 14680064
    s_lshl_b32 s97, s24, 12
    s_add_u32 s97, s97, 3506176
    buffer_load_dwordx4 v[176:179], v62, s[16:19], s96 offen offset:0 sc1
    buffer_load_dwordx4 v[180:183], v62, s[16:19], s96 offen offset:1024 sc1
    buffer_load_dwordx4 v[184:187], v62, s[16:19], s97 offen offset:0 sc1
    buffer_load_dwordx4 v[188:191], v62, s[16:19], s97 offen offset:1024 sc1
    buffer_load_dwordx4 v[192:195], v62, s[16:19], s97 offen offset:2048 sc1
    buffer_load_dwordx4 v[196:199], v62, s[16:19], s97 offen offset:3072 sc1
    s_waitcnt lgkmcnt(9)
    v_pk_add_f32 v[80:81], v[80:81], v[88:89]
    v_pk_add_f32 v[82:83], v[82:83], v[90:91]
    s_waitcnt lgkmcnt(8)
    v_pk_add_f32 v[84:85], v[84:85], v[92:93]
    v_pk_add_f32 v[86:87], v[86:87], v[94:95]
    s_waitcnt lgkmcnt(7)
    v_pk_add_f32 v[80:81], v[80:81], v[96:97]
    v_pk_add_f32 v[82:83], v[82:83], v[98:99]
    s_waitcnt lgkmcnt(6)
    v_pk_add_f32 v[84:85], v[84:85], v[100:101]
    v_pk_add_f32 v[86:87], v[86:87], v[102:103]
    s_waitcnt lgkmcnt(5)
    v_pk_add_f32 v[80:81], v[80:81], v[104:105]
    v_pk_add_f32 v[82:83], v[82:83], v[106:107]
    s_waitcnt lgkmcnt(4)
    v_pk_add_f32 v[84:85], v[84:85], v[108:109]
    v_pk_add_f32 v[86:87], v[86:87], v[110:111]
    v_cvt_pk_bf16_f32 v132, v80, v81
    v_cvt_pk_bf16_f32 v133, v82, v83
    v_cvt_pk_bf16_f32 v134, v84, v85
    v_cvt_pk_bf16_f32 v135, v86, v87
    s_waitcnt lgkmcnt(3)
    v_pk_add_f32 v[128:129], v[128:129], v[112:113]
    s_waitcnt lgkmcnt(2)
    v_pk_add_f32 v[128:129], v[128:129], v[114:115]
    s_waitcnt lgkmcnt(1)
    v_pk_add_f32 v[128:129], v[128:129], v[116:117]
    s_waitcnt lgkmcnt(0)
    v_pk_add_f32 v[128:129], v[128:129], v[118:119]
    v_cvt_pk_bf16_f32 v130, v128, v129
    buffer_store_dwordx4 v[132:135], v59, s[16:19], s25 offen sc1
    buffer_store_dword v130, v61, s[16:19], s26 offen sc1
    v_dot2c_f32_bf16 v136, v132, v215
    v_dot2c_f32_bf16 v137, v132, v132
    v_dot2c_f32_bf16 v136, v133, v215
    v_dot2c_f32_bf16 v137, v133, v133
    v_dot2c_f32_bf16 v138, v134, v215
    v_dot2c_f32_bf16 v139, v134, v134
    v_dot2c_f32_bf16 v138, v135, v215
    v_dot2c_f32_bf16 v139, v135, v135
    v_dot2c_f32_bf16 v140, v130, v215
    v_dot2c_f32_bf16 v141, v130, v130
    v_permlane32_swap_b32 v136, v138
    v_permlane32_swap_b32 v137, v139
    v_pk_add_f32 v[136:137], v[136:137], v[138:139]
    v_pk_add_f32 v[136:137], v[136:137], v[140:141]
    s_nop 1
    v_permlane16_swap_b32 v136, v137
    v_add_f32 v136, v136, v137
    ds_write_b32 v206, v136 offset:32768
    s_waitcnt lgkmcnt(0)
    s_barrier
    ds_read2st64_b32 v[136:137], v207 offset0:0 offset1:1
    ds_read2st64_b32 v[138:139], v207 offset0:2 offset1:3
    s_waitcnt lgkmcnt(0)
    v_pk_add_f32 v[136:137], v[136:137], v[138:139]
    v_add_f32 v136, v136, v137
    v_cndmask_b32 v136, v136, 1.0, s[28:29]
    s_mov_b64 exec, s[80:81]
    buffer_atomic_add_f32 v136, v214, s[16:19], s27 offen sc1
    s_mov_b64 exec, -1
    s_cmp_ge_u32 s2, 160
    s_cbranch_scc1 nc_81
    s_waitcnt vmcnt(3)
ce_83:
    v_max3_u32 v208, v176, v177, v178
    v_max3_u32 v208, v208, v179, v180
    v_max3_u32 v208, v208, v181, v182
    v_max_u32 v208, v208, v183
    v_cmp_eq_u32 s[82:83], -1, v208
    v_min3_f32 v209, v184, v187, v188
    v_min3_f32 v209, v209, v191, v192
    v_min3_f32 v209, v209, v195, v196
    v_min_f32 v209, v209, v199
    v_cmp_neq_f32 vcc, 0x41000000, v209
    s_nop 0
    s_or_b64 vcc, vcc, s[82:83]
    s_cbranch_vccnz rd_84
rc_85:
    v_mul_f32 v208, 0x3acccccd, v185
    v_mul_f32 v209, 0x3acccccd, v189
    v_mul_f32 v186, 0x3acccccd, v186
    v_mul_f32 v190, 0x3acccccd, v190
    v_fma_f32 v186, -v208, v208, v186
    v_fma_f32 v190, -v209, v209, v190
    v_max_f32 v186, 0, v186
    v_max_f32 v190, 0, v190
    v_add_f32 v186, 0x3727c5ac, v186
    v_add_f32 v190, 0x3727c5ac, v190
    v_rsq_f32 v185, v186
    v_rsq_f32 v189, v190
    v_mul_f32 v186, -v208, v185
    v_mul_f32 v190, -v209, v189
    v_lshlrev_b32 v80, 16, v176
    v_and_b32 v82, 0xffff0000, v176
    v_lshlrev_b32 v84, 16, v177
    v_and_b32 v86, 0xffff0000, v177
    v_lshlrev_b32 v81, 16, v178
    v_and_b32 v83, 0xffff0000, v178
    v_lshlrev_b32 v85, 16, v179
    v_and_b32 v87, 0xffff0000, v179
    v_fma_f32 v208, v80, v185, v186
    v_fma_f32 v209, v81, v189, v190
    v_cvt_pk_bf16_f32 v176, v208, v209
    v_fma_f32 v208, v82, v185, v186
    v_fma_f32 v209, v83, v189, v190
    v_cvt_pk_bf16_f32 v177, v208, v209
    v_fma_f32 v208, v84, v185, v186
    v_fma_f32 v209, v85, v189, v190
    v_cvt_pk_bf16_f32 v178, v208, v209
    v_fma_f32 v208, v86, v185, v186
    v_fma_f32 v209, v87, v189, v190
    v_cvt_pk_bf16_f32 v179, v208, v209
    ds_write_b32 v63, v176 offset:0
    ds_write_b32 v63, v177 offset:4864
    ds_write_b32 v63, v178 offset:9728
    ds_write_b32 v63, v179 offset:14592
    v_mul_f32 v208, 0x3acccccd, v193
    v_mul_f32 v209, 0x3acccccd, v197
    v_mul_f32 v194, 0x3acccccd, v194
    v_mul_f32 v198, 0x3acccccd, v198
    v_fma_f32 v194, -v208, v208, v194
    v_fma_f32 v198, -v209, v209, v198
    v_max_f32 v194, 0, v194
    v_max_f32 v198, 0, v198
    v_add_f32 v194, 0x3727c5ac, v194
    v_add_f32 v198, 0x3727c5ac, v198
    v_rsq_f32 v193, v194
    v_rsq_f32 v197, v198
    v_mul_f32 v194, -v208, v193
    v_mul_f32 v198, -v209, v197
    v_lshlrev_b32 v88, 16, v180
    v_and_b32 v90, 0xffff0000, v180
    v_lshlrev_b32 v92, 16, v181
    v_and_b32 v94, 0xffff0000, v181
    v_lshlrev_b32 v89, 16, v182
    v_and_b32 v91, 0xffff0000, v182
    v_lshlrev_b32 v93, 16, v183
    v_and_b32 v95, 0xffff0000, v183
    v_fma_f32 v208, v88, v193, v194
    v_fma_f32 v209, v89, v197, v198
    v_cvt_pk_bf16_f32 v180, v208, v209
    v_fma_f32 v208, v90, v193, v194
    v_fma_f32 v209, v91, v197, v198
    v_cvt_pk_bf16_f32 v181, v208, v209
    v_fma_f32 v208, v92, v193, v194
    v_fma_f32 v209, v93, v197, v198
    v_cvt_pk_bf16_f32 v182, v208, v209
    v_fma_f32 v208, v94, v193, v194
    v_fma_f32 v209, v95, v197, v198
    v_cvt_pk_bf16_f32 v183, v208, v209
    ds_write_b32 v63, v180 offset:256
    ds_write_b32 v63, v181 offset:5120
    ds_write_b32 v63, v182 offset:9984
    ds_write_b32 v63, v183 offset:14848
    s_waitcnt lgkmcnt(0)
    s_barrier
    ds_read_b128 v[212:215], v64 offset:96
    ds_read_b128 v[216:219], v64 offset:64
    ds_read_b128 v[220:223], v64 offset:32
    ds_read_b128 v[224:227], v64 offset:0
    s_waitcnt lgkmcnt(3)
    v_mfma_f32_32x32x16_bf16 v[96:111], v[212:215], v[144:147], 0
    ds_read_b128 v[228:231], v64 offset:224
    ds_read_b64_tr_b16 v[176:177], v65 offset:1056
    ds_read_b64_tr_b16 v[178:179], v65 offset:1024
    ds_read_b64_tr_b16 v[180:181], v65 offset:1184
    ds_read_b64_tr_b16 v[182:183], v65 offset:1152
    s_waitcnt lgkmcnt(7)
    v_mfma_f32_32x32x16_bf16 v[96:111], v[216:219], v[148:151], v[96:111]
    ds_read_b128 v[232:235], v64 offset:192
    ds_read_b64_tr_b16 v[184:185], v65 offset:1312
    ds_read_b64_tr_b16 v[186:187], v65 offset:1280
    ds_read_b64_tr_b16 v[188:189], v65 offset:1440
    ds_read_b64_tr_b16 v[190:191], v65 offset:1408
    s_waitcnt lgkmcnt(11)
    v_mfma_f32_32x32x16_bf16 v[96:111], v[220:223], v[152:155], v[96:111]
    ds_read_b128 v[236:239], v64 offset:160
    ds_read_b64_tr_b16 v[192:193], v65 offset:1568
    ds_read_b64_tr_b16 v[194:195], v65 offset:1536
    ds_read_b64_tr_b16 v[196:197], v65 offset:1696
    ds_read_b64_tr_b16 v[198:199], v65 offset:1664
    s_waitcnt lgkmcnt(15)
    v_mfma_f32_32x32x16_bf16 v[96:111], v[224:227], v[156:159], v[96:111]
    ds_read_b128 v[240:243], v64 offset:128
    ds_read_b64_tr_b16 v[200:201], v65 offset:1824
    ds_read_b64_tr_b16 v[202:203], v65 offset:1792
    ds_read_b64_tr_b16 v[204:205], v65 offset:1952
    ds_read_b64_tr_b16 v[206:207], v65 offset:1920
    s_waitcnt lgkmcnt(15)
    v_mfma_f32_32x32x16_bf16 v[112:127], v[228:231], v[144:147], 0
    s_nop 4
    s_waitcnt lgkmcnt(14)
    v_mfma_f32_32x32x16_bf16 v[112:127], v[232:235], v[148:151], v[112:127]
    v_cndmask_b32 v208, v99, v72, s[76:77]
    v_cndmask_b32 v209, v103, v99, s[76:77]
    v_cndmask_b32 v210, v107, v103, s[76:77]
    v_cndmask_b32 v211, v111, v107, s[76:77]
    v_mov_b32_e64 v72, v111
    s_waitcnt lgkmcnt(9)
    v_mfma_f32_32x32x16_bf16 v[112:127], v[236:239], v[152:155], v[112:127]
    v_add_f32_dpp v98, v208, v98 wave_ror:1 row_mask:0xf bank_mask:0xf
    v_add_f32_dpp v102, v209, v102 wave_ror:1 row_mask:0xf bank_mask:0xf
    v_add_f32_dpp v106, v210, v106 wave_ror:1 row_mask:0xf bank_mask:0xf
    v_add_f32_dpp v110, v211, v110 wave_ror:1 row_mask:0xf bank_mask:0xf
    v_cndmask_b32 v208, v98, v71, s[76:77]
    s_waitcnt lgkmcnt(4)
    v_mfma_f32_32x32x16_bf16 v[112:127], v[240:243], v[156:159], v[112:127]
    v_cndmask_b32 v209, v102, v98, s[76:77]
    v_cndmask_b32 v210, v106, v102, s[76:77]
    v_cndmask_b32 v211, v110, v106, s[76:77]
    v_mov_b32 v71, v110
    v_add_f32_dpp v97, v208, v97 wave_ror:1 row_mask:0xf bank_mask:0xf
    v_add_f32_dpp v101, v209, v101 wave_ror:1 row_mask:0xf bank_mask:0xf
    v_mfma_f32_32x32x16_bf16 v[112:127], v[212:215], v[160:163], v[112:127]
    ds_read_b128 v[244:247], v64 offset:352
    v_add_f32_dpp v105, v210, v105 wave_ror:1 row_mask:0xf bank_mask:0xf
    v_add_f32_dpp v109, v211, v109 wave_ror:1 row_mask:0xf bank_mask:0xf
    v_cndmask_b32 v208, v97, v70, s[76:77]
    v_cndmask_b32 v209, v101, v97, s[76:77]
    v_cndmask_b32 v210, v105, v101, s[76:77]
    v_mfma_f32_32x32x16_bf16 v[112:127], v[216:219], v[164:167], v[112:127]
    ds_read_b128 v[216:219], v64 offset:320
    v_cndmask_b32 v211, v109, v105, s[76:77]
    v_mov_b32_e64 v70, v109
    v_add_f32_dpp v96, v208, v96 wave_ror:1 row_mask:0xf bank_mask:0xf
    v_add_f32_dpp v100, v209, v100 wave_ror:1 row_mask:0xf bank_mask:0xf
    v_add_f32_dpp v104, v210, v104 wave_ror:1 row_mask:0xf bank_mask:0xf
    v_mfma_f32_32x32x16_bf16 v[112:127], v[220:223], v[168:171], v[112:127]
    ds_read_b128 v[220:223], v64 offset:288
    v_add_f32_dpp v108, v211, v108 wave_ror:1 row_mask:0xf bank_mask:0xf
    ds_write_b32 v66, v96 offset:0
    v_mfma_f32_32x32x16_bf16 v[112:127], v[224:227], v[172:175], v[112:127]
    ds_read_b128 v[224:227], v64 offset:256
    ds_write_b32 v66, v100 offset:64
    ds_write_b32 v66, v104 offset:128
    s_waitcnt lgkmcnt(6)
    v_mfma_f32_32x32x16_bf16 v[128:143], v[244:247], v[144:147], 0
    ds_write_b32 v66, v108 offset:192
    s_nop 2
    s_waitcnt lgkmcnt(6)
    v_mfma_f32_32x32x16_bf16 v[128:143], v[216:219], v[148:151], v[128:143]
    s_nop 2
    v_cndmask_b32 v208, v115, v72, s[76:77]
    v_cndmask_b32 v209, v119, v115, s[76:77]
    s_waitcnt lgkmcnt(5)
    v_mfma_f32_32x32x16_bf16 v[128:143], v[220:223], v[152:155], v[128:143]
    v_cndmask_b32 v210, v123, v119, s[76:77]
    v_cndmask_b32 v211, v127, v123, s[76:77]
    v_mov_b32 v72, v127
    v_add_f32_dpp v114, v208, v114 wave_ror:1 row_mask:0xf bank_mask:0xf
    v_add_f32_dpp v118, v209, v118 wave_ror:1 row_mask:0xf bank_mask:0xf
    s_waitcnt lgkmcnt(3)
    v_mfma_f32_32x32x16_bf16 v[128:143], v[224:227], v[156:159], v[128:143]
    v_add_f32_dpp v122, v210, v122 wave_ror:1 row_mask:0xf bank_mask:0xf
    v_add_f32_dpp v126, v211, v126 wave_ror:1 row_mask:0xf bank_mask:0xf
    v_cndmask_b32 v208, v114, v71, s[76:77]
    v_cndmask_b32 v209, v118, v114, s[76:77]
    v_cndmask_b32 v210, v122, v118, s[76:77]
    v_cndmask_b32 v211, v126, v122, s[76:77]
    v_mfma_f32_32x32x16_bf16 v[128:143], v[228:231], v[160:163], v[128:143]
    v_mov_b32 v71, v126
    v_add_f32_dpp v113, v208, v113 wave_ror:1 row_mask:0xf bank_mask:0xf
    v_add_f32_dpp v117, v209, v117 wave_ror:1 row_mask:0xf bank_mask:0xf
    v_add_f32_dpp v121, v210, v121 wave_ror:1 row_mask:0xf bank_mask:0xf
    v_add_f32_dpp v125, v211, v125 wave_ror:1 row_mask:0xf bank_mask:0xf
    v_cndmask_b32 v208, v113, v70, s[76:77]
    v_mfma_f32_32x32x16_bf16 v[128:143], v[232:235], v[164:167], v[128:143]
    ds_read_b128 v[232:235], v64 offset:64
    v_cndmask_b32 v209, v117, v113, s[76:77]
    v_cndmask_b32 v210, v121, v117, s[76:77]
    v_cndmask_b32 v211, v125, v121, s[76:77]
    v_mov_b32_e64 v70, v125
    v_add_f32_dpp v112, v208, v112 wave_ror:1 row_mask:0xf bank_mask:0xf
    v_mfma_f32_32x32x16_bf16 v[128:143], v[236:239], v[168:171], v[128:143]
    ds_read_b128 v[236:239], v64 offset:32
    v_add_f32_dpp v116, v209, v116 wave_ror:1 row_mask:0xf bank_mask:0xf
    v_add_f32_dpp v120, v210, v120 wave_ror:1 row_mask:0xf bank_mask:0xf
    v_add_f32_dpp v124, v211, v124 wave_ror:1 row_mask:0xf bank_mask:0xf
    v_mfma_f32_32x32x16_bf16 v[128:143], v[240:243], v[172:175], v[128:143]
    ds_read_b128 v[240:243], v64 offset:0
    ds_write_b32 v66, v112 offset:256
    ds_write_b32 v66, v116 offset:320
    v_mfma_f32_32x32x16_bf16 v[128:143], v[212:215], v[176:179], v[128:143]
    ds_read_b128 v[212:215], v64 offset:480
    ds_write_b32 v66, v120 offset:384
    ds_write_b32 v66, v124 offset:448
    s_waitcnt lgkmcnt(7)
    v_mfma_f32_32x32x16_bf16 v[128:143], v[232:235], v[180:183], v[128:143]
    ds_read_b128 v[232:235], v64 offset:448
    s_waitcnt lgkmcnt(7)
    v_mfma_f32_32x32x16_bf16 v[128:143], v[236:239], v[184:187], v[128:143]
    ds_read_b128 v[236:239], v64 offset:416
    s_waitcnt lgkmcnt(7)
    v_mfma_f32_32x32x16_bf16 v[128:143], v[240:243], v[188:191], v[128:143]
    ds_read_b128 v[240:243], v64 offset:384
    s_nop 3
    s_waitcnt lgkmcnt(5)
    v_mfma_f32_32x32x16_bf16 v[112:127], v[212:215], v[144:147], 0
    s_nop 4
    s_waitcnt lgkmcnt(2)
    v_mfma_f32_32x32x16_bf16 v[112:127], v[232:235], v[148:151], v[112:127]
    v_cndmask_b32 v208, v131, v72, s[76:77]
    v_cndmask_b32 v209, v135, v131, s[76:77]
    v_cndmask_b32 v210, v139, v135, s[76:77]
    v_cndmask_b32 v211, v143, v139, s[76:77]
    v_mov_b32_e64 v72, v143
    s_waitcnt lgkmcnt(1)
    v_mfma_f32_32x32x16_bf16 v[112:127], v[236:239], v[152:155], v[112:127]
    v_add_f32_dpp v130, v208, v130 wave_ror:1 row_mask:0xf bank_mask:0xf
    v_add_f32_dpp v134, v209, v134 wave_ror:1 row_mask:0xf bank_mask:0xf
    v_add_f32_dpp v138, v210, v138 wave_ror:1 row_mask:0xf bank_mask:0xf
    v_add_f32_dpp v142, v211, v142 wave_ror:1 row_mask:0xf bank_mask:0xf
    v_cndmask_b32 v208, v130, v71, s[76:77]
    s_waitcnt lgkmcnt(0)
    v_mfma_f32_32x32x16_bf16 v[112:127], v[240:243], v[156:159], v[112:127]
    v_cndmask_b32 v209, v134, v130, s[76:77]
    v_cndmask_b32 v210, v138, v134, s[76:77]
    v_cndmask_b32 v211, v142, v138, s[76:77]
    v_mov_b32 v71, v142
    v_add_f32_dpp v129, v208, v129 wave_ror:1 row_mask:0xf bank_mask:0xf
    v_add_f32_dpp v133, v209, v133 wave_ror:1 row_mask:0xf bank_mask:0xf
    v_mfma_f32_32x32x16_bf16 v[112:127], v[244:247], v[160:163], v[112:127]
    v_add_f32_dpp v137, v210, v137 wave_ror:1 row_mask:0xf bank_mask:0xf
    v_add_f32_dpp v141, v211, v141 wave_ror:1 row_mask:0xf bank_mask:0xf
    v_cndmask_b32 v208, v129, v70, s[76:77]
    v_cndmask_b32 v209, v133, v129, s[76:77]
    v_cndmask_b32 v210, v137, v133, s[76:77]
    v_cndmask_b32 v211, v141, v137, s[76:77]
    v_mfma_f32_32x32x16_bf16 v[112:127], v[216:219], v[164:167], v[112:127]
    ds_read_b128 v[240:243], v64 offset:192
    v_mov_b32_e64 v70, v141
    v_add_f32_dpp v128, v208, v128 wave_ror:1 row_mask:0xf bank_mask:0xf
    v_add_f32_dpp v132, v209, v132 wave_ror:1 row_mask:0xf bank_mask:0xf
    v_add_f32_dpp v136, v210, v136 wave_ror:1 row_mask:0xf bank_mask:0xf
    v_add_f32_dpp v140, v211, v140 wave_ror:1 row_mask:0xf bank_mask:0xf
    v_mfma_f32_32x32x16_bf16 v[112:127], v[220:223], v[168:171], v[112:127]
    ds_read_b128 v[220:223], v64 offset:160
    ds_write_b32 v66, v128 offset:512
    ds_write_b32 v66, v132 offset:576
    v_mfma_f32_32x32x16_bf16 v[112:127], v[224:227], v[172:175], v[112:127]
    ds_read_b128 v[224:227], v64 offset:128
    ds_write_b32 v66, v136 offset:640
    ds_write_b32 v66, v140 offset:704
    v_mfma_f32_32x32x16_bf16 v[112:127], v[228:231], v[176:179], v[112:127]
    ds_read_b128 v[236:239], v64 offset:96
    s_waitcnt lgkmcnt(7)
    v_mfma_f32_32x32x16_bf16 v[112:127], v[240:243], v[180:183], v[112:127]
    ds_read_b128 v[240:243], v64 offset:64
    s_waitcnt lgkmcnt(7)
    v_mfma_f32_32x32x16_bf16 v[112:127], v[220:223], v[184:187], v[112:127]
    ds_read_b128 v[220:223], v64 offset:32
    s_waitcnt lgkmcnt(5)
    v_mfma_f32_32x32x16_bf16 v[112:127], v[224:227], v[188:191], v[112:127]
    ds_read_b128 v[224:227], v64 offset:0
    s_waitcnt lgkmcnt(3)
    v_mfma_f32_32x32x16_bf16 v[112:127], v[236:239], v[192:195], v[112:127]
    ds_read_b64_tr_b16 v[216:217], v65 offset:544
    ds_read_b64_tr_b16 v[218:219], v65 offset:512
    s_waitcnt lgkmcnt(4)
    v_mfma_f32_32x32x16_bf16 v[112:127], v[240:243], v[196:199], v[112:127]
    ds_read_b64_tr_b16 v[240:241], v65 offset:1056
    ds_read_b64_tr_b16 v[242:243], v65 offset:1024
    s_waitcnt lgkmcnt(5)
    v_mfma_f32_32x32x16_bf16 v[112:127], v[220:223], v[200:203], v[112:127]
    s_waitcnt lgkmcnt(4)
    v_mfma_f32_32x32x16_bf16 v[112:127], v[224:227], v[204:207], v[112:127]
    ds_read_b64_tr_b16 v[224:225], v65 offset:1568
    ds_read_b64_tr_b16 v[226:227], v65 offset:1536
    s_lshl_b32 s96, s75, 14
    s_add_u32 s96, s96, 14680064
    s_lshl_b32 s97, s24, 12
    s_add_u32 s97, s97, 3510272
    buffer_load_dwordx4 v[248:251], v62, s[16:19], s96 offen offset:2048 sc1
    s_waitcnt lgkmcnt(4)
    v_mfma_f32_32x32x16_bf16 v[144:159], v[212:215], v[216:219], 0
    s_nop 3
    v_cndmask_b32 v208, v115, v72, s[76:77]
    s_waitcnt lgkmcnt(2)
    v_mfma_f32_32x32x16_bf16 v[144:159], v[244:247], v[240:243], v[144:159]
    buffer_load_dwordx4 v[252:255], v62, s[16:19], s96 offen offset:3072 sc1
    v_cndmask_b32 v209, v119, v115, s[76:77]
    v_cndmask_b32 v210, v123, v119, s[76:77]
    v_cndmask_b32 v211, v127, v123, s[76:77]
    v_mov_b32_e64 v72, v127
    v_add_f32_dpp v114, v208, v114 wave_ror:1 row_mask:0xf bank_mask:0xf
    v_mfma_f32_32x32x16_bf16 v[160:175], v[212:215], v[240:243], 0
    ds_read_b64_tr_b16 v[216:217], v65 offset:2080
    ds_read_b64_tr_b16 v[218:219], v65 offset:2048
    v_add_f32_dpp v118, v209, v118 wave_ror:1 row_mask:0xf bank_mask:0xf
    v_add_f32_dpp v122, v210, v122 wave_ror:1 row_mask:0xf bank_mask:0xf
    v_add_f32_dpp v126, v211, v126 wave_ror:1 row_mask:0xf bank_mask:0xf
    s_waitcnt lgkmcnt(2)
    v_mfma_f32_32x32x16_bf16 v[144:159], v[228:231], v[224:227], v[144:159]
    buffer_load_dwordx4 v[96:99], v62, s[16:19], s97 offen offset:0 sc1
    v_cndmask_b32 v208, v114, v71, s[76:77]
    v_cndmask_b32 v209, v118, v114, s[76:77]
    v_cndmask_b32 v210, v122, v118, s[76:77]
    v_cndmask_b32 v211, v126, v122, s[76:77]
    v_mov_b32 v71, v126
    v_mfma_f32_32x32x16_bf16 v[160:175], v[244:247], v[224:227], v[160:175]
    v_add_f32_dpp v113, v208, v113 wave_ror:1 row_mask:0xf bank_mask:0xf
    v_add_f32_dpp v117, v209, v117 wave_ror:1 row_mask:0xf bank_mask:0xf
    v_add_f32_dpp v121, v210, v121 wave_ror:1 row_mask:0xf bank_mask:0xf
    v_add_f32_dpp v125, v211, v125 wave_ror:1 row_mask:0xf bank_mask:0xf
    v_cndmask_b32 v208, v113, v70, s[76:77]
    v_cndmask_b32 v209, v117, v113, s[76:77]
    v_mfma_f32_32x32x16_bf16 v[176:191], v[212:215], v[224:227], 0
    buffer_load_dwordx4 v[100:103], v62, s[16:19], s97 offen offset:1024 sc1
    v_cndmask_b32 v210, v121, v117, s[76:77]
    v_cndmask_b32 v211, v125, v121, s[76:77]
    v_mov_b32 v70, v125
    v_add_f32_dpp v112, v208, v112 wave_ror:1 row_mask:0xf bank_mask:0xf
    s_waitcnt lgkmcnt(0)
    v_mfma_f32_32x32x16_bf16 v[144:159], v[236:239], v[216:219], v[144:159]
    ds_read_b64_tr_b16 v[240:241], v65 offset:2592
    ds_read_b64_tr_b16 v[242:243], v65 offset:2560
    v_add_f32_dpp v116, v209, v116 wave_ror:1 row_mask:0xf bank_mask:0xf
    v_add_f32_dpp v120, v210, v120 wave_ror:1 row_mask:0xf bank_mask:0xf
    v_add_f32_dpp v124, v211, v124 wave_ror:1 row_mask:0xf bank_mask:0xf
    v_mfma_f32_32x32x16_bf16 v[160:175], v[228:231], v[216:219], v[160:175]
    buffer_load_dwordx4 v[104:107], v62, s[16:19], s97 offen offset:2048 sc1
    ds_write_b32 v66, v112 offset:768
    ds_write_b32 v66, v116 offset:832
    v_mfma_f32_32x32x16_bf16 v[176:191], v[244:247], v[216:219], v[176:191]
    ds_write_b32 v66, v120 offset:896
    ds_write_b32 v66, v124 offset:960
    v_mfma_f32_32x32x16_bf16 v[192:207], v[212:215], v[216:219], 0
    ds_read_b64_tr_b16 v[212:213], v65 offset:3104
    ds_read_b64_tr_b16 v[214:215], v65 offset:3072
    buffer_load_dwordx4 v[108:111], v62, s[16:19], s97 offen offset:3072 sc1
    s_waitcnt lgkmcnt(6)
    v_mfma_f32_32x32x16_bf16 v[160:175], v[236:239], v[240:243], v[160:175]
    v_mfma_f32_32x32x16_bf16 v[176:191], v[228:231], v[240:243], v[176:191]
    ds_read_b64_tr_b16 v[224:225], v65 offset:3616
    ds_read_b64_tr_b16 v[226:227], v65 offset:3584
    s_waitcnt lgkmcnt(4)
    s_barrier
    v_mfma_f32_32x32x16_bf16 v[192:207], v[244:247], v[240:243], v[192:207]
    ds_read_b64_tr_b16 v[244:245], v65 offset:672
    ds_read_b64_tr_b16 v[246:247], v65 offset:640
    ds_read_b64 v[112:113], v67 offset:0
    ds_read_b64 v[114:115], v67 offset:4224
    ds_read_b64 v[116:117], v67 offset:8448
    s_waitcnt lgkmcnt(7)
    v_mfma_f32_32x32x16_bf16 v[176:191], v[236:239], v[212:215], v[176:191]
    ds_read_b128 v[216:219], v64 offset:320
    ds_read_b64_tr_b16 v[240:241], v65 offset:1184
    ds_read_b64_tr_b16 v[242:243], v65 offset:1152
    ds_read_b64 v[118:119], v67 offset:12672
    ds_read_b64 v[120:121], v67 offset:512
    ds_read_b64 v[122:123], v67 offset:4736
    v_mfma_f32_32x32x16_bf16 v[192:207], v[228:231], v[212:215], v[192:207]
    ds_read_b64 v[124:125], v67 offset:8960
    ds_read_b64 v[126:127], v67 offset:13184
    s_waitcnt lgkmcnt(13)
    v_mfma_f32_32x32x16_bf16 v[192:207], v[236:239], v[224:227], v[192:207]
    ds_read_b128 v[228:231], v64 offset:192
    ds_read_b64_tr_b16 v[236:237], v65 offset:1696
    ds_read_b64_tr_b16 v[238:239], v65 offset:1664
    s_waitcnt lgkmcnt(14)
    v_mfma_f32_32x32x16_bf16 v[144:159], v[232:235], v[244:247], v[144:159]
    s_waitcnt lgkmcnt(8)
    v_mfma_f32_32x32x16_bf16 v[144:159], v[216:219], v[240:243], v[144:159]
    v_mfma_f32_32x32x16_bf16 v[160:175], v[232:235], v[240:243], v[160:175]
    ds_read_b128 v[212:215], v64 offset:64
    ds_read_b64_tr_b16 v[224:225], v65 offset:2208
    ds_read_b64_tr_b16 v[226:227], v65 offset:2176
    s_waitcnt lgkmcnt(6)
    v_add_f32 v112, v112, v80
    s_waitcnt lgkmcnt(3)
    v_mfma_f32_32x32x16_bf16 v[144:159], v[228:231], v[236:239], v[144:159]
    v_add_f32 v113, v113, v81
    v_add_f32 v114, v114, v82
    v_add_f32 v115, v115, v83
    v_add_f32 v116, v116, v84
    v_add_f32 v117, v117, v85
    v_add_f32 v118, v118, v86
    v_mfma_f32_32x32x16_bf16 v[160:175], v[216:219], v[236:239], v[160:175]
    v_add_f32_e64 v119, v119, v87
    v_cvt_pk_bf16_f32 v128, v112, v114
    v_cvt_pk_bf16_f32 v129, v116, v118
    v_cvt_pk_bf16_f32 v130, v113, v115
    v_cvt_pk_bf16_f32 v131, v117, v119
    s_mov_b32 s25, 0
    v_mfma_f32_32x32x16_bf16 v[176:191], v[232:235], v[236:239], v[176:191]
    buffer_store_dwordx2 v[128:129], v68, s[20:23], s25 offen
    s_mov_b32 s25, 5120
    buffer_store_dwordx2 v[130:131], v68, s[20:23], s25 offen
    v_add_f32 v120, v120, v88
    v_add_f32 v121, v121, v89
    s_waitcnt lgkmcnt(0)
    v_mfma_f32_32x32x16_bf16 v[144:159], v[212:215], v[224:227], v[144:159]
    ds_read_b64_tr_b16 v[244:245], v65 offset:2720
    ds_read_b64_tr_b16 v[246:247], v65 offset:2688
    v_add_f32 v122, v122, v90
    v_add_f32 v123, v123, v91
    v_add_f32 v124, v124, v92
    v_add_f32 v125, v125, v93
    v_mfma_f32_32x32x16_bf16 v[160:175], v[228:231], v[224:227], v[160:175]
    v_add_f32 v126, v126, v94
    v_add_f32 v127, v127, v95
    v_cvt_pk_bf16_f32 v132, v120, v122
    v_cvt_pk_bf16_f32 v133, v124, v126
    v_cvt_pk_bf16_f32 v134, v121, v123
    v_cvt_pk_bf16_f32 v135, v125, v127
    v_mfma_f32_32x32x16_bf16 v[176:191], v[216:219], v[224:227], v[176:191]
    s_mov_b32 s25, 655360
    buffer_store_dwordx2 v[132:133], v68, s[20:23], s25 offen
    s_mov_b32 s25, 660480
    buffer_store_dwordx2 v[134:135], v68, s[20:23], s25 offen
    ds_read_b64_tr_b16 v[112:113], v65 offset:32
    ds_read_b64_tr_b16 v[114:115], v65 offset:0
    v_mfma_f32_32x32x16_bf16 v[192:207], v[232:235], v[224:227], v[192:207]
    ds_read_b64_tr_b16 v[232:233], v65 offset:3232
    ds_read_b64_tr_b16 v[234:235], v65 offset:3200
    ds_read_b64_tr_b16 v[116:117], v65 offset:160
    ds_read_b64_tr_b16 v[118:119], v65 offset:128
    ds_read_b64_tr_b16 v[120:121], v65 offset:288
    s_waitcnt lgkmcnt(7)
    v_mfma_f32_32x32x16_bf16 v[160:175], v[212:215], v[244:247], v[160:175]
    ds_read_b64_tr_b16 v[122:123], v65 offset:256
    ds_read_b64_tr_b16 v[124:125], v65 offset:416
    ds_read_b64_tr_b16 v[126:127], v65 offset:384
    ds_read_b64_tr_b16 v[128:129], v65 offset:544
    ds_read_b64_tr_b16 v[130:131], v65 offset:512
    ds_read_b64_tr_b16 v[132:133], v65 offset:672
    v_mfma_f32_32x32x16_bf16 v[176:191], v[228:231], v[244:247], v[176:191]
    ds_read_b64_tr_b16 v[240:241], v65 offset:3744
    ds_read_b64_tr_b16 v[242:243], v65 offset:3712
    ds_read_b64_tr_b16 v[134:135], v65 offset:640
    ds_read_b64_tr_b16 v[136:137], v65 offset:800
    ds_read_b64_tr_b16 v[138:139], v65 offset:768
    ds_read_b64_tr_b16 v[140:141], v65 offset:928
    v_mfma_f32_32x32x16_bf16 v[192:207], v[216:219], v[244:247], v[192:207]
    ds_read_b128 v[216:219], v64 offset:416
    ds_read_b64_tr_b16 v[236:237], v65 offset:800
    ds_read_b64_tr_b16 v[238:239], v65 offset:768
    ds_read_b64_tr_b16 v[142:143], v65 offset:896
    s_waitcnt lgkmcnt(15)
    v_mfma_f32_32x32x16_bf16 v[176:191], v[212:215], v[232:235], v[176:191]
    ds_read_b128 v[224:227], v64 offset:288
    ds_read_b64_tr_b16 v[244:245], v65 offset:1312
    ds_read_b64_tr_b16 v[246:247], v65 offset:1280
    s_waitcnt vmcnt(4)
ce_86:
    v_max3_u32 v208, v248, v249, v250
    v_max3_u32 v208, v208, v251, v252
    v_max3_u32 v208, v208, v253, v254
    v_max_u32 v208, v208, v255
    v_cmp_eq_u32 s[82:83], -1, v208
    v_min3_f32 v209, v96, v99, v100
    v_min3_f32 v209, v209, v103, v104
    v_min3_f32 v209, v209, v107, v108
    v_min_f32 v209, v209, v111
    v_cmp_neq_f32 vcc, 0x41000000, v209
    s_nop 0
    s_or_b64 vcc, vcc, s[82:83]
    s_cbranch_vccnz rd_87
rc_88:
    v_mfma_f32_32x32x16_bf16 v[192:207], v[228:231], v[232:235], v[192:207]
    v_mul_f32 v208, 0x3acccccd, v97
    v_mul_f32 v209, 0x3acccccd, v101
    v_mul_f32 v98, 0x3acccccd, v98
    v_mul_f32 v102, 0x3acccccd, v102
    v_fma_f32 v98, -v208, v208, v98
    s_waitcnt lgkmcnt(11)
    v_mfma_f32_32x32x16_bf16 v[192:207], v[212:215], v[240:243], v[192:207]
    ds_read_b128 v[228:231], v64 offset:160
    ds_read_b64_tr_b16 v[212:213], v65 offset:1824
    ds_read_b64_tr_b16 v[214:215], v65 offset:1792
    v_fma_f32 v102, -v209, v209, v102
    v_max_f32 v98, 0, v98
    s_waitcnt lgkmcnt(7)
    v_mfma_f32_32x32x16_bf16 v[144:159], v[216:219], v[236:239], v[144:159]
    v_max_f32 v102, 0, v102
    v_add_f32 v98, 0x3727c5ac, v98
    v_add_f32 v102, 0x3727c5ac, v102
    v_rsq_f32 v97, v98
    s_waitcnt lgkmcnt(3)
    v_mfma_f32_32x32x16_bf16 v[144:159], v[224:227], v[244:247], v[144:159]
    v_rsq_f32_e64 v101, v102
    v_mul_f32 v98, -v208, v97
    v_mul_f32 v102, -v209, v101
    v_lshlrev_b32_e64 v80, 16, v248
    v_and_b32 v82, 0xffff0000, v248
    v_mfma_f32_32x32x16_bf16 v[160:175], v[216:219], v[244:247], v[160:175]
    ds_read_b64_tr_b16 v[232:233], v65 offset:2336
    ds_read_b64_tr_b16 v[234:235], v65 offset:2304
    v_lshlrev_b32 v84, 16, v249
    v_and_b32 v86, 0xffff0000, v249
    v_lshlrev_b32_e64 v81, 16, v250
    s_waitcnt lgkmcnt(2)
    v_mfma_f32_32x32x16_bf16 v[144:159], v[228:231], v[212:215], v[144:159]
    v_and_b32 v83, 0xffff0000, v250
    v_lshlrev_b32_e64 v85, 16, v251
    v_and_b32 v87, 0xffff0000, v251
    v_fma_f32 v208, v80, v97, v98
    v_fma_f32 v209, v81, v101, v102
    v_cvt_pk_bf16_f32 v248, v208, v209
    v_mfma_f32_32x32x16_bf16 v[160:175], v[224:227], v[212:215], v[160:175]
    v_fma_f32 v208, v82, v97, v98
    v_fma_f32 v209, v83, v101, v102
    v_cvt_pk_bf16_f32 v249, v208, v209
    v_fma_f32 v208, v84, v97, v98
    v_fma_f32 v209, v85, v101, v102
    v_cvt_pk_bf16_f32 v250, v208, v209
    v_mfma_f32_32x32x16_bf16 v[176:191], v[216:219], v[212:215], v[176:191]
    v_fma_f32 v208, v86, v97, v98
    v_fma_f32 v209, v87, v101, v102
    v_cvt_pk_bf16_f32 v251, v208, v209
    s_waitcnt lgkmcnt(0)
    v_mfma_f32_32x32x16_bf16 v[144:159], v[220:223], v[232:235], v[144:159]
    ds_read_b64_tr_b16 v[240:241], v65 offset:2848
    ds_read_b64_tr_b16 v[242:243], v65 offset:2816
    ds_write_b32 v63, v248 offset:512
    ds_write_b32 v63, v249 offset:5376
    v_mfma_f32_32x32x16_bf16 v[160:175], v[228:231], v[232:235], v[160:175]
    ds_write_b32 v63, v250 offset:10240
    ds_write_b32 v63, v251 offset:15104
    v_mul_f32 v208, 0x3acccccd, v105
    v_mul_f32 v209, 0x3acccccd, v109
    v_mfma_f32_32x32x16_bf16 v[176:191], v[224:227], v[232:235], v[176:191]
    v_mul_f32 v106, 0x3acccccd, v106
    v_mul_f32 v110, 0x3acccccd, v110
    v_fma_f32 v106, -v208, v208, v106
    v_fma_f32 v110, -v209, v209, v110
    v_max_f32 v106, 0, v106
    v_max_f32_e64 v110, 0, v110
    v_mfma_f32_32x32x16_bf16 v[192:207], v[216:219], v[232:235], v[192:207]
    ds_read_b64_tr_b16 v[216:217], v65 offset:3360
    ds_read_b64_tr_b16 v[218:219], v65 offset:3328
    v_add_f32 v106, 0x3727c5ac, v106
    v_add_f32 v110, 0x3727c5ac, v110
    s_waitcnt lgkmcnt(6)
    v_mfma_f32_32x32x16_bf16 v[160:175], v[220:223], v[240:243], v[160:175]
    v_rsq_f32 v105, v106
    v_rsq_f32_e64 v109, v110
    v_mul_f32 v106, -v208, v105
    v_mul_f32 v110, -v209, v109
    v_mfma_f32_32x32x16_bf16 v[176:191], v[228:231], v[240:243], v[176:191]
    ds_read_b64_tr_b16 v[236:237], v65 offset:3872
    ds_read_b64_tr_b16 v[238:239], v65 offset:3840
    v_lshlrev_b32 v88, 16, v252
    v_and_b32 v90, 0xffff0000, v252
    v_lshlrev_b32 v92, 16, v253
    v_and_b32 v94, 0xffff0000, v253
    v_mfma_f32_32x32x16_bf16 v[192:207], v[224:227], v[240:243], v[192:207]
    ds_read_b128 v[224:227], v64 offset:384
    ds_read_b64_tr_b16 v[244:245], v65 offset:928
    ds_read_b64_tr_b16 v[246:247], v65 offset:896
    v_lshlrev_b32 v89, 16, v254
    v_and_b32 v91, 0xffff0000, v254
    s_waitcnt lgkmcnt(5)
    v_mfma_f32_32x32x16_bf16 v[176:191], v[220:223], v[216:219], v[176:191]
    ds_read_b128 v[212:215], v64 offset:256
    ds_read_b64_tr_b16 v[232:233], v65 offset:1440
    ds_read_b64_tr_b16 v[234:235], v65 offset:1408
    v_lshlrev_b32_e64 v93, 16, v255
    v_and_b32 v95, 0xffff0000, v255
    v_fma_f32 v208, v88, v105, v106
    v_mfma_f32_32x32x16_bf16 v[192:207], v[228:231], v[216:219], v[192:207]
    v_fma_f32 v209, v89, v109, v110
    v_cvt_pk_bf16_f32 v252, v208, v209
    v_fma_f32 v208, v90, v105, v106
    v_fma_f32 v209, v91, v109, v110
    v_cvt_pk_bf16_f32 v253, v208, v209
    s_waitcnt lgkmcnt(6)
    v_mfma_f32_32x32x16_bf16 v[192:207], v[220:223], v[236:239], v[192:207]
    ds_read_b128 v[220:223], v64 offset:128
    ds_read_b64_tr_b16 v[228:229], v65 offset:1952
    ds_read_b64_tr_b16 v[230:231], v65 offset:1920
    v_fma_f32 v208, v92, v105, v106
    v_fma_f32 v209, v93, v109, v110
    s_waitcnt lgkmcnt(6)
    v_mfma_f32_32x32x16_bf16 v[144:159], v[224:227], v[244:247], v[144:159]
    v_cvt_pk_bf16_f32 v254, v208, v209
    v_fma_f32 v208, v94, v105, v106
    v_fma_f32 v209, v95, v109, v110
    v_cvt_pk_bf16_f32 v255, v208, v209
    s_waitcnt lgkmcnt(3)
    v_mfma_f32_32x32x16_bf16 v[144:159], v[212:215], v[232:235], v[144:159]
    ds_write_b32 v63, v252 offset:768
    ds_write_b32 v63, v253 offset:5632
    ds_write_b32 v63, v254 offset:10496
    v_mfma_f32_32x32x16_bf16 v[160:175], v[224:227], v[232:235], v[160:175]
    ds_read_b128 v[240:243], v64 offset:0
    ds_read_b64_tr_b16 v[216:217], v65 offset:2464
    ds_read_b64_tr_b16 v[218:219], v65 offset:2432
    ds_write_b32 v63, v255 offset:15360
    s_waitcnt lgkmcnt(7)
    v_mfma_f32_32x32x16_bf16 v[144:159], v[220:223], v[228:231], v[144:159]
    v_mfma_f32_32x32x16_bf16 v[160:175], v[212:215], v[228:231], v[160:175]
    v_mfma_f32_32x32x16_bf16 v[176:191], v[224:227], v[228:231], v[176:191]
    s_waitcnt lgkmcnt(1)
    v_mfma_f32_32x32x16_bf16 v[144:159], v[240:243], v[216:219], v[144:159]
    ds_read_b64_tr_b16 v[236:237], v65 offset:2976
    ds_read_b64_tr_b16 v[238:239], v65 offset:2944
    v_mfma_f32_32x32x16_bf16 v[160:175], v[220:223], v[216:219], v[160:175]
    v_mfma_f32_32x32x16_bf16 v[176:191], v[212:215], v[216:219], v[176:191]
    v_mfma_f32_32x32x16_bf16 v[192:207], v[224:227], v[216:219], v[192:207]
    ds_read_b64_tr_b16 v[224:225], v65 offset:3488
    ds_read_b64_tr_b16 v[226:227], v65 offset:3456
    s_waitcnt lgkmcnt(2)
    v_mfma_f32_32x32x16_bf16 v[160:175], v[240:243], v[236:239], v[160:175]
    v_mfma_f32_32x32x16_bf16 v[176:191], v[220:223], v[236:239], v[176:191]
    ds_read_b64_tr_b16 v[244:245], v65 offset:4000
    ds_read_b64_tr_b16 v[246:247], v65 offset:3968
    v_mfma_f32_32x32x16_bf16 v[192:207], v[212:215], v[236:239], v[192:207]
    s_waitcnt lgkmcnt(2)
    v_mfma_f32_32x32x16_bf16 v[176:191], v[240:243], v[224:227], v[176:191]
    v_mfma_f32_32x32x16_bf16 v[192:207], v[220:223], v[224:227], v[192:207]
    s_waitcnt lgkmcnt(0)
    v_mfma_f32_32x32x16_bf16 v[192:207], v[240:243], v[244:247], v[192:207]
    s_waitcnt lgkmcnt(0)
    s_barrier
    ds_read_b128 v[212:215], v64 offset:608
    ds_read_b128 v[216:219], v64 offset:576
    ds_read_b128 v[220:223], v64 offset:544
    ds_read_b128 v[224:227], v64 offset:512
    s_waitcnt lgkmcnt(3)
    v_mfma_f32_32x32x16_bf16 v[144:159], v[212:215], v[112:115], v[144:159]
    ds_read_b128 v[228:231], v64 offset:736
    s_waitcnt lgkmcnt(3)
    v_mfma_f32_32x32x16_bf16 v[144:159], v[216:219], v[116:119], v[144:159]
    ds_read_b128 v[232:235], v64 offset:704
    s_waitcnt lgkmcnt(3)
    v_mfma_f32_32x32x16_bf16 v[144:159], v[220:223], v[120:123], v[144:159]
    ds_read_b128 v[236:239], v64 offset:672
    s_waitcnt lgkmcnt(3)
    v_mfma_f32_32x32x16_bf16 v[144:159], v[224:227], v[124:127], v[144:159]
    ds_read_b128 v[240:243], v64 offset:640
    s_nop 3
    s_waitcnt lgkmcnt(3)
    v_mfma_f32_32x32x16_bf16 v[160:175], v[228:231], v[112:115], v[160:175]
    s_nop 4
    s_waitcnt lgkmcnt(2)
    v_mfma_f32_32x32x16_bf16 v[160:175], v[232:235], v[116:119], v[160:175]
    v_cndmask_b32 v208, v147, v72, s[76:77]
    v_cndmask_b32 v209, v151, v147, s[76:77]
    v_cndmask_b32 v210, v155, v151, s[76:77]
    v_cndmask_b32 v211, v159, v155, s[76:77]
    v_mov_b32 v72, v159
    s_waitcnt lgkmcnt(1)
    v_mfma_f32_32x32x16_bf16 v[160:175], v[236:239], v[120:123], v[160:175]
    v_add_f32_dpp v146, v208, v146 wave_ror:1 row_mask:0xf bank_mask:0xf
    v_add_f32_dpp v150, v209, v150 wave_ror:1 row_mask:0xf bank_mask:0xf
    v_add_f32_dpp v154, v210, v154 wave_ror:1 row_mask:0xf bank_mask:0xf
    v_add_f32_dpp v158, v211, v158 wave_ror:1 row_mask:0xf bank_mask:0xf
    v_cndmask_b32 v208, v146, v71, s[76:77]
    s_waitcnt lgkmcnt(0)
    v_mfma_f32_32x32x16_bf16 v[160:175], v[240:243], v[124:127], v[160:175]
    v_cndmask_b32 v209, v150, v146, s[76:77]
    v_cndmask_b32 v210, v154, v150, s[76:77]
    v_cndmask_b32 v211, v158, v154, s[76:77]
    v_mov_b32 v71, v158
    v_add_f32_dpp v145, v208, v145 wave_ror:1 row_mask:0xf bank_mask:0xf
    v_add_f32_dpp v149, v209, v149 wave_ror:1 row_mask:0xf bank_mask:0xf
    v_mfma_f32_32x32x16_bf16 v[160:175], v[212:215], v[128:131], v[160:175]
    ds_read_b128 v[244:247], v64 offset:864
    v_add_f32_dpp v153, v210, v153 wave_ror:1 row_mask:0xf bank_mask:0xf
    v_add_f32_dpp v157, v211, v157 wave_ror:1 row_mask:0xf bank_mask:0xf
    v_cndmask_b32 v208, v145, v70, s[76:77]
    v_cndmask_b32 v209, v149, v145, s[76:77]
    v_cndmask_b32 v210, v153, v149, s[76:77]
    v_mfma_f32_32x32x16_bf16 v[160:175], v[216:219], v[132:135], v[160:175]
    ds_read_b128 v[248:251], v64 offset:832
    v_cndmask_b32 v211, v157, v153, s[76:77]
    v_mov_b32_e64 v70, v157
    v_add_f32_dpp v144, v208, v144 wave_ror:1 row_mask:0xf bank_mask:0xf
    v_add_f32_dpp v148, v209, v148 wave_ror:1 row_mask:0xf bank_mask:0xf
    v_add_f32_dpp v152, v210, v152 wave_ror:1 row_mask:0xf bank_mask:0xf
    v_mfma_f32_32x32x16_bf16 v[160:175], v[220:223], v[136:139], v[160:175]
    ds_read_b128 v[252:255], v64 offset:800
    v_add_f32_dpp v156, v211, v156 wave_ror:1 row_mask:0xf bank_mask:0xf
    ds_write_b32 v66, v144 offset:0
    v_mfma_f32_32x32x16_bf16 v[160:175], v[224:227], v[140:143], v[160:175]
    ds_read_b128 v[224:227], v64 offset:768
    ds_write_b32 v66, v148 offset:64
    ds_write_b32 v66, v152 offset:128
    s_waitcnt lgkmcnt(6)
    v_mfma_f32_32x32x16_bf16 v[176:191], v[244:247], v[112:115], v[176:191]
    ds_write_b32 v66, v156 offset:192
    s_nop 2
    s_waitcnt lgkmcnt(6)
    v_mfma_f32_32x32x16_bf16 v[176:191], v[248:251], v[116:119], v[176:191]
    s_nop 2
    v_cndmask_b32 v208, v163, v72, s[76:77]
    v_cndmask_b32 v209, v167, v163, s[76:77]
    s_waitcnt lgkmcnt(5)
    v_mfma_f32_32x32x16_bf16 v[176:191], v[252:255], v[120:123], v[176:191]
    v_cndmask_b32 v210, v171, v167, s[76:77]
    v_cndmask_b32 v211, v175, v171, s[76:77]
    v_mov_b32 v72, v175
    v_add_f32_dpp v162, v208, v162 wave_ror:1 row_mask:0xf bank_mask:0xf
    v_add_f32_dpp v166, v209, v166 wave_ror:1 row_mask:0xf bank_mask:0xf
    s_waitcnt lgkmcnt(3)
    v_mfma_f32_32x32x16_bf16 v[176:191], v[224:227], v[124:127], v[176:191]
    v_add_f32_dpp v170, v210, v170 wave_ror:1 row_mask:0xf bank_mask:0xf
    v_add_f32_dpp v174, v211, v174 wave_ror:1 row_mask:0xf bank_mask:0xf
    v_cndmask_b32 v208, v162, v71, s[76:77]
    v_cndmask_b32 v209, v166, v162, s[76:77]
    v_cndmask_b32 v210, v170, v166, s[76:77]
    v_cndmask_b32 v211, v174, v170, s[76:77]
    v_mfma_f32_32x32x16_bf16 v[176:191], v[228:231], v[128:131], v[176:191]
    ds_read_b64_tr_b16 v[228:229], v65 offset:1056
    ds_read_b64_tr_b16 v[230:231], v65 offset:1024
    v_mov_b32 v71, v174
    v_add_f32_dpp v161, v208, v161 wave_ror:1 row_mask:0xf bank_mask:0xf
    v_add_f32_dpp v165, v209, v165 wave_ror:1 row_mask:0xf bank_mask:0xf
    v_add_f32_dpp v169, v210, v169 wave_ror:1 row_mask:0xf bank_mask:0xf
    v_mfma_f32_32x32x16_bf16 v[176:191], v[232:235], v[132:135], v[176:191]
    ds_read_b64_tr_b16 v[232:233], v65 offset:1184
    ds_read_b64_tr_b16 v[234:235], v65 offset:1152
    v_add_f32_dpp v173, v211, v173 wave_ror:1 row_mask:0xf bank_mask:0xf
    v_cndmask_b32 v208, v161, v70, s[76:77]
    v_cndmask_b32 v209, v165, v161, s[76:77]
    v_cndmask_b32 v210, v169, v165, s[76:77]
    v_mfma_f32_32x32x16_bf16 v[176:191], v[236:239], v[136:139], v[176:191]
    ds_read_b64_tr_b16 v[236:237], v65 offset:1312
    ds_read_b64_tr_b16 v[238:239], v65 offset:1280
    v_cndmask_b32 v211, v173, v169, s[76:77]
    v_mov_b32_e64 v70, v173
    v_add_f32_dpp v160, v208, v160 wave_ror:1 row_mask:0xf bank_mask:0xf
    v_add_f32_dpp v164, v209, v164 wave_ror:1 row_mask:0xf bank_mask:0xf
    v_mfma_f32_32x32x16_bf16 v[176:191], v[240:243], v[140:143], v[176:191]
    ds_read_b128 v[240:243], v64 offset:512
    ds_read_b64_tr_b16 v[224:225], v65 offset:1440
    ds_read_b64_tr_b16 v[226:227], v65 offset:1408
    v_add_f32_dpp v168, v210, v168 wave_ror:1 row_mask:0xf bank_mask:0xf
    v_add_f32_dpp v172, v211, v172 wave_ror:1 row_mask:0xf bank_mask:0xf
    s_waitcnt lgkmcnt(7)
    v_mfma_f32_32x32x16_bf16 v[176:191], v[212:215], v[228:231], v[176:191]
    ds_read_b128 v[212:215], v64 offset:992
    ds_write_b32 v66, v160 offset:256
    ds_write_b32 v66, v164 offset:320
    s_waitcnt lgkmcnt(8)
    v_mfma_f32_32x32x16_bf16 v[176:191], v[216:219], v[232:235], v[176:191]
    ds_read_b128 v[216:219], v64 offset:960
    ds_write_b32 v66, v168 offset:384
    ds_write_b32 v66, v172 offset:448
    s_waitcnt lgkmcnt(9)
    v_mfma_f32_32x32x16_bf16 v[176:191], v[220:223], v[236:239], v[176:191]
    ds_read_b128 v[220:223], v64 offset:928
    s_waitcnt lgkmcnt(7)
    v_mfma_f32_32x32x16_bf16 v[176:191], v[240:243], v[224:227], v[176:191]
    ds_read_b128 v[240:243], v64 offset:896
    s_waitcnt lgkmcnt(2)
    s_barrier
    v_mfma_f32_32x32x16_bf16 v[192:207], v[212:215], v[112:115], v[192:207]
    ds_read_b64 v[144:145], v67 offset:0
    ds_read_b64 v[146:147], v67 offset:4224
    ds_read_b64 v[148:149], v67 offset:8448
    ds_read_b64 v[150:151], v67 offset:12672
    s_nop 0
    v_mfma_f32_32x32x16_bf16 v[192:207], v[216:219], v[116:119], v[192:207]
    s_nop 2
    v_cndmask_b32 v208, v179, v72, s[76:77]
    v_cndmask_b32 v209, v183, v179, s[76:77]
    s_waitcnt lgkmcnt(5)
    v_mfma_f32_32x32x16_bf16 v[192:207], v[220:223], v[120:123], v[192:207]
    v_cndmask_b32 v210, v187, v183, s[76:77]
    v_cndmask_b32 v211, v191, v187, s[76:77]
    v_mov_b32 v72, v191
    v_add_f32_dpp v178, v208, v178 wave_ror:1 row_mask:0xf bank_mask:0xf
    v_add_f32_dpp v182, v209, v182 wave_ror:1 row_mask:0xf bank_mask:0xf
    s_waitcnt lgkmcnt(4)
    v_mfma_f32_32x32x16_bf16 v[192:207], v[240:243], v[124:127], v[192:207]
    ds_read_b128 v[212:215], v64 offset:768
    v_add_f32_dpp v186, v210, v186 wave_ror:1 row_mask:0xf bank_mask:0xf
    v_add_f32_dpp v190, v211, v190 wave_ror:1 row_mask:0xf bank_mask:0xf
    v_cndmask_b32 v208, v178, v71, s[76:77]
    v_cndmask_b32 v209, v182, v178, s[76:77]
    v_cndmask_b32 v210, v186, v182, s[76:77]
    v_mfma_f32_32x32x16_bf16 v[192:207], v[244:247], v[128:131], v[192:207]
    ds_read_b128 v[244:247], v64 offset:736
    v_cndmask_b32 v211, v190, v186, s[76:77]
    v_mov_b32 v71, v190
    v_add_f32_dpp v177, v208, v177 wave_ror:1 row_mask:0xf bank_mask:0xf
    v_add_f32_dpp v181, v209, v181 wave_ror:1 row_mask:0xf bank_mask:0xf
    v_add_f32_dpp v185, v210, v185 wave_ror:1 row_mask:0xf bank_mask:0xf
    v_mfma_f32_32x32x16_bf16 v[192:207], v[248:251], v[132:135], v[192:207]
    ds_read_b128 v[248:251], v64 offset:704
    v_add_f32_dpp v189, v211, v189 wave_ror:1 row_mask:0xf bank_mask:0xf
    v_cndmask_b32 v208, v177, v70, s[76:77]
    v_cndmask_b32 v209, v181, v177, s[76:77]
    v_cndmask_b32 v210, v185, v181, s[76:77]
    v_cndmask_b32 v211, v189, v185, s[76:77]
    v_mfma_f32_32x32x16_bf16 v[192:207], v[252:255], v[136:139], v[192:207]
    ds_read_b128 v[252:255], v64 offset:672
    v_mov_b32_e64 v70, v189
    v_add_f32_dpp v176, v208, v176 wave_ror:1 row_mask:0xf bank_mask:0xf
    v_add_f32_dpp v180, v209, v180 wave_ror:1 row_mask:0xf bank_mask:0xf
    v_add_f32_dpp v184, v210, v184 wave_ror:1 row_mask:0xf bank_mask:0xf
    s_waitcnt lgkmcnt(3)
    v_mfma_f32_32x32x16_bf16 v[192:207], v[212:215], v[140:143], v[192:207]
    ds_read_b128 v[216:219], v64 offset:640
    v_add_f32_dpp v188, v211, v188 wave_ror:1 row_mask:0xf bank_mask:0xf
    s_waitcnt lgkmcnt(3)
    v_mfma_f32_32x32x16_bf16 v[192:207], v[244:247], v[228:231], v[192:207]
    ds_read_b128 v[228:231], v64 offset:608
    ds_read_b64_tr_b16 v[220:221], v65 offset:1568
    ds_read_b64_tr_b16 v[222:223], v65 offset:1536
    ds_write_b32 v66, v176 offset:512
    s_waitcnt lgkmcnt(6)
    v_mfma_f32_32x32x16_bf16 v[192:207], v[248:251], v[232:235], v[192:207]
    ds_read_b128 v[232:235], v64 offset:576
    ds_read_b64_tr_b16 v[240:241], v65 offset:1696
    ds_read_b64_tr_b16 v[242:243], v65 offset:1664
    ds_write_b32 v66, v180 offset:576
    s_waitcnt lgkmcnt(9)
    v_mfma_f32_32x32x16_bf16 v[192:207], v[252:255], v[236:239], v[192:207]
    ds_read_b128 v[236:239], v64 offset:544
    ds_read_b64_tr_b16 v[212:213], v65 offset:1824
    ds_read_b64_tr_b16 v[214:215], v65 offset:1792
    ds_write_b32 v66, v184 offset:640
    s_waitcnt lgkmcnt(12)
    v_mfma_f32_32x32x16_bf16 v[192:207], v[216:219], v[224:227], v[192:207]
    ds_read_b128 v[224:227], v64 offset:512
    ds_read_b64_tr_b16 v[244:245], v65 offset:1952
    ds_read_b64_tr_b16 v[246:247], v65 offset:1920
    ds_write_b32 v66, v188 offset:704
    s_waitcnt lgkmcnt(13)
    v_mfma_f32_32x32x16_bf16 v[192:207], v[228:231], v[220:223], v[192:207]
    v_add_f32 v144, v144, v80
    v_add_f32 v145, v145, v81
    v_add_f32 v146, v146, v82
    v_add_f32 v147, v147, v83
    s_waitcnt lgkmcnt(9)
    v_mfma_f32_32x32x16_bf16 v[192:207], v[232:235], v[240:243], v[192:207]
    v_add_f32 v148, v148, v84
    v_add_f32 v149, v149, v85
    v_add_f32 v150, v150, v86
    v_add_f32 v151, v151, v87
    v_cvt_pk_bf16_f32 v160, v144, v146
    s_waitcnt lgkmcnt(5)
    v_mfma_f32_32x32x16_bf16 v[192:207], v[236:239], v[212:215], v[192:207]
    v_cvt_pk_bf16_f32 v161, v148, v150
    v_cvt_pk_bf16_f32 v162, v145, v147
    v_cvt_pk_bf16_f32 v163, v149, v151
    s_mov_b32 s25, 1310720
    s_waitcnt lgkmcnt(1)
    v_mfma_f32_32x32x16_bf16 v[192:207], v[224:227], v[244:247], v[192:207]
    buffer_store_dwordx2 v[160:161], v68, s[20:23], s25 offen
    s_mov_b32 s25, 1315840
    buffer_store_dwordx2 v[162:163], v68, s[20:23], s25 offen
    s_nop 8
    v_cndmask_b32 v208, v195, v72, s[76:77]
    v_cndmask_b32 v209, v199, v195, s[76:77]
    v_cndmask_b32 v210, v203, v199, s[76:77]
    v_cndmask_b32 v211, v207, v203, s[76:77]
    v_mov_b32_e64 v72, v207
    v_add_f32_dpp v194, v208, v194 wave_ror:1 row_mask:0xf bank_mask:0xf
    v_add_f32_dpp v198, v209, v198 wave_ror:1 row_mask:0xf bank_mask:0xf
    v_add_f32_dpp v202, v210, v202 wave_ror:1 row_mask:0xf bank_mask:0xf
    v_add_f32_dpp v206, v211, v206 wave_ror:1 row_mask:0xf bank_mask:0xf
    v_cndmask_b32 v208, v194, v71, s[76:77]
    v_cndmask_b32 v209, v198, v194, s[76:77]
    v_cndmask_b32 v210, v202, v198, s[76:77]
    v_cndmask_b32 v211, v206, v202, s[76:77]
    v_mov_b32_e64 v71, v206
    v_add_f32_dpp v193, v208, v193 wave_ror:1 row_mask:0xf bank_mask:0xf
    v_add_f32_dpp v197, v209, v197 wave_ror:1 row_mask:0xf bank_mask:0xf
    v_add_f32_dpp v201, v210, v201 wave_ror:1 row_mask:0xf bank_mask:0xf
    v_add_f32_dpp v205, v211, v205 wave_ror:1 row_mask:0xf bank_mask:0xf
    v_cndmask_b32 v208, v193, v70, s[76:77]
    v_cndmask_b32 v209, v197, v193, s[76:77]
    v_cndmask_b32 v210, v201, v197, s[76:77]
    v_cndmask_b32 v211, v205, v201, s[76:77]
    v_mov_b32_e64 v70, v205
    v_add_f32_dpp v192, v208, v192 wave_ror:1 row_mask:0xf bank_mask:0xf
    v_add_f32_dpp v196, v209, v196 wave_ror:1 row_mask:0xf bank_mask:0xf
    v_add_f32_dpp v200, v210, v200 wave_ror:1 row_mask:0xf bank_mask:0xf
    v_add_f32_dpp v204, v211, v204 wave_ror:1 row_mask:0xf bank_mask:0xf
    ds_write_b32 v66, v192 offset:768
    ds_write_b32 v66, v196 offset:832
    ds_write_b32 v66, v200 offset:896
    ds_write_b32 v66, v204 offset:960
    s_waitcnt lgkmcnt(0)
    s_barrier
    ds_read_b64 v[152:153], v67 offset:512
    ds_read_b64 v[154:155], v67 offset:4736
    ds_read_b64 v[156:157], v67 offset:8960
    ds_read_b64 v[158:159], v67 offset:13184
    s_waitcnt lgkmcnt(0)
    v_add_f32 v152, v152, v88
    v_add_f32 v153, v153, v89
    v_add_f32 v154, v154, v90
    v_add_f32 v155, v155, v91
    v_add_f32 v156, v156, v92
    v_add_f32 v157, v157, v93
    v_add_f32 v158, v158, v94
    v_add_f32_e64 v159, v159, v95
    v_cvt_pk_bf16_f32 v164, v152, v154
    v_cvt_pk_bf16_f32 v165, v156, v158
    v_cvt_pk_bf16_f32 v166, v153, v155
    v_cvt_pk_bf16_f32 v167, v157, v159
    s_mov_b32 s25, 1966080
    buffer_store_dwordx2 v[164:165], v68, s[20:23], s25 offen
    s_mov_b32 s25, 1971200
    buffer_store_dwordx2 v[166:167], v68, s[20:23], s25 offen
    s_branch ec_82
nc_81:
ec_82:
L_end:
    s_endpgm
ps_5:
    s_mov_b32 s84, 1048576
pl_6:
    global_load_dword v7, v5, s[66:67] sc1
    s_waitcnt vmcnt(0)
    s_sub_u32 s84, s84, 1
    s_cbranch_scc1 pc_7
    v_cmp_gt_u32_e64 vcc, 1, v7
    s_nop 0
    s_and_b64 vcc, vcc, s[50:51]
    s_and_b64 vcc, vcc, 1
    s_cbranch_scc1 pl_6
    s_branch pc_7
ps_8:
    s_mov_b32 s84, 1048576
pl_9:
    buffer_load_dword v7, v4, s[16:19], s87 offen offset:0 sc1
    s_waitcnt vmcnt(0)
    s_sub_u32 s84, s84, 1
    s_cbranch_scc1 pc_10
    v_cmp_gt_u32 vcc, 32, v7
    s_nop 0
    s_and_b64 vcc, vcc, s[50:51]
    s_cbranch_scc1 pl_9
    s_branch pc_10
ps_11:
    s_mov_b32 s84, 1048576
pl_12:
    global_load_dword v7, v5, s[66:67] sc1
    s_waitcnt vmcnt(0)
    s_sub_u32 s84, s84, 1
    s_cbranch_scc1 pc_13
    v_cmp_gt_u32_e64 vcc, 1, v7
    s_nop 0
    s_and_b64 vcc, vcc, s[50:51]
    s_and_b64 vcc, vcc, 1
    s_cbranch_scc1 pl_12
    s_branch pc_13
ps_14:
    s_mov_b32 s84, 1048576
pl_15:
    buffer_load_dword v7, v4, s[16:19], s87 offen offset:0 sc1
    s_waitcnt vmcnt(0)
    s_sub_u32 s84, s84, 1
    s_cbranch_scc1 pc_16
    v_cmp_gt_u32 vcc, 32, v7
    s_nop 0
    s_and_b64 vcc, vcc, s[50:51]
    s_cbranch_scc1 pl_15
    s_branch pc_16
ps_17:
    s_mov_b32 s84, 1048576
pl_18:
    buffer_load_dword v7, v4, s[16:19], s89 offen offset:8 sc1
    s_waitcnt vmcnt(0)
    s_sub_u32 s84, s84, 1
    s_cbranch_scc1 pc_19
    v_cmp_gt_u32_e64 vcc, 32, v7
    s_nop 0
    s_and_b64 vcc, vcc, s[50:51]
    s_cbranch_scc1 pl_18
    s_branch pc_19
rd_21:
    s_cmp_eq_u32 s38, 0
    s_cbranch_scc1 rc_22
    s_sub_u32 s38, s38, 1
    s_nop 7
    s_nop 7
    s_sleep 4
    s_mov_b64 exec, vcc
    s_mov_b32 s96, 4194304
    buffer_load_dwordx4 v[216:219], v56, s[16:19], s96 offen offset:0 sc1
    buffer_load_dwordx4 v[220:223], v56, s[16:19], s96 offen offset:256 sc1
    s_mov_b32 s96, 4227072
    buffer_load_dwordx4 v[224:227], v56, s[16:19], s96 offen offset:0 sc1
    buffer_load_dwordx4 v[228:231], v56, s[16:19], s96 offen offset:256 sc1
    s_mov_b32 s96, 4259840
    buffer_load_dwordx4 v[232:235], v56, s[16:19], s96 offen offset:0 sc1
    buffer_load_dwordx4 v[236:239], v56, s[16:19], s96 offen offset:256 sc1
    s_mov_b32 s96, 4292608
    buffer_load_dwordx4 v[240:243], v56, s[16:19], s96 offen offset:0 sc1
    buffer_load_dwordx4 v[244:247], v56, s[16:19], s96 offen offset:256 sc1
    s_mov_b32 s96, 4194304
    buffer_load_dwordx2 v[248:249], v57, s[16:19], s96 offen offset:0 sc1
    buffer_load_dwordx2 v[252:253], v57, s[16:19], s96 offen offset:128 sc1
    s_mov_b32 s96, 4210688
    buffer_load_dwordx2 v[250:251], v57, s[16:19], s96 offen offset:0 sc1
    buffer_load_dwordx2 v[254:255], v57, s[16:19], s96 offen offset:128 sc1
    s_mov_b32 s96, 0
    s_mov_b32 s97, 5120
    s_waitcnt vmcnt(16)
    buffer_load_dwordx2 v[208:209], v60, s[4:7], s96 offen
    s_waitcnt vmcnt(16)
    buffer_load_dwordx2 v[210:211], v60, s[4:7], s97 offen
    s_waitcnt vmcnt(16)
    v_lshrrev_b32_e64 v212, 5, v1
    v_mul_u32_u24 v212, 5104, v212
    v_bfe_u32 v213, v1, 4, 1
    v_lshlrev_b32 v213, 2, v213
    v_sub_u32 v212, v212, v213
    v_add_u32 v212, v212, v60
    s_mul_i32 s97, s24, 24
    s_sub_u32 s97, 128, s97
    buffer_load_dword v212, v212, s[4:7], s97 offen
    s_mov_b64 exec, -1
    s_waitcnt vmcnt(0) lgkmcnt(0)
    s_branch oe_20
rd_24:
    s_cmp_eq_u32 s38, 0
    s_cbranch_scc1 rc_25
    s_sub_u32 s38, s38, 1
    s_nop 7
    s_nop 7
    s_sleep 4
    s_mov_b64 exec, vcc
    s_mov_b32 s96, 4198400
    buffer_load_dwordx4 v[216:219], v56, s[16:19], s96 offen offset:0 sc1
    buffer_load_dwordx4 v[220:223], v56, s[16:19], s96 offen offset:256 sc1
    s_mov_b32 s96, 4231168
    buffer_load_dwordx4 v[224:227], v56, s[16:19], s96 offen offset:0 sc1
    buffer_load_dwordx4 v[228:231], v56, s[16:19], s96 offen offset:256 sc1
    s_mov_b32 s96, 4263936
    buffer_load_dwordx4 v[232:235], v56, s[16:19], s96 offen offset:0 sc1
    buffer_load_dwordx4 v[236:239], v56, s[16:19], s96 offen offset:256 sc1
    s_mov_b32 s96, 4296704
    buffer_load_dwordx4 v[240:243], v56, s[16:19], s96 offen offset:0 sc1
    buffer_load_dwordx4 v[244:247], v56, s[16:19], s96 offen offset:256 sc1
    s_mov_b32 s96, 4196352
    buffer_load_dwordx2 v[248:249], v57, s[16:19], s96 offen offset:0 sc1
    buffer_load_dwordx2 v[252:253], v57, s[16:19], s96 offen offset:128 sc1
    s_mov_b32 s96, 4212736
    buffer_load_dwordx2 v[250:251], v57, s[16:19], s96 offen offset:0 sc1
    buffer_load_dwordx2 v[254:255], v57, s[16:19], s96 offen offset:128 sc1
    s_mov_b32 s96, 1310720
    s_mov_b32 s97, 1315840
    s_waitcnt vmcnt(15)
    buffer_load_dwordx2 v[208:209], v60, s[4:7], s96 offen
    s_waitcnt vmcnt(15)
    buffer_load_dwordx2 v[210:211], v60, s[4:7], s97 offen
    s_waitcnt vmcnt(15)
    v_lshrrev_b32 v212, 5, v1
    v_mul_u32_u24 v212, 5104, v212
    v_bfe_u32 v213, v1, 4, 1
    v_lshlrev_b32 v213, 2, v213
    v_sub_u32 v212, v212, v213
    v_add_u32 v212, v212, v60
    s_mul_i32 s97, s24, 24
    s_sub_u32 s97, 1310848, s97
    buffer_load_dword v212, v212, s[4:7], s97 offen
    s_mov_b64 exec, -1
    s_waitcnt vmcnt(0) lgkmcnt(0)
    s_branch oe_23
rd_29:
    s_cmp_eq_u32 s38, 0
    s_cbranch_scc1 rc_30
    s_sub_u32 s38, s38, 1
    s_nop 7
    s_nop 7
    s_sleep 4
    s_mov_b64 exec, vcc
    s_lshl_b32 s96, s75, 14
    s_add_u32 s96, s96, 6815744
    s_lshl_b32 s97, s24, 12
    s_add_u32 s97, s97, 3473408
    buffer_load_dwordx4 v[176:179], v62, s[16:19], s96 offen offset:0 sc1
    buffer_load_dwordx4 v[180:183], v62, s[16:19], s96 offen offset:1024 sc1
    buffer_load_dwordx4 v[184:187], v62, s[16:19], s97 offen offset:0 sc1
    buffer_load_dwordx4 v[188:191], v62, s[16:19], s97 offen offset:1024 sc1
    buffer_load_dwordx4 v[192:195], v62, s[16:19], s97 offen offset:2048 sc1
    buffer_load_dwordx4 v[196:199], v62, s[16:19], s97 offen offset:3072 sc1
    s_mov_b64 exec, -1
    s_waitcnt vmcnt(0) lgkmcnt(0)
    s_branch ce_28
rd_32:
    s_cmp_eq_u32 s38, 0
    s_cbranch_scc1 rc_33
    s_sub_u32 s38, s38, 1
    s_nop 7
    s_nop 7
    s_sleep 4
    s_mov_b64 exec, vcc
    s_lshl_b32 s96, s75, 14
    s_add_u32 s96, s96, 6815744
    s_lshl_b32 s97, s24, 12
    s_add_u32 s97, s97, 3477504
    buffer_load_dwordx4 v[248:251], v62, s[16:19], s96 offen offset:2048 sc1
    buffer_load_dwordx4 v[252:255], v62, s[16:19], s96 offen offset:3072 sc1
    buffer_load_dwordx4 v[96:99], v62, s[16:19], s97 offen offset:0 sc1
    buffer_load_dwordx4 v[100:103], v62, s[16:19], s97 offen offset:1024 sc1
    buffer_load_dwordx4 v[104:107], v62, s[16:19], s97 offen offset:2048 sc1
    buffer_load_dwordx4 v[108:111], v62, s[16:19], s97 offen offset:3072 sc1
    s_mov_b64 exec, -1
    s_waitcnt vmcnt(0) lgkmcnt(0)
    s_branch ce_31
gl_34:
    s_add_u32 s82, s86, 16384
    v_lshlrev_b32 v2, 10, v1
    v_mov_b32_e64 v5, 1
    s_mov_b64 exec, 255
    buffer_store_dword v5, v2, s[16:19], s82 offen offset:0 sc1
    s_mov_b64 exec, -1
    s_branch gc_35
ps_36:
    s_mov_b32 s84, 1048576
pl_37:
    buffer_load_dword v7, v4, s[16:19], s89 offen offset:0 sc1
    s_waitcnt vmcnt(0)
    s_sub_u32 s84, s84, 1
    s_cbranch_scc1 pc_38
    v_cmp_gt_u32 vcc, 1, v7
    s_nop 0
    s_and_b64 vcc, vcc, s[50:51]
    s_cbranch_scc1 pl_37
    s_branch pc_38
ps_39:
    s_mov_b32 s84, 1048576
pl_40:
    buffer_load_dword v7, v4, s[16:19], s87 offen offset:8 sc1
    s_waitcnt vmcnt(0)
    s_sub_u32 s84, s84, 1
    s_cbranch_scc1 pc_41
    v_cmp_gt_u32 vcc, 12, v7
    s_nop 0
    s_and_b64 vcc, vcc, s[50:51]
    s_cbranch_scc1 pl_40
    s_branch pc_41
gl_42:
    s_add_u32 s82, s86, 0
    v_lshlrev_b32 v2, 10, v1
    v_mov_b32_e64 v5, 1
    s_mov_b64 exec, 255
    buffer_store_dword v5, v2, s[16:19], s82 offen offset:12 sc1
    s_mov_b64 exec, -1
    s_branch gc_43
ps_44:
    s_mov_b32 s84, 1048576
pl_45:
    buffer_load_dword v7, v4, s[16:19], s89 offen offset:0 sc1
    s_waitcnt vmcnt(0)
    s_sub_u32 s84, s84, 1
    s_cbranch_scc1 pc_46
    v_cmp_gt_u32_e64 vcc, 1, v7
    s_nop 0
    s_and_b64 vcc, vcc, s[50:51]
    s_cbranch_scc1 pl_45
    s_branch pc_46
rd_49:
    s_cmp_eq_u32 s38, 0
    s_cbranch_scc1 rc_50
    s_sub_u32 s38, s38, 1
    s_nop 7
    s_nop 7
    s_sleep 4
    s_mov_b64 exec, vcc
    s_add_u32 s26, s3, 9437184
    buffer_load_dwordx4 v[216:219], v236, s[16:19], s26 offen sc1
    s_add_u32 s26, s26, 524288
    buffer_load_dwordx4 v[220:223], v236, s[16:19], s26 offen sc1
    s_add_u32 s26, s26, 524288
    buffer_load_dwordx4 v[224:227], v236, s[16:19], s26 offen sc1
    s_add_u32 s26, s26, 524288
    buffer_load_dwordx4 v[228:231], v236, s[16:19], s26 offen sc1
    s_add_u32 s26, s26, 524288
    buffer_load_dwordx4 v[232:235], v236, s[16:19], s26 offen sc1
    s_mov_b64 exec, -1
    s_waitcnt vmcnt(0) lgkmcnt(0)
    s_branch se_48
gl_52:
    s_add_u32 s82, s86, 16384
    v_lshlrev_b32 v2, 10, v1
    v_mov_b32_e64 v5, 1
    s_mov_b64 exec, 255
    buffer_store_dword v5, v2, s[16:19], s82 offen offset:4 sc1
    s_mov_b64 exec, -1
    s_branch gc_53
ps_54:
    s_mov_b32 s84, 1048576
pl_55:
    buffer_load_dword v7, v4, s[16:19], s87 offen offset:12 sc1
    s_waitcnt vmcnt(0)
    s_sub_u32 s84, s84, 1
    s_cbranch_scc1 pc_56
    v_cmp_gt_u32_e64 vcc, 1, v7
    s_nop 0
    s_and_b64 vcc, vcc, s[50:51]
    s_cbranch_scc1 pl_55
    s_branch pc_56
rd_58:
    s_cmp_eq_u32 s38, 0
    s_cbranch_scc1 rc_59
    s_sub_u32 s38, s38, 1
    s_nop 7
    s_nop 7
    s_sleep 4
    s_mov_b64 exec, vcc
    s_lshl_b32 s98, s72, 5
    s_add_u32 s98, s98, 0
    s_sub_u32 s95, s98, 4
    s_max_i32 s95, s95, 0
    s_lshl_b32 s94, s98, 3
    s_lshl_b32 s95, s95, 3
    s_add_u32 s94, s94, 3457024
    s_add_u32 s95, s95, 3457024
    s_add_u32 s96, s94, 8192
    buffer_load_dwordx2 v[152:153], v47, s[16:19], s94 offen sc1
    buffer_load_dwordx2 v[154:155], v47, s[16:19], s96 offen sc1
    buffer_load_dwordx2 v[156:157], v48, s[16:19], s95 offen sc1
    s_mov_b64 exec, -1
    s_waitcnt vmcnt(0) lgkmcnt(0)
    s_branch sl_57
ps_60:
    s_mov_b32 s84, 1048576
pl_61:
    buffer_load_dword v7, v4, s[16:19], s89 offen offset:4 sc1
    s_waitcnt vmcnt(0)
    s_sub_u32 s84, s84, 1
    s_cbranch_scc1 pc_62
    v_cmp_gt_u32 vcc, 1, v7
    s_nop 0
    s_and_b64 vcc, vcc, s[50:51]
    s_cbranch_scc1 pl_61
    s_branch pc_62
rd_65:
    s_cmp_eq_u32 s38, 0
    s_cbranch_scc1 rc_66
    s_sub_u32 s38, s38, 1
    s_nop 7
    s_nop 7
    s_sleep 4
    s_mov_b64 exec, vcc
    s_add_u32 s26, s3, 9437184
    buffer_load_dwordx4 v[216:219], v236, s[16:19], s26 offen sc1
    s_add_u32 s26, s26, 524288
    buffer_load_dwordx4 v[220:223], v236, s[16:19], s26 offen sc1
    s_add_u32 s26, s26, 524288
    buffer_load_dwordx4 v[224:227], v236, s[16:19], s26 offen sc1
    s_add_u32 s26, s26, 524288
    buffer_load_dwordx4 v[228:231], v236, s[16:19], s26 offen sc1
    s_add_u32 s26, s26, 524288
    buffer_load_dwordx4 v[232:235], v236, s[16:19], s26 offen sc1
    s_mov_b64 exec, -1
    s_waitcnt vmcnt(0) lgkmcnt(0)
    s_branch se_64
rd_67:
    s_cmp_eq_u32 s39, 0
    s_cbranch_scc1 rc_68
    s_sub_u32 s39, s39, 1
    s_nop 7
    s_nop 7
    s_waitcnt vmcnt(0) lgkmcnt(0)
    s_barrier
    s_lshl_b32 s25, s72, 5
    s_add_u32 s25, s25, 0
    s_sub_u32 s26, s25, 4
    s_max_i32 s26, s26, 0
    s_lshl_b32 s27, s71, 12
    s_add_u32 s27, s27, 9437184
    s_lshl_b32 s99, s25, 3
    s_lshl_b32 s100, s26, 3
    s_lshl_b32 s92, s24, 12
    s_lshl_b32 s93, s24, 9
    s_add_u32 s99, s99, s27
    s_add_u32 s100, s100, s27
    s_add_u32 m0, s92, 36352
    s_nop 0
    buffer_load_dwordx4 v73, s[16:19], s99 offen offset:0 sc1 lds
    buffer_load_dwordx4 v74, s[16:19], s99 offen offset:1024 sc1 lds
    buffer_load_dwordx4 v75, s[16:19], s99 offen offset:2048 sc1 lds
    buffer_load_dwordx4 v76, s[16:19], s99 offen offset:3072 sc1 lds
    s_add_u32 m0, s93, 53760
    s_add_u32 s99, s99, 524288
    s_mov_b64 exec, s[80:81]
    buffer_load_dwordx4 v77, s[16:19], s100 offen sc1 lds
    s_mov_b64 exec, -1
    s_add_u32 s100, s100, 524288
    s_add_u32 m0, s92, 55936
    s_nop 0
    s_nop 0
    buffer_load_dwordx4 v73, s[16:19], s99 offen offset:0 sc1 lds
    buffer_load_dwordx4 v74, s[16:19], s99 offen offset:1024 sc1 lds
    buffer_load_dwordx4 v75, s[16:19], s99 offen offset:2048 sc1 lds
    buffer_load_dwordx4 v76, s[16:19], s99 offen offset:3072 sc1 lds
    s_add_u32 m0, s93, 73344
    s_add_u32 s99, s99, 524288
    s_mov_b64 exec, s[80:81]
    buffer_load_dwordx4 v77, s[16:19], s100 offen sc1 lds
    s_mov_b64 exec, -1
    s_add_u32 s100, s100, 524288
    s_add_u32 m0, s92, 75520
    s_nop 0
    s_nop 0
    buffer_load_dwordx4 v73, s[16:19], s99 offen offset:0 sc1 lds
    buffer_load_dwordx4 v74, s[16:19], s99 offen offset:1024 sc1 lds
    buffer_load_dwordx4 v75, s[16:19], s99 offen offset:2048 sc1 lds
    buffer_load_dwordx4 v76, s[16:19], s99 offen offset:3072 sc1 lds
    s_add_u32 m0, s93, 92928
    s_add_u32 s99, s99, 524288
    s_mov_b64 exec, s[80:81]
    buffer_load_dwordx4 v77, s[16:19], s100 offen sc1 lds
    s_mov_b64 exec, -1
    s_add_u32 s100, s100, 524288
    s_mov_b64 exec, -1
    s_waitcnt vmcnt(0) lgkmcnt(0)
    s_branch ge_51
rd_71:
    s_cmp_eq_u32 s38, 0
    s_cbranch_scc1 rc_72
    s_sub_u32 s38, s38, 1
    s_nop 7
    s_nop 7
    s_sleep 4
    s_mov_b64 exec, vcc
    s_lshl_b32 s98, s72, 5
    s_add_u32 s98, s98, 256
    s_sub_u32 s95, s98, 4
    s_max_i32 s95, s95, 0
    s_lshl_b32 s94, s98, 3
    s_lshl_b32 s95, s95, 3
    s_nop 0
    s_add_u32 s94, s94, 3457024
    s_add_u32 s95, s95, 3457024
    s_add_u32 s96, s94, 8192
    buffer_load_dwordx2 v[152:153], v47, s[16:19], s94 offen sc1
    buffer_load_dwordx2 v[154:155], v47, s[16:19], s96 offen sc1
    buffer_load_dwordx2 v[156:157], v48, s[16:19], s95 offen sc1
    s_mov_b64 exec, -1
    s_waitcnt vmcnt(0) lgkmcnt(0)
    s_branch sl_70
rd_73:
    s_cmp_eq_u32 s39, 0
    s_cbranch_scc1 rc_74
    s_sub_u32 s39, s39, 1
    s_nop 7
    s_nop 7
    s_waitcnt vmcnt(0) lgkmcnt(0)
    s_barrier
    s_lshl_b32 s25, s72, 5
    s_add_u32 s25, s25, 256
    s_sub_u32 s26, s25, 4
    s_max_i32 s26, s26, 0
    s_lshl_b32 s27, s71, 12
    s_add_u32 s27, s27, 9437184
    s_lshl_b32 s99, s25, 3
    s_lshl_b32 s100, s26, 3
    s_lshl_b32 s92, s24, 12
    s_lshl_b32 s93, s24, 9
    s_add_u32 s99, s99, s27
    s_add_u32 s100, s100, s27
    s_add_u32 m0, s92, 36352
    s_nop 0
    s_nop 0
    buffer_load_dwordx4 v73, s[16:19], s99 offen offset:0 sc1 lds
    buffer_load_dwordx4 v74, s[16:19], s99 offen offset:1024 sc1 lds
    buffer_load_dwordx4 v75, s[16:19], s99 offen offset:2048 sc1 lds
    buffer_load_dwordx4 v76, s[16:19], s99 offen offset:3072 sc1 lds
    s_add_u32 m0, s93, 53760
    s_add_u32 s99, s99, 524288
    s_mov_b64 exec, s[80:81]
    buffer_load_dwordx4 v77, s[16:19], s100 offen sc1 lds
    s_mov_b64 exec, -1
    s_add_u32 s100, s100, 524288
    s_add_u32 m0, s92, 55936
    s_nop 0
    s_nop 0
    buffer_load_dwordx4 v73, s[16:19], s99 offen offset:0 sc1 lds
    buffer_load_dwordx4 v74, s[16:19], s99 offen offset:1024 sc1 lds
    buffer_load_dwordx4 v75, s[16:19], s99 offen offset:2048 sc1 lds
    buffer_load_dwordx4 v76, s[16:19], s99 offen offset:3072 sc1 lds
    s_add_u32 m0, s93, 73344
    s_add_u32 s99, s99, 524288
    s_mov_b64 exec, s[80:81]
    buffer_load_dwordx4 v77, s[16:19], s100 offen sc1 lds
    s_mov_b64 exec, -1
    s_add_u32 s100, s100, 524288
    s_add_u32 m0, s92, 75520
    s_nop 0
    s_nop 0
    buffer_load_dwordx4 v73, s[16:19], s99 offen offset:0 sc1 lds
    buffer_load_dwordx4 v74, s[16:19], s99 offen offset:1024 sc1 lds
    buffer_load_dwordx4 v75, s[16:19], s99 offen offset:2048 sc1 lds
    buffer_load_dwordx4 v76, s[16:19], s99 offen offset:3072 sc1 lds
    s_add_u32 m0, s93, 92928
    s_add_u32 s99, s99, 524288
    s_mov_b64 exec, s[80:81]
    buffer_load_dwordx4 v77, s[16:19], s100 offen sc1 lds
    s_mov_b64 exec, -1
    s_add_u32 s100, s100, 524288
    s_mov_b64 exec, -1
    s_waitcnt vmcnt(0) lgkmcnt(0)
    s_branch ge_69
rd_76:
    s_cmp_eq_u32 s38, 0
    s_cbranch_scc1 rc_77
    s_sub_u32 s38, s38, 1
    s_nop 7
    s_nop 7
    s_sleep 4
    s_mov_b64 exec, vcc
    s_mov_b32 s96, 12058624
    buffer_load_dwordx4 v[216:219], v56, s[16:19], s96 offen offset:0 sc1
    buffer_load_dwordx4 v[220:223], v56, s[16:19], s96 offen offset:256 sc1
    s_mov_b32 s96, 12091392
    buffer_load_dwordx4 v[224:227], v56, s[16:19], s96 offen offset:0 sc1
    buffer_load_dwordx4 v[228:231], v56, s[16:19], s96 offen offset:256 sc1
    s_mov_b32 s96, 12124160
    buffer_load_dwordx4 v[232:235], v56, s[16:19], s96 offen offset:0 sc1
    buffer_load_dwordx4 v[236:239], v56, s[16:19], s96 offen offset:256 sc1
    s_mov_b32 s96, 12156928
    buffer_load_dwordx4 v[240:243], v56, s[16:19], s96 offen offset:0 sc1
    buffer_load_dwordx4 v[244:247], v56, s[16:19], s96 offen offset:256 sc1
    s_mov_b32 s96, 12058624
    buffer_load_dwordx2 v[248:249], v57, s[16:19], s96 offen offset:0 sc1
    buffer_load_dwordx2 v[252:253], v57, s[16:19], s96 offen offset:128 sc1
    s_mov_b32 s96, 12075008
    buffer_load_dwordx2 v[250:251], v57, s[16:19], s96 offen offset:0 sc1
    buffer_load_dwordx2 v[254:255], v57, s[16:19], s96 offen offset:128 sc1
    s_mov_b32 s96, 9437184
    buffer_load_dwordx4 v[208:211], v59, s[16:19], s96 offen sc1
    s_add_u32 s97, s36, 9437184
    buffer_load_dword v212, v61, s[16:19], s97 offen sc1
    s_mov_b64 exec, -1
    s_waitcnt vmcnt(0) lgkmcnt(0)
    s_branch oe_75
rd_79:
    s_cmp_eq_u32 s38, 0
    s_cbranch_scc1 rc_80
    s_sub_u32 s38, s38, 1
    s_nop 7
    s_nop 7
    s_sleep 4
    s_mov_b64 exec, vcc
    s_mov_b32 s96, 12062720
    buffer_load_dwordx4 v[216:219], v56, s[16:19], s96 offen offset:0 sc1
    buffer_load_dwordx4 v[220:223], v56, s[16:19], s96 offen offset:256 sc1
    s_mov_b32 s96, 12095488
    buffer_load_dwordx4 v[224:227], v56, s[16:19], s96 offen offset:0 sc1
    buffer_load_dwordx4 v[228:231], v56, s[16:19], s96 offen offset:256 sc1
    s_mov_b32 s96, 12128256
    buffer_load_dwordx4 v[232:235], v56, s[16:19], s96 offen offset:0 sc1
    buffer_load_dwordx4 v[236:239], v56, s[16:19], s96 offen offset:256 sc1
    s_mov_b32 s96, 12161024
    buffer_load_dwordx4 v[240:243], v56, s[16:19], s96 offen offset:0 sc1
    buffer_load_dwordx4 v[244:247], v56, s[16:19], s96 offen offset:256 sc1
    s_mov_b32 s96, 12060672
    buffer_load_dwordx2 v[248:249], v57, s[16:19], s96 offen offset:0 sc1
    buffer_load_dwordx2 v[252:253], v57, s[16:19], s96 offen offset:128 sc1
    s_mov_b32 s96, 12077056
    buffer_load_dwordx2 v[250:251], v57, s[16:19], s96 offen offset:0 sc1
    buffer_load_dwordx2 v[254:255], v57, s[16:19], s96 offen offset:128 sc1
    s_mov_b32 s96, 9439232
    buffer_load_dwordx4 v[208:211], v59, s[16:19], s96 offen sc1
    s_add_u32 s97, s36, 9439232
    buffer_load_dword v212, v61, s[16:19], s97 offen sc1
    s_mov_b64 exec, -1
    s_waitcnt vmcnt(0) lgkmcnt(0)
    s_branch oe_78
rd_84:
    s_cmp_eq_u32 s38, 0
    s_cbranch_scc1 rc_85
    s_sub_u32 s38, s38, 1
    s_nop 7
    s_nop 7
    s_sleep 4
    s_mov_b64 exec, vcc
    s_lshl_b32 s96, s75, 14
    s_add_u32 s96, s96, 14680064
    s_lshl_b32 s97, s24, 12
    s_add_u32 s97, s97, 3506176
    buffer_load_dwordx4 v[176:179], v62, s[16:19], s96 offen offset:0 sc1
    buffer_load_dwordx4 v[180:183], v62, s[16:19], s96 offen offset:1024 sc1
    buffer_load_dwordx4 v[184:187], v62, s[16:19], s97 offen offset:0 sc1
    buffer_load_dwordx4 v[188:191], v62, s[16:19], s97 offen offset:1024 sc1
    buffer_load_dwordx4 v[192:195], v62, s[16:19], s97 offen offset:2048 sc1
    buffer_load_dwordx4 v[196:199], v62, s[16:19], s97 offen offset:3072 sc1
    s_mov_b64 exec, -1
    s_waitcnt vmcnt(0) lgkmcnt(0)
    s_branch ce_83
rd_87:
    s_cmp_eq_u32 s38, 0
    s_cbranch_scc1 rc_88
    s_sub_u32 s38, s38, 1
    s_nop 7
    s_nop 7
    s_sleep 4
    s_mov_b64 exec, vcc
    s_lshl_b32 s96, s75, 14
    s_add_u32 s96, s96, 14680064
    s_lshl_b32 s97, s24, 12
    s_add_u32 s97, s97, 3510272
    buffer_load_dwordx4 v[248:251], v62, s[16:19], s96 offen offset:2048 sc1
    buffer_load_dwordx4 v[252:255], v62, s[16:19], s96 offen offset:3072 sc1
    buffer_load_dwordx4 v[96:99], v62, s[16:19], s97 offen offset:0 sc1
    buffer_load_dwordx4 v[100:103], v62, s[16:19], s97 offen offset:1024 sc1
    buffer_load_dwordx4 v[104:107], v62, s[16:19], s97 offen offset:2048 sc1
    buffer_load_dwordx4 v[108:111], v62, s[16:19], s97 offen offset:3072 sc1
    s_mov_b64 exec, -1
    s_waitcnt vmcnt(0) lgkmcnt(0)
    s_branch ce_86
L_last:
    s_endpgm
.section .rodata,"a"
.p2align 6
.amdhsa_kernel interleave_layers__sliding_local_dilated__ssm_conv_s4d__prompt_kernel
  .amdhsa_next_free_vgpr 512
  .amdhsa_next_free_sgpr 102
  .amdhsa_accum_offset 256
  .amdhsa_group_segment_fixed_size 0
  .amdhsa_kernarg_size 104
  .amdhsa_user_sgpr_count 2
  .amdhsa_user_sgpr_kernarg_segment_ptr 1
  .amdhsa_system_sgpr_workgroup_id_x 1
.end_amdhsa_kernel
```

```asm
; @launch grid=(256,1,1) block=(256,1,1) lds=163840
.amdgcn_target "amdgcn-amd-amdhsa--gfx950"
.text
.globl interleave_layers__sliding_local_dilated__ssm_conv_s4d__prompt_kernel
.p2align 8
.type interleave_layers__sliding_local_dilated__ssm_conv_s4d__prompt_kernel,@function
interleave_layers__sliding_local_dilated__ssm_conv_s4d__prompt_kernel:
    s_getpc_b64 s[42:43]
L_start:
    s_cmp_ge_u32 s2, 256
    s_cbranch_scc1 L_end
    s_load_dwordx16 s[44:59], s[0:1], 0
    s_load_dwordx8 s[60:67], s[0:1], 64
    s_load_dwordx2 s[68:69], s[0:1], 96
    v_and_b32 v1, 63, v0
    v_lshrrev_b32 v2, 6, v0
    s_nop 0
    v_readfirstlane_b32 s24, v2
    s_bfe_u32 s82, s2, 0x40003
    s_lshl_b32 s82, s82, 13
    v_lshrrev_b32 v159, 2, v0
    v_lshl_add_u32 v159, v159, 7, s82
    v_min_u32 v159, L_last-L_start, v159
    global_load_dword v159, v159, s[42:43]
    s_and_b32 s25, s2, 7
    s_lshr_b32 s26, s2, 3
    s_and_b32 s27, s26, 3
    s_lshr_b32 s28, s26, 4
    s_lshl_b32 s28, s28, 2
    s_add_u32 s3, s27, s28
    s_lshl_b32 s27, s3, 2
    s_lshr_b32 s70, 0x75206431, s27
    s_and_b32 s70, s70, 7
    s_and_b32 s27, s25, 1
    s_lshl_b32 s27, s27, 3
    s_add_u32 s70, s70, s27
    s_bfe_u32 s71, s26, 0x10002
    s_bfe_u32 s28, s26, 0x10003
    s_and_b32 s72, s25, 6
    s_add_u32 s72, s72, s28
    s_and_b32 s73, s26, 7
    s_lshr_b32 s28, s26, 3
    s_lshl_b32 s74, s25, 2
    s_add_u32 s74, s74, s28
    s_mul_i32 s75, s25, 20
    s_add_u32 s75, s75, s26
    s_min_u32 s27, s2, 239
    s_mul_i32 s25, s27, 10923
    s_lshr_b32 s25, s25, 16
    s_mul_i32 s26, s25, 6
    s_sub_u32 s26, s27, s26
    s_mul_i32 s27, s25, 61440
    s_mul_i32 s28, s26, 640
    s_add_u32 s27, s27, s28
    s_lshl_b32 s28, s24, 10
    v_add_u32 v85, 0, v0
    v_mul_u32_u24 v84, 1639, v85
    v_lshrrev_b32 v84, 16, v84
    v_mul_u32_u24 v84, 3200, v84
    v_lshl_add_u32 v85, v85, 4, v84
    v_add_u32 v86, 256, v0
    v_mul_u32_u24 v84, 1639, v86
    v_lshrrev_b32_e64 v84, 16, v84
    v_mul_u32_u24 v84, 3200, v84
    v_lshl_add_u32 v86, v86, 4, v84
    v_add_u32 v87, 512, v0
    v_min_u32 v87, 639, v87
    v_mul_u32_u24 v84, 1639, v87
    v_lshrrev_b32_e64 v84, 16, v84
    v_mul_u32_u24 v84, 3200, v84
    v_lshl_add_u32 v87, v87, 4, v84
    s_mov_b32 s76, 0
    s_mov_b32 s77, 0x80000000
    s_mov_b32 s80, -1
    s_mov_b32 s81, 0
    s_nop 0
    s_mov_b32 s78, 0xfe0000fe
    s_mov_b32 s79, 0xfe0000fe
    s_mov_b32 s6, 2621440
    s_mov_b32 s7, 0x20000
    s_mov_b32 s10, 2457600
    s_mov_b32 s11, 0x20000
    s_mov_b32 s14, 819200
    s_mov_b32 s15, 0x20000
    s_mov_b32 s18, 22061056
    s_mov_b32 s19, 0x20000
    s_mov_b32 s22, 2621440
    s_mov_b32 s23, 0x20000
    s_waitcnt lgkmcnt(0)
    s_mov_b32 s4, s44
    s_and_b32 s5, s45, 0xffff
    s_mov_b32 s8, s46
    s_and_b32 s9, s47, 0xffff
    s_mov_b32 s12, s48
    s_and_b32 s13, s49, 0xffff
    s_mov_b32 s16, s68
    s_and_b32 s17, s69, 0xffff
    s_mov_b32 s20, s64
    s_and_b32 s21, s65, 0xffff
    s_cmp_lg_u32 s2, 255
    s_cbranch_scc1 fz_1
    v_mov_b32 v120, 0
    v_mov_b32 v121, 0
    v_mov_b32 v122, 0
    v_mov_b32 v123, 0
    v_lshlrev_b32 v124, 4, v0
    s_mov_b32 s88, 3538944
    buffer_store_dwordx4 v[120:123], v124, s[16:19], s88 offen sc1
    s_mov_b32 s88, 3543040
    buffer_store_dwordx4 v[120:123], v124, s[16:19], s88 offen sc1
    s_mov_b32 s88, 3547136
    buffer_store_dwordx4 v[120:123], v124, s[16:19], s88 offen sc1
    s_mov_b32 s88, 3555328
    buffer_store_dwordx4 v[120:123], v124, s[16:19], s88 offen sc1
    s_mov_b32 s88, 3559424
    buffer_store_dwordx4 v[120:123], v124, s[16:19], s88 offen sc1
    s_mov_b32 s88, 3563520
    buffer_store_dwordx4 v[120:123], v124, s[16:19], s88 offen sc1
fz_1:
    s_min_u32 s96, s75, 159
    s_lshl_b32 s96, s96, 2
    s_add_u32 s96, s96, s24
    s_mul_i32 s97, s96, 384
    s_lshl_b32 s96, s96, 1
    v_lshl_add_u32 v2, v1, 2, s97
    v_mov_b32 v241, s96
    global_load_dword v232, v2, s[52:53]
    global_load_dword v233, v2, s[54:55]
    global_load_dword v234, v2, s[56:57]
    global_load_dword v235, v2, s[58:59]
    global_load_ushort v240, v241, s[60:61]
    s_add_u32 m0, s28, 134272
    s_nop 0
    buffer_load_dwordx4 v85, s[8:11], s27 offen lds
    s_add_u32 m0, s28, 138368
    s_nop 0
    buffer_load_dwordx4 v86, s[8:11], s27 offen lds
    s_add_u32 m0, s28, 142464
    s_nop 0
    buffer_load_dwordx4 v87, s[8:11], s27 offen lds
    s_lshr_b32 s29, s26, 1
    s_and_b32 s30, s26, 1
    s_lshl_b32 s30, s30, 3
    s_lshl_b32 s31, s25, 10
    s_add_u32 s31, s31, 0
    s_cmp_ge_u32 s2, 240
    s_cselect_b32 s31, 1073741824, s31
    v_bfe_u32 v93, v0, 2, 2
    v_bfe_u32 v92, v0, 1, 1
    v_lshl_add_u32 v92, v92, 3, v93
    v_mul_u32_u24 v92, 640, v92
    v_and_b32 v93, 1, v0
    v_mul_u32_u24 v93, 40, v93
    v_add_u32 v91, v92, v93
    v_add_u32 v91, 134272, v91
    v_lshrrev_b32 v88, 4, v0
    v_add_u32 v88, 0, v88
    v_cmp_gt_u32 vcc, 40, v88
    v_min_u32 v88, 39, v88
    v_mul_u32_u24 v89, 13108, v88
    v_lshrrev_b32 v89, 16, v89
    v_mul_u32_u24 v90, 5, v89
    v_sub_u32_e64 v90, v88, v90
    v_mul_u32_u24 v92, 80, v89
    v_lshl_add_u32 v92, v90, 3, v92
    v_add_u32 v111, v92, v91
    v_add_u32 v89, s30, v89
    v_cmp_eq_u32 s[82:83], 4, v90
    v_mov_b32 v92, s29
    s_nop 0
    v_cndmask_b32 v93, v90, v92, s[82:83]
    v_cndmask_b32 v92, v92, 3, s[82:83]
    v_lshl_add_u32 v89, v89, 2, v93
    v_mul_u32_u24 v89, 40960, v89
    v_lshl_add_u32 v89, v92, 8, v89
    v_and_b32 v92, 15, v0
    v_lshl_add_u32 v89, v92, 4, v89
    v_mov_b32 v92, 1073741824
    v_cndmask_b32 v89, v92, v89, vcc
    v_add_u32 v108, s31, v89
    v_lshrrev_b32 v88, 4, v0
    v_add_u32 v88, 16, v88
    v_cmp_gt_u32 vcc, 40, v88
    v_min_u32 v88, 39, v88
    v_mul_u32_u24 v89, 13108, v88
    v_lshrrev_b32 v89, 16, v89
    v_mul_u32_u24 v90, 5, v89
    v_sub_u32_e64 v90, v88, v90
    v_mul_u32_u24 v92, 80, v89
    v_lshl_add_u32 v92, v90, 3, v92
    v_add_u32 v112, v92, v91
    v_add_u32 v89, s30, v89
    v_cmp_eq_u32 s[82:83], 4, v90
    v_mov_b32 v92, s29
    s_nop 0
    v_cndmask_b32 v93, v90, v92, s[82:83]
    v_cndmask_b32 v92, v92, 3, s[82:83]
    v_lshl_add_u32 v89, v89, 2, v93
    v_mul_u32_u24 v89, 40960, v89
    v_lshl_add_u32 v89, v92, 8, v89
    v_and_b32 v92, 15, v0
    v_lshl_add_u32 v89, v92, 4, v89
    v_mov_b32 v92, 1073741824
    v_cndmask_b32 v89, v92, v89, vcc
    v_add_u32 v109, s31, v89
    v_lshrrev_b32 v88, 4, v0
    v_add_u32 v88, 32, v88
    v_cmp_gt_u32 vcc, 40, v88
    v_min_u32 v88, 39, v88
    v_mul_u32_u24 v89, 13108, v88
    v_lshrrev_b32 v89, 16, v89
    v_mul_u32_u24 v90, 5, v89
    v_sub_u32_e64 v90, v88, v90
    v_mul_u32_u24 v92, 80, v89
    v_lshl_add_u32 v92, v90, 3, v92
    v_add_u32 v113, v92, v91
    v_add_u32 v89, s30, v89
    v_cmp_eq_u32 s[82:83], 4, v90
    v_mov_b32 v92, s29
    s_nop 0
    v_cndmask_b32 v93, v90, v92, s[82:83]
    v_cndmask_b32 v92, v92, 3, s[82:83]
    v_lshl_add_u32 v89, v89, 2, v93
    v_mul_u32_u24 v89, 40960, v89
    v_lshl_add_u32 v89, v92, 8, v89
    v_and_b32 v92, 15, v0
    v_lshl_add_u32 v89, v92, 4, v89
    v_mov_b32 v92, 1073741824
    v_cndmask_b32 v89, v92, v89, vcc
    v_add_u32 v110, s31, v89
    s_mul_i32 s25, s3, 18
    s_lshl_b32 s26, s72, 7
    s_add_u32 s25, s25, s26
    s_add_u32 s25, s25, s71
    s_add_u32 s25, s25, -16
    s_max_i32 s25, s25, 0
    s_mul_i32 s25, s25, 1280
    v_lshrrev_b32_e64 v204, 1, v0
    v_min_u32 v204, 89, v204
    v_mul_u32_u24 v205, 6554, v204
    v_lshrrev_b32_e64 v205, 16, v205
    v_mul_u32_u24 v205, 1280, v205
    v_lshl_add_u32 v204, v204, 7, v205
    buffer_load_dword v204, v204, s[4:7], s25 offen
    s_and_b32 s25, s2, 7
    s_lshl_b32 s86, s25, 7
    s_add_u32 s86, s86, 3538944
    s_lshl_b32 s87, s25, 10
    s_add_u32 s87, s87, 3538944
    s_add_u32 s89, s87, 16384
    v_cmp_gt_u32 s[50:51], 8, v0
    v_cmp_eq_u32 vcc, 0, v0
    v_lshlrev_b32 v4, 7, v1
    v_mov_b32 v6, 1073741824
    v_cndmask_b32 v4, v6, v4, s[50:51]
    v_cndmask_b32 v6, v6, 0, vcc
    v_mov_b32 v5, 0
    s_cmp_lg_u32 s2, 255
    s_cbranch_scc1 fr_2
    v_mov_b32 v2, 1
    s_waitcnt vmcnt(9)
    s_barrier
    s_mov_b64 exec, 1
    global_store_dword v5, v2, s[66:67] sc1
    s_mov_b64 exec, -1
fr_2:
    v_mov_b32 v140, 0
    v_mov_b32_e64 v141, 0
    v_mov_b32 v142, 0x3f803f80
    v_mov_b32 v143, 0x3f803f80
    v_lshlrev_b32_e64 v144, 3, v0
    v_add_u32 v144, 155648, v144
    ds_write_b64 v144, v[140:141]
    ds_write_b64 v144, v[140:141] offset:512
    ds_write_b64 v144, v[142:143] offset:2560
    ds_write_b64 v144, v[142:143] offset:3072
    v_and_b32 v50, 31, v1
    v_lshrrev_b32 v51, 5, v1
    v_mul_u32_u24 v52, 40, v50
    v_mul_u32_u24 v53, 3200, v51
    v_add_u32 v53, v52, v53
    s_lshl_b32 s25, s24, 3
    s_add_u32 s25, s25, 320
    v_add_u32 v38, s25, v53
    s_mul_i32 s25, s24, 6400
    s_add_u32 s25, s25, 352
    v_add_u32 v39, s25, v53
    s_lshl_b32 s31, s71, 12
    v_lshl_add_u32 v47, v50, 3, s31
    v_bfe_u32 v52, v1, 2, 1
    v_and_b32 v53, 3, v1
    v_lshlrev_b32 v54, 13, v52
    v_lshl_add_u32 v54, v53, 3, v54
    v_add_u32_e64 v48, s31, v54
    v_bfe_u32 v54, v1, 4, 1
    v_lshl_add_u32 v52, v54, 1, v52
    v_mul_u32_u24 v52, 40, v52
    v_add_u32 v52, v52, v53
    v_mul_u32_u24_e64 v52, 40, v52
    v_bfe_u32 v53, v1, 3, 1
    v_cmp_eq_u32 s[82:83], v53, v54
    v_lshl_add_u32 v53, v53, 1, v51
    v_cmp_eq_u32 vcc, 3, v53
    v_mov_b32 v54, s24
    s_nop 0
    v_cndmask_b32 v53, v53, v54, vcc
    v_cndmask_b32 v54, v54, 4, vcc
    v_mul_u32_u24 v53, 6400, v53
    v_lshl_add_u32 v52, v54, 3, v52
    v_add_u32_e64 v52, v52, v53
    v_add_u32 v40, 160, v52
    v_mov_b32 v52, 19584
    v_mov_b32 v53, 128
    v_cndmask_b32 v49, v53, v52, s[78:79]
    v_and_b32 v50, 15, v1
    v_lshrrev_b32 v51, 4, v1
    s_and_b32 s25, s24, 1
    s_and_b32 s26, s24, 2
    s_mul_i32 s27, s25, 3200
    s_mul_i32 s28, s26, 320
    s_add_u32 s27, s27, s28
    s_add_u32 s27, s27, 0
    v_and_b32 v52, 1, v1
    v_mul_u32_u24 v52, 1600, v52
    v_lshrrev_b32 v53, 1, v50
    v_mul_u32_u24_e64 v54, 40, v53
    v_add3_u32 v52, v52, v54, s27
    v_lshl_add_u32 v41, v51, 3, v52
    v_add_u32_e64 v42, 32, v52
    v_bfe_u32 v52, v1, 2, 1
    v_mul_u32_u24 v52, 1600, v52
    v_lshrrev_b32 v54, 3, v1
    v_mul_u32_u24 v54, 40, v54
    v_add3_u32 v52, v52, v54, s27
    v_add_u32 v52, 12800, v52
    v_and_b32 v54, 3, v1
    v_lshl_add_u32 v43, v54, 3, v52
    v_add_u32 v52, 32, v52
    v_cmp_eq_u32 vcc, 0, v54
    v_mov_b32 v54, 158208
    s_nop 0
    v_cndmask_b32 v44, v54, v52, vcc
    v_and_b32 v52, 1, v51
    v_add_u32 v52, s26, v52
    v_lshrrev_b32 v54, 2, v50
    v_lshl_add_u32 v52, v52, 2, v54
    v_and_b32 v53, 1, v53
    v_lshl_add_u32 v52, v53, 4, v52
    v_and_b32 v53, 1, v50
    v_lshl_add_u32 v52, v53, 10, v52
    s_lshl_b32 s30, s70, 1
    s_add_u32 s30, s30, s25
    s_lshl_b32 s29, s30, 3
    s_add_u32 s29, s29, s71
    s_lshl_b32 s29, s29, 13
    v_lshrrev_b32 v53, 1, v51
    v_lshlrev_b32 v53, 15, v53
    v_lshl_add_u32 v53, v52, 4, v53
    v_add_u32_e64 v45, s29, v53
    s_lshl_b32 s29, s30, 2
    s_add_u32 s29, s29, s71
    s_lshl_b32 s29, s29, 12
    s_add_u32 s29, s29, 2097152
    v_lshl_add_u32 v46, v52, 3, s29
    s_or_b32 s29, s26, s72
    s_cmp_eq_u32 s29, 0
    s_cselect_b64 s[90:91], -1, 0
    v_lshlrev_b32 v52, 2, v51
    v_sub_u32 v52, v50, v52
    v_mov_b32 v55, 0xf149f2ca
    v_subrev_u32 v53, 0, v52
    v_cmp_lt_u32 vcc, 7, v53
    s_nop 1
    v_cndmask_b32 v28, 0, v55, vcc
    v_cmp_lt_i32 vcc, -9, v53
    s_nop 1
    v_cndmask_b32 v32, 0, v55, vcc
    v_cmp_le_i32 vcc, 0, v53
    v_mov_b32 v54, 0xffff
    s_nop 0
    v_cndmask_b32 v54, 0, v54, vcc
    v_mov_b32 v36, v54
    v_subrev_u32 v53, 1, v52
    v_cmp_lt_u32 vcc, 7, v53
    s_nop 1
    v_cndmask_b32 v29, 0, v55, vcc
    v_cmp_lt_i32 vcc, -9, v53
    s_nop 1
    v_cndmask_b32 v33, 0, v55, vcc
    v_cmp_le_i32 vcc, 0, v53
    v_mov_b32 v54, 0xffff0000
    s_nop 0
    v_cndmask_b32 v54, 0, v54, vcc
    v_or_b32 v36, v36, v54
    v_subrev_u32 v53, 2, v52
    v_cmp_lt_u32 vcc, 7, v53
    s_nop 1
    v_cndmask_b32 v30, 0, v55, vcc
    v_cmp_lt_i32 vcc, -9, v53
    s_nop 1
    v_cndmask_b32 v34, 0, v55, vcc
    v_cmp_le_i32 vcc, 0, v53
    v_mov_b32 v54, 0xffff
    s_nop 0
    v_cndmask_b32 v54, 0, v54, vcc
    v_mov_b32 v37, v54
    v_subrev_u32 v53, 3, v52
    v_cmp_lt_u32 vcc, 7, v53
    s_nop 1
    v_cndmask_b32 v31, 0, v55, vcc
    v_cmp_lt_i32 vcc, -9, v53
    s_nop 1
    v_cndmask_b32 v35, 0, v55, vcc
    v_cmp_le_i32 vcc, 0, v53
    v_mov_b32 v54, 0xffff0000
    s_nop 0
    v_cndmask_b32 v54, 0, v54, vcc
    v_or_b32 v37, v37, v54
    v_and_b32 v62, 15, v1
    v_lshrrev_b32 v63, 4, v1
    s_and_b32 s25, s74, 3
    s_lshr_b32 s26, s74, 2
    s_lshl_b32 s27, s24, 6
    s_add_u32 s27, s27, s25
    s_lshl_b32 s27, s27, 13
    s_lshl_b32 s28, s26, 9
    s_add_u32 s27, s27, s28
    v_lshl_add_u32 v64, v63, 17, s27
    v_lshl_add_u32 v56, v62, 4, v64
    s_lshl_b32 s27, s24, 5
    s_add_u32 s27, s27, s25
    s_lshl_b32 s27, s27, 12
    s_lshl_b32 s28, s26, 8
    s_add_u32 s27, s27, s28
    s_add_u32 s27, s27, 2097152
    v_lshl_add_u32 v64, v63, 15, s27
    v_lshl_add_u32 v57, v62, 3, v64
    v_lshlrev_b32 v58, 4, v1
    s_lshl_b32 s29, s25, 12
    s_add_u32 s29, s29, s28
    v_lshl_add_u32 v64, v62, 4, s29
    v_lshl_add_u32 v61, v63, 2, v64
    s_mul_i32 s30, s73, 20
    s_lshl_b32 s31, s24, 2
    s_add_u32 s30, s30, s31
    s_lshl_b32 s31, s30, 14
    v_lshl_add_u32 v64, v63, 14, v64
    v_add_u32 v59, s31, v64
    s_lshl_b32 s31, s26, 7
    s_add_u32 s31, s31, s25
    s_mul_i32 s31, s31, 1280
    s_lshl_b32 s30, s30, 3
    s_add_u32 s31, s31, s30
    v_mul_u32_u24 v64, 10240, v62
    v_lshl_add_u32 v64, v63, 3, v64
    v_add_u32 v60, s31, v64
    s_and_b32 s25, s24, 1
    s_lshl_b32 s25, s25, 6
    s_and_b32 s26, s24, 2
    s_add_u32 s25, s25, s26
    s_mul_i32 s25, s25, 1280
    v_lshrrev_b32 v140, 4, v1
    v_and_b32 v141, 15, v1
    v_xor_b32 v141, v140, v141
    v_lshlrev_b32 v141, 4, v141
    v_mul_u32_u24 v142, 5120, v140
    v_add3_u32 v73, v141, v142, s25
    s_and_b32 s25, s24, 1
    s_lshl_b32 s25, s25, 3
    s_add_u32 s25, s25, s26
    s_mul_i32 s25, s25, 1280
    v_add3_u32 v77, v141, v142, s25
    v_lshrrev_b32 v141, 5, v1
    v_and_b32 v140, 3, v1
    v_xor_b32 v142, v140, v141
    v_lshlrev_b32_e64 v142, 4, v142
    v_lshl_add_u32 v142, v140, 8, v142
    v_bfe_u32 v140, v1, 2, 3
    v_mul_u32_u24 v140, 1088, v140
    v_add_u32 v78, v140, v142
    v_and_b32 v140, 1, v1
    v_xor_b32 v142, v140, v141
    v_lshlrev_b32 v142, 4, v142
    v_lshl_add_u32 v142, v140, 8, v142
    v_bfe_u32 v140, v1, 1, 2
    v_mul_u32_u24 v140, 544, v140
    v_add_u32_e64 v142, v140, v142
    v_add_u32 v74, 19392, v73
    v_add_u32 v75, 38784, v73
    v_add_u32 v76, 58176, v73
    v_add_u32 v142, 53760, v142
    v_and_b32 v140, 31, v1
    v_cmp_eq_u32 vcc, 0, v140
    v_cmp_eq_u32 s[82:83], 24, v140
    s_nop 0
    s_or_b64 vcc, vcc, s[82:83]
    v_mov_b32 v140, 155776
    v_mov_b32 v141, 158400
    v_cndmask_b32_e64 v140, v140, v141, vcc
    v_cndmask_b32 v79, v140, v142, s[78:79]
    v_bfe_u32 v201, v1, 3, 2
    v_and_b32 v202, s24, v201
    v_cmp_eq_u32 vcc, 3, v202
    v_lshrrev_b32 v202, 5, v1
    v_lshl_add_u32 v201, v201, 1, v202
    v_and_b32 v202, 7, v1
    v_lshl_add_u32 v201, v201, 3, v202
    v_lshlrev_b32 v200, 4, v201
    v_mov_b32 v201, 1073741824
    v_cndmask_b32 v200, v200, v201, vcc
    s_lshl_b32 s101, s70, 2
    s_add_u32 s101, s101, s24
    s_mul_i32 s101, s101, 40960
    s_add_u32 s101, s101, 0
    s_lshl_b32 s25, s72, 5
    s_add_u32 s25, s25, 0
    s_sub_u32 s26, s25, 4
    s_max_i32 s26, s26, 0
    s_mul_i32 s27, s71, 1280
    s_mul_i32 s99, s25, 5120
    s_mul_i32 s100, s26, 5120
    s_mul_i32 s92, s24, 4352
    s_mul_i32 s93, s24, 544
    s_add_u32 s99, s99, s27
    s_add_u32 s100, s100, s27
    s_mov_b32 s38, 0x10000
    s_mov_b32 s39, 0x1000
    s_cmp_ge_u32 s2, 160
    s_cbranch_scc1 nc_3
    s_mul_i32 s37, s24, 8704
    s_add_u32 s25, s37, 0
    s_add_u32 s37, s37, 0
    s_mov_b32 m0, s37
    v_and_b32 v199, 31, v1
    v_mul_u32_u24 v199, 272, v199
    v_lshrrev_b32 v215, 5, v1
    v_lshl_add_u32 v199, v215, 4, v199
    v_add_u32 v252, s25, v199
    s_waitcnt vmcnt(4)
    v_lshlrev_b32 v253, 16, v240
    v_mul_f32 v253, 0x3fb8aa3b, v253
    v_exp_f32 v253, v253
    s_nop 0
    v_cvt_pk_bf16_f32 v253, v253, v253
    v_lshlrev_b32 v253, 16, v253
    v_lshlrev_b32 v199, 16, v232
    v_mul_f32 v199, 0x3fb8aa3b, v199
    v_exp_f32 v199, v199
    v_lshlrev_b32 v255, 16, v233
    v_mul_f32 v255, v255, v253
    v_mul_f32 v255, 0x3e22f983, v255
    v_cvt_pk_bf16_f32 v199, v199, v199
    v_lshlrev_b32 v199, 16, v199
    v_mul_f32_e64 v254, v199, v253
    v_mul_f32 v254, 0xbfb8aa3b, v254
    v_mul_f32 v182, 0x41000000, v254
    v_mul_f32 v185, 0x41000000, v255
    v_mul_f32 v184, 0x43800000, v254
    v_mul_f32 v189, 0x43800000, v255
    v_fract_f32 v185, v185
    v_fract_f32 v188, v255
    s_waitcnt vmcnt(1)
    s_barrier
    ds_read_b64_tr_b16 v[96:97], v111
    ds_read_b64_tr_b16 v[98:99], v111 offset:2560
    ds_read_b64_tr_b16 v[100:101], v112
    ds_read_b64_tr_b16 v[102:103], v112 offset:2560
    ds_read_b64_tr_b16 v[104:105], v113
    ds_read_b64_tr_b16 v[106:107], v113 offset:2560
    s_waitcnt lgkmcnt(4)
    buffer_store_dwordx4 v[96:99], v108, s[16:19], 0 offen sc1
    s_waitcnt lgkmcnt(2)
    buffer_store_dwordx4 v[100:103], v109, s[16:19], 0 offen sc1
    s_waitcnt lgkmcnt(0)
    buffer_store_dwordx4 v[104:107], v110, s[16:19], 0 offen sc1
    global_load_dword v7, v5, s[66:67] sc1
    v_fract_f32 v189, v189
    v_exp_f32 v182, v182
    v_exp_f32 v183, v254
    v_exp_f32 v184, v184
    v_cos_f32 v186, v185
    v_sin_f32 v187, v185
    v_cos_f32 v180, v188
    v_sin_f32 v181, v188
    v_cos_f32 v190, v189
    v_sin_f32 v191, v189
    v_lshlrev_b32 v192, 16, v234
    v_lshlrev_b32 v193, 16, v235
    v_add_f32 v199, v253, v253
    v_mul_f32 v192, v192, v199
    v_mul_f32 v193, v193, v199
    v_mul_f32 v186, v186, v182
    v_mul_f32 v187, v187, v182
    v_mul_f32 v180, v180, v183
    v_mul_f32 v181, v181, v183
    v_mul_f32 v190, v190, v184
    v_mul_f32 v191, v191, v184
    v_mov_b32 v242, 0x3f80
    v_cvt_pk_bf16_f32 v243, v186, v187
    v_pk_mul_f32 v[194:195], v[186:187], v[186:187] op_sel:[0,0] op_sel_hi:[0,1]
    v_pk_fma_f32 v[172:173], v[186:187], v[186:187], v[194:195] op_sel:[1,1,0] op_sel_hi:[1,0,1] neg_lo:[0,1,0]
    v_cvt_pk_bf16_f32 v244, v172, v173
    v_pk_mul_f32 v[194:195], v[172:173], v[186:187] op_sel:[0,0] op_sel_hi:[0,1]
    v_pk_fma_f32 v[174:175], v[172:173], v[186:187], v[194:195] op_sel:[1,1,0] op_sel_hi:[1,0,1] neg_lo:[0,1,0]
    v_cvt_pk_bf16_f32 v245, v174, v175
    v_pk_mul_f32 v[194:195], v[174:175], v[186:187] op_sel:[0,0] op_sel_hi:[0,1]
    v_pk_fma_f32 v[172:173], v[174:175], v[186:187], v[194:195] op_sel:[1,1,0] op_sel_hi:[1,0,1] neg_lo:[0,1,0]
    v_cvt_pk_bf16_f32 v246, v172, v173
    v_pk_mul_f32 v[194:195], v[172:173], v[186:187] op_sel:[0,0] op_sel_hi:[0,1]
    v_pk_fma_f32 v[174:175], v[172:173], v[186:187], v[194:195] op_sel:[1,1,0] op_sel_hi:[1,0,1] neg_lo:[0,1,0]
    v_cvt_pk_bf16_f32 v247, v174, v175
    v_pk_mul_f32 v[194:195], v[174:175], v[186:187] op_sel:[0,0] op_sel_hi:[0,1]
    v_pk_fma_f32 v[172:173], v[174:175], v[186:187], v[194:195] op_sel:[1,1,0] op_sel_hi:[1,0,1] neg_lo:[0,1,0]
    v_cvt_pk_bf16_f32 v248, v172, v173
    v_pk_mul_f32 v[194:195], v[172:173], v[186:187] op_sel:[0,0] op_sel_hi:[0,1]
    v_pk_fma_f32 v[174:175], v[172:173], v[186:187], v[194:195] op_sel:[1,1,0] op_sel_hi:[1,0,1] neg_lo:[0,1,0]
    s_min_u32 s96, s75, 159
    s_lshl_b32 s96, s96, 2
    s_add_u32 s96, s96, s24
    s_mul_i32 s97, s96, 384
    s_lshl_b32 s96, s96, 1
    v_lshl_add_u32 v2, v1, 1, s97
    v_mov_b32 v241, s96
    global_load_ushort v236, v2, s[52:53] offset:256
    global_load_ushort v237, v2, s[54:55] offset:256
    global_load_ushort v238, v2, s[56:57] offset:256
    global_load_ushort v239, v2, s[58:59] offset:256
    global_load_ushort v241, v241, s[62:63]
    v_cvt_pk_bf16_f32 v249, v174, v175
    v_pk_mul_f32 v[194:195], v[174:175], v[186:187] op_sel:[0,0] op_sel_hi:[0,1]
    v_pk_fma_f32 v[172:173], v[174:175], v[186:187], v[194:195] op_sel:[1,1,0] op_sel_hi:[1,0,1] neg_lo:[0,1,0]
    v_cvt_pk_bf16_f32 v250, v172, v173
    v_pk_mul_f32 v[194:195], v[172:173], v[186:187] op_sel:[0,0] op_sel_hi:[0,1]
    v_pk_fma_f32 v[174:175], v[172:173], v[186:187], v[194:195] op_sel:[1,1,0] op_sel_hi:[1,0,1] neg_lo:[0,1,0]
    v_cvt_pk_bf16_f32 v251, v174, v175
    ds_write_addtid_b32 v242 offset:0
    ds_write_addtid_b32 v243 offset:272
    ds_write_addtid_b32 v244 offset:544
    ds_write_addtid_b32 v245 offset:816
    ds_write_addtid_b32 v246 offset:1088
    ds_write_addtid_b32 v247 offset:1360
    ds_write_addtid_b32 v248 offset:1632
    ds_write_addtid_b32 v249 offset:1904
    ds_write_addtid_b32 v250 offset:2176
    ds_write_addtid_b32 v251 offset:2448
    v_pk_mul_f32 v[194:195], v[174:175], v[186:187] op_sel:[0,0] op_sel_hi:[0,1]
    v_pk_fma_f32 v[172:173], v[174:175], v[186:187], v[194:195] op_sel:[1,1,0] op_sel_hi:[1,0,1] neg_lo:[0,1,0]
    v_cvt_pk_bf16_f32 v242, v172, v173
    v_pk_mul_f32 v[194:195], v[172:173], v[186:187] op_sel:[0,0] op_sel_hi:[0,1]
    v_pk_fma_f32 v[174:175], v[172:173], v[186:187], v[194:195] op_sel:[1,1,0] op_sel_hi:[1,0,1] neg_lo:[0,1,0]
    v_cvt_pk_bf16_f32 v243, v174, v175
    v_pk_mul_f32 v[194:195], v[174:175], v[186:187] op_sel:[0,0] op_sel_hi:[0,1]
    v_pk_fma_f32 v[172:173], v[174:175], v[186:187], v[194:195] op_sel:[1,1,0] op_sel_hi:[1,0,1] neg_lo:[0,1,0]
    v_cvt_pk_bf16_f32 v244, v172, v173
    v_pk_mul_f32 v[194:195], v[172:173], v[186:187] op_sel:[0,0] op_sel_hi:[0,1]
    v_pk_fma_f32 v[174:175], v[172:173], v[186:187], v[194:195] op_sel:[1,1,0] op_sel_hi:[1,0,1] neg_lo:[0,1,0]
    v_cvt_pk_bf16_f32 v245, v174, v175
    v_pk_mul_f32 v[194:195], v[174:175], v[186:187] op_sel:[0,0] op_sel_hi:[0,1]
    v_pk_fma_f32 v[172:173], v[174:175], v[186:187], v[194:195] op_sel:[1,1,0] op_sel_hi:[1,0,1] neg_lo:[0,1,0]
    v_cvt_pk_bf16_f32 v246, v172, v173
    v_pk_mul_f32 v[194:195], v[172:173], v[186:187] op_sel:[0,0] op_sel_hi:[0,1]
    v_pk_fma_f32 v[174:175], v[172:173], v[186:187], v[194:195] op_sel:[1,1,0] op_sel_hi:[1,0,1] neg_lo:[0,1,0]
    v_cvt_pk_bf16_f32 v247, v174, v175
    v_pk_mul_f32 v[194:195], v[174:175], v[186:187] op_sel:[0,0] op_sel_hi:[0,1]
    v_pk_fma_f32 v[172:173], v[174:175], v[186:187], v[194:195] op_sel:[1,1,0] op_sel_hi:[1,0,1] neg_lo:[0,1,0]
    v_cvt_pk_bf16_f32 v248, v172, v173
    v_pk_mul_f32 v[194:195], v[172:173], v[186:187] op_sel:[0,0] op_sel_hi:[0,1]
    v_pk_fma_f32 v[174:175], v[172:173], v[186:187], v[194:195] op_sel:[1,1,0] op_sel_hi:[1,0,1] neg_lo:[0,1,0]
    v_lshrrev_b32 v132, 5, v0
    v_and_b32 v133, 31, v0
    v_mul_u32_u24 v132, 1280, v132
    v_lshl_add_u32 v134, v133, 4, v132
    v_mov_b32 v135, 1073741824
    v_cmp_gt_u32 vcc, 16, v133
    s_mul_i32 s96, s2, 10240
    buffer_load_dwordx4 v[120:123], v134, s[4:7], s96 offen
    v_cndmask_b32_e64 v135, v135, v134, vcc
    buffer_load_dwordx4 v[124:127], v134, s[4:7], s96 offen offset:512
    buffer_load_dwordx4 v[128:131], v135, s[4:7], s96 offen offset:1024
    v_cvt_pk_bf16_f32 v249, v174, v175
    v_pk_mul_f32 v[194:195], v[174:175], v[186:187] op_sel:[0,0] op_sel_hi:[0,1]
    v_pk_fma_f32 v[172:173], v[174:175], v[186:187], v[194:195] op_sel:[1,1,0] op_sel_hi:[1,0,1] neg_lo:[0,1,0]
    v_cvt_pk_bf16_f32 v250, v172, v173
    v_pk_mul_f32 v[194:195], v[172:173], v[186:187] op_sel:[0,0] op_sel_hi:[0,1]
    v_pk_fma_f32 v[174:175], v[172:173], v[186:187], v[194:195] op_sel:[1,1,0] op_sel_hi:[1,0,1] neg_lo:[0,1,0]
    v_cvt_pk_bf16_f32 v251, v174, v175
    ds_write_addtid_b32 v242 offset:2720
    ds_write_addtid_b32 v243 offset:2992
    ds_write_addtid_b32 v244 offset:3264
    ds_write_addtid_b32 v245 offset:3536
    ds_write_addtid_b32 v246 offset:3808
    ds_write_addtid_b32 v247 offset:4080
    ds_write_addtid_b32 v248 offset:4352
    ds_write_addtid_b32 v249 offset:4624
    ds_write_addtid_b32 v250 offset:4896
    ds_write_addtid_b32 v251 offset:5168
    v_pk_mul_f32 v[194:195], v[174:175], v[186:187] op_sel:[0,0] op_sel_hi:[0,1]
    v_pk_fma_f32 v[172:173], v[174:175], v[186:187], v[194:195] op_sel:[1,1,0] op_sel_hi:[1,0,1] neg_lo:[0,1,0]
    v_cvt_pk_bf16_f32 v242, v172, v173
    v_pk_mul_f32 v[194:195], v[172:173], v[186:187] op_sel:[0,0] op_sel_hi:[0,1]
    v_pk_fma_f32 v[174:175], v[172:173], v[186:187], v[194:195] op_sel:[1,1,0] op_sel_hi:[1,0,1] neg_lo:[0,1,0]
    v_cvt_pk_bf16_f32 v243, v174, v175
    v_pk_mul_f32 v[194:195], v[174:175], v[186:187] op_sel:[0,0] op_sel_hi:[0,1]
    v_pk_fma_f32 v[172:173], v[174:175], v[186:187], v[194:195] op_sel:[1,1,0] op_sel_hi:[1,0,1] neg_lo:[0,1,0]
    v_cvt_pk_bf16_f32 v244, v172, v173
    v_pk_mul_f32 v[194:195], v[172:173], v[186:187] op_sel:[0,0] op_sel_hi:[0,1]
    v_pk_fma_f32 v[174:175], v[172:173], v[186:187], v[194:195] op_sel:[1,1,0] op_sel_hi:[1,0,1] neg_lo:[0,1,0]
    v_cvt_pk_bf16_f32 v245, v174, v175
    v_pk_mul_f32 v[194:195], v[174:175], v[186:187] op_sel:[0,0] op_sel_hi:[0,1]
    v_pk_fma_f32 v[172:173], v[174:175], v[186:187], v[194:195] op_sel:[1,1,0] op_sel_hi:[1,0,1] neg_lo:[0,1,0]
    v_cvt_pk_bf16_f32 v246, v172, v173
    v_pk_mul_f32 v[194:195], v[172:173], v[186:187] op_sel:[0,0] op_sel_hi:[0,1]
    v_pk_fma_f32 v[174:175], v[172:173], v[186:187], v[194:195] op_sel:[1,1,0] op_sel_hi:[1,0,1] neg_lo:[0,1,0]
    v_cvt_pk_bf16_f32 v247, v174, v175
    v_pk_mul_f32 v[194:195], v[174:175], v[186:187] op_sel:[0,0] op_sel_hi:[0,1]
    v_pk_fma_f32 v[172:173], v[174:175], v[186:187], v[194:195] op_sel:[1,1,0] op_sel_hi:[1,0,1] neg_lo:[0,1,0]
    v_cvt_pk_bf16_f32 v248, v172, v173
    v_pk_mul_f32 v[194:195], v[172:173], v[186:187] op_sel:[0,0] op_sel_hi:[0,1]
    v_pk_fma_f32 v[174:175], v[172:173], v[186:187], v[194:195] op_sel:[1,1,0] op_sel_hi:[1,0,1] neg_lo:[0,1,0]
    v_mov_b32 v140, 1073741824
    v_lshlrev_b32 v141, 2, v0
    v_cmp_gt_u32 vcc, 64, v0
    s_nop 1
    v_cndmask_b32 v141, v140, v141, vcc
    v_mov_b32_e64 v140, 0
    s_lshl_b32 s97, s2, 8
    s_add_u32 s97, s97, 3473408
    buffer_store_dword v140, v141, s[16:19], s97 offen sc1
    v_cvt_pk_bf16_f32 v249, v174, v175
    v_pk_mul_f32 v[194:195], v[174:175], v[186:187] op_sel:[0,0] op_sel_hi:[0,1]
    v_pk_fma_f32 v[172:173], v[174:175], v[186:187], v[194:195] op_sel:[1,1,0] op_sel_hi:[1,0,1] neg_lo:[0,1,0]
    v_cvt_pk_bf16_f32 v250, v172, v173
    v_pk_mul_f32 v[194:195], v[172:173], v[186:187] op_sel:[0,0] op_sel_hi:[0,1]
    v_pk_fma_f32 v[174:175], v[172:173], v[186:187], v[194:195] op_sel:[1,1,0] op_sel_hi:[1,0,1] neg_lo:[0,1,0]
    v_cvt_pk_bf16_f32 v251, v174, v175
    ds_write_addtid_b32 v242 offset:5440
    ds_write_addtid_b32 v243 offset:5712
    ds_write_addtid_b32 v244 offset:5984
    ds_write_addtid_b32 v245 offset:6256
    ds_write_addtid_b32 v246 offset:6528
    ds_write_addtid_b32 v247 offset:6800
    ds_write_addtid_b32 v248 offset:7072
    ds_write_addtid_b32 v249 offset:7344
    ds_write_addtid_b32 v250 offset:7616
    ds_write_addtid_b32 v251 offset:7888
    v_pk_mul_f32 v[194:195], v[174:175], v[186:187] op_sel:[0,0] op_sel_hi:[0,1]
    v_pk_fma_f32 v[172:173], v[174:175], v[186:187], v[194:195] op_sel:[1,1,0] op_sel_hi:[1,0,1] neg_lo:[0,1,0]
    v_cvt_pk_bf16_f32 v242, v172, v173
    v_pk_mul_f32 v[194:195], v[172:173], v[186:187] op_sel:[0,0] op_sel_hi:[0,1]
    v_pk_fma_f32 v[174:175], v[172:173], v[186:187], v[194:195] op_sel:[1,1,0] op_sel_hi:[1,0,1] neg_lo:[0,1,0]
    v_cvt_pk_bf16_f32 v243, v174, v175
    ds_write_addtid_b32 v242 offset:8160
    ds_write_addtid_b32 v243 offset:8432
    ds_read_b128 a[160:163], v252 offset:0
    ds_read_b128 a[164:167], v252 offset:32
    ds_read_b128 a[168:171], v252 offset:64
    ds_read_b128 a[172:175], v252 offset:96
    ds_read_b128 a[176:179], v252 offset:128
    ds_read_b128 a[180:183], v252 offset:160
    ds_read_b128 a[184:187], v252 offset:192
    ds_read_b128 a[188:191], v252 offset:224
    v_pk_mul_f32 v[194:195], v[180:181], v[180:181] op_sel:[0,0] op_sel_hi:[0,1]
    v_pk_fma_f32 v[182:183], v[180:181], v[180:181], v[194:195] op_sel:[1,1,0] op_sel_hi:[1,0,1] neg_lo:[0,1,0]
    v_pk_mul_f32 v[194:195], v[182:183], v[182:183] op_sel:[0,0] op_sel_hi:[0,1]
    v_pk_fma_f32 v[184:185], v[182:183], v[182:183], v[194:195] op_sel:[1,1,0] op_sel_hi:[1,0,1] neg_lo:[0,1,0]
    v_cvt_pk_bf16_f32 v242, v192, -v193
    v_pk_mul_f32 v[194:195], v[192:193], v[180:181] op_sel:[0,0] op_sel_hi:[0,1]
    v_pk_fma_f32 v[174:175], v[192:193], v[180:181], v[194:195] op_sel:[1,1,0] op_sel_hi:[1,0,1] neg_lo:[0,1,0]
    v_mov_b32 v142, 1073741824
    v_lshlrev_b32 v143, 2, v0
    v_cmp_gt_u32 vcc, 16, v0
    s_nop 1
    v_cndmask_b32 v143, v142, v143, vcc
    v_mov_b32_e64 v142, -1
    s_lshl_b32 s97, s2, 6
    s_add_u32 s97, s97, 3457024
    buffer_store_dword v142, v143, s[16:19], s97 offen sc1
    v_cvt_pk_bf16_f32 v243, v174, -v175
    v_pk_mul_f32 v[194:195], v[174:175], v[180:181] op_sel:[0,0] op_sel_hi:[0,1]
    v_pk_fma_f32 v[172:173], v[174:175], v[180:181], v[194:195] op_sel:[1,1,0] op_sel_hi:[1,0,1] neg_lo:[0,1,0]
    v_cvt_pk_bf16_f32 v244, v172, -v173
    v_pk_mul_f32 v[194:195], v[172:173], v[180:181] op_sel:[0,0] op_sel_hi:[0,1]
    v_pk_fma_f32 v[174:175], v[172:173], v[180:181], v[194:195] op_sel:[1,1,0] op_sel_hi:[1,0,1] neg_lo:[0,1,0]
    v_cvt_pk_bf16_f32 v245, v174, -v175
    v_pk_mul_f32 v[194:195], v[174:175], v[180:181] op_sel:[0,0] op_sel_hi:[0,1]
    v_pk_fma_f32 v[172:173], v[174:175], v[180:181], v[194:195] op_sel:[1,1,0] op_sel_hi:[1,0,1] neg_lo:[0,1,0]
    v_cvt_pk_bf16_f32 v246, v172, -v173
    v_pk_mul_f32 v[194:195], v[172:173], v[180:181] op_sel:[0,0] op_sel_hi:[0,1]
    v_pk_fma_f32 v[174:175], v[172:173], v[180:181], v[194:195] op_sel:[1,1,0] op_sel_hi:[1,0,1] neg_lo:[0,1,0]
    v_cvt_pk_bf16_f32 v247, v174, -v175
    v_pk_mul_f32 v[194:195], v[174:175], v[180:181] op_sel:[0,0] op_sel_hi:[0,1]
    v_pk_fma_f32 v[172:173], v[174:175], v[180:181], v[194:195] op_sel:[1,1,0] op_sel_hi:[1,0,1] neg_lo:[0,1,0]
    v_cvt_pk_bf16_f32 v248, v172, -v173
    v_pk_mul_f32 v[194:195], v[172:173], v[180:181] op_sel:[0,0] op_sel_hi:[0,1]
    v_pk_fma_f32 v[174:175], v[172:173], v[180:181], v[194:195] op_sel:[1,1,0] op_sel_hi:[1,0,1] neg_lo:[0,1,0]
    v_cvt_pk_bf16_f32 v249, v174, -v175
    v_pk_mul_f32 v[194:195], v[192:193], v[190:191] op_sel:[0,0] op_sel_hi:[0,1]
    v_pk_fma_f32 v[176:177], v[192:193], v[190:191], v[194:195] op_sel:[1,1,0] op_sel_hi:[1,0,1] neg_lo:[0,1,0]
    v_cvt_pk_bf16_f32 v250, v176, -v177
    v_pk_mul_f32 v[194:195], v[176:177], v[182:183] op_sel:[0,0] op_sel_hi:[0,1]
    v_pk_fma_f32 v[174:175], v[176:177], v[182:183], v[194:195] op_sel:[1,1,0] op_sel_hi:[1,0,1] neg_lo:[0,1,0]
    v_cvt_pk_bf16_f32 v251, v174, -v175
    ds_write_addtid_b32 v242 offset:0
    ds_write_addtid_b32 v243 offset:272
    ds_write_addtid_b32 v244 offset:544
    ds_write_addtid_b32 v245 offset:816
    ds_write_addtid_b32 v246 offset:1088
    ds_write_addtid_b32 v247 offset:1360
    ds_write_addtid_b32 v248 offset:1632
    ds_write_addtid_b32 v249 offset:1904
    ds_write_addtid_b32 v250 offset:2176
    ds_write_addtid_b32 v251 offset:2448
    v_pk_mul_f32 v[194:195], v[174:175], v[182:183] op_sel:[0,0] op_sel_hi:[0,1]
    v_pk_fma_f32 v[172:173], v[174:175], v[182:183], v[194:195] op_sel:[1,1,0] op_sel_hi:[1,0,1] neg_lo:[0,1,0]
    v_cvt_pk_bf16_f32 v242, v172, -v173
    v_pk_mul_f32 v[194:195], v[172:173], v[182:183] op_sel:[0,0] op_sel_hi:[0,1]
    v_pk_fma_f32 v[174:175], v[172:173], v[182:183], v[194:195] op_sel:[1,1,0] op_sel_hi:[1,0,1] neg_lo:[0,1,0]
    s_waitcnt vmcnt(11)
    s_waitcnt vmcnt(10)
    v_cmp_gt_u32 vcc, 1, v7
    s_nop 0
    s_and_b64 vcc, vcc, s[50:51]
    s_and_b64 vcc, vcc, 1
    s_cbranch_scc1 ps_5
pc_7:
    s_barrier
    v_lshlrev_b32 v2, 3, v4
    v_mov_b32 v5, 1
    v_cndmask_b32 v2, v4, v2, s[50:51]
    buffer_atomic_add v5, v2, s[16:19], s86 offen offset:0 sc1
    v_cvt_pk_bf16_f32 v243, v174, -v175
    v_pk_mul_f32 v[194:195], v[174:175], v[182:183] op_sel:[0,0] op_sel_hi:[0,1]
    v_pk_fma_f32 v[172:173], v[174:175], v[182:183], v[194:195] op_sel:[1,1,0] op_sel_hi:[1,0,1] neg_lo:[0,1,0]
    v_cvt_pk_bf16_f32 v244, v172, -v173
    v_pk_mul_f32 v[194:195], v[176:177], v[190:191] op_sel:[0,0] op_sel_hi:[0,1]
    v_pk_fma_f32 v[178:179], v[176:177], v[190:191], v[194:195] op_sel:[1,1,0] op_sel_hi:[1,0,1] neg_lo:[0,1,0]
    v_cvt_pk_bf16_f32 v245, v178, -v179
    v_pk_mul_f32 v[194:195], v[178:179], v[184:185] op_sel:[0,0] op_sel_hi:[0,1]
    v_pk_fma_f32 v[174:175], v[178:179], v[184:185], v[194:195] op_sel:[1,1,0] op_sel_hi:[1,0,1] neg_lo:[0,1,0]
    v_cvt_pk_bf16_f32 v246, v174, -v175
    v_pk_mul_f32 v[194:195], v[174:175], v[184:185] op_sel:[0,0] op_sel_hi:[0,1]
    v_pk_fma_f32 v[172:173], v[174:175], v[184:185], v[194:195] op_sel:[1,1,0] op_sel_hi:[1,0,1] neg_lo:[0,1,0]
    v_cvt_pk_bf16_f32 v247, v172, -v173
    v_pk_mul_f32 v[194:195], v[178:179], v[190:191] op_sel:[0,0] op_sel_hi:[0,1]
    v_pk_fma_f32 v[176:177], v[178:179], v[190:191], v[194:195] op_sel:[1,1,0] op_sel_hi:[1,0,1] neg_lo:[0,1,0]
    v_cvt_pk_bf16_f32 v248, v176, -v177
    v_pk_mul_f32 v[194:195], v[176:177], v[184:185] op_sel:[0,0] op_sel_hi:[0,1]
    v_pk_fma_f32 v[174:175], v[176:177], v[184:185], v[194:195] op_sel:[1,1,0] op_sel_hi:[1,0,1] neg_lo:[0,1,0]
    v_cvt_pk_bf16_f32 v249, v174, -v175
    v_pk_mul_f32 v[194:195], v[174:175], v[184:185] op_sel:[0,0] op_sel_hi:[0,1]
    v_pk_fma_f32 v[172:173], v[174:175], v[184:185], v[194:195] op_sel:[1,1,0] op_sel_hi:[1,0,1] neg_lo:[0,1,0]
    v_cvt_pk_bf16_f32 v250, v172, -v173
    v_pk_mul_f32 v[194:195], v[176:177], v[190:191] op_sel:[0,0] op_sel_hi:[0,1]
    v_pk_fma_f32 v[178:179], v[176:177], v[190:191], v[194:195] op_sel:[1,1,0] op_sel_hi:[1,0,1] neg_lo:[0,1,0]
    v_cvt_pk_bf16_f32 v251, v178, -v179
    ds_write_addtid_b32 v242 offset:2720
    ds_write_addtid_b32 v242 offset:3264
    ds_write_addtid_b32 v243 offset:3536
    ds_write_addtid_b32 v244 offset:3808
    ds_write_addtid_b32 v245 offset:4352
    ds_write_addtid_b32 v246 offset:4624
    ds_write_addtid_b32 v247 offset:4896
    ds_write_addtid_b32 v248 offset:5440
    ds_write_addtid_b32 v249 offset:5712
    ds_write_addtid_b32 v250 offset:5984
    v_mov_b32 v144, -1
    v_mov_b32 v145, -1
    v_mov_b32 v146, -1
    v_mov_b32 v147, -1
    v_lshlrev_b32 v148, 4, v0
    s_sub_u32 s88, s2, 0
    s_mul_i32 s88, s88, 20480
    s_min_u32 s88, s88, 5222400
    s_add_u32 s88, s88, 4194304
    buffer_store_dwordx4 v[144:147], v148, s[16:19], s88 offen sc1
    ds_write_addtid_b32 v251 offset:6528
    v_pk_mul_f32 v[194:195], v[178:179], v[186:187] op_sel:[0,0] op_sel_hi:[0,1]
    v_pk_fma_f32 v[174:175], v[178:179], v[186:187], v[194:195] op_sel:[1,1,0] op_sel_hi:[1,0,1] neg_lo:[0,1,0]
    v_cvt_pk_bf16_f32 v242, v174, -v175
    v_pk_mul_f32 v[194:195], v[178:179], v[190:191] op_sel:[0,0] op_sel_hi:[0,1]
    v_pk_fma_f32 v[176:177], v[178:179], v[190:191], v[194:195] op_sel:[1,1,0] op_sel_hi:[1,0,1] neg_lo:[0,1,0]
    v_cvt_pk_bf16_f32 v243, v176, -v177
    v_pk_mul_f32 v[194:195], v[176:177], v[186:187] op_sel:[0,0] op_sel_hi:[0,1]
    v_pk_fma_f32 v[174:175], v[176:177], v[186:187], v[194:195] op_sel:[1,1,0] op_sel_hi:[1,0,1] neg_lo:[0,1,0]
    v_cvt_pk_bf16_f32 v244, v174, -v175
    v_pk_mul_f32 v[194:195], v[176:177], v[190:191] op_sel:[0,0] op_sel_hi:[0,1]
    v_pk_fma_f32 v[178:179], v[176:177], v[190:191], v[194:195] op_sel:[1,1,0] op_sel_hi:[1,0,1] neg_lo:[0,1,0]
    v_cvt_pk_bf16_f32 v245, v178, -v179
    v_pk_mul_f32 v[194:195], v[178:179], v[186:187] op_sel:[0,0] op_sel_hi:[0,1]
    v_pk_fma_f32 v[174:175], v[178:179], v[186:187], v[194:195] op_sel:[1,1,0] op_sel_hi:[1,0,1] neg_lo:[0,1,0]
    v_cvt_pk_bf16_f32 v246, v174, -v175
    v_pk_mul_f32 v[194:195], v[178:179], v[190:191] op_sel:[0,0] op_sel_hi:[0,1]
    v_pk_fma_f32 v[176:177], v[178:179], v[190:191], v[194:195] op_sel:[1,1,0] op_sel_hi:[1,0,1] neg_lo:[0,1,0]
    v_cvt_pk_bf16_f32 v247, v176, -v177
    v_pk_mul_f32 v[194:195], v[176:177], v[186:187] op_sel:[0,0] op_sel_hi:[0,1]
    v_pk_fma_f32 v[174:175], v[176:177], v[186:187], v[194:195] op_sel:[1,1,0] op_sel_hi:[1,0,1] neg_lo:[0,1,0]
    v_cvt_pk_bf16_f32 v248, v174, -v175
    ds_write_addtid_b32 v242 offset:6800
    ds_write_addtid_b32 v243 offset:7072
    ds_write_addtid_b32 v244 offset:7344
    ds_write_addtid_b32 v245 offset:7616
    ds_write_addtid_b32 v246 offset:7888
    ds_write_addtid_b32 v247 offset:8160
    ds_write_addtid_b32 v248 offset:8432
    ds_read_b128 a[192:195], v252 offset:0
    ds_read_b128 a[196:199], v252 offset:32
    ds_read_b128 a[200:203], v252 offset:64
    ds_read_b128 a[204:207], v252 offset:96
    ds_read_b128 a[208:211], v252 offset:128
    ds_read_b128 a[212:215], v252 offset:160
    s_add_u32 s88, s88, 4096
    buffer_store_dwordx4 v[144:147], v148, s[16:19], s88 offen sc1
    ds_read_b128 a[216:219], v252 offset:192
    ds_read_b128 a[220:223], v252 offset:224
    v_and_b32 v199, 0xffff0000, v232
    v_mul_f32 v199, 0x3fb8aa3b, v199
    v_exp_f32 v199, v199
    v_and_b32 v255, 0xffff0000, v233
    v_mul_f32 v255, v255, v253
    v_mul_f32 v255, 0x3e22f983, v255
    v_cvt_pk_bf16_f32 v199, v199, v199
    v_lshlrev_b32 v199, 16, v199
    v_mul_f32 v254, v199, v253
    v_mul_f32 v254, 0xbfb8aa3b, v254
    s_waitcnt lgkmcnt(7)
    v_mfma_f32_32x32x16_bf16 v[216:231], a[192:195], a[160:163], 0
    v_mul_f32 v182, 0x41000000, v254
    v_mul_f32 v185, 0x41000000, v255
    v_mul_f32 v184, 0x43800000, v254
    v_mul_f32 v189, 0x43800000, v255
    s_waitcnt lgkmcnt(6)
    v_mfma_f32_32x32x16_bf16 v[216:231], a[196:199], a[164:167], v[216:231]
    v_fract_f32 v185, v185
    v_fract_f32 v188, v255
    v_fract_f32 v189, v189
    v_exp_f32 v182, v182
    s_waitcnt lgkmcnt(5)
    v_mfma_f32_32x32x16_bf16 v[216:231], a[200:203], a[168:171], v[216:231]
    v_exp_f32 v183, v254
    v_exp_f32 v184, v184
    v_cos_f32 v186, v185
    v_sin_f32 v187, v185
    s_waitcnt lgkmcnt(4)
    v_mfma_f32_32x32x16_bf16 v[216:231], a[204:207], a[172:175], v[216:231]
    v_cos_f32 v180, v188
    v_sin_f32 v181, v188
    v_cos_f32 v190, v189
    v_sin_f32 v191, v189
    s_waitcnt lgkmcnt(3)
    v_mfma_f32_32x32x16_bf16 v[216:231], a[208:211], a[176:179], v[216:231]
    v_and_b32 v192, 0xffff0000, v234
    v_and_b32 v193, 0xffff0000, v235
    s_add_u32 s88, s88, 4096
    buffer_store_dwordx4 v[144:147], v148, s[16:19], s88 offen sc1
    v_add_f32 v199, v253, v253
    v_mul_f32 v192, v192, v199
    s_waitcnt lgkmcnt(2)
    v_mfma_f32_32x32x16_bf16 v[216:231], a[212:215], a[180:183], v[216:231]
    v_mul_f32 v193, v193, v199
    v_mul_f32 v186, v186, v182
    v_mul_f32 v187, v187, v182
    v_mul_f32 v180, v180, v183
    s_waitcnt lgkmcnt(1)
    v_mfma_f32_32x32x16_bf16 v[216:231], a[216:219], a[184:187], v[216:231]
    v_mul_f32 v181, v181, v183
    v_mul_f32 v190, v190, v184
    v_mul_f32 v191, v191, v184
    s_waitcnt lgkmcnt(0)
    v_mfma_f32_32x32x16_bf16 v[216:231], a[220:223], a[188:191], v[216:231]
    v_mov_b32 v242, 0x3f80
    v_cvt_pk_bf16_f32 v243, v186, v187
    v_pk_mul_f32 v[194:195], v[186:187], v[186:187] op_sel:[0,0] op_sel_hi:[0,1]
    v_pk_fma_f32 v[172:173], v[186:187], v[186:187], v[194:195] op_sel:[1,1,0] op_sel_hi:[1,0,1] neg_lo:[0,1,0]
    v_cvt_pk_bf16_f32 v244, v172, v173
    v_pk_mul_f32 v[194:195], v[172:173], v[186:187] op_sel:[0,0] op_sel_hi:[0,1]
    v_pk_fma_f32 v[174:175], v[172:173], v[186:187], v[194:195] op_sel:[1,1,0] op_sel_hi:[1,0,1] neg_lo:[0,1,0]
    v_cvt_pk_bf16_f32 v245, v174, v175
    v_pk_mul_f32 v[194:195], v[174:175], v[186:187] op_sel:[0,0] op_sel_hi:[0,1]
    v_pk_fma_f32 v[172:173], v[174:175], v[186:187], v[194:195] op_sel:[1,1,0] op_sel_hi:[1,0,1] neg_lo:[0,1,0]
    v_cvt_pk_bf16_f32 v246, v172, v173
    v_pk_mul_f32 v[194:195], v[172:173], v[186:187] op_sel:[0,0] op_sel_hi:[0,1]
    v_pk_fma_f32 v[174:175], v[172:173], v[186:187], v[194:195] op_sel:[1,1,0] op_sel_hi:[1,0,1] neg_lo:[0,1,0]
    v_cvt_pk_bf16_f32 v247, v174, v175
    v_pk_mul_f32 v[194:195], v[174:175], v[186:187] op_sel:[0,0] op_sel_hi:[0,1]
    v_pk_fma_f32 v[172:173], v[174:175], v[186:187], v[194:195] op_sel:[1,1,0] op_sel_hi:[1,0,1] neg_lo:[0,1,0]
    v_cvt_pk_bf16_f32 v248, v172, v173
    v_pk_mul_f32 v[194:195], v[172:173], v[186:187] op_sel:[0,0] op_sel_hi:[0,1]
    v_pk_fma_f32 v[174:175], v[172:173], v[186:187], v[194:195] op_sel:[1,1,0] op_sel_hi:[1,0,1] neg_lo:[0,1,0]
    v_cvt_pk_bf16_f32 v249, v174, v175
    v_pk_mul_f32 v[194:195], v[174:175], v[186:187] op_sel:[0,0] op_sel_hi:[0,1]
    v_pk_fma_f32 v[172:173], v[174:175], v[186:187], v[194:195] op_sel:[1,1,0] op_sel_hi:[1,0,1] neg_lo:[0,1,0]
    v_cvt_pk_bf16_f32 v250, v172, v173
    s_add_u32 s88, s88, 4096
    buffer_store_dwordx4 v[144:147], v148, s[16:19], s88 offen sc1
    v_pk_mul_f32 v[194:195], v[172:173], v[186:187] op_sel:[0,0] op_sel_hi:[0,1]
    v_pk_fma_f32 v[174:175], v[172:173], v[186:187], v[194:195] op_sel:[1,1,0] op_sel_hi:[1,0,1] neg_lo:[0,1,0]
    v_cvt_pk_bf16_f32 v251, v174, v175
    ds_write_addtid_b32 v242 offset:0
    ds_write_addtid_b32 v243 offset:272
    ds_write_addtid_b32 v244 offset:544
    ds_write_addtid_b32 v245 offset:816
    ds_write_addtid_b32 v246 offset:1088
    ds_write_addtid_b32 v247 offset:1360
    ds_write_addtid_b32 v248 offset:1632
    ds_write_addtid_b32 v249 offset:1904
    ds_write_addtid_b32 v250 offset:2176
    ds_write_addtid_b32 v251 offset:2448
    v_pk_mul_f32 v[194:195], v[174:175], v[186:187] op_sel:[0,0] op_sel_hi:[0,1]
    v_pk_fma_f32 v[172:173], v[174:175], v[186:187], v[194:195] op_sel:[1,1,0] op_sel_hi:[1,0,1] neg_lo:[0,1,0]
    v_cvt_pk_bf16_f32 v242, v172, v173
    v_pk_mul_f32 v[194:195], v[172:173], v[186:187] op_sel:[0,0] op_sel_hi:[0,1]
    v_pk_fma_f32 v[174:175], v[172:173], v[186:187], v[194:195] op_sel:[1,1,0] op_sel_hi:[1,0,1] neg_lo:[0,1,0]
    v_cvt_pk_bf16_f32 v243, v174, v175
    v_pk_mul_f32 v[194:195], v[174:175], v[186:187] op_sel:[0,0] op_sel_hi:[0,1]
    v_pk_fma_f32 v[172:173], v[174:175], v[186:187], v[194:195] op_sel:[1,1,0] op_sel_hi:[1,0,1] neg_lo:[0,1,0]
    v_cvt_pk_bf16_f32 v244, v172, v173
    v_pk_mul_f32 v[194:195], v[172:173], v[186:187] op_sel:[0,0] op_sel_hi:[0,1]
    v_pk_fma_f32 v[174:175], v[172:173], v[186:187], v[194:195] op_sel:[1,1,0] op_sel_hi:[1,0,1] neg_lo:[0,1,0]
    v_cvt_pk_bf16_f32 v245, v174, v175
    v_pk_mul_f32 v[194:195], v[174:175], v[186:187] op_sel:[0,0] op_sel_hi:[0,1]
    v_pk_fma_f32 v[172:173], v[174:175], v[186:187], v[194:195] op_sel:[1,1,0] op_sel_hi:[1,0,1] neg_lo:[0,1,0]
    v_cvt_pk_bf16_f32 v246, v172, v173
    v_pk_mul_f32 v[194:195], v[172:173], v[186:187] op_sel:[0,0] op_sel_hi:[0,1]
    v_pk_fma_f32 v[174:175], v[172:173], v[186:187], v[194:195] op_sel:[1,1,0] op_sel_hi:[1,0,1] neg_lo:[0,1,0]
    v_cvt_pk_bf16_f32 v247, v174, v175
    v_pk_mul_f32 v[194:195], v[174:175], v[186:187] op_sel:[0,0] op_sel_hi:[0,1]
    v_pk_fma_f32 v[172:173], v[174:175], v[186:187], v[194:195] op_sel:[1,1,0] op_sel_hi:[1,0,1] neg_lo:[0,1,0]
    v_cvt_pk_bf16_f32 v248, v172, v173
    v_pk_mul_f32 v[194:195], v[172:173], v[186:187] op_sel:[0,0] op_sel_hi:[0,1]
    s_add_u32 s88, s88, 4096
    buffer_store_dwordx4 v[144:147], v148, s[16:19], s88 offen sc1
    v_pk_fma_f32 v[174:175], v[172:173], v[186:187], v[194:195] op_sel:[1,1,0] op_sel_hi:[1,0,1] neg_lo:[0,1,0]
    v_cvt_pk_bf16_f32 v249, v174, v175
    v_pk_mul_f32 v[194:195], v[174:175], v[186:187] op_sel:[0,0] op_sel_hi:[0,1]
    v_pk_fma_f32 v[172:173], v[174:175], v[186:187], v[194:195] op_sel:[1,1,0] op_sel_hi:[1,0,1] neg_lo:[0,1,0]
    v_cvt_pk_bf16_f32 v250, v172, v173
    v_pk_mul_f32 v[194:195], v[172:173], v[186:187] op_sel:[0,0] op_sel_hi:[0,1]
    v_pk_fma_f32 v[174:175], v[172:173], v[186:187], v[194:195] op_sel:[1,1,0] op_sel_hi:[1,0,1] neg_lo:[0,1,0]
    v_cvt_pk_bf16_f32 v251, v174, v175
    ds_write_addtid_b32 v242 offset:2720
    ds_write_addtid_b32 v243 offset:2992
    ds_write_addtid_b32 v244 offset:3264
    ds_write_addtid_b32 v245 offset:3536
    ds_write_addtid_b32 v246 offset:3808
    ds_write_addtid_b32 v247 offset:4080
    ds_write_addtid_b32 v248 offset:4352
    ds_write_addtid_b32 v249 offset:4624
    ds_write_addtid_b32 v250 offset:4896
    ds_write_addtid_b32 v251 offset:5168
    v_pk_mul_f32 v[194:195], v[174:175], v[186:187] op_sel:[0,0] op_sel_hi:[0,1]
    v_pk_fma_f32 v[172:173], v[174:175], v[186:187], v[194:195] op_sel:[1,1,0] op_sel_hi:[1,0,1] neg_lo:[0,1,0]
    v_cvt_pk_bf16_f32 v242, v172, v173
    v_pk_mul_f32 v[194:195], v[172:173], v[186:187] op_sel:[0,0] op_sel_hi:[0,1]
    v_pk_fma_f32 v[174:175], v[172:173], v[186:187], v[194:195] op_sel:[1,1,0] op_sel_hi:[1,0,1] neg_lo:[0,1,0]
    v_cvt_pk_bf16_f32 v243, v174, v175
    v_pk_mul_f32 v[194:195], v[174:175], v[186:187] op_sel:[0,0] op_sel_hi:[0,1]
    v_pk_fma_f32 v[172:173], v[174:175], v[186:187], v[194:195] op_sel:[1,1,0] op_sel_hi:[1,0,1] neg_lo:[0,1,0]
    v_cvt_pk_bf16_f32 v244, v172, v173
    v_pk_mul_f32 v[194:195], v[172:173], v[186:187] op_sel:[0,0] op_sel_hi:[0,1]
    v_pk_fma_f32 v[174:175], v[172:173], v[186:187], v[194:195] op_sel:[1,1,0] op_sel_hi:[1,0,1] neg_lo:[0,1,0]
    v_cvt_pk_bf16_f32 v245, v174, v175
    v_pk_mul_f32 v[194:195], v[174:175], v[186:187] op_sel:[0,0] op_sel_hi:[0,1]
    v_pk_fma_f32 v[172:173], v[174:175], v[186:187], v[194:195] op_sel:[1,1,0] op_sel_hi:[1,0,1] neg_lo:[0,1,0]
    v_cvt_pk_bf16_f32 v246, v172, v173
    v_pk_mul_f32 v[194:195], v[172:173], v[186:187] op_sel:[0,0] op_sel_hi:[0,1]
    v_pk_fma_f32 v[174:175], v[172:173], v[186:187], v[194:195] op_sel:[1,1,0] op_sel_hi:[1,0,1] neg_lo:[0,1,0]
    v_mov_b32 v134, 0x3f803f80
    v_mov_b32 v132, 0
    v_mov_b32 v133, 0
    s_waitcnt vmcnt(10)
    v_dot2c_f32_bf16 v132, v120, v134
    v_dot2c_f32_bf16 v133, v120, v120
    v_dot2c_f32_bf16 v132, v121, v134
    v_dot2c_f32_bf16 v133, v121, v121
    v_dot2c_f32_bf16 v132, v122, v134
    v_dot2c_f32_bf16 v133, v122, v122
    v_dot2c_f32_bf16 v132, v123, v134
    v_dot2c_f32_bf16 v133, v123, v123
    s_waitcnt vmcnt(9)
    v_dot2c_f32_bf16 v132, v124, v134
    v_dot2c_f32_bf16 v133, v124, v124
    v_dot2c_f32_bf16 v132, v125, v134
    v_dot2c_f32_bf16 v133, v125, v125
    v_dot2c_f32_bf16 v132, v126, v134
    v_dot2c_f32_bf16 v133, v126, v126
    v_dot2c_f32_bf16 v132, v127, v134
    v_dot2c_f32_bf16 v133, v127, v127
    s_waitcnt vmcnt(8)
    v_dot2c_f32_bf16 v132, v128, v134
    v_dot2c_f32_bf16 v133, v128, v128
    v_dot2c_f32_bf16 v132, v129, v134
    v_dot2c_f32_bf16 v133, v129, v129
    v_dot2c_f32_bf16 v132, v130, v134
    v_dot2c_f32_bf16 v133, v130, v130
    v_dot2c_f32_bf16 v132, v131, v134
    v_dot2c_f32_bf16 v133, v131, v131
    v_lshrrev_b32 v135, 5, v0
    v_and_b32 v121, 3, v135
    v_lshrrev_b32 v135, 2, v135
    v_add_f32_dpp v132, v132, v132 row_shr:1 row_mask:0xf bank_mask:0xf bound_ctrl:0
    v_add_f32_dpp v133, v133, v133 row_shr:1 row_mask:0xf bank_mask:0xf bound_ctrl:0
    v_lshlrev_b32_e64 v135, 3, v135
    v_add_f32_dpp v132, v132, v132 row_shr:2 row_mask:0xf bank_mask:0xf bound_ctrl:0
    v_add_f32_dpp v133, v133, v133 row_shr:2 row_mask:0xf bank_mask:0xf bound_ctrl:0
    v_lshl_add_u32 v135, v121, 12, v135
    v_add_f32_dpp v132, v132, v132 row_shr:4 row_mask:0xf bank_mask:0xf bound_ctrl:0
    v_add_f32_dpp v133, v133, v133 row_shr:4 row_mask:0xf bank_mask:0xf bound_ctrl:0
    v_and_b32_e64 v121, 31, v0
    v_add_f32_dpp v132, v132, v132 row_shr:8 row_mask:0xf bank_mask:0xf bound_ctrl:0
    v_add_f32_dpp v133, v133, v133 row_shr:8 row_mask:0xf bank_mask:0xf bound_ctrl:0
    v_cmp_eq_u32_e64 vcc, 31, v121
    v_add_f32_dpp v132, v132, v132 row_bcast:15 row_mask:0xa bank_mask:0xf
    v_add_f32_dpp v133, v133, v133 row_bcast:15 row_mask:0xa bank_mask:0xf
    v_mov_b32 v121, 1073741824
    v_cndmask_b32_e64 v120, v121, v135, vcc
    s_lshl_b32 s96, s2, 4
    s_add_u32 s96, s96, 3440640
    v_mul_f32 v135, 0x3acccccd, v132
    v_mul_f32 v133, 0x3acccccd, v133
    v_fma_f32 v133, -v135, v135, v133
    v_max_f32 v133, 0, v133
    v_add_f32 v133, 0x3727c5ac, v133
    v_rsq_f32_e64 v132, v133
    s_nop 0
    v_mul_f32 v133, -v135, v132
    buffer_store_dwordx2 v[132:133], v120, s[16:19], s96 offen sc1
    v_cvt_pk_bf16_f32 v247, v174, v175
    v_pk_mul_f32 v[194:195], v[174:175], v[186:187] op_sel:[0,0] op_sel_hi:[0,1]
    v_pk_fma_f32 v[172:173], v[174:175], v[186:187], v[194:195] op_sel:[1,1,0] op_sel_hi:[1,0,1] neg_lo:[0,1,0]
    v_cvt_pk_bf16_f32 v248, v172, v173
    v_pk_mul_f32 v[194:195], v[172:173], v[186:187] op_sel:[0,0] op_sel_hi:[0,1]
    v_pk_fma_f32 v[174:175], v[172:173], v[186:187], v[194:195] op_sel:[1,1,0] op_sel_hi:[1,0,1] neg_lo:[0,1,0]
    v_cvt_pk_bf16_f32 v249, v174, v175
    v_pk_mul_f32 v[194:195], v[174:175], v[186:187] op_sel:[0,0] op_sel_hi:[0,1]
    v_pk_fma_f32 v[172:173], v[174:175], v[186:187], v[194:195] op_sel:[1,1,0] op_sel_hi:[1,0,1] neg_lo:[0,1,0]
    v_cvt_pk_bf16_f32 v250, v172, v173
    v_pk_mul_f32 v[194:195], v[172:173], v[186:187] op_sel:[0,0] op_sel_hi:[0,1]
    v_pk_fma_f32 v[174:175], v[172:173], v[186:187], v[194:195] op_sel:[1,1,0] op_sel_hi:[1,0,1] neg_lo:[0,1,0]
    v_cvt_pk_bf16_f32 v251, v174, v175
    ds_write_addtid_b32 v242 offset:5440
    ds_write_addtid_b32 v243 offset:5712
    ds_write_addtid_b32 v244 offset:5984
    ds_write_addtid_b32 v245 offset:6256
    ds_write_addtid_b32 v246 offset:6528
    ds_write_addtid_b32 v247 offset:6800
    ds_write_addtid_b32 v248 offset:7072
    ds_write_addtid_b32 v249 offset:7344
    ds_write_addtid_b32 v250 offset:7616
    ds_write_addtid_b32 v251 offset:7888
    v_pk_mul_f32 v[194:195], v[174:175], v[186:187] op_sel:[0,0] op_sel_hi:[0,1]
    v_pk_fma_f32 v[172:173], v[174:175], v[186:187], v[194:195] op_sel:[1,1,0] op_sel_hi:[1,0,1] neg_lo:[0,1,0]
    v_cvt_pk_bf16_f32 v242, v172, v173
    v_pk_mul_f32 v[194:195], v[172:173], v[186:187] op_sel:[0,0] op_sel_hi:[0,1]
    v_pk_fma_f32 v[174:175], v[172:173], v[186:187], v[194:195] op_sel:[1,1,0] op_sel_hi:[1,0,1] neg_lo:[0,1,0]
    v_cvt_pk_bf16_f32 v243, v174, v175
    ds_write_addtid_b32 v242 offset:8160
    ds_write_addtid_b32 v243 offset:8432
    ds_read_b128 a[160:163], v252 offset:0
    ds_read_b128 a[164:167], v252 offset:32
    ds_read_b128 a[168:171], v252 offset:64
    ds_read_b128 a[172:175], v252 offset:96
    ds_read_b128 a[176:179], v252 offset:128
    ds_read_b128 a[180:183], v252 offset:160
    ds_read_b128 a[184:187], v252 offset:192
    ds_read_b128 a[188:191], v252 offset:224
    v_pk_mul_f32 v[194:195], v[180:181], v[180:181] op_sel:[0,0] op_sel_hi:[0,1]
    v_pk_fma_f32 v[182:183], v[180:181], v[180:181], v[194:195] op_sel:[1,1,0] op_sel_hi:[1,0,1] neg_lo:[0,1,0]
    v_pk_mul_f32 v[194:195], v[182:183], v[182:183] op_sel:[0,0] op_sel_hi:[0,1]
    v_pk_fma_f32 v[184:185], v[182:183], v[182:183], v[194:195] op_sel:[1,1,0] op_sel_hi:[1,0,1] neg_lo:[0,1,0]
    v_cvt_pk_bf16_f32 v242, v192, -v193
    v_pk_mul_f32 v[194:195], v[192:193], v[180:181] op_sel:[0,0] op_sel_hi:[0,1]
    v_pk_fma_f32 v[174:175], v[192:193], v[180:181], v[194:195] op_sel:[1,1,0] op_sel_hi:[1,0,1] neg_lo:[0,1,0]
    v_cvt_pk_bf16_f32 v243, v174, -v175
    v_pk_mul_f32 v[194:195], v[174:175], v[180:181] op_sel:[0,0] op_sel_hi:[0,1]
    v_pk_fma_f32 v[172:173], v[174:175], v[180:181], v[194:195] op_sel:[1,1,0] op_sel_hi:[1,0,1] neg_lo:[0,1,0]
    v_cvt_pk_bf16_f32 v244, v172, -v173
    v_pk_mul_f32 v[194:195], v[172:173], v[180:181] op_sel:[0,0] op_sel_hi:[0,1]
    v_pk_fma_f32 v[174:175], v[172:173], v[180:181], v[194:195] op_sel:[1,1,0] op_sel_hi:[1,0,1] neg_lo:[0,1,0]
    v_cvt_pk_bf16_f32 v245, v174, -v175
    v_pk_mul_f32 v[194:195], v[174:175], v[180:181] op_sel:[0,0] op_sel_hi:[0,1]
    v_pk_fma_f32 v[172:173], v[174:175], v[180:181], v[194:195] op_sel:[1,1,0] op_sel_hi:[1,0,1] neg_lo:[0,1,0]
    v_cvt_pk_bf16_f32 v246, v172, -v173
    v_pk_mul_f32 v[194:195], v[172:173], v[180:181] op_sel:[0,0] op_sel_hi:[0,1]
    v_pk_fma_f32 v[174:175], v[172:173], v[180:181], v[194:195] op_sel:[1,1,0] op_sel_hi:[1,0,1] neg_lo:[0,1,0]
    v_cvt_pk_bf16_f32 v247, v174, -v175
    v_pk_mul_f32 v[194:195], v[174:175], v[180:181] op_sel:[0,0] op_sel_hi:[0,1]
    buffer_load_dword v7, v4, s[16:19], s87 offen offset:0 sc1
    v_pk_fma_f32 v[172:173], v[174:175], v[180:181], v[194:195] op_sel:[1,1,0] op_sel_hi:[1,0,1] neg_lo:[0,1,0]
    v_cvt_pk_bf16_f32 v248, v172, -v173
    v_pk_mul_f32 v[194:195], v[172:173], v[180:181] op_sel:[0,0] op_sel_hi:[0,1]
    v_pk_fma_f32 v[174:175], v[172:173], v[180:181], v[194:195] op_sel:[1,1,0] op_sel_hi:[1,0,1] neg_lo:[0,1,0]
    v_cvt_pk_bf16_f32 v249, v174, -v175
    v_pk_mul_f32 v[194:195], v[192:193], v[190:191] op_sel:[0,0] op_sel_hi:[0,1]
    v_pk_fma_f32 v[176:177], v[192:193], v[190:191], v[194:195] op_sel:[1,1,0] op_sel_hi:[1,0,1] neg_lo:[0,1,0]
    v_cvt_pk_bf16_f32 v250, v176, -v177
    v_pk_mul_f32 v[194:195], v[176:177], v[182:183] op_sel:[0,0] op_sel_hi:[0,1]
    v_pk_fma_f32 v[174:175], v[176:177], v[182:183], v[194:195] op_sel:[1,1,0] op_sel_hi:[1,0,1] neg_lo:[0,1,0]
    v_cvt_pk_bf16_f32 v251, v174, -v175
    ds_write_addtid_b32 v242 offset:0
    ds_write_addtid_b32 v243 offset:272
    ds_write_addtid_b32 v244 offset:544
    ds_write_addtid_b32 v245 offset:816
    ds_write_addtid_b32 v246 offset:1088
    ds_write_addtid_b32 v247 offset:1360
    ds_write_addtid_b32 v248 offset:1632
    ds_write_addtid_b32 v249 offset:1904
    ds_write_addtid_b32 v250 offset:2176
    ds_write_addtid_b32 v251 offset:2448
    v_pk_mul_f32 v[194:195], v[174:175], v[182:183] op_sel:[0,0] op_sel_hi:[0,1]
    v_pk_fma_f32 v[172:173], v[174:175], v[182:183], v[194:195] op_sel:[1,1,0] op_sel_hi:[1,0,1] neg_lo:[0,1,0]
    v_cvt_pk_bf16_f32 v242, v172, -v173
    v_pk_mul_f32 v[194:195], v[172:173], v[182:183] op_sel:[0,0] op_sel_hi:[0,1]
    v_pk_fma_f32 v[174:175], v[172:173], v[182:183], v[194:195] op_sel:[1,1,0] op_sel_hi:[1,0,1] neg_lo:[0,1,0]
    v_cvt_pk_bf16_f32 v243, v174, -v175
    v_pk_mul_f32 v[194:195], v[174:175], v[182:183] op_sel:[0,0] op_sel_hi:[0,1]
    v_pk_fma_f32 v[172:173], v[174:175], v[182:183], v[194:195] op_sel:[1,1,0] op_sel_hi:[1,0,1] neg_lo:[0,1,0]
    v_cvt_pk_bf16_f32 v244, v172, -v173
    v_pk_mul_f32 v[194:195], v[176:177], v[190:191] op_sel:[0,0] op_sel_hi:[0,1]
    v_pk_fma_f32 v[178:179], v[176:177], v[190:191], v[194:195] op_sel:[1,1,0] op_sel_hi:[1,0,1] neg_lo:[0,1,0]
    v_cvt_pk_bf16_f32 v245, v178, -v179
    v_pk_mul_f32 v[194:195], v[178:179], v[184:185] op_sel:[0,0] op_sel_hi:[0,1]
    v_pk_fma_f32 v[174:175], v[178:179], v[184:185], v[194:195] op_sel:[1,1,0] op_sel_hi:[1,0,1] neg_lo:[0,1,0]
    v_cvt_pk_bf16_f32 v246, v174, -v175
    v_pk_mul_f32 v[194:195], v[174:175], v[184:185] op_sel:[0,0] op_sel_hi:[0,1]
    v_pk_fma_f32 v[172:173], v[174:175], v[184:185], v[194:195] op_sel:[1,1,0] op_sel_hi:[1,0,1] neg_lo:[0,1,0]
    v_cvt_pk_bf16_f32 v247, v172, -v173
    v_pk_mul_f32 v[194:195], v[178:179], v[190:191] op_sel:[0,0] op_sel_hi:[0,1]
    v_pk_fma_f32 v[176:177], v[178:179], v[190:191], v[194:195] op_sel:[1,1,0] op_sel_hi:[1,0,1] neg_lo:[0,1,0]
    v_cvt_pk_bf16_f32 v248, v176, -v177
    v_pk_mul_f32 v[194:195], v[176:177], v[184:185] op_sel:[0,0] op_sel_hi:[0,1]
    v_pk_fma_f32 v[174:175], v[176:177], v[184:185], v[194:195] op_sel:[1,1,0] op_sel_hi:[1,0,1] neg_lo:[0,1,0]
    v_cvt_pk_bf16_f32 v249, v174, -v175
    v_pk_mul_f32 v[194:195], v[174:175], v[184:185] op_sel:[0,0] op_sel_hi:[0,1]
    v_pk_fma_f32 v[172:173], v[174:175], v[184:185], v[194:195] op_sel:[1,1,0] op_sel_hi:[1,0,1] neg_lo:[0,1,0]
    v_cvt_pk_bf16_f32 v250, v172, -v173
    v_pk_mul_f32 v[194:195], v[176:177], v[190:191] op_sel:[0,0] op_sel_hi:[0,1]
    v_pk_fma_f32 v[178:179], v[176:177], v[190:191], v[194:195] op_sel:[1,1,0] op_sel_hi:[1,0,1] neg_lo:[0,1,0]
    v_cvt_pk_bf16_f32 v251, v178, -v179
    ds_write_addtid_b32 v242 offset:2720
    ds_write_addtid_b32 v242 offset:3264
    ds_write_addtid_b32 v243 offset:3536
    ds_write_addtid_b32 v244 offset:3808
    ds_write_addtid_b32 v245 offset:4352
    ds_write_addtid_b32 v246 offset:4624
    ds_write_addtid_b32 v247 offset:4896
    ds_write_addtid_b32 v248 offset:5440
    ds_write_addtid_b32 v249 offset:5712
    ds_write_addtid_b32 v250 offset:5984
    ds_write_addtid_b32 v251 offset:6528
    v_pk_mul_f32 v[194:195], v[178:179], v[186:187] op_sel:[0,0] op_sel_hi:[0,1]
    v_pk_fma_f32 v[174:175], v[178:179], v[186:187], v[194:195] op_sel:[1,1,0] op_sel_hi:[1,0,1] neg_lo:[0,1,0]
    v_cvt_pk_bf16_f32 v242, v174, -v175
    v_pk_mul_f32 v[194:195], v[178:179], v[190:191] op_sel:[0,0] op_sel_hi:[0,1]
    v_pk_fma_f32 v[176:177], v[178:179], v[190:191], v[194:195] op_sel:[1,1,0] op_sel_hi:[1,0,1] neg_lo:[0,1,0]
    v_cvt_pk_bf16_f32 v243, v176, -v177
    v_pk_mul_f32 v[194:195], v[176:177], v[186:187] op_sel:[0,0] op_sel_hi:[0,1]
    v_pk_fma_f32 v[174:175], v[176:177], v[186:187], v[194:195] op_sel:[1,1,0] op_sel_hi:[1,0,1] neg_lo:[0,1,0]
    v_cvt_pk_bf16_f32 v244, v174, -v175
    v_pk_mul_f32 v[194:195], v[176:177], v[190:191] op_sel:[0,0] op_sel_hi:[0,1]
    v_pk_fma_f32 v[178:179], v[176:177], v[190:191], v[194:195] op_sel:[1,1,0] op_sel_hi:[1,0,1] neg_lo:[0,1,0]
    v_cvt_pk_bf16_f32 v245, v178, -v179
    v_pk_mul_f32 v[194:195], v[178:179], v[186:187] op_sel:[0,0] op_sel_hi:[0,1]
    v_pk_fma_f32 v[174:175], v[178:179], v[186:187], v[194:195] op_sel:[1,1,0] op_sel_hi:[1,0,1] neg_lo:[0,1,0]
    v_cvt_pk_bf16_f32 v246, v174, -v175
    v_pk_mul_f32 v[194:195], v[178:179], v[190:191] op_sel:[0,0] op_sel_hi:[0,1]
    v_pk_fma_f32 v[176:177], v[178:179], v[190:191], v[194:195] op_sel:[1,1,0] op_sel_hi:[1,0,1] neg_lo:[0,1,0]
    v_cvt_pk_bf16_f32 v247, v176, -v177
    v_pk_mul_f32 v[194:195], v[176:177], v[186:187] op_sel:[0,0] op_sel_hi:[0,1]
    v_pk_fma_f32 v[174:175], v[176:177], v[186:187], v[194:195] op_sel:[1,1,0] op_sel_hi:[1,0,1] neg_lo:[0,1,0]
    v_cvt_pk_bf16_f32 v248, v174, -v175
    ds_write_addtid_b32 v242 offset:6800
    ds_write_addtid_b32 v243 offset:7072
    ds_write_addtid_b32 v244 offset:7344
    ds_write_addtid_b32 v245 offset:7616
    ds_write_addtid_b32 v246 offset:7888
    ds_write_addtid_b32 v247 offset:8160
    ds_write_addtid_b32 v248 offset:8432
    ds_read_b128 a[192:195], v252 offset:0
    ds_read_b128 a[196:199], v252 offset:32
    ds_read_b128 a[200:203], v252 offset:64
    ds_read_b128 a[204:207], v252 offset:96
    ds_read_b128 a[208:211], v252 offset:128
    ds_read_b128 a[212:215], v252 offset:160
    ds_read_b128 a[216:219], v252 offset:192
    ds_read_b128 a[220:223], v252 offset:224
    s_add_u32 m0, s92, 36352
    s_nop 0
    buffer_load_dwordx4 v73, s[4:7], s99 offen offset:0  lds
    v_lshlrev_b32 v199, 16, v236
    v_mul_f32 v199, 0x3fb8aa3b, v199
    v_exp_f32 v199, v199
    v_lshlrev_b32 v255, 16, v237
    v_mul_f32 v255, v255, v253
    v_mul_f32 v255, 0x3e22f983, v255
    v_cvt_pk_bf16_f32 v199, v199, v199
    v_lshlrev_b32 v199, 16, v199
    v_mul_f32 v254, v199, v253
    v_mul_f32 v254, 0xbfb8aa3b, v254
    s_waitcnt lgkmcnt(7)
    v_mfma_f32_32x32x16_bf16 v[216:231], a[192:195], a[160:163], v[216:231]
    s_add_u32 m0, s92, 36352
    s_nop 0
    buffer_load_dwordx4 v74, s[4:7], s99 offen offset:1088  lds
    v_mul_f32 v182, 0x41000000, v254
    v_mul_f32 v185, 0x41000000, v255
    v_mul_f32 v184, 0x43800000, v254
    v_mul_f32 v189, 0x43800000, v255
    s_waitcnt lgkmcnt(6)
    v_mfma_f32_32x32x16_bf16 v[216:231], a[196:199], a[164:167], v[216:231]
    s_add_u32 m0, s92, 36352
    s_nop 0
    buffer_load_dwordx4 v75, s[4:7], s99 offen offset:2176  lds
    v_fract_f32 v185, v185
    v_fract_f32 v188, v255
    v_fract_f32 v189, v189
    v_exp_f32_e64 v182, v182
    s_waitcnt lgkmcnt(5)
    v_mfma_f32_32x32x16_bf16 v[216:231], a[200:203], a[168:171], v[216:231]
    s_add_u32 m0, s92, 36352
    s_nop 0
    buffer_load_dwordx4 v76, s[4:7], s99 offen offset:3264  lds
    v_exp_f32 v183, v254
    v_exp_f32 v184, v184
    v_cos_f32 v186, v185
    v_sin_f32 v187, v185
    s_waitcnt lgkmcnt(4)
    v_mfma_f32_32x32x16_bf16 v[216:231], a[204:207], a[172:175], v[216:231]
    s_add_u32 m0, s93, 53760
    s_add_u32 s99, s99, 256
    s_mov_b64 exec, s[80:81]
    buffer_load_dwordx4 v77, s[4:7], s100 offen  lds
    s_mov_b64 exec, -1
    s_add_u32 s100, s100, 256
    v_cos_f32 v180, v188
    v_sin_f32 v181, v188
    v_cos_f32 v190, v189
    v_sin_f32_e64 v191, v189
    s_waitcnt lgkmcnt(3)
    v_mfma_f32_32x32x16_bf16 v[216:231], a[208:211], a[176:179], v[216:231]
    s_add_u32 m0, s92, 55936
    s_nop 0
    buffer_load_dwordx4 v73, s[4:7], s99 offen offset:0  lds
    v_lshlrev_b32 v192, 16, v238
    v_lshlrev_b32 v193, 16, v239
    v_add_f32 v199, v253, v253
    v_mul_f32 v192, v192, v199
    s_waitcnt lgkmcnt(2)
    v_mfma_f32_32x32x16_bf16 v[216:231], a[212:215], a[180:183], v[216:231]
    s_add_u32 m0, s92, 55936
    s_nop 0
    buffer_load_dwordx4 v74, s[4:7], s99 offen offset:1088  lds
    v_mul_f32 v193, v193, v199
    v_mul_f32 v186, v186, v182
    v_mul_f32 v187, v187, v182
    v_mul_f32 v180, v180, v183
    s_waitcnt lgkmcnt(1)
    v_mfma_f32_32x32x16_bf16 v[216:231], a[216:219], a[184:187], v[216:231]
    s_add_u32 m0, s92, 55936
    s_nop 0
    buffer_load_dwordx4 v75, s[4:7], s99 offen offset:2176  lds
    v_mul_f32 v181, v181, v183
    v_mul_f32 v190, v190, v184
    v_mul_f32_e64 v191, v191, v184
    s_waitcnt lgkmcnt(0)
    v_mfma_f32_32x32x16_bf16 v[216:231], a[220:223], a[188:191], v[216:231]
    s_add_u32 m0, s92, 55936
    s_nop 0
    buffer_load_dwordx4 v76, s[4:7], s99 offen offset:3264  lds
    s_add_u32 m0, s93, 73344
    s_add_u32 s99, s99, 256
    s_mov_b64 exec, s[80:81]
    buffer_load_dwordx4 v77, s[4:7], s100 offen  lds
    s_mov_b64 exec, -1
    s_add_u32 s100, s100, 256
    s_add_u32 m0, s92, 75520
    s_nop 0
    buffer_load_dwordx4 v73, s[4:7], s99 offen offset:0  lds
    s_add_u32 m0, s92, 75520
    s_nop 0
    buffer_load_dwordx4 v74, s[4:7], s99 offen offset:1088  lds
    s_mov_b32 m0, s37
    v_mov_b32 v242, 0x3f80
    v_cvt_pk_bf16_f32 v243, v186, v187
    v_pk_mul_f32 v[194:195], v[186:187], v[186:187] op_sel:[0,0] op_sel_hi:[0,1]
    v_pk_fma_f32 v[172:173], v[186:187], v[186:187], v[194:195] op_sel:[1,1,0] op_sel_hi:[1,0,1] neg_lo:[0,1,0]
    v_cvt_pk_bf16_f32 v244, v172, v173
    v_pk_mul_f32 v[194:195], v[172:173], v[186:187] op_sel:[0,0] op_sel_hi:[0,1]
    v_pk_fma_f32 v[174:175], v[172:173], v[186:187], v[194:195] op_sel:[1,1,0] op_sel_hi:[1,0,1] neg_lo:[0,1,0]
    v_cvt_pk_bf16_f32 v245, v174, v175
    v_pk_mul_f32 v[194:195], v[174:175], v[186:187] op_sel:[0,0] op_sel_hi:[0,1]
    v_pk_fma_f32 v[172:173], v[174:175], v[186:187], v[194:195] op_sel:[1,1,0] op_sel_hi:[1,0,1] neg_lo:[0,1,0]
    v_cvt_pk_bf16_f32 v246, v172, v173
    v_pk_mul_f32 v[194:195], v[172:173], v[186:187] op_sel:[0,0] op_sel_hi:[0,1]
    v_pk_fma_f32 v[174:175], v[172:173], v[186:187], v[194:195] op_sel:[1,1,0] op_sel_hi:[1,0,1] neg_lo:[0,1,0]
    v_cvt_pk_bf16_f32 v247, v174, v175
    v_pk_mul_f32 v[194:195], v[174:175], v[186:187] op_sel:[0,0] op_sel_hi:[0,1]
    v_pk_fma_f32 v[172:173], v[174:175], v[186:187], v[194:195] op_sel:[1,1,0] op_sel_hi:[1,0,1] neg_lo:[0,1,0]
    v_cvt_pk_bf16_f32 v248, v172, v173
    v_pk_mul_f32 v[194:195], v[172:173], v[186:187] op_sel:[0,0] op_sel_hi:[0,1]
    v_pk_fma_f32 v[174:175], v[172:173], v[186:187], v[194:195] op_sel:[1,1,0] op_sel_hi:[1,0,1] neg_lo:[0,1,0]
    v_cvt_pk_bf16_f32 v249, v174, v175
    v_pk_mul_f32 v[194:195], v[174:175], v[186:187] op_sel:[0,0] op_sel_hi:[0,1]
    v_pk_fma_f32 v[172:173], v[174:175], v[186:187], v[194:195] op_sel:[1,1,0] op_sel_hi:[1,0,1] neg_lo:[0,1,0]
    v_cvt_pk_bf16_f32 v250, v172, v173
    v_pk_mul_f32 v[194:195], v[172:173], v[186:187] op_sel:[0,0] op_sel_hi:[0,1]
    s_waitcnt vmcnt(12)
    v_cmp_gt_u32 vcc, 32, v7
    s_nop 0
    s_and_b64 vcc, vcc, s[50:51]
    s_cbranch_scc1 ps_8
pc_10:
    s_barrier
    v_pk_fma_f32 v[174:175], v[172:173], v[186:187], v[194:195] op_sel:[1,1,0] op_sel_hi:[1,0,1] neg_lo:[0,1,0]
    v_cvt_pk_bf16_f32 v251, v174, v175
    ds_write_addtid_b32 v242 offset:0
    ds_write_addtid_b32 v243 offset:272
    ds_write_addtid_b32 v244 offset:544
    ds_write_addtid_b32 v245 offset:816
    ds_write_addtid_b32 v246 offset:1088
    ds_write_addtid_b32 v247 offset:1360
    ds_write_addtid_b32 v248 offset:1632
    ds_write_addtid_b32 v249 offset:1904
    ds_write_addtid_b32 v250 offset:2176
    ds_write_addtid_b32 v251 offset:2448
    v_pk_mul_f32 v[194:195], v[174:175], v[186:187] op_sel:[0,0] op_sel_hi:[0,1]
    v_pk_fma_f32 v[172:173], v[174:175], v[186:187], v[194:195] op_sel:[1,1,0] op_sel_hi:[1,0,1] neg_lo:[0,1,0]
    v_cvt_pk_bf16_f32 v242, v172, v173
    v_pk_mul_f32 v[194:195], v[172:173], v[186:187] op_sel:[0,0] op_sel_hi:[0,1]
    v_pk_fma_f32 v[174:175], v[172:173], v[186:187], v[194:195] op_sel:[1,1,0] op_sel_hi:[1,0,1] neg_lo:[0,1,0]
    v_cvt_pk_bf16_f32 v243, v174, v175
    buffer_load_dwordx4 a[0:3], v200, s[16:19], s101 offen offset:0 sc1
    v_pk_mul_f32 v[194:195], v[174:175], v[186:187] op_sel:[0,0] op_sel_hi:[0,1]
    v_pk_fma_f32 v[172:173], v[174:175], v[186:187], v[194:195] op_sel:[1,1,0] op_sel_hi:[1,0,1] neg_lo:[0,1,0]
    v_cvt_pk_bf16_f32 v244, v172, v173
    v_pk_mul_f32 v[194:195], v[172:173], v[186:187] op_sel:[0,0] op_sel_hi:[0,1]
    v_pk_fma_f32 v[174:175], v[172:173], v[186:187], v[194:195] op_sel:[1,1,0] op_sel_hi:[1,0,1] neg_lo:[0,1,0]
    v_cvt_pk_bf16_f32 v245, v174, v175
    v_pk_mul_f32 v[194:195], v[174:175], v[186:187] op_sel:[0,0] op_sel_hi:[0,1]
    v_pk_fma_f32 v[172:173], v[174:175], v[186:187], v[194:195] op_sel:[1,1,0] op_sel_hi:[1,0,1] neg_lo:[0,1,0]
    v_cvt_pk_bf16_f32 v246, v172, v173
    v_pk_mul_f32 v[194:195], v[172:173], v[186:187] op_sel:[0,0] op_sel_hi:[0,1]
    v_pk_fma_f32 v[174:175], v[172:173], v[186:187], v[194:195] op_sel:[1,1,0] op_sel_hi:[1,0,1] neg_lo:[0,1,0]
    v_cvt_pk_bf16_f32 v247, v174, v175
    v_pk_mul_f32 v[194:195], v[174:175], v[186:187] op_sel:[0,0] op_sel_hi:[0,1]
    v_pk_fma_f32 v[172:173], v[174:175], v[186:187], v[194:195] op_sel:[1,1,0] op_sel_hi:[1,0,1] neg_lo:[0,1,0]
    v_cvt_pk_bf16_f32 v248, v172, v173
    v_pk_mul_f32 v[194:195], v[172:173], v[186:187] op_sel:[0,0] op_sel_hi:[0,1]
    v_pk_fma_f32 v[174:175], v[172:173], v[186:187], v[194:195] op_sel:[1,1,0] op_sel_hi:[1,0,1] neg_lo:[0,1,0]
    v_cvt_pk_bf16_f32 v249, v174, v175
    buffer_load_dwordx4 a[4:7], v200, s[16:19], s101 offen offset:1024 sc1
    v_pk_mul_f32 v[194:195], v[174:175], v[186:187] op_sel:[0,0] op_sel_hi:[0,1]
    v_pk_fma_f32 v[172:173], v[174:175], v[186:187], v[194:195] op_sel:[1,1,0] op_sel_hi:[1,0,1] neg_lo:[0,1,0]
    v_cvt_pk_bf16_f32 v250, v172, v173
    v_pk_mul_f32 v[194:195], v[172:173], v[186:187] op_sel:[0,0] op_sel_hi:[0,1]
    v_pk_fma_f32 v[174:175], v[172:173], v[186:187], v[194:195] op_sel:[1,1,0] op_sel_hi:[1,0,1] neg_lo:[0,1,0]
    v_cvt_pk_bf16_f32 v251, v174, v175
    ds_write_addtid_b32 v242 offset:2720
    ds_write_addtid_b32 v243 offset:2992
    ds_write_addtid_b32 v244 offset:3264
    ds_write_addtid_b32 v245 offset:3536
    ds_write_addtid_b32 v246 offset:3808
    ds_write_addtid_b32 v247 offset:4080
    ds_write_addtid_b32 v248 offset:4352
    ds_write_addtid_b32 v249 offset:4624
    ds_write_addtid_b32 v250 offset:4896
    ds_write_addtid_b32 v251 offset:5168
    v_pk_mul_f32 v[194:195], v[174:175], v[186:187] op_sel:[0,0] op_sel_hi:[0,1]
    v_pk_fma_f32 v[172:173], v[174:175], v[186:187], v[194:195] op_sel:[1,1,0] op_sel_hi:[1,0,1] neg_lo:[0,1,0]
    buffer_load_dwordx4 a[8:11], v200, s[16:19], s101 offen offset:2048 sc1
    v_cvt_pk_bf16_f32 v242, v172, v173
    v_pk_mul_f32 v[194:195], v[172:173], v[186:187] op_sel:[0,0] op_sel_hi:[0,1]
    v_pk_fma_f32 v[174:175], v[172:173], v[186:187], v[194:195] op_sel:[1,1,0] op_sel_hi:[1,0,1] neg_lo:[0,1,0]
    v_cvt_pk_bf16_f32 v243, v174, v175
    v_pk_mul_f32 v[194:195], v[174:175], v[186:187] op_sel:[0,0] op_sel_hi:[0,1]
    v_pk_fma_f32 v[172:173], v[174:175], v[186:187], v[194:195] op_sel:[1,1,0] op_sel_hi:[1,0,1] neg_lo:[0,1,0]
    v_cvt_pk_bf16_f32 v244, v172, v173
    v_pk_mul_f32 v[194:195], v[172:173], v[186:187] op_sel:[0,0] op_sel_hi:[0,1]
    v_pk_fma_f32 v[174:175], v[172:173], v[186:187], v[194:195] op_sel:[1,1,0] op_sel_hi:[1,0,1] neg_lo:[0,1,0]
    v_cvt_pk_bf16_f32 v245, v174, v175
    v_pk_mul_f32 v[194:195], v[174:175], v[186:187] op_sel:[0,0] op_sel_hi:[0,1]
    v_pk_fma_f32 v[172:173], v[174:175], v[186:187], v[194:195] op_sel:[1,1,0] op_sel_hi:[1,0,1] neg_lo:[0,1,0]
    v_cvt_pk_bf16_f32 v246, v172, v173
    v_pk_mul_f32 v[194:195], v[172:173], v[186:187] op_sel:[0,0] op_sel_hi:[0,1]
    v_pk_fma_f32 v[174:175], v[172:173], v[186:187], v[194:195] op_sel:[1,1,0] op_sel_hi:[1,0,1] neg_lo:[0,1,0]
    v_cvt_pk_bf16_f32 v247, v174, v175
    v_pk_mul_f32 v[194:195], v[174:175], v[186:187] op_sel:[0,0] op_sel_hi:[0,1]
    v_pk_fma_f32 v[172:173], v[174:175], v[186:187], v[194:195] op_sel:[1,1,0] op_sel_hi:[1,0,1] neg_lo:[0,1,0]
    buffer_load_dwordx4 a[12:15], v200, s[16:19], s101 offen offset:3072 sc1
    v_cvt_pk_bf16_f32 v248, v172, v173
    v_pk_mul_f32 v[194:195], v[172:173], v[186:187] op_sel:[0,0] op_sel_hi:[0,1]
    v_pk_fma_f32 v[174:175], v[172:173], v[186:187], v[194:195] op_sel:[1,1,0] op_sel_hi:[1,0,1] neg_lo:[0,1,0]
    v_cvt_pk_bf16_f32 v249, v174, v175
    v_pk_mul_f32 v[194:195], v[174:175], v[186:187] op_sel:[0,0] op_sel_hi:[0,1]
    v_pk_fma_f32 v[172:173], v[174:175], v[186:187], v[194:195] op_sel:[1,1,0] op_sel_hi:[1,0,1] neg_lo:[0,1,0]
    v_cvt_pk_bf16_f32 v250, v172, v173
    v_pk_mul_f32 v[194:195], v[172:173], v[186:187] op_sel:[0,0] op_sel_hi:[0,1]
    v_pk_fma_f32 v[174:175], v[172:173], v[186:187], v[194:195] op_sel:[1,1,0] op_sel_hi:[1,0,1] neg_lo:[0,1,0]
    v_cvt_pk_bf16_f32 v251, v174, v175
    ds_write_addtid_b32 v242 offset:5440
    ds_write_addtid_b32 v243 offset:5712
    ds_write_addtid_b32 v244 offset:5984
    ds_write_addtid_b32 v245 offset:6256
    ds_write_addtid_b32 v246 offset:6528
    ds_write_addtid_b32 v247 offset:6800
    ds_write_addtid_b32 v248 offset:7072
    ds_write_addtid_b32 v249 offset:7344
    s_add_u32 s101, s101, 4096
    buffer_load_dwordx4 a[16:19], v200, s[16:19], s101 offen offset:0 sc1
    ds_write_addtid_b32 v250 offset:7616
    ds_write_addtid_b32 v251 offset:7888
    v_pk_mul_f32 v[194:195], v[174:175], v[186:187] op_sel:[0,0] op_sel_hi:[0,1]
    v_pk_fma_f32 v[172:173], v[174:175], v[186:187], v[194:195] op_sel:[1,1,0] op_sel_hi:[1,0,1] neg_lo:[0,1,0]
    v_cvt_pk_bf16_f32 v242, v172, v173
    v_pk_mul_f32 v[194:195], v[172:173], v[186:187] op_sel:[0,0] op_sel_hi:[0,1]
    v_pk_fma_f32 v[174:175], v[172:173], v[186:187], v[194:195] op_sel:[1,1,0] op_sel_hi:[1,0,1] neg_lo:[0,1,0]
    v_cvt_pk_bf16_f32 v243, v174, v175
    ds_write_addtid_b32 v242 offset:8160
    ds_write_addtid_b32 v243 offset:8432
    ds_read_b128 a[160:163], v252 offset:0
    ds_read_b128 a[164:167], v252 offset:32
    ds_read_b128 a[168:171], v252 offset:64
    ds_read_b128 a[172:175], v252 offset:96
    ds_read_b128 a[176:179], v252 offset:128
    ds_read_b128 a[180:183], v252 offset:160
    ds_read_b128 a[184:187], v252 offset:192
    ds_read_b128 a[188:191], v252 offset:224
    buffer_load_dwordx4 a[20:23], v200, s[16:19], s101 offen offset:1024 sc1
    v_pk_mul_f32 v[194:195], v[180:181], v[180:181] op_sel:[0,0] op_sel_hi:[0,1]
    v_pk_fma_f32 v[182:183], v[180:181], v[180:181], v[194:195] op_sel:[1,1,0] op_sel_hi:[1,0,1] neg_lo:[0,1,0]
    v_pk_mul_f32 v[194:195], v[182:183], v[182:183] op_sel:[0,0] op_sel_hi:[0,1]
    v_pk_fma_f32 v[184:185], v[182:183], v[182:183], v[194:195] op_sel:[1,1,0] op_sel_hi:[1,0,1] neg_lo:[0,1,0]
    v_cvt_pk_bf16_f32 v242, v192, -v193
    v_pk_mul_f32 v[194:195], v[192:193], v[180:181] op_sel:[0,0] op_sel_hi:[0,1]
    v_pk_fma_f32 v[174:175], v[192:193], v[180:181], v[194:195] op_sel:[1,1,0] op_sel_hi:[1,0,1] neg_lo:[0,1,0]
    v_cvt_pk_bf16_f32 v243, v174, -v175
    v_pk_mul_f32 v[194:195], v[174:175], v[180:181] op_sel:[0,0] op_sel_hi:[0,1]
    v_pk_fma_f32 v[172:173], v[174:175], v[180:181], v[194:195] op_sel:[1,1,0] op_sel_hi:[1,0,1] neg_lo:[0,1,0]
    v_cvt_pk_bf16_f32 v244, v172, -v173
    v_pk_mul_f32 v[194:195], v[172:173], v[180:181] op_sel:[0,0] op_sel_hi:[0,1]
    v_pk_fma_f32 v[174:175], v[172:173], v[180:181], v[194:195] op_sel:[1,1,0] op_sel_hi:[1,0,1] neg_lo:[0,1,0]
    v_cvt_pk_bf16_f32 v245, v174, -v175
    v_pk_mul_f32 v[194:195], v[174:175], v[180:181] op_sel:[0,0] op_sel_hi:[0,1]
    v_pk_fma_f32 v[172:173], v[174:175], v[180:181], v[194:195] op_sel:[1,1,0] op_sel_hi:[1,0,1] neg_lo:[0,1,0]
    v_cvt_pk_bf16_f32 v246, v172, -v173
    v_pk_mul_f32 v[194:195], v[172:173], v[180:181] op_sel:[0,0] op_sel_hi:[0,1]
    buffer_load_dwordx4 a[24:27], v200, s[16:19], s101 offen offset:2048 sc1
    v_pk_fma_f32 v[174:175], v[172:173], v[180:181], v[194:195] op_sel:[1,1,0] op_sel_hi:[1,0,1] neg_lo:[0,1,0]
    v_cvt_pk_bf16_f32 v247, v174, -v175
    v_pk_mul_f32 v[194:195], v[174:175], v[180:181] op_sel:[0,0] op_sel_hi:[0,1]
    v_pk_fma_f32 v[172:173], v[174:175], v[180:181], v[194:195] op_sel:[1,1,0] op_sel_hi:[1,0,1] neg_lo:[0,1,0]
    v_cvt_pk_bf16_f32 v248, v172, -v173
    v_pk_mul_f32 v[194:195], v[172:173], v[180:181] op_sel:[0,0] op_sel_hi:[0,1]
    v_pk_fma_f32 v[174:175], v[172:173], v[180:181], v[194:195] op_sel:[1,1,0] op_sel_hi:[1,0,1] neg_lo:[0,1,0]
    v_cvt_pk_bf16_f32 v249, v174, -v175
    v_pk_mul_f32 v[194:195], v[192:193], v[190:191] op_sel:[0,0] op_sel_hi:[0,1]
    v_pk_fma_f32 v[176:177], v[192:193], v[190:191], v[194:195] op_sel:[1,1,0] op_sel_hi:[1,0,1] neg_lo:[0,1,0]
    v_cvt_pk_bf16_f32 v250, v176, -v177
    v_pk_mul_f32 v[194:195], v[176:177], v[182:183] op_sel:[0,0] op_sel_hi:[0,1]
    v_pk_fma_f32 v[174:175], v[176:177], v[182:183], v[194:195] op_sel:[1,1,0] op_sel_hi:[1,0,1] neg_lo:[0,1,0]
    v_cvt_pk_bf16_f32 v251, v174, -v175
    ds_write_addtid_b32 v242 offset:0
    ds_write_addtid_b32 v243 offset:272
    ds_write_addtid_b32 v244 offset:544
    ds_write_addtid_b32 v245 offset:816
    buffer_load_dwordx4 a[28:31], v200, s[16:19], s101 offen offset:3072 sc1
    ds_write_addtid_b32 v246 offset:1088
    ds_write_addtid_b32 v247 offset:1360
    ds_write_addtid_b32 v248 offset:1632
    ds_write_addtid_b32 v249 offset:1904
    ds_write_addtid_b32 v250 offset:2176
    ds_write_addtid_b32 v251 offset:2448
    v_pk_mul_f32 v[194:195], v[174:175], v[182:183] op_sel:[0,0] op_sel_hi:[0,1]
    v_pk_fma_f32 v[172:173], v[174:175], v[182:183], v[194:195] op_sel:[1,1,0] op_sel_hi:[1,0,1] neg_lo:[0,1,0]
    v_cvt_pk_bf16_f32 v242, v172, -v173
    v_pk_mul_f32 v[194:195], v[172:173], v[182:183] op_sel:[0,0] op_sel_hi:[0,1]
    v_pk_fma_f32 v[174:175], v[172:173], v[182:183], v[194:195] op_sel:[1,1,0] op_sel_hi:[1,0,1] neg_lo:[0,1,0]
    v_cvt_pk_bf16_f32 v243, v174, -v175
    v_pk_mul_f32 v[194:195], v[174:175], v[182:183] op_sel:[0,0] op_sel_hi:[0,1]
    v_pk_fma_f32 v[172:173], v[174:175], v[182:183], v[194:195] op_sel:[1,1,0] op_sel_hi:[1,0,1] neg_lo:[0,1,0]
    v_cvt_pk_bf16_f32 v244, v172, -v173
    v_pk_mul_f32 v[194:195], v[176:177], v[190:191] op_sel:[0,0] op_sel_hi:[0,1]
    v_pk_fma_f32 v[178:179], v[176:177], v[190:191], v[194:195] op_sel:[1,1,0] op_sel_hi:[1,0,1] neg_lo:[0,1,0]
    v_cvt_pk_bf16_f32 v245, v178, -v179
    s_add_u32 s101, s101, 4096
    buffer_load_dwordx4 a[32:35], v200, s[16:19], s101 offen offset:0 sc1
    v_pk_mul_f32 v[194:195], v[178:179], v[184:185] op_sel:[0,0] op_sel_hi:[0,1]
    v_pk_fma_f32 v[174:175], v[178:179], v[184:185], v[194:195] op_sel:[1,1,0] op_sel_hi:[1,0,1] neg_lo:[0,1,0]
    v_cvt_pk_bf16_f32 v246, v174, -v175
    v_pk_mul_f32 v[194:195], v[174:175], v[184:185] op_sel:[0,0] op_sel_hi:[0,1]
    v_pk_fma_f32 v[172:173], v[174:175], v[184:185], v[194:195] op_sel:[1,1,0] op_sel_hi:[1,0,1] neg_lo:[0,1,0]
    v_cvt_pk_bf16_f32 v247, v172, -v173
    v_pk_mul_f32 v[194:195], v[178:179], v[190:191] op_sel:[0,0] op_sel_hi:[0,1]
    v_pk_fma_f32 v[176:177], v[178:179], v[190:191], v[194:195] op_sel:[1,1,0] op_sel_hi:[1,0,1] neg_lo:[0,1,0]
    v_cvt_pk_bf16_f32 v248, v176, -v177
    v_pk_mul_f32 v[194:195], v[176:177], v[184:185] op_sel:[0,0] op_sel_hi:[0,1]
    v_pk_fma_f32 v[174:175], v[176:177], v[184:185], v[194:195] op_sel:[1,1,0] op_sel_hi:[1,0,1] neg_lo:[0,1,0]
    v_cvt_pk_bf16_f32 v249, v174, -v175
    v_pk_mul_f32 v[194:195], v[174:175], v[184:185] op_sel:[0,0] op_sel_hi:[0,1]
    v_pk_fma_f32 v[172:173], v[174:175], v[184:185], v[194:195] op_sel:[1,1,0] op_sel_hi:[1,0,1] neg_lo:[0,1,0]
    v_cvt_pk_bf16_f32 v250, v172, -v173
    v_pk_mul_f32 v[194:195], v[176:177], v[190:191] op_sel:[0,0] op_sel_hi:[0,1]
    v_pk_fma_f32 v[178:179], v[176:177], v[190:191], v[194:195] op_sel:[1,1,0] op_sel_hi:[1,0,1] neg_lo:[0,1,0]
    v_cvt_pk_bf16_f32 v251, v178, -v179
    buffer_load_dwordx4 a[36:39], v200, s[16:19], s101 offen offset:1024 sc1
    ds_write_addtid_b32 v242 offset:2720
    ds_write_addtid_b32 v242 offset:3264
    ds_write_addtid_b32 v243 offset:3536
    ds_write_addtid_b32 v244 offset:3808
    ds_write_addtid_b32 v245 offset:4352
    ds_write_addtid_b32 v246 offset:4624
    ds_write_addtid_b32 v247 offset:4896
    ds_write_addtid_b32 v248 offset:5440
    ds_write_addtid_b32 v249 offset:5712
    ds_write_addtid_b32 v250 offset:5984
    ds_write_addtid_b32 v251 offset:6528
    v_pk_mul_f32 v[194:195], v[178:179], v[186:187] op_sel:[0,0] op_sel_hi:[0,1]
    v_pk_fma_f32 v[174:175], v[178:179], v[186:187], v[194:195] op_sel:[1,1,0] op_sel_hi:[1,0,1] neg_lo:[0,1,0]
    v_cvt_pk_bf16_f32 v242, v174, -v175
    v_pk_mul_f32 v[194:195], v[178:179], v[190:191] op_sel:[0,0] op_sel_hi:[0,1]
    v_pk_fma_f32 v[176:177], v[178:179], v[190:191], v[194:195] op_sel:[1,1,0] op_sel_hi:[1,0,1] neg_lo:[0,1,0]
    v_cvt_pk_bf16_f32 v243, v176, -v177
    v_pk_mul_f32 v[194:195], v[176:177], v[186:187] op_sel:[0,0] op_sel_hi:[0,1]
    buffer_load_dwordx4 a[40:43], v200, s[16:19], s101 offen offset:2048 sc1
    v_pk_fma_f32 v[174:175], v[176:177], v[186:187], v[194:195] op_sel:[1,1,0] op_sel_hi:[1,0,1] neg_lo:[0,1,0]
    v_cvt_pk_bf16_f32 v244, v174, -v175
    v_pk_mul_f32 v[194:195], v[176:177], v[190:191] op_sel:[0,0] op_sel_hi:[0,1]
    v_pk_fma_f32 v[178:179], v[176:177], v[190:191], v[194:195] op_sel:[1,1,0] op_sel_hi:[1,0,1] neg_lo:[0,1,0]
    v_cvt_pk_bf16_f32 v245, v178, -v179
    v_pk_mul_f32 v[194:195], v[178:179], v[186:187] op_sel:[0,0] op_sel_hi:[0,1]
    v_pk_fma_f32 v[174:175], v[178:179], v[186:187], v[194:195] op_sel:[1,1,0] op_sel_hi:[1,0,1] neg_lo:[0,1,0]
    v_cvt_pk_bf16_f32 v246, v174, -v175
    v_pk_mul_f32 v[194:195], v[178:179], v[190:191] op_sel:[0,0] op_sel_hi:[0,1]
    v_pk_fma_f32 v[176:177], v[178:179], v[190:191], v[194:195] op_sel:[1,1,0] op_sel_hi:[1,0,1] neg_lo:[0,1,0]
    v_cvt_pk_bf16_f32 v247, v176, -v177
    v_pk_mul_f32 v[194:195], v[176:177], v[186:187] op_sel:[0,0] op_sel_hi:[0,1]
    v_pk_fma_f32 v[174:175], v[176:177], v[186:187], v[194:195] op_sel:[1,1,0] op_sel_hi:[1,0,1] neg_lo:[0,1,0]
    v_cvt_pk_bf16_f32 v248, v174, -v175
    ds_write_addtid_b32 v242 offset:6800
    ds_write_addtid_b32 v243 offset:7072
    ds_write_addtid_b32 v244 offset:7344
    ds_write_addtid_b32 v245 offset:7616
    buffer_load_dwordx4 a[44:47], v200, s[16:19], s101 offen offset:3072 sc1
    ds_write_addtid_b32 v246 offset:7888
    ds_write_addtid_b32 v247 offset:8160
    ds_write_addtid_b32 v248 offset:8432
    ds_read_b128 a[192:195], v252 offset:0
    ds_read_b128 a[196:199], v252 offset:32
    ds_read_b128 a[200:203], v252 offset:64
    ds_read_b128 a[204:207], v252 offset:96
    ds_read_b128 a[208:211], v252 offset:128
    ds_read_b128 a[212:215], v252 offset:160
    ds_read_b128 a[216:219], v252 offset:192
    ds_read_b128 a[220:223], v252 offset:224
    s_add_u32 m0, s92, 75520
    s_nop 0
    buffer_load_dwordx4 v75, s[4:7], s99 offen offset:2176  lds
    s_waitcnt lgkmcnt(7)
    v_mfma_f32_32x32x16_bf16 v[216:231], a[192:195], a[160:163], v[216:231]
    s_add_u32 m0, s92, 75520
    s_nop 0
    buffer_load_dwordx4 v76, s[4:7], s99 offen offset:3264  lds
    s_waitcnt lgkmcnt(6)
    v_mfma_f32_32x32x16_bf16 v[216:231], a[196:199], a[164:167], v[216:231]
    s_add_u32 m0, s93, 92928
    s_add_u32 s101, s101, 4096
    buffer_load_dwordx4 a[48:51], v200, s[16:19], s101 offen offset:0 sc1
    s_add_u32 s99, s99, 256
    s_mov_b64 exec, s[80:81]
    buffer_load_dwordx4 v77, s[4:7], s100 offen  lds
    s_mov_b64 exec, -1
    s_add_u32 s100, s100, 256
    s_waitcnt lgkmcnt(5)
    v_mfma_f32_32x32x16_bf16 v[216:231], a[200:203], a[168:171], v[216:231]
    s_add_u32 m0, s92, 95104
    s_nop 0
    buffer_load_dwordx4 v73, s[4:7], s99 offen offset:0  lds
    s_waitcnt lgkmcnt(4)
    v_mfma_f32_32x32x16_bf16 v[216:231], a[204:207], a[172:175], v[216:231]
    s_add_u32 m0, s92, 95104
    s_nop 0
    buffer_load_dwordx4 v74, s[4:7], s99 offen offset:1088  lds
    s_waitcnt lgkmcnt(3)
    v_mfma_f32_32x32x16_bf16 v[216:231], a[208:211], a[176:179], v[216:231]
    s_add_u32 m0, s92, 95104
    s_nop 0
    buffer_load_dwordx4 v75, s[4:7], s99 offen offset:2176  lds
    s_waitcnt lgkmcnt(2)
    v_mfma_f32_32x32x16_bf16 v[216:231], a[212:215], a[180:183], v[216:231]
    s_add_u32 m0, s92, 95104
    s_nop 0
    buffer_load_dwordx4 v76, s[4:7], s99 offen offset:3264  lds
    s_waitcnt lgkmcnt(1)
    v_mfma_f32_32x32x16_bf16 v[216:231], a[216:219], a[184:187], v[216:231]
    buffer_load_dwordx4 a[52:55], v200, s[16:19], s101 offen offset:1024 sc1
    s_add_u32 m0, s93, 112512
    s_add_u32 s99, s99, 256
    s_mov_b64 exec, s[80:81]
    buffer_load_dwordx4 v77, s[4:7], s100 offen  lds
    s_mov_b64 exec, -1
    s_add_u32 s100, s100, 256
    s_waitcnt lgkmcnt(0)
    v_mfma_f32_32x32x16_bf16 v[216:231], a[220:223], a[188:191], v[216:231]
    s_add_u32 m0, s92, 114688
    s_nop 0
    buffer_load_dwordx4 v73, s[4:7], s99 offen offset:0  lds
    s_add_u32 m0, s92, 114688
    s_nop 0
    buffer_load_dwordx4 v74, s[4:7], s99 offen offset:1088  lds
    s_add_u32 m0, s92, 114688
    s_nop 0
    buffer_load_dwordx4 v75, s[4:7], s99 offen offset:2176  lds
    s_add_u32 m0, s92, 114688
    s_nop 0
    buffer_load_dwordx4 v76, s[4:7], s99 offen offset:3264  lds
    s_add_u32 m0, s93, 132096
    s_add_u32 s99, s99, 256
    s_mov_b64 exec, s[80:81]
    buffer_load_dwordx4 v77, s[4:7], s100 offen  lds
    s_mov_b64 exec, -1
    s_add_u32 s100, s100, 256
    s_mov_b32 m0, s37
    s_branch ec_4
nc_3:
    s_sub_u32 s33, s2, 160
    s_min_u32 s33, s33, 159
    s_mul_i32 s29, s33, 3277
    s_lshr_b32 s29, s29, 16
    s_mul_i32 s30, s29, 20
    s_sub_u32 s30, s33, s30
    s_mul_i32 s31, s30, 13108
    s_lshr_b32 s31, s31, 16
    s_mul_i32 s32, s31, 5
    s_sub_u32 s32, s30, s32
    s_lshl_b32 s28, s24, 10
    s_lshr_b32 s34, s32, 1
    s_mul_i32 s34, s34, 20
    s_and_b32 s35, s32, 1
    s_lshl_b32 s35, s35, 3
    s_add_u32 s34, s34, s35
    s_cmp_eq_u32 s32, 4
    s_cselect_b32 s34, 16, s34
    s_cselect_b32 s35, 20, 4
    s_mul_i32 s36, s31, 160
    s_add_u32 s34, s34, s36
    s_mul_i32 s34, s34, 1280
    s_mul_i32 s36, s29, 160
    s_add_u32 s34, s34, s36
    v_add_u32 v162, 0, v0
    v_mul_u32_u24 v160, 6554, v162
    v_lshrrev_b32 v160, 16, v160
    v_mul_u32_u24 v161, 10, v160
    v_sub_u32 v161, v162, v161
    v_lshrrev_b32 v163, 3, v160
    v_mul_u32_u24 v163, 40, v163
    v_bfe_u32 v164, v160, 2, 1
    v_mul_u32_u24 v164, s35, v164
    v_and_b32_e64 v160, 3, v160
    v_add3_u32 v160, v160, v163, v164
    v_mul_u32_u24 v160, 1280, v160
    v_lshl_add_u32 v162, v161, 4, v160
    s_add_u32 m0, s28, 0
    s_nop 0
    buffer_load_dwordx4 v162, s[12:15], s34 offen lds
    v_add_u32 v162, 256, v0
    v_min_u32 v162, 319, v162
    v_mul_u32_u24 v160, 6554, v162
    v_lshrrev_b32 v160, 16, v160
    v_mul_u32_u24 v161, 10, v160
    v_sub_u32 v161, v162, v161
    v_lshrrev_b32 v163, 3, v160
    v_mul_u32_u24 v163, 40, v163
    v_bfe_u32 v164, v160, 2, 1
    v_mul_u32_u24 v164, s35, v164
    v_and_b32_e64 v160, 3, v160
    v_add3_u32 v160, v160, v163, v164
    v_mul_u32_u24 v160, 1280, v160
    v_lshl_add_u32 v162, v161, 4, v160
    s_add_u32 m0, s28, 4096
    s_nop 0
    buffer_load_dwordx4 v162, s[12:15], s34 offen lds
    v_bfe_u32 v163, v0, 4, 2
    v_bfe_u32 v164, v0, 2, 2
    v_lshl_add_u32 v163, v163, 3, v164
    v_mul_u32_u24 v163, 160, v163
    v_and_b32 v164, 3, v0
    v_lshl_add_u32 v165, v164, 3, v163
    v_add_u32 v165, 0, v165
    s_lshl_b32 s36, s24, 5
    v_add_u32_e64 v166, s36, v165
    s_mul_i32 s33, s33, 5120
    s_add_u32 s33, s33, 2621440
    v_lshl_add_u32 v167, v1, 4, s33
    v_add_u32 v164, 4096, v167
    v_mov_b32 v163, 1073741824
    v_cmp_gt_u32 vcc, 64, v0
    s_sub_u32 s36, s24, s31
    s_and_b32 s36, s36, 3
    s_lshl_b32 s36, s36, 10
    v_cndmask_b32 v168, v163, v164, vcc
    v_add_u32 v167, s36, v167
    s_sub_u32 s33, s2, 64
    s_min_u32 s33, s33, 159
    s_mul_i32 s29, s33, 3277
    s_lshr_b32 s29, s29, 16
    s_mul_i32 s30, s29, 20
    s_sub_u32 s30, s33, s30
    s_mul_i32 s31, s30, 13108
    s_lshr_b32 s31, s31, 16
    s_mul_i32 s32, s31, 5
    s_sub_u32 s32, s30, s32
    s_lshl_b32 s28, s24, 10
    s_lshr_b32 s34, s32, 1
    s_mul_i32 s34, s34, 20
    s_and_b32 s35, s32, 1
    s_lshl_b32 s35, s35, 3
    s_add_u32 s34, s34, s35
    s_cmp_eq_u32 s32, 4
    s_cselect_b32 s34, 16, s34
    s_cselect_b32 s35, 20, 4
    s_mul_i32 s36, s31, 160
    s_add_u32 s34, s34, s36
    s_mul_i32 s34, s34, 1280
    s_mul_i32 s36, s29, 160
    s_add_u32 s34, s34, s36
    v_add_u32 v182, 0, v0
    v_mul_u32_u24 v180, 6554, v182
    v_lshrrev_b32 v180, 16, v180
    v_mul_u32_u24 v181, 10, v180
    v_sub_u32 v181, v182, v181
    v_lshrrev_b32 v183, 3, v180
    v_mul_u32_u24 v183, 40, v183
    v_bfe_u32 v184, v180, 2, 1
    v_mul_u32_u24 v184, s35, v184
    v_and_b32_e64 v180, 3, v180
    v_add3_u32 v180, v180, v183, v184
    v_mul_u32_u24 v180, 1280, v180
    v_lshl_add_u32 v182, v181, 4, v180
    s_add_u32 m0, s28, 8192
    s_nop 0
    buffer_load_dwordx4 v182, s[12:15], s34 offen lds
    v_add_u32 v182, 256, v0
    v_min_u32 v182, 319, v182
    v_mul_u32_u24 v180, 6554, v182
    v_lshrrev_b32 v180, 16, v180
    v_mul_u32_u24 v181, 10, v180
    v_sub_u32 v181, v182, v181
    v_lshrrev_b32 v183, 3, v180
    v_mul_u32_u24 v183, 40, v183
    v_bfe_u32 v184, v180, 2, 1
    v_mul_u32_u24 v184, s35, v184
    v_and_b32 v180, 3, v180
    v_add3_u32 v180, v180, v183, v184
    v_mul_u32_u24 v180, 1280, v180
    v_lshl_add_u32 v182, v181, 4, v180
    s_add_u32 m0, s28, 12288
    s_nop 0
    buffer_load_dwordx4 v182, s[12:15], s34 offen lds
    v_bfe_u32 v183, v0, 4, 2
    v_bfe_u32 v184, v0, 2, 2
    v_lshl_add_u32 v183, v183, 3, v184
    v_mul_u32_u24 v183, 160, v183
    v_and_b32 v184, 3, v0
    v_lshl_add_u32 v185, v184, 3, v183
    v_add_u32 v185, 8192, v185
    s_lshl_b32 s36, s24, 5
    v_add_u32 v186, s36, v185
    s_mul_i32 s33, s33, 5120
    s_add_u32 s33, s33, 2621440
    v_lshl_add_u32 v187, v1, 4, s33
    v_add_u32 v184, 4096, v187
    v_mov_b32 v183, 1073741824
    v_cmp_gt_u32 vcc, 64, v0
    s_sub_u32 s36, s24, s31
    s_and_b32 s36, s36, 3
    s_lshl_b32 s36, s36, 10
    v_cndmask_b32 v188, v183, v184, vcc
    v_add_u32 v187, s36, v187
    v_mov_b32 v216, 0
    v_mov_b32 v217, 0
    v_mov_b32 v218, 0
    v_mov_b32 v219, 0
    v_mov_b32 v220, 0
    v_mov_b32 v221, 0
    v_mov_b32 v222, 0
    v_mov_b32 v223, 0
    v_mov_b32 v224, 0
    v_mov_b32 v225, 0
    v_mov_b32 v226, 0
    v_mov_b32 v227, 0
    v_mov_b32 v228, 0
    v_mov_b32 v229, 0
    v_mov_b32 v230, 0
    v_mov_b32_e64 v231, 0
    s_waitcnt vmcnt(5)
    s_barrier
    ds_read_b64_tr_b16 v[96:97], v111
    ds_read_b64_tr_b16 v[98:99], v111 offset:2560
    ds_read_b64_tr_b16 v[100:101], v112
    ds_read_b64_tr_b16 v[102:103], v112 offset:2560
    ds_read_b64_tr_b16 v[104:105], v113
    ds_read_b64_tr_b16 v[106:107], v113 offset:2560
    s_waitcnt lgkmcnt(4)
    buffer_store_dwordx4 v[96:99], v108, s[16:19], 0 offen sc1
    s_waitcnt lgkmcnt(2)
    buffer_store_dwordx4 v[100:103], v109, s[16:19], 0 offen sc1
    s_waitcnt lgkmcnt(0)
    buffer_store_dwordx4 v[104:107], v110, s[16:19], 0 offen sc1
    global_load_dword v7, v5, s[66:67] sc1
    v_lshrrev_b32 v132, 5, v0
    v_and_b32_e64 v133, 31, v0
    v_mul_u32_u24 v132, 1280, v132
    v_lshl_add_u32 v134, v133, 4, v132
    v_mov_b32 v135, 1073741824
    v_cmp_gt_u32 vcc, 16, v133
    s_mul_i32 s96, s2, 10240
    buffer_load_dwordx4 v[120:123], v134, s[4:7], s96 offen
    v_cndmask_b32_e64 v135, v135, v134, vcc
    buffer_load_dwordx4 v[124:127], v134, s[4:7], s96 offen offset:512
    buffer_load_dwordx4 v[128:131], v135, s[4:7], s96 offen offset:1024
    s_waitcnt vmcnt(4)
    s_waitcnt vmcnt(3)
    v_cmp_gt_u32 vcc, 1, v7
    s_nop 0
    s_and_b64 vcc, vcc, s[50:51]
    s_and_b64 vcc, vcc, 1
    s_cbranch_scc1 ps_11
pc_13:
    s_barrier
    v_lshlrev_b32 v2, 3, v4
    v_mov_b32 v5, 1
    v_cndmask_b32 v2, v4, v2, s[50:51]
    buffer_atomic_add v5, v2, s[16:19], s86 offen offset:0 sc1
    ds_read_b64_tr_b16 v[172:173], v166
    ds_read_b64_tr_b16 v[174:175], v166 offset:640
    ds_read_b64_tr_b16 v[176:177], v165 offset:128
    ds_read_b64_tr_b16 v[178:179], v165 offset:768
    s_waitcnt lgkmcnt(2)
    buffer_store_dwordx4 v[172:175], v167, s[16:19], 0 offen sc1
    s_waitcnt lgkmcnt(0)
    buffer_store_dwordx4 v[176:179], v168, s[16:19], 0 offen sc1
    ds_read_b64_tr_b16 v[192:193], v186
    ds_read_b64_tr_b16 v[194:195], v186 offset:640
    ds_read_b64_tr_b16 v[196:197], v185 offset:128
    ds_read_b64_tr_b16 v[198:199], v185 offset:768
    s_waitcnt lgkmcnt(2)
    buffer_store_dwordx4 v[192:195], v187, s[16:19], 0 offen sc1
    s_waitcnt lgkmcnt(0)
    buffer_store_dwordx4 v[196:199], v188, s[16:19], 0 offen sc1
    v_mov_b32 v134, 0x3f803f80
    v_mov_b32 v132, 0
    v_mov_b32 v133, 0
    s_waitcnt vmcnt(7)
    v_dot2c_f32_bf16 v132, v120, v134
    v_dot2c_f32_bf16 v133, v120, v120
    v_dot2c_f32_bf16 v132, v121, v134
    v_dot2c_f32_bf16 v133, v121, v121
    v_dot2c_f32_bf16 v132, v122, v134
    v_dot2c_f32_bf16 v133, v122, v122
    v_dot2c_f32_bf16 v132, v123, v134
    v_dot2c_f32_bf16 v133, v123, v123
    s_waitcnt vmcnt(6)
    v_dot2c_f32_bf16 v132, v124, v134
    v_dot2c_f32_bf16 v133, v124, v124
    v_dot2c_f32_bf16 v132, v125, v134
    v_dot2c_f32_bf16 v133, v125, v125
    v_dot2c_f32_bf16 v132, v126, v134
    v_dot2c_f32_bf16 v133, v126, v126
    v_dot2c_f32_bf16 v132, v127, v134
    v_dot2c_f32_bf16 v133, v127, v127
    s_waitcnt vmcnt(5)
    v_dot2c_f32_bf16 v132, v128, v134
    v_dot2c_f32_bf16 v133, v128, v128
    v_dot2c_f32_bf16 v132, v129, v134
    v_dot2c_f32_bf16 v133, v129, v129
    v_dot2c_f32_bf16 v132, v130, v134
    v_dot2c_f32_bf16 v133, v130, v130
    v_dot2c_f32_bf16 v132, v131, v134
    v_dot2c_f32_bf16 v133, v131, v131
    v_lshrrev_b32 v135, 5, v0
    v_and_b32 v121, 3, v135
    v_lshrrev_b32 v135, 2, v135
    v_add_f32_dpp v132, v132, v132 row_shr:1 row_mask:0xf bank_mask:0xf bound_ctrl:0
    v_add_f32_dpp v133, v133, v133 row_shr:1 row_mask:0xf bank_mask:0xf bound_ctrl:0
    v_lshlrev_b32_e64 v135, 3, v135
    v_add_f32_dpp v132, v132, v132 row_shr:2 row_mask:0xf bank_mask:0xf bound_ctrl:0
    v_add_f32_dpp v133, v133, v133 row_shr:2 row_mask:0xf bank_mask:0xf bound_ctrl:0
    v_lshl_add_u32 v135, v121, 12, v135
    v_add_f32_dpp v132, v132, v132 row_shr:4 row_mask:0xf bank_mask:0xf bound_ctrl:0
    v_add_f32_dpp v133, v133, v133 row_shr:4 row_mask:0xf bank_mask:0xf bound_ctrl:0
    v_and_b32_e64 v121, 31, v0
    v_add_f32_dpp v132, v132, v132 row_shr:8 row_mask:0xf bank_mask:0xf bound_ctrl:0
    v_add_f32_dpp v133, v133, v133 row_shr:8 row_mask:0xf bank_mask:0xf bound_ctrl:0
    v_cmp_eq_u32_e64 vcc, 31, v121
    v_add_f32_dpp v132, v132, v132 row_bcast:15 row_mask:0xa bank_mask:0xf
    v_add_f32_dpp v133, v133, v133 row_bcast:15 row_mask:0xa bank_mask:0xf
    v_mov_b32 v121, 1073741824
    v_cndmask_b32_e64 v120, v121, v135, vcc
    s_lshl_b32 s96, s2, 4
    s_add_u32 s96, s96, 3440640
    v_mul_f32 v135, 0x3acccccd, v132
    v_mul_f32 v133, 0x3acccccd, v133
    v_fma_f32 v133, -v135, v135, v133
    v_max_f32 v133, 0, v133
    v_add_f32 v133, 0x3727c5ac, v133
    v_rsq_f32_e64 v132, v133
    s_nop 0
    v_mul_f32 v133, -v135, v132
    buffer_store_dwordx2 v[132:133], v120, s[16:19], s96 offen sc1
    s_add_u32 m0, s92, 36352
    s_nop 0
    s_nop 0
    buffer_load_dwordx4 v73, s[4:7], s99 offen offset:0  lds
    buffer_load_dwordx4 v74, s[4:7], s99 offen offset:1088  lds
    buffer_load_dwordx4 v75, s[4:7], s99 offen offset:2176  lds
    buffer_load_dwordx4 v76, s[4:7], s99 offen offset:3264  lds
    s_add_u32 m0, s93, 53760
    s_add_u32 s99, s99, 256
    s_mov_b64 exec, s[80:81]
    buffer_load_dwordx4 v77, s[4:7], s100 offen  lds
    s_mov_b64 exec, -1
    s_add_u32 s100, s100, 256
    s_add_u32 m0, s92, 55936
    s_nop 0
    s_nop 0
    buffer_load_dwordx4 v73, s[4:7], s99 offen offset:0  lds
    buffer_load_dwordx4 v74, s[4:7], s99 offen offset:1088  lds
    buffer_load_dwordx4 v75, s[4:7], s99 offen offset:2176  lds
    buffer_load_dwordx4 v76, s[4:7], s99 offen offset:3264  lds
    s_add_u32 m0, s93, 73344
    s_add_u32 s99, s99, 256
    s_mov_b64 exec, s[80:81]
    buffer_load_dwordx4 v77, s[4:7], s100 offen  lds
    s_mov_b64 exec, -1
    s_add_u32 s100, s100, 256
    v_mov_b32 v140, 1073741824
    v_lshlrev_b32 v141, 2, v0
    v_cmp_gt_u32 vcc, 64, v0
    s_nop 1
    v_cndmask_b32 v141, v140, v141, vcc
    v_mov_b32_e64 v140, 0
    s_lshl_b32 s97, s2, 8
    s_add_u32 s97, s97, 3473408
    buffer_store_dword v140, v141, s[16:19], s97 offen sc1
    v_mov_b32 v142, 1073741824
    v_lshlrev_b32 v143, 2, v0
    v_cmp_gt_u32 vcc, 16, v0
    s_nop 1
    v_cndmask_b32 v143, v142, v143, vcc
    v_mov_b32_e64 v142, -1
    s_lshl_b32 s97, s2, 6
    s_add_u32 s97, s97, 3457024
    buffer_store_dword v142, v143, s[16:19], s97 offen sc1
    v_mov_b32 v144, -1
    v_mov_b32 v145, -1
    v_mov_b32 v146, -1
    v_mov_b32 v147, -1
    v_lshlrev_b32 v148, 4, v0
    s_sub_u32 s88, s2, 0
    s_mul_i32 s88, s88, 20480
    s_min_u32 s88, s88, 5222400
    s_add_u32 s88, s88, 4194304
    buffer_store_dwordx4 v[144:147], v148, s[16:19], s88 offen sc1
    s_add_u32 s88, s88, 4096
    buffer_store_dwordx4 v[144:147], v148, s[16:19], s88 offen sc1
    s_add_u32 s88, s88, 4096
    buffer_store_dwordx4 v[144:147], v148, s[16:19], s88 offen sc1
    s_add_u32 s88, s88, 4096
    buffer_store_dwordx4 v[144:147], v148, s[16:19], s88 offen sc1
    s_add_u32 s88, s88, 4096
    buffer_store_dwordx4 v[144:147], v148, s[16:19], s88 offen sc1
    s_add_u32 m0, s92, 75520
    s_nop 0
    s_nop 0
    buffer_load_dwordx4 v73, s[4:7], s99 offen offset:0  lds
    buffer_load_dwordx4 v74, s[4:7], s99 offen offset:1088  lds
    buffer_load_dwordx4 v75, s[4:7], s99 offen offset:2176  lds
    buffer_load_dwordx4 v76, s[4:7], s99 offen offset:3264  lds
    s_add_u32 m0, s93, 92928
    s_add_u32 s99, s99, 256
    s_mov_b64 exec, s[80:81]
    buffer_load_dwordx4 v77, s[4:7], s100 offen  lds
    s_mov_b64 exec, -1
    s_add_u32 s100, s100, 256
    s_add_u32 m0, s92, 95104
    s_nop 0
    s_nop 0
    buffer_load_dwordx4 v73, s[4:7], s99 offen offset:0  lds
    buffer_load_dwordx4 v74, s[4:7], s99 offen offset:1088  lds
    buffer_load_dwordx4 v75, s[4:7], s99 offen offset:2176  lds
    buffer_load_dwordx4 v76, s[4:7], s99 offen offset:3264  lds
    s_add_u32 m0, s93, 112512
    s_add_u32 s99, s99, 256
    s_mov_b64 exec, s[80:81]
    buffer_load_dwordx4 v77, s[4:7], s100 offen  lds
    s_mov_b64 exec, -1
    s_add_u32 s100, s100, 256
    s_add_u32 m0, s92, 114688
    s_nop 0
    s_nop 0
    buffer_load_dwordx4 v73, s[4:7], s99 offen offset:0  lds
    buffer_load_dwordx4 v74, s[4:7], s99 offen offset:1088  lds
    buffer_load_dwordx4 v75, s[4:7], s99 offen offset:2176  lds
    buffer_load_dwordx4 v76, s[4:7], s99 offen offset:3264  lds
    s_add_u32 m0, s93, 132096
    s_add_u32 s99, s99, 256
    s_mov_b64 exec, s[80:81]
    buffer_load_dwordx4 v77, s[4:7], s100 offen  lds
    s_mov_b64 exec, -1
    s_add_u32 s100, s100, 256
    s_waitcnt vmcnt(15)
    buffer_load_dword v7, v4, s[16:19], s87 offen offset:0 sc1
    s_waitcnt vmcnt(0)
    v_cmp_gt_u32_e64 vcc, 32, v7
    s_nop 0
    s_and_b64 vcc, vcc, s[50:51]
    s_cbranch_scc1 ps_14
pc_16:
    s_barrier
    buffer_load_dwordx4 a[0:3], v200, s[16:19], s101 offen offset:0 sc1
    buffer_load_dwordx4 a[4:7], v200, s[16:19], s101 offen offset:1024 sc1
    buffer_load_dwordx4 a[8:11], v200, s[16:19], s101 offen offset:2048 sc1
    buffer_load_dwordx4 a[12:15], v200, s[16:19], s101 offen offset:3072 sc1
    s_add_u32 s101, s101, 4096
    buffer_load_dwordx4 a[16:19], v200, s[16:19], s101 offen offset:0 sc1
    buffer_load_dwordx4 a[20:23], v200, s[16:19], s101 offen offset:1024 sc1
    buffer_load_dwordx4 a[24:27], v200, s[16:19], s101 offen offset:2048 sc1
    buffer_load_dwordx4 a[28:31], v200, s[16:19], s101 offen offset:3072 sc1
    s_add_u32 s101, s101, 4096
    buffer_load_dwordx4 a[32:35], v200, s[16:19], s101 offen offset:0 sc1
    buffer_load_dwordx4 a[36:39], v200, s[16:19], s101 offen offset:1024 sc1
    buffer_load_dwordx4 a[40:43], v200, s[16:19], s101 offen offset:2048 sc1
    buffer_load_dwordx4 a[44:47], v200, s[16:19], s101 offen offset:3072 sc1
    s_add_u32 s101, s101, 4096
    buffer_load_dwordx4 a[48:51], v200, s[16:19], s101 offen offset:0 sc1
    buffer_load_dwordx4 a[52:55], v200, s[16:19], s101 offen offset:1024 sc1
ec_4:
    v_add_u32 v196, 36352, v78
    v_mov_b32 v198, v79
    v_xor_b32 v197, 32, v196
    s_waitcnt vmcnt(34)
    s_barrier
    s_add_u32 s82, s86, 16384
    v_lshlrev_b32 v2, 3, v4
    v_mov_b32 v5, 1
    v_cndmask_b32 v2, v4, v2, s[50:51]
    buffer_atomic_add v5, v2, s[16:19], s82 offen offset:8 sc1
    ds_read_b128 v[160:163], v198 offset:0
    ds_read_b128 v[164:167], v196 offset:0
    ds_read_b128 v[168:171], v196 offset:8704
    ds_read_b128 v[172:175], v198 offset:32
    ds_read_b128 v[176:179], v197 offset:0
    ds_read_b128 v[180:183], v197 offset:8704
    s_waitcnt lgkmcnt(3)
    s_waitcnt vmcnt(14)
    v_mfma_f32_16x16x32_bf16 v[112:115], a[0:3], v[160:163], 0
    ds_read_b128 v[184:187], v198 offset:64
    v_mfma_f32_32x32x16_bf16 v[80:95], a[0:3], v[164:167], 0
    ds_read_b128 v[188:191], v196 offset:64
    v_mov_b32 v208, 0
    v_mov_b32 v209, 0
    v_lshrrev_b32_e64 v210, 5, v0
    v_mul_u32_u24 v210, 1600, v210
    v_mfma_f32_32x32x16_bf16 v[96:111], a[0:3], v[168:171], 0
    ds_read_b128 v[192:195], v196 offset:8768
    buffer_load_dwordx4 a[56:59], v200, s[16:19], s101 offen offset:2048 sc1
    v_and_b32 v211, 31, v0
    v_min_u32 v211, 19, v211
    s_waitcnt lgkmcnt(3)
    s_waitcnt vmcnt(14)
    v_mfma_f32_16x16x32_bf16 v[112:115], a[4:7], v[172:175], v[112:115]
    ds_read_b128 v[160:163], v198 offset:96
    v_mfma_f32_32x32x16_bf16 v[80:95], a[4:7], v[176:179], v[80:95]
    ds_read_b128 v[164:167], v197 offset:64
    v_lshl_add_u32 v210, v211, 3, v210
    v_add_u32 v210, 6400, v210
    ds_write_b64 v210, v[208:209]
    s_mul_i32 s33, s24, 4160
    v_mfma_f32_32x32x16_bf16 v[96:111], a[4:7], v[180:183], v[96:111]
    ds_read_b128 v[168:171], v197 offset:8768
    buffer_load_dwordx4 a[60:63], v200, s[16:19], s101 offen offset:3072 sc1
    s_add_u32 s33, s33, 134272
    v_and_b32_e64 v250, 31, v1
    s_waitcnt lgkmcnt(4)
    s_waitcnt vmcnt(14)
    v_mfma_f32_16x16x32_bf16 v[112:115], a[8:11], v[184:187], v[112:115]
    ds_read_b128 v[172:175], v198 offset:128
    v_mfma_f32_32x32x16_bf16 v[80:95], a[8:11], v[188:191], v[80:95]
    ds_read_b128 v[176:179], v196 offset:128
    v_lshl_add_u32 v250, v250, 4, s33
    v_lshrrev_b32_e64 v253, 5, v1
    v_lshl_add_u32 v251, v253, 3, v250
    v_lshl_add_u32 v252, v253, 9, v250
    v_mfma_f32_32x32x16_bf16 v[96:111], a[8:11], v[192:195], v[96:111]
    ds_read_b128 v[180:183], v196 offset:8832
    s_add_u32 s101, s101, 4096
    buffer_load_dwordx4 a[64:67], v200, s[16:19], s101 offen offset:0 sc1
    v_lshl_add_u32 v250, v253, 10, v250
    s_waitcnt lgkmcnt(3)
    s_waitcnt vmcnt(14)
    v_mfma_f32_16x16x32_bf16 v[112:115], a[12:15], v[160:163], v[112:115]
    ds_read_b128 v[184:187], v198 offset:160
    v_mfma_f32_32x32x16_bf16 v[80:95], a[12:15], v[164:167], v[80:95]
    ds_read_b128 v[188:191], v197 offset:128
    v_cmp_eq_u32 vcc, 0, v1
    v_lshlrev_b32 v254, 16, v241
    v_min_u32 v253, 15, v1
    v_cndmask_b32 v254, 0, v254, vcc
    v_mfma_f32_32x32x16_bf16 v[96:111], a[12:15], v[168:171], v[96:111]
    ds_read_b128 v[192:195], v197 offset:8832
    buffer_load_dwordx4 a[68:71], v200, s[16:19], s101 offen offset:1024 sc1
    v_lshl_add_u32 v253, v253, 2, s33
    v_add_f32_e64 v216, v216, v254
    s_waitcnt lgkmcnt(3)
    s_waitcnt vmcnt(14)
    v_mfma_f32_16x16x32_bf16 v[112:115], a[16:19], v[172:175], v[112:115]
    ds_read_b128 v[160:163], v198 offset:192
    v_mfma_f32_32x32x16_bf16 v[80:95], a[16:19], v[176:179], v[80:95]
    ds_read_b128 v[164:167], v196 offset:192
    v_and_b32 v254, 1, v1
    v_cmp_eq_u32 vcc, 1, v254
    v_mov_b32_e64 v254, 0
    v_cvt_pk_bf16_f32 v242, v216, v217
    v_mfma_f32_32x32x16_bf16 v[96:111], a[16:19], v[180:183], v[96:111]
    ds_read_b128 v[168:171], v196 offset:8896
    buffer_load_dwordx4 a[72:75], v200, s[16:19], s101 offen offset:2048 sc1
    v_cvt_pk_bf16_f32 v243, v218, v219
    v_cvt_pk_bf16_f32 v244, v220, v220
    s_waitcnt lgkmcnt(3)
    s_waitcnt vmcnt(14)
    v_mfma_f32_16x16x32_bf16 v[112:115], a[20:23], v[184:187], v[112:115]
    ds_read_b128 v[172:175], v198 offset:224
    v_mfma_f32_32x32x16_bf16 v[80:95], a[20:23], v[188:191], v[80:95]
    ds_read_b128 v[176:179], v197 offset:192
    v_cvt_pk_bf16_f32 v245, v221, v222
    v_cvt_pk_bf16_f32 v246, v224, v224
    v_cvt_pk_bf16_f32 v247, v224, v225
    v_cvt_pk_bf16_f32 v248, v225, v225
    v_mfma_f32_32x32x16_bf16 v[96:111], a[20:23], v[192:195], v[96:111]
    ds_read_b128 v[180:183], v197 offset:8896
    buffer_load_dwordx4 a[76:79], v200, s[16:19], s101 offen offset:3072 sc1
    v_cvt_pk_bf16_f32 v249, v226, v226
    ds_write_b32 v253, v254
    s_barrier
    s_waitcnt lgkmcnt(4)
    s_waitcnt vmcnt(14)
    v_mfma_f32_16x16x32_bf16 v[112:115], a[24:27], v[160:163], v[112:115]
    v_add_u32 v198, v49, v198
    v_mfma_f32_32x32x16_bf16 v[80:95], a[24:27], v[164:167], v[80:95]
    v_add_u32 v196, 19584, v196
    v_add_u32 v197, 19584, v197
    ds_read_b128 v[184:187], v198 offset:0
    ds_write_b64 v251, v[242:243] offset:64
    ds_write_b64 v251, v[244:245] offset:576
    v_mfma_f32_32x32x16_bf16 v[96:111], a[24:27], v[168:171], v[96:111]
    ds_read_b128 v[188:191], v196 offset:0
    ds_read_b128 v[192:195], v196 offset:8704
    s_add_u32 s101, s101, 4096
    buffer_load_dwordx4 a[80:83], v200, s[16:19], s101 offen offset:0 sc1
    s_waitcnt lgkmcnt(6)
    s_waitcnt vmcnt(14)
    v_mfma_f32_16x16x32_bf16 v[112:115], a[28:31], v[172:175], v[112:115]
    ds_read_b128 v[160:163], v198 offset:32
    v_mfma_f32_32x32x16_bf16 v[80:95], a[28:31], v[176:179], v[80:95]
    ds_read_b128 v[164:167], v197 offset:0
    ds_write_b128 v252, v[246:249] offset:1088
    v_cndmask_b32 v255, v228, v229, vcc
    v_cvt_pk_bf16_f32 v216, v228, v228
    v_mov_b32 v217, v216
    v_mfma_f32_32x32x16_bf16 v[96:111], a[28:31], v[180:183], v[96:111]
    ds_read_b128 v[168:171], v197 offset:8704
    buffer_load_dwordx4 a[84:87], v200, s[16:19], s101 offen offset:1024 sc1
    v_cvt_pk_bf16_f32 v218, v255, v229
    v_cvt_pk_bf16_f32 v219, v229, v229
    s_waitcnt lgkmcnt(4)
    s_waitcnt vmcnt(14)
    v_mfma_f32_16x16x32_bf16 v[112:115], a[32:35], v[184:187], v[112:115]
    ds_read_b128 v[172:175], v198 offset:64
    v_mfma_f32_32x32x16_bf16 v[80:95], a[32:35], v[188:191], v[80:95]
    ds_read_b128 v[176:179], v196 offset:64
    ds_write_b128 v250, v[216:219] offset:2112
    v_cndmask_b32 v255, v230, v231, vcc
    v_cvt_pk_bf16_f32 v220, v230, v230
    v_mov_b32 v221, v220
    v_mfma_f32_32x32x16_bf16 v[96:111], a[32:35], v[192:195], v[96:111]
    ds_read_b128 v[180:183], v196 offset:8768
    buffer_load_dwordx4 a[88:91], v200, s[16:19], s101 offen offset:2048 sc1
    v_cvt_pk_bf16_f32 v222, v255, v231
    v_cvt_pk_bf16_f32 v223, v231, v231
    s_waitcnt lgkmcnt(4)
    s_waitcnt vmcnt(14)
    v_mfma_f32_16x16x32_bf16 v[112:115], a[36:39], v[160:163], v[112:115]
    ds_read_b128 v[184:187], v198 offset:96
    v_mfma_f32_32x32x16_bf16 v[80:95], a[36:39], v[164:167], v[80:95]
    ds_read_b128 v[188:191], v197 offset:64
    ds_write_b128 v250, v[220:223] offset:2624
    v_mfma_f32_32x32x16_bf16 v[96:111], a[36:39], v[168:171], v[96:111]
    ds_read_b128 v[192:195], v197 offset:8768
    buffer_load_dwordx4 a[92:95], v200, s[16:19], s101 offen offset:3072 sc1
    s_waitcnt lgkmcnt(4)
    s_waitcnt vmcnt(14)
    v_mfma_f32_16x16x32_bf16 v[112:115], a[40:43], v[172:175], v[112:115]
    ds_read_b128 v[160:163], v198 offset:128
    v_mfma_f32_32x32x16_bf16 v[80:95], a[40:43], v[176:179], v[80:95]
    ds_read_b128 v[164:167], v196 offset:128
    v_mfma_f32_32x32x16_bf16 v[96:111], a[40:43], v[180:183], v[96:111]
    ds_read_b128 v[168:171], v196 offset:8832
    s_add_u32 s101, s101, 4096
    buffer_load_dwordx4 a[96:99], v200, s[16:19], s101 offen offset:0 sc1
    s_waitcnt lgkmcnt(3)
    s_waitcnt vmcnt(14)
    v_mfma_f32_16x16x32_bf16 v[112:115], a[44:47], v[184:187], v[112:115]
    ds_read_b128 v[172:175], v198 offset:160
    v_mfma_f32_32x32x16_bf16 v[80:95], a[44:47], v[188:191], v[80:95]
    ds_read_b128 v[176:179], v197 offset:128
    v_mfma_f32_32x32x16_bf16 v[96:111], a[44:47], v[192:195], v[96:111]
    ds_read_b128 v[180:183], v197 offset:8832
    buffer_load_dwordx4 a[100:103], v200, s[16:19], s101 offen offset:1024 sc1
    s_waitcnt lgkmcnt(3)
    s_waitcnt vmcnt(14)
    v_mfma_f32_16x16x32_bf16 v[112:115], a[48:51], v[160:163], v[112:115]
    ds_read_b128 v[184:187], v198 offset:192
    v_mfma_f32_32x32x16_bf16 v[80:95], a[48:51], v[164:167], v[80:95]
    ds_read_b128 v[188:191], v196 offset:192
    v_mfma_f32_32x32x16_bf16 v[96:111], a[48:51], v[168:171], v[96:111]
    ds_read_b128 v[192:195], v196 offset:8896
    buffer_load_dwordx4 a[104:107], v200, s[16:19], s101 offen offset:2048 sc1
    s_waitcnt lgkmcnt(3)
    s_waitcnt vmcnt(14)
    v_mfma_f32_16x16x32_bf16 v[112:115], a[52:55], v[172:175], v[112:115]
    ds_read_b128 v[160:163], v198 offset:224
    v_mfma_f32_32x32x16_bf16 v[80:95], a[52:55], v[176:179], v[80:95]
    ds_read_b128 v[164:167], v197 offset:192
    v_mfma_f32_32x32x16_bf16 v[96:111], a[52:55], v[180:183], v[96:111]
    ds_read_b128 v[168:171], v197 offset:8896
    buffer_load_dwordx4 a[108:111], v200, s[16:19], s101 offen offset:3072 sc1
    s_barrier
    s_waitcnt lgkmcnt(3)
    s_waitcnt vmcnt(13)
    v_mfma_f32_16x16x32_bf16 v[112:115], a[56:59], v[184:187], v[112:115]
    v_add_u32 v198, v49, v198
    v_mfma_f32_32x32x16_bf16 v[80:95], a[56:59], v[188:191], v[80:95]
    v_add_u32 v196, 19584, v196
    v_add_u32 v197, 19584, v197
    ds_read_b128 v[172:175], v198 offset:0
    v_mfma_f32_32x32x16_bf16 v[96:111], a[56:59], v[192:195], v[96:111]
    ds_read_b128 v[176:179], v196 offset:0
    ds_read_b128 v[180:183], v196 offset:8704
    s_add_u32 s101, s101, 4096
    buffer_load_dwordx4 a[112:115], v200, s[16:19], s101 offen offset:0 sc1
    s_waitcnt lgkmcnt(3)
    s_waitcnt vmcnt(13)
    v_mfma_f32_16x16x32_bf16 v[112:115], a[60:63], v[160:163], v[112:115]
    ds_read_b128 v[184:187], v198 offset:32
    v_mfma_f32_32x32x16_bf16 v[80:95], a[60:63], v[164:167], v[80:95]
    ds_read_b128 v[188:191], v197 offset:0
    v_mfma_f32_32x32x16_bf16 v[96:111], a[60:63], v[168:171], v[96:111]
    ds_read_b128 v[192:195], v197 offset:8704
    buffer_load_dwordx4 a[116:119], v200, s[16:19], s101 offen offset:1024 sc1
    s_waitcnt lgkmcnt(3)
    s_waitcnt vmcnt(13)
    v_mfma_f32_16x16x32_bf16 v[112:115], a[64:67], v[172:175], v[112:115]
    ds_read_b128 v[160:163], v198 offset:64
    v_mfma_f32_32x32x16_bf16 v[80:95], a[64:67], v[176:179], v[80:95]
    ds_read_b128 v[164:167], v196 offset:64
    v_mfma_f32_32x32x16_bf16 v[96:111], a[64:67], v[180:183], v[96:111]
    ds_read_b128 v[168:171], v196 offset:8768
    buffer_load_dwordx4 a[120:123], v200, s[16:19], s101 offen offset:2048 sc1
    s_waitcnt lgkmcnt(3)
    s_waitcnt vmcnt(13)
    v_mfma_f32_16x16x32_bf16 v[112:115], a[68:71], v[184:187], v[112:115]
    ds_read_b128 v[172:175], v198 offset:96
    v_mfma_f32_32x32x16_bf16 v[80:95], a[68:71], v[188:191], v[80:95]
    ds_read_b128 v[176:179], v197 offset:64
    v_mfma_f32_32x32x16_bf16 v[96:111], a[68:71], v[192:195], v[96:111]
    ds_read_b128 v[180:183], v197 offset:8768
    buffer_load_dwordx4 a[124:127], v200, s[16:19], s101 offen offset:3072 sc1
    s_waitcnt lgkmcnt(3)
    s_waitcnt vmcnt(13)
    v_mfma_f32_16x16x32_bf16 v[112:115], a[72:75], v[160:163], v[112:115]
    ds_read_b128 v[184:187], v198 offset:128
    v_mfma_f32_32x32x16_bf16 v[80:95], a[72:75], v[164:167], v[80:95]
    ds_read_b128 v[188:191], v196 offset:128
    v_mfma_f32_32x32x16_bf16 v[96:111], a[72:75], v[168:171], v[96:111]
    ds_read_b128 v[192:195], v196 offset:8832
    s_add_u32 s101, s101, 4096
    buffer_load_dwordx4 a[128:131], v200, s[16:19], s101 offen offset:0 sc1
    s_waitcnt lgkmcnt(3)
    s_waitcnt vmcnt(13)
    v_mfma_f32_16x16x32_bf16 v[112:115], a[76:79], v[172:175], v[112:115]
    ds_read_b128 v[160:163], v198 offset:160
    v_mfma_f32_32x32x16_bf16 v[80:95], a[76:79], v[176:179], v[80:95]
    ds_read_b128 v[164:167], v197 offset:128
    v_mfma_f32_32x32x16_bf16 v[96:111], a[76:79], v[180:183], v[96:111]
    ds_read_b128 v[168:171], v197 offset:8832
    buffer_load_dwordx4 a[132:135], v200, s[16:19], s101 offen offset:1024 sc1
    s_waitcnt lgkmcnt(3)
    s_waitcnt vmcnt(13)
    v_mfma_f32_16x16x32_bf16 v[112:115], a[80:83], v[184:187], v[112:115]
    ds_read_b128 v[172:175], v198 offset:192
    v_mfma_f32_32x32x16_bf16 v[80:95], a[80:83], v[188:191], v[80:95]
    ds_read_b128 v[176:179], v196 offset:192
    v_mfma_f32_32x32x16_bf16 v[96:111], a[80:83], v[192:195], v[96:111]
    ds_read_b128 v[180:183], v196 offset:8896
    buffer_load_dwordx4 a[136:139], v200, s[16:19], s101 offen offset:2048 sc1
    s_waitcnt lgkmcnt(3)
    s_waitcnt vmcnt(13)
    v_mfma_f32_16x16x32_bf16 v[112:115], a[84:87], v[160:163], v[112:115]
    ds_read_b128 v[184:187], v198 offset:224
    v_mfma_f32_32x32x16_bf16 v[80:95], a[84:87], v[164:167], v[80:95]
    ds_read_b128 v[188:191], v197 offset:192
    v_mfma_f32_32x32x16_bf16 v[96:111], a[84:87], v[168:171], v[96:111]
    ds_read_b128 v[192:195], v197 offset:8896
    buffer_load_dwordx4 a[140:143], v200, s[16:19], s101 offen offset:3072 sc1
    s_barrier
    s_waitcnt lgkmcnt(3)
    s_waitcnt vmcnt(13)
    v_mfma_f32_16x16x32_bf16 v[112:115], a[88:91], v[172:175], v[112:115]
    v_add_u32 v198, v49, v198
    v_mfma_f32_32x32x16_bf16 v[80:95], a[88:91], v[176:179], v[80:95]
    v_add_u32 v196, 19584, v196
    v_add_u32 v197, 19584, v197
    ds_read_b128 v[160:163], v198 offset:0
    v_mfma_f32_32x32x16_bf16 v[96:111], a[88:91], v[180:183], v[96:111]
    ds_read_b128 v[164:167], v196 offset:0
    ds_read_b128 v[168:171], v196 offset:8704
    s_add_u32 s101, s101, 4096
    buffer_load_dword v7, v4, s[16:19], s89 offen offset:8 sc1
    s_waitcnt lgkmcnt(3)
    s_waitcnt vmcnt(13)
    v_mfma_f32_16x16x32_bf16 v[112:115], a[92:95], v[184:187], v[112:115]
    ds_read_b128 v[172:175], v198 offset:32
    v_mfma_f32_32x32x16_bf16 v[80:95], a[92:95], v[188:191], v[80:95]
    ds_read_b128 v[176:179], v197 offset:0
    v_mfma_f32_32x32x16_bf16 v[96:111], a[92:95], v[192:195], v[96:111]
    ds_read_b128 v[180:183], v197 offset:8704
    buffer_load_dwordx4 a[144:147], v200, s[16:19], s101 offen offset:0 sc1
    s_waitcnt lgkmcnt(3)
    s_waitcnt vmcnt(13)
    v_mfma_f32_16x16x32_bf16 v[112:115], a[96:99], v[160:163], v[112:115]
    ds_read_b128 v[184:187], v198 offset:64
    v_mfma_f32_32x32x16_bf16 v[80:95], a[96:99], v[164:167], v[80:95]
    ds_read_b128 v[188:191], v196 offset:64
    v_mfma_f32_32x32x16_bf16 v[96:111], a[96:99], v[168:171], v[96:111]
    ds_read_b128 v[192:195], v196 offset:8768
    buffer_load_dwordx4 a[148:151], v200, s[16:19], s101 offen offset:1024 sc1
    s_waitcnt lgkmcnt(3)
    s_waitcnt vmcnt(13)
    v_mfma_f32_16x16x32_bf16 v[112:115], a[100:103], v[172:175], v[112:115]
    ds_read_b128 v[160:163], v198 offset:96
    v_mfma_f32_32x32x16_bf16 v[80:95], a[100:103], v[176:179], v[80:95]
    ds_read_b128 v[164:167], v197 offset:64
    v_mfma_f32_32x32x16_bf16 v[96:111], a[100:103], v[180:183], v[96:111]
    ds_read_b128 v[168:171], v197 offset:8768
    buffer_load_dwordx4 a[152:155], v200, s[16:19], s101 offen offset:2048 sc1
    s_waitcnt lgkmcnt(3)
    s_waitcnt vmcnt(13)
    v_mfma_f32_16x16x32_bf16 v[112:115], a[104:107], v[184:187], v[112:115]
    ds_read_b128 v[172:175], v198 offset:128
    v_mfma_f32_32x32x16_bf16 v[80:95], a[104:107], v[188:191], v[80:95]
    ds_read_b128 v[176:179], v196 offset:128
    v_mfma_f32_32x32x16_bf16 v[96:111], a[104:107], v[192:195], v[96:111]
    ds_read_b128 v[180:183], v196 offset:8832
    buffer_load_dwordx4 a[156:159], v200, s[16:19], s101 offen offset:3072 sc1
    s_waitcnt lgkmcnt(3)
    s_waitcnt vmcnt(13)
    v_mfma_f32_16x16x32_bf16 v[112:115], a[108:111], v[160:163], v[112:115]
    ds_read_b128 v[184:187], v198 offset:160
    v_mfma_f32_32x32x16_bf16 v[80:95], a[108:111], v[164:167], v[80:95]
    ds_read_b128 v[188:191], v197 offset:128
    v_mfma_f32_32x32x16_bf16 v[96:111], a[108:111], v[168:171], v[96:111]
    ds_read_b128 v[192:195], v197 offset:8832
    s_add_u32 s101, s101, 4096
    s_lshl_b32 s25, s72, 5
    s_add_u32 s25, s25, 256
    s_sub_u32 s26, s25, 4
    s_max_i32 s26, s26, 0
    s_mul_i32 s27, s71, 1280
    s_mul_i32 s99, s25, 5120
    s_mul_i32 s100, s26, 5120
    s_mul_i32 s92, s24, 4352
    s_mul_i32 s93, s24, 544
    s_add_u32 s99, s99, s27
    s_add_u32 s100, s100, s27
    s_waitcnt lgkmcnt(3)
    s_waitcnt vmcnt(12)
    v_mfma_f32_16x16x32_bf16 v[112:115], a[112:115], v[172:175], v[112:115]
    ds_read_b128 v[160:163], v198 offset:192
    v_mfma_f32_32x32x16_bf16 v[80:95], a[112:115], v[176:179], v[80:95]
    ds_read_b128 v[164:167], v196 offset:192
    v_mfma_f32_32x32x16_bf16 v[96:111], a[112:115], v[180:183], v[96:111]
    ds_read_b128 v[168:171], v196 offset:8896
    s_waitcnt lgkmcnt(3)
    s_waitcnt vmcnt(11)
    v_mfma_f32_16x16x32_bf16 v[112:115], a[116:119], v[184:187], v[112:115]
    ds_read_b128 v[172:175], v198 offset:224
    v_mfma_f32_32x32x16_bf16 v[80:95], a[116:119], v[188:191], v[80:95]
    ds_read_b128 v[176:179], v197 offset:192
    v_mfma_f32_32x32x16_bf16 v[96:111], a[116:119], v[192:195], v[96:111]
    ds_read_b128 v[180:183], v197 offset:8896
    s_waitcnt vmcnt(4)
    v_cmp_gt_u32 vcc, 32, v7
    s_nop 0
    s_and_b64 vcc, vcc, s[50:51]
    s_cbranch_scc1 ps_17
pc_19:
    s_barrier
    s_waitcnt lgkmcnt(3)
    v_mfma_f32_16x16x32_bf16 v[112:115], a[120:123], v[160:163], v[112:115]
    v_add_u32_e64 v198, v49, v198
    v_mfma_f32_32x32x16_bf16 v[80:95], a[120:123], v[164:167], v[80:95]
    v_add_u32 v196, 19584, v196
    v_add_u32 v197, 19584, v197
    s_lshl_b32 s31, s24, 7
    s_add_u32 s31, s31, 160768
    v_bfe_u32 v132, v1, 3, 1
    v_mfma_f32_32x32x16_bf16 v[96:111], a[120:123], v[168:171], v[96:111]
    ds_read_b128 v[184:187], v198 offset:0
    ds_read_b128 v[188:191], v196 offset:0
    s_lshl_b32 s98, s72, 5
    s_add_u32 s98, s98, 0
    s_sub_u32 s95, s98, 4
    s_max_i32 s95, s95, 0
    s_lshl_b32 s94, s98, 3
    s_lshl_b32 s95, s95, 3
    s_add_u32 s94, s94, 3440640
    s_add_u32 s95, s95, 3440640
    s_add_u32 s96, s94, 8192
    buffer_load_dwordx2 v[152:153], v47, s[16:19], s94 offen sc1
    v_lshrrev_b32 v133, 4, v1
    v_lshl_add_u32 v132, v132, 2, v133
    s_waitcnt lgkmcnt(2)
    v_mfma_f32_16x16x32_bf16 v[112:115], a[124:127], v[172:175], v[112:115]
    ds_read_b128 v[192:195], v198 offset:32
    v_mfma_f32_32x32x16_bf16 v[80:95], a[124:127], v[176:179], v[80:95]
    ds_read_b128 v[160:163], v197 offset:0
    v_lshl_add_u32 v132, v132, 4, s31
    v_lshrrev_b32 v133, 5, v1
    v_lshl_add_u32 v133, v133, 4, s31
    v_mfma_f32_32x32x16_bf16 v[96:111], a[124:127], v[180:183], v[96:111]
    buffer_load_dwordx2 v[154:155], v47, s[16:19], s96 offen sc1
    s_waitcnt lgkmcnt(2)
    v_mfma_f32_16x16x32_bf16 v[112:115], a[128:131], v[184:187], v[112:115]
    ds_read_b128 v[164:167], v198 offset:64
    v_mfma_f32_32x32x16_bf16 v[80:95], a[128:131], v[188:191], v[80:95]
    ds_read_b128 v[168:171], v196 offset:64
    s_waitcnt lgkmcnt(2)
    v_mfma_f32_16x16x32_bf16 v[112:115], a[132:135], v[192:195], v[112:115]
    ds_read_b128 v[172:175], v198 offset:96
    v_mfma_f32_32x32x16_bf16 v[80:95], a[132:135], v[160:163], v[80:95]
    ds_read_b128 v[176:179], v197 offset:64
    buffer_load_dwordx2 v[156:157], v48, s[16:19], s95 offen sc1
    s_waitcnt lgkmcnt(2)
    v_mfma_f32_16x16x32_bf16 v[112:115], a[136:139], v[164:167], v[112:115]
    ds_read_b128 v[180:183], v198 offset:128
    v_mfma_f32_32x32x16_bf16 v[80:95], a[136:139], v[168:171], v[80:95]
    ds_read_b128 v[184:187], v196 offset:128
    s_waitcnt lgkmcnt(2)
    v_mfma_f32_16x16x32_bf16 v[112:115], a[140:143], v[172:175], v[112:115]
    ds_read_b128 v[188:191], v198 offset:160
    v_mfma_f32_32x32x16_bf16 v[80:95], a[140:143], v[176:179], v[80:95]
    ds_read_b128 v[192:195], v197 offset:128
    s_add_u32 m0, s92, 36352
    s_nop 0
    buffer_load_dwordx4 v73, s[4:7], s99 offen offset:0  lds
    s_waitcnt lgkmcnt(2)
    s_waitcnt vmcnt(7)
    v_mfma_f32_16x16x32_bf16 v[112:115], a[144:147], v[180:183], v[112:115]
    ds_read_b128 v[160:163], v198 offset:192
    v_mfma_f32_32x32x16_bf16 v[80:95], a[144:147], v[184:187], v[80:95]
    ds_read_b128 v[164:167], v196 offset:192
    s_waitcnt lgkmcnt(2)
    s_waitcnt vmcnt(6)
    v_mfma_f32_16x16x32_bf16 v[112:115], a[148:151], v[188:191], v[112:115]
    ds_read_b128 v[168:171], v198 offset:224
    v_mfma_f32_32x32x16_bf16 v[80:95], a[148:151], v[192:195], v[80:95]
    ds_read_b128 v[172:175], v197 offset:192
    buffer_load_dwordx4 v74, s[4:7], s99 offen offset:1088  lds
    s_waitcnt lgkmcnt(2)
    s_waitcnt vmcnt(6)
    v_mfma_f32_16x16x32_bf16 v[112:115], a[152:155], v[160:163], v[112:115]
    ds_read_b128 v[176:179], v196 offset:8704
    v_mfma_f32_32x32x16_bf16 v[80:95], a[152:155], v[164:167], v[80:95]
    ds_read_b128 v[180:183], v197 offset:8704
    s_waitcnt lgkmcnt(2)
    s_waitcnt vmcnt(5)
    v_mfma_f32_16x16x32_bf16 v[112:115], a[156:159], v[168:171], v[112:115]
    ds_read_b128 v[184:187], v196 offset:8768
    v_mfma_f32_32x32x16_bf16 v[80:95], a[156:159], v[172:175], v[80:95]
    ds_read_b128 v[188:191], v197 offset:8768
    buffer_load_dwordx4 v75, s[4:7], s99 offen offset:2176  lds
    s_waitcnt lgkmcnt(2)
    v_mfma_f32_32x32x16_bf16 v[96:111], a[128:131], v[176:179], v[96:111]
    ds_read_b128 v[192:195], v196 offset:8832
    v_mfma_f32_32x32x16_bf16 v[96:111], a[132:135], v[180:183], v[96:111]
    ds_read_b128 v[160:163], v197 offset:8832
    buffer_load_dwordx4 v76, s[4:7], s99 offen offset:3264  lds
    s_mov_b32 exec_lo, 0x01010101
    s_mov_b32 exec_hi, 0x01010101
    ds_write_b128 v132, v[112:115]
    s_mov_b64 exec, -1
    s_waitcnt lgkmcnt(3)
    v_mfma_f32_32x32x16_bf16 v[96:111], a[136:139], v[184:187], v[96:111]
    ds_read_b128 v[164:167], v196 offset:8896
    ds_read_b128 v[24:27], v132
    ds_read_b128 v[8:11], v133 offset:0
    ds_read_b128 v[12:15], v133 offset:32
    ds_read_b128 v[16:19], v133 offset:64
    v_mfma_f32_32x32x16_bf16 v[96:111], a[140:143], v[188:191], v[96:111]
    ds_read_b128 v[168:171], v197 offset:8896
    s_add_u32 m0, s93, 53760
    s_add_u32 s99, s99, 256
    s_mov_b64 exec, s[80:81]
    buffer_load_dwordx4 v77, s[4:7], s100 offen  lds
    s_mov_b64 exec, -1
    s_add_u32 s100, s100, 256
    ds_read_b128 v[20:23], v133 offset:96
    s_waitcnt vmcnt(5) lgkmcnt(5)
    v_mul_f32 v148, v24, v157
    v_mfma_f32_32x32x16_bf16 v[96:111], a[144:147], v[192:195], v[96:111]
    v_mul_f32 v149, v25, v157
    v_mul_f32 v150, v26, v157
    v_mul_f32 v151, v27, v157
    s_waitcnt lgkmcnt(4)
    v_mul_f32 v116, v8, v153
    v_mul_f32 v117, v9, v153
    v_mfma_f32_32x32x16_bf16 v[96:111], a[148:151], v[160:163], v[96:111]
    v_mul_f32 v118, v10, v153
    v_mul_f32 v119, v11, v153
    s_waitcnt lgkmcnt(3)
    v_mul_f32 v120, v12, v153
    v_mul_f32 v121, v13, v153
    s_waitcnt lgkmcnt(1)
    v_mfma_f32_32x32x16_bf16 v[96:111], a[152:155], v[164:167], v[96:111]
    v_mul_f32 v122, v14, v153
    v_mul_f32 v123, v15, v153
    v_mul_f32 v124, v16, v153
    v_mul_f32 v125, v17, v153
    v_mul_f32_e64 v126, v18, v153
    v_mfma_f32_32x32x16_bf16 v[96:111], a[156:159], v[168:171], v[96:111]
    s_add_u32 m0, s92, 55936
    s_nop 0
    buffer_load_dwordx4 v73, s[4:7], s99 offen offset:0  lds
    v_mul_f32 v127, v19, v153
    s_waitcnt lgkmcnt(0)
    v_mul_f32 v128, v20, v153
    v_mul_f32 v129, v21, v153
    v_mul_f32 v130, v22, v153
    v_mul_f32_e64 v131, v23, v153
    v_fma_f32 v112, v112, v156, v148
    v_fma_f32 v113, v113, v156, v149
    v_fma_f32 v114, v114, v156, v150
    v_fma_f32 v115, v115, v156, v151
    v_cvt_pk_bf16_f32 v112, v112, v113
    v_cvt_pk_bf16_f32 v113, v114, v115
    v_fma_f32 v80, v80, v152, v116
    v_fma_f32 v81, v81, v152, v117
    v_fma_f32 v82, v82, v152, v118
    v_fma_f32 v83, v83, v152, v119
    v_cvt_pk_bf16_f32 v80, v80, v81
    v_cvt_pk_bf16_f32 v81, v82, v83
    ds_write_b64 v40, v[112:113] offset:0
    ds_write_b64 v38, v[80:81] offset:0
    v_fma_f32 v84, v84, v152, v120
    v_fma_f32 v85, v85, v152, v121
    v_fma_f32 v86, v86, v152, v122
    v_fma_f32 v87, v87, v152, v123
    v_cvt_pk_bf16_f32 v84, v84, v85
    v_cvt_pk_bf16_f32 v85, v86, v87
    v_fma_f32 v88, v88, v152, v124
    v_fma_f32 v89, v89, v152, v125
    v_fma_f32 v90, v90, v152, v126
    v_fma_f32 v91, v91, v152, v127
    v_cvt_pk_bf16_f32 v88, v88, v89
    v_cvt_pk_bf16_f32 v89, v90, v91
    ds_write_b64 v38, v[84:85] offset:6400
    ds_write_b64 v38, v[88:89] offset:12800
    v_fma_f32 v92, v92, v152, v128
    v_fma_f32 v93, v93, v152, v129
    v_fma_f32 v94, v94, v152, v130
    v_fma_f32 v95, v95, v152, v131
    v_cvt_pk_bf16_f32 v92, v92, v93
    v_cvt_pk_bf16_f32 v93, v94, v95
    ds_write_b64 v39, v[92:93] offset:0
    v_mul_f32 v132, v8, v155
    v_mul_f32 v133, v9, v155
    v_mul_f32 v134, v10, v155
    v_mul_f32 v135, v11, v155
    v_mul_f32 v136, v12, v155
    v_mul_f32 v137, v13, v155
    v_mul_f32 v138, v14, v155
    v_mul_f32 v139, v15, v155
    v_mul_f32 v140, v16, v155
    v_mul_f32 v141, v17, v155
    v_mul_f32 v142, v18, v155
    v_mul_f32 v143, v19, v155
    v_mul_f32 v144, v20, v155
    v_mul_f32 v145, v21, v155
    v_mul_f32 v146, v22, v155
    v_mul_f32 v147, v23, v155
    v_pk_fma_f32 v[96:97], v[96:97], v[154:155], v[132:133] op_sel_hi:[1,0,1]
    v_pk_fma_f32 v[98:99], v[98:99], v[154:155], v[134:135] op_sel_hi:[1,0,1]
    v_cvt_pk_bf16_f32 v96, v96, v97
    v_cvt_pk_bf16_f32 v97, v98, v99
    v_pk_fma_f32 v[100:101], v[100:101], v[154:155], v[136:137] op_sel_hi:[1,0,1]
    v_pk_fma_f32 v[102:103], v[102:103], v[154:155], v[138:139] op_sel_hi:[1,0,1]
    v_cvt_pk_bf16_f32 v100, v100, v101
    v_cvt_pk_bf16_f32 v101, v102, v103
    ds_write_b64 v38, v[96:97] offset:1600
    ds_write_b64 v38, v[100:101] offset:8000
    v_pk_fma_f32 v[104:105], v[104:105], v[154:155], v[140:141] op_sel_hi:[1,0,1]
    v_pk_fma_f32 v[106:107], v[106:107], v[154:155], v[142:143] op_sel_hi:[1,0,1]
    v_cvt_pk_bf16_f32 v104, v104, v105
    v_cvt_pk_bf16_f32 v105, v106, v107
    v_pk_fma_f32 v[108:109], v[108:109], v[154:155], v[144:145] op_sel_hi:[1,0,1]
    v_pk_fma_f32 v[110:111], v[110:111], v[154:155], v[146:147] op_sel_hi:[1,0,1]
    v_cvt_pk_bf16_f32 v108, v108, v109
    v_cvt_pk_bf16_f32 v109, v110, v111
    ds_write_b64 v38, v[104:105] offset:14400
    ds_write_b64 v39, v[108:109] offset:1600
    s_waitcnt lgkmcnt(0)
    s_barrier
    v_mov_b32 v94, 0
    v_mov_b32 v95, 0
    v_mov_b32 v98, 0
    v_mov_b32 v99, 0
    s_mov_b64 exec, 0xffff
    ds_read_b64 v[94:95], v42 offset:320
    ds_read_b64 v[98:99], v42 offset:640
    s_mov_b64 exec, -1
    s_nop 0
    ds_read_b64 v[92:93], v41 offset:320
    ds_read_b64 v[96:97], v41 offset:640
    ds_read_b64 v[84:85], v41 offset:6720
    ds_read_b64 v[86:87], v42 offset:6720
    ds_read_b64 v[80:81], v41 offset:6400
    ds_read_b64 v[82:83], v42 offset:6400
    ds_read_b64 v[88:89], v41 offset:7040
    ds_read_b64 v[90:91], v42 offset:7040
    ds_read_b64_tr_b16 v[106:107], v44 offset:0
    ds_read_b64_tr_b16 v[100:101], v43 offset:0
    ds_read_b64_tr_b16 v[108:109], v44 offset:320
    ds_read_b64_tr_b16 v[102:103], v43 offset:320
    buffer_load_dwordx4 v74, s[4:7], s99 offen offset:1088  lds
    ds_read_b64_tr_b16 v[110:111], v44 offset:640
    ds_read_b64_tr_b16 v[104:105], v43 offset:640
    v_mov_b32 v156, 0xf149f2ca
    v_cndmask_b32 v152, v32, v156, s[90:91]
    v_cndmask_b32 v153, v33, v156, s[90:91]
    v_cndmask_b32 v154, v34, v156, s[90:91]
    v_cndmask_b32 v155, v35, v156, s[90:91]
    s_mov_b32 s82, 0x3ea52b5c
    buffer_load_dwordx4 v75, s[4:7], s99 offen offset:2176  lds
    s_lshl_b32 s25, s98, 4
    s_add_u32 s25, s25, 4194304
    s_lshl_b32 s26, s98, 3
    s_add_u32 s26, s26, 4194304
    s_waitcnt lgkmcnt(10)
    v_mfma_f32_16x16x32_bf16 v[116:119], v[84:87], v[92:95], v[28:31]
    v_mfma_f32_16x16x32_bf16 v[120:123], v[84:87], v[96:99], v[32:35]
    s_waitcnt lgkmcnt(8)
    v_mfma_f32_16x16x32_bf16 v[112:115], v[80:83], v[92:95], v[152:155]
    s_waitcnt lgkmcnt(6)
    v_mfma_f32_16x16x32_bf16 v[124:127], v[88:91], v[96:99], v[28:31]
    buffer_load_dwordx4 v76, s[4:7], s99 offen offset:3264  lds
    s_nop 4
    v_max_f32 v112, v112, v116
    v_max_f32 v113, v113, v117
    v_max_f32 v114, v114, v118
    v_max_f32 v115, v115, v119
    v_max3_f32 v156, v112, v113, v114
    v_max_f32 v156, v156, v115
    v_max_f32 v120, v120, v124
    v_max_f32_e64 v121, v121, v125
    s_add_u32 m0, s93, 73344
    s_add_u32 s99, s99, 256
    s_mov_b64 exec, s[80:81]
    buffer_load_dwordx4 v77, s[4:7], s100 offen  lds
    s_mov_b64 exec, -1
    s_add_u32 s100, s100, 256
    v_max_f32 v122, v122, v126
    v_max_f32 v123, v123, v127
    v_max3_f32 v157, v120, v121, v122
    v_max_f32 v157, v157, v123
    s_nop 1
    v_permlane16_swap_b32 v156, v157
    v_max_f32 v156, v156, v157
    v_mov_b32 v157, v156
    s_nop 1
    v_permlane32_swap_b32 v156, v157
    s_add_u32 m0, s92, 75520
    s_nop 0
    buffer_load_dwordx4 v73, s[4:7], s99 offen offset:0  lds
    v_max_f32 v156, v156, v157
    v_mul_f32 v156, s82, v156
    v_mov_b32 v157, v156
    s_nop 1
    v_permlane16_swap_b32_e64 v156, v157
    v_fma_f32 v112, v112, s82, -v156
    v_fma_f32 v113, v113, s82, -v156
    v_fma_f32 v114, v114, s82, -v156
    v_fma_f32 v115, v115, s82, -v156
    buffer_load_dwordx4 v74, s[4:7], s99 offen offset:1088  lds
    v_exp_f32 v112, v112
    v_exp_f32 v113, v113
    v_exp_f32 v114, v114
    v_exp_f32 v115, v115
    v_cvt_pk_bf16_f32 v116, v112, v113
    v_cvt_pk_bf16_f32 v117, v114, v115
    v_bfi_b32 v128, v36, 0, v116
    v_and_b32_e64 v130, v36, v116
    buffer_load_dwordx4 v75, s[4:7], s99 offen offset:2176  lds
    v_bfi_b32 v129, v37, 0, v117
    v_and_b32 v131, v37, v117
    s_waitcnt lgkmcnt(3)
    s_nop 0
    v_mfma_f32_16x16x32_bf16 v[144:147], v[106:109], v[128:131], 0
    s_waitcnt lgkmcnt(2)
    v_mfma_f32_16x16x32_bf16 v[136:139], v[100:103], v[128:131], 0
    v_fma_f32 v120, v120, s82, -v157
    v_fma_f32 v121, v121, s82, -v157
    v_fma_f32 v122, v122, s82, -v157
    v_fma_f32 v123, v123, s82, -v157
    buffer_load_dwordx4 v76, s[4:7], s99 offen offset:3264  lds
    v_exp_f32 v120, v120
    v_exp_f32 v121, v121
    v_exp_f32 v122, v122
    v_exp_f32 v123, v123
    v_cvt_pk_bf16_f32 v124, v120, v121
    v_cvt_pk_bf16_f32 v125, v122, v123
    v_bfi_b32 v132, v36, 0, v124
    v_and_b32_e64 v134, v36, v124
    s_add_u32 m0, s93, 92928
    s_add_u32 s99, s99, 256
    s_mov_b64 exec, s[80:81]
    buffer_load_dwordx4 v77, s[4:7], s100 offen  lds
    s_mov_b64 exec, -1
    s_add_u32 s100, s100, 256
    v_bfi_b32 v133, v37, 0, v125
    v_and_b32 v135, v37, v125
    s_waitcnt lgkmcnt(1)
    s_nop 0
    v_mfma_f32_16x16x32_bf16 v[148:151], v[108:111], v[132:135], 0
    s_waitcnt lgkmcnt(0)
    v_mfma_f32_16x16x32_bf16 v[140:143], v[102:105], v[132:135], 0
    v_mov_b32 v158, v144
    s_nop 1
    v_permlane16_swap_b32 v144, v158
    v_rcp_f32 v158, v158
    s_nop 0
    v_pk_mul_f32 v[136:137], v[136:137], v[158:159] op_sel_hi:[1,0]
    s_lshl_b32 s97, s73, 2
    s_add_u32 s97, s97, s24
    s_nop 0
    s_mul_i32 s97, s97, 25600
    s_add_u32 s97, s97, 2621440
    buffer_load_dwordx4 a[160:163], v58, s[16:19], s97 offen offset:0 sc1
    v_pk_mul_f32 v[138:139], v[138:139], v[158:159] op_sel_hi:[1,0]
    v_pk_mul_f32 v[144:145], v[144:145], v[158:159] op_sel_hi:[1,0]
    v_pk_mul_f32 v[146:147], v[146:147], v[158:159] op_sel_hi:[1,0]
    v_cvt_pk_bf16_f32 v112, v136, v137
    v_cvt_pk_bf16_f32 v116, v144, v145
    v_cvt_pk_bf16_f32 v113, v138, v139
    v_cvt_pk_bf16_f32 v117, v146, v147
    v_mov_b32 v160, v148
    buffer_load_dwordx4 a[164:167], v58, s[16:19], s97 offen offset:1024 sc1
    s_nop 0
    v_permlane16_swap_b32 v148, v160
    v_rcp_f32_e64 v160, v160
    s_nop 0
    v_pk_mul_f32 v[140:141], v[140:141], v[160:161] op_sel_hi:[1,0]
    v_pk_mul_f32 v[142:143], v[142:143], v[160:161] op_sel_hi:[1,0]
    v_pk_mul_f32 v[148:149], v[148:149], v[160:161] op_sel_hi:[1,0]
    v_pk_mul_f32 v[150:151], v[150:151], v[160:161] op_sel_hi:[1,0]
    v_cvt_pk_bf16_f32 v114, v140, v141
    v_cvt_pk_bf16_f32 v118, v148, v149
    buffer_load_dwordx4 a[168:171], v58, s[16:19], s97 offen offset:2048 sc1
    v_cvt_pk_bf16_f32 v115, v142, v143
    v_cvt_pk_bf16_f32 v119, v150, v151
    v_permlane16_swap_b32 v112, v114
    v_permlane16_swap_b32 v113, v115
    v_permlane16_swap_b32 v116, v118
    v_permlane16_swap_b32 v117, v119
    buffer_store_dwordx4 v[112:115], v45, s[16:19], s25 offen sc1
    s_mov_b64 exec, s[80:81]
    buffer_store_dwordx2 v[116:117], v46, s[16:19], s26 offen sc1
    s_mov_b64 exec, -1
    buffer_load_dwordx4 a[172:175], v58, s[16:19], s97 offen offset:3072 sc1
    s_add_u32 s97, s97, 4096
    buffer_load_dwordx4 a[176:179], v58, s[16:19], s97 offen offset:0 sc1
    v_add_u32 v196, 36352, v78
    v_mov_b32 v198, v79
    v_xor_b32 v197, 32, v196
    s_waitcnt vmcnt(17)
    s_barrier
    ds_read_b128 v[160:163], v198 offset:0
    ds_read_b128 v[164:167], v196 offset:0
    ds_read_b128 v[168:171], v196 offset:8704
    ds_read_b128 v[172:175], v198 offset:32
    ds_read_b128 v[176:179], v197 offset:0
    ds_read_b128 v[180:183], v197 offset:8704
    s_waitcnt lgkmcnt(3)
    v_mfma_f32_16x16x32_bf16 v[112:115], a[0:3], v[160:163], 0
    ds_read_b128 v[184:187], v198 offset:64
    v_mfma_f32_32x32x16_bf16 v[80:95], a[0:3], v[164:167], 0
    ds_read_b128 v[188:191], v196 offset:64
    s_lshl_b32 s59, s24, 12
    v_lshl_add_u32 v62, v1, 4, s59
    s_mul_i32 s59, s24, 1216
    s_add_u32 s59, s59, 192
    v_mfma_f32_32x32x16_bf16 v[96:111], a[0:3], v[168:171], 0
    ds_read_b128 v[192:195], v196 offset:8768
    s_add_u32 m0, s92, 95104
    s_nop 0
    buffer_load_dwordx4 v73, s[4:7], s99 offen offset:0  lds
    v_lshl_add_u32 v63, v1, 2, s59
    s_waitcnt lgkmcnt(3)
    v_mfma_f32_16x16x32_bf16 v[112:115], a[4:7], v[172:175], v[112:115]
    ds_read_b128 v[160:163], v198 offset:96
    v_mfma_f32_32x32x16_bf16 v[80:95], a[4:7], v[176:179], v[80:95]
    ds_read_b128 v[164:167], v197 offset:64
    s_mul_i32 s59, s24, 4864
    s_add_u32 s59, s59, 80
    v_and_b32_e64 v70, 3, v1
    v_mul_u32_u24 v70, 1216, v70
    v_mfma_f32_32x32x16_bf16 v[96:111], a[4:7], v[180:183], v[96:111]
    ds_read_b128 v[168:171], v197 offset:8768
    buffer_load_dwordx4 v74, s[4:7], s99 offen offset:1088  lds
    v_bfe_u32 v71, v1, 2, 3
    v_lshl_add_u32 v70, v71, 4, v70
    s_waitcnt lgkmcnt(3)
    v_mfma_f32_16x16x32_bf16 v[112:115], a[8:11], v[184:187], v[112:115]
    ds_read_b128 v[172:175], v198 offset:128
    v_mfma_f32_32x32x16_bf16 v[80:95], a[8:11], v[188:191], v[80:95]
    ds_read_b128 v[176:179], v196 offset:128
    v_lshrrev_b32 v71, 5, v1
    v_lshl_add_u32 v70, v71, 4, v70
    v_add_u32_e64 v64, s59, v70
    s_mul_i32 s59, s24, 4160
    v_mfma_f32_32x32x16_bf16 v[96:111], a[8:11], v[192:195], v[96:111]
    ds_read_b128 v[180:183], v196 offset:8832
    buffer_load_dwordx4 v75, s[4:7], s99 offen offset:2176  lds
    s_add_u32 s59, s59, 134368
    v_lshlrev_b32 v71, 6, v71
    s_waitcnt lgkmcnt(3)
    v_mfma_f32_16x16x32_bf16 v[112:115], a[12:15], v[160:163], v[112:115]
    ds_read_b128 v[184:187], v198 offset:160
    v_mfma_f32_32x32x16_bf16 v[80:95], a[12:15], v[164:167], v[80:95]
    ds_read_b128 v[188:191], v197 offset:128
    v_sub_u32_e64 v71, s59, v71
    v_bfe_u32 v70, v1, 4, 1
    v_lshl_add_u32 v71, v70, 5, v71
    v_and_b32_e64 v70, 3, v1
    v_mfma_f32_32x32x16_bf16 v[96:111], a[12:15], v[168:171], v[96:111]
    ds_read_b128 v[192:195], v197 offset:8832
    buffer_load_dwordx4 v76, s[4:7], s99 offen offset:3264  lds
    v_lshl_add_u32 v71, v70, 3, v71
    v_bfe_u32 v70, v1, 2, 2
    s_waitcnt lgkmcnt(3)
    v_mfma_f32_16x16x32_bf16 v[112:115], a[16:19], v[172:175], v[112:115]
    ds_read_b128 v[160:163], v198 offset:192
    v_mfma_f32_32x32x16_bf16 v[80:95], a[16:19], v[176:179], v[80:95]
    ds_read_b128 v[164:167], v196 offset:192
    v_lshlrev_b32 v70, 3, v70
    v_sub_u32_e64 v65, v71, v70
    s_mul_i32 s59, s24, 4224
    s_add_u32 s59, s59, 19456
    v_mfma_f32_32x32x16_bf16 v[96:111], a[16:19], v[180:183], v[96:111]
    ds_read_b128 v[168:171], v196 offset:8896
    s_add_u32 m0, s93, 112512
    s_add_u32 s99, s99, 256
    s_mov_b64 exec, s[80:81]
    buffer_load_dwordx4 v77, s[4:7], s100 offen  lds
    s_mov_b64 exec, -1
    s_add_u32 s100, s100, 256
    s_waitcnt lgkmcnt(3)
    v_mfma_f32_16x16x32_bf16 v[112:115], a[20:23], v[184:187], v[112:115]
    ds_read_b128 v[172:175], v198 offset:224
    v_mfma_f32_32x32x16_bf16 v[80:95], a[20:23], v[188:191], v[80:95]
    ds_read_b128 v[176:179], v197 offset:192
    v_and_b32 v70, 3, v1
    v_mul_u32_u24 v70, 1056, v70
    v_and_b32_e64 v71, 60, v1
    v_add3_u32 v66, v70, v71, s59
    v_mfma_f32_32x32x16_bf16 v[96:111], a[20:23], v[192:195], v[96:111]
    ds_read_b128 v[180:183], v197 offset:8896
    s_add_u32 m0, s92, 114688
    s_nop 0
    buffer_load_dwordx4 v73, s[4:7], s99 offen offset:0  lds
    s_mul_i32 s59, s24, 1056
    s_waitcnt vmcnt(18)
    s_barrier
    s_waitcnt lgkmcnt(3)
    v_mfma_f32_16x16x32_bf16 v[112:115], a[24:27], v[160:163], v[112:115]
    v_add_u32_e64 v198, v49, v198
    v_mfma_f32_32x32x16_bf16 v[80:95], a[24:27], v[164:167], v[80:95]
    v_add_u32 v196, 19584, v196
    v_add_u32 v197, 19584, v197
    ds_read_b128 v[184:187], v198 offset:0
    s_add_u32 s59, s59, 19456
    v_lshl_add_u32 v67, v1, 3, s59
    v_mfma_f32_32x32x16_bf16 v[96:111], a[24:27], v[168:171], v[96:111]
    ds_read_b128 v[188:191], v196 offset:0
    ds_read_b128 v[192:195], v196 offset:8704
    buffer_load_dwordx4 v74, s[4:7], s99 offen offset:1088  lds
    s_mul_i32 s59, s24, 1280
    s_waitcnt lgkmcnt(3)
    v_mfma_f32_16x16x32_bf16 v[112:115], a[28:31], v[172:175], v[112:115]
    ds_read_b128 v[160:163], v198 offset:32
    v_mfma_f32_32x32x16_bf16 v[80:95], a[28:31], v[176:179], v[80:95]
    ds_read_b128 v[164:167], v197 offset:0
    s_lshl_b32 s60, s75, 3
    s_add_u32 s59, s59, s60
    v_mul_u32_u24 v70, 10240, v1
    v_add_u32 v68, s59, v70
    v_mfma_f32_32x32x16_bf16 v[96:111], a[28:31], v[180:183], v[96:111]
    ds_read_b128 v[168:171], v197 offset:8704
    buffer_load_dwordx4 v75, s[4:7], s99 offen offset:2176  lds
    s_waitcnt lgkmcnt(3)
    v_mfma_f32_16x16x32_bf16 v[112:115], a[32:35], v[184:187], v[112:115]
    ds_read_b128 v[172:175], v198 offset:64
    v_mfma_f32_32x32x16_bf16 v[80:95], a[32:35], v[188:191], v[80:95]
    ds_read_b128 v[176:179], v196 offset:64
    v_mfma_f32_32x32x16_bf16 v[96:111], a[32:35], v[192:195], v[96:111]
    ds_read_b128 v[180:183], v196 offset:8768
    buffer_load_dwordx4 v76, s[4:7], s99 offen offset:3264  lds
    s_waitcnt lgkmcnt(3)
    v_mfma_f32_16x16x32_bf16 v[112:115], a[36:39], v[160:163], v[112:115]
    ds_read_b128 v[184:187], v198 offset:96
    v_mfma_f32_32x32x16_bf16 v[80:95], a[36:39], v[164:167], v[80:95]
    ds_read_b128 v[188:191], v197 offset:64
    v_mfma_f32_32x32x16_bf16 v[96:111], a[36:39], v[168:171], v[96:111]
    ds_read_b128 v[192:195], v197 offset:8768
    s_add_u32 m0, s93, 132096
    s_add_u32 s99, s99, 256
    s_mov_b64 exec, s[80:81]
    buffer_load_dwordx4 v77, s[4:7], s100 offen  lds
    s_mov_b64 exec, -1
    s_add_u32 s100, s100, 256
    s_waitcnt lgkmcnt(3)
    v_mfma_f32_16x16x32_bf16 v[112:115], a[40:43], v[172:175], v[112:115]
    ds_read_b128 v[160:163], v198 offset:128
    v_mfma_f32_32x32x16_bf16 v[80:95], a[40:43], v[176:179], v[80:95]
    ds_read_b128 v[164:167], v196 offset:128
    s_lshl_b32 s25, s24, 6
    s_and_b32 s35, s74, 3
    s_lshl_b32 s35, s35, 13
    s_add_u32 s35, s35, s25
    v_mfma_f32_32x32x16_bf16 v[96:111], a[40:43], v[180:183], v[96:111]
    ds_read_b128 v[168:171], v196 offset:8832
    s_lshl_b32 s98, s72, 5
    s_add_u32 s98, s98, 256
    s_sub_u32 s95, s98, 4
    s_max_i32 s95, s95, 0
    s_lshl_b32 s94, s98, 3
    s_lshl_b32 s95, s95, 3
    s_add_u32 s94, s94, 3440640
    s_add_u32 s95, s95, 3440640
    s_add_u32 s96, s94, 8192
    buffer_load_dwordx2 v[152:153], v47, s[16:19], s94 offen sc1
    s_waitcnt lgkmcnt(3)
    v_mfma_f32_16x16x32_bf16 v[112:115], a[44:47], v[184:187], v[112:115]
    ds_read_b128 v[172:175], v198 offset:160
    v_mfma_f32_32x32x16_bf16 v[80:95], a[44:47], v[188:191], v[80:95]
    ds_read_b128 v[176:179], v197 offset:128
    s_lshr_b32 s25, s74, 4
    s_lshl_b32 s25, s25, 11
    s_add_u32 s35, s35, s25
    s_and_b32 s25, s74, 12
    v_mfma_f32_32x32x16_bf16 v[96:111], a[44:47], v[192:195], v[96:111]
    ds_read_b128 v[180:183], v197 offset:8832
    buffer_load_dwordx2 v[154:155], v47, s[16:19], s96 offen sc1
    s_lshl_b32 s25, s25, 6
    s_add_u32 s35, s35, s25
    s_waitcnt lgkmcnt(3)
    v_mfma_f32_16x16x32_bf16 v[112:115], a[48:51], v[160:163], v[112:115]
    ds_read_b128 v[184:187], v198 offset:192
    v_mfma_f32_32x32x16_bf16 v[80:95], a[48:51], v[164:167], v[80:95]
    ds_read_b128 v[188:191], v196 offset:192
    s_mul_i32 s36, s73, 20
    s_add_u32 s36, s36, s24
    s_add_u32 s36, s36, 16
    s_lshl_b32 s36, s36, 14
    v_mfma_f32_32x32x16_bf16 v[96:111], a[48:51], v[168:171], v[96:111]
    ds_read_b128 v[192:195], v196 offset:8896
    buffer_load_dwordx2 v[156:157], v48, s[16:19], s95 offen sc1
    v_add_u32 v199, 36352, v58
    s_lshl_b32 s32, s24, 11
    s_waitcnt lgkmcnt(3)
    v_mfma_f32_16x16x32_bf16 v[112:115], a[52:55], v[172:175], v[112:115]
    ds_read_b128 v[160:163], v198 offset:224
    v_mfma_f32_32x32x16_bf16 v[80:95], a[52:55], v[176:179], v[80:95]
    ds_read_b128 v[164:167], v197 offset:192
    v_add_u32_e64 v203, s32, v199
    s_add_u32 s32, s24, 1
    s_and_b32 s32, s32, 3
    s_mul_i32 s32, s32, 6144
    v_mfma_f32_32x32x16_bf16 v[96:111], a[52:55], v[180:183], v[96:111]
    ds_read_b128 v[168:171], v197 offset:8896
    buffer_load_dwordx4 a[180:183], v58, s[16:19], s97 offen offset:1024 sc1
    v_add_u32 v200, s32, v199
    s_add_u32 s32, s24, 2
    s_waitcnt vmcnt(21)
    s_barrier
    s_waitcnt lgkmcnt(3)
    v_mfma_f32_16x16x32_bf16 v[112:115], a[56:59], v[184:187], v[112:115]
    v_add_u32 v198, v49, v198
    v_mfma_f32_32x32x16_bf16 v[80:95], a[56:59], v[188:191], v[80:95]
    v_add_u32 v196, 19584, v196
    v_add_u32 v197, 19584, v197
    ds_read_b128 v[172:175], v198 offset:0
    s_and_b32 s32, s32, 3
    s_mul_i32 s32, s32, 6144
    v_mfma_f32_32x32x16_bf16 v[96:111], a[56:59], v[192:195], v[96:111]
    ds_read_b128 v[176:179], v196 offset:0
    ds_read_b128 v[180:183], v196 offset:8704
    buffer_load_dwordx4 a[184:187], v58, s[16:19], s97 offen offset:2048 sc1
    v_add_u32_e64 v201, s32, v199
    s_waitcnt lgkmcnt(3)
    v_mfma_f32_16x16x32_bf16 v[112:115], a[60:63], v[160:163], v[112:115]
    ds_read_b128 v[184:187], v198 offset:32
    v_mfma_f32_32x32x16_bf16 v[80:95], a[60:63], v[164:167], v[80:95]
    ds_read_b128 v[188:191], v197 offset:0
    s_add_u32 s32, s24, 3
    s_and_b32 s32, s32, 3
    s_mul_i32 s32, s32, 6144
    v_add_u32_e64 v202, s32, v199
    v_mfma_f32_32x32x16_bf16 v[96:111], a[60:63], v[168:171], v[96:111]
    ds_read_b128 v[192:195], v197 offset:8704
    buffer_load_dwordx4 a[188:191], v58, s[16:19], s97 offen offset:3072 sc1
    s_mul_i32 s32, s24, 6144
    v_add_u32 v204, s32, v199
    s_waitcnt lgkmcnt(3)
    v_mfma_f32_16x16x32_bf16 v[112:115], a[64:67], v[172:175], v[112:115]
    ds_read_b128 v[160:163], v198 offset:64
    v_mfma_f32_32x32x16_bf16 v[80:95], a[64:67], v[176:179], v[80:95]
    ds_read_b128 v[164:167], v196 offset:64
    s_lshl_b32 s32, s24, 8
    s_add_u32 s32, s32, 36352
    v_and_b32 v214, 15, v1
    v_lshl_add_u32 v206, v214, 4, s32
    v_mfma_f32_32x32x16_bf16 v[96:111], a[64:67], v[180:183], v[96:111]
    ds_read_b128 v[168:171], v196 offset:8768
    s_add_u32 s97, s97, 4096
    buffer_load_dwordx4 a[192:195], v58, s[16:19], s97 offen offset:0 sc1
    v_lshrrev_b32 v215, 5, v1
    s_waitcnt lgkmcnt(3)
    v_mfma_f32_16x16x32_bf16 v[112:115], a[68:71], v[184:187], v[112:115]
    ds_read_b128 v[172:175], v198 offset:96
    v_mfma_f32_32x32x16_bf16 v[80:95], a[68:71], v[188:191], v[80:95]
    ds_read_b128 v[176:179], v197 offset:64
    v_lshl_add_u32 v205, v215, 10, v206
    v_bfe_u32 v215, v1, 4, 1
    v_lshl_add_u32 v205, v215, 3, v205
    v_lshlrev_b32_e64 v214, 2, v214
    v_mfma_f32_32x32x16_bf16 v[96:111], a[68:71], v[192:195], v[96:111]
    ds_read_b128 v[180:183], v197 offset:8768
    buffer_load_dwordx4 a[196:199], v58, s[16:19], s97 offen offset:1024 sc1
    v_lshl_add_u32 v214, v215, 10, v214
    s_lshl_b32 s32, s24, 6
    s_waitcnt lgkmcnt(3)
    v_mfma_f32_16x16x32_bf16 v[112:115], a[72:75], v[160:163], v[112:115]
    ds_read_b128 v[184:187], v198 offset:128
    v_mfma_f32_32x32x16_bf16 v[80:95], a[72:75], v[164:167], v[80:95]
    ds_read_b128 v[188:191], v196 offset:128
    v_lshl_add_u32 v207, v215, 3, s32
    v_and_b32 v215, 12, v1
    v_lshl_add_u32 v207, v215, 2, v207
    v_and_b32 v215, 2, v1
    v_mfma_f32_32x32x16_bf16 v[96:111], a[72:75], v[168:171], v[96:111]
    ds_read_b128 v[192:195], v196 offset:8832
    buffer_load_dwordx4 a[200:203], v58, s[16:19], s97 offen offset:2048 sc1
    v_lshl_add_u32 v207, v215, 1, v207
    v_add_u32 v207, 69120, v207
    s_waitcnt lgkmcnt(3)
    v_mfma_f32_16x16x32_bf16 v[112:115], a[76:79], v[172:175], v[112:115]
    ds_read_b128 v[160:163], v198 offset:160
    v_mfma_f32_32x32x16_bf16 v[80:95], a[76:79], v[176:179], v[80:95]
    ds_read_b128 v[164:167], v197 offset:128
    v_lshrrev_b32 v215, 4, v1
    v_lshl_add_u32 v206, v215, 2, v206
    v_mov_b32 v215, 0x3f803f80
    v_mfma_f32_32x32x16_bf16 v[96:111], a[76:79], v[180:183], v[96:111]
    ds_read_b128 v[168:171], v197 offset:8832
    buffer_load_dwordx4 a[204:207], v58, s[16:19], s97 offen offset:3072 sc1
    s_waitcnt lgkmcnt(3)
    v_mfma_f32_16x16x32_bf16 v[112:115], a[80:83], v[184:187], v[112:115]
    ds_read_b128 v[172:175], v198 offset:192
    v_mfma_f32_32x32x16_bf16 v[80:95], a[80:83], v[188:191], v[80:95]
    ds_read_b128 v[176:179], v196 offset:192
    v_mfma_f32_32x32x16_bf16 v[96:111], a[80:83], v[192:195], v[96:111]
    ds_read_b128 v[180:183], v196 offset:8896
    s_add_u32 s97, s97, 4096
    buffer_load_dwordx4 a[208:211], v58, s[16:19], s97 offen offset:0 sc1
    s_waitcnt lgkmcnt(3)
    v_mfma_f32_16x16x32_bf16 v[112:115], a[84:87], v[160:163], v[112:115]
    ds_read_b128 v[184:187], v198 offset:224
    v_mfma_f32_32x32x16_bf16 v[80:95], a[84:87], v[164:167], v[80:95]
    ds_read_b128 v[188:191], v197 offset:192
    v_mfma_f32_32x32x16_bf16 v[96:111], a[84:87], v[168:171], v[96:111]
    ds_read_b128 v[192:195], v197 offset:8896
    buffer_load_dwordx4 a[212:215], v58, s[16:19], s97 offen offset:1024 sc1
    s_waitcnt vmcnt(17)
    s_barrier
    s_waitcnt lgkmcnt(3)
    v_mfma_f32_16x16x32_bf16 v[112:115], a[88:91], v[172:175], v[112:115]
    v_add_u32 v198, v49, v198
    v_mfma_f32_32x32x16_bf16 v[80:95], a[88:91], v[176:179], v[80:95]
    v_add_u32 v196, 19584, v196
    v_add_u32 v197, 19584, v197
    ds_read_b128 v[160:163], v198 offset:0
    v_mfma_f32_32x32x16_bf16 v[96:111], a[88:91], v[180:183], v[96:111]
    ds_read_b128 v[164:167], v196 offset:0
    ds_read_b128 v[168:171], v196 offset:8704
    buffer_load_dwordx4 a[216:219], v58, s[16:19], s97 offen offset:2048 sc1
    s_waitcnt lgkmcnt(3)
    v_mfma_f32_16x16x32_bf16 v[112:115], a[92:95], v[184:187], v[112:115]
    ds_read_b128 v[172:175], v198 offset:32
    v_mfma_f32_32x32x16_bf16 v[80:95], a[92:95], v[188:191], v[80:95]
    ds_read_b128 v[176:179], v197 offset:0
    v_mfma_f32_32x32x16_bf16 v[96:111], a[92:95], v[192:195], v[96:111]
    ds_read_b128 v[180:183], v197 offset:8704
    buffer_load_dwordx4 a[220:223], v58, s[16:19], s97 offen offset:3072 sc1
    s_waitcnt lgkmcnt(3)
    v_mfma_f32_16x16x32_bf16 v[112:115], a[96:99], v[160:163], v[112:115]
    ds_read_b128 v[184:187], v198 offset:64
    v_mfma_f32_32x32x16_bf16 v[80:95], a[96:99], v[164:167], v[80:95]
    ds_read_b128 v[188:191], v196 offset:64
    v_mfma_f32_32x32x16_bf16 v[96:111], a[96:99], v[168:171], v[96:111]
    ds_read_b128 v[192:195], v196 offset:8768
    s_add_u32 s97, s97, 4096
    buffer_load_dwordx4 a[224:227], v58, s[16:19], s97 offen offset:0 sc1
    s_waitcnt lgkmcnt(3)
    v_mfma_f32_16x16x32_bf16 v[112:115], a[100:103], v[172:175], v[112:115]
    ds_read_b128 v[160:163], v198 offset:96
    v_mfma_f32_32x32x16_bf16 v[80:95], a[100:103], v[176:179], v[80:95]
    ds_read_b128 v[164:167], v197 offset:64
    v_mfma_f32_32x32x16_bf16 v[96:111], a[100:103], v[180:183], v[96:111]
    ds_read_b128 v[168:171], v197 offset:8768
    buffer_load_dwordx4 a[228:231], v58, s[16:19], s97 offen offset:1024 sc1
    s_waitcnt lgkmcnt(3)
    v_mfma_f32_16x16x32_bf16 v[112:115], a[104:107], v[184:187], v[112:115]
    ds_read_b128 v[172:175], v198 offset:128
    v_mfma_f32_32x32x16_bf16 v[80:95], a[104:107], v[188:191], v[80:95]
    ds_read_b128 v[176:179], v196 offset:128
    v_mfma_f32_32x32x16_bf16 v[96:111], a[104:107], v[192:195], v[96:111]
    ds_read_b128 v[180:183], v196 offset:8832
    buffer_load_dwordx4 a[232:235], v58, s[16:19], s97 offen offset:2048 sc1
    s_waitcnt lgkmcnt(3)
    v_mfma_f32_16x16x32_bf16 v[112:115], a[108:111], v[160:163], v[112:115]
    ds_read_b128 v[184:187], v198 offset:160
    v_mfma_f32_32x32x16_bf16 v[80:95], a[108:111], v[164:167], v[80:95]
    ds_read_b128 v[188:191], v197 offset:128
    v_mfma_f32_32x32x16_bf16 v[96:111], a[108:111], v[168:171], v[96:111]
    ds_read_b128 v[192:195], v197 offset:8832
    buffer_load_dwordx4 a[236:239], v58, s[16:19], s97 offen offset:3072 sc1
    s_waitcnt lgkmcnt(3)
    v_mfma_f32_16x16x32_bf16 v[112:115], a[112:115], v[172:175], v[112:115]
    ds_read_b128 v[160:163], v198 offset:192
    v_mfma_f32_32x32x16_bf16 v[80:95], a[112:115], v[176:179], v[80:95]
    ds_read_b128 v[164:167], v196 offset:192
    v_mfma_f32_32x32x16_bf16 v[96:111], a[112:115], v[180:183], v[96:111]
    ds_read_b128 v[168:171], v196 offset:8896
    s_add_u32 s97, s97, 4096
    buffer_load_dwordx4 a[240:243], v58, s[16:19], s97 offen offset:0 sc1
    s_waitcnt lgkmcnt(3)
    v_mfma_f32_16x16x32_bf16 v[112:115], a[116:119], v[184:187], v[112:115]
    ds_read_b128 v[172:175], v198 offset:224
    v_mfma_f32_32x32x16_bf16 v[80:95], a[116:119], v[188:191], v[80:95]
    ds_read_b128 v[176:179], v197 offset:192
    v_mfma_f32_32x32x16_bf16 v[96:111], a[116:119], v[192:195], v[96:111]
    ds_read_b128 v[180:183], v197 offset:8896
    buffer_load_dwordx4 a[244:247], v58, s[16:19], s97 offen offset:1024 sc1
    s_waitcnt vmcnt(20)
    s_barrier
    s_waitcnt lgkmcnt(3)
    v_mfma_f32_16x16x32_bf16 v[112:115], a[120:123], v[160:163], v[112:115]
    v_add_u32_e64 v198, v49, v198
    v_mfma_f32_32x32x16_bf16 v[80:95], a[120:123], v[164:167], v[80:95]
    v_add_u32 v196, 19584, v196
    v_add_u32 v197, 19584, v197
    s_waitcnt vmcnt(17)
    v_mul_f32 v148, v24, v157
    v_mul_f32 v149, v25, v157
    v_mul_f32 v150, v26, v157
    v_mfma_f32_32x32x16_bf16 v[96:111], a[120:123], v[168:171], v[96:111]
    ds_read_b128 v[184:187], v198 offset:0
    ds_read_b128 v[188:191], v196 offset:0
    buffer_load_dwordx4 a[248:251], v58, s[16:19], s97 offen offset:2048 sc1
    v_mul_f32 v151, v27, v157
    v_mul_f32_e64 v116, v8, v153
    s_waitcnt lgkmcnt(2)
    v_mfma_f32_16x16x32_bf16 v[112:115], a[124:127], v[172:175], v[112:115]
    ds_read_b128 v[192:195], v198 offset:32
    v_mfma_f32_32x32x16_bf16 v[80:95], a[124:127], v[176:179], v[80:95]
    ds_read_b128 v[160:163], v197 offset:0
    v_mul_f32 v117, v9, v153
    v_mul_f32 v118, v10, v153
    v_mul_f32 v119, v11, v153
    v_mul_f32 v120, v12, v153
    v_mfma_f32_32x32x16_bf16 v[96:111], a[124:127], v[180:183], v[96:111]
    buffer_load_dwordx4 a[252:255], v58, s[16:19], s97 offen offset:3072 sc1
    v_mul_f32 v121, v13, v153
    v_mul_f32 v122, v14, v153
    v_mul_f32 v123, v15, v153
    s_waitcnt lgkmcnt(2)
    v_mfma_f32_16x16x32_bf16 v[112:115], a[128:131], v[184:187], v[112:115]
    ds_read_b128 v[164:167], v198 offset:64
    v_mfma_f32_32x32x16_bf16 v[80:95], a[128:131], v[188:191], v[80:95]
    ds_read_b128 v[168:171], v196 offset:64
    v_mul_f32 v124, v16, v153
    v_mul_f32 v125, v17, v153
    v_mul_f32 v126, v18, v153
    s_waitcnt lgkmcnt(2)
    v_mfma_f32_16x16x32_bf16 v[112:115], a[132:135], v[192:195], v[112:115]
    ds_read_b128 v[172:175], v198 offset:96
    v_mfma_f32_32x32x16_bf16 v[80:95], a[132:135], v[160:163], v[80:95]
    ds_read_b128 v[176:179], v197 offset:64
    s_add_u32 s97, s97, 4096
    buffer_load_dwordx4 v[52:55], v58, s[16:19], s97 offen offset:0 sc1
    v_mul_f32 v127, v19, v153
    v_mul_f32_e64 v128, v20, v153
    s_waitcnt lgkmcnt(2)
    v_mfma_f32_16x16x32_bf16 v[112:115], a[136:139], v[164:167], v[112:115]
    ds_read_b128 v[180:183], v198 offset:128
    v_mfma_f32_32x32x16_bf16 v[80:95], a[136:139], v[168:171], v[80:95]
    ds_read_b128 v[184:187], v196 offset:128
    v_mul_f32 v129, v21, v153
    v_mul_f32 v130, v22, v153
    v_mul_f32 v131, v23, v153
    s_waitcnt lgkmcnt(2)
    v_mfma_f32_16x16x32_bf16 v[112:115], a[140:143], v[172:175], v[112:115]
    ds_read_b128 v[188:191], v198 offset:160
    v_mfma_f32_32x32x16_bf16 v[80:95], a[140:143], v[176:179], v[80:95]
    ds_read_b128 v[192:195], v197 offset:128
    s_mov_b32 s96, 4194304
    buffer_load_dwordx4 v[216:219], v56, s[16:19], s96 offen offset:0 sc1
    v_mul_f32 v132, v8, v155
    v_mul_f32_e64 v133, v9, v155
    s_waitcnt lgkmcnt(2)
    v_mfma_f32_16x16x32_bf16 v[112:115], a[144:147], v[180:183], v[112:115]
    ds_read_b128 v[160:163], v198 offset:192
    v_mfma_f32_32x32x16_bf16 v[80:95], a[144:147], v[184:187], v[80:95]
    ds_read_b128 v[164:167], v196 offset:192
    v_mul_f32 v134, v10, v155
    v_mul_f32 v135, v11, v155
    v_mul_f32 v136, v12, v155
    s_waitcnt lgkmcnt(2)
    v_mfma_f32_16x16x32_bf16 v[112:115], a[148:151], v[188:191], v[112:115]
    ds_read_b128 v[168:171], v198 offset:224
    v_mfma_f32_32x32x16_bf16 v[80:95], a[148:151], v[192:195], v[80:95]
    ds_read_b128 v[172:175], v197 offset:192
    buffer_load_dwordx4 v[220:223], v56, s[16:19], s96 offen offset:256 sc1
    v_mul_f32 v137, v13, v155
    v_mul_f32_e64 v138, v14, v155
    s_waitcnt lgkmcnt(2)
    v_mfma_f32_16x16x32_bf16 v[112:115], a[152:155], v[160:163], v[112:115]
    ds_read_b128 v[176:179], v196 offset:8704
    v_mfma_f32_32x32x16_bf16 v[80:95], a[152:155], v[164:167], v[80:95]
    ds_read_b128 v[180:183], v197 offset:8704
    v_mul_f32 v139, v15, v155
    v_mul_f32 v140, v16, v155
    v_mul_f32 v141, v17, v155
    s_waitcnt lgkmcnt(2)
    v_mfma_f32_16x16x32_bf16 v[112:115], a[156:159], v[168:171], v[112:115]
    ds_read_b128 v[184:187], v196 offset:8768
    v_mfma_f32_32x32x16_bf16 v[80:95], a[156:159], v[172:175], v[80:95]
    ds_read_b128 v[188:191], v197 offset:8768
    s_mov_b32 s96, 4227072
    buffer_load_dwordx4 v[224:227], v56, s[16:19], s96 offen offset:0 sc1
    v_mul_f32 v142, v18, v155
    v_mul_f32 v143, v19, v155
    v_mul_f32 v144, v20, v155
    v_mul_f32 v145, v21, v155
    v_mul_f32 v146, v22, v155
    v_mul_f32_e64 v147, v23, v155
    s_waitcnt lgkmcnt(2)
    v_mfma_f32_32x32x16_bf16 v[96:111], a[128:131], v[176:179], v[96:111]
    ds_read_b128 v[192:195], v196 offset:8832
    v_mfma_f32_32x32x16_bf16 v[96:111], a[132:135], v[180:183], v[96:111]
    ds_read_b128 v[160:163], v197 offset:8832
    buffer_load_dwordx4 v[228:231], v56, s[16:19], s96 offen offset:256 sc1
    v_fma_f32 v112, v112, v156, v148
    v_fma_f32 v113, v113, v156, v149
    s_waitcnt lgkmcnt(2)
    v_mfma_f32_32x32x16_bf16 v[96:111], a[136:139], v[184:187], v[96:111]
    ds_read_b128 v[164:167], v196 offset:8896
    v_fma_f32 v114, v114, v156, v150
    v_fma_f32 v115, v115, v156, v151
    v_cvt_pk_bf16_f32 v112, v112, v113
    v_cvt_pk_bf16_f32 v113, v114, v115
    v_mfma_f32_32x32x16_bf16 v[96:111], a[140:143], v[188:191], v[96:111]
    ds_read_b128 v[168:171], v197 offset:8896
    s_mov_b32 s96, 4259840
    buffer_load_dwordx4 v[232:235], v56, s[16:19], s96 offen offset:0 sc1
    v_fma_f32 v80, v80, v152, v116
    v_fma_f32 v81, v81, v152, v117
    s_waitcnt lgkmcnt(2)
    v_mfma_f32_32x32x16_bf16 v[96:111], a[144:147], v[192:195], v[96:111]
    v_fma_f32 v82, v82, v152, v118
    v_fma_f32 v83, v83, v152, v119
    v_cvt_pk_bf16_f32 v80, v80, v81
    v_cvt_pk_bf16_f32 v81, v82, v83
    ds_write_b64 v40, v[112:113] offset:0
    v_mfma_f32_32x32x16_bf16 v[96:111], a[148:151], v[160:163], v[96:111]
    ds_write_b64 v38, v[80:81] offset:0
    v_fma_f32 v84, v84, v152, v120
    v_fma_f32 v85, v85, v152, v121
    v_fma_f32 v86, v86, v152, v122
    s_waitcnt lgkmcnt(2)
    v_mfma_f32_32x32x16_bf16 v[96:111], a[152:155], v[164:167], v[96:111]
    v_fma_f32 v87, v87, v152, v123
    v_cvt_pk_bf16_f32 v84, v84, v85
    v_cvt_pk_bf16_f32 v85, v86, v87
    v_fma_f32 v88, v88, v152, v124
    v_fma_f32 v89, v89, v152, v125
    v_mfma_f32_32x32x16_bf16 v[96:111], a[156:159], v[168:171], v[96:111]
    buffer_load_dwordx4 v[236:239], v56, s[16:19], s96 offen offset:256 sc1
    v_fma_f32 v90, v90, v152, v126
    v_fma_f32 v91, v91, v152, v127
    v_cvt_pk_bf16_f32 v88, v88, v89
    v_cvt_pk_bf16_f32 v89, v90, v91
    ds_write_b64 v38, v[84:85] offset:6400
    ds_write_b64 v38, v[88:89] offset:12800
    v_fma_f32 v92, v92, v152, v128
    v_fma_f32 v93, v93, v152, v129
    v_fma_f32 v94, v94, v152, v130
    v_fma_f32 v95, v95, v152, v131
    v_cvt_pk_bf16_f32 v92, v92, v93
    v_cvt_pk_bf16_f32 v93, v94, v95
    ds_write_b64 v39, v[92:93] offset:0
    v_pk_fma_f32 v[96:97], v[96:97], v[154:155], v[132:133] op_sel_hi:[1,0,1]
    v_pk_fma_f32 v[98:99], v[98:99], v[154:155], v[134:135] op_sel_hi:[1,0,1]
    v_cvt_pk_bf16_f32 v96, v96, v97
    v_cvt_pk_bf16_f32 v97, v98, v99
    v_pk_fma_f32 v[100:101], v[100:101], v[154:155], v[136:137] op_sel_hi:[1,0,1]
    v_pk_fma_f32 v[102:103], v[102:103], v[154:155], v[138:139] op_sel_hi:[1,0,1]
    v_cvt_pk_bf16_f32 v100, v100, v101
    v_cvt_pk_bf16_f32 v101, v102, v103
    ds_write_b64 v38, v[96:97] offset:1600
    ds_write_b64 v38, v[100:101] offset:8000
    v_pk_fma_f32 v[104:105], v[104:105], v[154:155], v[140:141] op_sel_hi:[1,0,1]
    v_pk_fma_f32 v[106:107], v[106:107], v[154:155], v[142:143] op_sel_hi:[1,0,1]
    v_cvt_pk_bf16_f32 v104, v104, v105
    v_cvt_pk_bf16_f32 v105, v106, v107
    v_pk_fma_f32 v[108:109], v[108:109], v[154:155], v[144:145] op_sel_hi:[1,0,1]
    v_pk_fma_f32 v[110:111], v[110:111], v[154:155], v[146:147] op_sel_hi:[1,0,1]
    v_cvt_pk_bf16_f32 v108, v108, v109
    v_cvt_pk_bf16_f32 v109, v110, v111
    ds_write_b64 v38, v[104:105] offset:14400
    ds_write_b64 v39, v[108:109] offset:1600
    s_waitcnt lgkmcnt(0)
    s_barrier
    v_mov_b32 v94, 0
    v_mov_b32 v95, 0
    v_mov_b32 v98, 0
    v_mov_b32_e64 v99, 0
    s_mov_b64 exec, 0xffff
    ds_read_b64 v[94:95], v42 offset:320
    ds_read_b64 v[98:99], v42 offset:640
    s_mov_b64 exec, -1
    s_nop 0
    ds_read_b64 v[92:93], v41 offset:320
    ds_read_b64 v[96:97], v41 offset:640
    ds_read_b64 v[84:85], v41 offset:6720
    ds_read_b64 v[86:87], v42 offset:6720
    ds_read_b64 v[80:81], v41 offset:6400
    ds_read_b64 v[82:83], v42 offset:6400
    ds_read_b64 v[88:89], v41 offset:7040
    ds_read_b64 v[90:91], v42 offset:7040
    ds_read_b64_tr_b16 v[106:107], v44 offset:0
    ds_read_b64_tr_b16 v[100:101], v43 offset:0
    ds_read_b64_tr_b16 v[108:109], v44 offset:320
    ds_read_b64_tr_b16 v[102:103], v43 offset:320
    s_mov_b32 s96, 4292608
    buffer_load_dwordx4 v[240:243], v56, s[16:19], s96 offen offset:0 sc1
    ds_read_b64_tr_b16 v[110:111], v44 offset:640
    ds_read_b64_tr_b16 v[104:105], v43 offset:640
    s_mov_b32 s82, 0x3ea52b5c
    s_lshl_b32 s25, s98, 4
    s_add_u32 s25, s25, 4194304
    s_lshl_b32 s26, s98, 3
    s_add_u32 s26, s26, 4194304
    s_waitcnt lgkmcnt(10)
    v_mfma_f32_16x16x32_bf16 v[116:119], v[84:87], v[92:95], v[28:31]
    buffer_load_dwordx4 v[244:247], v56, s[16:19], s96 offen offset:256 sc1
    v_mfma_f32_16x16x32_bf16 v[120:123], v[84:87], v[96:99], v[32:35]
    s_waitcnt lgkmcnt(8)
    v_mfma_f32_16x16x32_bf16 v[112:115], v[80:83], v[92:95], v[32:35]
    s_waitcnt lgkmcnt(6)
    v_mfma_f32_16x16x32_bf16 v[124:127], v[88:91], v[96:99], v[28:31]
    s_nop 5
    v_max_f32 v112, v112, v116
    v_max_f32 v113, v113, v117
    v_max_f32 v114, v114, v118
    v_max_f32 v115, v115, v119
    v_max3_f32 v156, v112, v113, v114
    s_mov_b32 s96, 4194304
    buffer_load_dwordx2 v[248:249], v57, s[16:19], s96 offen offset:0 sc1
    v_max_f32 v156, v156, v115
    v_max_f32 v120, v120, v124
    v_max_f32 v121, v121, v125
    v_max_f32 v122, v122, v126
    v_max_f32 v123, v123, v127
    v_max3_f32 v157, v120, v121, v122
    v_max_f32 v157, v157, v123
    s_nop 1
    v_permlane16_swap_b32 v156, v157
    buffer_load_dwordx2 v[252:253], v57, s[16:19], s96 offen offset:128 sc1
    v_max_f32 v156, v156, v157
    v_mov_b32 v157, v156
    s_nop 1
    v_permlane32_swap_b32 v156, v157
    v_max_f32 v156, v156, v157
    v_mul_f32 v156, s82, v156
    v_mov_b32 v157, v156
    s_nop 1
    v_permlane16_swap_b32_e64 v156, v157
    v_fma_f32 v112, v112, s82, -v156
    s_mov_b32 s96, 4210688
    buffer_load_dwordx2 v[250:251], v57, s[16:19], s96 offen offset:0 sc1
    v_fma_f32 v113, v113, s82, -v156
    v_fma_f32 v114, v114, s82, -v156
    v_fma_f32 v115, v115, s82, -v156
    v_exp_f32 v112, v112
    v_exp_f32 v113, v113
    v_exp_f32 v114, v114
    v_exp_f32 v115, v115
    v_cvt_pk_bf16_f32 v116, v112, v113
    buffer_load_dwordx2 v[254:255], v57, s[16:19], s96 offen offset:128 sc1
    v_cvt_pk_bf16_f32 v117, v114, v115
    v_bfi_b32 v128, v36, 0, v116
    v_and_b32 v130, v36, v116
    v_bfi_b32 v129, v37, 0, v117
    v_and_b32 v131, v37, v117
    s_waitcnt lgkmcnt(3)
    s_nop 0
    v_mfma_f32_16x16x32_bf16 v[144:147], v[106:109], v[128:131], 0
    s_waitcnt lgkmcnt(2)
    v_mfma_f32_16x16x32_bf16 v[136:139], v[100:103], v[128:131], 0
    v_fma_f32 v120, v120, s82, -v157
    s_mov_b32 s96, 0
    s_mov_b32 s97, 5120
    buffer_load_dwordx2 v[208:209], v60, s[4:7], s96 offen
    v_fma_f32 v121, v121, s82, -v157
    v_fma_f32 v122, v122, s82, -v157
    v_fma_f32 v123, v123, s82, -v157
    v_exp_f32 v120, v120
    v_exp_f32 v121, v121
    v_exp_f32 v122, v122
    v_exp_f32 v123, v123
    v_cvt_pk_bf16_f32 v124, v120, v121
    buffer_load_dwordx2 v[210:211], v60, s[4:7], s97 offen
    v_cvt_pk_bf16_f32 v125, v122, v123
    v_bfi_b32 v132, v36, 0, v124
    v_and_b32 v134, v36, v124
    v_bfi_b32 v133, v37, 0, v125
    v_and_b32 v135, v37, v125
    s_waitcnt lgkmcnt(1)
    s_nop 0
    v_mfma_f32_16x16x32_bf16 v[148:151], v[108:111], v[132:135], 0
    s_waitcnt lgkmcnt(0)
    v_mfma_f32_16x16x32_bf16 v[140:143], v[102:105], v[132:135], 0
    v_mov_b32 v158, v144
    v_lshrrev_b32_e64 v212, 5, v1
    v_mul_u32_u24 v212, 5104, v212
    v_bfe_u32 v213, v1, 4, 1
    v_lshlrev_b32 v213, 2, v213
    v_sub_u32 v212, v212, v213
    v_add_u32 v212, v212, v60
    s_mul_i32 s97, s24, 24
    s_sub_u32 s97, 128, s97
    buffer_load_dword v212, v212, s[4:7], s97 offen
    v_permlane16_swap_b32 v144, v158
    v_rcp_f32_e64 v158, v158
    s_nop 0
    v_pk_mul_f32 v[136:137], v[136:137], v[158:159] op_sel_hi:[1,0]
    v_pk_mul_f32 v[138:139], v[138:139], v[158:159] op_sel_hi:[1,0]
    v_pk_mul_f32 v[144:145], v[144:145], v[158:159] op_sel_hi:[1,0]
    v_pk_mul_f32 v[146:147], v[146:147], v[158:159] op_sel_hi:[1,0]
    v_cvt_pk_bf16_f32 v112, v136, v137
    v_cvt_pk_bf16_f32 v116, v144, v145
    v_cvt_pk_bf16_f32 v113, v138, v139
    v_cvt_pk_bf16_f32 v117, v146, v147
    v_mov_b32 v160, v148
    s_nop 1
    v_permlane16_swap_b32 v148, v160
    v_rcp_f32_e64 v160, v160
    s_nop 0
    v_pk_mul_f32 v[140:141], v[140:141], v[160:161] op_sel_hi:[1,0]
    v_pk_mul_f32 v[142:143], v[142:143], v[160:161] op_sel_hi:[1,0]
    v_pk_mul_f32 v[148:149], v[148:149], v[160:161] op_sel_hi:[1,0]
    v_pk_mul_f32 v[150:151], v[150:151], v[160:161] op_sel_hi:[1,0]
    v_cvt_pk_bf16_f32 v114, v140, v141
    v_cvt_pk_bf16_f32 v118, v148, v149
    v_cvt_pk_bf16_f32 v115, v142, v143
    v_cvt_pk_bf16_f32 v119, v150, v151
    v_permlane16_swap_b32 v112, v114
    v_permlane16_swap_b32 v113, v115
    v_permlane16_swap_b32 v116, v118
    v_permlane16_swap_b32 v117, v119
    buffer_store_dwordx4 v[112:115], v45, s[16:19], s25 offen sc1
    s_mov_b64 exec, s[80:81]
    buffer_store_dwordx2 v[116:117], v46, s[16:19], s26 offen sc1
    s_mov_b64 exec, -1
oe_20:
    s_waitcnt vmcnt(16)
    v_mfma_f32_16x16x32_bf16 v[112:115], a[176:179], v[216:219], 0
    v_mov_b32 v136, 0
    v_mov_b32 v137, 0
    s_waitcnt vmcnt(15)
    v_mfma_f32_16x16x32_bf16 v[116:119], a[176:179], v[220:223], 0
    v_mov_b32 v138, 0
    v_mov_b32 v139, 0
    s_waitcnt vmcnt(14)
    v_mfma_f32_16x16x32_bf16 v[112:115], a[196:199], v[224:227], v[112:115]
    v_mov_b32 v140, 0
    v_mov_b32 v141, 0
    s_waitcnt vmcnt(13)
    v_mfma_f32_16x16x32_bf16 v[116:119], a[196:199], v[228:231], v[116:119]
    s_mov_b32 s25, 6815744
    s_add_u32 s26, s36, 6815744
    s_waitcnt vmcnt(12)
    v_mfma_f32_16x16x32_bf16 v[112:115], a[216:219], v[232:235], v[112:115]
    s_add_u32 s27, s35, 3473408
    s_mov_b32 s28, 0x99999999
    s_waitcnt vmcnt(11)
    v_mfma_f32_16x16x32_bf16 v[116:119], a[216:219], v[236:239], v[116:119]
    s_mov_b32 s29, 0x99999999
    s_waitcnt vmcnt(10)
    v_mfma_f32_16x16x32_bf16 v[112:115], a[236:239], v[240:243], v[112:115]
    s_waitcnt vmcnt(9)
    v_mfma_f32_16x16x32_bf16 v[116:119], a[236:239], v[244:247], v[116:119]
    s_waitcnt vmcnt(6)
    v_mfma_f32_16x16x32_bf16 v[112:115], v[52:55], v[248:251], v[112:115]
    s_waitcnt vmcnt(5)
    v_mfma_f32_16x16x32_bf16 v[116:119], v[52:55], v[252:255], v[116:119]
    v_mfma_f32_16x16x32_bf16 v[88:91], a[164:167], v[216:219], 0
    v_mfma_f32_16x16x32_bf16 v[92:95], a[164:167], v[220:223], 0
    v_mfma_f32_16x16x32_bf16 v[88:91], a[184:187], v[224:227], v[88:91]
    v_mfma_f32_16x16x32_bf16 v[92:95], a[184:187], v[228:231], v[92:95]
    v_mfma_f32_16x16x32_bf16 v[88:91], a[204:207], v[232:235], v[88:91]
    v_mfma_f32_16x16x32_bf16 v[92:95], a[204:207], v[236:239], v[92:95]
    s_nop 1
    v_cmp_u_f32 vcc, v112, v116
    s_nop 0
    s_cbranch_vccnz rd_21
rc_22:
    v_mfma_f32_16x16x32_bf16 v[88:91], a[224:227], v[240:243], v[88:91]
    ds_write_b128 v203, v[112:115] offset:24576
    v_mfma_f32_16x16x32_bf16 v[92:95], a[224:227], v[244:247], v[92:95]
    v_mfma_f32_16x16x32_bf16 v[88:91], a[244:247], v[248:251], v[88:91]
    ds_write_b128 v203, v[116:119] offset:25600
    v_mfma_f32_16x16x32_bf16 v[92:95], a[244:247], v[252:255], v[92:95]
    v_mfma_f32_16x16x32_bf16 v[96:99], a[168:171], v[216:219], 0
    s_waitcnt vmcnt(4)
    v_lshlrev_b32 v120, 16, v208
    v_and_b32 v121, 0xffff0000, v208
    v_mfma_f32_16x16x32_bf16 v[100:103], a[168:171], v[220:223], 0
    v_lshlrev_b32_e64 v122, 16, v209
    v_and_b32 v123, 0xffff0000, v209
    v_mfma_f32_16x16x32_bf16 v[96:99], a[188:191], v[224:227], v[96:99]
    s_waitcnt vmcnt(3)
    v_lshlrev_b32 v124, 16, v210
    v_and_b32 v125, 0xffff0000, v210
    v_mfma_f32_16x16x32_bf16 v[100:103], a[188:191], v[228:231], v[100:103]
    v_lshlrev_b32_e64 v126, 16, v211
    v_and_b32 v127, 0xffff0000, v211
    v_mfma_f32_16x16x32_bf16 v[96:99], a[208:211], v[232:235], v[96:99]
    s_waitcnt vmcnt(2)
    v_lshlrev_b32 v128, 16, v212
    v_and_b32 v129, 0xffff0000, v212
    v_mfma_f32_16x16x32_bf16 v[100:103], a[208:211], v[236:239], v[100:103]
    v_mfma_f32_16x16x32_bf16 v[96:99], a[228:231], v[240:243], v[96:99]
    ds_write_b128 v200, v[88:91] offset:0
    v_mfma_f32_16x16x32_bf16 v[100:103], a[228:231], v[244:247], v[100:103]
    v_mfma_f32_16x16x32_bf16 v[96:99], a[248:251], v[248:251], v[96:99]
    ds_write_b128 v200, v[92:95] offset:1024
    v_mfma_f32_16x16x32_bf16 v[100:103], a[248:251], v[252:255], v[100:103]
    v_mfma_f32_16x16x32_bf16 v[104:107], a[172:175], v[216:219], 0
    v_mfma_f32_16x16x32_bf16 v[108:111], a[172:175], v[220:223], 0
    v_mfma_f32_16x16x32_bf16 v[104:107], a[192:195], v[224:227], v[104:107]
    v_mfma_f32_16x16x32_bf16 v[108:111], a[192:195], v[228:231], v[108:111]
    v_mfma_f32_16x16x32_bf16 v[104:107], a[212:215], v[232:235], v[104:107]
    v_mfma_f32_16x16x32_bf16 v[108:111], a[212:215], v[236:239], v[108:111]
    v_mfma_f32_16x16x32_bf16 v[104:107], a[232:235], v[240:243], v[104:107]
    ds_write_b128 v201, v[96:99] offset:2048
    v_mfma_f32_16x16x32_bf16 v[108:111], a[232:235], v[244:247], v[108:111]
    v_mfma_f32_16x16x32_bf16 v[104:107], a[252:255], v[248:251], v[104:107]
    ds_write_b128 v201, v[100:103] offset:3072
    v_mfma_f32_16x16x32_bf16 v[108:111], a[252:255], v[252:255], v[108:111]
    v_mfma_f32_16x16x32_bf16 v[80:83], a[160:163], v[216:219], v[120:123]
    v_mfma_f32_16x16x32_bf16 v[84:87], a[160:163], v[220:223], v[124:127]
    v_mfma_f32_16x16x32_bf16 v[80:83], a[180:183], v[224:227], v[80:83]
    v_mfma_f32_16x16x32_bf16 v[84:87], a[180:183], v[228:231], v[84:87]
    v_mfma_f32_16x16x32_bf16 v[80:83], a[200:203], v[232:235], v[80:83]
    s_nop 0
    ds_write_b128 v202, v[104:107] offset:4096
    v_mfma_f32_16x16x32_bf16 v[84:87], a[200:203], v[236:239], v[84:87]
    ds_write_b128 v202, v[108:111] offset:5120
    v_mfma_f32_16x16x32_bf16 v[80:83], a[220:223], v[240:243], v[80:83]
    v_mfma_f32_16x16x32_bf16 v[84:87], a[220:223], v[244:247], v[84:87]
    v_mfma_f32_16x16x32_bf16 v[80:83], a[240:243], v[248:251], v[80:83]
    v_mfma_f32_16x16x32_bf16 v[84:87], a[240:243], v[252:255], v[84:87]
    s_waitcnt lgkmcnt(0)
    s_barrier
    s_nop 0
    ds_read_b128 v[88:91], v204 offset:0
    ds_read_b128 v[92:95], v204 offset:1024
    ds_read_b128 v[96:99], v204 offset:2048
    ds_read_b128 v[100:103], v204 offset:3072
    ds_read_b128 v[104:107], v204 offset:4096
    ds_read_b128 v[108:111], v204 offset:5120
    ds_read_b64 v[112:113], v205 offset:24576
    ds_read_b64 v[114:115], v205 offset:26624
    ds_read_b64 v[116:117], v205 offset:28672
    ds_read_b64 v[118:119], v205 offset:30720
    s_waitcnt lgkmcnt(9)
    v_pk_add_f32 v[80:81], v[80:81], v[88:89]
    v_pk_add_f32 v[82:83], v[82:83], v[90:91]
    s_waitcnt lgkmcnt(8)
    v_pk_add_f32 v[84:85], v[84:85], v[92:93]
    v_pk_add_f32 v[86:87], v[86:87], v[94:95]
    s_waitcnt lgkmcnt(7)
    v_pk_add_f32 v[80:81], v[80:81], v[96:97]
    v_pk_add_f32 v[82:83], v[82:83], v[98:99]
    s_waitcnt lgkmcnt(6)
    v_pk_add_f32 v[84:85], v[84:85], v[100:101]
    v_pk_add_f32 v[86:87], v[86:87], v[102:103]
    s_waitcnt lgkmcnt(5)
    v_pk_add_f32 v[80:81], v[80:81], v[104:105]
    v_pk_add_f32 v[82:83], v[82:83], v[106:107]
    s_waitcnt lgkmcnt(4)
    v_pk_add_f32 v[84:85], v[84:85], v[108:109]
    v_pk_add_f32 v[86:87], v[86:87], v[110:111]
    v_cvt_pk_bf16_f32 v132, v80, v81
    v_cvt_pk_bf16_f32 v133, v82, v83
    v_cvt_pk_bf16_f32 v134, v84, v85
    v_cvt_pk_bf16_f32 v135, v86, v87
    s_waitcnt lgkmcnt(3)
    v_pk_add_f32 v[128:129], v[128:129], v[112:113]
    s_waitcnt lgkmcnt(2)
    v_pk_add_f32 v[128:129], v[128:129], v[114:115]
    s_waitcnt lgkmcnt(1)
    v_pk_add_f32 v[128:129], v[128:129], v[116:117]
    s_waitcnt lgkmcnt(0)
    v_pk_add_f32 v[128:129], v[128:129], v[118:119]
    v_cvt_pk_bf16_f32 v130, v128, v129
    buffer_store_dwordx4 v[132:135], v59, s[16:19], s25 offen sc1
    buffer_store_dword v130, v61, s[16:19], s26 offen sc1
    v_dot2c_f32_bf16 v136, v132, v215
    v_dot2c_f32_bf16 v137, v132, v132
    v_dot2c_f32_bf16 v136, v133, v215
    v_dot2c_f32_bf16 v137, v133, v133
    v_dot2c_f32_bf16 v138, v134, v215
    v_dot2c_f32_bf16 v139, v134, v134
    v_dot2c_f32_bf16 v138, v135, v215
    v_dot2c_f32_bf16 v139, v135, v135
    v_dot2c_f32_bf16 v140, v130, v215
    v_dot2c_f32_bf16 v141, v130, v130
    v_permlane32_swap_b32 v136, v138
    v_permlane32_swap_b32 v137, v139
    v_pk_add_f32 v[136:137], v[136:137], v[138:139]
    v_pk_add_f32 v[136:137], v[136:137], v[140:141]
    s_nop 1
    v_permlane16_swap_b32 v136, v137
    v_add_f32_e64 v136, v136, v137
    ds_write_b32 v206, v136 offset:32768
    s_mov_b32 s96, 4198400
    buffer_load_dwordx4 v[216:219], v56, s[16:19], s96 offen offset:0 sc1
    buffer_load_dwordx4 v[220:223], v56, s[16:19], s96 offen offset:256 sc1
    s_mov_b32 s96, 4231168
    buffer_load_dwordx4 v[224:227], v56, s[16:19], s96 offen offset:0 sc1
    buffer_load_dwordx4 v[228:231], v56, s[16:19], s96 offen offset:256 sc1
    s_mov_b32 s96, 4263936
    buffer_load_dwordx4 v[232:235], v56, s[16:19], s96 offen offset:0 sc1
    buffer_load_dwordx4 v[236:239], v56, s[16:19], s96 offen offset:256 sc1
    s_mov_b32 s96, 4296704
    buffer_load_dwordx4 v[240:243], v56, s[16:19], s96 offen offset:0 sc1
    buffer_load_dwordx4 v[244:247], v56, s[16:19], s96 offen offset:256 sc1
    s_mov_b32 s96, 4196352
    buffer_load_dwordx2 v[248:249], v57, s[16:19], s96 offen offset:0 sc1
    buffer_load_dwordx2 v[252:253], v57, s[16:19], s96 offen offset:128 sc1
    s_mov_b32 s96, 4212736
    buffer_load_dwordx2 v[250:251], v57, s[16:19], s96 offen offset:0 sc1
    buffer_load_dwordx2 v[254:255], v57, s[16:19], s96 offen offset:128 sc1
    s_mov_b32 s96, 1310720
    s_mov_b32 s97, 1315840
    buffer_load_dwordx2 v[208:209], v60, s[4:7], s96 offen
    buffer_load_dwordx2 v[210:211], v60, s[4:7], s97 offen
    v_lshrrev_b32_e64 v212, 5, v1
    v_mul_u32_u24 v212, 5104, v212
    v_bfe_u32 v213, v1, 4, 1
    v_lshlrev_b32 v213, 2, v213
    v_sub_u32 v212, v212, v213
    v_add_u32 v212, v212, v60
    s_mul_i32 s97, s24, 24
    s_sub_u32 s97, 1310848, s97
    buffer_load_dword v212, v212, s[4:7], s97 offen
    s_waitcnt lgkmcnt(0)
    s_barrier
    ds_read2st64_b32 v[136:137], v207 offset0:0 offset1:1
    ds_read2st64_b32 v[138:139], v207 offset0:2 offset1:3
    ds_read_b64_tr_b16 v[144:145], v65 offset:32
    ds_read_b64_tr_b16 v[146:147], v65 offset:0
    ds_read_b64_tr_b16 v[148:149], v65 offset:160
    ds_read_b64_tr_b16 v[150:151], v65 offset:128
    ds_read_b64_tr_b16 v[152:153], v65 offset:288
    ds_read_b64_tr_b16 v[154:155], v65 offset:256
    ds_read_b64_tr_b16 v[156:157], v65 offset:416
    ds_read_b64_tr_b16 v[158:159], v65 offset:384
    ds_read_b64_tr_b16 v[160:161], v65 offset:544
    ds_read_b64_tr_b16 v[162:163], v65 offset:512
    ds_read_b64_tr_b16 v[164:165], v65 offset:672
    ds_read_b64_tr_b16 v[166:167], v65 offset:640
    ds_read_b64_tr_b16 v[168:169], v65 offset:800
    ds_read_b64_tr_b16 v[170:171], v65 offset:768
    ds_read_b64_tr_b16 v[172:173], v65 offset:928
    ds_read_b64_tr_b16 v[174:175], v65 offset:896
    s_waitcnt lgkmcnt(15)
    v_pk_add_f32 v[136:137], v[136:137], v[138:139]
    v_add_f32 v136, v136, v137
    v_cndmask_b32 v136, v136, 1.0, s[28:29]
    s_mov_b64 exec, s[80:81]
    buffer_atomic_add_f32 v136, v214, s[16:19], s27 offen sc1
    s_mov_b64 exec, -1
    v_lshrrev_b32 v176, 4, v0
    v_mul_u32_u24 v176, 1216, v176
    v_and_b32 v177, 15, v0
    v_lshl_add_u32 v176, v177, 3, v176
    v_add_u32 v176, 64, v176
    v_mov_b32 v178, 0
    v_mov_b32 v179, 0
    ds_write_b64 v176, v[178:179]
    v_mov_b32 v70, 0
    v_mov_b32 v71, 0
    v_mov_b32 v72, 0
    s_lshl_b32 s25, s24, 17
    v_lshrrev_b32 v176, 5, v1
    v_lshl_add_u32 v176, v176, 14, s25
    v_bfe_u32 v177, v1, 4, 1
    v_lshl_add_u32 v176, v177, 13, v176
    v_and_b32_e64 v177, 15, v1
    v_lshl_add_u32 v73, v177, 4, v176
    v_bfe_u32 v176, v1, 2, 3
    v_lshl_add_u32 v176, v176, 14, s25
    v_bfe_u32 v177, v1, 1, 1
    v_lshl_add_u32 v176, v177, 13, v176
    v_and_b32 v177, 1, v1
    v_lshl_add_u32 v77, v177, 4, v176
    v_lshrrev_b32 v177, 5, v1
    v_and_b32 v176, 31, v1
    v_lshlrev_b32 v176, 3, v176
    v_lshl_add_u32 v78, v177, 10, v176
    v_and_b32 v176, 7, v1
    v_lshlrev_b32 v176, 3, v176
    v_lshl_add_u32 v178, v177, 7, v176
    v_add_u32 v74, 31744, v73
    v_add_u32 v75, 63488, v73
    v_add_u32 v76, 95232, v73
    v_add_u32 v178, 53760, v178
    v_and_b32 v176, 31, v1
    v_cmp_eq_u32 vcc, 0, v176
    v_cmp_eq_u32 s[82:83], 24, v176
    s_nop 0
    s_or_b64 vcc, vcc, s[82:83]
    v_mov_b32 v176, 155712
    v_mov_b32 v177, 158288
    v_cndmask_b32 v176, v176, v177, vcc
    v_cndmask_b32 v79, v176, v178, s[78:79]
oe_23:
    s_waitcnt vmcnt(15)
    v_mfma_f32_16x16x32_bf16 v[112:115], a[176:179], v[216:219], 0
    v_mov_b32 v136, 0
    v_mov_b32 v137, 0
    s_waitcnt vmcnt(14)
    v_mfma_f32_16x16x32_bf16 v[116:119], a[176:179], v[220:223], 0
    v_mov_b32 v138, 0
    v_mov_b32 v139, 0
    s_waitcnt vmcnt(13)
    v_mfma_f32_16x16x32_bf16 v[112:115], a[196:199], v[224:227], v[112:115]
    v_mov_b32 v140, 0
    v_mov_b32_e64 v141, 0
    s_waitcnt vmcnt(12)
    v_mfma_f32_16x16x32_bf16 v[116:119], a[196:199], v[228:231], v[116:119]
    s_mov_b32 s25, 6817792
    s_add_u32 s26, s36, 6817792
    s_waitcnt vmcnt(11)
    v_mfma_f32_16x16x32_bf16 v[112:115], a[216:219], v[232:235], v[112:115]
    s_add_u32 s27, s35, 3477504
    s_mov_b32 s28, 0x99999999
    s_waitcnt vmcnt(10)
    v_mfma_f32_16x16x32_bf16 v[116:119], a[216:219], v[236:239], v[116:119]
    s_mov_b32 s29, 0x99999999
    s_waitcnt vmcnt(9)
    v_mfma_f32_16x16x32_bf16 v[112:115], a[236:239], v[240:243], v[112:115]
    s_waitcnt vmcnt(8)
    v_mfma_f32_16x16x32_bf16 v[116:119], a[236:239], v[244:247], v[116:119]
    s_waitcnt vmcnt(5)
    v_mfma_f32_16x16x32_bf16 v[112:115], v[52:55], v[248:251], v[112:115]
    s_waitcnt vmcnt(4)
    v_mfma_f32_16x16x32_bf16 v[116:119], v[52:55], v[252:255], v[116:119]
    v_mfma_f32_16x16x32_bf16 v[88:91], a[164:167], v[216:219], 0
    v_mfma_f32_16x16x32_bf16 v[92:95], a[164:167], v[220:223], 0
    v_mfma_f32_16x16x32_bf16 v[88:91], a[184:187], v[224:227], v[88:91]
    v_mfma_f32_16x16x32_bf16 v[92:95], a[184:187], v[228:231], v[92:95]
    v_mfma_f32_16x16x32_bf16 v[88:91], a[204:207], v[232:235], v[88:91]
    v_mfma_f32_16x16x32_bf16 v[92:95], a[204:207], v[236:239], v[92:95]
    s_nop 1
    v_cmp_u_f32 vcc, v112, v116
    s_nop 0
    s_cbranch_vccnz rd_24
rc_25:
    v_mfma_f32_16x16x32_bf16 v[88:91], a[224:227], v[240:243], v[88:91]
    ds_write_b128 v203, v[112:115] offset:24576
    v_mfma_f32_16x16x32_bf16 v[92:95], a[224:227], v[244:247], v[92:95]
    v_mfma_f32_16x16x32_bf16 v[88:91], a[244:247], v[248:251], v[88:91]
    ds_write_b128 v203, v[116:119] offset:25600
    v_mfma_f32_16x16x32_bf16 v[92:95], a[244:247], v[252:255], v[92:95]
    v_mfma_f32_16x16x32_bf16 v[96:99], a[168:171], v[216:219], 0
    s_waitcnt vmcnt(3)
    v_lshlrev_b32 v120, 16, v208
    v_and_b32 v121, 0xffff0000, v208
    v_mfma_f32_16x16x32_bf16 v[100:103], a[168:171], v[220:223], 0
    v_lshlrev_b32_e64 v122, 16, v209
    v_and_b32 v123, 0xffff0000, v209
    v_mfma_f32_16x16x32_bf16 v[96:99], a[188:191], v[224:227], v[96:99]
    s_waitcnt vmcnt(2)
    v_lshlrev_b32 v124, 16, v210
    v_and_b32 v125, 0xffff0000, v210
    v_mfma_f32_16x16x32_bf16 v[100:103], a[188:191], v[228:231], v[100:103]
    v_lshlrev_b32_e64 v126, 16, v211
    v_and_b32 v127, 0xffff0000, v211
    v_mfma_f32_16x16x32_bf16 v[96:99], a[208:211], v[232:235], v[96:99]
    s_waitcnt vmcnt(1)
    v_lshlrev_b32 v128, 16, v212
    v_and_b32 v129, 0xffff0000, v212
    v_mfma_f32_16x16x32_bf16 v[100:103], a[208:211], v[236:239], v[100:103]
    v_mfma_f32_16x16x32_bf16 v[96:99], a[228:231], v[240:243], v[96:99]
    ds_write_b128 v200, v[88:91] offset:0
    v_mfma_f32_16x16x32_bf16 v[100:103], a[228:231], v[244:247], v[100:103]
    v_mfma_f32_16x16x32_bf16 v[96:99], a[248:251], v[248:251], v[96:99]
    ds_write_b128 v200, v[92:95] offset:1024
    v_mfma_f32_16x16x32_bf16 v[100:103], a[248:251], v[252:255], v[100:103]
    v_mfma_f32_16x16x32_bf16 v[104:107], a[172:175], v[216:219], 0
    v_mfma_f32_16x16x32_bf16 v[108:111], a[172:175], v[220:223], 0
    v_mfma_f32_16x16x32_bf16 v[104:107], a[192:195], v[224:227], v[104:107]
    v_mfma_f32_16x16x32_bf16 v[108:111], a[192:195], v[228:231], v[108:111]
    v_mfma_f32_16x16x32_bf16 v[104:107], a[212:215], v[232:235], v[104:107]
    v_mfma_f32_16x16x32_bf16 v[108:111], a[212:215], v[236:239], v[108:111]
    v_mfma_f32_16x16x32_bf16 v[104:107], a[232:235], v[240:243], v[104:107]
    ds_write_b128 v201, v[96:99] offset:2048
    v_mfma_f32_16x16x32_bf16 v[108:111], a[232:235], v[244:247], v[108:111]
    v_mfma_f32_16x16x32_bf16 v[104:107], a[252:255], v[248:251], v[104:107]
    ds_write_b128 v201, v[100:103] offset:3072
    v_mfma_f32_16x16x32_bf16 v[108:111], a[252:255], v[252:255], v[108:111]
    v_mfma_f32_16x16x32_bf16 v[80:83], a[160:163], v[216:219], v[120:123]
    v_mfma_f32_16x16x32_bf16 v[84:87], a[160:163], v[220:223], v[124:127]
    v_mfma_f32_16x16x32_bf16 v[80:83], a[180:183], v[224:227], v[80:83]
    v_mfma_f32_16x16x32_bf16 v[84:87], a[180:183], v[228:231], v[84:87]
    v_mfma_f32_16x16x32_bf16 v[80:83], a[200:203], v[232:235], v[80:83]
    s_nop 0
    ds_write_b128 v202, v[104:107] offset:4096
    v_mfma_f32_16x16x32_bf16 v[84:87], a[200:203], v[236:239], v[84:87]
    ds_write_b128 v202, v[108:111] offset:5120
    v_mfma_f32_16x16x32_bf16 v[80:83], a[220:223], v[240:243], v[80:83]
    v_mfma_f32_16x16x32_bf16 v[84:87], a[220:223], v[244:247], v[84:87]
    v_mfma_f32_16x16x32_bf16 v[80:83], a[240:243], v[248:251], v[80:83]
    v_mfma_f32_16x16x32_bf16 v[84:87], a[240:243], v[252:255], v[84:87]
    s_waitcnt lgkmcnt(0)
    s_barrier
    s_nop 0
    ds_read_b128 v[88:91], v204 offset:0
    ds_read_b128 v[92:95], v204 offset:1024
    ds_read_b128 v[96:99], v204 offset:2048
    ds_read_b128 v[100:103], v204 offset:3072
    ds_read_b128 v[104:107], v204 offset:4096
    ds_read_b128 v[108:111], v204 offset:5120
    ds_read_b64 v[112:113], v205 offset:24576
    ds_read_b64 v[114:115], v205 offset:26624
    ds_read_b64 v[116:117], v205 offset:28672
    ds_read_b64 v[118:119], v205 offset:30720
    s_lshl_b32 s96, s75, 14
    s_add_u32 s96, s96, 6815744
    s_lshl_b32 s97, s24, 12
    s_add_u32 s97, s97, 3473408
    buffer_load_dwordx4 v[176:179], v62, s[16:19], s96 offen offset:0 sc1
    buffer_load_dwordx4 v[180:183], v62, s[16:19], s96 offen offset:1024 sc1
    s_waitcnt lgkmcnt(9)
    v_pk_add_f32 v[80:81], v[80:81], v[88:89]
    v_pk_add_f32 v[82:83], v[82:83], v[90:91]
    s_waitcnt lgkmcnt(8)
    v_pk_add_f32 v[84:85], v[84:85], v[92:93]
    v_pk_add_f32 v[86:87], v[86:87], v[94:95]
    s_waitcnt lgkmcnt(7)
    v_pk_add_f32 v[80:81], v[80:81], v[96:97]
    v_pk_add_f32 v[82:83], v[82:83], v[98:99]
    s_waitcnt lgkmcnt(6)
    v_pk_add_f32 v[84:85], v[84:85], v[100:101]
    v_pk_add_f32 v[86:87], v[86:87], v[102:103]
    s_waitcnt lgkmcnt(5)
    v_pk_add_f32 v[80:81], v[80:81], v[104:105]
    v_pk_add_f32 v[82:83], v[82:83], v[106:107]
    s_waitcnt lgkmcnt(4)
    v_pk_add_f32 v[84:85], v[84:85], v[108:109]
    v_pk_add_f32 v[86:87], v[86:87], v[110:111]
    v_cvt_pk_bf16_f32 v132, v80, v81
    v_cvt_pk_bf16_f32 v133, v82, v83
    v_cvt_pk_bf16_f32 v134, v84, v85
    v_cvt_pk_bf16_f32 v135, v86, v87
    s_waitcnt lgkmcnt(3)
    v_pk_add_f32 v[128:129], v[128:129], v[112:113]
    s_waitcnt lgkmcnt(2)
    v_pk_add_f32 v[128:129], v[128:129], v[114:115]
    s_waitcnt lgkmcnt(1)
    v_pk_add_f32 v[128:129], v[128:129], v[116:117]
    s_waitcnt lgkmcnt(0)
    v_pk_add_f32 v[128:129], v[128:129], v[118:119]
    v_cvt_pk_bf16_f32 v130, v128, v129
    buffer_store_dwordx4 v[132:135], v59, s[16:19], s25 offen sc1
    buffer_store_dword v130, v61, s[16:19], s26 offen sc1
    v_dot2c_f32_bf16 v136, v132, v215
    v_dot2c_f32_bf16 v137, v132, v132
    v_dot2c_f32_bf16 v136, v133, v215
    v_dot2c_f32_bf16 v137, v133, v133
    v_dot2c_f32_bf16 v138, v134, v215
    v_dot2c_f32_bf16 v139, v134, v134
    v_dot2c_f32_bf16 v138, v135, v215
    v_dot2c_f32_bf16 v139, v135, v135
    v_dot2c_f32_bf16 v140, v130, v215
    v_dot2c_f32_bf16 v141, v130, v130
    v_permlane32_swap_b32 v136, v138
    v_permlane32_swap_b32 v137, v139
    v_pk_add_f32 v[136:137], v[136:137], v[138:139]
    v_pk_add_f32 v[136:137], v[136:137], v[140:141]
    s_nop 1
    v_permlane16_swap_b32 v136, v137
    v_add_f32_e64 v136, v136, v137
    ds_write_b32 v206, v136 offset:32768
    buffer_load_dwordx4 v[184:187], v62, s[16:19], s97 offen offset:0 sc1
    buffer_load_dwordx4 v[188:191], v62, s[16:19], s97 offen offset:1024 sc1
    buffer_load_dwordx4 v[192:195], v62, s[16:19], s97 offen offset:2048 sc1
    buffer_load_dwordx4 v[196:199], v62, s[16:19], s97 offen offset:3072 sc1
    s_waitcnt lgkmcnt(0)
    s_barrier
    ds_read2st64_b32 v[136:137], v207 offset0:0 offset1:1
    ds_read2st64_b32 v[138:139], v207 offset0:2 offset1:3
    s_waitcnt lgkmcnt(0)
    v_pk_add_f32 v[136:137], v[136:137], v[138:139]
    v_add_f32 v136, v136, v137
    v_cndmask_b32 v136, v136, 1.0, s[28:29]
    s_mov_b64 exec, s[80:81]
    buffer_atomic_add_f32 v136, v214, s[16:19], s27 offen sc1
    s_mov_b64 exec, -1
    s_cmp_ge_u32 s2, 160
    s_cbranch_scc1 nc_26
    v_mov_b32 v248, -1
    v_mov_b32 v249, -1
    v_mov_b32 v250, -1
    v_mov_b32 v251, -1
    s_lshl_b32 s88, s75, 14
    s_add_u32 s88, s88, 9437184
    buffer_store_dwordx4 v[248:251], v62, s[16:19], s88 offen offset:0 sc1
    s_waitcnt vmcnt(2)
ce_28:
    v_max3_u32 v208, v176, v177, v178
    v_max3_u32 v208, v208, v179, v180
    v_max3_u32 v208, v208, v181, v182
    v_max_u32 v208, v208, v183
    v_cmp_eq_u32 s[82:83], -1, v208
    v_min3_f32 v209, v184, v187, v188
    v_min3_f32 v209, v209, v191, v192
    v_min3_f32 v209, v209, v195, v196
    v_min_f32 v209, v209, v199
    v_cmp_neq_f32 vcc, 0x41000000, v209
    s_nop 0
    s_or_b64 vcc, vcc, s[82:83]
    s_cbranch_vccnz rd_29
rc_30:
    v_mul_f32 v208, 0x3acccccd, v185
    v_mul_f32 v209, 0x3acccccd, v189
    v_mul_f32 v186, 0x3acccccd, v186
    v_mul_f32 v190, 0x3acccccd, v190
    v_fma_f32 v186, -v208, v208, v186
    v_fma_f32 v190, -v209, v209, v190
    v_max_f32 v186, 0, v186
    v_max_f32 v190, 0, v190
    v_add_f32 v186, 0x3727c5ac, v186
    v_add_f32 v190, 0x3727c5ac, v190
    v_rsq_f32 v185, v186
    v_rsq_f32 v189, v190
    v_mul_f32 v186, -v208, v185
    v_mul_f32 v190, -v209, v189
    v_lshlrev_b32 v80, 16, v176
    v_and_b32 v82, 0xffff0000, v176
    v_lshlrev_b32 v84, 16, v177
    v_and_b32 v86, 0xffff0000, v177
    v_lshlrev_b32 v81, 16, v178
    v_and_b32 v83, 0xffff0000, v178
    v_lshlrev_b32 v85, 16, v179
    v_and_b32 v87, 0xffff0000, v179
    v_fma_f32 v208, v80, v185, v186
    v_fma_f32 v209, v81, v189, v190
    v_cvt_pk_bf16_f32 v176, v208, v209
    v_fma_f32 v208, v82, v185, v186
    v_fma_f32 v209, v83, v189, v190
    v_cvt_pk_bf16_f32 v177, v208, v209
    v_fma_f32 v208, v84, v185, v186
    v_fma_f32 v209, v85, v189, v190
    v_cvt_pk_bf16_f32 v178, v208, v209
    v_fma_f32 v208, v86, v185, v186
    v_fma_f32 v209, v87, v189, v190
    v_cvt_pk_bf16_f32 v179, v208, v209
    ds_write_b32 v63, v176 offset:0
    ds_write_b32 v63, v177 offset:4864
    ds_write_b32 v63, v178 offset:9728
    ds_write_b32 v63, v179 offset:14592
    v_mul_f32 v208, 0x3acccccd, v193
    v_mul_f32 v209, 0x3acccccd, v197
    v_mul_f32 v194, 0x3acccccd, v194
    v_mul_f32 v198, 0x3acccccd, v198
    v_fma_f32 v194, -v208, v208, v194
    v_fma_f32 v198, -v209, v209, v198
    v_max_f32 v194, 0, v194
    v_max_f32 v198, 0, v198
    v_add_f32 v194, 0x3727c5ac, v194
    v_add_f32 v198, 0x3727c5ac, v198
    v_rsq_f32 v193, v194
    v_rsq_f32 v197, v198
    v_mul_f32 v194, -v208, v193
    v_mul_f32 v198, -v209, v197
    v_lshlrev_b32 v88, 16, v180
    v_and_b32 v90, 0xffff0000, v180
    v_lshlrev_b32 v92, 16, v181
    v_and_b32 v94, 0xffff0000, v181
    v_lshlrev_b32 v89, 16, v182
    v_and_b32 v91, 0xffff0000, v182
    v_lshlrev_b32 v93, 16, v183
    v_and_b32 v95, 0xffff0000, v183
    v_fma_f32 v208, v88, v193, v194
    v_fma_f32 v209, v89, v197, v198
    v_cvt_pk_bf16_f32 v180, v208, v209
    v_fma_f32 v208, v90, v193, v194
    v_fma_f32 v209, v91, v197, v198
    v_cvt_pk_bf16_f32 v181, v208, v209
    v_fma_f32 v208, v92, v193, v194
    v_fma_f32 v209, v93, v197, v198
    v_cvt_pk_bf16_f32 v182, v208, v209
    v_fma_f32 v208, v94, v193, v194
    v_fma_f32 v209, v95, v197, v198
    v_cvt_pk_bf16_f32 v183, v208, v209
    ds_write_b32 v63, v180 offset:256
    ds_write_b32 v63, v181 offset:5120
    ds_write_b32 v63, v182 offset:9984
    ds_write_b32 v63, v183 offset:14848
    s_waitcnt lgkmcnt(0)
    s_barrier
    ds_read_b128 v[212:215], v64 offset:96
    ds_read_b128 v[216:219], v64 offset:64
    ds_read_b128 v[220:223], v64 offset:32
    ds_read_b128 v[224:227], v64 offset:0
    s_waitcnt lgkmcnt(3)
    v_mfma_f32_32x32x16_bf16 v[96:111], v[212:215], v[144:147], 0
    ds_read_b128 v[228:231], v64 offset:224
    ds_read_b64_tr_b16 v[176:177], v65 offset:1056
    ds_read_b64_tr_b16 v[178:179], v65 offset:1024
    ds_read_b64_tr_b16 v[180:181], v65 offset:1184
    ds_read_b64_tr_b16 v[182:183], v65 offset:1152
    s_waitcnt lgkmcnt(7)
    v_mfma_f32_32x32x16_bf16 v[96:111], v[216:219], v[148:151], v[96:111]
    ds_read_b128 v[232:235], v64 offset:192
    ds_read_b64_tr_b16 v[184:185], v65 offset:1312
    ds_read_b64_tr_b16 v[186:187], v65 offset:1280
    ds_read_b64_tr_b16 v[188:189], v65 offset:1440
    ds_read_b64_tr_b16 v[190:191], v65 offset:1408
    s_waitcnt lgkmcnt(11)
    v_mfma_f32_32x32x16_bf16 v[96:111], v[220:223], v[152:155], v[96:111]
    ds_read_b128 v[236:239], v64 offset:160
    ds_read_b64_tr_b16 v[192:193], v65 offset:1568
    ds_read_b64_tr_b16 v[194:195], v65 offset:1536
    ds_read_b64_tr_b16 v[196:197], v65 offset:1696
    ds_read_b64_tr_b16 v[198:199], v65 offset:1664
    s_waitcnt lgkmcnt(15)
    v_mfma_f32_32x32x16_bf16 v[96:111], v[224:227], v[156:159], v[96:111]
    ds_read_b128 v[240:243], v64 offset:128
    ds_read_b64_tr_b16 v[200:201], v65 offset:1824
    ds_read_b64_tr_b16 v[202:203], v65 offset:1792
    ds_read_b64_tr_b16 v[204:205], v65 offset:1952
    ds_read_b64_tr_b16 v[206:207], v65 offset:1920
    s_waitcnt lgkmcnt(15)
    v_mfma_f32_32x32x16_bf16 v[112:127], v[228:231], v[144:147], 0
    buffer_store_dwordx4 v[248:251], v62, s[16:19], s88 offen offset:1024 sc1
    s_nop 3
    s_waitcnt lgkmcnt(14)
    v_mfma_f32_32x32x16_bf16 v[112:127], v[232:235], v[148:151], v[112:127]
    v_cndmask_b32 v208, v99, v72, s[76:77]
    v_cndmask_b32 v209, v103, v99, s[76:77]
    v_cndmask_b32 v210, v107, v103, s[76:77]
    v_cndmask_b32 v211, v111, v107, s[76:77]
    v_mov_b32_e64 v72, v111
    s_waitcnt lgkmcnt(9)
    v_mfma_f32_32x32x16_bf16 v[112:127], v[236:239], v[152:155], v[112:127]
    v_add_f32_dpp v98, v208, v98 wave_ror:1 row_mask:0xf bank_mask:0xf
    v_add_f32_dpp v102, v209, v102 wave_ror:1 row_mask:0xf bank_mask:0xf
    v_add_f32_dpp v106, v210, v106 wave_ror:1 row_mask:0xf bank_mask:0xf
    v_add_f32_dpp v110, v211, v110 wave_ror:1 row_mask:0xf bank_mask:0xf
    v_cndmask_b32 v208, v98, v71, s[76:77]
    s_waitcnt lgkmcnt(4)
    v_mfma_f32_32x32x16_bf16 v[112:127], v[240:243], v[156:159], v[112:127]
    v_cndmask_b32 v209, v102, v98, s[76:77]
    v_cndmask_b32 v210, v106, v102, s[76:77]
    v_cndmask_b32 v211, v110, v106, s[76:77]
    v_mov_b32 v71, v110
    v_add_f32_dpp v97, v208, v97 wave_ror:1 row_mask:0xf bank_mask:0xf
    v_add_f32_dpp v101, v209, v101 wave_ror:1 row_mask:0xf bank_mask:0xf
    v_mfma_f32_32x32x16_bf16 v[112:127], v[212:215], v[160:163], v[112:127]
    ds_read_b128 v[244:247], v64 offset:352
    v_add_f32_dpp v105, v210, v105 wave_ror:1 row_mask:0xf bank_mask:0xf
    v_add_f32_dpp v109, v211, v109 wave_ror:1 row_mask:0xf bank_mask:0xf
    v_cndmask_b32 v208, v97, v70, s[76:77]
    v_cndmask_b32 v209, v101, v97, s[76:77]
    v_cndmask_b32 v210, v105, v101, s[76:77]
    v_mfma_f32_32x32x16_bf16 v[112:127], v[216:219], v[164:167], v[112:127]
    ds_read_b128 v[216:219], v64 offset:320
    v_cndmask_b32 v211, v109, v105, s[76:77]
    v_mov_b32_e64 v70, v109
    v_add_f32_dpp v96, v208, v96 wave_ror:1 row_mask:0xf bank_mask:0xf
    v_add_f32_dpp v100, v209, v100 wave_ror:1 row_mask:0xf bank_mask:0xf
    v_add_f32_dpp v104, v210, v104 wave_ror:1 row_mask:0xf bank_mask:0xf
    v_mfma_f32_32x32x16_bf16 v[112:127], v[220:223], v[168:171], v[112:127]
    ds_read_b128 v[220:223], v64 offset:288
    buffer_store_dwordx4 v[248:251], v62, s[16:19], s88 offen offset:2048 sc1
    v_add_f32_dpp v108, v211, v108 wave_ror:1 row_mask:0xf bank_mask:0xf
    v_mfma_f32_32x32x16_bf16 v[112:127], v[224:227], v[172:175], v[112:127]
    ds_read_b128 v[224:227], v64 offset:256
    ds_write_b32 v66, v96 offset:0
    ds_write_b32 v66, v100 offset:64
    s_waitcnt lgkmcnt(5)
    v_mfma_f32_32x32x16_bf16 v[128:143], v[244:247], v[144:147], 0
    ds_write_b32 v66, v104 offset:128
    ds_write_b32 v66, v108 offset:192
    s_nop 0
    s_waitcnt lgkmcnt(6)
    v_mfma_f32_32x32x16_bf16 v[128:143], v[216:219], v[148:151], v[128:143]
    s_nop 3
    v_cndmask_b32 v208, v115, v72, s[76:77]
    s_waitcnt lgkmcnt(5)
    v_mfma_f32_32x32x16_bf16 v[128:143], v[220:223], v[152:155], v[128:143]
    v_cndmask_b32 v209, v119, v115, s[76:77]
    v_cndmask_b32 v210, v123, v119, s[76:77]
    v_cndmask_b32 v211, v127, v123, s[76:77]
    v_mov_b32 v72, v127
    v_add_f32_dpp v114, v208, v114 wave_ror:1 row_mask:0xf bank_mask:0xf
    s_waitcnt lgkmcnt(4)
    v_mfma_f32_32x32x16_bf16 v[128:143], v[224:227], v[156:159], v[128:143]
    v_add_f32_dpp v118, v209, v118 wave_ror:1 row_mask:0xf bank_mask:0xf
    v_add_f32_dpp v122, v210, v122 wave_ror:1 row_mask:0xf bank_mask:0xf
    v_add_f32_dpp v126, v211, v126 wave_ror:1 row_mask:0xf bank_mask:0xf
    v_cndmask_b32 v208, v114, v71, s[76:77]
    v_cndmask_b32 v209, v118, v114, s[76:77]
    v_cndmask_b32 v210, v122, v118, s[76:77]
    v_mfma_f32_32x32x16_bf16 v[128:143], v[228:231], v[160:163], v[128:143]
    buffer_store_dwordx4 v[248:251], v62, s[16:19], s88 offen offset:3072 sc1
    v_cndmask_b32 v211, v126, v122, s[76:77]
    v_mov_b32 v71, v126
    v_add_f32_dpp v113, v208, v113 wave_ror:1 row_mask:0xf bank_mask:0xf
    v_add_f32_dpp v117, v209, v117 wave_ror:1 row_mask:0xf bank_mask:0xf
    v_add_f32_dpp v121, v210, v121 wave_ror:1 row_mask:0xf bank_mask:0xf
    v_mfma_f32_32x32x16_bf16 v[128:143], v[232:235], v[164:167], v[128:143]
    ds_read_b128 v[232:235], v64 offset:64
    v_add_f32_dpp v125, v211, v125 wave_ror:1 row_mask:0xf bank_mask:0xf
    v_cndmask_b32 v208, v113, v70, s[76:77]
    v_cndmask_b32 v209, v117, v113, s[76:77]
    v_cndmask_b32 v210, v121, v117, s[76:77]
    v_cndmask_b32 v211, v125, v121, s[76:77]
    v_mfma_f32_32x32x16_bf16 v[128:143], v[236:239], v[168:171], v[128:143]
    ds_read_b128 v[236:239], v64 offset:32
    v_mov_b32_e64 v70, v125
    v_add_f32_dpp v112, v208, v112 wave_ror:1 row_mask:0xf bank_mask:0xf
    v_add_f32_dpp v116, v209, v116 wave_ror:1 row_mask:0xf bank_mask:0xf
    v_add_f32_dpp v120, v210, v120 wave_ror:1 row_mask:0xf bank_mask:0xf
    v_add_f32_dpp v124, v211, v124 wave_ror:1 row_mask:0xf bank_mask:0xf
    v_mfma_f32_32x32x16_bf16 v[128:143], v[240:243], v[172:175], v[128:143]
    ds_read_b128 v[240:243], v64 offset:0
    ds_write_b32 v66, v112 offset:256
    ds_write_b32 v66, v116 offset:320
    v_mfma_f32_32x32x16_bf16 v[128:143], v[212:215], v[176:179], v[128:143]
    ds_read_b128 v[212:215], v64 offset:480
    ds_write_b32 v66, v120 offset:384
    ds_write_b32 v66, v124 offset:448
    s_waitcnt lgkmcnt(7)
    v_mfma_f32_32x32x16_bf16 v[128:143], v[232:235], v[180:183], v[128:143]
    ds_read_b128 v[232:235], v64 offset:448
    s_waitcnt lgkmcnt(7)
    v_mfma_f32_32x32x16_bf16 v[128:143], v[236:239], v[184:187], v[128:143]
    ds_read_b128 v[236:239], v64 offset:416
    s_waitcnt lgkmcnt(7)
    v_mfma_f32_32x32x16_bf16 v[128:143], v[240:243], v[188:191], v[128:143]
    ds_read_b128 v[240:243], v64 offset:384
    s_nop 3
    s_waitcnt lgkmcnt(5)
    v_mfma_f32_32x32x16_bf16 v[112:127], v[212:215], v[144:147], 0
    s_nop 4
    s_waitcnt lgkmcnt(2)
    v_mfma_f32_32x32x16_bf16 v[112:127], v[232:235], v[148:151], v[112:127]
    v_cndmask_b32 v208, v131, v72, s[76:77]
    v_cndmask_b32 v209, v135, v131, s[76:77]
    v_cndmask_b32 v210, v139, v135, s[76:77]
    v_cndmask_b32 v211, v143, v139, s[76:77]
    v_mov_b32_e64 v72, v143
    s_waitcnt lgkmcnt(1)
    v_mfma_f32_32x32x16_bf16 v[112:127], v[236:239], v[152:155], v[112:127]
    v_add_f32_dpp v130, v208, v130 wave_ror:1 row_mask:0xf bank_mask:0xf
    v_add_f32_dpp v134, v209, v134 wave_ror:1 row_mask:0xf bank_mask:0xf
    v_add_f32_dpp v138, v210, v138 wave_ror:1 row_mask:0xf bank_mask:0xf
    v_add_f32_dpp v142, v211, v142 wave_ror:1 row_mask:0xf bank_mask:0xf
    v_cndmask_b32 v208, v130, v71, s[76:77]
    s_waitcnt lgkmcnt(0)
    v_mfma_f32_32x32x16_bf16 v[112:127], v[240:243], v[156:159], v[112:127]
    v_cndmask_b32 v209, v134, v130, s[76:77]
    v_cndmask_b32 v210, v138, v134, s[76:77]
    v_cndmask_b32 v211, v142, v138, s[76:77]
    v_mov_b32 v71, v142
    v_add_f32_dpp v129, v208, v129 wave_ror:1 row_mask:0xf bank_mask:0xf
    v_add_f32_dpp v133, v209, v133 wave_ror:1 row_mask:0xf bank_mask:0xf
    v_mfma_f32_32x32x16_bf16 v[112:127], v[244:247], v[160:163], v[112:127]
    v_add_f32_dpp v137, v210, v137 wave_ror:1 row_mask:0xf bank_mask:0xf
    v_add_f32_dpp v141, v211, v141 wave_ror:1 row_mask:0xf bank_mask:0xf
    v_cndmask_b32 v208, v129, v70, s[76:77]
    v_cndmask_b32 v209, v133, v129, s[76:77]
    v_cndmask_b32 v210, v137, v133, s[76:77]
    v_cndmask_b32 v211, v141, v137, s[76:77]
    v_mfma_f32_32x32x16_bf16 v[112:127], v[216:219], v[164:167], v[112:127]
    ds_read_b128 v[240:243], v64 offset:192
    v_mov_b32_e64 v70, v141
    v_add_f32_dpp v128, v208, v128 wave_ror:1 row_mask:0xf bank_mask:0xf
    v_add_f32_dpp v132, v209, v132 wave_ror:1 row_mask:0xf bank_mask:0xf
    v_add_f32_dpp v136, v210, v136 wave_ror:1 row_mask:0xf bank_mask:0xf
    v_add_f32_dpp v140, v211, v140 wave_ror:1 row_mask:0xf bank_mask:0xf
    v_mfma_f32_32x32x16_bf16 v[112:127], v[220:223], v[168:171], v[112:127]
    ds_read_b128 v[220:223], v64 offset:160
    ds_write_b32 v66, v128 offset:512
    ds_write_b32 v66, v132 offset:576
    v_mfma_f32_32x32x16_bf16 v[112:127], v[224:227], v[172:175], v[112:127]
    ds_read_b128 v[224:227], v64 offset:128
    ds_write_b32 v66, v136 offset:640
    ds_write_b32 v66, v140 offset:704
    v_mfma_f32_32x32x16_bf16 v[112:127], v[228:231], v[176:179], v[112:127]
    ds_read_b128 v[236:239], v64 offset:96
    s_waitcnt lgkmcnt(7)
    v_mfma_f32_32x32x16_bf16 v[112:127], v[240:243], v[180:183], v[112:127]
    ds_read_b128 v[240:243], v64 offset:64
    s_waitcnt lgkmcnt(7)
    v_mfma_f32_32x32x16_bf16 v[112:127], v[220:223], v[184:187], v[112:127]
    ds_read_b128 v[220:223], v64 offset:32
    s_waitcnt lgkmcnt(5)
    v_mfma_f32_32x32x16_bf16 v[112:127], v[224:227], v[188:191], v[112:127]
    ds_read_b128 v[224:227], v64 offset:0
    s_waitcnt lgkmcnt(3)
    v_mfma_f32_32x32x16_bf16 v[112:127], v[236:239], v[192:195], v[112:127]
    ds_read_b64_tr_b16 v[216:217], v65 offset:544
    ds_read_b64_tr_b16 v[218:219], v65 offset:512
    s_waitcnt lgkmcnt(4)
    v_mfma_f32_32x32x16_bf16 v[112:127], v[240:243], v[196:199], v[112:127]
    ds_read_b64_tr_b16 v[240:241], v65 offset:1056
    ds_read_b64_tr_b16 v[242:243], v65 offset:1024
    s_waitcnt lgkmcnt(5)
    v_mfma_f32_32x32x16_bf16 v[112:127], v[220:223], v[200:203], v[112:127]
    s_waitcnt lgkmcnt(4)
    v_mfma_f32_32x32x16_bf16 v[112:127], v[224:227], v[204:207], v[112:127]
    ds_read_b64_tr_b16 v[224:225], v65 offset:1568
    ds_read_b64_tr_b16 v[226:227], v65 offset:1536
    s_lshl_b32 s96, s75, 14
    s_add_u32 s96, s96, 6815744
    s_lshl_b32 s97, s24, 12
    s_add_u32 s97, s97, 3477504
    buffer_load_dwordx4 v[248:251], v62, s[16:19], s96 offen offset:2048 sc1
    s_waitcnt lgkmcnt(4)
    v_mfma_f32_32x32x16_bf16 v[144:159], v[212:215], v[216:219], 0
    s_nop 3
    v_cndmask_b32 v208, v115, v72, s[76:77]
    s_waitcnt lgkmcnt(2)
    v_mfma_f32_32x32x16_bf16 v[144:159], v[244:247], v[240:243], v[144:159]
    buffer_load_dwordx4 v[252:255], v62, s[16:19], s96 offen offset:3072 sc1
    v_cndmask_b32 v209, v119, v115, s[76:77]
    v_cndmask_b32 v210, v123, v119, s[76:77]
    v_cndmask_b32 v211, v127, v123, s[76:77]
    v_mov_b32_e64 v72, v127
    v_add_f32_dpp v114, v208, v114 wave_ror:1 row_mask:0xf bank_mask:0xf
    v_mfma_f32_32x32x16_bf16 v[160:175], v[212:215], v[240:243], 0
    ds_read_b64_tr_b16 v[216:217], v65 offset:2080
    ds_read_b64_tr_b16 v[218:219], v65 offset:2048
    v_add_f32_dpp v118, v209, v118 wave_ror:1 row_mask:0xf bank_mask:0xf
    v_add_f32_dpp v122, v210, v122 wave_ror:1 row_mask:0xf bank_mask:0xf
    v_add_f32_dpp v126, v211, v126 wave_ror:1 row_mask:0xf bank_mask:0xf
    s_waitcnt lgkmcnt(2)
    v_mfma_f32_32x32x16_bf16 v[144:159], v[228:231], v[224:227], v[144:159]
    buffer_load_dwordx4 v[96:99], v62, s[16:19], s97 offen offset:0 sc1
    v_cndmask_b32 v208, v114, v71, s[76:77]
    v_cndmask_b32 v209, v118, v114, s[76:77]
    v_cndmask_b32 v210, v122, v118, s[76:77]
    v_cndmask_b32 v211, v126, v122, s[76:77]
    v_mov_b32 v71, v126
    v_mfma_f32_32x32x16_bf16 v[160:175], v[244:247], v[224:227], v[160:175]
    v_add_f32_dpp v113, v208, v113 wave_ror:1 row_mask:0xf bank_mask:0xf
    v_add_f32_dpp v117, v209, v117 wave_ror:1 row_mask:0xf bank_mask:0xf
    v_add_f32_dpp v121, v210, v121 wave_ror:1 row_mask:0xf bank_mask:0xf
    v_add_f32_dpp v125, v211, v125 wave_ror:1 row_mask:0xf bank_mask:0xf
    v_cndmask_b32 v208, v113, v70, s[76:77]
    v_cndmask_b32 v209, v117, v113, s[76:77]
    v_mfma_f32_32x32x16_bf16 v[176:191], v[212:215], v[224:227], 0
    buffer_load_dwordx4 v[100:103], v62, s[16:19], s97 offen offset:1024 sc1
    v_cndmask_b32 v210, v121, v117, s[76:77]
    v_cndmask_b32 v211, v125, v121, s[76:77]
    v_mov_b32 v70, v125
    v_add_f32_dpp v112, v208, v112 wave_ror:1 row_mask:0xf bank_mask:0xf
    s_waitcnt lgkmcnt(0)
    v_mfma_f32_32x32x16_bf16 v[144:159], v[236:239], v[216:219], v[144:159]
    ds_read_b64_tr_b16 v[240:241], v65 offset:2592
    ds_read_b64_tr_b16 v[242:243], v65 offset:2560
    v_add_f32_dpp v116, v209, v116 wave_ror:1 row_mask:0xf bank_mask:0xf
    v_add_f32_dpp v120, v210, v120 wave_ror:1 row_mask:0xf bank_mask:0xf
    v_add_f32_dpp v124, v211, v124 wave_ror:1 row_mask:0xf bank_mask:0xf
    v_mfma_f32_32x32x16_bf16 v[160:175], v[228:231], v[216:219], v[160:175]
    buffer_load_dwordx4 v[104:107], v62, s[16:19], s97 offen offset:2048 sc1
    ds_write_b32 v66, v112 offset:768
    ds_write_b32 v66, v116 offset:832
    v_mfma_f32_32x32x16_bf16 v[176:191], v[244:247], v[216:219], v[176:191]
    ds_write_b32 v66, v120 offset:896
    ds_write_b32 v66, v124 offset:960
    v_mfma_f32_32x32x16_bf16 v[192:207], v[212:215], v[216:219], 0
    ds_read_b64_tr_b16 v[212:213], v65 offset:3104
    ds_read_b64_tr_b16 v[214:215], v65 offset:3072
    buffer_load_dwordx4 v[108:111], v62, s[16:19], s97 offen offset:3072 sc1
    s_waitcnt lgkmcnt(6)
    v_mfma_f32_32x32x16_bf16 v[160:175], v[236:239], v[240:243], v[160:175]
    v_mfma_f32_32x32x16_bf16 v[176:191], v[228:231], v[240:243], v[176:191]
    ds_read_b64_tr_b16 v[224:225], v65 offset:3616
    ds_read_b64_tr_b16 v[226:227], v65 offset:3584
    s_waitcnt vmcnt(6) lgkmcnt(4)
    s_barrier
    v_mfma_f32_32x32x16_bf16 v[192:207], v[244:247], v[240:243], v[192:207]
    ds_read_b64_tr_b16 v[244:245], v65 offset:672
    ds_read_b64_tr_b16 v[246:247], v65 offset:640
    ds_read_b64 v[112:113], v67 offset:0
    ds_read_b64 v[114:115], v67 offset:4224
    ds_read_b64 v[116:117], v67 offset:8448
    s_waitcnt lgkmcnt(7)
    v_mfma_f32_32x32x16_bf16 v[176:191], v[236:239], v[212:215], v[176:191]
    ds_read_b128 v[216:219], v64 offset:320
    ds_read_b64_tr_b16 v[240:241], v65 offset:1184
    ds_read_b64_tr_b16 v[242:243], v65 offset:1152
    ds_read_b64 v[118:119], v67 offset:12672
    ds_read_b64 v[120:121], v67 offset:512
    ds_read_b64 v[122:123], v67 offset:4736
    v_mfma_f32_32x32x16_bf16 v[192:207], v[228:231], v[212:215], v[192:207]
    ds_read_b64 v[124:125], v67 offset:8960
    ds_read_b64 v[126:127], v67 offset:13184
    s_lshl_b32 s25, s75, 14
    s_add_u32 s25, s25, 9437184
    s_waitcnt lgkmcnt(13)
    v_mfma_f32_32x32x16_bf16 v[192:207], v[236:239], v[224:227], v[192:207]
    ds_read_b128 v[228:231], v64 offset:192
    ds_read_b64_tr_b16 v[236:237], v65 offset:1696
    ds_read_b64_tr_b16 v[238:239], v65 offset:1664
    s_waitcnt lgkmcnt(14)
    v_mfma_f32_32x32x16_bf16 v[144:159], v[232:235], v[244:247], v[144:159]
    v_mov_b32 v5, 1
    s_add_u32 s82, s86, 24576
    buffer_atomic_add v5, v6, s[16:19], s82 offen offset:0 sc0 sc1
    s_waitcnt lgkmcnt(8)
    v_mfma_f32_32x32x16_bf16 v[144:159], v[216:219], v[240:243], v[144:159]
    v_mfma_f32_32x32x16_bf16 v[160:175], v[232:235], v[240:243], v[160:175]
    ds_read_b128 v[212:215], v64 offset:64
    ds_read_b64_tr_b16 v[224:225], v65 offset:2208
    ds_read_b64_tr_b16 v[226:227], v65 offset:2176
    s_waitcnt lgkmcnt(3)
    v_mfma_f32_32x32x16_bf16 v[144:159], v[228:231], v[236:239], v[144:159]
    v_mfma_f32_32x32x16_bf16 v[160:175], v[216:219], v[236:239], v[160:175]
    v_add_f32 v112, v112, v80
    v_add_f32 v113, v113, v81
    v_add_f32 v114, v114, v82
    v_add_f32 v115, v115, v83
    v_add_f32 v116, v116, v84
    v_mfma_f32_32x32x16_bf16 v[176:191], v[232:235], v[236:239], v[176:191]
    v_add_f32 v117, v117, v85
    v_add_f32 v118, v118, v86
    v_add_f32 v119, v119, v87
    v_cvt_pk_bf16_f32 v128, v112, v114
    v_cvt_pk_bf16_f32 v129, v116, v118
    s_waitcnt lgkmcnt(0)
    v_mfma_f32_32x32x16_bf16 v[144:159], v[212:215], v[224:227], v[144:159]
    ds_read_b64_tr_b16 v[244:245], v65 offset:2720
    ds_read_b64_tr_b16 v[246:247], v65 offset:2688
    v_cvt_pk_bf16_f32 v130, v113, v115
    v_cvt_pk_bf16_f32 v131, v117, v119
    v_mfma_f32_32x32x16_bf16 v[160:175], v[228:231], v[224:227], v[160:175]
    buffer_store_dwordx4 v[128:131], v62, s[16:19], s25 offen offset:0 sc1
    v_add_f32 v120, v120, v88
    v_add_f32 v121, v121, v89
    v_add_f32 v122, v122, v90
    v_add_f32 v123, v123, v91
    v_add_f32 v124, v124, v92
    v_mfma_f32_32x32x16_bf16 v[176:191], v[216:219], v[224:227], v[176:191]
    v_add_f32 v125, v125, v93
    v_add_f32 v126, v126, v94
    v_add_f32_e64 v127, v127, v95
    v_cvt_pk_bf16_f32 v132, v120, v122
    v_cvt_pk_bf16_f32 v133, v124, v126
    v_cvt_pk_bf16_f32 v134, v121, v123
    v_mfma_f32_32x32x16_bf16 v[192:207], v[232:235], v[224:227], v[192:207]
    ds_read_b64_tr_b16 v[232:233], v65 offset:3232
    ds_read_b64_tr_b16 v[234:235], v65 offset:3200
    v_cvt_pk_bf16_f32 v135, v125, v127
    s_waitcnt lgkmcnt(2)
    v_mfma_f32_32x32x16_bf16 v[160:175], v[212:215], v[244:247], v[160:175]
    buffer_store_dwordx4 v[132:135], v62, s[16:19], s25 offen offset:1024 sc1
    ds_read_b64_tr_b16 v[112:113], v65 offset:32
    ds_read_b64_tr_b16 v[114:115], v65 offset:0
    ds_read_b64_tr_b16 v[116:117], v65 offset:160
    ds_read_b64_tr_b16 v[118:119], v65 offset:128
    ds_read_b64_tr_b16 v[120:121], v65 offset:288
    v_mfma_f32_32x32x16_bf16 v[176:191], v[228:231], v[244:247], v[176:191]
    ds_read_b64_tr_b16 v[240:241], v65 offset:3744
    ds_read_b64_tr_b16 v[242:243], v65 offset:3712
    ds_read_b64_tr_b16 v[122:123], v65 offset:256
    ds_read_b64_tr_b16 v[124:125], v65 offset:416
    ds_read_b64_tr_b16 v[126:127], v65 offset:384
    ds_read_b64_tr_b16 v[128:129], v65 offset:544
    v_mfma_f32_32x32x16_bf16 v[192:207], v[216:219], v[244:247], v[192:207]
    ds_read_b128 v[216:219], v64 offset:416
    ds_read_b64_tr_b16 v[236:237], v65 offset:800
    ds_read_b64_tr_b16 v[238:239], v65 offset:768
    ds_read_b64_tr_b16 v[130:131], v65 offset:512
    ds_read_b64_tr_b16 v[132:133], v65 offset:672
    s_waitcnt lgkmcnt(15)
    v_mfma_f32_32x32x16_bf16 v[176:191], v[212:215], v[232:235], v[176:191]
    ds_read_b128 v[224:227], v64 offset:288
    ds_read_b64_tr_b16 v[244:245], v65 offset:1312
    ds_read_b64_tr_b16 v[246:247], v65 offset:1280
    ds_read_b64_tr_b16 v[134:135], v65 offset:640
    ds_read_b64_tr_b16 v[136:137], v65 offset:800
    ds_read_b64_tr_b16 v[138:139], v65 offset:768
    v_mfma_f32_32x32x16_bf16 v[192:207], v[228:231], v[232:235], v[192:207]
    ds_read_b64_tr_b16 v[140:141], v65 offset:928
    ds_read_b64_tr_b16 v[142:143], v65 offset:896
    s_waitcnt lgkmcnt(15)
    v_mfma_f32_32x32x16_bf16 v[192:207], v[212:215], v[240:243], v[192:207]
    ds_read_b128 v[228:231], v64 offset:160
    ds_read_b64_tr_b16 v[212:213], v65 offset:1824
    ds_read_b64_tr_b16 v[214:215], v65 offset:1792
    s_waitcnt vmcnt(3)
ce_31:
    v_max3_u32 v208, v248, v249, v250
    v_max3_u32 v208, v208, v251, v252
    v_max3_u32 v208, v208, v253, v254
    v_max_u32_e64 v208, v208, v255
    v_cmp_eq_u32 s[82:83], -1, v208
    v_min3_f32 v209, v96, v99, v100
    v_min3_f32 v209, v209, v103, v104
    v_min3_f32 v209, v209, v107, v108
    v_min_f32 v209, v209, v111
    v_cmp_neq_f32 vcc, 0x41000000, v209
    s_nop 0
    s_or_b64 vcc, vcc, s[82:83]
    s_cbranch_vccnz rd_32
rc_33:
    s_waitcnt lgkmcnt(13)
    v_mfma_f32_32x32x16_bf16 v[144:159], v[216:219], v[236:239], v[144:159]
    v_mul_f32 v208, 0x3acccccd, v97
    v_mul_f32 v209, 0x3acccccd, v101
    v_mul_f32 v98, 0x3acccccd, v98
    v_mul_f32 v102, 0x3acccccd, v102
    v_fma_f32 v98, -v208, v208, v98
    s_waitcnt lgkmcnt(8)
    v_mfma_f32_32x32x16_bf16 v[144:159], v[224:227], v[244:247], v[144:159]
    v_fma_f32 v102, -v209, v209, v102
    v_max_f32 v98, 0, v98
    v_max_f32 v102, 0, v102
    v_add_f32 v98, 0x3727c5ac, v98
    v_add_f32 v102, 0x3727c5ac, v102
    v_mfma_f32_32x32x16_bf16 v[160:175], v[216:219], v[244:247], v[160:175]
    ds_read_b64_tr_b16 v[232:233], v65 offset:2336
    ds_read_b64_tr_b16 v[234:235], v65 offset:2304
    v_rsq_f32 v97, v98
    s_waitcnt lgkmcnt(2)
    v_mfma_f32_32x32x16_bf16 v[144:159], v[228:231], v[212:215], v[144:159]
    v_rsq_f32_e64 v101, v102
    v_mul_f32 v98, -v208, v97
    v_mul_f32 v102, -v209, v101
    v_lshlrev_b32_e64 v80, 16, v248
    v_and_b32 v82, 0xffff0000, v248
    v_mfma_f32_32x32x16_bf16 v[160:175], v[224:227], v[212:215], v[160:175]
    v_lshlrev_b32 v84, 16, v249
    v_and_b32 v86, 0xffff0000, v249
    v_lshlrev_b32 v81, 16, v250
    v_and_b32 v83, 0xffff0000, v250
    v_lshlrev_b32_e64 v85, 16, v251
    v_and_b32 v87, 0xffff0000, v251
    v_mfma_f32_32x32x16_bf16 v[176:191], v[216:219], v[212:215], v[176:191]
    v_fma_f32 v208, v80, v97, v98
    v_fma_f32 v209, v81, v101, v102
    v_cvt_pk_bf16_f32 v248, v208, v209
    v_fma_f32 v208, v82, v97, v98
    v_fma_f32 v209, v83, v101, v102
    s_waitcnt lgkmcnt(0)
    v_mfma_f32_32x32x16_bf16 v[144:159], v[220:223], v[232:235], v[144:159]
    ds_read_b64_tr_b16 v[240:241], v65 offset:2848
    ds_read_b64_tr_b16 v[242:243], v65 offset:2816
    v_cvt_pk_bf16_f32 v249, v208, v209
    v_fma_f32 v208, v84, v97, v98
    v_fma_f32 v209, v85, v101, v102
    v_cvt_pk_bf16_f32 v250, v208, v209
    v_mfma_f32_32x32x16_bf16 v[160:175], v[228:231], v[232:235], v[160:175]
    v_fma_f32 v208, v86, v97, v98
    v_fma_f32 v209, v87, v101, v102
    v_cvt_pk_bf16_f32 v251, v208, v209
    v_mfma_f32_32x32x16_bf16 v[176:191], v[224:227], v[232:235], v[176:191]
    ds_write_b32 v63, v248 offset:512
    ds_write_b32 v63, v249 offset:5376
    ds_write_b32 v63, v250 offset:10240
    v_mfma_f32_32x32x16_bf16 v[192:207], v[216:219], v[232:235], v[192:207]
    ds_read_b64_tr_b16 v[216:217], v65 offset:3360
    ds_read_b64_tr_b16 v[218:219], v65 offset:3328
    ds_write_b32 v63, v251 offset:15104
    v_mul_f32 v208, 0x3acccccd, v105
    s_waitcnt lgkmcnt(6)
    v_mfma_f32_32x32x16_bf16 v[160:175], v[220:223], v[240:243], v[160:175]
    v_mul_f32 v209, 0x3acccccd, v109
    v_mul_f32 v106, 0x3acccccd, v106
    v_mul_f32 v110, 0x3acccccd, v110
    v_fma_f32 v106, -v208, v208, v106
    v_fma_f32 v110, -v209, v209, v110
    v_max_f32_e64 v106, 0, v106
    v_mfma_f32_32x32x16_bf16 v[176:191], v[228:231], v[240:243], v[176:191]
    ds_read_b64_tr_b16 v[236:237], v65 offset:3872
    ds_read_b64_tr_b16 v[238:239], v65 offset:3840
    v_max_f32_e64 v110, 0, v110
    v_add_f32 v106, 0x3727c5ac, v106
    v_add_f32 v110, 0x3727c5ac, v110
    v_mfma_f32_32x32x16_bf16 v[192:207], v[224:227], v[240:243], v[192:207]
    ds_read_b128 v[224:227], v64 offset:384
    ds_read_b64_tr_b16 v[244:245], v65 offset:928
    ds_read_b64_tr_b16 v[246:247], v65 offset:896
    v_rsq_f32 v105, v106
    s_waitcnt lgkmcnt(6)
    v_mfma_f32_32x32x16_bf16 v[176:191], v[220:223], v[216:219], v[176:191]
    ds_read_b128 v[212:215], v64 offset:256
    ds_read_b64_tr_b16 v[232:233], v65 offset:1440
    ds_read_b64_tr_b16 v[234:235], v65 offset:1408
    v_rsq_f32_e64 v109, v110
    v_mul_f32 v106, -v208, v105
    v_mfma_f32_32x32x16_bf16 v[192:207], v[228:231], v[216:219], v[192:207]
    v_mul_f32 v110, -v209, v109
    v_lshlrev_b32 v88, 16, v252
    v_and_b32 v90, 0xffff0000, v252
    v_lshlrev_b32 v92, 16, v253
    v_and_b32 v94, 0xffff0000, v253
    s_waitcnt lgkmcnt(6)
    v_mfma_f32_32x32x16_bf16 v[192:207], v[220:223], v[236:239], v[192:207]
    ds_read_b128 v[220:223], v64 offset:128
    ds_read_b64_tr_b16 v[228:229], v65 offset:1952
    ds_read_b64_tr_b16 v[230:231], v65 offset:1920
    v_lshlrev_b32 v89, 16, v254
    v_and_b32 v91, 0xffff0000, v254
    s_waitcnt lgkmcnt(6)
    v_mfma_f32_32x32x16_bf16 v[144:159], v[224:227], v[244:247], v[144:159]
    v_lshlrev_b32 v93, 16, v255
    v_and_b32 v95, 0xffff0000, v255
    v_fma_f32 v208, v88, v105, v106
    v_fma_f32 v209, v89, v109, v110
    v_cvt_pk_bf16_f32 v252, v208, v209
    s_waitcnt lgkmcnt(3)
    v_mfma_f32_32x32x16_bf16 v[144:159], v[212:215], v[232:235], v[144:159]
    v_fma_f32 v208, v90, v105, v106
    v_fma_f32 v209, v91, v109, v110
    v_cvt_pk_bf16_f32 v253, v208, v209
    v_fma_f32 v208, v92, v105, v106
    v_fma_f32 v209, v93, v109, v110
    v_cvt_pk_bf16_f32 v254, v208, v209
    v_mfma_f32_32x32x16_bf16 v[160:175], v[224:227], v[232:235], v[160:175]
    ds_read_b128 v[240:243], v64 offset:0
    ds_read_b64_tr_b16 v[216:217], v65 offset:2464
    ds_read_b64_tr_b16 v[218:219], v65 offset:2432
    v_fma_f32 v208, v94, v105, v106
    v_fma_f32 v209, v95, v109, v110
    s_waitcnt lgkmcnt(3)
    v_mfma_f32_32x32x16_bf16 v[144:159], v[220:223], v[228:231], v[144:159]
    v_cvt_pk_bf16_f32 v255, v208, v209
    ds_write_b32 v63, v252 offset:768
    v_mfma_f32_32x32x16_bf16 v[160:175], v[212:215], v[228:231], v[160:175]
    ds_write_b32 v63, v253 offset:5632
    ds_write_b32 v63, v254 offset:10496
    ds_write_b32 v63, v255 offset:15360
    v_mfma_f32_32x32x16_bf16 v[176:191], v[224:227], v[228:231], v[176:191]
    s_waitcnt vmcnt(2)
    v_cmp_eq_u32 vcc, 19, v5
    s_nop 0
    s_cbranch_vccnz gl_34
gc_35:
    s_lshl_b32 s25, s72, 5
    s_add_u32 s25, s25, 0
    s_sub_u32 s26, s25, 4
    s_waitcnt lgkmcnt(4)
    v_mfma_f32_32x32x16_bf16 v[144:159], v[240:243], v[216:219], v[144:159]
    ds_read_b64_tr_b16 v[236:237], v65 offset:2976
    ds_read_b64_tr_b16 v[238:239], v65 offset:2944
    s_max_i32 s26, s26, 0
    s_lshl_b32 s27, s71, 12
    s_add_u32 s27, s27, 9437184
    s_lshl_b32 s99, s25, 3
    v_mfma_f32_32x32x16_bf16 v[160:175], v[220:223], v[216:219], v[160:175]
    s_lshl_b32 s100, s26, 3
    s_lshl_b32 s92, s24, 12
    s_lshl_b32 s93, s24, 9
    s_add_u32 s99, s99, s27
    s_add_u32 s100, s100, s27
    v_mfma_f32_32x32x16_bf16 v[176:191], v[212:215], v[216:219], v[176:191]
    v_mfma_f32_32x32x16_bf16 v[192:207], v[224:227], v[216:219], v[192:207]
    ds_read_b64_tr_b16 v[224:225], v65 offset:3488
    ds_read_b64_tr_b16 v[226:227], v65 offset:3456
    s_waitcnt lgkmcnt(2)
    v_mfma_f32_32x32x16_bf16 v[160:175], v[240:243], v[236:239], v[160:175]
    v_mfma_f32_32x32x16_bf16 v[176:191], v[220:223], v[236:239], v[176:191]
    ds_read_b64_tr_b16 v[244:245], v65 offset:4000
    ds_read_b64_tr_b16 v[246:247], v65 offset:3968
    v_mfma_f32_32x32x16_bf16 v[192:207], v[212:215], v[236:239], v[192:207]
    s_waitcnt lgkmcnt(2)
    v_mfma_f32_32x32x16_bf16 v[176:191], v[240:243], v[224:227], v[176:191]
    v_mfma_f32_32x32x16_bf16 v[192:207], v[220:223], v[224:227], v[192:207]
    s_waitcnt lgkmcnt(0)
    v_mfma_f32_32x32x16_bf16 v[192:207], v[240:243], v[244:247], v[192:207]
    s_waitcnt lgkmcnt(0)
    s_barrier
    ds_read_b128 v[212:215], v64 offset:608
    ds_read_b128 v[216:219], v64 offset:576
    ds_read_b128 v[220:223], v64 offset:544
    ds_read_b128 v[224:227], v64 offset:512
    s_waitcnt lgkmcnt(3)
    v_mfma_f32_32x32x16_bf16 v[144:159], v[212:215], v[112:115], v[144:159]
    ds_read_b128 v[228:231], v64 offset:736
    s_waitcnt lgkmcnt(3)
    v_mfma_f32_32x32x16_bf16 v[144:159], v[216:219], v[116:119], v[144:159]
    ds_read_b128 v[232:235], v64 offset:704
    s_waitcnt lgkmcnt(3)
    v_mfma_f32_32x32x16_bf16 v[144:159], v[220:223], v[120:123], v[144:159]
    ds_read_b128 v[236:239], v64 offset:672
    s_waitcnt lgkmcnt(3)
    v_mfma_f32_32x32x16_bf16 v[144:159], v[224:227], v[124:127], v[144:159]
    ds_read_b128 v[240:243], v64 offset:640
    s_nop 3
    s_waitcnt lgkmcnt(3)
    v_mfma_f32_32x32x16_bf16 v[160:175], v[228:231], v[112:115], v[160:175]
    s_nop 4
    s_waitcnt lgkmcnt(2)
    v_mfma_f32_32x32x16_bf16 v[160:175], v[232:235], v[116:119], v[160:175]
    v_cndmask_b32 v208, v147, v72, s[76:77]
    v_cndmask_b32 v209, v151, v147, s[76:77]
    v_cndmask_b32 v210, v155, v151, s[76:77]
    v_cndmask_b32 v211, v159, v155, s[76:77]
    v_mov_b32_e64 v72, v159
    s_waitcnt lgkmcnt(1)
    v_mfma_f32_32x32x16_bf16 v[160:175], v[236:239], v[120:123], v[160:175]
    v_add_f32_dpp v146, v208, v146 wave_ror:1 row_mask:0xf bank_mask:0xf
    v_add_f32_dpp v150, v209, v150 wave_ror:1 row_mask:0xf bank_mask:0xf
    v_add_f32_dpp v154, v210, v154 wave_ror:1 row_mask:0xf bank_mask:0xf
    v_add_f32_dpp v158, v211, v158 wave_ror:1 row_mask:0xf bank_mask:0xf
    v_cndmask_b32 v208, v146, v71, s[76:77]
    s_waitcnt lgkmcnt(0)
    v_mfma_f32_32x32x16_bf16 v[160:175], v[240:243], v[124:127], v[160:175]
    v_cndmask_b32 v209, v150, v146, s[76:77]
    v_cndmask_b32 v210, v154, v150, s[76:77]
    v_cndmask_b32 v211, v158, v154, s[76:77]
    v_mov_b32 v71, v158
    v_add_f32_dpp v145, v208, v145 wave_ror:1 row_mask:0xf bank_mask:0xf
    v_add_f32_dpp v149, v209, v149 wave_ror:1 row_mask:0xf bank_mask:0xf
    v_mfma_f32_32x32x16_bf16 v[160:175], v[212:215], v[128:131], v[160:175]
    ds_read_b128 v[244:247], v64 offset:864
    v_add_f32_dpp v153, v210, v153 wave_ror:1 row_mask:0xf bank_mask:0xf
    v_add_f32_dpp v157, v211, v157 wave_ror:1 row_mask:0xf bank_mask:0xf
    v_cndmask_b32 v208, v145, v70, s[76:77]
    v_cndmask_b32 v209, v149, v145, s[76:77]
    v_cndmask_b32 v210, v153, v149, s[76:77]
    v_mfma_f32_32x32x16_bf16 v[160:175], v[216:219], v[132:135], v[160:175]
    ds_read_b128 v[248:251], v64 offset:832
    v_cndmask_b32 v211, v157, v153, s[76:77]
    v_mov_b32_e64 v70, v157
    v_add_f32_dpp v144, v208, v144 wave_ror:1 row_mask:0xf bank_mask:0xf
    v_add_f32_dpp v148, v209, v148 wave_ror:1 row_mask:0xf bank_mask:0xf
    v_add_f32_dpp v152, v210, v152 wave_ror:1 row_mask:0xf bank_mask:0xf
    v_mfma_f32_32x32x16_bf16 v[160:175], v[220:223], v[136:139], v[160:175]
    ds_read_b128 v[252:255], v64 offset:800
    v_add_f32_dpp v156, v211, v156 wave_ror:1 row_mask:0xf bank_mask:0xf
    ds_write_b32 v66, v144 offset:0
    v_mfma_f32_32x32x16_bf16 v[160:175], v[224:227], v[140:143], v[160:175]
    ds_read_b128 v[224:227], v64 offset:768
    ds_write_b32 v66, v148 offset:64
    ds_write_b32 v66, v152 offset:128
    s_waitcnt lgkmcnt(6)
    v_mfma_f32_32x32x16_bf16 v[176:191], v[244:247], v[112:115], v[176:191]
    ds_write_b32 v66, v156 offset:192
    buffer_load_dword v7, v4, s[16:19], s89 offen offset:0 sc1
    s_nop 1
    s_waitcnt lgkmcnt(6)
    v_mfma_f32_32x32x16_bf16 v[176:191], v[248:251], v[116:119], v[176:191]
    s_nop 2
    v_cndmask_b32 v208, v163, v72, s[76:77]
    v_cndmask_b32 v209, v167, v163, s[76:77]
    s_waitcnt lgkmcnt(5)
    v_mfma_f32_32x32x16_bf16 v[176:191], v[252:255], v[120:123], v[176:191]
    v_cndmask_b32 v210, v171, v167, s[76:77]
    v_cndmask_b32 v211, v175, v171, s[76:77]
    v_mov_b32 v72, v175
    v_add_f32_dpp v162, v208, v162 wave_ror:1 row_mask:0xf bank_mask:0xf
    v_add_f32_dpp v166, v209, v166 wave_ror:1 row_mask:0xf bank_mask:0xf
    s_waitcnt lgkmcnt(3)
    v_mfma_f32_32x32x16_bf16 v[176:191], v[224:227], v[124:127], v[176:191]
    v_add_f32_dpp v170, v210, v170 wave_ror:1 row_mask:0xf bank_mask:0xf
    v_add_f32_dpp v174, v211, v174 wave_ror:1 row_mask:0xf bank_mask:0xf
    v_cndmask_b32 v208, v162, v71, s[76:77]
    v_cndmask_b32 v209, v166, v162, s[76:77]
    v_cndmask_b32 v210, v170, v166, s[76:77]
    v_cndmask_b32 v211, v174, v170, s[76:77]
    v_mfma_f32_32x32x16_bf16 v[176:191], v[228:231], v[128:131], v[176:191]
    ds_read_b64_tr_b16 v[228:229], v65 offset:1056
    ds_read_b64_tr_b16 v[230:231], v65 offset:1024
    v_mov_b32 v71, v174
    v_add_f32_dpp v161, v208, v161 wave_ror:1 row_mask:0xf bank_mask:0xf
    v_add_f32_dpp v165, v209, v165 wave_ror:1 row_mask:0xf bank_mask:0xf
    v_add_f32_dpp v169, v210, v169 wave_ror:1 row_mask:0xf bank_mask:0xf
    v_mfma_f32_32x32x16_bf16 v[176:191], v[232:235], v[132:135], v[176:191]
    ds_read_b64_tr_b16 v[232:233], v65 offset:1184
    ds_read_b64_tr_b16 v[234:235], v65 offset:1152
    v_add_f32_dpp v173, v211, v173 wave_ror:1 row_mask:0xf bank_mask:0xf
    v_cndmask_b32 v208, v161, v70, s[76:77]
    v_cndmask_b32 v209, v165, v161, s[76:77]
    v_cndmask_b32 v210, v169, v165, s[76:77]
    v_mfma_f32_32x32x16_bf16 v[176:191], v[236:239], v[136:139], v[176:191]
    ds_read_b64_tr_b16 v[236:237], v65 offset:1312
    ds_read_b64_tr_b16 v[238:239], v65 offset:1280
    v_cndmask_b32 v211, v173, v169, s[76:77]
    v_mov_b32_e64 v70, v173
    v_add_f32_dpp v160, v208, v160 wave_ror:1 row_mask:0xf bank_mask:0xf
    v_add_f32_dpp v164, v209, v164 wave_ror:1 row_mask:0xf bank_mask:0xf
    v_mfma_f32_32x32x16_bf16 v[176:191], v[240:243], v[140:143], v[176:191]
    ds_read_b128 v[240:243], v64 offset:512
    ds_read_b64_tr_b16 v[224:225], v65 offset:1440
    ds_read_b64_tr_b16 v[226:227], v65 offset:1408
    v_add_f32_dpp v168, v210, v168 wave_ror:1 row_mask:0xf bank_mask:0xf
    v_add_f32_dpp v172, v211, v172 wave_ror:1 row_mask:0xf bank_mask:0xf
    s_waitcnt lgkmcnt(7)
    v_mfma_f32_32x32x16_bf16 v[176:191], v[212:215], v[228:231], v[176:191]
    ds_read_b128 v[212:215], v64 offset:992
    ds_write_b32 v66, v160 offset:256
    ds_write_b32 v66, v164 offset:320
    s_waitcnt lgkmcnt(8)
    v_mfma_f32_32x32x16_bf16 v[176:191], v[216:219], v[232:235], v[176:191]
    ds_read_b128 v[216:219], v64 offset:960
    ds_write_b32 v66, v168 offset:384
    ds_write_b32 v66, v172 offset:448
    s_waitcnt lgkmcnt(9)
    v_mfma_f32_32x32x16_bf16 v[176:191], v[220:223], v[236:239], v[176:191]
    ds_read_b128 v[220:223], v64 offset:928
    s_waitcnt lgkmcnt(7)
    v_mfma_f32_32x32x16_bf16 v[176:191], v[240:243], v[224:227], v[176:191]
    ds_read_b128 v[240:243], v64 offset:896
    s_waitcnt lgkmcnt(2)
    s_waitcnt vmcnt(0)
    v_cmp_gt_u32_e64 vcc, 1, v7
    s_nop 0
    s_and_b64 vcc, vcc, s[50:51]
    s_cbranch_scc1 ps_36
pc_38:
    s_barrier
    v_mfma_f32_32x32x16_bf16 v[192:207], v[212:215], v[112:115], v[192:207]
    ds_read_b64 v[144:145], v67 offset:0
    ds_read_b64 v[146:147], v67 offset:4224
    ds_read_b64 v[148:149], v67 offset:8448
    ds_read_b64 v[150:151], v67 offset:12672
    s_lshl_b32 s25, s75, 14
    v_mfma_f32_32x32x16_bf16 v[192:207], v[216:219], v[116:119], v[192:207]
    s_add_u32 s25, s25, 9437184
    s_add_u32 m0, s92, 36352
    s_nop 0
    buffer_load_dwordx4 v73, s[16:19], s99 offen offset:0 sc1 lds
    buffer_load_dwordx4 v74, s[16:19], s99 offen offset:1024 sc1 lds
    buffer_load_dwordx4 v75, s[16:19], s99 offen offset:2048 sc1 lds
    s_waitcnt lgkmcnt(5)
    v_mfma_f32_32x32x16_bf16 v[192:207], v[220:223], v[120:123], v[192:207]
    buffer_load_dwordx4 v76, s[16:19], s99 offen offset:3072 sc1 lds
    s_waitcnt lgkmcnt(4)
    v_mfma_f32_32x32x16_bf16 v[192:207], v[240:243], v[124:127], v[192:207]
    ds_read_b128 v[212:215], v64 offset:768
    s_add_u32 m0, s93, 53760
    s_add_u32 s99, s99, 524288
    s_mov_b64 exec, s[80:81]
    buffer_load_dwordx4 v77, s[16:19], s100 offen sc1 lds
    s_mov_b64 exec, -1
    s_add_u32 s100, s100, 524288
    v_mfma_f32_32x32x16_bf16 v[192:207], v[244:247], v[128:131], v[192:207]
    ds_read_b128 v[244:247], v64 offset:736
    v_cndmask_b32 v208, v179, v72, s[76:77]
    v_cndmask_b32 v209, v183, v179, s[76:77]
    v_cndmask_b32 v210, v187, v183, s[76:77]
    v_cndmask_b32 v211, v191, v187, s[76:77]
    v_mov_b32_e64 v72, v191
    v_mfma_f32_32x32x16_bf16 v[192:207], v[248:251], v[132:135], v[192:207]
    ds_read_b128 v[248:251], v64 offset:704
    v_add_f32_dpp v178, v208, v178 wave_ror:1 row_mask:0xf bank_mask:0xf
    v_add_f32_dpp v182, v209, v182 wave_ror:1 row_mask:0xf bank_mask:0xf
    v_add_f32_dpp v186, v210, v186 wave_ror:1 row_mask:0xf bank_mask:0xf
    v_add_f32_dpp v190, v211, v190 wave_ror:1 row_mask:0xf bank_mask:0xf
    v_cndmask_b32 v208, v178, v71, s[76:77]
    v_mfma_f32_32x32x16_bf16 v[192:207], v[252:255], v[136:139], v[192:207]
    ds_read_b128 v[252:255], v64 offset:672
    v_cndmask_b32 v209, v182, v178, s[76:77]
    v_cndmask_b32 v210, v186, v182, s[76:77]
    v_cndmask_b32 v211, v190, v186, s[76:77]
    v_mov_b32 v71, v190
    s_waitcnt lgkmcnt(3)
    v_mfma_f32_32x32x16_bf16 v[192:207], v[212:215], v[140:143], v[192:207]
    ds_read_b128 v[216:219], v64 offset:640
    v_add_f32_dpp v177, v208, v177 wave_ror:1 row_mask:0xf bank_mask:0xf
    v_add_f32_dpp v181, v209, v181 wave_ror:1 row_mask:0xf bank_mask:0xf
    v_add_f32_dpp v185, v210, v185 wave_ror:1 row_mask:0xf bank_mask:0xf
    v_add_f32_dpp v189, v211, v189 wave_ror:1 row_mask:0xf bank_mask:0xf
    s_waitcnt lgkmcnt(3)
    v_mfma_f32_32x32x16_bf16 v[192:207], v[244:247], v[228:231], v[192:207]
    ds_read_b128 v[228:231], v64 offset:608
    ds_read_b64_tr_b16 v[220:221], v65 offset:1568
    ds_read_b64_tr_b16 v[222:223], v65 offset:1536
    v_cndmask_b32 v208, v177, v70, s[76:77]
    v_cndmask_b32 v209, v181, v177, s[76:77]
    s_waitcnt lgkmcnt(5)
    v_mfma_f32_32x32x16_bf16 v[192:207], v[248:251], v[232:235], v[192:207]
    ds_read_b128 v[232:235], v64 offset:576
    ds_read_b64_tr_b16 v[240:241], v65 offset:1696
    ds_read_b64_tr_b16 v[242:243], v65 offset:1664
    v_cndmask_b32 v210, v185, v181, s[76:77]
    v_cndmask_b32 v211, v189, v185, s[76:77]
    s_waitcnt lgkmcnt(7)
    v_mfma_f32_32x32x16_bf16 v[192:207], v[252:255], v[236:239], v[192:207]
    ds_read_b128 v[236:239], v64 offset:544
    ds_read_b64_tr_b16 v[212:213], v65 offset:1824
    ds_read_b64_tr_b16 v[214:215], v65 offset:1792
    v_mov_b32 v70, v189
    v_add_f32_dpp v176, v208, v176 wave_ror:1 row_mask:0xf bank_mask:0xf
    s_waitcnt lgkmcnt(9)
    v_mfma_f32_32x32x16_bf16 v[192:207], v[216:219], v[224:227], v[192:207]
    ds_read_b128 v[224:227], v64 offset:512
    ds_read_b64_tr_b16 v[244:245], v65 offset:1952
    ds_read_b64_tr_b16 v[246:247], v65 offset:1920
    v_add_f32_dpp v180, v209, v180 wave_ror:1 row_mask:0xf bank_mask:0xf
    v_add_f32_dpp v184, v210, v184 wave_ror:1 row_mask:0xf bank_mask:0xf
    s_waitcnt lgkmcnt(9)
    v_mfma_f32_32x32x16_bf16 v[192:207], v[228:231], v[220:223], v[192:207]
    v_add_f32_dpp v188, v211, v188 wave_ror:1 row_mask:0xf bank_mask:0xf
    ds_write_b32 v66, v176 offset:512
    s_waitcnt lgkmcnt(7)
    v_mfma_f32_32x32x16_bf16 v[192:207], v[232:235], v[240:243], v[192:207]
    ds_write_b32 v66, v180 offset:576
    ds_write_b32 v66, v184 offset:640
    s_waitcnt lgkmcnt(6)
    v_mfma_f32_32x32x16_bf16 v[192:207], v[236:239], v[212:215], v[192:207]
    ds_write_b32 v66, v188 offset:704
    v_add_f32 v144, v144, v80
    v_add_f32 v145, v145, v81
    s_waitcnt lgkmcnt(4)
    v_mfma_f32_32x32x16_bf16 v[192:207], v[224:227], v[244:247], v[192:207]
    v_add_f32 v146, v146, v82
    v_add_f32 v147, v147, v83
    v_add_f32 v148, v148, v84
    v_add_f32 v149, v149, v85
    v_add_f32 v150, v150, v86
    v_add_f32_e64 v151, v151, v87
    v_cvt_pk_bf16_f32 v160, v144, v146
    v_cvt_pk_bf16_f32 v161, v148, v150
    v_cvt_pk_bf16_f32 v162, v145, v147
    v_cvt_pk_bf16_f32 v163, v149, v151
    buffer_store_dwordx4 v[160:163], v62, s[16:19], s25 offen offset:2048 sc1
    s_add_u32 m0, s92, 55936
    s_nop 0
    s_nop 0
    buffer_load_dwordx4 v73, s[16:19], s99 offen offset:0 sc1 lds
    buffer_load_dwordx4 v74, s[16:19], s99 offen offset:1024 sc1 lds
    buffer_load_dwordx4 v75, s[16:19], s99 offen offset:2048 sc1 lds
    buffer_load_dwordx4 v76, s[16:19], s99 offen offset:3072 sc1 lds
    s_add_u32 m0, s93, 73344
    s_add_u32 s99, s99, 524288
    s_mov_b64 exec, s[80:81]
    buffer_load_dwordx4 v77, s[16:19], s100 offen sc1 lds
    s_mov_b64 exec, -1
    s_add_u32 s100, s100, 524288
    s_add_u32 m0, s92, 75520
    s_nop 0
    s_nop 0
    buffer_load_dwordx4 v73, s[16:19], s99 offen offset:0 sc1 lds
    buffer_load_dwordx4 v74, s[16:19], s99 offen offset:1024 sc1 lds
    buffer_load_dwordx4 v75, s[16:19], s99 offen offset:2048 sc1 lds
    buffer_load_dwordx4 v76, s[16:19], s99 offen offset:3072 sc1 lds
    s_add_u32 m0, s93, 92928
    s_add_u32 s99, s99, 524288
    s_mov_b64 exec, s[80:81]
    buffer_load_dwordx4 v77, s[16:19], s100 offen sc1 lds
    s_mov_b64 exec, -1
    s_add_u32 s100, s100, 524288
    v_cndmask_b32 v208, v195, v72, s[76:77]
    v_cndmask_b32 v209, v199, v195, s[76:77]
    v_cndmask_b32 v210, v203, v199, s[76:77]
    v_cndmask_b32 v211, v207, v203, s[76:77]
    v_mov_b32_e64 v72, v207
    v_add_f32_dpp v194, v208, v194 wave_ror:1 row_mask:0xf bank_mask:0xf
    v_add_f32_dpp v198, v209, v198 wave_ror:1 row_mask:0xf bank_mask:0xf
    v_add_f32_dpp v202, v210, v202 wave_ror:1 row_mask:0xf bank_mask:0xf
    v_add_f32_dpp v206, v211, v206 wave_ror:1 row_mask:0xf bank_mask:0xf
    v_cndmask_b32 v208, v194, v71, s[76:77]
    v_cndmask_b32 v209, v198, v194, s[76:77]
    v_cndmask_b32 v210, v202, v198, s[76:77]
    v_cndmask_b32 v211, v206, v202, s[76:77]
    v_mov_b32_e64 v71, v206
    v_add_f32_dpp v193, v208, v193 wave_ror:1 row_mask:0xf bank_mask:0xf
    v_add_f32_dpp v197, v209, v197 wave_ror:1 row_mask:0xf bank_mask:0xf
    v_add_f32_dpp v201, v210, v201 wave_ror:1 row_mask:0xf bank_mask:0xf
    v_add_f32_dpp v205, v211, v205 wave_ror:1 row_mask:0xf bank_mask:0xf
    v_cndmask_b32 v208, v193, v70, s[76:77]
    v_cndmask_b32 v209, v197, v193, s[76:77]
    v_cndmask_b32 v210, v201, v197, s[76:77]
    v_cndmask_b32 v211, v205, v201, s[76:77]
    v_mov_b32_e64 v70, v205
    v_add_f32_dpp v192, v208, v192 wave_ror:1 row_mask:0xf bank_mask:0xf
    v_add_f32_dpp v196, v209, v196 wave_ror:1 row_mask:0xf bank_mask:0xf
    v_add_f32_dpp v200, v210, v200 wave_ror:1 row_mask:0xf bank_mask:0xf
    v_add_f32_dpp v204, v211, v204 wave_ror:1 row_mask:0xf bank_mask:0xf
    ds_write_b32 v66, v192 offset:768
    ds_write_b32 v66, v196 offset:832
    ds_write_b32 v66, v200 offset:896
    ds_write_b32 v66, v204 offset:960
    s_waitcnt lgkmcnt(0)
    s_barrier
    ds_read_b64 v[152:153], v67 offset:512
    ds_read_b64 v[154:155], v67 offset:4736
    ds_read_b64 v[156:157], v67 offset:8960
    ds_read_b64 v[158:159], v67 offset:13184
    s_lshl_b32 s25, s75, 14
    s_add_u32 s25, s25, 9437184
    s_waitcnt lgkmcnt(0)
    v_add_f32 v152, v152, v88
    v_add_f32 v153, v153, v89
    v_add_f32 v154, v154, v90
    v_add_f32 v155, v155, v91
    v_add_f32 v156, v156, v92
    v_add_f32 v157, v157, v93
    v_add_f32 v158, v158, v94
    v_add_f32 v159, v159, v95
    v_cvt_pk_bf16_f32 v164, v152, v154
    v_cvt_pk_bf16_f32 v165, v156, v158
    v_cvt_pk_bf16_f32 v166, v153, v155
    v_cvt_pk_bf16_f32 v167, v157, v159
    buffer_store_dwordx4 v[164:167], v62, s[16:19], s25 offen offset:3072 sc1
    v_mov_b32_e64 v5, 1
    s_add_u32 s82, s86, 24576
    buffer_atomic_add v5, v6, s[16:19], s82 offen offset:4 sc0 sc1
    s_branch ec_27
nc_26:
    v_lshlrev_b32 v2, 3, v4
    v_mov_b32_e64 v5, 1
    v_cndmask_b32 v2, v4, v2, s[50:51]
    buffer_atomic_add v5, v2, s[16:19], s86 offen offset:8 sc1
    buffer_load_dword v7, v4, s[16:19], s87 offen offset:8 sc1
    s_waitcnt vmcnt(0)
    v_cmp_gt_u32 vcc, 12, v7
    s_nop 0
    s_and_b64 vcc, vcc, s[50:51]
    s_cbranch_scc1 ps_39
pc_41:
    v_mov_b32 v100, -1
    v_mov_b32 v101, -1
    v_mov_b32 v102, -1
    v_mov_b32 v103, -1
    v_lshlrev_b32 v104, 4, v0
    s_sub_u32 s88, s2, 160
    s_mul_i32 s88, s88, 57344
    s_min_u32 s88, s88, 5185536
    s_add_u32 s88, s88, 12058624
    buffer_store_dwordx4 v[100:103], v104, s[16:19], s88 offen sc1
    s_add_u32 s88, s88, 4096
    buffer_store_dwordx4 v[100:103], v104, s[16:19], s88 offen sc1
    s_add_u32 s88, s88, 4096
    buffer_store_dwordx4 v[100:103], v104, s[16:19], s88 offen sc1
    s_add_u32 s88, s88, 4096
    buffer_store_dwordx4 v[100:103], v104, s[16:19], s88 offen sc1
    s_add_u32 s88, s88, 4096
    buffer_store_dwordx4 v[100:103], v104, s[16:19], s88 offen sc1
    s_add_u32 s88, s88, 4096
    buffer_store_dwordx4 v[100:103], v104, s[16:19], s88 offen sc1
    s_add_u32 s88, s88, 4096
    buffer_store_dwordx4 v[100:103], v104, s[16:19], s88 offen sc1
    s_add_u32 s88, s88, 4096
    buffer_store_dwordx4 v[100:103], v104, s[16:19], s88 offen sc1
    s_add_u32 s88, s88, 4096
    buffer_store_dwordx4 v[100:103], v104, s[16:19], s88 offen sc1
    s_add_u32 s88, s88, 4096
    buffer_store_dwordx4 v[100:103], v104, s[16:19], s88 offen sc1
    s_add_u32 s88, s88, 4096
    buffer_store_dwordx4 v[100:103], v104, s[16:19], s88 offen sc1
    s_add_u32 s88, s88, 4096
    buffer_store_dwordx4 v[100:103], v104, s[16:19], s88 offen sc1
    s_add_u32 s88, s88, 4096
    buffer_store_dwordx4 v[100:103], v104, s[16:19], s88 offen sc1
    s_add_u32 s88, s88, 4096
    buffer_store_dwordx4 v[100:103], v104, s[16:19], s88 offen sc1
    s_waitcnt vmcnt(0)
    s_barrier
    v_mov_b32_e64 v5, 1
    s_add_u32 s82, s86, 8192
    buffer_atomic_add v5, v6, s[16:19], s82 offen offset:12 sc0 sc1
    s_waitcnt vmcnt(0)
    v_cmp_eq_u32 vcc, 11, v5
    s_nop 0
    s_cbranch_vccnz gl_42
gc_43:
    buffer_load_dword v7, v4, s[16:19], s89 offen offset:0 sc1
    s_waitcnt vmcnt(0)
    v_cmp_gt_u32 vcc, 1, v7
    s_nop 0
    s_and_b64 vcc, vcc, s[50:51]
    s_cbranch_scc1 ps_44
pc_46:
    s_barrier
    s_sub_u32 s3, s2, 160
    s_and_b32 s3, s3, 63
    s_add_u32 s3, s3, 0
    s_and_b32 s25, s3, 3
    s_lshl_b32 s25, s25, 12
    s_lshr_b32 s26, s3, 2
    s_lshl_b32 s26, s26, 7
    s_add_u32 s3, s25, s26
    v_lshrrev_b32 v236, 3, v0
    v_and_b32 v237, 7, v0
    v_lshlrev_b32 v237, 4, v237
    v_lshl_add_u32 v236, v236, 14, v237
    s_sub_u32 s25, s2, 160
    s_cmp_lt_u32 s25, 64
    s_cselect_b32 s25, 0, 1073741824
    v_add_u32_e64 v236, s25, v236
    s_add_u32 s26, s3, 9437184
    buffer_load_dwordx4 v[216:219], v236, s[16:19], s26 offen sc1
    s_add_u32 s26, s26, 524288
    buffer_load_dwordx4 v[220:223], v236, s[16:19], s26 offen sc1
    s_add_u32 s26, s26, 524288
    buffer_load_dwordx4 v[224:227], v236, s[16:19], s26 offen sc1
    s_add_u32 s26, s26, 524288
    buffer_load_dwordx4 v[228:231], v236, s[16:19], s26 offen sc1
    s_add_u32 s26, s26, 524288
    buffer_load_dwordx4 v[232:235], v236, s[16:19], s26 offen sc1
    s_lshl_b32 s25, s72, 5
    s_add_u32 s25, s25, 0
    s_sub_u32 s26, s25, 4
    s_max_i32 s26, s26, 0
    s_lshl_b32 s27, s71, 12
    s_add_u32 s27, s27, 9437184
    s_lshl_b32 s99, s25, 3
    s_lshl_b32 s100, s26, 3
    s_lshl_b32 s92, s24, 12
    s_lshl_b32 s93, s24, 9
    s_add_u32 s99, s99, s27
    s_add_u32 s100, s100, s27
    s_add_u32 m0, s92, 36352
    s_nop 0
    buffer_load_dwordx4 v73, s[16:19], s99 offen offset:0 sc1 lds
    buffer_load_dwordx4 v74, s[16:19], s99 offen offset:1024 sc1 lds
    buffer_load_dwordx4 v75, s[16:19], s99 offen offset:2048 sc1 lds
    buffer_load_dwordx4 v76, s[16:19], s99 offen offset:3072 sc1 lds
    s_add_u32 m0, s93, 53760
    s_add_u32 s99, s99, 524288
    s_mov_b64 exec, s[80:81]
    buffer_load_dwordx4 v77, s[16:19], s100 offen sc1 lds
    s_mov_b64 exec, -1
    s_add_u32 s100, s100, 524288
    s_add_u32 m0, s92, 55936
    s_nop 0
    s_nop 0
    buffer_load_dwordx4 v73, s[16:19], s99 offen offset:0 sc1 lds
    buffer_load_dwordx4 v74, s[16:19], s99 offen offset:1024 sc1 lds
    buffer_load_dwordx4 v75, s[16:19], s99 offen offset:2048 sc1 lds
    buffer_load_dwordx4 v76, s[16:19], s99 offen offset:3072 sc1 lds
    s_add_u32 m0, s93, 73344
    s_add_u32 s99, s99, 524288
    s_mov_b64 exec, s[80:81]
    buffer_load_dwordx4 v77, s[16:19], s100 offen sc1 lds
    s_mov_b64 exec, -1
    s_add_u32 s100, s100, 524288
    s_sub_u32 s85, s2, 160
    s_cmp_ge_u32 s85, 64
    s_cbranch_scc1 s2_47
    v_mov_b32 v238, 0x3f803f80
    s_lshl_b32 s25, s24, 7
    s_add_u32 s25, s25, 134272
    v_lshrrev_b32 v239, 4, v1
    v_lshl_add_u32 v237, v239, 2, v237
    v_add_u32 v237, s25, v237
se_48:
    v_mov_b32 v240, 0
    v_mov_b32 v241, 0
    v_mov_b32 v242, 0
    v_mov_b32 v243, 0
    s_waitcnt vmcnt(14)
    v_dot2c_f32_bf16 v240, v216, v238
    v_dot2c_f32_bf16 v241, v216, v216
    v_dot2c_f32_bf16 v240, v217, v238
    v_dot2c_f32_bf16 v241, v217, v217
    v_dot2c_f32_bf16 v242, v218, v238
    v_dot2c_f32_bf16 v243, v218, v218
    v_dot2c_f32_bf16 v242, v219, v238
    v_dot2c_f32_bf16 v243, v219, v219
    s_waitcnt vmcnt(13)
    v_dot2c_f32_bf16 v240, v220, v238
    v_dot2c_f32_bf16 v241, v220, v220
    v_dot2c_f32_bf16 v240, v221, v238
    v_dot2c_f32_bf16 v241, v221, v221
    v_dot2c_f32_bf16 v242, v222, v238
    v_dot2c_f32_bf16 v243, v222, v222
    v_dot2c_f32_bf16 v242, v223, v238
    v_dot2c_f32_bf16 v243, v223, v223
    s_waitcnt vmcnt(12)
    v_dot2c_f32_bf16 v240, v224, v238
    v_dot2c_f32_bf16 v241, v224, v224
    v_dot2c_f32_bf16 v240, v225, v238
    v_dot2c_f32_bf16 v241, v225, v225
    v_dot2c_f32_bf16 v242, v226, v238
    v_dot2c_f32_bf16 v243, v226, v226
    v_dot2c_f32_bf16 v242, v227, v238
    v_dot2c_f32_bf16 v243, v227, v227
    s_waitcnt vmcnt(11)
    v_dot2c_f32_bf16 v240, v228, v238
    v_dot2c_f32_bf16 v241, v228, v228
    v_dot2c_f32_bf16 v240, v229, v238
    v_dot2c_f32_bf16 v241, v229, v229
    v_dot2c_f32_bf16 v242, v230, v238
    v_dot2c_f32_bf16 v243, v230, v230
    v_dot2c_f32_bf16 v242, v231, v238
    v_dot2c_f32_bf16 v243, v231, v231
    s_waitcnt vmcnt(10)
    v_dot2c_f32_bf16 v240, v232, v238
    v_dot2c_f32_bf16 v241, v232, v232
    v_dot2c_f32_bf16 v240, v233, v238
    v_dot2c_f32_bf16 v241, v233, v233
    v_dot2c_f32_bf16 v242, v234, v238
    v_dot2c_f32_bf16 v243, v234, v234
    v_dot2c_f32_bf16 v242, v235, v238
    v_dot2c_f32_bf16 v243, v235, v235
    s_nop 2
    v_cmp_u_f32 vcc, v241, v243
    s_nop 0
    s_cbranch_vccnz rd_49
rc_50:
    v_permlane32_swap_b32 v240, v242
    v_permlane32_swap_b32 v241, v243
    v_pk_add_f32 v[240:241], v[240:241], v[242:243]
    s_nop 1
    v_permlane16_swap_b32 v240, v241
    v_add_f32 v240, v240, v241
    s_nop 1
    v_add_f32_dpp v240, v240, v240 row_ror:8 row_mask:0xf bank_mask:0xf
    ds_write_b32 v237, v240
    v_and_b32 v236, 15, v0
    v_lshlrev_b32 v236, 3, v236
    v_add_u32 v237, 134272, v236
    v_mov_b32 v239, 1073741824
    v_cmp_gt_u32 vcc, 16, v0
    s_nop 1
    v_cndmask_b32 v236, v239, v236, vcc
    s_add_u32 s25, s3, 3457024
    s_waitcnt lgkmcnt(0)
    s_barrier
    ds_read_b64 v[216:217], v237 offset:0
    ds_read_b64 v[218:219], v237 offset:128
    ds_read_b64 v[220:221], v237 offset:256
    ds_read_b64 v[222:223], v237 offset:384
    s_waitcnt lgkmcnt(2)
    v_pk_add_f32 v[216:217], v[216:217], v[218:219]
    s_waitcnt lgkmcnt(0)
    v_pk_add_f32 v[220:221], v[220:221], v[222:223]
    v_pk_add_f32 v[216:217], v[216:217], v[220:221]
    v_mul_f32 v239, 0x3acccccd, v216
    v_mul_f32 v217, 0x3acccccd, v217
    v_fma_f32 v217, -v239, v239, v217
    v_max_f32 v217, 0, v217
    v_add_f32 v217, 0x3727c5ac, v217
    v_rsq_f32_e64 v216, v217
    s_nop 0
    v_mul_f32 v217, -v239, v216
    buffer_store_dwordx2 v[216:217], v236, s[16:19], s25 offen sc1
s2_47:
    s_add_u32 m0, s92, 75520
    s_nop 0
    s_nop 0
    buffer_load_dwordx4 v73, s[16:19], s99 offen offset:0 sc1 lds
    buffer_load_dwordx4 v74, s[16:19], s99 offen offset:1024 sc1 lds
    buffer_load_dwordx4 v75, s[16:19], s99 offen offset:2048 sc1 lds
    buffer_load_dwordx4 v76, s[16:19], s99 offen offset:3072 sc1 lds
    s_add_u32 m0, s93, 92928
    s_add_u32 s99, s99, 524288
    s_mov_b64 exec, s[80:81]
    buffer_load_dwordx4 v77, s[16:19], s100 offen sc1 lds
    s_mov_b64 exec, -1
    s_add_u32 s100, s100, 524288
ec_27:
ge_51:
    v_add_u32 v196, 36352, v78
    v_mov_b32_e64 v198, v79
    s_waitcnt vmcnt(10)
    s_barrier
    ds_read_b64 v[160:161], v198 offset:0
    ds_read_b64 v[162:163], v198 offset:64
    ds_read_b64 v[164:165], v196 offset:0
    ds_read_b64 v[166:167], v196 offset:512
    ds_read_b64 v[168:169], v196 offset:256
    ds_read_b64 v[170:171], v196 offset:768
    ds_read_b64 v[172:173], v198 offset:256
    ds_read_b64 v[174:175], v198 offset:320
    ds_read_b64 v[176:177], v196 offset:2048
    ds_read_b64 v[178:179], v196 offset:2560
    ds_read_b64 v[180:181], v196 offset:2304
    ds_read_b64 v[182:183], v196 offset:2816
    s_waitcnt lgkmcnt(6)
    v_mfma_f32_16x16x32_bf16 v[112:115], a[0:3], v[160:163], 0
    ds_read_b64 v[184:185], v198 offset:512
    v_mfma_f32_32x32x16_bf16 v[80:95], a[0:3], v[164:167], 0
    ds_read_b64 v[186:187], v198 offset:576
    ds_read_b64 v[188:189], v196 offset:4096
    ds_read_b64 v[190:191], v196 offset:4608
    v_mov_b32 v208, 0
    v_mov_b32_e64 v209, 0
    v_mfma_f32_32x32x16_bf16 v[96:111], a[0:3], v[168:171], 0
    ds_read_b64 v[192:193], v196 offset:4352
    ds_read_b64 v[194:195], v196 offset:4864
    buffer_load_dword v7, v4, s[16:19], s87 offen offset:12 sc1
    s_waitcnt lgkmcnt(6)
    v_mfma_f32_16x16x32_bf16 v[112:115], a[4:7], v[172:175], v[112:115]
    ds_read_b64 v[160:161], v198 offset:768
    v_mfma_f32_32x32x16_bf16 v[80:95], a[4:7], v[176:179], v[80:95]
    ds_read_b64 v[162:163], v198 offset:832
    ds_read_b64 v[164:165], v196 offset:6144
    ds_read_b64 v[166:167], v196 offset:6656
    v_lshrrev_b32 v210, 5, v0
    v_mul_u32_u24 v210, 1600, v210
    v_mfma_f32_32x32x16_bf16 v[96:111], a[4:7], v[180:183], v[96:111]
    ds_read_b64 v[168:169], v196 offset:6400
    ds_read_b64 v[170:171], v196 offset:6912
    s_add_u32 m0, s92, 95104
    s_nop 0
    buffer_load_dwordx4 v73, s[16:19], s99 offen offset:0 sc1 lds
    s_waitcnt lgkmcnt(6)
    v_mfma_f32_16x16x32_bf16 v[112:115], a[8:11], v[184:187], v[112:115]
    ds_read_b64 v[172:173], v198 offset:1024
    v_mfma_f32_32x32x16_bf16 v[80:95], a[8:11], v[188:191], v[80:95]
    ds_read_b64 v[174:175], v198 offset:1088
    ds_read_b64 v[176:177], v196 offset:8192
    ds_read_b64 v[178:179], v196 offset:8704
    v_and_b32 v211, 31, v0
    v_min_u32 v211, 19, v211
    v_mfma_f32_32x32x16_bf16 v[96:111], a[8:11], v[192:195], v[96:111]
    ds_read_b64 v[180:181], v196 offset:8448
    ds_read_b64 v[182:183], v196 offset:8960
    buffer_load_dwordx4 v74, s[16:19], s99 offen offset:1024 sc1 lds
    v_lshl_add_u32 v210, v211, 3, v210
    s_waitcnt lgkmcnt(6)
    v_mfma_f32_16x16x32_bf16 v[112:115], a[12:15], v[160:163], v[112:115]
    ds_read_b64 v[184:185], v198 offset:1280
    v_mfma_f32_32x32x16_bf16 v[80:95], a[12:15], v[164:167], v[80:95]
    ds_read_b64 v[186:187], v198 offset:1344
    ds_read_b64 v[188:189], v196 offset:10240
    ds_read_b64 v[190:191], v196 offset:10752
    v_add_u32 v210, 6400, v210
    ds_write_b64 v210, v[208:209]
    v_mfma_f32_32x32x16_bf16 v[96:111], a[12:15], v[168:171], v[96:111]
    ds_read_b64 v[192:193], v196 offset:10496
    ds_read_b64 v[194:195], v196 offset:11008
    buffer_load_dwordx4 v75, s[16:19], s99 offen offset:2048 sc1 lds
    s_waitcnt lgkmcnt(7)
    v_mfma_f32_16x16x32_bf16 v[112:115], a[16:19], v[172:175], v[112:115]
    ds_read_b64 v[160:161], v198 offset:1536
    v_mfma_f32_32x32x16_bf16 v[80:95], a[16:19], v[176:179], v[80:95]
    ds_read_b64 v[162:163], v198 offset:1600
    ds_read_b64 v[164:165], v196 offset:12288
    ds_read_b64 v[166:167], v196 offset:12800
    v_mfma_f32_32x32x16_bf16 v[96:111], a[16:19], v[180:183], v[96:111]
    ds_read_b64 v[168:169], v196 offset:12544
    ds_read_b64 v[170:171], v196 offset:13056
    buffer_load_dwordx4 v76, s[16:19], s99 offen offset:3072 sc1 lds
    s_waitcnt lgkmcnt(6)
    v_mfma_f32_16x16x32_bf16 v[112:115], a[20:23], v[184:187], v[112:115]
    ds_read_b64 v[172:173], v198 offset:1792
    v_mfma_f32_32x32x16_bf16 v[80:95], a[20:23], v[188:191], v[80:95]
    ds_read_b64 v[174:175], v198 offset:1856
    ds_read_b64 v[176:177], v196 offset:14336
    ds_read_b64 v[178:179], v196 offset:14848
    v_mfma_f32_32x32x16_bf16 v[96:111], a[20:23], v[192:195], v[96:111]
    ds_read_b64 v[180:181], v196 offset:14592
    ds_read_b64 v[182:183], v196 offset:15104
    s_add_u32 m0, s93, 112512
    s_add_u32 s99, s99, 524288
    s_mov_b64 exec, s[80:81]
    buffer_load_dwordx4 v77, s[16:19], s100 offen sc1 lds
    s_mov_b64 exec, -1
    s_add_u32 s100, s100, 524288
    s_waitcnt vmcnt(6)
    v_cmp_eq_u32 vcc, 19, v5
    s_nop 0
    s_cbranch_vccnz gl_52
gc_53:
    s_barrier
    s_waitcnt lgkmcnt(6)
    v_mfma_f32_16x16x32_bf16 v[112:115], a[24:27], v[160:163], v[112:115]
    v_add_u32 v198, v49, v198
    v_mfma_f32_32x32x16_bf16 v[80:95], a[24:27], v[164:167], v[80:95]
    v_add_u32 v196, 19584, v196
    ds_read_b64 v[184:185], v198 offset:0
    ds_read_b64 v[186:187], v198 offset:64
    ds_read_b64 v[188:189], v196 offset:0
    v_mfma_f32_32x32x16_bf16 v[96:111], a[24:27], v[168:171], v[96:111]
    ds_read_b64 v[190:191], v196 offset:512
    ds_read_b64 v[192:193], v196 offset:256
    ds_read_b64 v[194:195], v196 offset:768
    s_add_u32 m0, s92, 114688
    s_nop 0
    buffer_load_dwordx4 v73, s[16:19], s99 offen offset:0 sc1 lds
    s_waitcnt lgkmcnt(6)
    v_mfma_f32_16x16x32_bf16 v[112:115], a[28:31], v[172:175], v[112:115]
    ds_read_b64 v[160:161], v198 offset:256
    v_mfma_f32_32x32x16_bf16 v[80:95], a[28:31], v[176:179], v[80:95]
    ds_read_b64 v[162:163], v198 offset:320
    ds_read_b64 v[164:165], v196 offset:2048
    ds_read_b64 v[166:167], v196 offset:2560
    v_mfma_f32_32x32x16_bf16 v[96:111], a[28:31], v[180:183], v[96:111]
    ds_read_b64 v[168:169], v196 offset:2304
    ds_read_b64 v[170:171], v196 offset:2816
    buffer_load_dwordx4 v74, s[16:19], s99 offen offset:1024 sc1 lds
    s_waitcnt lgkmcnt(6)
    v_mfma_f32_16x16x32_bf16 v[112:115], a[32:35], v[184:187], v[112:115]
    ds_read_b64 v[172:173], v198 offset:512
    v_mfma_f32_32x32x16_bf16 v[80:95], a[32:35], v[188:191], v[80:95]
    ds_read_b64 v[174:175], v198 offset:576
    ds_read_b64 v[176:177], v196 offset:4096
    ds_read_b64 v[178:179], v196 offset:4608
    v_mfma_f32_32x32x16_bf16 v[96:111], a[32:35], v[192:195], v[96:111]
    ds_read_b64 v[180:181], v196 offset:4352
    ds_read_b64 v[182:183], v196 offset:4864
    buffer_load_dwordx4 v75, s[16:19], s99 offen offset:2048 sc1 lds
    s_waitcnt lgkmcnt(6)
    v_mfma_f32_16x16x32_bf16 v[112:115], a[36:39], v[160:163], v[112:115]
    ds_read_b64 v[184:185], v198 offset:768
    v_mfma_f32_32x32x16_bf16 v[80:95], a[36:39], v[164:167], v[80:95]
    ds_read_b64 v[186:187], v198 offset:832
    ds_read_b64 v[188:189], v196 offset:6144
    ds_read_b64 v[190:191], v196 offset:6656
    v_mfma_f32_32x32x16_bf16 v[96:111], a[36:39], v[168:171], v[96:111]
    ds_read_b64 v[192:193], v196 offset:6400
    ds_read_b64 v[194:195], v196 offset:6912
    buffer_load_dwordx4 v76, s[16:19], s99 offen offset:3072 sc1 lds
    s_waitcnt lgkmcnt(6)
    v_mfma_f32_16x16x32_bf16 v[112:115], a[40:43], v[172:175], v[112:115]
    ds_read_b64 v[160:161], v198 offset:1024
    v_mfma_f32_32x32x16_bf16 v[80:95], a[40:43], v[176:179], v[80:95]
    ds_read_b64 v[162:163], v198 offset:1088
    ds_read_b64 v[164:165], v196 offset:8192
    ds_read_b64 v[166:167], v196 offset:8704
    v_mfma_f32_32x32x16_bf16 v[96:111], a[40:43], v[180:183], v[96:111]
    ds_read_b64 v[168:169], v196 offset:8448
    ds_read_b64 v[170:171], v196 offset:8960
    s_add_u32 m0, s93, 132096
    s_add_u32 s99, s99, 524288
    s_mov_b64 exec, s[80:81]
    buffer_load_dwordx4 v77, s[16:19], s100 offen sc1 lds
    s_mov_b64 exec, -1
    s_add_u32 s100, s100, 524288
    s_waitcnt lgkmcnt(6)
    v_mfma_f32_16x16x32_bf16 v[112:115], a[44:47], v[184:187], v[112:115]
    ds_read_b64 v[172:173], v198 offset:1280
    v_mfma_f32_32x32x16_bf16 v[80:95], a[44:47], v[188:191], v[80:95]
    ds_read_b64 v[174:175], v198 offset:1344
    ds_read_b64 v[176:177], v196 offset:10240
    ds_read_b64 v[178:179], v196 offset:10752
    v_mfma_f32_32x32x16_bf16 v[96:111], a[44:47], v[192:195], v[96:111]
    ds_read_b64 v[180:181], v196 offset:10496
    ds_read_b64 v[182:183], v196 offset:11008
    s_lshl_b32 s25, s72, 5
    s_add_u32 s25, s25, 256
    s_sub_u32 s26, s25, 4
    s_max_i32 s26, s26, 0
    s_lshl_b32 s27, s71, 12
    s_add_u32 s27, s27, 9437184
    s_lshl_b32 s99, s25, 3
    s_lshl_b32 s100, s26, 3
    s_lshl_b32 s92, s24, 12
    s_lshl_b32 s93, s24, 9
    s_add_u32 s99, s99, s27
    s_add_u32 s100, s100, s27
    s_waitcnt lgkmcnt(6)
    v_mfma_f32_16x16x32_bf16 v[112:115], a[48:51], v[160:163], v[112:115]
    ds_read_b64 v[184:185], v198 offset:1536
    v_mfma_f32_32x32x16_bf16 v[80:95], a[48:51], v[164:167], v[80:95]
    ds_read_b64 v[186:187], v198 offset:1600
    ds_read_b64 v[188:189], v196 offset:12288
    ds_read_b64 v[190:191], v196 offset:12800
    v_mfma_f32_32x32x16_bf16 v[96:111], a[48:51], v[168:171], v[96:111]
    ds_read_b64 v[192:193], v196 offset:12544
    ds_read_b64 v[194:195], v196 offset:13056
    s_waitcnt lgkmcnt(6)
    v_mfma_f32_16x16x32_bf16 v[112:115], a[52:55], v[172:175], v[112:115]
    ds_read_b64 v[160:161], v198 offset:1792
    v_mfma_f32_32x32x16_bf16 v[80:95], a[52:55], v[176:179], v[80:95]
    ds_read_b64 v[162:163], v198 offset:1856
    ds_read_b64 v[164:165], v196 offset:14336
    ds_read_b64 v[166:167], v196 offset:14848
    v_mfma_f32_32x32x16_bf16 v[96:111], a[52:55], v[180:183], v[96:111]
    ds_read_b64 v[168:169], v196 offset:14592
    ds_read_b64 v[170:171], v196 offset:15104
    s_waitcnt vmcnt(10)
    v_cmp_gt_u32 vcc, 1, v7
    s_nop 0
    s_and_b64 vcc, vcc, s[50:51]
    s_cbranch_scc1 ps_54
pc_56:
    s_barrier
    s_waitcnt lgkmcnt(6)
    v_mfma_f32_16x16x32_bf16 v[112:115], a[56:59], v[184:187], v[112:115]
    v_add_u32 v198, v49, v198
    v_mfma_f32_32x32x16_bf16 v[80:95], a[56:59], v[188:191], v[80:95]
    v_add_u32 v196, 19584, v196
    ds_read_b64 v[172:173], v198 offset:0
    ds_read_b64 v[174:175], v198 offset:64
    ds_read_b64 v[176:177], v196 offset:0
    v_mfma_f32_32x32x16_bf16 v[96:111], a[56:59], v[192:195], v[96:111]
    ds_read_b64 v[178:179], v196 offset:512
    ds_read_b64 v[180:181], v196 offset:256
    ds_read_b64 v[182:183], v196 offset:768
    s_waitcnt lgkmcnt(6)
    v_mfma_f32_16x16x32_bf16 v[112:115], a[60:63], v[160:163], v[112:115]
    ds_read_b64 v[184:185], v198 offset:256
    v_mfma_f32_32x32x16_bf16 v[80:95], a[60:63], v[164:167], v[80:95]
    ds_read_b64 v[186:187], v198 offset:320
    ds_read_b64 v[188:189], v196 offset:2048
    ds_read_b64 v[190:191], v196 offset:2560
    v_mfma_f32_32x32x16_bf16 v[96:111], a[60:63], v[168:171], v[96:111]
    ds_read_b64 v[192:193], v196 offset:2304
    ds_read_b64 v[194:195], v196 offset:2816
    s_waitcnt lgkmcnt(6)
    v_mfma_f32_16x16x32_bf16 v[112:115], a[64:67], v[172:175], v[112:115]
    ds_read_b64 v[160:161], v198 offset:512
    v_mfma_f32_32x32x16_bf16 v[80:95], a[64:67], v[176:179], v[80:95]
    ds_read_b64 v[162:163], v198 offset:576
    ds_read_b64 v[164:165], v196 offset:4096
    ds_read_b64 v[166:167], v196 offset:4608
    v_mfma_f32_32x32x16_bf16 v[96:111], a[64:67], v[180:183], v[96:111]
    ds_read_b64 v[168:169], v196 offset:4352
    ds_read_b64 v[170:171], v196 offset:4864
    s_waitcnt lgkmcnt(6)
    v_mfma_f32_16x16x32_bf16 v[112:115], a[68:71], v[184:187], v[112:115]
    ds_read_b64 v[172:173], v198 offset:768
    v_mfma_f32_32x32x16_bf16 v[80:95], a[68:71], v[188:191], v[80:95]
    ds_read_b64 v[174:175], v198 offset:832
    ds_read_b64 v[176:177], v196 offset:6144
    ds_read_b64 v[178:179], v196 offset:6656
    v_mfma_f32_32x32x16_bf16 v[96:111], a[68:71], v[192:195], v[96:111]
    ds_read_b64 v[180:181], v196 offset:6400
    ds_read_b64 v[182:183], v196 offset:6912
    s_waitcnt lgkmcnt(6)
    v_mfma_f32_16x16x32_bf16 v[112:115], a[72:75], v[160:163], v[112:115]
    ds_read_b64 v[184:185], v198 offset:1024
    v_mfma_f32_32x32x16_bf16 v[80:95], a[72:75], v[164:167], v[80:95]
    ds_read_b64 v[186:187], v198 offset:1088
    ds_read_b64 v[188:189], v196 offset:8192
    ds_read_b64 v[190:191], v196 offset:8704
    v_mfma_f32_32x32x16_bf16 v[96:111], a[72:75], v[168:171], v[96:111]
    ds_read_b64 v[192:193], v196 offset:8448
    ds_read_b64 v[194:195], v196 offset:8960
    s_waitcnt lgkmcnt(6)
    v_mfma_f32_16x16x32_bf16 v[112:115], a[76:79], v[172:175], v[112:115]
    ds_read_b64 v[160:161], v198 offset:1280
    v_mfma_f32_32x32x16_bf16 v[80:95], a[76:79], v[176:179], v[80:95]
    ds_read_b64 v[162:163], v198 offset:1344
    ds_read_b64 v[164:165], v196 offset:10240
    ds_read_b64 v[166:167], v196 offset:10752
    v_mfma_f32_32x32x16_bf16 v[96:111], a[76:79], v[180:183], v[96:111]
    ds_read_b64 v[168:169], v196 offset:10496
    ds_read_b64 v[170:171], v196 offset:11008
    s_waitcnt lgkmcnt(6)
    v_mfma_f32_16x16x32_bf16 v[112:115], a[80:83], v[184:187], v[112:115]
    ds_read_b64 v[172:173], v198 offset:1536
    v_mfma_f32_32x32x16_bf16 v[80:95], a[80:83], v[188:191], v[80:95]
    ds_read_b64 v[174:175], v198 offset:1600
    ds_read_b64 v[176:177], v196 offset:12288
    ds_read_b64 v[178:179], v196 offset:12800
    v_mfma_f32_32x32x16_bf16 v[96:111], a[80:83], v[192:195], v[96:111]
    ds_read_b64 v[180:181], v196 offset:12544
    ds_read_b64 v[182:183], v196 offset:13056
    s_lshl_b32 s98, s72, 5
    s_add_u32 s98, s98, 0
    s_sub_u32 s95, s98, 4
    s_max_i32 s95, s95, 0
    s_lshl_b32 s94, s98, 3
    s_lshl_b32 s95, s95, 3
    s_add_u32 s94, s94, 3457024
    s_add_u32 s95, s95, 3457024
    s_add_u32 s96, s94, 8192
    buffer_load_dwordx2 v[152:153], v47, s[16:19], s94 offen sc1
    s_waitcnt lgkmcnt(6)
    v_mfma_f32_16x16x32_bf16 v[112:115], a[84:87], v[160:163], v[112:115]
    ds_read_b64 v[184:185], v198 offset:1792
    v_mfma_f32_32x32x16_bf16 v[80:95], a[84:87], v[164:167], v[80:95]
    ds_read_b64 v[186:187], v198 offset:1856
    ds_read_b64 v[188:189], v196 offset:14336
    ds_read_b64 v[190:191], v196 offset:14848
    v_mfma_f32_32x32x16_bf16 v[96:111], a[84:87], v[168:171], v[96:111]
    ds_read_b64 v[192:193], v196 offset:14592
    ds_read_b64 v[194:195], v196 offset:15104
    buffer_load_dwordx2 v[154:155], v47, s[16:19], s96 offen sc1
    s_waitcnt vmcnt(7)
    s_barrier
    s_waitcnt lgkmcnt(6)
    v_mfma_f32_16x16x32_bf16 v[112:115], a[88:91], v[172:175], v[112:115]
    v_add_u32_e64 v198, v49, v198
    v_mfma_f32_32x32x16_bf16 v[80:95], a[88:91], v[176:179], v[80:95]
    v_add_u32 v196, 19584, v196
    ds_read_b64 v[160:161], v198 offset:0
    ds_read_b64 v[162:163], v198 offset:64
    ds_read_b64 v[164:165], v196 offset:0
    v_mfma_f32_32x32x16_bf16 v[96:111], a[88:91], v[180:183], v[96:111]
    ds_read_b64 v[166:167], v196 offset:512
    ds_read_b64 v[168:169], v196 offset:256
    ds_read_b64 v[170:171], v196 offset:768
    buffer_load_dwordx2 v[156:157], v48, s[16:19], s95 offen sc1
    s_waitcnt lgkmcnt(6)
    v_mfma_f32_16x16x32_bf16 v[112:115], a[92:95], v[184:187], v[112:115]
    ds_read_b64 v[172:173], v198 offset:256
    v_mfma_f32_32x32x16_bf16 v[80:95], a[92:95], v[188:191], v[80:95]
    ds_read_b64 v[174:175], v198 offset:320
    ds_read_b64 v[176:177], v196 offset:2048
    ds_read_b64 v[178:179], v196 offset:2560
    v_mfma_f32_32x32x16_bf16 v[96:111], a[92:95], v[192:195], v[96:111]
    ds_read_b64 v[180:181], v196 offset:2304
    ds_read_b64 v[182:183], v196 offset:2816
    buffer_load_dword v7, v4, s[16:19], s89 offen offset:4 sc1
    s_waitcnt lgkmcnt(6)
    v_mfma_f32_16x16x32_bf16 v[112:115], a[96:99], v[160:163], v[112:115]
    ds_read_b64 v[184:185], v198 offset:512
    v_mfma_f32_32x32x16_bf16 v[80:95], a[96:99], v[164:167], v[80:95]
    ds_read_b64 v[186:187], v198 offset:576
    ds_read_b64 v[188:189], v196 offset:4096
    ds_read_b64 v[190:191], v196 offset:4608
    v_mfma_f32_32x32x16_bf16 v[96:111], a[96:99], v[168:171], v[96:111]
    ds_read_b64 v[192:193], v196 offset:4352
    ds_read_b64 v[194:195], v196 offset:4864
    s_waitcnt lgkmcnt(6)
    v_mfma_f32_16x16x32_bf16 v[112:115], a[100:103], v[172:175], v[112:115]
    ds_read_b64 v[160:161], v198 offset:768
    v_mfma_f32_32x32x16_bf16 v[80:95], a[100:103], v[176:179], v[80:95]
    ds_read_b64 v[162:163], v198 offset:832
    ds_read_b64 v[164:165], v196 offset:6144
    ds_read_b64 v[166:167], v196 offset:6656
    v_mfma_f32_32x32x16_bf16 v[96:111], a[100:103], v[180:183], v[96:111]
    ds_read_b64 v[168:169], v196 offset:6400
    ds_read_b64 v[170:171], v196 offset:6912
    s_waitcnt lgkmcnt(6)
    v_mfma_f32_16x16x32_bf16 v[112:115], a[104:107], v[184:187], v[112:115]
    ds_read_b64 v[172:173], v198 offset:1024
    v_mfma_f32_32x32x16_bf16 v[80:95], a[104:107], v[188:191], v[80:95]
    ds_read_b64 v[174:175], v198 offset:1088
    ds_read_b64 v[176:177], v196 offset:8192
    ds_read_b64 v[178:179], v196 offset:8704
    v_mfma_f32_32x32x16_bf16 v[96:111], a[104:107], v[192:195], v[96:111]
    ds_read_b64 v[180:181], v196 offset:8448
    ds_read_b64 v[182:183], v196 offset:8960
    s_waitcnt lgkmcnt(6)
    v_mfma_f32_16x16x32_bf16 v[112:115], a[108:111], v[160:163], v[112:115]
    ds_read_b64 v[184:185], v198 offset:1280
    v_mfma_f32_32x32x16_bf16 v[80:95], a[108:111], v[164:167], v[80:95]
    ds_read_b64 v[186:187], v198 offset:1344
    ds_read_b64 v[188:189], v196 offset:10240
    ds_read_b64 v[190:191], v196 offset:10752
    v_mfma_f32_32x32x16_bf16 v[96:111], a[108:111], v[168:171], v[96:111]
    ds_read_b64 v[192:193], v196 offset:10496
    ds_read_b64 v[194:195], v196 offset:11008
    s_waitcnt lgkmcnt(6)
    v_mfma_f32_16x16x32_bf16 v[112:115], a[112:115], v[172:175], v[112:115]
    ds_read_b64 v[160:161], v198 offset:1536
    v_mfma_f32_32x32x16_bf16 v[80:95], a[112:115], v[176:179], v[80:95]
    ds_read_b64 v[162:163], v198 offset:1600
    ds_read_b64 v[164:165], v196 offset:12288
    ds_read_b64 v[166:167], v196 offset:12800
    v_mfma_f32_32x32x16_bf16 v[96:111], a[112:115], v[180:183], v[96:111]
    ds_read_b64 v[168:169], v196 offset:12544
    ds_read_b64 v[170:171], v196 offset:13056
    s_waitcnt lgkmcnt(6)
    v_mfma_f32_16x16x32_bf16 v[112:115], a[116:119], v[184:187], v[112:115]
    ds_read_b64 v[172:173], v198 offset:1792
    v_mfma_f32_32x32x16_bf16 v[80:95], a[116:119], v[188:191], v[80:95]
    ds_read_b64 v[174:175], v198 offset:1856
    ds_read_b64 v[176:177], v196 offset:14336
    ds_read_b64 v[178:179], v196 offset:14848
    v_mfma_f32_32x32x16_bf16 v[96:111], a[116:119], v[192:195], v[96:111]
    ds_read_b64 v[180:181], v196 offset:14592
    ds_read_b64 v[182:183], v196 offset:15104
sl_57:
    s_waitcnt vmcnt(2)
    v_max3_u32 v2, v152, v153, v154
    s_waitcnt vmcnt(1)
    v_max3_u32 v2, v2, v155, v156
    v_max_u32 v2, v2, v157
    v_cmp_eq_u32 vcc, -1, v2
    s_nop 0
    s_cbranch_vccnz rd_58
rc_59:
    s_waitcnt vmcnt(0)
    v_cmp_gt_u32 vcc, 1, v7
    s_nop 0
    s_and_b64 vcc, vcc, s[50:51]
    s_cbranch_scc1 ps_60
pc_62:
    s_barrier
    s_waitcnt lgkmcnt(6)
    v_mfma_f32_16x16x32_bf16 v[112:115], a[120:123], v[160:163], v[112:115]
    v_add_u32_e64 v198, v49, v198
    v_mfma_f32_32x32x16_bf16 v[80:95], a[120:123], v[164:167], v[80:95]
    v_add_u32 v196, 19584, v196
    ds_read_b64 v[184:185], v198 offset:0
    ds_read_b64 v[186:187], v198 offset:64
    v_mul_f32 v148, v24, v157
    v_mul_f32 v149, v25, v157
    v_mfma_f32_32x32x16_bf16 v[96:111], a[120:123], v[168:171], v[96:111]
    ds_read_b64 v[188:189], v196 offset:0
    ds_read_b64 v[190:191], v196 offset:512
    s_sub_u32 s3, s2, 160
    s_and_b32 s3, s3, 63
    s_add_u32 s3, s3, 64
    s_and_b32 s25, s3, 3
    s_lshl_b32 s25, s25, 12
    s_lshr_b32 s26, s3, 2
    s_lshl_b32 s26, s26, 7
    s_add_u32 s3, s25, s26
    v_lshrrev_b32 v236, 3, v0
    v_and_b32 v237, 7, v0
    v_lshlrev_b32 v237, 4, v237
    v_lshl_add_u32 v236, v236, 14, v237
    s_sub_u32 s25, s2, 160
    s_cmp_lt_u32 s25, 64
    s_cselect_b32 s25, 0, 1073741824
    v_add_u32_e64 v236, s25, v236
    s_add_u32 s26, s3, 9437184
    buffer_load_dwordx4 v[216:219], v236, s[16:19], s26 offen sc1
    v_mul_f32 v150, v26, v157
    v_mul_f32_e64 v151, v27, v157
    s_waitcnt lgkmcnt(4)
    v_mfma_f32_16x16x32_bf16 v[112:115], a[124:127], v[172:175], v[112:115]
    ds_read_b64 v[192:193], v198 offset:256
    v_mfma_f32_32x32x16_bf16 v[80:95], a[124:127], v[176:179], v[80:95]
    ds_read_b64 v[194:195], v198 offset:320
    ds_read_b64 v[160:161], v196 offset:2048
    v_mul_f32 v116, v8, v153
    v_mul_f32 v117, v9, v153
    v_mul_f32_e64 v118, v10, v153
    v_mfma_f32_32x32x16_bf16 v[96:111], a[124:127], v[180:183], v[96:111]
    ds_read_b64 v[162:163], v196 offset:2560
    s_add_u32 s26, s26, 524288
    buffer_load_dwordx4 v[220:223], v236, s[16:19], s26 offen sc1
    v_mul_f32 v119, v11, v153
    v_mul_f32_e64 v120, v12, v153
    s_waitcnt lgkmcnt(4)
    v_mfma_f32_16x16x32_bf16 v[112:115], a[128:131], v[184:187], v[112:115]
    ds_read_b64 v[164:165], v198 offset:512
    v_mfma_f32_32x32x16_bf16 v[80:95], a[128:131], v[188:191], v[80:95]
    ds_read_b64 v[166:167], v198 offset:576
    ds_read_b64 v[168:169], v196 offset:4096
    ds_read_b64 v[170:171], v196 offset:4608
    v_mul_f32 v121, v13, v153
    v_mul_f32_e64 v122, v14, v153
    s_waitcnt lgkmcnt(4)
    v_mfma_f32_16x16x32_bf16 v[112:115], a[132:135], v[192:195], v[112:115]
    ds_read_b64 v[172:173], v198 offset:768
    v_mfma_f32_32x32x16_bf16 v[80:95], a[132:135], v[160:163], v[80:95]
    ds_read_b64 v[174:175], v198 offset:832
    ds_read_b64 v[176:177], v196 offset:6144
    ds_read_b64 v[178:179], v196 offset:6656
    s_add_u32 s26, s26, 524288
    buffer_load_dwordx4 v[224:227], v236, s[16:19], s26 offen sc1
    v_mul_f32 v123, v15, v153
    v_mul_f32_e64 v124, v16, v153
    s_waitcnt lgkmcnt(4)
    v_mfma_f32_16x16x32_bf16 v[112:115], a[136:139], v[164:167], v[112:115]
    ds_read_b64 v[180:181], v198 offset:1024
    v_mfma_f32_32x32x16_bf16 v[80:95], a[136:139], v[168:171], v[80:95]
    ds_read_b64 v[182:183], v198 offset:1088
    ds_read_b64 v[184:185], v196 offset:8192
    ds_read_b64 v[186:187], v196 offset:8704
    v_mul_f32 v125, v17, v153
    v_mul_f32_e64 v126, v18, v153
    s_waitcnt lgkmcnt(4)
    v_mfma_f32_16x16x32_bf16 v[112:115], a[140:143], v[172:175], v[112:115]
    ds_read_b64 v[188:189], v198 offset:1280
    v_mfma_f32_32x32x16_bf16 v[80:95], a[140:143], v[176:179], v[80:95]
    ds_read_b64 v[190:191], v198 offset:1344
    ds_read_b64 v[192:193], v196 offset:10240
    ds_read_b64 v[194:195], v196 offset:10752
    s_add_u32 s26, s26, 524288
    buffer_load_dwordx4 v[228:231], v236, s[16:19], s26 offen sc1
    v_mul_f32 v127, v19, v153
    v_mul_f32_e64 v128, v20, v153
    s_waitcnt lgkmcnt(4)
    v_mfma_f32_16x16x32_bf16 v[112:115], a[144:147], v[180:183], v[112:115]
    ds_read_b64 v[160:161], v198 offset:1536
    v_mfma_f32_32x32x16_bf16 v[80:95], a[144:147], v[184:187], v[80:95]
    ds_read_b64 v[162:163], v198 offset:1600
    ds_read_b64 v[164:165], v196 offset:12288
    ds_read_b64 v[166:167], v196 offset:12800
    v_mul_f32 v129, v21, v153
    v_mul_f32_e64 v130, v22, v153
    s_waitcnt lgkmcnt(4)
    v_mfma_f32_16x16x32_bf16 v[112:115], a[148:151], v[188:191], v[112:115]
    ds_read_b64 v[168:169], v198 offset:1792
    v_mfma_f32_32x32x16_bf16 v[80:95], a[148:151], v[192:195], v[80:95]
    ds_read_b64 v[170:171], v198 offset:1856
    ds_read_b64 v[172:173], v196 offset:14336
    ds_read_b64 v[174:175], v196 offset:14848
    s_add_u32 s26, s26, 524288
    buffer_load_dwordx4 v[232:235], v236, s[16:19], s26 offen sc1
    v_mul_f32 v131, v23, v153
    v_mul_f32_e64 v132, v8, v155
    s_waitcnt lgkmcnt(4)
    v_mfma_f32_16x16x32_bf16 v[112:115], a[152:155], v[160:163], v[112:115]
    ds_read_b64 v[176:177], v196 offset:256
    v_mfma_f32_32x32x16_bf16 v[80:95], a[152:155], v[164:167], v[80:95]
    ds_read_b64 v[178:179], v196 offset:768
    ds_read_b64 v[180:181], v196 offset:2304
    ds_read_b64 v[182:183], v196 offset:2816
    v_mul_f32 v133, v9, v155
    v_mul_f32_e64 v134, v10, v155
    s_waitcnt lgkmcnt(4)
    v_mfma_f32_16x16x32_bf16 v[112:115], a[156:159], v[168:171], v[112:115]
    ds_read_b64 v[184:185], v196 offset:4352
    v_mfma_f32_32x32x16_bf16 v[80:95], a[156:159], v[172:175], v[80:95]
    ds_read_b64 v[186:187], v196 offset:4864
    ds_read_b64 v[188:189], v196 offset:6400
    ds_read_b64 v[190:191], v196 offset:6912
    s_add_u32 m0, s92, 36352
    s_nop 0
    buffer_load_dwordx4 v73, s[16:19], s99 offen offset:0 sc1 lds
    v_mul_f32 v135, v11, v155
    v_mul_f32 v136, v12, v155
    v_mul_f32 v137, v13, v155
    v_mul_f32 v138, v14, v155
    v_mul_f32 v139, v15, v155
    v_mul_f32 v140, v16, v155
    v_mul_f32 v141, v17, v155
    v_mul_f32 v142, v18, v155
    v_mul_f32 v143, v19, v155
    v_mul_f32 v144, v20, v155
    v_mul_f32 v145, v21, v155
    v_mul_f32 v146, v22, v155
    v_mul_f32_e64 v147, v23, v155
    s_waitcnt lgkmcnt(4)
    v_mfma_f32_32x32x16_bf16 v[96:111], a[128:131], v[176:179], v[96:111]
    ds_read_b64 v[192:193], v196 offset:8448
    ds_read_b64 v[194:195], v196 offset:8960
    v_mfma_f32_32x32x16_bf16 v[96:111], a[132:135], v[180:183], v[96:111]
    ds_read_b64 v[160:161], v196 offset:10496
    ds_read_b64 v[162:163], v196 offset:11008
    buffer_load_dwordx4 v74, s[16:19], s99 offen offset:1024 sc1 lds
    v_fma_f32 v112, v112, v156, v148
    v_fma_f32 v113, v113, v156, v149
    s_waitcnt lgkmcnt(4)
    v_mfma_f32_32x32x16_bf16 v[96:111], a[136:139], v[184:187], v[96:111]
    ds_read_b64 v[164:165], v196 offset:12544
    ds_read_b64 v[166:167], v196 offset:13056
    v_fma_f32 v114, v114, v156, v150
    v_fma_f32 v115, v115, v156, v151
    v_cvt_pk_bf16_f32 v112, v112, v113
    v_mfma_f32_32x32x16_bf16 v[96:111], a[140:143], v[188:191], v[96:111]
    ds_read_b64 v[168:169], v196 offset:14592
    ds_read_b64 v[170:171], v196 offset:15104
    buffer_load_dwordx4 v75, s[16:19], s99 offen offset:2048 sc1 lds
    v_cvt_pk_bf16_f32 v113, v114, v115
    v_fma_f32 v80, v80, v152, v116
    s_waitcnt lgkmcnt(4)
    v_mfma_f32_32x32x16_bf16 v[96:111], a[144:147], v[192:195], v[96:111]
    v_fma_f32 v81, v81, v152, v117
    v_fma_f32 v82, v82, v152, v118
    v_fma_f32 v83, v83, v152, v119
    v_cvt_pk_bf16_f32 v80, v80, v81
    v_cvt_pk_bf16_f32 v81, v82, v83
    v_mfma_f32_32x32x16_bf16 v[96:111], a[148:151], v[160:163], v[96:111]
    ds_write_b64 v40, v[112:113] offset:0
    ds_write_b64 v38, v[80:81] offset:0
    v_fma_f32 v84, v84, v152, v120
    v_fma_f32 v85, v85, v152, v121
    s_waitcnt lgkmcnt(2)
    v_mfma_f32_32x32x16_bf16 v[96:111], a[152:155], v[164:167], v[96:111]
    v_fma_f32 v86, v86, v152, v122
    v_fma_f32 v87, v87, v152, v123
    v_cvt_pk_bf16_f32 v84, v84, v85
    v_cvt_pk_bf16_f32 v85, v86, v87
    v_fma_f32 v88, v88, v152, v124
    v_mfma_f32_32x32x16_bf16 v[96:111], a[156:159], v[168:171], v[96:111]
    buffer_load_dwordx4 v76, s[16:19], s99 offen offset:3072 sc1 lds
    v_fma_f32 v89, v89, v152, v125
    v_fma_f32 v90, v90, v152, v126
    v_fma_f32 v91, v91, v152, v127
    v_cvt_pk_bf16_f32 v88, v88, v89
    v_cvt_pk_bf16_f32 v89, v90, v91
    ds_write_b64 v38, v[84:85] offset:6400
    ds_write_b64 v38, v[88:89] offset:12800
    v_fma_f32 v92, v92, v152, v128
    v_fma_f32 v93, v93, v152, v129
    v_fma_f32 v94, v94, v152, v130
    v_fma_f32 v95, v95, v152, v131
    v_cvt_pk_bf16_f32 v92, v92, v93
    v_cvt_pk_bf16_f32 v93, v94, v95
    ds_write_b64 v39, v[92:93] offset:0
    v_pk_fma_f32 v[96:97], v[96:97], v[154:155], v[132:133] op_sel_hi:[1,0,1]
    v_pk_fma_f32 v[98:99], v[98:99], v[154:155], v[134:135] op_sel_hi:[1,0,1]
    v_cvt_pk_bf16_f32 v96, v96, v97
    v_cvt_pk_bf16_f32 v97, v98, v99
    v_pk_fma_f32 v[100:101], v[100:101], v[154:155], v[136:137] op_sel_hi:[1,0,1]
    v_pk_fma_f32 v[102:103], v[102:103], v[154:155], v[138:139] op_sel_hi:[1,0,1]
    v_cvt_pk_bf16_f32 v100, v100, v101
    v_cvt_pk_bf16_f32 v101, v102, v103
    ds_write_b64 v38, v[96:97] offset:1600
    ds_write_b64 v38, v[100:101] offset:8000
    v_pk_fma_f32 v[104:105], v[104:105], v[154:155], v[140:141] op_sel_hi:[1,0,1]
    v_pk_fma_f32 v[106:107], v[106:107], v[154:155], v[142:143] op_sel_hi:[1,0,1]
    v_cvt_pk_bf16_f32 v104, v104, v105
    v_cvt_pk_bf16_f32 v105, v106, v107
    v_pk_fma_f32 v[108:109], v[108:109], v[154:155], v[144:145] op_sel_hi:[1,0,1]
    v_pk_fma_f32 v[110:111], v[110:111], v[154:155], v[146:147] op_sel_hi:[1,0,1]
    v_cvt_pk_bf16_f32 v108, v108, v109
    v_cvt_pk_bf16_f32 v109, v110, v111
    ds_write_b64 v38, v[104:105] offset:14400
    ds_write_b64 v39, v[108:109] offset:1600
    v_cmp_u_f32 vcc, v82, v114
    v_cmp_u_f32 s[82:83], v98, v98
    s_lshl_b32 s25, s24, 2
    s_add_u32 s25, s25, 161280
    s_or_b64 vcc, vcc, s[82:83]
    s_cselect_b32 s26, 1, 0
    v_mov_b32 v196, s25
    v_mov_b32 v197, s26
    ds_write_b32 v196, v197
    s_waitcnt lgkmcnt(0)
    s_barrier
    s_sub_u32 s85, s2, 160
    s_cmp_ge_u32 s85, 64
    s_cbranch_scc1 s2_63
    v_mov_b32 v238, 0x3f803f80
    s_lshl_b32 s25, s24, 7
    s_add_u32 s25, s25, 134272
    v_lshrrev_b32 v239, 4, v1
    v_lshl_add_u32 v237, v239, 2, v237
    v_add_u32 v237, s25, v237
se_64:
    v_mov_b32 v240, 0
    v_mov_b32 v241, 0
    v_mov_b32 v242, 0
    v_mov_b32 v243, 0
    s_waitcnt vmcnt(8)
    v_dot2c_f32_bf16 v240, v216, v238
    v_dot2c_f32_bf16 v241, v216, v216
    v_dot2c_f32_bf16 v240, v217, v238
    v_dot2c_f32_bf16 v241, v217, v217
    v_dot2c_f32_bf16 v242, v218, v238
    v_dot2c_f32_bf16 v243, v218, v218
    v_dot2c_f32_bf16 v242, v219, v238
    v_dot2c_f32_bf16 v243, v219, v219
    s_waitcnt vmcnt(7)
    v_dot2c_f32_bf16 v240, v220, v238
    v_dot2c_f32_bf16 v241, v220, v220
    v_dot2c_f32_bf16 v240, v221, v238
    v_dot2c_f32_bf16 v241, v221, v221
    v_dot2c_f32_bf16 v242, v222, v238
    v_dot2c_f32_bf16 v243, v222, v222
    v_dot2c_f32_bf16 v242, v223, v238
    v_dot2c_f32_bf16 v243, v223, v223
    s_waitcnt vmcnt(6)
    v_dot2c_f32_bf16 v240, v224, v238
    v_dot2c_f32_bf16 v241, v224, v224
    v_dot2c_f32_bf16 v240, v225, v238
    v_dot2c_f32_bf16 v241, v225, v225
    v_dot2c_f32_bf16 v242, v226, v238
    v_dot2c_f32_bf16 v243, v226, v226
    v_dot2c_f32_bf16 v242, v227, v238
    v_dot2c_f32_bf16 v243, v227, v227
    s_waitcnt vmcnt(5)
    v_dot2c_f32_bf16 v240, v228, v238
    v_dot2c_f32_bf16 v241, v228, v228
    v_dot2c_f32_bf16 v240, v229, v238
    v_dot2c_f32_bf16 v241, v229, v229
    v_dot2c_f32_bf16 v242, v230, v238
    v_dot2c_f32_bf16 v243, v230, v230
    v_dot2c_f32_bf16 v242, v231, v238
    v_dot2c_f32_bf16 v243, v231, v231
    s_waitcnt vmcnt(4)
    v_dot2c_f32_bf16 v240, v232, v238
    v_dot2c_f32_bf16 v241, v232, v232
    v_dot2c_f32_bf16 v240, v233, v238
    v_dot2c_f32_bf16 v241, v233, v233
    v_dot2c_f32_bf16 v242, v234, v238
    v_dot2c_f32_bf16 v243, v234, v234
    v_dot2c_f32_bf16 v242, v235, v238
    v_dot2c_f32_bf16 v243, v235, v235
    s_nop 2
    v_cmp_u_f32 vcc, v241, v243
    s_nop 0
    s_cbranch_vccnz rd_65
rc_66:
    v_permlane32_swap_b32 v240, v242
    v_permlane32_swap_b32 v241, v243
    v_pk_add_f32 v[240:241], v[240:241], v[242:243]
    s_nop 1
    v_permlane16_swap_b32 v240, v241
    v_add_f32_e64 v240, v240, v241
    s_nop 1
    v_add_f32_dpp v240, v240, v240 row_ror:8 row_mask:0xf bank_mask:0xf
    ds_write_b32 v237, v240
    v_and_b32 v236, 15, v0
    v_lshlrev_b32 v236, 3, v236
    v_add_u32 v237, 134272, v236
    v_mov_b32 v239, 1073741824
    v_cmp_gt_u32 vcc, 16, v0
    s_nop 1
    v_cndmask_b32 v236, v239, v236, vcc
    s_add_u32 s25, s3, 3457024
    s_waitcnt lgkmcnt(0)
    s_barrier
    ds_read_b64 v[216:217], v237 offset:0
    ds_read_b64 v[218:219], v237 offset:128
    ds_read_b64 v[220:221], v237 offset:256
    ds_read_b64 v[222:223], v237 offset:384
    s_waitcnt lgkmcnt(2)
    v_pk_add_f32 v[216:217], v[216:217], v[218:219]
    s_waitcnt lgkmcnt(0)
    v_pk_add_f32 v[220:221], v[220:221], v[222:223]
    v_pk_add_f32 v[216:217], v[216:217], v[220:221]
    v_mul_f32 v239, 0x3acccccd, v216
    v_mul_f32 v217, 0x3acccccd, v217
    v_fma_f32 v217, -v239, v239, v217
    v_max_f32 v217, 0, v217
    v_add_f32 v217, 0x3727c5ac, v217
    v_rsq_f32_e64 v216, v217
    s_nop 0
    v_mul_f32 v217, -v239, v216
    buffer_store_dwordx2 v[216:217], v236, s[16:19], s25 offen sc1
s2_63:
    v_mov_b32 v158, 161280
    ds_read_b128 v[128:131], v158
    v_mov_b32 v94, 0
    v_mov_b32 v95, 0
    v_mov_b32 v98, 0
    v_mov_b32 v99, 0
    s_mov_b64 exec, 0xffff
    ds_read_b64 v[94:95], v42 offset:320
    ds_read_b64 v[98:99], v42 offset:640
    s_mov_b64 exec, -1
    s_nop 0
    ds_read_b64 v[92:93], v41 offset:320
    ds_read_b64 v[96:97], v41 offset:640
    ds_read_b64 v[84:85], v41 offset:6720
    ds_read_b64 v[86:87], v42 offset:6720
    ds_read_b64 v[80:81], v41 offset:6400
    ds_read_b64 v[82:83], v42 offset:6400
    ds_read_b64 v[88:89], v41 offset:7040
    ds_read_b64 v[90:91], v42 offset:7040
    ds_read_b64_tr_b16 v[106:107], v44 offset:0
    ds_read_b64_tr_b16 v[100:101], v43 offset:0
    s_add_u32 m0, s93, 53760
    s_add_u32 s99, s99, 524288
    s_mov_b64 exec, s[80:81]
    buffer_load_dwordx4 v77, s[16:19], s100 offen sc1 lds
    s_mov_b64 exec, -1
    s_add_u32 s100, s100, 524288
    ds_read_b64_tr_b16 v[108:109], v44 offset:320
    ds_read_b64_tr_b16 v[102:103], v43 offset:320
    ds_read_b64_tr_b16 v[110:111], v44 offset:640
    ds_read_b64_tr_b16 v[104:105], v43 offset:640
    v_mov_b32 v156, 0xf149f2ca
    v_cndmask_b32 v152, v32, v156, s[90:91]
    v_cndmask_b32 v153, v33, v156, s[90:91]
    v_cndmask_b32 v154, v34, v156, s[90:91]
    s_add_u32 m0, s92, 55936
    s_nop 0
    buffer_load_dwordx4 v73, s[16:19], s99 offen offset:0 sc1 lds
    v_cndmask_b32 v155, v35, v156, s[90:91]
    s_mov_b32 s82, 0x3ea52b5c
    s_lshl_b32 s25, s98, 4
    s_add_u32 s25, s25, 12058624
    s_lshl_b32 s26, s98, 3
    s_add_u32 s26, s26, 12058624
    s_waitcnt lgkmcnt(15)
    v_or3_b32 v128, v128, v129, v130
    v_or_b32 v128, v128, v131
    buffer_load_dwordx4 v74, s[16:19], s99 offen offset:1024 sc1 lds
    v_cmp_ne_u32_e64 vcc, 0, v128
    s_nop 0
    s_cbranch_vccnz rd_67
rc_68:
    s_waitcnt lgkmcnt(10)
    v_mfma_f32_16x16x32_bf16 v[116:119], v[84:87], v[92:95], v[28:31]
    v_mfma_f32_16x16x32_bf16 v[120:123], v[84:87], v[96:99], v[32:35]
    s_waitcnt lgkmcnt(8)
    v_mfma_f32_16x16x32_bf16 v[112:115], v[80:83], v[92:95], v[152:155]
    s_waitcnt lgkmcnt(6)
    v_mfma_f32_16x16x32_bf16 v[124:127], v[88:91], v[96:99], v[28:31]
    s_nop 5
    v_max_f32 v112, v112, v116
    v_max_f32 v113, v113, v117
    v_max_f32 v114, v114, v118
    buffer_load_dwordx4 v75, s[16:19], s99 offen offset:2048 sc1 lds
    v_max_f32 v115, v115, v119
    v_max3_f32 v156, v112, v113, v114
    v_max_f32 v156, v156, v115
    v_max_f32 v120, v120, v124
    v_max_f32 v121, v121, v125
    v_max_f32 v122, v122, v126
    v_max_f32 v123, v123, v127
    v_max3_f32 v157, v120, v121, v122
    buffer_load_dwordx4 v76, s[16:19], s99 offen offset:3072 sc1 lds
    v_max_f32 v157, v157, v123
    s_nop 1
    v_permlane16_swap_b32 v156, v157
    v_max_f32 v156, v156, v157
    v_mov_b32 v157, v156
    s_nop 1
    v_permlane32_swap_b32 v156, v157
    v_max_f32 v156, v156, v157
    v_mul_f32 v156, s82, v156
    v_mov_b32 v157, v156
    s_add_u32 m0, s93, 73344
    s_add_u32 s99, s99, 524288
    s_mov_b64 exec, s[80:81]
    buffer_load_dwordx4 v77, s[16:19], s100 offen sc1 lds
    s_mov_b64 exec, -1
    s_add_u32 s100, s100, 524288
    v_permlane16_swap_b32_e64 v156, v157
    v_fma_f32 v112, v112, s82, -v156
    v_fma_f32 v113, v113, s82, -v156
    v_fma_f32 v114, v114, s82, -v156
    v_fma_f32 v115, v115, s82, -v156
    v_exp_f32 v112, v112
    v_exp_f32 v113, v113
    v_exp_f32 v114, v114
    s_add_u32 m0, s92, 75520
    s_nop 0
    buffer_load_dwordx4 v73, s[16:19], s99 offen offset:0 sc1 lds
    v_exp_f32_e64 v115, v115
    v_cvt_pk_bf16_f32 v116, v112, v113
    v_cvt_pk_bf16_f32 v117, v114, v115
    v_bfi_b32 v128, v36, 0, v116
    v_and_b32 v130, v36, v116
    v_bfi_b32 v129, v37, 0, v117
    v_and_b32 v131, v37, v117
    s_waitcnt lgkmcnt(3)
    s_nop 0
    v_mfma_f32_16x16x32_bf16 v[144:147], v[106:109], v[128:131], 0
    buffer_load_dwordx4 v74, s[16:19], s99 offen offset:1024 sc1 lds
    s_waitcnt lgkmcnt(2)
    v_mfma_f32_16x16x32_bf16 v[136:139], v[100:103], v[128:131], 0
    v_fma_f32 v120, v120, s82, -v157
    v_fma_f32 v121, v121, s82, -v157
    v_fma_f32 v122, v122, s82, -v157
    v_fma_f32 v123, v123, s82, -v157
    v_exp_f32 v120, v120
    v_exp_f32 v121, v121
    v_exp_f32 v122, v122
    buffer_load_dwordx4 v75, s[16:19], s99 offen offset:2048 sc1 lds
    v_exp_f32_e64 v123, v123
    v_cvt_pk_bf16_f32 v124, v120, v121
    v_cvt_pk_bf16_f32 v125, v122, v123
    v_bfi_b32 v132, v36, 0, v124
    v_and_b32 v134, v36, v124
    v_bfi_b32 v133, v37, 0, v125
    v_and_b32 v135, v37, v125
    s_waitcnt lgkmcnt(1)
    s_nop 0
    v_mfma_f32_16x16x32_bf16 v[148:151], v[108:111], v[132:135], 0
    buffer_load_dwordx4 v76, s[16:19], s99 offen offset:3072 sc1 lds
    s_waitcnt lgkmcnt(0)
    v_mfma_f32_16x16x32_bf16 v[140:143], v[102:105], v[132:135], 0
    v_mov_b32 v158, v144
    s_nop 1
    v_permlane16_swap_b32 v144, v158
    v_rcp_f32 v158, v158
    s_nop 0
    v_pk_mul_f32 v[136:137], v[136:137], v[158:159] op_sel_hi:[1,0]
    v_pk_mul_f32 v[138:139], v[138:139], v[158:159] op_sel_hi:[1,0]
    v_pk_mul_f32 v[144:145], v[144:145], v[158:159] op_sel_hi:[1,0]
    v_pk_mul_f32 v[146:147], v[146:147], v[158:159] op_sel_hi:[1,0]
    s_add_u32 m0, s93, 92928
    s_add_u32 s99, s99, 524288
    s_mov_b64 exec, s[80:81]
    buffer_load_dwordx4 v77, s[16:19], s100 offen sc1 lds
    s_mov_b64 exec, -1
    s_add_u32 s100, s100, 524288
    v_cvt_pk_bf16_f32 v112, v136, v137
    v_cvt_pk_bf16_f32 v116, v144, v145
    v_cvt_pk_bf16_f32 v113, v138, v139
    v_cvt_pk_bf16_f32 v117, v146, v147
    v_mov_b32 v160, v148
    s_nop 1
    v_permlane16_swap_b32 v148, v160
    v_rcp_f32_e64 v160, v160
    s_nop 0
    v_pk_mul_f32 v[140:141], v[140:141], v[160:161] op_sel_hi:[1,0]
    v_pk_mul_f32 v[142:143], v[142:143], v[160:161] op_sel_hi:[1,0]
    v_pk_mul_f32 v[148:149], v[148:149], v[160:161] op_sel_hi:[1,0]
    v_pk_mul_f32 v[150:151], v[150:151], v[160:161] op_sel_hi:[1,0]
    v_cvt_pk_bf16_f32 v114, v140, v141
    v_cvt_pk_bf16_f32 v118, v148, v149
    v_cvt_pk_bf16_f32 v115, v142, v143
    v_cvt_pk_bf16_f32 v119, v150, v151
    v_permlane16_swap_b32 v112, v114
    v_permlane16_swap_b32 v113, v115
    v_permlane16_swap_b32 v116, v118
    v_permlane16_swap_b32 v117, v119
    buffer_store_dwordx4 v[112:115], v45, s[16:19], s25 offen sc1
    s_mov_b64 exec, s[80:81]
    buffer_store_dwordx2 v[116:117], v46, s[16:19], s26 offen sc1
    s_mov_b64 exec, -1
ge_69:
    v_add_u32 v196, 36352, v78
    v_mov_b32_e64 v198, v79
    s_waitcnt vmcnt(12)
    s_barrier
    ds_read_b64 v[160:161], v198 offset:0
    ds_read_b64 v[162:163], v198 offset:64
    ds_read_b64 v[164:165], v196 offset:0
    ds_read_b64 v[166:167], v196 offset:512
    ds_read_b64 v[168:169], v196 offset:256
    ds_read_b64 v[170:171], v196 offset:768
    ds_read_b64 v[172:173], v198 offset:256
    ds_read_b64 v[174:175], v198 offset:320
    ds_read_b64 v[176:177], v196 offset:2048
    ds_read_b64 v[178:179], v196 offset:2560
    ds_read_b64 v[180:181], v196 offset:2304
    ds_read_b64 v[182:183], v196 offset:2816
    s_waitcnt lgkmcnt(6)
    v_mfma_f32_16x16x32_bf16 v[112:115], a[0:3], v[160:163], 0
    ds_read_b64 v[184:185], v198 offset:512
    v_mfma_f32_32x32x16_bf16 v[80:95], a[0:3], v[164:167], 0
    ds_read_b64 v[186:187], v198 offset:576
    ds_read_b64 v[188:189], v196 offset:4096
    ds_read_b64 v[190:191], v196 offset:4608
    v_mfma_f32_32x32x16_bf16 v[96:111], a[0:3], v[168:171], 0
    ds_read_b64 v[192:193], v196 offset:4352
    ds_read_b64 v[194:195], v196 offset:4864
    s_add_u32 m0, s92, 95104
    s_nop 0
    buffer_load_dwordx4 v73, s[16:19], s99 offen offset:0 sc1 lds
    s_waitcnt lgkmcnt(6)
    v_mfma_f32_16x16x32_bf16 v[112:115], a[4:7], v[172:175], v[112:115]
    ds_read_b64 v[160:161], v198 offset:768
    v_mfma_f32_32x32x16_bf16 v[80:95], a[4:7], v[176:179], v[80:95]
    ds_read_b64 v[162:163], v198 offset:832
    ds_read_b64 v[164:165], v196 offset:6144
    ds_read_b64 v[166:167], v196 offset:6656
    v_mfma_f32_32x32x16_bf16 v[96:111], a[4:7], v[180:183], v[96:111]
    ds_read_b64 v[168:169], v196 offset:6400
    ds_read_b64 v[170:171], v196 offset:6912
    buffer_load_dwordx4 v74, s[16:19], s99 offen offset:1024 sc1 lds
    s_waitcnt lgkmcnt(6)
    v_mfma_f32_16x16x32_bf16 v[112:115], a[8:11], v[184:187], v[112:115]
    ds_read_b64 v[172:173], v198 offset:1024
    v_mfma_f32_32x32x16_bf16 v[80:95], a[8:11], v[188:191], v[80:95]
    ds_read_b64 v[174:175], v198 offset:1088
    ds_read_b64 v[176:177], v196 offset:8192
    ds_read_b64 v[178:179], v196 offset:8704
    v_mfma_f32_32x32x16_bf16 v[96:111], a[8:11], v[192:195], v[96:111]
    ds_read_b64 v[180:181], v196 offset:8448
    ds_read_b64 v[182:183], v196 offset:8960
    buffer_load_dwordx4 v75, s[16:19], s99 offen offset:2048 sc1 lds
    s_waitcnt lgkmcnt(6)
    v_mfma_f32_16x16x32_bf16 v[112:115], a[12:15], v[160:163], v[112:115]
    ds_read_b64 v[184:185], v198 offset:1280
    v_mfma_f32_32x32x16_bf16 v[80:95], a[12:15], v[164:167], v[80:95]
    ds_read_b64 v[186:187], v198 offset:1344
    ds_read_b64 v[188:189], v196 offset:10240
    ds_read_b64 v[190:191], v196 offset:10752
    v_mfma_f32_32x32x16_bf16 v[96:111], a[12:15], v[168:171], v[96:111]
    ds_read_b64 v[192:193], v196 offset:10496
    ds_read_b64 v[194:195], v196 offset:11008
    buffer_load_dwordx4 v76, s[16:19], s99 offen offset:3072 sc1 lds
    s_waitcnt lgkmcnt(6)
    v_mfma_f32_16x16x32_bf16 v[112:115], a[16:19], v[172:175], v[112:115]
    ds_read_b64 v[160:161], v198 offset:1536
    v_mfma_f32_32x32x16_bf16 v[80:95], a[16:19], v[176:179], v[80:95]
    ds_read_b64 v[162:163], v198 offset:1600
    ds_read_b64 v[164:165], v196 offset:12288
    ds_read_b64 v[166:167], v196 offset:12800
    v_mfma_f32_32x32x16_bf16 v[96:111], a[16:19], v[180:183], v[96:111]
    ds_read_b64 v[168:169], v196 offset:12544
    ds_read_b64 v[170:171], v196 offset:13056
    s_add_u32 m0, s93, 112512
    s_add_u32 s99, s99, 524288
    s_mov_b64 exec, s[80:81]
    buffer_load_dwordx4 v77, s[16:19], s100 offen sc1 lds
    s_mov_b64 exec, -1
    s_add_u32 s100, s100, 524288
    s_waitcnt lgkmcnt(6)
    v_mfma_f32_16x16x32_bf16 v[112:115], a[20:23], v[184:187], v[112:115]
    ds_read_b64 v[172:173], v198 offset:1792
    v_mfma_f32_32x32x16_bf16 v[80:95], a[20:23], v[188:191], v[80:95]
    ds_read_b64 v[174:175], v198 offset:1856
    ds_read_b64 v[176:177], v196 offset:14336
    ds_read_b64 v[178:179], v196 offset:14848
    v_mfma_f32_32x32x16_bf16 v[96:111], a[20:23], v[192:195], v[96:111]
    ds_read_b64 v[180:181], v196 offset:14592
    ds_read_b64 v[182:183], v196 offset:15104
    s_add_u32 m0, s92, 114688
    s_nop 0
    buffer_load_dwordx4 v73, s[16:19], s99 offen offset:0 sc1 lds
    s_waitcnt vmcnt(13)
    s_barrier
    s_waitcnt lgkmcnt(6)
    v_mfma_f32_16x16x32_bf16 v[112:115], a[24:27], v[160:163], v[112:115]
    v_add_u32 v198, v49, v198
    v_mfma_f32_32x32x16_bf16 v[80:95], a[24:27], v[164:167], v[80:95]
    v_add_u32 v196, 19584, v196
    ds_read_b64 v[184:185], v198 offset:0
    ds_read_b64 v[186:187], v198 offset:64
    ds_read_b64 v[188:189], v196 offset:0
    v_mfma_f32_32x32x16_bf16 v[96:111], a[24:27], v[168:171], v[96:111]
    ds_read_b64 v[190:191], v196 offset:512
    ds_read_b64 v[192:193], v196 offset:256
    ds_read_b64 v[194:195], v196 offset:768
    buffer_load_dwordx4 v74, s[16:19], s99 offen offset:1024 sc1 lds
    s_waitcnt lgkmcnt(6)
    v_mfma_f32_16x16x32_bf16 v[112:115], a[28:31], v[172:175], v[112:115]
    ds_read_b64 v[160:161], v198 offset:256
    v_mfma_f32_32x32x16_bf16 v[80:95], a[28:31], v[176:179], v[80:95]
    ds_read_b64 v[162:163], v198 offset:320
    ds_read_b64 v[164:165], v196 offset:2048
    ds_read_b64 v[166:167], v196 offset:2560
    v_mfma_f32_32x32x16_bf16 v[96:111], a[28:31], v[180:183], v[96:111]
    ds_read_b64 v[168:169], v196 offset:2304
    ds_read_b64 v[170:171], v196 offset:2816
    buffer_load_dwordx4 v75, s[16:19], s99 offen offset:2048 sc1 lds
    s_waitcnt lgkmcnt(6)
    v_mfma_f32_16x16x32_bf16 v[112:115], a[32:35], v[184:187], v[112:115]
    ds_read_b64 v[172:173], v198 offset:512
    v_mfma_f32_32x32x16_bf16 v[80:95], a[32:35], v[188:191], v[80:95]
    ds_read_b64 v[174:175], v198 offset:576
    ds_read_b64 v[176:177], v196 offset:4096
    ds_read_b64 v[178:179], v196 offset:4608
    v_mfma_f32_32x32x16_bf16 v[96:111], a[32:35], v[192:195], v[96:111]
    ds_read_b64 v[180:181], v196 offset:4352
    ds_read_b64 v[182:183], v196 offset:4864
    buffer_load_dwordx4 v76, s[16:19], s99 offen offset:3072 sc1 lds
    s_waitcnt lgkmcnt(6)
    v_mfma_f32_16x16x32_bf16 v[112:115], a[36:39], v[160:163], v[112:115]
    ds_read_b64 v[184:185], v198 offset:768
    v_mfma_f32_32x32x16_bf16 v[80:95], a[36:39], v[164:167], v[80:95]
    ds_read_b64 v[186:187], v198 offset:832
    ds_read_b64 v[188:189], v196 offset:6144
    ds_read_b64 v[190:191], v196 offset:6656
    v_mfma_f32_32x32x16_bf16 v[96:111], a[36:39], v[168:171], v[96:111]
    ds_read_b64 v[192:193], v196 offset:6400
    ds_read_b64 v[194:195], v196 offset:6912
    s_add_u32 m0, s93, 132096
    s_add_u32 s99, s99, 524288
    s_mov_b64 exec, s[80:81]
    buffer_load_dwordx4 v77, s[16:19], s100 offen sc1 lds
    s_mov_b64 exec, -1
    s_add_u32 s100, s100, 524288
    s_waitcnt lgkmcnt(6)
    v_mfma_f32_16x16x32_bf16 v[112:115], a[40:43], v[172:175], v[112:115]
    ds_read_b64 v[160:161], v198 offset:1024
    v_mfma_f32_32x32x16_bf16 v[80:95], a[40:43], v[176:179], v[80:95]
    ds_read_b64 v[162:163], v198 offset:1088
    ds_read_b64 v[164:165], v196 offset:8192
    ds_read_b64 v[166:167], v196 offset:8704
    v_add_u32 v199, 36352, v58
    s_lshl_b32 s32, s24, 11
    v_mfma_f32_32x32x16_bf16 v[96:111], a[40:43], v[180:183], v[96:111]
    ds_read_b64 v[168:169], v196 offset:8448
    ds_read_b64 v[170:171], v196 offset:8960
    v_add_u32 v203, s32, v199
    s_add_u32 s32, s24, 1
    s_waitcnt lgkmcnt(6)
    v_mfma_f32_16x16x32_bf16 v[112:115], a[44:47], v[184:187], v[112:115]
    ds_read_b64 v[172:173], v198 offset:1280
    v_mfma_f32_32x32x16_bf16 v[80:95], a[44:47], v[188:191], v[80:95]
    ds_read_b64 v[174:175], v198 offset:1344
    ds_read_b64 v[176:177], v196 offset:10240
    ds_read_b64 v[178:179], v196 offset:10752
    s_and_b32 s32, s32, 3
    s_mul_i32 s32, s32, 6144
    v_mfma_f32_32x32x16_bf16 v[96:111], a[44:47], v[192:195], v[96:111]
    ds_read_b64 v[180:181], v196 offset:10496
    ds_read_b64 v[182:183], v196 offset:11008
    v_add_u32 v200, s32, v199
    s_add_u32 s32, s24, 2
    s_waitcnt lgkmcnt(6)
    v_mfma_f32_16x16x32_bf16 v[112:115], a[48:51], v[160:163], v[112:115]
    ds_read_b64 v[184:185], v198 offset:1536
    v_mfma_f32_32x32x16_bf16 v[80:95], a[48:51], v[164:167], v[80:95]
    ds_read_b64 v[186:187], v198 offset:1600
    ds_read_b64 v[188:189], v196 offset:12288
    ds_read_b64 v[190:191], v196 offset:12800
    s_and_b32 s32, s32, 3
    s_mul_i32 s32, s32, 6144
    v_mfma_f32_32x32x16_bf16 v[96:111], a[48:51], v[168:171], v[96:111]
    ds_read_b64 v[192:193], v196 offset:12544
    ds_read_b64 v[194:195], v196 offset:13056
    v_add_u32 v201, s32, v199
    s_add_u32 s32, s24, 3
    s_waitcnt lgkmcnt(6)
    v_mfma_f32_16x16x32_bf16 v[112:115], a[52:55], v[172:175], v[112:115]
    ds_read_b64 v[160:161], v198 offset:1792
    v_mfma_f32_32x32x16_bf16 v[80:95], a[52:55], v[176:179], v[80:95]
    ds_read_b64 v[162:163], v198 offset:1856
    ds_read_b64 v[164:165], v196 offset:14336
    ds_read_b64 v[166:167], v196 offset:14848
    s_and_b32 s32, s32, 3
    s_mul_i32 s32, s32, 6144
    v_mfma_f32_32x32x16_bf16 v[96:111], a[52:55], v[180:183], v[96:111]
    ds_read_b64 v[168:169], v196 offset:14592
    ds_read_b64 v[170:171], v196 offset:15104
    v_add_u32 v202, s32, v199
    s_mul_i32 s32, s24, 6144
    s_waitcnt vmcnt(12)
    s_barrier
    s_waitcnt lgkmcnt(6)
    v_mfma_f32_16x16x32_bf16 v[112:115], a[56:59], v[184:187], v[112:115]
    v_add_u32 v198, v49, v198
    v_mfma_f32_32x32x16_bf16 v[80:95], a[56:59], v[188:191], v[80:95]
    v_add_u32 v196, 19584, v196
    ds_read_b64 v[172:173], v198 offset:0
    ds_read_b64 v[174:175], v198 offset:64
    ds_read_b64 v[176:177], v196 offset:0
    v_add_u32_e64 v204, s32, v199
    v_mfma_f32_32x32x16_bf16 v[96:111], a[56:59], v[192:195], v[96:111]
    ds_read_b64 v[178:179], v196 offset:512
    ds_read_b64 v[180:181], v196 offset:256
    ds_read_b64 v[182:183], v196 offset:768
    s_lshl_b32 s32, s24, 8
    s_waitcnt lgkmcnt(6)
    v_mfma_f32_16x16x32_bf16 v[112:115], a[60:63], v[160:163], v[112:115]
    ds_read_b64 v[184:185], v198 offset:256
    v_mfma_f32_32x32x16_bf16 v[80:95], a[60:63], v[164:167], v[80:95]
    ds_read_b64 v[186:187], v198 offset:320
    ds_read_b64 v[188:189], v196 offset:2048
    ds_read_b64 v[190:191], v196 offset:2560
    s_add_u32 s32, s32, 36352
    v_and_b32_e64 v214, 15, v1
    v_mfma_f32_32x32x16_bf16 v[96:111], a[60:63], v[168:171], v[96:111]
    ds_read_b64 v[192:193], v196 offset:2304
    ds_read_b64 v[194:195], v196 offset:2816
    v_lshl_add_u32 v206, v214, 4, s32
    v_lshrrev_b32 v215, 5, v1
    s_waitcnt lgkmcnt(6)
    v_mfma_f32_16x16x32_bf16 v[112:115], a[64:67], v[172:175], v[112:115]
    ds_read_b64 v[160:161], v198 offset:512
    v_mfma_f32_32x32x16_bf16 v[80:95], a[64:67], v[176:179], v[80:95]
    ds_read_b64 v[162:163], v198 offset:576
    ds_read_b64 v[164:165], v196 offset:4096
    ds_read_b64 v[166:167], v196 offset:4608
    v_lshl_add_u32 v205, v215, 10, v206
    v_bfe_u32 v215, v1, 4, 1
    v_mfma_f32_32x32x16_bf16 v[96:111], a[64:67], v[180:183], v[96:111]
    ds_read_b64 v[168:169], v196 offset:4352
    ds_read_b64 v[170:171], v196 offset:4864
    v_lshl_add_u32 v205, v215, 3, v205
    v_lshlrev_b32 v214, 2, v214
    s_waitcnt lgkmcnt(6)
    v_mfma_f32_16x16x32_bf16 v[112:115], a[68:71], v[184:187], v[112:115]
    ds_read_b64 v[172:173], v198 offset:768
    v_mfma_f32_32x32x16_bf16 v[80:95], a[68:71], v[188:191], v[80:95]
    ds_read_b64 v[174:175], v198 offset:832
    ds_read_b64 v[176:177], v196 offset:6144
    ds_read_b64 v[178:179], v196 offset:6656
    v_lshl_add_u32 v214, v215, 10, v214
    s_lshl_b32 s32, s24, 6
    v_mfma_f32_32x32x16_bf16 v[96:111], a[68:71], v[192:195], v[96:111]
    ds_read_b64 v[180:181], v196 offset:6400
    ds_read_b64 v[182:183], v196 offset:6912
    v_lshl_add_u32 v207, v215, 3, s32
    v_and_b32_e64 v215, 12, v1
    s_waitcnt lgkmcnt(6)
    v_mfma_f32_16x16x32_bf16 v[112:115], a[72:75], v[160:163], v[112:115]
    ds_read_b64 v[184:185], v198 offset:1024
    v_mfma_f32_32x32x16_bf16 v[80:95], a[72:75], v[164:167], v[80:95]
    ds_read_b64 v[186:187], v198 offset:1088
    ds_read_b64 v[188:189], v196 offset:8192
    ds_read_b64 v[190:191], v196 offset:8704
    v_lshl_add_u32 v207, v215, 2, v207
    v_and_b32_e64 v215, 2, v1
    v_mfma_f32_32x32x16_bf16 v[96:111], a[72:75], v[168:171], v[96:111]
    ds_read_b64 v[192:193], v196 offset:8448
    ds_read_b64 v[194:195], v196 offset:8960
    s_lshl_b32 s98, s72, 5
    s_add_u32 s98, s98, 256
    s_sub_u32 s95, s98, 4
    s_max_i32 s95, s95, 0
    s_lshl_b32 s94, s98, 3
    s_lshl_b32 s95, s95, 3
    s_add_u32 s94, s94, 3457024
    s_add_u32 s95, s95, 3457024
    s_add_u32 s96, s94, 8192
    buffer_load_dwordx2 v[152:153], v47, s[16:19], s94 offen sc1
    s_waitcnt lgkmcnt(6)
    v_mfma_f32_16x16x32_bf16 v[112:115], a[76:79], v[172:175], v[112:115]
    ds_read_b64 v[160:161], v198 offset:1280
    v_mfma_f32_32x32x16_bf16 v[80:95], a[76:79], v[176:179], v[80:95]
    ds_read_b64 v[162:163], v198 offset:1344
    ds_read_b64 v[164:165], v196 offset:10240
    ds_read_b64 v[166:167], v196 offset:10752
    v_lshl_add_u32 v207, v215, 1, v207
    v_add_u32 v207, 69120, v207
    v_mfma_f32_32x32x16_bf16 v[96:111], a[76:79], v[180:183], v[96:111]
    ds_read_b64 v[168:169], v196 offset:10496
    ds_read_b64 v[170:171], v196 offset:11008
    buffer_load_dwordx2 v[154:155], v47, s[16:19], s96 offen sc1
    v_lshrrev_b32 v215, 4, v1
    s_waitcnt lgkmcnt(6)
    v_mfma_f32_16x16x32_bf16 v[112:115], a[80:83], v[184:187], v[112:115]
    ds_read_b64 v[172:173], v198 offset:1536
    v_mfma_f32_32x32x16_bf16 v[80:95], a[80:83], v[188:191], v[80:95]
    ds_read_b64 v[174:175], v198 offset:1600
    ds_read_b64 v[176:177], v196 offset:12288
    ds_read_b64 v[178:179], v196 offset:12800
    v_lshl_add_u32 v206, v215, 2, v206
    v_mov_b32 v215, 0x3f803f80
    v_mfma_f32_32x32x16_bf16 v[96:111], a[80:83], v[192:195], v[96:111]
    ds_read_b64 v[180:181], v196 offset:12544
    ds_read_b64 v[182:183], v196 offset:13056
    buffer_load_dwordx2 v[156:157], v48, s[16:19], s95 offen sc1
    s_waitcnt lgkmcnt(6)
    v_mfma_f32_16x16x32_bf16 v[112:115], a[84:87], v[160:163], v[112:115]
    ds_read_b64 v[184:185], v198 offset:1792
    v_mfma_f32_32x32x16_bf16 v[80:95], a[84:87], v[164:167], v[80:95]
    ds_read_b64 v[186:187], v198 offset:1856
    ds_read_b64 v[188:189], v196 offset:14336
    ds_read_b64 v[190:191], v196 offset:14848
    v_mfma_f32_32x32x16_bf16 v[96:111], a[84:87], v[168:171], v[96:111]
    ds_read_b64 v[192:193], v196 offset:14592
    ds_read_b64 v[194:195], v196 offset:15104
    s_waitcnt vmcnt(8)
    s_barrier
    s_waitcnt lgkmcnt(6)
    v_mfma_f32_16x16x32_bf16 v[112:115], a[88:91], v[172:175], v[112:115]
    v_add_u32_e64 v198, v49, v198
    v_mfma_f32_32x32x16_bf16 v[80:95], a[88:91], v[176:179], v[80:95]
    v_add_u32 v196, 19584, v196
    ds_read_b64 v[160:161], v198 offset:0
    ds_read_b64 v[162:163], v198 offset:64
    ds_read_b64 v[164:165], v196 offset:0
    v_mfma_f32_32x32x16_bf16 v[96:111], a[88:91], v[180:183], v[96:111]
    ds_read_b64 v[166:167], v196 offset:512
    ds_read_b64 v[168:169], v196 offset:256
    ds_read_b64 v[170:171], v196 offset:768
    s_waitcnt lgkmcnt(6)
    v_mfma_f32_16x16x32_bf16 v[112:115], a[92:95], v[184:187], v[112:115]
    ds_read_b64 v[172:173], v198 offset:256
    v_mfma_f32_32x32x16_bf16 v[80:95], a[92:95], v[188:191], v[80:95]
    ds_read_b64 v[174:175], v198 offset:320
    ds_read_b64 v[176:177], v196 offset:2048
    ds_read_b64 v[178:179], v196 offset:2560
    v_mfma_f32_32x32x16_bf16 v[96:111], a[92:95], v[192:195], v[96:111]
    ds_read_b64 v[180:181], v196 offset:2304
    ds_read_b64 v[182:183], v196 offset:2816
    s_waitcnt lgkmcnt(6)
    v_mfma_f32_16x16x32_bf16 v[112:115], a[96:99], v[160:163], v[112:115]
    ds_read_b64 v[184:185], v198 offset:512
    v_mfma_f32_32x32x16_bf16 v[80:95], a[96:99], v[164:167], v[80:95]
    ds_read_b64 v[186:187], v198 offset:576
    ds_read_b64 v[188:189], v196 offset:4096
    ds_read_b64 v[190:191], v196 offset:4608
    v_mfma_f32_32x32x16_bf16 v[96:111], a[96:99], v[168:171], v[96:111]
    ds_read_b64 v[192:193], v196 offset:4352
    ds_read_b64 v[194:195], v196 offset:4864
    s_waitcnt lgkmcnt(6)
    v_mfma_f32_16x16x32_bf16 v[112:115], a[100:103], v[172:175], v[112:115]
    ds_read_b64 v[160:161], v198 offset:768
    v_mfma_f32_32x32x16_bf16 v[80:95], a[100:103], v[176:179], v[80:95]
    ds_read_b64 v[162:163], v198 offset:832
    ds_read_b64 v[164:165], v196 offset:6144
    ds_read_b64 v[166:167], v196 offset:6656
    v_mfma_f32_32x32x16_bf16 v[96:111], a[100:103], v[180:183], v[96:111]
    ds_read_b64 v[168:169], v196 offset:6400
    ds_read_b64 v[170:171], v196 offset:6912
    s_waitcnt lgkmcnt(6)
    v_mfma_f32_16x16x32_bf16 v[112:115], a[104:107], v[184:187], v[112:115]
    ds_read_b64 v[172:173], v198 offset:1024
    v_mfma_f32_32x32x16_bf16 v[80:95], a[104:107], v[188:191], v[80:95]
    ds_read_b64 v[174:175], v198 offset:1088
    ds_read_b64 v[176:177], v196 offset:8192
    ds_read_b64 v[178:179], v196 offset:8704
    v_mfma_f32_32x32x16_bf16 v[96:111], a[104:107], v[192:195], v[96:111]
    ds_read_b64 v[180:181], v196 offset:8448
    ds_read_b64 v[182:183], v196 offset:8960
    s_waitcnt lgkmcnt(6)
    v_mfma_f32_16x16x32_bf16 v[112:115], a[108:111], v[160:163], v[112:115]
    ds_read_b64 v[184:185], v198 offset:1280
    v_mfma_f32_32x32x16_bf16 v[80:95], a[108:111], v[164:167], v[80:95]
    ds_read_b64 v[186:187], v198 offset:1344
    ds_read_b64 v[188:189], v196 offset:10240
    ds_read_b64 v[190:191], v196 offset:10752
    v_mfma_f32_32x32x16_bf16 v[96:111], a[108:111], v[168:171], v[96:111]
    ds_read_b64 v[192:193], v196 offset:10496
    ds_read_b64 v[194:195], v196 offset:11008
    s_waitcnt lgkmcnt(6)
    v_mfma_f32_16x16x32_bf16 v[112:115], a[112:115], v[172:175], v[112:115]
    ds_read_b64 v[160:161], v198 offset:1536
    v_mfma_f32_32x32x16_bf16 v[80:95], a[112:115], v[176:179], v[80:95]
    ds_read_b64 v[162:163], v198 offset:1600
    ds_read_b64 v[164:165], v196 offset:12288
    ds_read_b64 v[166:167], v196 offset:12800
    v_mfma_f32_32x32x16_bf16 v[96:111], a[112:115], v[180:183], v[96:111]
    ds_read_b64 v[168:169], v196 offset:12544
    ds_read_b64 v[170:171], v196 offset:13056
    s_waitcnt lgkmcnt(6)
    v_mfma_f32_16x16x32_bf16 v[112:115], a[116:119], v[184:187], v[112:115]
    ds_read_b64 v[172:173], v198 offset:1792
    v_mfma_f32_32x32x16_bf16 v[80:95], a[116:119], v[188:191], v[80:95]
    ds_read_b64 v[174:175], v198 offset:1856
    ds_read_b64 v[176:177], v196 offset:14336
    ds_read_b64 v[178:179], v196 offset:14848
    v_mfma_f32_32x32x16_bf16 v[96:111], a[116:119], v[192:195], v[96:111]
    ds_read_b64 v[180:181], v196 offset:14592
    ds_read_b64 v[182:183], v196 offset:15104
sl_70:
    s_waitcnt vmcnt(1)
    v_max3_u32 v2, v152, v153, v154
    s_waitcnt vmcnt(0)
    v_max3_u32 v2, v2, v155, v156
    v_max_u32 v2, v2, v157
    v_cmp_eq_u32 vcc, -1, v2
    s_nop 0
    s_cbranch_vccnz rd_71
rc_72:
    s_barrier
    s_waitcnt lgkmcnt(6)
    v_mfma_f32_16x16x32_bf16 v[112:115], a[120:123], v[160:163], v[112:115]
    v_add_u32 v198, v49, v198
    v_mfma_f32_32x32x16_bf16 v[80:95], a[120:123], v[164:167], v[80:95]
    v_add_u32 v196, 19584, v196
    ds_read_b64 v[184:185], v198 offset:0
    ds_read_b64 v[186:187], v198 offset:64
    v_mul_f32 v148, v24, v157
    v_mul_f32 v149, v25, v157
    v_mfma_f32_32x32x16_bf16 v[96:111], a[120:123], v[168:171], v[96:111]
    ds_read_b64 v[188:189], v196 offset:0
    ds_read_b64 v[190:191], v196 offset:512
    s_mov_b32 s96, 12058624
    buffer_load_dwordx4 v[216:219], v56, s[16:19], s96 offen offset:0 sc1
    v_mul_f32 v150, v26, v157
    v_mul_f32_e64 v151, v27, v157
    s_waitcnt lgkmcnt(4)
    v_mfma_f32_16x16x32_bf16 v[112:115], a[124:127], v[172:175], v[112:115]
    ds_read_b64 v[192:193], v198 offset:256
    v_mfma_f32_32x32x16_bf16 v[80:95], a[124:127], v[176:179], v[80:95]
    ds_read_b64 v[194:195], v198 offset:320
    ds_read_b64 v[160:161], v196 offset:2048
    v_mul_f32 v116, v8, v153
    v_mul_f32 v117, v9, v153
    v_mul_f32_e64 v118, v10, v153
    v_mfma_f32_32x32x16_bf16 v[96:111], a[124:127], v[180:183], v[96:111]
    ds_read_b64 v[162:163], v196 offset:2560
    buffer_load_dwordx4 v[220:223], v56, s[16:19], s96 offen offset:256 sc1
    v_mul_f32 v119, v11, v153
    v_mul_f32_e64 v120, v12, v153
    s_waitcnt lgkmcnt(4)
    v_mfma_f32_16x16x32_bf16 v[112:115], a[128:131], v[184:187], v[112:115]
    ds_read_b64 v[164:165], v198 offset:512
    v_mfma_f32_32x32x16_bf16 v[80:95], a[128:131], v[188:191], v[80:95]
    ds_read_b64 v[166:167], v198 offset:576
    ds_read_b64 v[168:169], v196 offset:4096
    ds_read_b64 v[170:171], v196 offset:4608
    v_mul_f32 v121, v13, v153
    v_mul_f32_e64 v122, v14, v153
    s_waitcnt lgkmcnt(4)
    v_mfma_f32_16x16x32_bf16 v[112:115], a[132:135], v[192:195], v[112:115]
    ds_read_b64 v[172:173], v198 offset:768
    v_mfma_f32_32x32x16_bf16 v[80:95], a[132:135], v[160:163], v[80:95]
    ds_read_b64 v[174:175], v198 offset:832
    ds_read_b64 v[176:177], v196 offset:6144
    ds_read_b64 v[178:179], v196 offset:6656
    s_mov_b32 s96, 12091392
    buffer_load_dwordx4 v[224:227], v56, s[16:19], s96 offen offset:0 sc1
    v_mul_f32 v123, v15, v153
    v_mul_f32_e64 v124, v16, v153
    s_waitcnt lgkmcnt(4)
    v_mfma_f32_16x16x32_bf16 v[112:115], a[136:139], v[164:167], v[112:115]
    ds_read_b64 v[180:181], v198 offset:1024
    v_mfma_f32_32x32x16_bf16 v[80:95], a[136:139], v[168:171], v[80:95]
    ds_read_b64 v[182:183], v198 offset:1088
    ds_read_b64 v[184:185], v196 offset:8192
    ds_read_b64 v[186:187], v196 offset:8704
    v_mul_f32 v125, v17, v153
    v_mul_f32_e64 v126, v18, v153
    s_waitcnt lgkmcnt(4)
    v_mfma_f32_16x16x32_bf16 v[112:115], a[140:143], v[172:175], v[112:115]
    ds_read_b64 v[188:189], v198 offset:1280
    v_mfma_f32_32x32x16_bf16 v[80:95], a[140:143], v[176:179], v[80:95]
    ds_read_b64 v[190:191], v198 offset:1344
    ds_read_b64 v[192:193], v196 offset:10240
    ds_read_b64 v[194:195], v196 offset:10752
    buffer_load_dwordx4 v[228:231], v56, s[16:19], s96 offen offset:256 sc1
    v_mul_f32 v127, v19, v153
    v_mul_f32_e64 v128, v20, v153
    s_waitcnt lgkmcnt(4)
    v_mfma_f32_16x16x32_bf16 v[112:115], a[144:147], v[180:183], v[112:115]
    ds_read_b64 v[160:161], v198 offset:1536
    v_mfma_f32_32x32x16_bf16 v[80:95], a[144:147], v[184:187], v[80:95]
    ds_read_b64 v[162:163], v198 offset:1600
    ds_read_b64 v[164:165], v196 offset:12288
    ds_read_b64 v[166:167], v196 offset:12800
    v_mul_f32 v129, v21, v153
    v_mul_f32_e64 v130, v22, v153
    s_waitcnt lgkmcnt(4)
    v_mfma_f32_16x16x32_bf16 v[112:115], a[148:151], v[188:191], v[112:115]
    ds_read_b64 v[168:169], v198 offset:1792
    v_mfma_f32_32x32x16_bf16 v[80:95], a[148:151], v[192:195], v[80:95]
    ds_read_b64 v[170:171], v198 offset:1856
    ds_read_b64 v[172:173], v196 offset:14336
    ds_read_b64 v[174:175], v196 offset:14848
    s_mov_b32 s96, 12124160
    buffer_load_dwordx4 v[232:235], v56, s[16:19], s96 offen offset:0 sc1
    v_mul_f32 v131, v23, v153
    v_mul_f32_e64 v132, v8, v155
    s_waitcnt lgkmcnt(4)
    v_mfma_f32_16x16x32_bf16 v[112:115], a[152:155], v[160:163], v[112:115]
    ds_read_b64 v[176:177], v196 offset:256
    v_mfma_f32_32x32x16_bf16 v[80:95], a[152:155], v[164:167], v[80:95]
    ds_read_b64 v[178:179], v196 offset:768
    ds_read_b64 v[180:181], v196 offset:2304
    ds_read_b64 v[182:183], v196 offset:2816
    v_mul_f32 v133, v9, v155
    v_mul_f32_e64 v134, v10, v155
    s_waitcnt lgkmcnt(4)
    v_mfma_f32_16x16x32_bf16 v[112:115], a[156:159], v[168:171], v[112:115]
    ds_read_b64 v[184:185], v196 offset:4352
    v_mfma_f32_32x32x16_bf16 v[80:95], a[156:159], v[172:175], v[80:95]
    ds_read_b64 v[186:187], v196 offset:4864
    ds_read_b64 v[188:189], v196 offset:6400
    ds_read_b64 v[190:191], v196 offset:6912
    buffer_load_dwordx4 v[236:239], v56, s[16:19], s96 offen offset:256 sc1
    v_mul_f32 v135, v11, v155
    v_mul_f32 v136, v12, v155
    v_mul_f32 v137, v13, v155
    v_mul_f32 v138, v14, v155
    v_mul_f32 v139, v15, v155
    v_mul_f32 v140, v16, v155
    v_mul_f32 v141, v17, v155
    v_mul_f32 v142, v18, v155
    v_mul_f32 v143, v19, v155
    v_mul_f32 v144, v20, v155
    v_mul_f32 v145, v21, v155
    v_mul_f32 v146, v22, v155
    v_mul_f32 v147, v23, v155
    s_waitcnt lgkmcnt(4)
    v_mfma_f32_32x32x16_bf16 v[96:111], a[128:131], v[176:179], v[96:111]
    ds_read_b64 v[192:193], v196 offset:8448
    ds_read_b64 v[194:195], v196 offset:8960
    v_mfma_f32_32x32x16_bf16 v[96:111], a[132:135], v[180:183], v[96:111]
    ds_read_b64 v[160:161], v196 offset:10496
    ds_read_b64 v[162:163], v196 offset:11008
    s_mov_b32 s96, 12156928
    buffer_load_dwordx4 v[240:243], v56, s[16:19], s96 offen offset:0 sc1
    v_fma_f32 v112, v112, v156, v148
    v_fma_f32 v113, v113, v156, v149
    s_waitcnt lgkmcnt(4)
    v_mfma_f32_32x32x16_bf16 v[96:111], a[136:139], v[184:187], v[96:111]
    ds_read_b64 v[164:165], v196 offset:12544
    ds_read_b64 v[166:167], v196 offset:13056
    v_fma_f32 v114, v114, v156, v150
    v_fma_f32 v115, v115, v156, v151
    v_cvt_pk_bf16_f32 v112, v112, v113
    v_mfma_f32_32x32x16_bf16 v[96:111], a[140:143], v[188:191], v[96:111]
    ds_read_b64 v[168:169], v196 offset:14592
    ds_read_b64 v[170:171], v196 offset:15104
    buffer_load_dwordx4 v[244:247], v56, s[16:19], s96 offen offset:256 sc1
    v_cvt_pk_bf16_f32 v113, v114, v115
    v_fma_f32 v80, v80, v152, v116
    s_waitcnt lgkmcnt(4)
    v_mfma_f32_32x32x16_bf16 v[96:111], a[144:147], v[192:195], v[96:111]
    v_fma_f32 v81, v81, v152, v117
    v_fma_f32 v82, v82, v152, v118
    v_fma_f32 v83, v83, v152, v119
    v_cvt_pk_bf16_f32 v80, v80, v81
    v_cvt_pk_bf16_f32 v81, v82, v83
    v_mfma_f32_32x32x16_bf16 v[96:111], a[148:151], v[160:163], v[96:111]
    ds_write_b64 v40, v[112:113] offset:0
    ds_write_b64 v38, v[80:81] offset:0
    v_fma_f32 v84, v84, v152, v120
    v_fma_f32 v85, v85, v152, v121
    s_waitcnt lgkmcnt(2)
    v_mfma_f32_32x32x16_bf16 v[96:111], a[152:155], v[164:167], v[96:111]
    v_fma_f32 v86, v86, v152, v122
    v_fma_f32 v87, v87, v152, v123
    v_cvt_pk_bf16_f32 v84, v84, v85
    v_cvt_pk_bf16_f32 v85, v86, v87
    v_fma_f32 v88, v88, v152, v124
    v_mfma_f32_32x32x16_bf16 v[96:111], a[156:159], v[168:171], v[96:111]
    s_mov_b32 s96, 12058624
    buffer_load_dwordx2 v[248:249], v57, s[16:19], s96 offen offset:0 sc1
    v_fma_f32 v89, v89, v152, v125
    v_fma_f32 v90, v90, v152, v126
    v_fma_f32 v91, v91, v152, v127
    v_cvt_pk_bf16_f32 v88, v88, v89
    v_cvt_pk_bf16_f32 v89, v90, v91
    ds_write_b64 v38, v[84:85] offset:6400
    ds_write_b64 v38, v[88:89] offset:12800
    v_fma_f32 v92, v92, v152, v128
    v_fma_f32 v93, v93, v152, v129
    v_fma_f32 v94, v94, v152, v130
    v_fma_f32 v95, v95, v152, v131
    v_cvt_pk_bf16_f32 v92, v92, v93
    v_cvt_pk_bf16_f32 v93, v94, v95
    ds_write_b64 v39, v[92:93] offset:0
    v_pk_fma_f32 v[96:97], v[96:97], v[154:155], v[132:133] op_sel_hi:[1,0,1]
    v_pk_fma_f32 v[98:99], v[98:99], v[154:155], v[134:135] op_sel_hi:[1,0,1]
    v_cvt_pk_bf16_f32 v96, v96, v97
    v_cvt_pk_bf16_f32 v97, v98, v99
    v_pk_fma_f32 v[100:101], v[100:101], v[154:155], v[136:137] op_sel_hi:[1,0,1]
    v_pk_fma_f32 v[102:103], v[102:103], v[154:155], v[138:139] op_sel_hi:[1,0,1]
    v_cvt_pk_bf16_f32 v100, v100, v101
    v_cvt_pk_bf16_f32 v101, v102, v103
    ds_write_b64 v38, v[96:97] offset:1600
    ds_write_b64 v38, v[100:101] offset:8000
    v_pk_fma_f32 v[104:105], v[104:105], v[154:155], v[140:141] op_sel_hi:[1,0,1]
    v_pk_fma_f32 v[106:107], v[106:107], v[154:155], v[142:143] op_sel_hi:[1,0,1]
    v_cvt_pk_bf16_f32 v104, v104, v105
    v_cvt_pk_bf16_f32 v105, v106, v107
    v_pk_fma_f32 v[108:109], v[108:109], v[154:155], v[144:145] op_sel_hi:[1,0,1]
    v_pk_fma_f32 v[110:111], v[110:111], v[154:155], v[146:147] op_sel_hi:[1,0,1]
    v_cvt_pk_bf16_f32 v108, v108, v109
    v_cvt_pk_bf16_f32 v109, v110, v111
    ds_write_b64 v38, v[104:105] offset:14400
    ds_write_b64 v39, v[108:109] offset:1600
    v_cmp_u_f32 vcc, v82, v114
    v_cmp_u_f32 s[82:83], v98, v98
    s_lshl_b32 s25, s24, 2
    s_add_u32 s25, s25, 161280
    s_or_b64 vcc, vcc, s[82:83]
    s_cselect_b32 s26, 1, 0
    v_mov_b32 v196, s25
    v_mov_b32 v197, s26
    ds_write_b32 v196, v197
    s_waitcnt lgkmcnt(0)
    s_barrier
    v_mov_b32 v158, 161280
    ds_read_b128 v[128:131], v158
    v_mov_b32 v94, 0
    v_mov_b32 v95, 0
    v_mov_b32 v98, 0
    v_mov_b32_e64 v99, 0
    s_mov_b64 exec, 0xffff
    ds_read_b64 v[94:95], v42 offset:320
    ds_read_b64 v[98:99], v42 offset:640
    s_mov_b64 exec, -1
    s_nop 0
    ds_read_b64 v[92:93], v41 offset:320
    ds_read_b64 v[96:97], v41 offset:640
    ds_read_b64 v[84:85], v41 offset:6720
    ds_read_b64 v[86:87], v42 offset:6720
    ds_read_b64 v[80:81], v41 offset:6400
    ds_read_b64 v[82:83], v42 offset:6400
    ds_read_b64 v[88:89], v41 offset:7040
    ds_read_b64 v[90:91], v42 offset:7040
    ds_read_b64_tr_b16 v[106:107], v44 offset:0
    ds_read_b64_tr_b16 v[100:101], v43 offset:0
    buffer_load_dwordx2 v[252:253], v57, s[16:19], s96 offen offset:128 sc1
    ds_read_b64_tr_b16 v[108:109], v44 offset:320
    ds_read_b64_tr_b16 v[102:103], v43 offset:320
    ds_read_b64_tr_b16 v[110:111], v44 offset:640
    ds_read_b64_tr_b16 v[104:105], v43 offset:640
    s_mov_b32 s82, 0x3ea52b5c
    s_lshl_b32 s25, s98, 4
    s_add_u32 s25, s25, 12058624
    s_lshl_b32 s26, s98, 3
    s_mov_b32 s96, 12075008
    buffer_load_dwordx2 v[250:251], v57, s[16:19], s96 offen offset:0 sc1
    s_add_u32 s26, s26, 12058624
    s_waitcnt lgkmcnt(15)
    v_or3_b32 v128, v128, v129, v130
    v_or_b32 v128, v128, v131
    v_cmp_ne_u32 vcc, 0, v128
    s_nop 0
    s_cbranch_vccnz rd_73
rc_74:
    s_waitcnt lgkmcnt(10)
    v_mfma_f32_16x16x32_bf16 v[116:119], v[84:87], v[92:95], v[28:31]
    v_mfma_f32_16x16x32_bf16 v[120:123], v[84:87], v[96:99], v[32:35]
    s_waitcnt lgkmcnt(8)
    v_mfma_f32_16x16x32_bf16 v[112:115], v[80:83], v[92:95], v[32:35]
    s_waitcnt lgkmcnt(6)
    v_mfma_f32_16x16x32_bf16 v[124:127], v[88:91], v[96:99], v[28:31]
    buffer_load_dwordx2 v[254:255], v57, s[16:19], s96 offen offset:128 sc1
    s_nop 4
    v_max_f32 v112, v112, v116
    v_max_f32 v113, v113, v117
    v_max_f32 v114, v114, v118
    v_max_f32 v115, v115, v119
    v_max3_f32 v156, v112, v113, v114
    v_max_f32 v156, v156, v115
    v_max_f32 v120, v120, v124
    v_max_f32 v121, v121, v125
    s_mov_b32 s96, 9437184
    buffer_load_dwordx4 v[208:211], v59, s[16:19], s96 offen sc1
    v_max_f32 v122, v122, v126
    v_max_f32 v123, v123, v127
    v_max3_f32 v157, v120, v121, v122
    v_max_f32 v157, v157, v123
    s_nop 1
    v_permlane16_swap_b32 v156, v157
    v_max_f32 v156, v156, v157
    v_mov_b32 v157, v156
    s_nop 1
    v_permlane32_swap_b32_e64 v156, v157
    s_add_u32 s97, s36, 9437184
    buffer_load_dword v212, v61, s[16:19], s97 offen sc1
    v_max_f32 v156, v156, v157
    v_mul_f32 v156, s82, v156
    v_mov_b32 v157, v156
    s_nop 1
    v_permlane16_swap_b32_e64 v156, v157
    v_fma_f32 v112, v112, s82, -v156
    v_fma_f32 v113, v113, s82, -v156
    v_fma_f32 v114, v114, s82, -v156
    v_fma_f32 v115, v115, s82, -v156
    v_exp_f32 v112, v112
    v_exp_f32 v113, v113
    v_exp_f32 v114, v114
    v_exp_f32 v115, v115
    v_cvt_pk_bf16_f32 v116, v112, v113
    v_cvt_pk_bf16_f32 v117, v114, v115
    v_bfi_b32 v128, v36, 0, v116
    v_and_b32 v130, v36, v116
    v_bfi_b32 v129, v37, 0, v117
    v_and_b32 v131, v37, v117
    s_waitcnt lgkmcnt(3)
    s_nop 0
    v_mfma_f32_16x16x32_bf16 v[144:147], v[106:109], v[128:131], 0
    s_waitcnt lgkmcnt(2)
    v_mfma_f32_16x16x32_bf16 v[136:139], v[100:103], v[128:131], 0
    v_fma_f32 v120, v120, s82, -v157
    v_fma_f32 v121, v121, s82, -v157
    v_fma_f32 v122, v122, s82, -v157
    v_fma_f32 v123, v123, s82, -v157
    v_exp_f32 v120, v120
    v_exp_f32 v121, v121
    v_exp_f32 v122, v122
    v_exp_f32_e64 v123, v123
    v_cvt_pk_bf16_f32 v124, v120, v121
    v_cvt_pk_bf16_f32 v125, v122, v123
    v_bfi_b32 v132, v36, 0, v124
    v_and_b32 v134, v36, v124
    v_bfi_b32 v133, v37, 0, v125
    v_and_b32 v135, v37, v125
    s_waitcnt lgkmcnt(1)
    s_nop 0
    v_mfma_f32_16x16x32_bf16 v[148:151], v[108:111], v[132:135], 0
    s_waitcnt lgkmcnt(0)
    v_mfma_f32_16x16x32_bf16 v[140:143], v[102:105], v[132:135], 0
    v_mov_b32 v158, v144
    s_nop 1
    v_permlane16_swap_b32 v144, v158
    v_rcp_f32 v158, v158
    s_nop 0
    v_pk_mul_f32 v[136:137], v[136:137], v[158:159] op_sel_hi:[1,0]
    v_pk_mul_f32 v[138:139], v[138:139], v[158:159] op_sel_hi:[1,0]
    v_pk_mul_f32 v[144:145], v[144:145], v[158:159] op_sel_hi:[1,0]
    v_pk_mul_f32 v[146:147], v[146:147], v[158:159] op_sel_hi:[1,0]
    v_cvt_pk_bf16_f32 v112, v136, v137
    v_cvt_pk_bf16_f32 v116, v144, v145
    v_cvt_pk_bf16_f32 v113, v138, v139
    v_cvt_pk_bf16_f32 v117, v146, v147
    v_mov_b32 v160, v148
    s_nop 1
    v_permlane16_swap_b32 v148, v160
    v_rcp_f32_e64 v160, v160
    s_nop 0
    v_pk_mul_f32 v[140:141], v[140:141], v[160:161] op_sel_hi:[1,0]
    v_pk_mul_f32 v[142:143], v[142:143], v[160:161] op_sel_hi:[1,0]
    v_pk_mul_f32 v[148:149], v[148:149], v[160:161] op_sel_hi:[1,0]
    v_pk_mul_f32 v[150:151], v[150:151], v[160:161] op_sel_hi:[1,0]
    v_cvt_pk_bf16_f32 v114, v140, v141
    v_cvt_pk_bf16_f32 v118, v148, v149
    v_cvt_pk_bf16_f32 v115, v142, v143
    v_cvt_pk_bf16_f32 v119, v150, v151
    v_permlane16_swap_b32 v112, v114
    v_permlane16_swap_b32 v113, v115
    v_permlane16_swap_b32 v116, v118
    v_permlane16_swap_b32 v117, v119
    buffer_store_dwordx4 v[112:115], v45, s[16:19], s25 offen sc1
    s_mov_b64 exec, s[80:81]
    buffer_store_dwordx2 v[116:117], v46, s[16:19], s26 offen sc1
    s_mov_b64 exec, -1
oe_75:
    s_waitcnt vmcnt(15)
    v_mfma_f32_16x16x32_bf16 v[112:115], a[176:179], v[216:219], 0
    v_mov_b32 v136, 0
    v_mov_b32 v137, 0
    s_waitcnt vmcnt(14)
    v_mfma_f32_16x16x32_bf16 v[116:119], a[176:179], v[220:223], 0
    v_mov_b32 v138, 0
    v_mov_b32 v139, 0
    s_waitcnt vmcnt(13)
    v_mfma_f32_16x16x32_bf16 v[112:115], a[196:199], v[224:227], v[112:115]
    v_mov_b32 v140, 0
    v_mov_b32 v141, 0
    s_waitcnt vmcnt(12)
    v_mfma_f32_16x16x32_bf16 v[116:119], a[196:199], v[228:231], v[116:119]
    s_mov_b32 s25, 14680064
    s_add_u32 s26, s36, 14680064
    s_waitcnt vmcnt(11)
    v_mfma_f32_16x16x32_bf16 v[112:115], a[216:219], v[232:235], v[112:115]
    s_add_u32 s27, s35, 3506176
    s_mov_b32 s28, 0x99999999
    s_waitcnt vmcnt(10)
    v_mfma_f32_16x16x32_bf16 v[116:119], a[216:219], v[236:239], v[116:119]
    s_mov_b32 s29, 0x99999999
    s_waitcnt vmcnt(9)
    v_mfma_f32_16x16x32_bf16 v[112:115], a[236:239], v[240:243], v[112:115]
    s_waitcnt vmcnt(8)
    v_mfma_f32_16x16x32_bf16 v[116:119], a[236:239], v[244:247], v[116:119]
    s_waitcnt vmcnt(5)
    v_mfma_f32_16x16x32_bf16 v[112:115], v[52:55], v[248:251], v[112:115]
    s_waitcnt vmcnt(4)
    v_mfma_f32_16x16x32_bf16 v[116:119], v[52:55], v[252:255], v[116:119]
    v_mfma_f32_16x16x32_bf16 v[88:91], a[164:167], v[216:219], 0
    v_mfma_f32_16x16x32_bf16 v[92:95], a[164:167], v[220:223], 0
    v_mfma_f32_16x16x32_bf16 v[88:91], a[184:187], v[224:227], v[88:91]
    s_waitcnt vmcnt(3)
    v_max3_u32 v132, v208, v209, v210
    s_waitcnt vmcnt(2)
    v_max3_u32 v132, v132, v211, v212
    v_mfma_f32_16x16x32_bf16 v[92:95], a[184:187], v[228:231], v[92:95]
    v_cmp_eq_u32 s[82:83], -1, v132
    v_mfma_f32_16x16x32_bf16 v[88:91], a[204:207], v[232:235], v[88:91]
    v_mfma_f32_16x16x32_bf16 v[92:95], a[204:207], v[236:239], v[92:95]
    v_cmp_u_f32 vcc, v112, v116
    s_nop 0
    s_or_b64 vcc, vcc, s[82:83]
    s_cbranch_vccnz rd_76
rc_77:
    v_mfma_f32_16x16x32_bf16 v[88:91], a[224:227], v[240:243], v[88:91]
    ds_write_b128 v203, v[112:115] offset:24576
    v_mfma_f32_16x16x32_bf16 v[92:95], a[224:227], v[244:247], v[92:95]
    v_mfma_f32_16x16x32_bf16 v[88:91], a[244:247], v[248:251], v[88:91]
    ds_write_b128 v203, v[116:119] offset:25600
    v_mfma_f32_16x16x32_bf16 v[92:95], a[244:247], v[252:255], v[92:95]
    v_mfma_f32_16x16x32_bf16 v[96:99], a[168:171], v[216:219], 0
    v_lshlrev_b32_e64 v120, 16, v208
    v_and_b32 v121, 0xffff0000, v208
    v_mfma_f32_16x16x32_bf16 v[100:103], a[168:171], v[220:223], 0
    v_lshlrev_b32_e64 v122, 16, v209
    v_and_b32 v123, 0xffff0000, v209
    v_mfma_f32_16x16x32_bf16 v[96:99], a[188:191], v[224:227], v[96:99]
    v_lshlrev_b32_e64 v124, 16, v210
    v_and_b32 v125, 0xffff0000, v210
    v_mfma_f32_16x16x32_bf16 v[100:103], a[188:191], v[228:231], v[100:103]
    v_lshlrev_b32_e64 v126, 16, v211
    v_and_b32 v127, 0xffff0000, v211
    v_mfma_f32_16x16x32_bf16 v[96:99], a[208:211], v[232:235], v[96:99]
    v_lshlrev_b32_e64 v128, 16, v212
    v_and_b32 v129, 0xffff0000, v212
    v_mfma_f32_16x16x32_bf16 v[100:103], a[208:211], v[236:239], v[100:103]
    v_mfma_f32_16x16x32_bf16 v[96:99], a[228:231], v[240:243], v[96:99]
    ds_write_b128 v200, v[88:91] offset:0
    v_mfma_f32_16x16x32_bf16 v[100:103], a[228:231], v[244:247], v[100:103]
    v_mfma_f32_16x16x32_bf16 v[96:99], a[248:251], v[248:251], v[96:99]
    ds_write_b128 v200, v[92:95] offset:1024
    v_mfma_f32_16x16x32_bf16 v[100:103], a[248:251], v[252:255], v[100:103]
    v_mfma_f32_16x16x32_bf16 v[104:107], a[172:175], v[216:219], 0
    v_mfma_f32_16x16x32_bf16 v[108:111], a[172:175], v[220:223], 0
    v_mfma_f32_16x16x32_bf16 v[104:107], a[192:195], v[224:227], v[104:107]
    v_mfma_f32_16x16x32_bf16 v[108:111], a[192:195], v[228:231], v[108:111]
    v_mfma_f32_16x16x32_bf16 v[104:107], a[212:215], v[232:235], v[104:107]
    v_mfma_f32_16x16x32_bf16 v[108:111], a[212:215], v[236:239], v[108:111]
    v_mfma_f32_16x16x32_bf16 v[104:107], a[232:235], v[240:243], v[104:107]
    ds_write_b128 v201, v[96:99] offset:2048
    v_mfma_f32_16x16x32_bf16 v[108:111], a[232:235], v[244:247], v[108:111]
    v_mfma_f32_16x16x32_bf16 v[104:107], a[252:255], v[248:251], v[104:107]
    ds_write_b128 v201, v[100:103] offset:3072
    v_mfma_f32_16x16x32_bf16 v[108:111], a[252:255], v[252:255], v[108:111]
    v_mfma_f32_16x16x32_bf16 v[80:83], a[160:163], v[216:219], v[120:123]
    v_mfma_f32_16x16x32_bf16 v[84:87], a[160:163], v[220:223], v[124:127]
    v_mfma_f32_16x16x32_bf16 v[80:83], a[180:183], v[224:227], v[80:83]
    v_mfma_f32_16x16x32_bf16 v[84:87], a[180:183], v[228:231], v[84:87]
    v_mfma_f32_16x16x32_bf16 v[80:83], a[200:203], v[232:235], v[80:83]
    s_nop 0
    ds_write_b128 v202, v[104:107] offset:4096
    v_mfma_f32_16x16x32_bf16 v[84:87], a[200:203], v[236:239], v[84:87]
    ds_write_b128 v202, v[108:111] offset:5120
    v_mfma_f32_16x16x32_bf16 v[80:83], a[220:223], v[240:243], v[80:83]
    v_mfma_f32_16x16x32_bf16 v[84:87], a[220:223], v[244:247], v[84:87]
    v_mfma_f32_16x16x32_bf16 v[80:83], a[240:243], v[248:251], v[80:83]
    v_mfma_f32_16x16x32_bf16 v[84:87], a[240:243], v[252:255], v[84:87]
    s_waitcnt lgkmcnt(0)
    s_barrier
    s_nop 0
    ds_read_b128 v[88:91], v204 offset:0
    ds_read_b128 v[92:95], v204 offset:1024
    ds_read_b128 v[96:99], v204 offset:2048
    ds_read_b128 v[100:103], v204 offset:3072
    ds_read_b128 v[104:107], v204 offset:4096
    ds_read_b128 v[108:111], v204 offset:5120
    ds_read_b64 v[112:113], v205 offset:24576
    ds_read_b64 v[114:115], v205 offset:26624
    ds_read_b64 v[116:117], v205 offset:28672
    ds_read_b64 v[118:119], v205 offset:30720
    s_mov_b32 s96, 12062720
    buffer_load_dwordx4 v[216:219], v56, s[16:19], s96 offen offset:0 sc1
    buffer_load_dwordx4 v[220:223], v56, s[16:19], s96 offen offset:256 sc1
    s_mov_b32 s96, 12095488
    buffer_load_dwordx4 v[224:227], v56, s[16:19], s96 offen offset:0 sc1
    s_waitcnt lgkmcnt(9)
    v_pk_add_f32 v[80:81], v[80:81], v[88:89]
    v_pk_add_f32 v[82:83], v[82:83], v[90:91]
    s_waitcnt lgkmcnt(8)
    v_pk_add_f32 v[84:85], v[84:85], v[92:93]
    v_pk_add_f32 v[86:87], v[86:87], v[94:95]
    s_waitcnt lgkmcnt(7)
    v_pk_add_f32 v[80:81], v[80:81], v[96:97]
    v_pk_add_f32 v[82:83], v[82:83], v[98:99]
    s_waitcnt lgkmcnt(6)
    v_pk_add_f32 v[84:85], v[84:85], v[100:101]
    v_pk_add_f32 v[86:87], v[86:87], v[102:103]
    s_waitcnt lgkmcnt(5)
    v_pk_add_f32 v[80:81], v[80:81], v[104:105]
    v_pk_add_f32 v[82:83], v[82:83], v[106:107]
    s_waitcnt lgkmcnt(4)
    v_pk_add_f32 v[84:85], v[84:85], v[108:109]
    v_pk_add_f32 v[86:87], v[86:87], v[110:111]
    v_cvt_pk_bf16_f32 v132, v80, v81
    v_cvt_pk_bf16_f32 v133, v82, v83
    v_cvt_pk_bf16_f32 v134, v84, v85
    v_cvt_pk_bf16_f32 v135, v86, v87
    s_waitcnt lgkmcnt(3)
    v_pk_add_f32 v[128:129], v[128:129], v[112:113]
    s_waitcnt lgkmcnt(2)
    v_pk_add_f32 v[128:129], v[128:129], v[114:115]
    s_waitcnt lgkmcnt(1)
    v_pk_add_f32 v[128:129], v[128:129], v[116:117]
    s_waitcnt lgkmcnt(0)
    v_pk_add_f32 v[128:129], v[128:129], v[118:119]
    v_cvt_pk_bf16_f32 v130, v128, v129
    buffer_store_dwordx4 v[132:135], v59, s[16:19], s25 offen sc1
    buffer_store_dword v130, v61, s[16:19], s26 offen sc1
    v_dot2c_f32_bf16 v136, v132, v215
    v_dot2c_f32_bf16 v137, v132, v132
    v_dot2c_f32_bf16 v136, v133, v215
    v_dot2c_f32_bf16 v137, v133, v133
    v_dot2c_f32_bf16 v138, v134, v215
    v_dot2c_f32_bf16 v139, v134, v134
    v_dot2c_f32_bf16 v138, v135, v215
    v_dot2c_f32_bf16 v139, v135, v135
    v_dot2c_f32_bf16 v140, v130, v215
    v_dot2c_f32_bf16 v141, v130, v130
    v_permlane32_swap_b32 v136, v138
    v_permlane32_swap_b32 v137, v139
    v_pk_add_f32 v[136:137], v[136:137], v[138:139]
    v_pk_add_f32 v[136:137], v[136:137], v[140:141]
    s_nop 1
    v_permlane16_swap_b32 v136, v137
    v_add_f32_e64 v136, v136, v137
    ds_write_b32 v206, v136 offset:32768
    buffer_load_dwordx4 v[228:231], v56, s[16:19], s96 offen offset:256 sc1
    s_mov_b32 s96, 12128256
    buffer_load_dwordx4 v[232:235], v56, s[16:19], s96 offen offset:0 sc1
    buffer_load_dwordx4 v[236:239], v56, s[16:19], s96 offen offset:256 sc1
    s_mov_b32 s96, 12161024
    buffer_load_dwordx4 v[240:243], v56, s[16:19], s96 offen offset:0 sc1
    buffer_load_dwordx4 v[244:247], v56, s[16:19], s96 offen offset:256 sc1
    s_mov_b32 s96, 12060672
    buffer_load_dwordx2 v[248:249], v57, s[16:19], s96 offen offset:0 sc1
    buffer_load_dwordx2 v[252:253], v57, s[16:19], s96 offen offset:128 sc1
    s_mov_b32 s96, 12077056
    buffer_load_dwordx2 v[250:251], v57, s[16:19], s96 offen offset:0 sc1
    buffer_load_dwordx2 v[254:255], v57, s[16:19], s96 offen offset:128 sc1
    s_mov_b32 s96, 9439232
    buffer_load_dwordx4 v[208:211], v59, s[16:19], s96 offen sc1
    s_add_u32 s97, s36, 9439232
    buffer_load_dword v212, v61, s[16:19], s97 offen sc1
    s_waitcnt lgkmcnt(0)
    s_barrier
    ds_read2st64_b32 v[136:137], v207 offset0:0 offset1:1
    ds_read2st64_b32 v[138:139], v207 offset0:2 offset1:3
    ds_read_b64_tr_b16 v[144:145], v65 offset:32
    ds_read_b64_tr_b16 v[146:147], v65 offset:0
    ds_read_b64_tr_b16 v[148:149], v65 offset:160
    ds_read_b64_tr_b16 v[150:151], v65 offset:128
    ds_read_b64_tr_b16 v[152:153], v65 offset:288
    ds_read_b64_tr_b16 v[154:155], v65 offset:256
    ds_read_b64_tr_b16 v[156:157], v65 offset:416
    ds_read_b64_tr_b16 v[158:159], v65 offset:384
    ds_read_b64_tr_b16 v[160:161], v65 offset:544
    ds_read_b64_tr_b16 v[162:163], v65 offset:512
    ds_read_b64_tr_b16 v[164:165], v65 offset:672
    ds_read_b64_tr_b16 v[166:167], v65 offset:640
    ds_read_b64_tr_b16 v[168:169], v65 offset:800
    ds_read_b64_tr_b16 v[170:171], v65 offset:768
    ds_read_b64_tr_b16 v[172:173], v65 offset:928
    ds_read_b64_tr_b16 v[174:175], v65 offset:896
    s_waitcnt lgkmcnt(15)
    v_pk_add_f32 v[136:137], v[136:137], v[138:139]
    v_add_f32 v136, v136, v137
    v_cndmask_b32 v136, v136, 1.0, s[28:29]
    s_mov_b64 exec, s[80:81]
    buffer_atomic_add_f32 v136, v214, s[16:19], s27 offen sc1
    s_mov_b64 exec, -1
    v_lshrrev_b32 v176, 4, v0
    v_mul_u32_u24 v176, 1216, v176
    v_and_b32 v177, 15, v0
    v_lshl_add_u32 v176, v177, 3, v176
    v_add_u32 v176, 64, v176
    v_mov_b32 v178, 0
    v_mov_b32 v179, 0
    ds_write_b64 v176, v[178:179]
    v_mov_b32 v70, 0
    v_mov_b32 v71, 0
    v_mov_b32 v72, 0
oe_78:
    s_waitcnt vmcnt(16)
    v_mfma_f32_16x16x32_bf16 v[112:115], a[176:179], v[216:219], 0
    v_mov_b32 v136, 0
    v_mov_b32 v137, 0
    s_waitcnt vmcnt(15)
    v_mfma_f32_16x16x32_bf16 v[116:119], a[176:179], v[220:223], 0
    v_mov_b32 v138, 0
    v_mov_b32 v139, 0
    s_waitcnt vmcnt(14)
    v_mfma_f32_16x16x32_bf16 v[112:115], a[196:199], v[224:227], v[112:115]
    v_mov_b32 v140, 0
    v_mov_b32 v141, 0
    s_waitcnt vmcnt(11)
    v_mfma_f32_16x16x32_bf16 v[116:119], a[196:199], v[228:231], v[116:119]
    s_mov_b32 s25, 14682112
    s_add_u32 s26, s36, 14682112
    s_waitcnt vmcnt(10)
    v_mfma_f32_16x16x32_bf16 v[112:115], a[216:219], v[232:235], v[112:115]
    s_add_u32 s27, s35, 3510272
    s_mov_b32 s28, 0x99999999
    s_waitcnt vmcnt(9)
    v_mfma_f32_16x16x32_bf16 v[116:119], a[216:219], v[236:239], v[116:119]
    s_mov_b32 s29, 0x99999999
    s_waitcnt vmcnt(8)
    v_mfma_f32_16x16x32_bf16 v[112:115], a[236:239], v[240:243], v[112:115]
    s_waitcnt vmcnt(7)
    v_mfma_f32_16x16x32_bf16 v[116:119], a[236:239], v[244:247], v[116:119]
    s_waitcnt vmcnt(4)
    v_mfma_f32_16x16x32_bf16 v[112:115], v[52:55], v[248:251], v[112:115]
    s_waitcnt vmcnt(3)
    v_mfma_f32_16x16x32_bf16 v[116:119], v[52:55], v[252:255], v[116:119]
    v_mfma_f32_16x16x32_bf16 v[88:91], a[164:167], v[216:219], 0
    v_mfma_f32_16x16x32_bf16 v[92:95], a[164:167], v[220:223], 0
    v_mfma_f32_16x16x32_bf16 v[88:91], a[184:187], v[224:227], v[88:91]
    s_waitcnt vmcnt(2)
    v_max3_u32 v132, v208, v209, v210
    s_waitcnt vmcnt(1)
    v_max3_u32 v132, v132, v211, v212
    v_mfma_f32_16x16x32_bf16 v[92:95], a[184:187], v[228:231], v[92:95]
    v_cmp_eq_u32 s[82:83], -1, v132
    v_mfma_f32_16x16x32_bf16 v[88:91], a[204:207], v[232:235], v[88:91]
    v_mfma_f32_16x16x32_bf16 v[92:95], a[204:207], v[236:239], v[92:95]
    v_cmp_u_f32 vcc, v112, v116
    s_nop 0
    s_or_b64 vcc, vcc, s[82:83]
    s_cbranch_vccnz rd_79
rc_80:
    v_mfma_f32_16x16x32_bf16 v[88:91], a[224:227], v[240:243], v[88:91]
    ds_write_b128 v203, v[112:115] offset:24576
    v_mfma_f32_16x16x32_bf16 v[92:95], a[224:227], v[244:247], v[92:95]
    v_mfma_f32_16x16x32_bf16 v[88:91], a[244:247], v[248:251], v[88:91]
    ds_write_b128 v203, v[116:119] offset:25600
    v_mfma_f32_16x16x32_bf16 v[92:95], a[244:247], v[252:255], v[92:95]
    v_mfma_f32_16x16x32_bf16 v[96:99], a[168:171], v[216:219], 0
    v_lshlrev_b32_e64 v120, 16, v208
    v_and_b32 v121, 0xffff0000, v208
    v_mfma_f32_16x16x32_bf16 v[100:103], a[168:171], v[220:223], 0
    v_lshlrev_b32_e64 v122, 16, v209
    v_and_b32 v123, 0xffff0000, v209
    v_mfma_f32_16x16x32_bf16 v[96:99], a[188:191], v[224:227], v[96:99]
    v_lshlrev_b32_e64 v124, 16, v210
    v_and_b32 v125, 0xffff0000, v210
    v_mfma_f32_16x16x32_bf16 v[100:103], a[188:191], v[228:231], v[100:103]
    v_lshlrev_b32_e64 v126, 16, v211
    v_and_b32 v127, 0xffff0000, v211
    v_mfma_f32_16x16x32_bf16 v[96:99], a[208:211], v[232:235], v[96:99]
    v_lshlrev_b32_e64 v128, 16, v212
    v_and_b32 v129, 0xffff0000, v212
    v_mfma_f32_16x16x32_bf16 v[100:103], a[208:211], v[236:239], v[100:103]
    v_mfma_f32_16x16x32_bf16 v[96:99], a[228:231], v[240:243], v[96:99]
    ds_write_b128 v200, v[88:91] offset:0
    v_mfma_f32_16x16x32_bf16 v[100:103], a[228:231], v[244:247], v[100:103]
    v_mfma_f32_16x16x32_bf16 v[96:99], a[248:251], v[248:251], v[96:99]
    ds_write_b128 v200, v[92:95] offset:1024
    v_mfma_f32_16x16x32_bf16 v[100:103], a[248:251], v[252:255], v[100:103]
    v_mfma_f32_16x16x32_bf16 v[104:107], a[172:175], v[216:219], 0
    v_mfma_f32_16x16x32_bf16 v[108:111], a[172:175], v[220:223], 0
    v_mfma_f32_16x16x32_bf16 v[104:107], a[192:195], v[224:227], v[104:107]
    v_mfma_f32_16x16x32_bf16 v[108:111], a[192:195], v[228:231], v[108:111]
    v_mfma_f32_16x16x32_bf16 v[104:107], a[212:215], v[232:235], v[104:107]
    v_mfma_f32_16x16x32_bf16 v[108:111], a[212:215], v[236:239], v[108:111]
    v_mfma_f32_16x16x32_bf16 v[104:107], a[232:235], v[240:243], v[104:107]
    ds_write_b128 v201, v[96:99] offset:2048
    v_mfma_f32_16x16x32_bf16 v[108:111], a[232:235], v[244:247], v[108:111]
    v_mfma_f32_16x16x32_bf16 v[104:107], a[252:255], v[248:251], v[104:107]
    ds_write_b128 v201, v[100:103] offset:3072
    v_mfma_f32_16x16x32_bf16 v[108:111], a[252:255], v[252:255], v[108:111]
    v_mfma_f32_16x16x32_bf16 v[80:83], a[160:163], v[216:219], v[120:123]
    v_mfma_f32_16x16x32_bf16 v[84:87], a[160:163], v[220:223], v[124:127]
    v_mfma_f32_16x16x32_bf16 v[80:83], a[180:183], v[224:227], v[80:83]
    v_mfma_f32_16x16x32_bf16 v[84:87], a[180:183], v[228:231], v[84:87]
    v_mfma_f32_16x16x32_bf16 v[80:83], a[200:203], v[232:235], v[80:83]
    s_nop 0
    ds_write_b128 v202, v[104:107] offset:4096
    v_mfma_f32_16x16x32_bf16 v[84:87], a[200:203], v[236:239], v[84:87]
    ds_write_b128 v202, v[108:111] offset:5120
    v_mfma_f32_16x16x32_bf16 v[80:83], a[220:223], v[240:243], v[80:83]
    v_mfma_f32_16x16x32_bf16 v[84:87], a[220:223], v[244:247], v[84:87]
    v_mfma_f32_16x16x32_bf16 v[80:83], a[240:243], v[248:251], v[80:83]
    v_mfma_f32_16x16x32_bf16 v[84:87], a[240:243], v[252:255], v[84:87]
    s_waitcnt lgkmcnt(0)
    s_barrier
    s_nop 0
    ds_read_b128 v[88:91], v204 offset:0
    ds_read_b128 v[92:95], v204 offset:1024
    ds_read_b128 v[96:99], v204 offset:2048
    ds_read_b128 v[100:103], v204 offset:3072
    ds_read_b128 v[104:107], v204 offset:4096
    ds_read_b128 v[108:111], v204 offset:5120
    ds_read_b64 v[112:113], v205 offset:24576
    ds_read_b64 v[114:115], v205 offset:26624
    ds_read_b64 v[116:117], v205 offset:28672
    ds_read_b64 v[118:119], v205 offset:30720
    s_lshl_b32 s96, s75, 14
    s_add_u32 s96, s96, 14680064
    s_lshl_b32 s97, s24, 12
    s_add_u32 s97, s97, 3506176
    buffer_load_dwordx4 v[176:179], v62, s[16:19], s96 offen offset:0 sc1
    buffer_load_dwordx4 v[180:183], v62, s[16:19], s96 offen offset:1024 sc1
    buffer_load_dwordx4 v[184:187], v62, s[16:19], s97 offen offset:0 sc1
    buffer_load_dwordx4 v[188:191], v62, s[16:19], s97 offen offset:1024 sc1
    buffer_load_dwordx4 v[192:195], v62, s[16:19], s97 offen offset:2048 sc1
    buffer_load_dwordx4 v[196:199], v62, s[16:19], s97 offen offset:3072 sc1
    s_waitcnt lgkmcnt(9)
    v_pk_add_f32 v[80:81], v[80:81], v[88:89]
    v_pk_add_f32 v[82:83], v[82:83], v[90:91]
    s_waitcnt lgkmcnt(8)
    v_pk_add_f32 v[84:85], v[84:85], v[92:93]
    v_pk_add_f32 v[86:87], v[86:87], v[94:95]
    s_waitcnt lgkmcnt(7)
    v_pk_add_f32 v[80:81], v[80:81], v[96:97]
    v_pk_add_f32 v[82:83], v[82:83], v[98:99]
    s_waitcnt lgkmcnt(6)
    v_pk_add_f32 v[84:85], v[84:85], v[100:101]
    v_pk_add_f32 v[86:87], v[86:87], v[102:103]
    s_waitcnt lgkmcnt(5)
    v_pk_add_f32 v[80:81], v[80:81], v[104:105]
    v_pk_add_f32 v[82:83], v[82:83], v[106:107]
    s_waitcnt lgkmcnt(4)
    v_pk_add_f32 v[84:85], v[84:85], v[108:109]
    v_pk_add_f32 v[86:87], v[86:87], v[110:111]
    v_cvt_pk_bf16_f32 v132, v80, v81
    v_cvt_pk_bf16_f32 v133, v82, v83
    v_cvt_pk_bf16_f32 v134, v84, v85
    v_cvt_pk_bf16_f32 v135, v86, v87
    s_waitcnt lgkmcnt(3)
    v_pk_add_f32 v[128:129], v[128:129], v[112:113]
    s_waitcnt lgkmcnt(2)
    v_pk_add_f32 v[128:129], v[128:129], v[114:115]
    s_waitcnt lgkmcnt(1)
    v_pk_add_f32 v[128:129], v[128:129], v[116:117]
    s_waitcnt lgkmcnt(0)
    v_pk_add_f32 v[128:129], v[128:129], v[118:119]
    v_cvt_pk_bf16_f32 v130, v128, v129
    buffer_store_dwordx4 v[132:135], v59, s[16:19], s25 offen sc1
    buffer_store_dword v130, v61, s[16:19], s26 offen sc1
    v_dot2c_f32_bf16 v136, v132, v215
    v_dot2c_f32_bf16 v137, v132, v132
    v_dot2c_f32_bf16 v136, v133, v215
    v_dot2c_f32_bf16 v137, v133, v133
    v_dot2c_f32_bf16 v138, v134, v215
    v_dot2c_f32_bf16 v139, v134, v134
    v_dot2c_f32_bf16 v138, v135, v215
    v_dot2c_f32_bf16 v139, v135, v135
    v_dot2c_f32_bf16 v140, v130, v215
    v_dot2c_f32_bf16 v141, v130, v130
    v_permlane32_swap_b32 v136, v138
    v_permlane32_swap_b32 v137, v139
    v_pk_add_f32 v[136:137], v[136:137], v[138:139]
    v_pk_add_f32 v[136:137], v[136:137], v[140:141]
    s_nop 1
    v_permlane16_swap_b32 v136, v137
    v_add_f32 v136, v136, v137
    ds_write_b32 v206, v136 offset:32768
    s_waitcnt lgkmcnt(0)
    s_barrier
    ds_read2st64_b32 v[136:137], v207 offset0:0 offset1:1
    ds_read2st64_b32 v[138:139], v207 offset0:2 offset1:3
    s_waitcnt lgkmcnt(0)
    v_pk_add_f32 v[136:137], v[136:137], v[138:139]
    v_add_f32 v136, v136, v137
    v_cndmask_b32 v136, v136, 1.0, s[28:29]
    s_mov_b64 exec, s[80:81]
    buffer_atomic_add_f32 v136, v214, s[16:19], s27 offen sc1
    s_mov_b64 exec, -1
    s_cmp_ge_u32 s2, 160
    s_cbranch_scc1 nc_81
    s_waitcnt vmcnt(3)
ce_83:
    v_max3_u32 v208, v176, v177, v178
    v_max3_u32 v208, v208, v179, v180
    v_max3_u32 v208, v208, v181, v182
    v_max_u32 v208, v208, v183
    v_cmp_eq_u32 s[82:83], -1, v208
    v_min3_f32 v209, v184, v187, v188
    v_min3_f32 v209, v209, v191, v192
    v_min3_f32 v209, v209, v195, v196
    v_min_f32 v209, v209, v199
    v_cmp_neq_f32 vcc, 0x41000000, v209
    s_nop 0
    s_or_b64 vcc, vcc, s[82:83]
    s_cbranch_vccnz rd_84
rc_85:
    v_mul_f32 v208, 0x3acccccd, v185
    v_mul_f32 v209, 0x3acccccd, v189
    v_mul_f32 v186, 0x3acccccd, v186
    v_mul_f32 v190, 0x3acccccd, v190
    v_fma_f32 v186, -v208, v208, v186
    v_fma_f32 v190, -v209, v209, v190
    v_max_f32 v186, 0, v186
    v_max_f32 v190, 0, v190
    v_add_f32 v186, 0x3727c5ac, v186
    v_add_f32 v190, 0x3727c5ac, v190
    v_rsq_f32 v185, v186
    v_rsq_f32 v189, v190
    v_mul_f32 v186, -v208, v185
    v_mul_f32 v190, -v209, v189
    v_lshlrev_b32 v80, 16, v176
    v_and_b32 v82, 0xffff0000, v176
    v_lshlrev_b32 v84, 16, v177
    v_and_b32 v86, 0xffff0000, v177
    v_lshlrev_b32 v81, 16, v178
    v_and_b32 v83, 0xffff0000, v178
    v_lshlrev_b32 v85, 16, v179
    v_and_b32 v87, 0xffff0000, v179
    v_fma_f32 v208, v80, v185, v186
    v_fma_f32 v209, v81, v189, v190
    v_cvt_pk_bf16_f32 v176, v208, v209
    v_fma_f32 v208, v82, v185, v186
    v_fma_f32 v209, v83, v189, v190
    v_cvt_pk_bf16_f32 v177, v208, v209
    v_fma_f32 v208, v84, v185, v186
    v_fma_f32 v209, v85, v189, v190
    v_cvt_pk_bf16_f32 v178, v208, v209
    v_fma_f32 v208, v86, v185, v186
    v_fma_f32 v209, v87, v189, v190
    v_cvt_pk_bf16_f32 v179, v208, v209
    ds_write_b32 v63, v176 offset:0
    ds_write_b32 v63, v177 offset:4864
    ds_write_b32 v63, v178 offset:9728
    ds_write_b32 v63, v179 offset:14592
    v_mul_f32 v208, 0x3acccccd, v193
    v_mul_f32 v209, 0x3acccccd, v197
    v_mul_f32 v194, 0x3acccccd, v194
    v_mul_f32 v198, 0x3acccccd, v198
    v_fma_f32 v194, -v208, v208, v194
    v_fma_f32 v198, -v209, v209, v198
    v_max_f32 v194, 0, v194
    v_max_f32 v198, 0, v198
    v_add_f32 v194, 0x3727c5ac, v194
    v_add_f32 v198, 0x3727c5ac, v198
    v_rsq_f32 v193, v194
    v_rsq_f32 v197, v198
    v_mul_f32 v194, -v208, v193
    v_mul_f32 v198, -v209, v197
    v_lshlrev_b32 v88, 16, v180
    v_and_b32 v90, 0xffff0000, v180
    v_lshlrev_b32 v92, 16, v181
    v_and_b32 v94, 0xffff0000, v181
    v_lshlrev_b32 v89, 16, v182
    v_and_b32 v91, 0xffff0000, v182
    v_lshlrev_b32 v93, 16, v183
    v_and_b32 v95, 0xffff0000, v183
    v_fma_f32 v208, v88, v193, v194
    v_fma_f32 v209, v89, v197, v198
    v_cvt_pk_bf16_f32 v180, v208, v209
    v_fma_f32 v208, v90, v193, v194
    v_fma_f32 v209, v91, v197, v198
    v_cvt_pk_bf16_f32 v181, v208, v209
    v_fma_f32 v208, v92, v193, v194
    v_fma_f32 v209, v93, v197, v198
    v_cvt_pk_bf16_f32 v182, v208, v209
    v_fma_f32 v208, v94, v193, v194
    v_fma_f32 v209, v95, v197, v198
    v_cvt_pk_bf16_f32 v183, v208, v209
    ds_write_b32 v63, v180 offset:256
    ds_write_b32 v63, v181 offset:5120
    ds_write_b32 v63, v182 offset:9984
    ds_write_b32 v63, v183 offset:14848
    s_waitcnt lgkmcnt(0)
    s_barrier
    ds_read_b128 v[212:215], v64 offset:96
    ds_read_b128 v[216:219], v64 offset:64
    ds_read_b128 v[220:223], v64 offset:32
    ds_read_b128 v[224:227], v64 offset:0
    s_waitcnt lgkmcnt(3)
    v_mfma_f32_32x32x16_bf16 v[96:111], v[212:215], v[144:147], 0
    ds_read_b128 v[228:231], v64 offset:224
    ds_read_b64_tr_b16 v[176:177], v65 offset:1056
    ds_read_b64_tr_b16 v[178:179], v65 offset:1024
    ds_read_b64_tr_b16 v[180:181], v65 offset:1184
    ds_read_b64_tr_b16 v[182:183], v65 offset:1152
    s_waitcnt lgkmcnt(7)
    v_mfma_f32_32x32x16_bf16 v[96:111], v[216:219], v[148:151], v[96:111]
    ds_read_b128 v[232:235], v64 offset:192
    ds_read_b64_tr_b16 v[184:185], v65 offset:1312
    ds_read_b64_tr_b16 v[186:187], v65 offset:1280
    ds_read_b64_tr_b16 v[188:189], v65 offset:1440
    ds_read_b64_tr_b16 v[190:191], v65 offset:1408
    s_waitcnt lgkmcnt(11)
    v_mfma_f32_32x32x16_bf16 v[96:111], v[220:223], v[152:155], v[96:111]
    ds_read_b128 v[236:239], v64 offset:160
    ds_read_b64_tr_b16 v[192:193], v65 offset:1568
    ds_read_b64_tr_b16 v[194:195], v65 offset:1536
    ds_read_b64_tr_b16 v[196:197], v65 offset:1696
    ds_read_b64_tr_b16 v[198:199], v65 offset:1664
    s_waitcnt lgkmcnt(15)
    v_mfma_f32_32x32x16_bf16 v[96:111], v[224:227], v[156:159], v[96:111]
    ds_read_b128 v[240:243], v64 offset:128
    ds_read_b64_tr_b16 v[200:201], v65 offset:1824
    ds_read_b64_tr_b16 v[202:203], v65 offset:1792
    ds_read_b64_tr_b16 v[204:205], v65 offset:1952
    ds_read_b64_tr_b16 v[206:207], v65 offset:1920
    s_waitcnt lgkmcnt(15)
    v_mfma_f32_32x32x16_bf16 v[112:127], v[228:231], v[144:147], 0
    s_nop 4
    s_waitcnt lgkmcnt(14)
    v_mfma_f32_32x32x16_bf16 v[112:127], v[232:235], v[148:151], v[112:127]
    v_cndmask_b32 v208, v99, v72, s[76:77]
    v_cndmask_b32 v209, v103, v99, s[76:77]
    v_cndmask_b32 v210, v107, v103, s[76:77]
    v_cndmask_b32 v211, v111, v107, s[76:77]
    v_mov_b32_e64 v72, v111
    s_waitcnt lgkmcnt(9)
    v_mfma_f32_32x32x16_bf16 v[112:127], v[236:239], v[152:155], v[112:127]
    v_add_f32_dpp v98, v208, v98 wave_ror:1 row_mask:0xf bank_mask:0xf
    v_add_f32_dpp v102, v209, v102 wave_ror:1 row_mask:0xf bank_mask:0xf
    v_add_f32_dpp v106, v210, v106 wave_ror:1 row_mask:0xf bank_mask:0xf
    v_add_f32_dpp v110, v211, v110 wave_ror:1 row_mask:0xf bank_mask:0xf
    v_cndmask_b32 v208, v98, v71, s[76:77]
    s_waitcnt lgkmcnt(4)
    v_mfma_f32_32x32x16_bf16 v[112:127], v[240:243], v[156:159], v[112:127]
    v_cndmask_b32 v209, v102, v98, s[76:77]
    v_cndmask_b32 v210, v106, v102, s[76:77]
    v_cndmask_b32 v211, v110, v106, s[76:77]
    v_mov_b32 v71, v110
    v_add_f32_dpp v97, v208, v97 wave_ror:1 row_mask:0xf bank_mask:0xf
    v_add_f32_dpp v101, v209, v101 wave_ror:1 row_mask:0xf bank_mask:0xf
    v_mfma_f32_32x32x16_bf16 v[112:127], v[212:215], v[160:163], v[112:127]
    ds_read_b128 v[244:247], v64 offset:352
    v_add_f32_dpp v105, v210, v105 wave_ror:1 row_mask:0xf bank_mask:0xf
    v_add_f32_dpp v109, v211, v109 wave_ror:1 row_mask:0xf bank_mask:0xf
    v_cndmask_b32 v208, v97, v70, s[76:77]
    v_cndmask_b32 v209, v101, v97, s[76:77]
    v_cndmask_b32 v210, v105, v101, s[76:77]
    v_mfma_f32_32x32x16_bf16 v[112:127], v[216:219], v[164:167], v[112:127]
    ds_read_b128 v[216:219], v64 offset:320
    v_cndmask_b32 v211, v109, v105, s[76:77]
    v_mov_b32_e64 v70, v109
    v_add_f32_dpp v96, v208, v96 wave_ror:1 row_mask:0xf bank_mask:0xf
    v_add_f32_dpp v100, v209, v100 wave_ror:1 row_mask:0xf bank_mask:0xf
    v_add_f32_dpp v104, v210, v104 wave_ror:1 row_mask:0xf bank_mask:0xf
    v_mfma_f32_32x32x16_bf16 v[112:127], v[220:223], v[168:171], v[112:127]
    ds_read_b128 v[220:223], v64 offset:288
    v_add_f32_dpp v108, v211, v108 wave_ror:1 row_mask:0xf bank_mask:0xf
    ds_write_b32 v66, v96 offset:0
    v_mfma_f32_32x32x16_bf16 v[112:127], v[224:227], v[172:175], v[112:127]
    ds_read_b128 v[224:227], v64 offset:256
    ds_write_b32 v66, v100 offset:64
    ds_write_b32 v66, v104 offset:128
    s_waitcnt lgkmcnt(6)
    v_mfma_f32_32x32x16_bf16 v[128:143], v[244:247], v[144:147], 0
    ds_write_b32 v66, v108 offset:192
    s_nop 2
    s_waitcnt lgkmcnt(6)
    v_mfma_f32_32x32x16_bf16 v[128:143], v[216:219], v[148:151], v[128:143]
    s_nop 2
    v_cndmask_b32 v208, v115, v72, s[76:77]
    v_cndmask_b32 v209, v119, v115, s[76:77]
    s_waitcnt lgkmcnt(5)
    v_mfma_f32_32x32x16_bf16 v[128:143], v[220:223], v[152:155], v[128:143]
    v_cndmask_b32 v210, v123, v119, s[76:77]
    v_cndmask_b32 v211, v127, v123, s[76:77]
    v_mov_b32 v72, v127
    v_add_f32_dpp v114, v208, v114 wave_ror:1 row_mask:0xf bank_mask:0xf
    v_add_f32_dpp v118, v209, v118 wave_ror:1 row_mask:0xf bank_mask:0xf
    s_waitcnt lgkmcnt(3)
    v_mfma_f32_32x32x16_bf16 v[128:143], v[224:227], v[156:159], v[128:143]
    v_add_f32_dpp v122, v210, v122 wave_ror:1 row_mask:0xf bank_mask:0xf
    v_add_f32_dpp v126, v211, v126 wave_ror:1 row_mask:0xf bank_mask:0xf
    v_cndmask_b32 v208, v114, v71, s[76:77]
    v_cndmask_b32 v209, v118, v114, s[76:77]
    v_cndmask_b32 v210, v122, v118, s[76:77]
    v_cndmask_b32 v211, v126, v122, s[76:77]
    v_mfma_f32_32x32x16_bf16 v[128:143], v[228:231], v[160:163], v[128:143]
    v_mov_b32 v71, v126
    v_add_f32_dpp v113, v208, v113 wave_ror:1 row_mask:0xf bank_mask:0xf
    v_add_f32_dpp v117, v209, v117 wave_ror:1 row_mask:0xf bank_mask:0xf
    v_add_f32_dpp v121, v210, v121 wave_ror:1 row_mask:0xf bank_mask:0xf
    v_add_f32_dpp v125, v211, v125 wave_ror:1 row_mask:0xf bank_mask:0xf
    v_cndmask_b32 v208, v113, v70, s[76:77]
    v_mfma_f32_32x32x16_bf16 v[128:143], v[232:235], v[164:167], v[128:143]
    ds_read_b128 v[232:235], v64 offset:64
    v_cndmask_b32 v209, v117, v113, s[76:77]
    v_cndmask_b32 v210, v121, v117, s[76:77]
    v_cndmask_b32 v211, v125, v121, s[76:77]
    v_mov_b32_e64 v70, v125
    v_add_f32_dpp v112, v208, v112 wave_ror:1 row_mask:0xf bank_mask:0xf
    v_mfma_f32_32x32x16_bf16 v[128:143], v[236:239], v[168:171], v[128:143]
    ds_read_b128 v[236:239], v64 offset:32
    v_add_f32_dpp v116, v209, v116 wave_ror:1 row_mask:0xf bank_mask:0xf
    v_add_f32_dpp v120, v210, v120 wave_ror:1 row_mask:0xf bank_mask:0xf
    v_add_f32_dpp v124, v211, v124 wave_ror:1 row_mask:0xf bank_mask:0xf
    v_mfma_f32_32x32x16_bf16 v[128:143], v[240:243], v[172:175], v[128:143]
    ds_read_b128 v[240:243], v64 offset:0
    ds_write_b32 v66, v112 offset:256
    ds_write_b32 v66, v116 offset:320
    v_mfma_f32_32x32x16_bf16 v[128:143], v[212:215], v[176:179], v[128:143]
    ds_read_b128 v[212:215], v64 offset:480
    ds_write_b32 v66, v120 offset:384
    ds_write_b32 v66, v124 offset:448
    s_waitcnt lgkmcnt(7)
    v_mfma_f32_32x32x16_bf16 v[128:143], v[232:235], v[180:183], v[128:143]
    ds_read_b128 v[232:235], v64 offset:448
    s_waitcnt lgkmcnt(7)
    v_mfma_f32_32x32x16_bf16 v[128:143], v[236:239], v[184:187], v[128:143]
    ds_read_b128 v[236:239], v64 offset:416
    s_waitcnt lgkmcnt(7)
    v_mfma_f32_32x32x16_bf16 v[128:143], v[240:243], v[188:191], v[128:143]
    ds_read_b128 v[240:243], v64 offset:384
    s_nop 3
    s_waitcnt lgkmcnt(5)
    v_mfma_f32_32x32x16_bf16 v[112:127], v[212:215], v[144:147], 0
    s_nop 4
    s_waitcnt lgkmcnt(2)
    v_mfma_f32_32x32x16_bf16 v[112:127], v[232:235], v[148:151], v[112:127]
    v_cndmask_b32 v208, v131, v72, s[76:77]
    v_cndmask_b32 v209, v135, v131, s[76:77]
    v_cndmask_b32 v210, v139, v135, s[76:77]
    v_cndmask_b32 v211, v143, v139, s[76:77]
    v_mov_b32_e64 v72, v143
    s_waitcnt lgkmcnt(1)
    v_mfma_f32_32x32x16_bf16 v[112:127], v[236:239], v[152:155], v[112:127]
    v_add_f32_dpp v130, v208, v130 wave_ror:1 row_mask:0xf bank_mask:0xf
    v_add_f32_dpp v134, v209, v134 wave_ror:1 row_mask:0xf bank_mask:0xf
    v_add_f32_dpp v138, v210, v138 wave_ror:1 row_mask:0xf bank_mask:0xf
    v_add_f32_dpp v142, v211, v142 wave_ror:1 row_mask:0xf bank_mask:0xf
    v_cndmask_b32 v208, v130, v71, s[76:77]
    s_waitcnt lgkmcnt(0)
    v_mfma_f32_32x32x16_bf16 v[112:127], v[240:243], v[156:159], v[112:127]
    v_cndmask_b32 v209, v134, v130, s[76:77]
    v_cndmask_b32 v210, v138, v134, s[76:77]
    v_cndmask_b32 v211, v142, v138, s[76:77]
    v_mov_b32 v71, v142
    v_add_f32_dpp v129, v208, v129 wave_ror:1 row_mask:0xf bank_mask:0xf
    v_add_f32_dpp v133, v209, v133 wave_ror:1 row_mask:0xf bank_mask:0xf
    v_mfma_f32_32x32x16_bf16 v[112:127], v[244:247], v[160:163], v[112:127]
    v_add_f32_dpp v137, v210, v137 wave_ror:1 row_mask:0xf bank_mask:0xf
    v_add_f32_dpp v141, v211, v141 wave_ror:1 row_mask:0xf bank_mask:0xf
    v_cndmask_b32 v208, v129, v70, s[76:77]
    v_cndmask_b32 v209, v133, v129, s[76:77]
    v_cndmask_b32 v210, v137, v133, s[76:77]
    v_cndmask_b32 v211, v141, v137, s[76:77]
    v_mfma_f32_32x32x16_bf16 v[112:127], v[216:219], v[164:167], v[112:127]
    ds_read_b128 v[240:243], v64 offset:192
    v_mov_b32_e64 v70, v141
    v_add_f32_dpp v128, v208, v128 wave_ror:1 row_mask:0xf bank_mask:0xf
    v_add_f32_dpp v132, v209, v132 wave_ror:1 row_mask:0xf bank_mask:0xf
    v_add_f32_dpp v136, v210, v136 wave_ror:1 row_mask:0xf bank_mask:0xf
    v_add_f32_dpp v140, v211, v140 wave_ror:1 row_mask:0xf bank_mask:0xf
    v_mfma_f32_32x32x16_bf16 v[112:127], v[220:223], v[168:171], v[112:127]
    ds_read_b128 v[220:223], v64 offset:160
    ds_write_b32 v66, v128 offset:512
    ds_write_b32 v66, v132 offset:576
    v_mfma_f32_32x32x16_bf16 v[112:127], v[224:227], v[172:175], v[112:127]
    ds_read_b128 v[224:227], v64 offset:128
    ds_write_b32 v66, v136 offset:640
    ds_write_b32 v66, v140 offset:704
    v_mfma_f32_32x32x16_bf16 v[112:127], v[228:231], v[176:179], v[112:127]
    ds_read_b128 v[236:239], v64 offset:96
    s_waitcnt lgkmcnt(7)
    v_mfma_f32_32x32x16_bf16 v[112:127], v[240:243], v[180:183], v[112:127]
    ds_read_b128 v[240:243], v64 offset:64
    s_waitcnt lgkmcnt(7)
    v_mfma_f32_32x32x16_bf16 v[112:127], v[220:223], v[184:187], v[112:127]
    ds_read_b128 v[220:223], v64 offset:32
    s_waitcnt lgkmcnt(5)
    v_mfma_f32_32x32x16_bf16 v[112:127], v[224:227], v[188:191], v[112:127]
    ds_read_b128 v[224:227], v64 offset:0
    s_waitcnt lgkmcnt(3)
    v_mfma_f32_32x32x16_bf16 v[112:127], v[236:239], v[192:195], v[112:127]
    ds_read_b64_tr_b16 v[216:217], v65 offset:544
    ds_read_b64_tr_b16 v[218:219], v65 offset:512
    s_waitcnt lgkmcnt(4)
    v_mfma_f32_32x32x16_bf16 v[112:127], v[240:243], v[196:199], v[112:127]
    ds_read_b64_tr_b16 v[240:241], v65 offset:1056
    ds_read_b64_tr_b16 v[242:243], v65 offset:1024
    s_waitcnt lgkmcnt(5)
    v_mfma_f32_32x32x16_bf16 v[112:127], v[220:223], v[200:203], v[112:127]
    s_waitcnt lgkmcnt(4)
    v_mfma_f32_32x32x16_bf16 v[112:127], v[224:227], v[204:207], v[112:127]
    ds_read_b64_tr_b16 v[224:225], v65 offset:1568
    ds_read_b64_tr_b16 v[226:227], v65 offset:1536
    s_lshl_b32 s96, s75, 14
    s_add_u32 s96, s96, 14680064
    s_lshl_b32 s97, s24, 12
    s_add_u32 s97, s97, 3510272
    buffer_load_dwordx4 v[248:251], v62, s[16:19], s96 offen offset:2048 sc1
    s_waitcnt lgkmcnt(4)
    v_mfma_f32_32x32x16_bf16 v[144:159], v[212:215], v[216:219], 0
    s_nop 3
    v_cndmask_b32 v208, v115, v72, s[76:77]
    s_waitcnt lgkmcnt(2)
    v_mfma_f32_32x32x16_bf16 v[144:159], v[244:247], v[240:243], v[144:159]
    buffer_load_dwordx4 v[252:255], v62, s[16:19], s96 offen offset:3072 sc1
    v_cndmask_b32 v209, v119, v115, s[76:77]
    v_cndmask_b32 v210, v123, v119, s[76:77]
    v_cndmask_b32 v211, v127, v123, s[76:77]
    v_mov_b32_e64 v72, v127
    v_add_f32_dpp v114, v208, v114 wave_ror:1 row_mask:0xf bank_mask:0xf
    v_mfma_f32_32x32x16_bf16 v[160:175], v[212:215], v[240:243], 0
    ds_read_b64_tr_b16 v[216:217], v65 offset:2080
    ds_read_b64_tr_b16 v[218:219], v65 offset:2048
    v_add_f32_dpp v118, v209, v118 wave_ror:1 row_mask:0xf bank_mask:0xf
    v_add_f32_dpp v122, v210, v122 wave_ror:1 row_mask:0xf bank_mask:0xf
    v_add_f32_dpp v126, v211, v126 wave_ror:1 row_mask:0xf bank_mask:0xf
    s_waitcnt lgkmcnt(2)
    v_mfma_f32_32x32x16_bf16 v[144:159], v[228:231], v[224:227], v[144:159]
    buffer_load_dwordx4 v[96:99], v62, s[16:19], s97 offen offset:0 sc1
    v_cndmask_b32 v208, v114, v71, s[76:77]
    v_cndmask_b32 v209, v118, v114, s[76:77]
    v_cndmask_b32 v210, v122, v118, s[76:77]
    v_cndmask_b32 v211, v126, v122, s[76:77]
    v_mov_b32 v71, v126
    v_mfma_f32_32x32x16_bf16 v[160:175], v[244:247], v[224:227], v[160:175]
    v_add_f32_dpp v113, v208, v113 wave_ror:1 row_mask:0xf bank_mask:0xf
    v_add_f32_dpp v117, v209, v117 wave_ror:1 row_mask:0xf bank_mask:0xf
    v_add_f32_dpp v121, v210, v121 wave_ror:1 row_mask:0xf bank_mask:0xf
    v_add_f32_dpp v125, v211, v125 wave_ror:1 row_mask:0xf bank_mask:0xf
    v_cndmask_b32 v208, v113, v70, s[76:77]
    v_cndmask_b32 v209, v117, v113, s[76:77]
    v_mfma_f32_32x32x16_bf16 v[176:191], v[212:215], v[224:227], 0
    buffer_load_dwordx4 v[100:103], v62, s[16:19], s97 offen offset:1024 sc1
    v_cndmask_b32 v210, v121, v117, s[76:77]
    v_cndmask_b32 v211, v125, v121, s[76:77]
    v_mov_b32 v70, v125
    v_add_f32_dpp v112, v208, v112 wave_ror:1 row_mask:0xf bank_mask:0xf
    s_waitcnt lgkmcnt(0)
    v_mfma_f32_32x32x16_bf16 v[144:159], v[236:239], v[216:219], v[144:159]
    ds_read_b64_tr_b16 v[240:241], v65 offset:2592
    ds_read_b64_tr_b16 v[242:243], v65 offset:2560
    v_add_f32_dpp v116, v209, v116 wave_ror:1 row_mask:0xf bank_mask:0xf
    v_add_f32_dpp v120, v210, v120 wave_ror:1 row_mask:0xf bank_mask:0xf
    v_add_f32_dpp v124, v211, v124 wave_ror:1 row_mask:0xf bank_mask:0xf
    v_mfma_f32_32x32x16_bf16 v[160:175], v[228:231], v[216:219], v[160:175]
    buffer_load_dwordx4 v[104:107], v62, s[16:19], s97 offen offset:2048 sc1
    ds_write_b32 v66, v112 offset:768
    ds_write_b32 v66, v116 offset:832
    v_mfma_f32_32x32x16_bf16 v[176:191], v[244:247], v[216:219], v[176:191]
    ds_write_b32 v66, v120 offset:896
    ds_write_b32 v66, v124 offset:960
    v_mfma_f32_32x32x16_bf16 v[192:207], v[212:215], v[216:219], 0
    ds_read_b64_tr_b16 v[212:213], v65 offset:3104
    ds_read_b64_tr_b16 v[214:215], v65 offset:3072
    buffer_load_dwordx4 v[108:111], v62, s[16:19], s97 offen offset:3072 sc1
    s_waitcnt lgkmcnt(6)
    v_mfma_f32_32x32x16_bf16 v[160:175], v[236:239], v[240:243], v[160:175]
    v_mfma_f32_32x32x16_bf16 v[176:191], v[228:231], v[240:243], v[176:191]
    ds_read_b64_tr_b16 v[224:225], v65 offset:3616
    ds_read_b64_tr_b16 v[226:227], v65 offset:3584
    s_waitcnt lgkmcnt(4)
    s_barrier
    v_mfma_f32_32x32x16_bf16 v[192:207], v[244:247], v[240:243], v[192:207]
    ds_read_b64_tr_b16 v[244:245], v65 offset:672
    ds_read_b64_tr_b16 v[246:247], v65 offset:640
    ds_read_b64 v[112:113], v67 offset:0
    ds_read_b64 v[114:115], v67 offset:4224
    ds_read_b64 v[116:117], v67 offset:8448
    s_waitcnt lgkmcnt(7)
    v_mfma_f32_32x32x16_bf16 v[176:191], v[236:239], v[212:215], v[176:191]
    ds_read_b128 v[216:219], v64 offset:320
    ds_read_b64_tr_b16 v[240:241], v65 offset:1184
    ds_read_b64_tr_b16 v[242:243], v65 offset:1152
    ds_read_b64 v[118:119], v67 offset:12672
    ds_read_b64 v[120:121], v67 offset:512
    ds_read_b64 v[122:123], v67 offset:4736
    v_mfma_f32_32x32x16_bf16 v[192:207], v[228:231], v[212:215], v[192:207]
    ds_read_b64 v[124:125], v67 offset:8960
    ds_read_b64 v[126:127], v67 offset:13184
    s_waitcnt lgkmcnt(13)
    v_mfma_f32_32x32x16_bf16 v[192:207], v[236:239], v[224:227], v[192:207]
    ds_read_b128 v[228:231], v64 offset:192
    ds_read_b64_tr_b16 v[236:237], v65 offset:1696
    ds_read_b64_tr_b16 v[238:239], v65 offset:1664
    s_waitcnt lgkmcnt(14)
    v_mfma_f32_32x32x16_bf16 v[144:159], v[232:235], v[244:247], v[144:159]
    s_waitcnt lgkmcnt(8)
    v_mfma_f32_32x32x16_bf16 v[144:159], v[216:219], v[240:243], v[144:159]
    v_mfma_f32_32x32x16_bf16 v[160:175], v[232:235], v[240:243], v[160:175]
    ds_read_b128 v[212:215], v64 offset:64
    ds_read_b64_tr_b16 v[224:225], v65 offset:2208
    ds_read_b64_tr_b16 v[226:227], v65 offset:2176
    s_waitcnt lgkmcnt(6)
    v_add_f32 v112, v112, v80
    s_waitcnt lgkmcnt(3)
    v_mfma_f32_32x32x16_bf16 v[144:159], v[228:231], v[236:239], v[144:159]
    v_add_f32 v113, v113, v81
    v_add_f32 v114, v114, v82
    v_add_f32 v115, v115, v83
    v_add_f32 v116, v116, v84
    v_add_f32 v117, v117, v85
    v_add_f32 v118, v118, v86
    v_mfma_f32_32x32x16_bf16 v[160:175], v[216:219], v[236:239], v[160:175]
    v_add_f32_e64 v119, v119, v87
    v_cvt_pk_bf16_f32 v128, v112, v114
    v_cvt_pk_bf16_f32 v129, v116, v118
    v_cvt_pk_bf16_f32 v130, v113, v115
    v_cvt_pk_bf16_f32 v131, v117, v119
    s_mov_b32 s25, 0
    v_mfma_f32_32x32x16_bf16 v[176:191], v[232:235], v[236:239], v[176:191]
    buffer_store_dwordx2 v[128:129], v68, s[20:23], s25 offen
    s_mov_b32 s25, 5120
    buffer_store_dwordx2 v[130:131], v68, s[20:23], s25 offen
    v_add_f32 v120, v120, v88
    v_add_f32 v121, v121, v89
    s_waitcnt lgkmcnt(0)
    v_mfma_f32_32x32x16_bf16 v[144:159], v[212:215], v[224:227], v[144:159]
    ds_read_b64_tr_b16 v[244:245], v65 offset:2720
    ds_read_b64_tr_b16 v[246:247], v65 offset:2688
    v_add_f32 v122, v122, v90
    v_add_f32 v123, v123, v91
    v_add_f32 v124, v124, v92
    v_add_f32 v125, v125, v93
    v_mfma_f32_32x32x16_bf16 v[160:175], v[228:231], v[224:227], v[160:175]
    v_add_f32 v126, v126, v94
    v_add_f32 v127, v127, v95
    v_cvt_pk_bf16_f32 v132, v120, v122
    v_cvt_pk_bf16_f32 v133, v124, v126
    v_cvt_pk_bf16_f32 v134, v121, v123
    v_cvt_pk_bf16_f32 v135, v125, v127
    v_mfma_f32_32x32x16_bf16 v[176:191], v[216:219], v[224:227], v[176:191]
    s_mov_b32 s25, 655360
    buffer_store_dwordx2 v[132:133], v68, s[20:23], s25 offen
    s_mov_b32 s25, 660480
    buffer_store_dwordx2 v[134:135], v68, s[20:23], s25 offen
    ds_read_b64_tr_b16 v[112:113], v65 offset:32
    ds_read_b64_tr_b16 v[114:115], v65 offset:0
    v_mfma_f32_32x32x16_bf16 v[192:207], v[232:235], v[224:227], v[192:207]
    ds_read_b64_tr_b16 v[232:233], v65 offset:3232
    ds_read_b64_tr_b16 v[234:235], v65 offset:3200
    ds_read_b64_tr_b16 v[116:117], v65 offset:160
    ds_read_b64_tr_b16 v[118:119], v65 offset:128
    ds_read_b64_tr_b16 v[120:121], v65 offset:288
    s_waitcnt lgkmcnt(7)
    v_mfma_f32_32x32x16_bf16 v[160:175], v[212:215], v[244:247], v[160:175]
    ds_read_b64_tr_b16 v[122:123], v65 offset:256
    ds_read_b64_tr_b16 v[124:125], v65 offset:416
    ds_read_b64_tr_b16 v[126:127], v65 offset:384
    ds_read_b64_tr_b16 v[128:129], v65 offset:544
    ds_read_b64_tr_b16 v[130:131], v65 offset:512
    ds_read_b64_tr_b16 v[132:133], v65 offset:672
    v_mfma_f32_32x32x16_bf16 v[176:191], v[228:231], v[244:247], v[176:191]
    ds_read_b64_tr_b16 v[240:241], v65 offset:3744
    ds_read_b64_tr_b16 v[242:243], v65 offset:3712
    ds_read_b64_tr_b16 v[134:135], v65 offset:640
    ds_read_b64_tr_b16 v[136:137], v65 offset:800
    ds_read_b64_tr_b16 v[138:139], v65 offset:768
    ds_read_b64_tr_b16 v[140:141], v65 offset:928
    v_mfma_f32_32x32x16_bf16 v[192:207], v[216:219], v[244:247], v[192:207]
    ds_read_b128 v[216:219], v64 offset:416
    ds_read_b64_tr_b16 v[236:237], v65 offset:800
    ds_read_b64_tr_b16 v[238:239], v65 offset:768
    ds_read_b64_tr_b16 v[142:143], v65 offset:896
    s_waitcnt lgkmcnt(15)
    v_mfma_f32_32x32x16_bf16 v[176:191], v[212:215], v[232:235], v[176:191]
    ds_read_b128 v[224:227], v64 offset:288
    ds_read_b64_tr_b16 v[244:245], v65 offset:1312
    ds_read_b64_tr_b16 v[246:247], v65 offset:1280
    s_waitcnt vmcnt(4)
ce_86:
    v_max3_u32 v208, v248, v249, v250
    v_max3_u32 v208, v208, v251, v252
    v_max3_u32 v208, v208, v253, v254
    v_max_u32 v208, v208, v255
    v_cmp_eq_u32 s[82:83], -1, v208
    v_min3_f32 v209, v96, v99, v100
    v_min3_f32 v209, v209, v103, v104
    v_min3_f32 v209, v209, v107, v108
    v_min_f32 v209, v209, v111
    v_cmp_neq_f32 vcc, 0x41000000, v209
    s_nop 0
    s_or_b64 vcc, vcc, s[82:83]
    s_cbranch_vccnz rd_87
rc_88:
    v_mfma_f32_32x32x16_bf16 v[192:207], v[228:231], v[232:235], v[192:207]
    v_mul_f32 v208, 0x3acccccd, v97
    v_mul_f32 v209, 0x3acccccd, v101
    v_mul_f32 v98, 0x3acccccd, v98
    v_mul_f32 v102, 0x3acccccd, v102
    v_fma_f32 v98, -v208, v208, v98
    s_waitcnt lgkmcnt(11)
    v_mfma_f32_32x32x16_bf16 v[192:207], v[212:215], v[240:243], v[192:207]
    ds_read_b128 v[228:231], v64 offset:160
    ds_read_b64_tr_b16 v[212:213], v65 offset:1824
    ds_read_b64_tr_b16 v[214:215], v65 offset:1792
    v_fma_f32 v102, -v209, v209, v102
    v_max_f32 v98, 0, v98
    s_waitcnt lgkmcnt(7)
    v_mfma_f32_32x32x16_bf16 v[144:159], v[216:219], v[236:239], v[144:159]
    v_max_f32 v102, 0, v102
    v_add_f32 v98, 0x3727c5ac, v98
    v_add_f32 v102, 0x3727c5ac, v102
    v_rsq_f32 v97, v98
    s_waitcnt lgkmcnt(3)
    v_mfma_f32_32x32x16_bf16 v[144:159], v[224:227], v[244:247], v[144:159]
    v_rsq_f32_e64 v101, v102
    v_mul_f32 v98, -v208, v97
    v_mul_f32 v102, -v209, v101
    v_lshlrev_b32_e64 v80, 16, v248
    v_and_b32 v82, 0xffff0000, v248
    v_mfma_f32_32x32x16_bf16 v[160:175], v[216:219], v[244:247], v[160:175]
    ds_read_b64_tr_b16 v[232:233], v65 offset:2336
    ds_read_b64_tr_b16 v[234:235], v65 offset:2304
    v_lshlrev_b32 v84, 16, v249
    v_and_b32 v86, 0xffff0000, v249
    v_lshlrev_b32_e64 v81, 16, v250
    s_waitcnt lgkmcnt(2)
    v_mfma_f32_32x32x16_bf16 v[144:159], v[228:231], v[212:215], v[144:159]
    v_and_b32 v83, 0xffff0000, v250
    v_lshlrev_b32_e64 v85, 16, v251
    v_and_b32 v87, 0xffff0000, v251
    v_fma_f32 v208, v80, v97, v98
    v_fma_f32 v209, v81, v101, v102
    v_cvt_pk_bf16_f32 v248, v208, v209
    v_mfma_f32_32x32x16_bf16 v[160:175], v[224:227], v[212:215], v[160:175]
    v_fma_f32 v208, v82, v97, v98
    v_fma_f32 v209, v83, v101, v102
    v_cvt_pk_bf16_f32 v249, v208, v209
    v_fma_f32 v208, v84, v97, v98
    v_fma_f32 v209, v85, v101, v102
    v_cvt_pk_bf16_f32 v250, v208, v209
    v_mfma_f32_32x32x16_bf16 v[176:191], v[216:219], v[212:215], v[176:191]
    v_fma_f32 v208, v86, v97, v98
    v_fma_f32 v209, v87, v101, v102
    v_cvt_pk_bf16_f32 v251, v208, v209
    s_waitcnt lgkmcnt(0)
    v_mfma_f32_32x32x16_bf16 v[144:159], v[220:223], v[232:235], v[144:159]
    ds_read_b64_tr_b16 v[240:241], v65 offset:2848
    ds_read_b64_tr_b16 v[242:243], v65 offset:2816
    ds_write_b32 v63, v248 offset:512
    ds_write_b32 v63, v249 offset:5376
    v_mfma_f32_32x32x16_bf16 v[160:175], v[228:231], v[232:235], v[160:175]
    ds_write_b32 v63, v250 offset:10240
    ds_write_b32 v63, v251 offset:15104
    v_mul_f32 v208, 0x3acccccd, v105
    v_mul_f32 v209, 0x3acccccd, v109
    v_mfma_f32_32x32x16_bf16 v[176:191], v[224:227], v[232:235], v[176:191]
    v_mul_f32 v106, 0x3acccccd, v106
    v_mul_f32 v110, 0x3acccccd, v110
    v_fma_f32 v106, -v208, v208, v106
    v_fma_f32 v110, -v209, v209, v110
    v_max_f32 v106, 0, v106
    v_max_f32_e64 v110, 0, v110
    v_mfma_f32_32x32x16_bf16 v[192:207], v[216:219], v[232:235], v[192:207]
    ds_read_b64_tr_b16 v[216:217], v65 offset:3360
    ds_read_b64_tr_b16 v[218:219], v65 offset:3328
    v_add_f32 v106, 0x3727c5ac, v106
    v_add_f32 v110, 0x3727c5ac, v110
    s_waitcnt lgkmcnt(6)
    v_mfma_f32_32x32x16_bf16 v[160:175], v[220:223], v[240:243], v[160:175]
    v_rsq_f32 v105, v106
    v_rsq_f32_e64 v109, v110
    v_mul_f32 v106, -v208, v105
    v_mul_f32 v110, -v209, v109
    v_mfma_f32_32x32x16_bf16 v[176:191], v[228:231], v[240:243], v[176:191]
    ds_read_b64_tr_b16 v[236:237], v65 offset:3872
    ds_read_b64_tr_b16 v[238:239], v65 offset:3840
    v_lshlrev_b32 v88, 16, v252
    v_and_b32 v90, 0xffff0000, v252
    v_lshlrev_b32 v92, 16, v253
    v_and_b32 v94, 0xffff0000, v253
    v_mfma_f32_32x32x16_bf16 v[192:207], v[224:227], v[240:243], v[192:207]
    ds_read_b128 v[224:227], v64 offset:384
    ds_read_b64_tr_b16 v[244:245], v65 offset:928
    ds_read_b64_tr_b16 v[246:247], v65 offset:896
    v_lshlrev_b32 v89, 16, v254
    v_and_b32 v91, 0xffff0000, v254
    s_waitcnt lgkmcnt(5)
    v_mfma_f32_32x32x16_bf16 v[176:191], v[220:223], v[216:219], v[176:191]
    ds_read_b128 v[212:215], v64 offset:256
    ds_read_b64_tr_b16 v[232:233], v65 offset:1440
    ds_read_b64_tr_b16 v[234:235], v65 offset:1408
    v_lshlrev_b32_e64 v93, 16, v255
    v_and_b32 v95, 0xffff0000, v255
    v_fma_f32 v208, v88, v105, v106
    v_mfma_f32_32x32x16_bf16 v[192:207], v[228:231], v[216:219], v[192:207]
    v_fma_f32 v209, v89, v109, v110
    v_cvt_pk_bf16_f32 v252, v208, v209
    v_fma_f32 v208, v90, v105, v106
    v_fma_f32 v209, v91, v109, v110
    v_cvt_pk_bf16_f32 v253, v208, v209
    s_waitcnt lgkmcnt(6)
    v_mfma_f32_32x32x16_bf16 v[192:207], v[220:223], v[236:239], v[192:207]
    ds_read_b128 v[220:223], v64 offset:128
    ds_read_b64_tr_b16 v[228:229], v65 offset:1952
    ds_read_b64_tr_b16 v[230:231], v65 offset:1920
    v_fma_f32 v208, v92, v105, v106
    v_fma_f32 v209, v93, v109, v110
    s_waitcnt lgkmcnt(6)
    v_mfma_f32_32x32x16_bf16 v[144:159], v[224:227], v[244:247], v[144:159]
    v_cvt_pk_bf16_f32 v254, v208, v209
    v_fma_f32 v208, v94, v105, v106
    v_fma_f32 v209, v95, v109, v110
    v_cvt_pk_bf16_f32 v255, v208, v209
    s_waitcnt lgkmcnt(3)
    v_mfma_f32_32x32x16_bf16 v[144:159], v[212:215], v[232:235], v[144:159]
    ds_write_b32 v63, v252 offset:768
    ds_write_b32 v63, v253 offset:5632
    ds_write_b32 v63, v254 offset:10496
    v_mfma_f32_32x32x16_bf16 v[160:175], v[224:227], v[232:235], v[160:175]
    ds_read_b128 v[240:243], v64 offset:0
    ds_read_b64_tr_b16 v[216:217], v65 offset:2464
    ds_read_b64_tr_b16 v[218:219], v65 offset:2432
    ds_write_b32 v63, v255 offset:15360
    s_waitcnt lgkmcnt(7)
    v_mfma_f32_32x32x16_bf16 v[144:159], v[220:223], v[228:231], v[144:159]
    v_mfma_f32_32x32x16_bf16 v[160:175], v[212:215], v[228:231], v[160:175]
    v_mfma_f32_32x32x16_bf16 v[176:191], v[224:227], v[228:231], v[176:191]
    s_waitcnt lgkmcnt(1)
    v_mfma_f32_32x32x16_bf16 v[144:159], v[240:243], v[216:219], v[144:159]
    ds_read_b64_tr_b16 v[236:237], v65 offset:2976
    ds_read_b64_tr_b16 v[238:239], v65 offset:2944
    v_mfma_f32_32x32x16_bf16 v[160:175], v[220:223], v[216:219], v[160:175]
    v_mfma_f32_32x32x16_bf16 v[176:191], v[212:215], v[216:219], v[176:191]
    v_mfma_f32_32x32x16_bf16 v[192:207], v[224:227], v[216:219], v[192:207]
    ds_read_b64_tr_b16 v[224:225], v65 offset:3488
    ds_read_b64_tr_b16 v[226:227], v65 offset:3456
    s_waitcnt lgkmcnt(2)
    v_mfma_f32_32x32x16_bf16 v[160:175], v[240:243], v[236:239], v[160:175]
    v_mfma_f32_32x32x16_bf16 v[176:191], v[220:223], v[236:239], v[176:191]
    ds_read_b64_tr_b16 v[244:245], v65 offset:4000
    ds_read_b64_tr_b16 v[246:247], v65 offset:3968
    v_mfma_f32_32x32x16_bf16 v[192:207], v[212:215], v[236:239], v[192:207]
    s_waitcnt lgkmcnt(2)
    v_mfma_f32_32x32x16_bf16 v[176:191], v[240:243], v[224:227], v[176:191]
    v_mfma_f32_32x32x16_bf16 v[192:207], v[220:223], v[224:227], v[192:207]
    s_waitcnt lgkmcnt(0)
    v_mfma_f32_32x32x16_bf16 v[192:207], v[240:243], v[244:247], v[192:207]
    s_waitcnt lgkmcnt(0)
    s_barrier
    ds_read_b128 v[212:215], v64 offset:608
    ds_read_b128 v[216:219], v64 offset:576
    ds_read_b128 v[220:223], v64 offset:544
    ds_read_b128 v[224:227], v64 offset:512
    s_waitcnt lgkmcnt(3)
    v_mfma_f32_32x32x16_bf16 v[144:159], v[212:215], v[112:115], v[144:159]
    ds_read_b128 v[228:231], v64 offset:736
    s_waitcnt lgkmcnt(3)
    v_mfma_f32_32x32x16_bf16 v[144:159], v[216:219], v[116:119], v[144:159]
    ds_read_b128 v[232:235], v64 offset:704
    s_waitcnt lgkmcnt(3)
    v_mfma_f32_32x32x16_bf16 v[144:159], v[220:223], v[120:123], v[144:159]
    ds_read_b128 v[236:239], v64 offset:672
    s_waitcnt lgkmcnt(3)
    v_mfma_f32_32x32x16_bf16 v[144:159], v[224:227], v[124:127], v[144:159]
    ds_read_b128 v[240:243], v64 offset:640
    s_nop 3
    s_waitcnt lgkmcnt(3)
    v_mfma_f32_32x32x16_bf16 v[160:175], v[228:231], v[112:115], v[160:175]
    s_nop 4
    s_waitcnt lgkmcnt(2)
    v_mfma_f32_32x32x16_bf16 v[160:175], v[232:235], v[116:119], v[160:175]
    v_cndmask_b32 v208, v147, v72, s[76:77]
    v_cndmask_b32 v209, v151, v147, s[76:77]
    v_cndmask_b32 v210, v155, v151, s[76:77]
    v_cndmask_b32 v211, v159, v155, s[76:77]
    v_mov_b32 v72, v159
    s_waitcnt lgkmcnt(1)
    v_mfma_f32_32x32x16_bf16 v[160:175], v[236:239], v[120:123], v[160:175]
    v_add_f32_dpp v146, v208, v146 wave_ror:1 row_mask:0xf bank_mask:0xf
    v_add_f32_dpp v150, v209, v150 wave_ror:1 row_mask:0xf bank_mask:0xf
    v_add_f32_dpp v154, v210, v154 wave_ror:1 row_mask:0xf bank_mask:0xf
    v_add_f32_dpp v158, v211, v158 wave_ror:1 row_mask:0xf bank_mask:0xf
    v_cndmask_b32 v208, v146, v71, s[76:77]
    s_waitcnt lgkmcnt(0)
    v_mfma_f32_32x32x16_bf16 v[160:175], v[240:243], v[124:127], v[160:175]
    v_cndmask_b32 v209, v150, v146, s[76:77]
    v_cndmask_b32 v210, v154, v150, s[76:77]
    v_cndmask_b32 v211, v158, v154, s[76:77]
    v_mov_b32 v71, v158
    v_add_f32_dpp v145, v208, v145 wave_ror:1 row_mask:0xf bank_mask:0xf
    v_add_f32_dpp v149, v209, v149 wave_ror:1 row_mask:0xf bank_mask:0xf
    v_mfma_f32_32x32x16_bf16 v[160:175], v[212:215], v[128:131], v[160:175]
    ds_read_b128 v[244:247], v64 offset:864
    v_add_f32_dpp v153, v210, v153 wave_ror:1 row_mask:0xf bank_mask:0xf
    v_add_f32_dpp v157, v211, v157 wave_ror:1 row_mask:0xf bank_mask:0xf
    v_cndmask_b32 v208, v145, v70, s[76:77]
    v_cndmask_b32 v209, v149, v145, s[76:77]
    v_cndmask_b32 v210, v153, v149, s[76:77]
    v_mfma_f32_32x32x16_bf16 v[160:175], v[216:219], v[132:135], v[160:175]
    ds_read_b128 v[248:251], v64 offset:832
    v_cndmask_b32 v211, v157, v153, s[76:77]
    v_mov_b32_e64 v70, v157
    v_add_f32_dpp v144, v208, v144 wave_ror:1 row_mask:0xf bank_mask:0xf
    v_add_f32_dpp v148, v209, v148 wave_ror:1 row_mask:0xf bank_mask:0xf
    v_add_f32_dpp v152, v210, v152 wave_ror:1 row_mask:0xf bank_mask:0xf
    v_mfma_f32_32x32x16_bf16 v[160:175], v[220:223], v[136:139], v[160:175]
    ds_read_b128 v[252:255], v64 offset:800
    v_add_f32_dpp v156, v211, v156 wave_ror:1 row_mask:0xf bank_mask:0xf
    ds_write_b32 v66, v144 offset:0
    v_mfma_f32_32x32x16_bf16 v[160:175], v[224:227], v[140:143], v[160:175]
    ds_read_b128 v[224:227], v64 offset:768
    ds_write_b32 v66, v148 offset:64
    ds_write_b32 v66, v152 offset:128
    s_waitcnt lgkmcnt(6)
    v_mfma_f32_32x32x16_bf16 v[176:191], v[244:247], v[112:115], v[176:191]
    ds_write_b32 v66, v156 offset:192
    s_nop 2
    s_waitcnt lgkmcnt(6)
    v_mfma_f32_32x32x16_bf16 v[176:191], v[248:251], v[116:119], v[176:191]
    s_nop 2
    v_cndmask_b32 v208, v163, v72, s[76:77]
    v_cndmask_b32 v209, v167, v163, s[76:77]
    s_waitcnt lgkmcnt(5)
    v_mfma_f32_32x32x16_bf16 v[176:191], v[252:255], v[120:123], v[176:191]
    v_cndmask_b32 v210, v171, v167, s[76:77]
    v_cndmask_b32 v211, v175, v171, s[76:77]
    v_mov_b32 v72, v175
    v_add_f32_dpp v162, v208, v162 wave_ror:1 row_mask:0xf bank_mask:0xf
    v_add_f32_dpp v166, v209, v166 wave_ror:1 row_mask:0xf bank_mask:0xf
    s_waitcnt lgkmcnt(3)
    v_mfma_f32_32x32x16_bf16 v[176:191], v[224:227], v[124:127], v[176:191]
    v_add_f32_dpp v170, v210, v170 wave_ror:1 row_mask:0xf bank_mask:0xf
    v_add_f32_dpp v174, v211, v174 wave_ror:1 row_mask:0xf bank_mask:0xf
    v_cndmask_b32 v208, v162, v71, s[76:77]
    v_cndmask_b32 v209, v166, v162, s[76:77]
    v_cndmask_b32 v210, v170, v166, s[76:77]
    v_cndmask_b32 v211, v174, v170, s[76:77]
    v_mfma_f32_32x32x16_bf16 v[176:191], v[228:231], v[128:131], v[176:191]
    ds_read_b64_tr_b16 v[228:229], v65 offset:1056
    ds_read_b64_tr_b16 v[230:231], v65 offset:1024
    v_mov_b32 v71, v174
    v_add_f32_dpp v161, v208, v161 wave_ror:1 row_mask:0xf bank_mask:0xf
    v_add_f32_dpp v165, v209, v165 wave_ror:1 row_mask:0xf bank_mask:0xf
    v_add_f32_dpp v169, v210, v169 wave_ror:1 row_mask:0xf bank_mask:0xf
    v_mfma_f32_32x32x16_bf16 v[176:191], v[232:235], v[132:135], v[176:191]
    ds_read_b64_tr_b16 v[232:233], v65 offset:1184
    ds_read_b64_tr_b16 v[234:235], v65 offset:1152
    v_add_f32_dpp v173, v211, v173 wave_ror:1 row_mask:0xf bank_mask:0xf
    v_cndmask_b32 v208, v161, v70, s[76:77]
    v_cndmask_b32 v209, v165, v161, s[76:77]
    v_cndmask_b32 v210, v169, v165, s[76:77]
    v_mfma_f32_32x32x16_bf16 v[176:191], v[236:239], v[136:139], v[176:191]
    ds_read_b64_tr_b16 v[236:237], v65 offset:1312
    ds_read_b64_tr_b16 v[238:239], v65 offset:1280
    v_cndmask_b32 v211, v173, v169, s[76:77]
    v_mov_b32_e64 v70, v173
    v_add_f32_dpp v160, v208, v160 wave_ror:1 row_mask:0xf bank_mask:0xf
    v_add_f32_dpp v164, v209, v164 wave_ror:1 row_mask:0xf bank_mask:0xf
    v_mfma_f32_32x32x16_bf16 v[176:191], v[240:243], v[140:143], v[176:191]
    ds_read_b128 v[240:243], v64 offset:512
    ds_read_b64_tr_b16 v[224:225], v65 offset:1440
    ds_read_b64_tr_b16 v[226:227], v65 offset:1408
    v_add_f32_dpp v168, v210, v168 wave_ror:1 row_mask:0xf bank_mask:0xf
    v_add_f32_dpp v172, v211, v172 wave_ror:1 row_mask:0xf bank_mask:0xf
    s_waitcnt lgkmcnt(7)
    v_mfma_f32_32x32x16_bf16 v[176:191], v[212:215], v[228:231], v[176:191]
    ds_read_b128 v[212:215], v64 offset:992
    ds_write_b32 v66, v160 offset:256
    ds_write_b32 v66, v164 offset:320
    s_waitcnt lgkmcnt(8)
    v_mfma_f32_32x32x16_bf16 v[176:191], v[216:219], v[232:235], v[176:191]
    ds_read_b128 v[216:219], v64 offset:960
    ds_write_b32 v66, v168 offset:384
    ds_write_b32 v66, v172 offset:448
    s_waitcnt lgkmcnt(9)
    v_mfma_f32_32x32x16_bf16 v[176:191], v[220:223], v[236:239], v[176:191]
    ds_read_b128 v[220:223], v64 offset:928
    s_waitcnt lgkmcnt(7)
    v_mfma_f32_32x32x16_bf16 v[176:191], v[240:243], v[224:227], v[176:191]
    ds_read_b128 v[240:243], v64 offset:896
    s_waitcnt lgkmcnt(2)
    s_barrier
    v_mfma_f32_32x32x16_bf16 v[192:207], v[212:215], v[112:115], v[192:207]
    ds_read_b64 v[144:145], v67 offset:0
    ds_read_b64 v[146:147], v67 offset:4224
    ds_read_b64 v[148:149], v67 offset:8448
    ds_read_b64 v[150:151], v67 offset:12672
    s_nop 0
    v_mfma_f32_32x32x16_bf16 v[192:207], v[216:219], v[116:119], v[192:207]
    s_nop 2
    v_cndmask_b32 v208, v179, v72, s[76:77]
    v_cndmask_b32 v209, v183, v179, s[76:77]
    s_waitcnt lgkmcnt(5)
    v_mfma_f32_32x32x16_bf16 v[192:207], v[220:223], v[120:123], v[192:207]
    v_cndmask_b32 v210, v187, v183, s[76:77]
    v_cndmask_b32 v211, v191, v187, s[76:77]
    v_mov_b32 v72, v191
    v_add_f32_dpp v178, v208, v178 wave_ror:1 row_mask:0xf bank_mask:0xf
    v_add_f32_dpp v182, v209, v182 wave_ror:1 row_mask:0xf bank_mask:0xf
    s_waitcnt lgkmcnt(4)
    v_mfma_f32_32x32x16_bf16 v[192:207], v[240:243], v[124:127], v[192:207]
    ds_read_b128 v[212:215], v64 offset:768
    v_add_f32_dpp v186, v210, v186 wave_ror:1 row_mask:0xf bank_mask:0xf
    v_add_f32_dpp v190, v211, v190 wave_ror:1 row_mask:0xf bank_mask:0xf
    v_cndmask_b32 v208, v178, v71, s[76:77]
    v_cndmask_b32 v209, v182, v178, s[76:77]
    v_cndmask_b32 v210, v186, v182, s[76:77]
    v_mfma_f32_32x32x16_bf16 v[192:207], v[244:247], v[128:131], v[192:207]
    ds_read_b128 v[244:247], v64 offset:736
    v_cndmask_b32 v211, v190, v186, s[76:77]
    v_mov_b32 v71, v190
    v_add_f32_dpp v177, v208, v177 wave_ror:1 row_mask:0xf bank_mask:0xf
    v_add_f32_dpp v181, v209, v181 wave_ror:1 row_mask:0xf bank_mask:0xf
    v_add_f32_dpp v185, v210, v185 wave_ror:1 row_mask:0xf bank_mask:0xf
    v_mfma_f32_32x32x16_bf16 v[192:207], v[248:251], v[132:135], v[192:207]
    ds_read_b128 v[248:251], v64 offset:704
    v_add_f32_dpp v189, v211, v189 wave_ror:1 row_mask:0xf bank_mask:0xf
    v_cndmask_b32 v208, v177, v70, s[76:77]
    v_cndmask_b32 v209, v181, v177, s[76:77]
    v_cndmask_b32 v210, v185, v181, s[76:77]
    v_cndmask_b32 v211, v189, v185, s[76:77]
    v_mfma_f32_32x32x16_bf16 v[192:207], v[252:255], v[136:139], v[192:207]
    ds_read_b128 v[252:255], v64 offset:672
    v_mov_b32_e64 v70, v189
    v_add_f32_dpp v176, v208, v176 wave_ror:1 row_mask:0xf bank_mask:0xf
    v_add_f32_dpp v180, v209, v180 wave_ror:1 row_mask:0xf bank_mask:0xf
    v_add_f32_dpp v184, v210, v184 wave_ror:1 row_mask:0xf bank_mask:0xf
    s_waitcnt lgkmcnt(3)
    v_mfma_f32_32x32x16_bf16 v[192:207], v[212:215], v[140:143], v[192:207]
    ds_read_b128 v[216:219], v64 offset:640
    v_add_f32_dpp v188, v211, v188 wave_ror:1 row_mask:0xf bank_mask:0xf
    s_waitcnt lgkmcnt(3)
    v_mfma_f32_32x32x16_bf16 v[192:207], v[244:247], v[228:231], v[192:207]
    ds_read_b128 v[228:231], v64 offset:608
    ds_read_b64_tr_b16 v[220:221], v65 offset:1568
    ds_read_b64_tr_b16 v[222:223], v65 offset:1536
    ds_write_b32 v66, v176 offset:512
    s_waitcnt lgkmcnt(6)
    v_mfma_f32_32x32x16_bf16 v[192:207], v[248:251], v[232:235], v[192:207]
    ds_read_b128 v[232:235], v64 offset:576
    ds_read_b64_tr_b16 v[240:241], v65 offset:1696
    ds_read_b64_tr_b16 v[242:243], v65 offset:1664
    ds_write_b32 v66, v180 offset:576
    s_waitcnt lgkmcnt(9)
    v_mfma_f32_32x32x16_bf16 v[192:207], v[252:255], v[236:239], v[192:207]
    ds_read_b128 v[236:239], v64 offset:544
    ds_read_b64_tr_b16 v[212:213], v65 offset:1824
    ds_read_b64_tr_b16 v[214:215], v65 offset:1792
    ds_write_b32 v66, v184 offset:640
    s_waitcnt lgkmcnt(12)
    v_mfma_f32_32x32x16_bf16 v[192:207], v[216:219], v[224:227], v[192:207]
    ds_read_b128 v[224:227], v64 offset:512
    ds_read_b64_tr_b16 v[244:245], v65 offset:1952
    ds_read_b64_tr_b16 v[246:247], v65 offset:1920
    ds_write_b32 v66, v188 offset:704
    s_waitcnt lgkmcnt(13)
    v_mfma_f32_32x32x16_bf16 v[192:207], v[228:231], v[220:223], v[192:207]
    v_add_f32 v144, v144, v80
    v_add_f32 v145, v145, v81
    v_add_f32 v146, v146, v82
    v_add_f32 v147, v147, v83
    s_waitcnt lgkmcnt(9)
    v_mfma_f32_32x32x16_bf16 v[192:207], v[232:235], v[240:243], v[192:207]
    v_add_f32 v148, v148, v84
    v_add_f32 v149, v149, v85
    v_add_f32 v150, v150, v86
    v_add_f32 v151, v151, v87
    v_cvt_pk_bf16_f32 v160, v144, v146
    s_waitcnt lgkmcnt(5)
    v_mfma_f32_32x32x16_bf16 v[192:207], v[236:239], v[212:215], v[192:207]
    v_cvt_pk_bf16_f32 v161, v148, v150
    v_cvt_pk_bf16_f32 v162, v145, v147
    v_cvt_pk_bf16_f32 v163, v149, v151
    s_mov_b32 s25, 1310720
    s_waitcnt lgkmcnt(1)
    v_mfma_f32_32x32x16_bf16 v[192:207], v[224:227], v[244:247], v[192:207]
    buffer_store_dwordx2 v[160:161], v68, s[20:23], s25 offen
    s_mov_b32 s25, 1315840
    buffer_store_dwordx2 v[162:163], v68, s[20:23], s25 offen
    s_nop 8
    v_cndmask_b32 v208, v195, v72, s[76:77]
    v_cndmask_b32 v209, v199, v195, s[76:77]
    v_cndmask_b32 v210, v203, v199, s[76:77]
    v_cndmask_b32 v211, v207, v203, s[76:77]
    v_mov_b32_e64 v72, v207
    v_add_f32_dpp v194, v208, v194 wave_ror:1 row_mask:0xf bank_mask:0xf
    v_add_f32_dpp v198, v209, v198 wave_ror:1 row_mask:0xf bank_mask:0xf
    v_add_f32_dpp v202, v210, v202 wave_ror:1 row_mask:0xf bank_mask:0xf
    v_add_f32_dpp v206, v211, v206 wave_ror:1 row_mask:0xf bank_mask:0xf
    v_cndmask_b32 v208, v194, v71, s[76:77]
    v_cndmask_b32 v209, v198, v194, s[76:77]
    v_cndmask_b32 v210, v202, v198, s[76:77]
    v_cndmask_b32 v211, v206, v202, s[76:77]
    v_mov_b32_e64 v71, v206
    v_add_f32_dpp v193, v208, v193 wave_ror:1 row_mask:0xf bank_mask:0xf
    v_add_f32_dpp v197, v209, v197 wave_ror:1 row_mask:0xf bank_mask:0xf
    v_add_f32_dpp v201, v210, v201 wave_ror:1 row_mask:0xf bank_mask:0xf
    v_add_f32_dpp v205, v211, v205 wave_ror:1 row_mask:0xf bank_mask:0xf
    v_cndmask_b32 v208, v193, v70, s[76:77]
    v_cndmask_b32 v209, v197, v193, s[76:77]
    v_cndmask_b32 v210, v201, v197, s[76:77]
    v_cndmask_b32 v211, v205, v201, s[76:77]
    v_mov_b32_e64 v70, v205
    v_add_f32_dpp v192, v208, v192 wave_ror:1 row_mask:0xf bank_mask:0xf
    v_add_f32_dpp v196, v209, v196 wave_ror:1 row_mask:0xf bank_mask:0xf
    v_add_f32_dpp v200, v210, v200 wave_ror:1 row_mask:0xf bank_mask:0xf
    v_add_f32_dpp v204, v211, v204 wave_ror:1 row_mask:0xf bank_mask:0xf
    ds_write_b32 v66, v192 offset:768
    ds_write_b32 v66, v196 offset:832
    ds_write_b32 v66, v200 offset:896
    ds_write_b32 v66, v204 offset:960
    s_waitcnt lgkmcnt(0)
    s_barrier
    ds_read_b64 v[152:153], v67 offset:512
    ds_read_b64 v[154:155], v67 offset:4736
    ds_read_b64 v[156:157], v67 offset:8960
    ds_read_b64 v[158:159], v67 offset:13184
    s_waitcnt lgkmcnt(0)
    v_add_f32 v152, v152, v88
    v_add_f32 v153, v153, v89
    v_add_f32 v154, v154, v90
    v_add_f32 v155, v155, v91
    v_add_f32 v156, v156, v92
    v_add_f32 v157, v157, v93
    v_add_f32 v158, v158, v94
    v_add_f32_e64 v159, v159, v95
    v_cvt_pk_bf16_f32 v164, v152, v154
    v_cvt_pk_bf16_f32 v165, v156, v158
    v_cvt_pk_bf16_f32 v166, v153, v155
    v_cvt_pk_bf16_f32 v167, v157, v159
    s_mov_b32 s25, 1966080
    buffer_store_dwordx2 v[164:165], v68, s[20:23], s25 offen
    s_mov_b32 s25, 1971200
    buffer_store_dwordx2 v[166:167], v68, s[20:23], s25 offen
    s_branch ec_82
nc_81:
ec_82:
L_end:
    s_endpgm
ps_5:
    s_mov_b32 s84, 1048576
pl_6:
    global_load_dword v7, v5, s[66:67] sc1
    s_waitcnt vmcnt(0)
    s_sub_u32 s84, s84, 1
    s_cbranch_scc1 pc_7
    v_cmp_gt_u32_e64 vcc, 1, v7
    s_nop 0
    s_and_b64 vcc, vcc, s[50:51]
    s_and_b64 vcc, vcc, 1
    s_cbranch_scc1 pl_6
    s_branch pc_7
ps_8:
    s_mov_b32 s84, 1048576
pl_9:
    buffer_load_dword v7, v4, s[16:19], s87 offen offset:0 sc1
    s_waitcnt vmcnt(0)
    s_sub_u32 s84, s84, 1
    s_cbranch_scc1 pc_10
    v_cmp_gt_u32 vcc, 32, v7
    s_nop 0
    s_and_b64 vcc, vcc, s[50:51]
    s_cbranch_scc1 pl_9
    s_branch pc_10
ps_11:
    s_mov_b32 s84, 1048576
pl_12:
    global_load_dword v7, v5, s[66:67] sc1
    s_waitcnt vmcnt(0)
    s_sub_u32 s84, s84, 1
    s_cbranch_scc1 pc_13
    v_cmp_gt_u32_e64 vcc, 1, v7
    s_nop 0
    s_and_b64 vcc, vcc, s[50:51]
    s_and_b64 vcc, vcc, 1
    s_cbranch_scc1 pl_12
    s_branch pc_13
ps_14:
    s_mov_b32 s84, 1048576
pl_15:
    buffer_load_dword v7, v4, s[16:19], s87 offen offset:0 sc1
    s_waitcnt vmcnt(0)
    s_sub_u32 s84, s84, 1
    s_cbranch_scc1 pc_16
    v_cmp_gt_u32 vcc, 32, v7
    s_nop 0
    s_and_b64 vcc, vcc, s[50:51]
    s_cbranch_scc1 pl_15
    s_branch pc_16
ps_17:
    s_mov_b32 s84, 1048576
pl_18:
    buffer_load_dword v7, v4, s[16:19], s89 offen offset:8 sc1
    s_waitcnt vmcnt(0)
    s_sub_u32 s84, s84, 1
    s_cbranch_scc1 pc_19
    v_cmp_gt_u32_e64 vcc, 32, v7
    s_nop 0
    s_and_b64 vcc, vcc, s[50:51]
    s_cbranch_scc1 pl_18
    s_branch pc_19
rd_21:
    s_cmp_eq_u32 s38, 0
    s_cbranch_scc1 rc_22
    s_sub_u32 s38, s38, 1
    s_nop 7
    s_nop 7
    s_sleep 4
    s_mov_b64 exec, vcc
    s_mov_b32 s96, 4194304
    buffer_load_dwordx4 v[216:219], v56, s[16:19], s96 offen offset:0 sc1
    buffer_load_dwordx4 v[220:223], v56, s[16:19], s96 offen offset:256 sc1
    s_mov_b32 s96, 4227072
    buffer_load_dwordx4 v[224:227], v56, s[16:19], s96 offen offset:0 sc1
    buffer_load_dwordx4 v[228:231], v56, s[16:19], s96 offen offset:256 sc1
    s_mov_b32 s96, 4259840
    buffer_load_dwordx4 v[232:235], v56, s[16:19], s96 offen offset:0 sc1
    buffer_load_dwordx4 v[236:239], v56, s[16:19], s96 offen offset:256 sc1
    s_mov_b32 s96, 4292608
    buffer_load_dwordx4 v[240:243], v56, s[16:19], s96 offen offset:0 sc1
    buffer_load_dwordx4 v[244:247], v56, s[16:19], s96 offen offset:256 sc1
    s_mov_b32 s96, 4194304
    buffer_load_dwordx2 v[248:249], v57, s[16:19], s96 offen offset:0 sc1
    buffer_load_dwordx2 v[252:253], v57, s[16:19], s96 offen offset:128 sc1
    s_mov_b32 s96, 4210688
    buffer_load_dwordx2 v[250:251], v57, s[16:19], s96 offen offset:0 sc1
    buffer_load_dwordx2 v[254:255], v57, s[16:19], s96 offen offset:128 sc1
    s_mov_b32 s96, 0
    s_mov_b32 s97, 5120
    s_waitcnt vmcnt(16)
    buffer_load_dwordx2 v[208:209], v60, s[4:7], s96 offen
    s_waitcnt vmcnt(16)
    buffer_load_dwordx2 v[210:211], v60, s[4:7], s97 offen
    s_waitcnt vmcnt(16)
    v_lshrrev_b32_e64 v212, 5, v1
    v_mul_u32_u24 v212, 5104, v212
    v_bfe_u32 v213, v1, 4, 1
    v_lshlrev_b32 v213, 2, v213
    v_sub_u32 v212, v212, v213
    v_add_u32 v212, v212, v60
    s_mul_i32 s97, s24, 24
    s_sub_u32 s97, 128, s97
    buffer_load_dword v212, v212, s[4:7], s97 offen
    s_mov_b64 exec, -1
    s_waitcnt vmcnt(0) lgkmcnt(0)
    s_branch oe_20
rd_24:
    s_cmp_eq_u32 s38, 0
    s_cbranch_scc1 rc_25
    s_sub_u32 s38, s38, 1
    s_nop 7
    s_nop 7
    s_sleep 4
    s_mov_b64 exec, vcc
    s_mov_b32 s96, 4198400
    buffer_load_dwordx4 v[216:219], v56, s[16:19], s96 offen offset:0 sc1
    buffer_load_dwordx4 v[220:223], v56, s[16:19], s96 offen offset:256 sc1
    s_mov_b32 s96, 4231168
    buffer_load_dwordx4 v[224:227], v56, s[16:19], s96 offen offset:0 sc1
    buffer_load_dwordx4 v[228:231], v56, s[16:19], s96 offen offset:256 sc1
    s_mov_b32 s96, 4263936
    buffer_load_dwordx4 v[232:235], v56, s[16:19], s96 offen offset:0 sc1
    buffer_load_dwordx4 v[236:239], v56, s[16:19], s96 offen offset:256 sc1
    s_mov_b32 s96, 4296704
    buffer_load_dwordx4 v[240:243], v56, s[16:19], s96 offen offset:0 sc1
    buffer_load_dwordx4 v[244:247], v56, s[16:19], s96 offen offset:256 sc1
    s_mov_b32 s96, 4196352
    buffer_load_dwordx2 v[248:249], v57, s[16:19], s96 offen offset:0 sc1
    buffer_load_dwordx2 v[252:253], v57, s[16:19], s96 offen offset:128 sc1
    s_mov_b32 s96, 4212736
    buffer_load_dwordx2 v[250:251], v57, s[16:19], s96 offen offset:0 sc1
    buffer_load_dwordx2 v[254:255], v57, s[16:19], s96 offen offset:128 sc1
    s_mov_b32 s96, 1310720
    s_mov_b32 s97, 1315840
    s_waitcnt vmcnt(15)
    buffer_load_dwordx2 v[208:209], v60, s[4:7], s96 offen
    s_waitcnt vmcnt(15)
    buffer_load_dwordx2 v[210:211], v60, s[4:7], s97 offen
    s_waitcnt vmcnt(15)
    v_lshrrev_b32 v212, 5, v1
    v_mul_u32_u24 v212, 5104, v212
    v_bfe_u32 v213, v1, 4, 1
    v_lshlrev_b32 v213, 2, v213
    v_sub_u32 v212, v212, v213
    v_add_u32 v212, v212, v60
    s_mul_i32 s97, s24, 24
    s_sub_u32 s97, 1310848, s97
    buffer_load_dword v212, v212, s[4:7], s97 offen
    s_mov_b64 exec, -1
    s_waitcnt vmcnt(0) lgkmcnt(0)
    s_branch oe_23
rd_29:
    s_cmp_eq_u32 s38, 0
    s_cbranch_scc1 rc_30
    s_sub_u32 s38, s38, 1
    s_nop 7
    s_nop 7
    s_sleep 4
    s_mov_b64 exec, vcc
    s_lshl_b32 s96, s75, 14
    s_add_u32 s96, s96, 6815744
    s_lshl_b32 s97, s24, 12
    s_add_u32 s97, s97, 3473408
    buffer_load_dwordx4 v[176:179], v62, s[16:19], s96 offen offset:0 sc1
    buffer_load_dwordx4 v[180:183], v62, s[16:19], s96 offen offset:1024 sc1
    buffer_load_dwordx4 v[184:187], v62, s[16:19], s97 offen offset:0 sc1
    buffer_load_dwordx4 v[188:191], v62, s[16:19], s97 offen offset:1024 sc1
    buffer_load_dwordx4 v[192:195], v62, s[16:19], s97 offen offset:2048 sc1
    buffer_load_dwordx4 v[196:199], v62, s[16:19], s97 offen offset:3072 sc1
    s_mov_b64 exec, -1
    s_waitcnt vmcnt(0) lgkmcnt(0)
    s_branch ce_28
rd_32:
    s_cmp_eq_u32 s38, 0
    s_cbranch_scc1 rc_33
    s_sub_u32 s38, s38, 1
    s_nop 7
    s_nop 7
    s_sleep 4
    s_mov_b64 exec, vcc
    s_lshl_b32 s96, s75, 14
    s_add_u32 s96, s96, 6815744
    s_lshl_b32 s97, s24, 12
    s_add_u32 s97, s97, 3477504
    buffer_load_dwordx4 v[248:251], v62, s[16:19], s96 offen offset:2048 sc1
    buffer_load_dwordx4 v[252:255], v62, s[16:19], s96 offen offset:3072 sc1
    buffer_load_dwordx4 v[96:99], v62, s[16:19], s97 offen offset:0 sc1
    buffer_load_dwordx4 v[100:103], v62, s[16:19], s97 offen offset:1024 sc1
    buffer_load_dwordx4 v[104:107], v62, s[16:19], s97 offen offset:2048 sc1
    buffer_load_dwordx4 v[108:111], v62, s[16:19], s97 offen offset:3072 sc1
    s_mov_b64 exec, -1
    s_waitcnt vmcnt(0) lgkmcnt(0)
    s_branch ce_31
gl_34:
    s_add_u32 s82, s86, 16384
    v_lshlrev_b32 v2, 10, v1
    v_mov_b32_e64 v5, 1
    s_mov_b64 exec, 255
    buffer_store_dword v5, v2, s[16:19], s82 offen offset:0 sc1
    s_mov_b64 exec, -1
    s_branch gc_35
ps_36:
    s_mov_b32 s84, 1048576
pl_37:
    buffer_load_dword v7, v4, s[16:19], s89 offen offset:0 sc1
    s_waitcnt vmcnt(0)
    s_sub_u32 s84, s84, 1
    s_cbranch_scc1 pc_38
    v_cmp_gt_u32 vcc, 1, v7
    s_nop 0
    s_and_b64 vcc, vcc, s[50:51]
    s_cbranch_scc1 pl_37
    s_branch pc_38
ps_39:
    s_mov_b32 s84, 1048576
pl_40:
    buffer_load_dword v7, v4, s[16:19], s87 offen offset:8 sc1
    s_waitcnt vmcnt(0)
    s_sub_u32 s84, s84, 1
    s_cbranch_scc1 pc_41
    v_cmp_gt_u32 vcc, 12, v7
    s_nop 0
    s_and_b64 vcc, vcc, s[50:51]
    s_cbranch_scc1 pl_40
    s_branch pc_41
gl_42:
    s_add_u32 s82, s86, 0
    v_lshlrev_b32 v2, 10, v1
    v_mov_b32_e64 v5, 1
    s_mov_b64 exec, 255
    buffer_store_dword v5, v2, s[16:19], s82 offen offset:12 sc1
    s_mov_b64 exec, -1
    s_branch gc_43
ps_44:
    s_mov_b32 s84, 1048576
pl_45:
    buffer_load_dword v7, v4, s[16:19], s89 offen offset:0 sc1
    s_waitcnt vmcnt(0)
    s_sub_u32 s84, s84, 1
    s_cbranch_scc1 pc_46
    v_cmp_gt_u32_e64 vcc, 1, v7
    s_nop 0
    s_and_b64 vcc, vcc, s[50:51]
    s_cbranch_scc1 pl_45
    s_branch pc_46
rd_49:
    s_cmp_eq_u32 s38, 0
    s_cbranch_scc1 rc_50
    s_sub_u32 s38, s38, 1
    s_nop 7
    s_nop 7
    s_sleep 4
    s_mov_b64 exec, vcc
    s_add_u32 s26, s3, 9437184
    buffer_load_dwordx4 v[216:219], v236, s[16:19], s26 offen sc1
    s_add_u32 s26, s26, 524288
    buffer_load_dwordx4 v[220:223], v236, s[16:19], s26 offen sc1
    s_add_u32 s26, s26, 524288
    buffer_load_dwordx4 v[224:227], v236, s[16:19], s26 offen sc1
    s_add_u32 s26, s26, 524288
    buffer_load_dwordx4 v[228:231], v236, s[16:19], s26 offen sc1
    s_add_u32 s26, s26, 524288
    buffer_load_dwordx4 v[232:235], v236, s[16:19], s26 offen sc1
    s_mov_b64 exec, -1
    s_waitcnt vmcnt(0) lgkmcnt(0)
    s_branch se_48
gl_52:
    s_add_u32 s82, s86, 16384
    v_lshlrev_b32 v2, 10, v1
    v_mov_b32_e64 v5, 1
    s_mov_b64 exec, 255
    buffer_store_dword v5, v2, s[16:19], s82 offen offset:4 sc1
    s_mov_b64 exec, -1
    s_branch gc_53
ps_54:
    s_mov_b32 s84, 1048576
pl_55:
    buffer_load_dword v7, v4, s[16:19], s87 offen offset:12 sc1
    s_waitcnt vmcnt(0)
    s_sub_u32 s84, s84, 1
    s_cbranch_scc1 pc_56
    v_cmp_gt_u32_e64 vcc, 1, v7
    s_nop 0
    s_and_b64 vcc, vcc, s[50:51]
    s_cbranch_scc1 pl_55
    s_branch pc_56
rd_58:
    s_cmp_eq_u32 s38, 0
    s_cbranch_scc1 rc_59
    s_sub_u32 s38, s38, 1
    s_nop 7
    s_nop 7
    s_sleep 4
    s_mov_b64 exec, vcc
    s_lshl_b32 s98, s72, 5
    s_add_u32 s98, s98, 0
    s_sub_u32 s95, s98, 4
    s_max_i32 s95, s95, 0
    s_lshl_b32 s94, s98, 3
    s_lshl_b32 s95, s95, 3
    s_add_u32 s94, s94, 3457024
    s_add_u32 s95, s95, 3457024
    s_add_u32 s96, s94, 8192
    buffer_load_dwordx2 v[152:153], v47, s[16:19], s94 offen sc1
    buffer_load_dwordx2 v[154:155], v47, s[16:19], s96 offen sc1
    buffer_load_dwordx2 v[156:157], v48, s[16:19], s95 offen sc1
    s_mov_b64 exec, -1
    s_waitcnt vmcnt(0) lgkmcnt(0)
    s_branch sl_57
ps_60:
    s_mov_b32 s84, 1048576
pl_61:
    buffer_load_dword v7, v4, s[16:19], s89 offen offset:4 sc1
    s_waitcnt vmcnt(0)
    s_sub_u32 s84, s84, 1
    s_cbranch_scc1 pc_62
    v_cmp_gt_u32 vcc, 1, v7
    s_nop 0
    s_and_b64 vcc, vcc, s[50:51]
    s_cbranch_scc1 pl_61
    s_branch pc_62
rd_65:
    s_cmp_eq_u32 s38, 0
    s_cbranch_scc1 rc_66
    s_sub_u32 s38, s38, 1
    s_nop 7
    s_nop 7
    s_sleep 4
    s_mov_b64 exec, vcc
    s_add_u32 s26, s3, 9437184
    buffer_load_dwordx4 v[216:219], v236, s[16:19], s26 offen sc1
    s_add_u32 s26, s26, 524288
    buffer_load_dwordx4 v[220:223], v236, s[16:19], s26 offen sc1
    s_add_u32 s26, s26, 524288
    buffer_load_dwordx4 v[224:227], v236, s[16:19], s26 offen sc1
    s_add_u32 s26, s26, 524288
    buffer_load_dwordx4 v[228:231], v236, s[16:19], s26 offen sc1
    s_add_u32 s26, s26, 524288
    buffer_load_dwordx4 v[232:235], v236, s[16:19], s26 offen sc1
    s_mov_b64 exec, -1
    s_waitcnt vmcnt(0) lgkmcnt(0)
    s_branch se_64
rd_67:
    s_cmp_eq_u32 s39, 0
    s_cbranch_scc1 rc_68
    s_sub_u32 s39, s39, 1
    s_nop 7
    s_nop 7
    s_waitcnt vmcnt(0) lgkmcnt(0)
    s_barrier
    s_lshl_b32 s25, s72, 5
    s_add_u32 s25, s25, 0
    s_sub_u32 s26, s25, 4
    s_max_i32 s26, s26, 0
    s_lshl_b32 s27, s71, 12
    s_add_u32 s27, s27, 9437184
    s_lshl_b32 s99, s25, 3
    s_lshl_b32 s100, s26, 3
    s_lshl_b32 s92, s24, 12
    s_lshl_b32 s93, s24, 9
    s_add_u32 s99, s99, s27
    s_add_u32 s100, s100, s27
    s_add_u32 m0, s92, 36352
    s_nop 0
    buffer_load_dwordx4 v73, s[16:19], s99 offen offset:0 sc1 lds
    buffer_load_dwordx4 v74, s[16:19], s99 offen offset:1024 sc1 lds
    buffer_load_dwordx4 v75, s[16:19], s99 offen offset:2048 sc1 lds
    buffer_load_dwordx4 v76, s[16:19], s99 offen offset:3072 sc1 lds
    s_add_u32 m0, s93, 53760
    s_add_u32 s99, s99, 524288
    s_mov_b64 exec, s[80:81]
    buffer_load_dwordx4 v77, s[16:19], s100 offen sc1 lds
    s_mov_b64 exec, -1
    s_add_u32 s100, s100, 524288
    s_add_u32 m0, s92, 55936
    s_nop 0
    s_nop 0
    buffer_load_dwordx4 v73, s[16:19], s99 offen offset:0 sc1 lds
    buffer_load_dwordx4 v74, s[16:19], s99 offen offset:1024 sc1 lds
    buffer_load_dwordx4 v75, s[16:19], s99 offen offset:2048 sc1 lds
    buffer_load_dwordx4 v76, s[16:19], s99 offen offset:3072 sc1 lds
    s_add_u32 m0, s93, 73344
    s_add_u32 s99, s99, 524288
    s_mov_b64 exec, s[80:81]
    buffer_load_dwordx4 v77, s[16:19], s100 offen sc1 lds
    s_mov_b64 exec, -1
    s_add_u32 s100, s100, 524288
    s_add_u32 m0, s92, 75520
    s_nop 0
    s_nop 0
    buffer_load_dwordx4 v73, s[16:19], s99 offen offset:0 sc1 lds
    buffer_load_dwordx4 v74, s[16:19], s99 offen offset:1024 sc1 lds
    buffer_load_dwordx4 v75, s[16:19], s99 offen offset:2048 sc1 lds
    buffer_load_dwordx4 v76, s[16:19], s99 offen offset:3072 sc1 lds
    s_add_u32 m0, s93, 92928
    s_add_u32 s99, s99, 524288
    s_mov_b64 exec, s[80:81]
    buffer_load_dwordx4 v77, s[16:19], s100 offen sc1 lds
    s_mov_b64 exec, -1
    s_add_u32 s100, s100, 524288
    s_mov_b64 exec, -1
    s_waitcnt vmcnt(0) lgkmcnt(0)
    s_branch ge_51
rd_71:
    s_cmp_eq_u32 s38, 0
    s_cbranch_scc1 rc_72
    s_sub_u32 s38, s38, 1
    s_nop 7
    s_nop 7
    s_sleep 4
    s_mov_b64 exec, vcc
    s_lshl_b32 s98, s72, 5
    s_add_u32 s98, s98, 256
    s_sub_u32 s95, s98, 4
    s_max_i32 s95, s95, 0
    s_lshl_b32 s94, s98, 3
    s_lshl_b32 s95, s95, 3
    s_nop 0
    s_add_u32 s94, s94, 3457024
    s_add_u32 s95, s95, 3457024
    s_add_u32 s96, s94, 8192
    buffer_load_dwordx2 v[152:153], v47, s[16:19], s94 offen sc1
    buffer_load_dwordx2 v[154:155], v47, s[16:19], s96 offen sc1
    buffer_load_dwordx2 v[156:157], v48, s[16:19], s95 offen sc1
    s_mov_b64 exec, -1
    s_waitcnt vmcnt(0) lgkmcnt(0)
    s_branch sl_70
rd_73:
    s_cmp_eq_u32 s39, 0
    s_cbranch_scc1 rc_74
    s_sub_u32 s39, s39, 1
    s_nop 7
    s_nop 7
    s_waitcnt vmcnt(0) lgkmcnt(0)
    s_barrier
    s_lshl_b32 s25, s72, 5
    s_add_u32 s25, s25, 256
    s_sub_u32 s26, s25, 4
    s_max_i32 s26, s26, 0
    s_lshl_b32 s27, s71, 12
    s_add_u32 s27, s27, 9437184
    s_lshl_b32 s99, s25, 3
    s_lshl_b32 s100, s26, 3
    s_lshl_b32 s92, s24, 12
    s_lshl_b32 s93, s24, 9
    s_add_u32 s99, s99, s27
    s_add_u32 s100, s100, s27
    s_add_u32 m0, s92, 36352
    s_nop 0
    s_nop 0
    buffer_load_dwordx4 v73, s[16:19], s99 offen offset:0 sc1 lds
    buffer_load_dwordx4 v74, s[16:19], s99 offen offset:1024 sc1 lds
    buffer_load_dwordx4 v75, s[16:19], s99 offen offset:2048 sc1 lds
    buffer_load_dwordx4 v76, s[16:19], s99 offen offset:3072 sc1 lds
    s_add_u32 m0, s93, 53760
    s_add_u32 s99, s99, 524288
    s_mov_b64 exec, s[80:81]
    buffer_load_dwordx4 v77, s[16:19], s100 offen sc1 lds
    s_mov_b64 exec, -1
    s_add_u32 s100, s100, 524288
    s_add_u32 m0, s92, 55936
    s_nop 0
    s_nop 0
    buffer_load_dwordx4 v73, s[16:19], s99 offen offset:0 sc1 lds
    buffer_load_dwordx4 v74, s[16:19], s99 offen offset:1024 sc1 lds
    buffer_load_dwordx4 v75, s[16:19], s99 offen offset:2048 sc1 lds
    buffer_load_dwordx4 v76, s[16:19], s99 offen offset:3072 sc1 lds
    s_add_u32 m0, s93, 73344
    s_add_u32 s99, s99, 524288
    s_mov_b64 exec, s[80:81]
    buffer_load_dwordx4 v77, s[16:19], s100 offen sc1 lds
    s_mov_b64 exec, -1
    s_add_u32 s100, s100, 524288
    s_add_u32 m0, s92, 75520
    s_nop 0
    s_nop 0
    buffer_load_dwordx4 v73, s[16:19], s99 offen offset:0 sc1 lds
    buffer_load_dwordx4 v74, s[16:19], s99 offen offset:1024 sc1 lds
    buffer_load_dwordx4 v75, s[16:19], s99 offen offset:2048 sc1 lds
    buffer_load_dwordx4 v76, s[16:19], s99 offen offset:3072 sc1 lds
    s_add_u32 m0, s93, 92928
    s_add_u32 s99, s99, 524288
    s_mov_b64 exec, s[80:81]
    buffer_load_dwordx4 v77, s[16:19], s100 offen sc1 lds
    s_mov_b64 exec, -1
    s_add_u32 s100, s100, 524288
    s_mov_b64 exec, -1
    s_waitcnt vmcnt(0) lgkmcnt(0)
    s_branch ge_69
rd_76:
    s_cmp_eq_u32 s38, 0
    s_cbranch_scc1 rc_77
    s_sub_u32 s38, s38, 1
    s_nop 7
    s_nop 7
    s_sleep 4
    s_mov_b64 exec, vcc
    s_mov_b32 s96, 12058624
    buffer_load_dwordx4 v[216:219], v56, s[16:19], s96 offen offset:0 sc1
    buffer_load_dwordx4 v[220:223], v56, s[16:19], s96 offen offset:256 sc1
    s_mov_b32 s96, 12091392
    buffer_load_dwordx4 v[224:227], v56, s[16:19], s96 offen offset:0 sc1
    buffer_load_dwordx4 v[228:231], v56, s[16:19], s96 offen offset:256 sc1
    s_mov_b32 s96, 12124160
    buffer_load_dwordx4 v[232:235], v56, s[16:19], s96 offen offset:0 sc1
    buffer_load_dwordx4 v[236:239], v56, s[16:19], s96 offen offset:256 sc1
    s_mov_b32 s96, 12156928
    buffer_load_dwordx4 v[240:243], v56, s[16:19], s96 offen offset:0 sc1
    buffer_load_dwordx4 v[244:247], v56, s[16:19], s96 offen offset:256 sc1
    s_mov_b32 s96, 12058624
    buffer_load_dwordx2 v[248:249], v57, s[16:19], s96 offen offset:0 sc1
    buffer_load_dwordx2 v[252:253], v57, s[16:19], s96 offen offset:128 sc1
    s_mov_b32 s96, 12075008
    buffer_load_dwordx2 v[250:251], v57, s[16:19], s96 offen offset:0 sc1
    buffer_load_dwordx2 v[254:255], v57, s[16:19], s96 offen offset:128 sc1
    s_mov_b32 s96, 9437184
    buffer_load_dwordx4 v[208:211], v59, s[16:19], s96 offen sc1
    s_add_u32 s97, s36, 9437184
    buffer_load_dword v212, v61, s[16:19], s97 offen sc1
    s_mov_b64 exec, -1
    s_waitcnt vmcnt(0) lgkmcnt(0)
    s_branch oe_75
rd_79:
    s_cmp_eq_u32 s38, 0
    s_cbranch_scc1 rc_80
    s_sub_u32 s38, s38, 1
    s_nop 7
    s_nop 7
    s_sleep 4
    s_mov_b64 exec, vcc
    s_mov_b32 s96, 12062720
    buffer_load_dwordx4 v[216:219], v56, s[16:19], s96 offen offset:0 sc1
    buffer_load_dwordx4 v[220:223], v56, s[16:19], s96 offen offset:256 sc1
    s_mov_b32 s96, 12095488
    buffer_load_dwordx4 v[224:227], v56, s[16:19], s96 offen offset:0 sc1
    buffer_load_dwordx4 v[228:231], v56, s[16:19], s96 offen offset:256 sc1
    s_mov_b32 s96, 12128256
    buffer_load_dwordx4 v[232:235], v56, s[16:19], s96 offen offset:0 sc1
    buffer_load_dwordx4 v[236:239], v56, s[16:19], s96 offen offset:256 sc1
    s_mov_b32 s96, 12161024
    buffer_load_dwordx4 v[240:243], v56, s[16:19], s96 offen offset:0 sc1
    buffer_load_dwordx4 v[244:247], v56, s[16:19], s96 offen offset:256 sc1
    s_mov_b32 s96, 12060672
    buffer_load_dwordx2 v[248:249], v57, s[16:19], s96 offen offset:0 sc1
    buffer_load_dwordx2 v[252:253], v57, s[16:19], s96 offen offset:128 sc1
    s_mov_b32 s96, 12077056
    buffer_load_dwordx2 v[250:251], v57, s[16:19], s96 offen offset:0 sc1
    buffer_load_dwordx2 v[254:255], v57, s[16:19], s96 offen offset:128 sc1
    s_mov_b32 s96, 9439232
    buffer_load_dwordx4 v[208:211], v59, s[16:19], s96 offen sc1
    s_add_u32 s97, s36, 9439232
    buffer_load_dword v212, v61, s[16:19], s97 offen sc1
    s_mov_b64 exec, -1
    s_waitcnt vmcnt(0) lgkmcnt(0)
    s_branch oe_78
rd_84:
    s_cmp_eq_u32 s38, 0
    s_cbranch_scc1 rc_85
    s_sub_u32 s38, s38, 1
    s_nop 7
    s_nop 7
    s_sleep 4
    s_mov_b64 exec, vcc
    s_lshl_b32 s96, s75, 14
    s_add_u32 s96, s96, 14680064
    s_lshl_b32 s97, s24, 12
    s_add_u32 s97, s97, 3506176
    buffer_load_dwordx4 v[176:179], v62, s[16:19], s96 offen offset:0 sc1
    buffer_load_dwordx4 v[180:183], v62, s[16:19], s96 offen offset:1024 sc1
    buffer_load_dwordx4 v[184:187], v62, s[16:19], s97 offen offset:0 sc1
    buffer_load_dwordx4 v[188:191], v62, s[16:19], s97 offen offset:1024 sc1
    buffer_load_dwordx4 v[192:195], v62, s[16:19], s97 offen offset:2048 sc1
    buffer_load_dwordx4 v[196:199], v62, s[16:19], s97 offen offset:3072 sc1
    s_mov_b64 exec, -1
    s_waitcnt vmcnt(0) lgkmcnt(0)
    s_branch ce_83
rd_87:
    s_cmp_eq_u32 s38, 0
    s_cbranch_scc1 rc_88
    s_sub_u32 s38, s38, 1
    s_nop 7
    s_nop 7
    s_sleep 4
    s_mov_b64 exec, vcc
    s_lshl_b32 s96, s75, 14
    s_add_u32 s96, s96, 14680064
    s_lshl_b32 s97, s24, 12
    s_add_u32 s97, s97, 3510272
    buffer_load_dwordx4 v[248:251], v62, s[16:19], s96 offen offset:2048 sc1
    buffer_load_dwordx4 v[252:255], v62, s[16:19], s96 offen offset:3072 sc1
    buffer_load_dwordx4 v[96:99], v62, s[16:19], s97 offen offset:0 sc1
    buffer_load_dwordx4 v[100:103], v62, s[16:19], s97 offen offset:1024 sc1
    buffer_load_dwordx4 v[104:107], v62, s[16:19], s97 offen offset:2048 sc1
    buffer_load_dwordx4 v[108:111], v62, s[16:19], s97 offen offset:3072 sc1
    s_mov_b64 exec, -1
    s_waitcnt vmcnt(0) lgkmcnt(0)
    s_branch ce_86
L_last:
    s_endpgm
.section .rodata,"a"
.p2align 6
.amdhsa_kernel interleave_layers__sliding_local_dilated__ssm_conv_s4d__prompt_kernel
  .amdhsa_next_free_vgpr 512
  .amdhsa_next_free_sgpr 102
  .amdhsa_accum_offset 256
  .amdhsa_group_segment_fixed_size 0
  .amdhsa_kernarg_size 104
  .amdhsa_user_sgpr_count 2
  .amdhsa_user_sgpr_kernarg_segment_ptr 1
  .amdhsa_system_sgpr_workgroup_id_x 1
.end_amdhsa_kernel
```

```asm
; @launch grid=(256,1,1) block=(256,1,1) lds=163840
.amdgcn_target "amdgcn-amd-amdhsa--gfx950"
.text
.globl interleave_layers__sliding_local_dilated__ssm_conv_s4d__prompt_kernel
.p2align 8
.type interleave_layers__sliding_local_dilated__ssm_conv_s4d__prompt_kernel,@function
interleave_layers__sliding_local_dilated__ssm_conv_s4d__prompt_kernel:
    s_getpc_b64 s[42:43]
L_start:
    s_cmp_ge_u32 s2, 256
    s_cbranch_scc1 L_end
    s_load_dwordx16 s[44:59], s[0:1], 0
    s_load_dwordx8 s[60:67], s[0:1], 64
    s_load_dwordx2 s[68:69], s[0:1], 96
    v_and_b32 v1, 63, v0
    v_lshrrev_b32 v2, 6, v0
    s_nop 0
    v_readfirstlane_b32 s24, v2
    s_bfe_u32 s82, s2, 0x40003
    s_lshl_b32 s82, s82, 13
    v_lshrrev_b32 v159, 2, v0
    v_lshl_add_u32 v159, v159, 7, s82
    v_min_u32 v159, L_last-L_start, v159
    global_load_dword v159, v159, s[42:43]
    s_and_b32 s25, s2, 7
    s_lshr_b32 s26, s2, 3
    s_and_b32 s27, s26, 3
    s_lshr_b32 s28, s26, 4
    s_lshl_b32 s28, s28, 2
    s_add_u32 s3, s27, s28
    s_lshl_b32 s27, s3, 2
    s_lshr_b32 s70, 0x75206431, s27
    s_and_b32 s70, s70, 7
    s_and_b32 s27, s25, 1
    s_lshl_b32 s27, s27, 3
    s_add_u32 s70, s70, s27
    s_bfe_u32 s71, s26, 0x10002
    s_bfe_u32 s28, s26, 0x10003
    s_and_b32 s72, s25, 6
    s_add_u32 s72, s72, s28
    s_and_b32 s73, s26, 7
    s_lshr_b32 s28, s26, 3
    s_lshl_b32 s74, s25, 2
    s_add_u32 s74, s74, s28
    s_mul_i32 s75, s25, 20
    s_add_u32 s75, s75, s26
    s_min_u32 s27, s2, 239
    s_mul_i32 s25, s27, 10923
    s_lshr_b32 s25, s25, 16
    s_mul_i32 s26, s25, 6
    s_sub_u32 s26, s27, s26
    s_mul_i32 s27, s25, 61440
    s_mul_i32 s28, s26, 640
    s_add_u32 s27, s27, s28
    s_lshl_b32 s28, s24, 10
    v_add_u32 v85, 0, v0
    v_mul_u32_u24 v84, 1639, v85
    v_lshrrev_b32 v84, 16, v84
    v_mul_u32_u24 v84, 3200, v84
    v_lshl_add_u32 v85, v85, 4, v84
    v_add_u32 v86, 256, v0
    v_mul_u32_u24 v84, 1639, v86
    v_lshrrev_b32_e64 v84, 16, v84
    v_mul_u32_u24 v84, 3200, v84
    v_lshl_add_u32 v86, v86, 4, v84
    v_add_u32 v87, 512, v0
    v_min_u32 v87, 639, v87
    v_mul_u32_u24 v84, 1639, v87
    v_lshrrev_b32_e64 v84, 16, v84
    v_mul_u32_u24 v84, 3200, v84
    v_lshl_add_u32 v87, v87, 4, v84
    s_mov_b32 s76, 0
    s_mov_b32 s77, 0x80000000
    s_mov_b32 s80, -1
    s_mov_b32 s81, 0
    s_nop 0
    s_mov_b32 s78, 0xfe0000fe
    s_mov_b32 s79, 0xfe0000fe
    s_mov_b32 s6, 2621440
    s_mov_b32 s7, 0x20000
    s_mov_b32 s10, 2457600
    s_mov_b32 s11, 0x20000
    s_mov_b32 s14, 819200
    s_mov_b32 s15, 0x20000
    s_mov_b32 s18, 22061056
    s_mov_b32 s19, 0x20000
    s_mov_b32 s22, 2621440
    s_mov_b32 s23, 0x20000
    s_waitcnt lgkmcnt(0)
    s_mov_b32 s4, s44
    s_and_b32 s5, s45, 0xffff
    s_mov_b32 s8, s46
    s_and_b32 s9, s47, 0xffff
    s_mov_b32 s12, s48
    s_and_b32 s13, s49, 0xffff
    s_mov_b32 s16, s68
    s_and_b32 s17, s69, 0xffff
    s_mov_b32 s20, s64
    s_and_b32 s21, s65, 0xffff
    s_cmp_lg_u32 s2, 255
    s_cbranch_scc1 fz_1
    v_mov_b32 v120, 0
    v_mov_b32 v121, 0
    v_mov_b32 v122, 0
    v_mov_b32 v123, 0
    v_lshlrev_b32 v124, 4, v0
    s_mov_b32 s88, 3538944
    buffer_store_dwordx4 v[120:123], v124, s[16:19], s88 offen sc1
    s_mov_b32 s88, 3543040
    buffer_store_dwordx4 v[120:123], v124, s[16:19], s88 offen sc1
    s_mov_b32 s88, 3547136
    buffer_store_dwordx4 v[120:123], v124, s[16:19], s88 offen sc1
    s_mov_b32 s88, 3555328
    buffer_store_dwordx4 v[120:123], v124, s[16:19], s88 offen sc1
    s_mov_b32 s88, 3559424
    buffer_store_dwordx4 v[120:123], v124, s[16:19], s88 offen sc1
    s_mov_b32 s88, 3563520
    buffer_store_dwordx4 v[120:123], v124, s[16:19], s88 offen sc1
fz_1:
    s_min_u32 s96, s75, 159
    s_lshl_b32 s96, s96, 2
    s_add_u32 s96, s96, s24
    s_mul_i32 s97, s96, 384
    s_lshl_b32 s96, s96, 1
    v_lshl_add_u32 v2, v1, 2, s97
    v_mov_b32 v241, s96
    global_load_dword v232, v2, s[52:53]
    global_load_dword v233, v2, s[54:55]
    global_load_dword v234, v2, s[56:57]
    global_load_dword v235, v2, s[58:59]
    global_load_ushort v240, v241, s[60:61]
    s_add_u32 m0, s28, 134272
    s_nop 0
    buffer_load_dwordx4 v85, s[8:11], s27 offen lds
    s_add_u32 m0, s28, 138368
    s_nop 0
    buffer_load_dwordx4 v86, s[8:11], s27 offen lds
    s_add_u32 m0, s28, 142464
    s_nop 0
    buffer_load_dwordx4 v87, s[8:11], s27 offen lds
    s_lshr_b32 s29, s26, 1
    s_and_b32 s30, s26, 1
    s_lshl_b32 s30, s30, 3
    s_lshl_b32 s31, s25, 10
    s_add_u32 s31, s31, 0
    s_cmp_ge_u32 s2, 240
    s_cselect_b32 s31, 1073741824, s31
    v_bfe_u32 v93, v0, 2, 2
    v_bfe_u32 v92, v0, 1, 1
    v_lshl_add_u32 v92, v92, 3, v93
    v_mul_u32_u24 v92, 640, v92
    v_and_b32 v93, 1, v0
    v_mul_u32_u24 v93, 40, v93
    v_add_u32 v91, v92, v93
    v_add_u32 v91, 134272, v91
    v_lshrrev_b32 v88, 4, v0
    v_add_u32 v88, 0, v88
    v_cmp_gt_u32 vcc, 40, v88
    v_min_u32 v88, 39, v88
    v_mul_u32_u24 v89, 13108, v88
    v_lshrrev_b32 v89, 16, v89
    v_mul_u32_u24 v90, 5, v89
    v_sub_u32_e64 v90, v88, v90
    v_mul_u32_u24 v92, 80, v89
    v_lshl_add_u32 v92, v90, 3, v92
    v_add_u32 v111, v92, v91
    v_add_u32 v89, s30, v89
    v_cmp_eq_u32 s[82:83], 4, v90
    v_mov_b32 v92, s29
    s_nop 0
    v_cndmask_b32 v93, v90, v92, s[82:83]
    v_cndmask_b32 v92, v92, 3, s[82:83]
    v_lshl_add_u32 v89, v89, 2, v93
    v_mul_u32_u24 v89, 40960, v89
    v_lshl_add_u32 v89, v92, 8, v89
    v_and_b32 v92, 15, v0
    v_lshl_add_u32 v89, v92, 4, v89
    v_mov_b32 v92, 1073741824
    v_cndmask_b32 v89, v92, v89, vcc
    v_add_u32 v108, s31, v89
    v_lshrrev_b32 v88, 4, v0
    v_add_u32 v88, 16, v88
    v_cmp_gt_u32 vcc, 40, v88
    v_min_u32 v88, 39, v88
    v_mul_u32_u24 v89, 13108, v88
    v_lshrrev_b32 v89, 16, v89
    v_mul_u32_u24 v90, 5, v89
    v_sub_u32_e64 v90, v88, v90
    v_mul_u32_u24 v92, 80, v89
    v_lshl_add_u32 v92, v90, 3, v92
    v_add_u32 v112, v92, v91
    v_add_u32 v89, s30, v89
    v_cmp_eq_u32 s[82:83], 4, v90
    v_mov_b32 v92, s29
    s_nop 0
    v_cndmask_b32 v93, v90, v92, s[82:83]
    v_cndmask_b32 v92, v92, 3, s[82:83]
    v_lshl_add_u32 v89, v89, 2, v93
    v_mul_u32_u24 v89, 40960, v89
    v_lshl_add_u32 v89, v92, 8, v89
    v_and_b32 v92, 15, v0
    v_lshl_add_u32 v89, v92, 4, v89
    v_mov_b32 v92, 1073741824
    v_cndmask_b32 v89, v92, v89, vcc
    v_add_u32 v109, s31, v89
    v_lshrrev_b32 v88, 4, v0
    v_add_u32 v88, 32, v88
    v_cmp_gt_u32 vcc, 40, v88
    v_min_u32 v88, 39, v88
    v_mul_u32_u24 v89, 13108, v88
    v_lshrrev_b32 v89, 16, v89
    v_mul_u32_u24 v90, 5, v89
    v_sub_u32_e64 v90, v88, v90
    v_mul_u32_u24 v92, 80, v89
    v_lshl_add_u32 v92, v90, 3, v92
    v_add_u32 v113, v92, v91
    v_add_u32 v89, s30, v89
    v_cmp_eq_u32 s[82:83], 4, v90
    v_mov_b32 v92, s29
    s_nop 0
    v_cndmask_b32 v93, v90, v92, s[82:83]
    v_cndmask_b32 v92, v92, 3, s[82:83]
    v_lshl_add_u32 v89, v89, 2, v93
    v_mul_u32_u24 v89, 40960, v89
    v_lshl_add_u32 v89, v92, 8, v89
    v_and_b32 v92, 15, v0
    v_lshl_add_u32 v89, v92, 4, v89
    v_mov_b32 v92, 1073741824
    v_cndmask_b32 v89, v92, v89, vcc
    v_add_u32 v110, s31, v89
    s_mul_i32 s25, s3, 18
    s_lshl_b32 s26, s72, 7
    s_add_u32 s25, s25, s26
    s_add_u32 s25, s25, s71
    s_add_u32 s25, s25, -16
    s_max_i32 s25, s25, 0
    s_mul_i32 s25, s25, 1280
    v_lshrrev_b32_e64 v204, 1, v0
    v_min_u32 v204, 89, v204
    v_mul_u32_u24 v205, 6554, v204
    v_lshrrev_b32_e64 v205, 16, v205
    v_mul_u32_u24 v205, 1280, v205
    v_lshl_add_u32 v204, v204, 7, v205
    buffer_load_dword v204, v204, s[4:7], s25 offen
    s_and_b32 s25, s2, 7
    s_lshl_b32 s86, s25, 7
    s_add_u32 s86, s86, 3538944
    s_lshl_b32 s87, s25, 10
    s_add_u32 s87, s87, 3538944
    s_add_u32 s89, s87, 16384
    v_cmp_gt_u32 s[50:51], 8, v0
    v_cmp_eq_u32 vcc, 0, v0
    v_lshlrev_b32 v4, 7, v1
    v_mov_b32 v6, 1073741824
    v_cndmask_b32 v4, v6, v4, s[50:51]
    v_cndmask_b32 v6, v6, 0, vcc
    v_mov_b32 v5, 0
    s_cmp_lg_u32 s2, 255
    s_cbranch_scc1 fr_2
    v_mov_b32 v2, 1
    s_waitcnt vmcnt(9)
    s_barrier
    s_mov_b64 exec, 1
    global_store_dword v5, v2, s[66:67] sc1
    s_mov_b64 exec, -1
fr_2:
    v_mov_b32 v140, 0
    v_mov_b32_e64 v141, 0
    v_mov_b32 v142, 0x3f803f80
    v_mov_b32 v143, 0x3f803f80
    v_lshlrev_b32_e64 v144, 3, v0
    v_add_u32 v144, 155648, v144
    ds_write_b64 v144, v[140:141]
    ds_write_b64 v144, v[140:141] offset:512
    ds_write_b64 v144, v[142:143] offset:2560
    ds_write_b64 v144, v[142:143] offset:3072
    v_and_b32 v50, 31, v1
    v_lshrrev_b32 v51, 5, v1
    v_mul_u32_u24 v52, 40, v50
    v_mul_u32_u24 v53, 3200, v51
    v_add_u32 v53, v52, v53
    s_lshl_b32 s25, s24, 3
    s_add_u32 s25, s25, 320
    v_add_u32 v38, s25, v53
    s_mul_i32 s25, s24, 6400
    s_add_u32 s25, s25, 352
    v_add_u32 v39, s25, v53
    s_lshl_b32 s31, s71, 12
    v_lshl_add_u32 v47, v50, 3, s31
    v_bfe_u32 v52, v1, 2, 1
    v_and_b32 v53, 3, v1
    v_lshlrev_b32 v54, 13, v52
    v_lshl_add_u32 v54, v53, 3, v54
    v_add_u32_e64 v48, s31, v54
    v_bfe_u32 v54, v1, 4, 1
    v_lshl_add_u32 v52, v54, 1, v52
    v_mul_u32_u24 v52, 40, v52
    v_add_u32 v52, v52, v53
    v_mul_u32_u24_e64 v52, 40, v52
    v_bfe_u32 v53, v1, 3, 1
    v_cmp_eq_u32 s[82:83], v53, v54
    v_lshl_add_u32 v53, v53, 1, v51
    v_cmp_eq_u32 vcc, 3, v53
    v_mov_b32 v54, s24
    s_nop 0
    v_cndmask_b32 v53, v53, v54, vcc
    v_cndmask_b32 v54, v54, 4, vcc
    v_mul_u32_u24 v53, 6400, v53
    v_lshl_add_u32 v52, v54, 3, v52
    v_add_u32_e64 v52, v52, v53
    v_add_u32 v40, 160, v52
    v_mov_b32 v52, 19584
    v_mov_b32 v53, 128
    v_cndmask_b32 v49, v53, v52, s[78:79]
    v_and_b32 v50, 15, v1
    v_lshrrev_b32 v51, 4, v1
    s_and_b32 s25, s24, 1
    s_and_b32 s26, s24, 2
    s_mul_i32 s27, s25, 3200
    s_mul_i32 s28, s26, 320
    s_add_u32 s27, s27, s28
    s_add_u32 s27, s27, 0
    v_and_b32 v52, 1, v1
    v_mul_u32_u24 v52, 1600, v52
    v_lshrrev_b32 v53, 1, v50
    v_mul_u32_u24_e64 v54, 40, v53
    v_add3_u32 v52, v52, v54, s27
    v_lshl_add_u32 v41, v51, 3, v52
    v_add_u32_e64 v42, 32, v52
    v_bfe_u32 v52, v1, 2, 1
    v_mul_u32_u24 v52, 1600, v52
    v_lshrrev_b32 v54, 3, v1
    v_mul_u32_u24 v54, 40, v54
    v_add3_u32 v52, v52, v54, s27
    v_add_u32 v52, 12800, v52
    v_and_b32 v54, 3, v1
    v_lshl_add_u32 v43, v54, 3, v52
    v_add_u32 v52, 32, v52
    v_cmp_eq_u32 vcc, 0, v54
    v_mov_b32 v54, 158208
    s_nop 0
    v_cndmask_b32 v44, v54, v52, vcc
    v_and_b32 v52, 1, v51
    v_add_u32 v52, s26, v52
    v_lshrrev_b32 v54, 2, v50
    v_lshl_add_u32 v52, v52, 2, v54
    v_and_b32 v53, 1, v53
    v_lshl_add_u32 v52, v53, 4, v52
    v_and_b32 v53, 1, v50
    v_lshl_add_u32 v52, v53, 10, v52
    s_lshl_b32 s30, s70, 1
    s_add_u32 s30, s30, s25
    s_lshl_b32 s29, s30, 3
    s_add_u32 s29, s29, s71
    s_lshl_b32 s29, s29, 13
    v_lshrrev_b32 v53, 1, v51
    v_lshlrev_b32 v53, 15, v53
    v_lshl_add_u32 v53, v52, 4, v53
    v_add_u32_e64 v45, s29, v53
    s_lshl_b32 s29, s30, 2
    s_add_u32 s29, s29, s71
    s_lshl_b32 s29, s29, 12
    s_add_u32 s29, s29, 2097152
    v_lshl_add_u32 v46, v52, 3, s29
    s_or_b32 s29, s26, s72
    s_cmp_eq_u32 s29, 0
    s_cselect_b64 s[90:91], -1, 0
    v_lshlrev_b32 v52, 2, v51
    v_sub_u32 v52, v50, v52
    v_mov_b32 v55, 0xf149f2ca
    v_subrev_u32 v53, 0, v52
    v_cmp_lt_u32 vcc, 7, v53
    s_nop 1
    v_cndmask_b32 v28, 0, v55, vcc
    v_cmp_lt_i32 vcc, -9, v53
    s_nop 1
    v_cndmask_b32 v32, 0, v55, vcc
    v_cmp_le_i32 vcc, 0, v53
    v_mov_b32 v54, 0xffff
    s_nop 0
    v_cndmask_b32 v54, 0, v54, vcc
    v_mov_b32 v36, v54
    v_subrev_u32 v53, 1, v52
    v_cmp_lt_u32 vcc, 7, v53
    s_nop 1
    v_cndmask_b32 v29, 0, v55, vcc
    v_cmp_lt_i32 vcc, -9, v53
    s_nop 1
    v_cndmask_b32 v33, 0, v55, vcc
    v_cmp_le_i32 vcc, 0, v53
    v_mov_b32 v54, 0xffff0000
    s_nop 0
    v_cndmask_b32 v54, 0, v54, vcc
    v_or_b32 v36, v36, v54
    v_subrev_u32 v53, 2, v52
    v_cmp_lt_u32 vcc, 7, v53
    s_nop 1
    v_cndmask_b32 v30, 0, v55, vcc
    v_cmp_lt_i32 vcc, -9, v53
    s_nop 1
    v_cndmask_b32 v34, 0, v55, vcc
    v_cmp_le_i32 vcc, 0, v53
    v_mov_b32 v54, 0xffff
    s_nop 0
    v_cndmask_b32 v54, 0, v54, vcc
    v_mov_b32 v37, v54
    v_subrev_u32 v53, 3, v52
    v_cmp_lt_u32 vcc, 7, v53
    s_nop 1
    v_cndmask_b32 v31, 0, v55, vcc
    v_cmp_lt_i32 vcc, -9, v53
    s_nop 1
    v_cndmask_b32 v35, 0, v55, vcc
    v_cmp_le_i32 vcc, 0, v53
    v_mov_b32 v54, 0xffff0000
    s_nop 0
    v_cndmask_b32 v54, 0, v54, vcc
    v_or_b32 v37, v37, v54
    v_and_b32 v62, 15, v1
    v_lshrrev_b32 v63, 4, v1
    s_and_b32 s25, s74, 3
    s_lshr_b32 s26, s74, 2
    s_lshl_b32 s27, s24, 6
    s_add_u32 s27, s27, s25
    s_lshl_b32 s27, s27, 13
    s_lshl_b32 s28, s26, 9
    s_add_u32 s27, s27, s28
    v_lshl_add_u32 v64, v63, 17, s27
    v_lshl_add_u32 v56, v62, 4, v64
    s_lshl_b32 s27, s24, 5
    s_add_u32 s27, s27, s25
    s_lshl_b32 s27, s27, 12
    s_lshl_b32 s28, s26, 8
    s_add_u32 s27, s27, s28
    s_add_u32 s27, s27, 2097152
    v_lshl_add_u32 v64, v63, 15, s27
    v_lshl_add_u32 v57, v62, 3, v64
    v_lshlrev_b32 v58, 4, v1
    s_lshl_b32 s29, s25, 12
    s_add_u32 s29, s29, s28
    v_lshl_add_u32 v64, v62, 4, s29
    v_lshl_add_u32 v61, v63, 2, v64
    s_mul_i32 s30, s73, 20
    s_lshl_b32 s31, s24, 2
    s_add_u32 s30, s30, s31
    s_lshl_b32 s31, s30, 14
    v_lshl_add_u32 v64, v63, 14, v64
    v_add_u32 v59, s31, v64
    s_lshl_b32 s31, s26, 7
    s_add_u32 s31, s31, s25
    s_mul_i32 s31, s31, 1280
    s_lshl_b32 s30, s30, 3
    s_add_u32 s31, s31, s30
    v_mul_u32_u24 v64, 10240, v62
    v_lshl_add_u32 v64, v63, 3, v64
    v_add_u32 v60, s31, v64
    s_and_b32 s25, s24, 1
    s_lshl_b32 s25, s25, 6
    s_and_b32 s26, s24, 2
    s_add_u32 s25, s25, s26
    s_mul_i32 s25, s25, 1280
    v_lshrrev_b32 v140, 4, v1
    v_and_b32 v141, 15, v1
    v_xor_b32 v141, v140, v141
    v_lshlrev_b32 v141, 4, v141
    v_mul_u32_u24 v142, 5120, v140
    v_add3_u32 v73, v141, v142, s25
    s_and_b32 s25, s24, 1
    s_lshl_b32 s25, s25, 3
    s_add_u32 s25, s25, s26
    s_mul_i32 s25, s25, 1280
    v_add3_u32 v77, v141, v142, s25
    v_lshrrev_b32 v141, 5, v1
    v_and_b32 v140, 3, v1
    v_xor_b32 v142, v140, v141
    v_lshlrev_b32_e64 v142, 4, v142
    v_lshl_add_u32 v142, v140, 8, v142
    v_bfe_u32 v140, v1, 2, 3
    v_mul_u32_u24 v140, 1088, v140
    v_add_u32 v78, v140, v142
    v_and_b32 v140, 1, v1
    v_xor_b32 v142, v140, v141
    v_lshlrev_b32 v142, 4, v142
    v_lshl_add_u32 v142, v140, 8, v142
    v_bfe_u32 v140, v1, 1, 2
    v_mul_u32_u24 v140, 544, v140
    v_add_u32_e64 v142, v140, v142
    v_add_u32 v74, 19392, v73
    v_add_u32 v75, 38784, v73
    v_add_u32 v76, 58176, v73
    v_add_u32 v142, 53760, v142
    v_and_b32 v140, 31, v1
    v_cmp_eq_u32 vcc, 0, v140
    v_cmp_eq_u32 s[82:83], 24, v140
    s_nop 0
    s_or_b64 vcc, vcc, s[82:83]
    v_mov_b32 v140, 155776
    v_mov_b32 v141, 158400
    v_cndmask_b32_e64 v140, v140, v141, vcc
    v_cndmask_b32 v79, v140, v142, s[78:79]
    v_bfe_u32 v201, v1, 3, 2
    v_and_b32 v202, s24, v201
    v_cmp_eq_u32 vcc, 3, v202
    v_lshrrev_b32 v202, 5, v1
    v_lshl_add_u32 v201, v201, 1, v202
    v_and_b32 v202, 7, v1
    v_lshl_add_u32 v201, v201, 3, v202
    v_lshlrev_b32 v200, 4, v201
    v_mov_b32 v201, 1073741824
    v_cndmask_b32 v200, v200, v201, vcc
    s_lshl_b32 s101, s70, 2
    s_add_u32 s101, s101, s24
    s_mul_i32 s101, s101, 40960
    s_add_u32 s101, s101, 0
    s_lshl_b32 s25, s72, 5
    s_add_u32 s25, s25, 0
    s_sub_u32 s26, s25, 4
    s_max_i32 s26, s26, 0
    s_mul_i32 s27, s71, 1280
    s_mul_i32 s99, s25, 5120
    s_mul_i32 s100, s26, 5120
    s_mul_i32 s92, s24, 4352
    s_mul_i32 s93, s24, 544
    s_add_u32 s99, s99, s27
    s_add_u32 s100, s100, s27
    s_mov_b32 s38, 0x10000
    s_mov_b32 s39, 0x1000
    s_cmp_ge_u32 s2, 160
    s_cbranch_scc1 nc_3
    s_waitcnt vmcnt(1)
    s_barrier
    s_nop 0
    ds_read_b64_tr_b16 v[96:97], v111
    ds_read_b64_tr_b16 v[98:99], v111 offset:2560
    ds_read_b64_tr_b16 v[100:101], v112
    ds_read_b64_tr_b16 v[102:103], v112 offset:2560
    ds_read_b64_tr_b16 v[104:105], v113
    ds_read_b64_tr_b16 v[106:107], v113 offset:2560
    s_waitcnt lgkmcnt(4)
    buffer_store_dwordx4 v[96:99], v108, s[16:19], 0 offen sc1
    s_waitcnt lgkmcnt(2)
    buffer_store_dwordx4 v[100:103], v109, s[16:19], 0 offen sc1
    s_waitcnt lgkmcnt(0)
    buffer_store_dwordx4 v[104:107], v110, s[16:19], 0 offen sc1
    global_load_dword v7, v5, s[66:67] sc1
    s_mul_i32 s37, s24, 8704
    s_add_u32 s25, s37, 0
    s_add_u32 s37, s37, 0
    s_mov_b32 m0, s37
    v_and_b32 v199, 31, v1
    v_mul_u32_u24 v199, 272, v199
    v_lshrrev_b32 v215, 5, v1
    v_lshl_add_u32 v199, v215, 4, v199
    v_add_u32 v252, s25, v199
    v_lshlrev_b32 v253, 16, v240
    v_mul_f32 v253, 0x3fb8aa3b, v253
    v_exp_f32 v253, v253
    s_nop 0
    v_cvt_pk_bf16_f32 v253, v253, v253
    v_lshlrev_b32 v253, 16, v253
    v_lshlrev_b32 v199, 16, v232
    v_mul_f32 v199, 0x3fb8aa3b, v199
    v_exp_f32 v199, v199
    v_lshlrev_b32 v255, 16, v233
    v_mul_f32 v255, v255, v253
    v_mul_f32 v255, 0x3e22f983, v255
    v_cvt_pk_bf16_f32 v199, v199, v199
    v_lshlrev_b32 v199, 16, v199
    v_mul_f32 v254, v199, v253
    v_mul_f32 v254, 0xbfb8aa3b, v254
    v_mul_f32 v182, 0x41000000, v254
    v_mul_f32 v185, 0x41000000, v255
    v_mul_f32 v184, 0x43800000, v254
    v_mul_f32 v189, 0x43800000, v255
    v_fract_f32 v185, v185
    v_fract_f32 v188, v255
    v_fract_f32 v189, v189
    v_exp_f32 v182, v182
    v_exp_f32 v183, v254
    v_exp_f32 v184, v184
    v_cos_f32 v186, v185
    v_sin_f32 v187, v185
    v_cos_f32 v180, v188
    v_sin_f32 v181, v188
    v_cos_f32 v190, v189
    v_sin_f32 v191, v189
    s_min_u32 s96, s75, 159
    s_lshl_b32 s96, s96, 2
    s_add_u32 s96, s96, s24
    s_mul_i32 s97, s96, 384
    s_lshl_b32 s96, s96, 1
    v_lshl_add_u32 v2, v1, 1, s97
    v_mov_b32 v241, s96
    global_load_ushort v236, v2, s[52:53] offset:256
    global_load_ushort v237, v2, s[54:55] offset:256
    global_load_ushort v238, v2, s[56:57] offset:256
    global_load_ushort v239, v2, s[58:59] offset:256
    global_load_ushort v241, v241, s[62:63]
    v_lshlrev_b32 v192, 16, v234
    v_lshlrev_b32 v193, 16, v235
    v_add_f32 v199, v253, v253
    v_mul_f32 v192, v192, v199
    v_mul_f32 v193, v193, v199
    v_mul_f32 v186, v186, v182
    v_mul_f32 v187, v187, v182
    v_mul_f32 v180, v180, v183
    v_mul_f32 v181, v181, v183
    v_mul_f32 v190, v190, v184
    v_mul_f32_e64 v191, v191, v184
    v_mov_b32 v242, 0x3f80
    v_cvt_pk_bf16_f32 v243, v186, v187
    v_pk_mul_f32 v[194:195], v[186:187], v[186:187] op_sel:[0,0] op_sel_hi:[0,1]
    v_pk_fma_f32 v[172:173], v[186:187], v[186:187], v[194:195] op_sel:[1,1,0] op_sel_hi:[1,0,1] neg_lo:[0,1,0]
    v_cvt_pk_bf16_f32 v244, v172, v173
    v_pk_mul_f32 v[194:195], v[172:173], v[186:187] op_sel:[0,0] op_sel_hi:[0,1]
    v_pk_fma_f32 v[174:175], v[172:173], v[186:187], v[194:195] op_sel:[1,1,0] op_sel_hi:[1,0,1] neg_lo:[0,1,0]
    v_cvt_pk_bf16_f32 v245, v174, v175
    v_pk_mul_f32 v[194:195], v[174:175], v[186:187] op_sel:[0,0] op_sel_hi:[0,1]
    v_pk_fma_f32 v[172:173], v[174:175], v[186:187], v[194:195] op_sel:[1,1,0] op_sel_hi:[1,0,1] neg_lo:[0,1,0]
    v_cvt_pk_bf16_f32 v246, v172, v173
    v_pk_mul_f32 v[194:195], v[172:173], v[186:187] op_sel:[0,0] op_sel_hi:[0,1]
    v_pk_fma_f32 v[174:175], v[172:173], v[186:187], v[194:195] op_sel:[1,1,0] op_sel_hi:[1,0,1] neg_lo:[0,1,0]
    v_cvt_pk_bf16_f32 v247, v174, v175
    v_pk_mul_f32 v[194:195], v[174:175], v[186:187] op_sel:[0,0] op_sel_hi:[0,1]
    v_pk_fma_f32 v[172:173], v[174:175], v[186:187], v[194:195] op_sel:[1,1,0] op_sel_hi:[1,0,1] neg_lo:[0,1,0]
    v_cvt_pk_bf16_f32 v248, v172, v173
    v_pk_mul_f32 v[194:195], v[172:173], v[186:187] op_sel:[0,0] op_sel_hi:[0,1]
    v_pk_fma_f32 v[174:175], v[172:173], v[186:187], v[194:195] op_sel:[1,1,0] op_sel_hi:[1,0,1] neg_lo:[0,1,0]
    v_cvt_pk_bf16_f32 v249, v174, v175
    v_pk_mul_f32 v[194:195], v[174:175], v[186:187] op_sel:[0,0] op_sel_hi:[0,1]
    v_pk_fma_f32 v[172:173], v[174:175], v[186:187], v[194:195] op_sel:[1,1,0] op_sel_hi:[1,0,1] neg_lo:[0,1,0]
    v_cvt_pk_bf16_f32 v250, v172, v173
    v_pk_mul_f32 v[194:195], v[172:173], v[186:187] op_sel:[0,0] op_sel_hi:[0,1]
    v_pk_fma_f32 v[174:175], v[172:173], v[186:187], v[194:195] op_sel:[1,1,0] op_sel_hi:[1,0,1] neg_lo:[0,1,0]
    v_cvt_pk_bf16_f32 v251, v174, v175
    ds_write_addtid_b32 v242 offset:0
    ds_write_addtid_b32 v243 offset:272
    ds_write_addtid_b32 v244 offset:544
    v_lshrrev_b32 v132, 5, v0
    v_and_b32 v133, 31, v0
    v_mul_u32_u24 v132, 1280, v132
    v_lshl_add_u32 v134, v133, 4, v132
    v_mov_b32 v135, 1073741824
    v_cmp_gt_u32 vcc, 16, v133
    s_mul_i32 s96, s2, 10240
    buffer_load_dwordx4 v[120:123], v134, s[4:7], s96 offen
    v_cndmask_b32_e64 v135, v135, v134, vcc
    buffer_load_dwordx4 v[124:127], v134, s[4:7], s96 offen offset:512
    buffer_load_dwordx4 v[128:131], v135, s[4:7], s96 offen offset:1024
    ds_write_addtid_b32 v245 offset:816
    ds_write_addtid_b32 v246 offset:1088
    ds_write_addtid_b32 v247 offset:1360
    ds_write_addtid_b32 v248 offset:1632
    ds_write_addtid_b32 v249 offset:1904
    ds_write_addtid_b32 v250 offset:2176
    ds_write_addtid_b32 v251 offset:2448
    v_pk_mul_f32 v[194:195], v[174:175], v[186:187] op_sel:[0,0] op_sel_hi:[0,1]
    v_pk_fma_f32 v[172:173], v[174:175], v[186:187], v[194:195] op_sel:[1,1,0] op_sel_hi:[1,0,1] neg_lo:[0,1,0]
    v_cvt_pk_bf16_f32 v242, v172, v173
    v_pk_mul_f32 v[194:195], v[172:173], v[186:187] op_sel:[0,0] op_sel_hi:[0,1]
    v_pk_fma_f32 v[174:175], v[172:173], v[186:187], v[194:195] op_sel:[1,1,0] op_sel_hi:[1,0,1] neg_lo:[0,1,0]
    v_cvt_pk_bf16_f32 v243, v174, v175
    v_pk_mul_f32 v[194:195], v[174:175], v[186:187] op_sel:[0,0] op_sel_hi:[0,1]
    v_pk_fma_f32 v[172:173], v[174:175], v[186:187], v[194:195] op_sel:[1,1,0] op_sel_hi:[1,0,1] neg_lo:[0,1,0]
    v_cvt_pk_bf16_f32 v244, v172, v173
    v_pk_mul_f32 v[194:195], v[172:173], v[186:187] op_sel:[0,0] op_sel_hi:[0,1]
    v_pk_fma_f32 v[174:175], v[172:173], v[186:187], v[194:195] op_sel:[1,1,0] op_sel_hi:[1,0,1] neg_lo:[0,1,0]
    v_cvt_pk_bf16_f32 v245, v174, v175
    v_pk_mul_f32 v[194:195], v[174:175], v[186:187] op_sel:[0,0] op_sel_hi:[0,1]
    v_pk_fma_f32 v[172:173], v[174:175], v[186:187], v[194:195] op_sel:[1,1,0] op_sel_hi:[1,0,1] neg_lo:[0,1,0]
    v_cvt_pk_bf16_f32 v246, v172, v173
    v_pk_mul_f32 v[194:195], v[172:173], v[186:187] op_sel:[0,0] op_sel_hi:[0,1]
    v_pk_fma_f32 v[174:175], v[172:173], v[186:187], v[194:195] op_sel:[1,1,0] op_sel_hi:[1,0,1] neg_lo:[0,1,0]
    v_cvt_pk_bf16_f32 v247, v174, v175
    v_pk_mul_f32 v[194:195], v[174:175], v[186:187] op_sel:[0,0] op_sel_hi:[0,1]
    v_pk_fma_f32 v[172:173], v[174:175], v[186:187], v[194:195] op_sel:[1,1,0] op_sel_hi:[1,0,1] neg_lo:[0,1,0]
    v_cvt_pk_bf16_f32 v248, v172, v173
    v_pk_mul_f32 v[194:195], v[172:173], v[186:187] op_sel:[0,0] op_sel_hi:[0,1]
    v_pk_fma_f32 v[174:175], v[172:173], v[186:187], v[194:195] op_sel:[1,1,0] op_sel_hi:[1,0,1] neg_lo:[0,1,0]
    v_cvt_pk_bf16_f32 v249, v174, v175
    v_pk_mul_f32 v[194:195], v[174:175], v[186:187] op_sel:[0,0] op_sel_hi:[0,1]
    v_pk_fma_f32 v[172:173], v[174:175], v[186:187], v[194:195] op_sel:[1,1,0] op_sel_hi:[1,0,1] neg_lo:[0,1,0]
    v_cvt_pk_bf16_f32 v250, v172, v173
    v_pk_mul_f32 v[194:195], v[172:173], v[186:187] op_sel:[0,0] op_sel_hi:[0,1]
    v_pk_fma_f32 v[174:175], v[172:173], v[186:187], v[194:195] op_sel:[1,1,0] op_sel_hi:[1,0,1] neg_lo:[0,1,0]
    v_cvt_pk_bf16_f32 v251, v174, v175
    ds_write_addtid_b32 v242 offset:2720
    ds_write_addtid_b32 v243 offset:2992
    ds_write_addtid_b32 v244 offset:3264
    v_mov_b32 v140, 1073741824
    v_lshlrev_b32 v141, 2, v0
    v_cmp_gt_u32 vcc, 64, v0
    s_nop 1
    v_cndmask_b32 v141, v140, v141, vcc
    v_mov_b32_e64 v140, 0
    s_lshl_b32 s97, s2, 8
    s_add_u32 s97, s97, 3473408
    buffer_store_dword v140, v141, s[16:19], s97 offen sc1
    ds_write_addtid_b32 v245 offset:3536
    ds_write_addtid_b32 v246 offset:3808
    ds_write_addtid_b32 v247 offset:4080
    ds_write_addtid_b32 v248 offset:4352
    ds_write_addtid_b32 v249 offset:4624
    ds_write_addtid_b32 v250 offset:4896
    ds_write_addtid_b32 v251 offset:5168
    v_pk_mul_f32 v[194:195], v[174:175], v[186:187] op_sel:[0,0] op_sel_hi:[0,1]
    v_pk_fma_f32 v[172:173], v[174:175], v[186:187], v[194:195] op_sel:[1,1,0] op_sel_hi:[1,0,1] neg_lo:[0,1,0]
    v_cvt_pk_bf16_f32 v242, v172, v173
    v_pk_mul_f32 v[194:195], v[172:173], v[186:187] op_sel:[0,0] op_sel_hi:[0,1]
    v_pk_fma_f32 v[174:175], v[172:173], v[186:187], v[194:195] op_sel:[1,1,0] op_sel_hi:[1,0,1] neg_lo:[0,1,0]
    v_cvt_pk_bf16_f32 v243, v174, v175
    v_pk_mul_f32 v[194:195], v[174:175], v[186:187] op_sel:[0,0] op_sel_hi:[0,1]
    v_pk_fma_f32 v[172:173], v[174:175], v[186:187], v[194:195] op_sel:[1,1,0] op_sel_hi:[1,0,1] neg_lo:[0,1,0]
    v_cvt_pk_bf16_f32 v244, v172, v173
    v_pk_mul_f32 v[194:195], v[172:173], v[186:187] op_sel:[0,0] op_sel_hi:[0,1]
    v_pk_fma_f32 v[174:175], v[172:173], v[186:187], v[194:195] op_sel:[1,1,0] op_sel_hi:[1,0,1] neg_lo:[0,1,0]
    v_cvt_pk_bf16_f32 v245, v174, v175
    v_pk_mul_f32 v[194:195], v[174:175], v[186:187] op_sel:[0,0] op_sel_hi:[0,1]
    v_pk_fma_f32 v[172:173], v[174:175], v[186:187], v[194:195] op_sel:[1,1,0] op_sel_hi:[1,0,1] neg_lo:[0,1,0]
    v_cvt_pk_bf16_f32 v246, v172, v173
    v_pk_mul_f32 v[194:195], v[172:173], v[186:187] op_sel:[0,0] op_sel_hi:[0,1]
    v_pk_fma_f32 v[174:175], v[172:173], v[186:187], v[194:195] op_sel:[1,1,0] op_sel_hi:[1,0,1] neg_lo:[0,1,0]
    v_cvt_pk_bf16_f32 v247, v174, v175
    v_pk_mul_f32 v[194:195], v[174:175], v[186:187] op_sel:[0,0] op_sel_hi:[0,1]
    v_pk_fma_f32 v[172:173], v[174:175], v[186:187], v[194:195] op_sel:[1,1,0] op_sel_hi:[1,0,1] neg_lo:[0,1,0]
    v_cvt_pk_bf16_f32 v248, v172, v173
    v_pk_mul_f32 v[194:195], v[172:173], v[186:187] op_sel:[0,0] op_sel_hi:[0,1]
    v_pk_fma_f32 v[174:175], v[172:173], v[186:187], v[194:195] op_sel:[1,1,0] op_sel_hi:[1,0,1] neg_lo:[0,1,0]
    v_cvt_pk_bf16_f32 v249, v174, v175
    v_pk_mul_f32 v[194:195], v[174:175], v[186:187] op_sel:[0,0] op_sel_hi:[0,1]
    v_pk_fma_f32 v[172:173], v[174:175], v[186:187], v[194:195] op_sel:[1,1,0] op_sel_hi:[1,0,1] neg_lo:[0,1,0]
    v_cvt_pk_bf16_f32 v250, v172, v173
    v_pk_mul_f32 v[194:195], v[172:173], v[186:187] op_sel:[0,0] op_sel_hi:[0,1]
    v_pk_fma_f32 v[174:175], v[172:173], v[186:187], v[194:195] op_sel:[1,1,0] op_sel_hi:[1,0,1] neg_lo:[0,1,0]
    v_cvt_pk_bf16_f32 v251, v174, v175
    ds_write_addtid_b32 v242 offset:5440
    ds_write_addtid_b32 v243 offset:5712
    ds_write_addtid_b32 v244 offset:5984
    v_mov_b32 v142, 1073741824
    v_lshlrev_b32 v143, 2, v0
    v_cmp_gt_u32 vcc, 16, v0
    s_nop 1
    v_cndmask_b32 v143, v142, v143, vcc
    v_mov_b32_e64 v142, -1
    s_lshl_b32 s97, s2, 6
    s_add_u32 s97, s97, 3457024
    buffer_store_dword v142, v143, s[16:19], s97 offen sc1
    ds_write_addtid_b32 v245 offset:6256
    ds_write_addtid_b32 v246 offset:6528
    ds_write_addtid_b32 v247 offset:6800
    ds_write_addtid_b32 v248 offset:7072
    ds_write_addtid_b32 v249 offset:7344
    ds_write_addtid_b32 v250 offset:7616
    ds_write_addtid_b32 v251 offset:7888
    v_pk_mul_f32 v[194:195], v[174:175], v[186:187] op_sel:[0,0] op_sel_hi:[0,1]
    v_pk_fma_f32 v[172:173], v[174:175], v[186:187], v[194:195] op_sel:[1,1,0] op_sel_hi:[1,0,1] neg_lo:[0,1,0]
    v_cvt_pk_bf16_f32 v242, v172, v173
    v_pk_mul_f32 v[194:195], v[172:173], v[186:187] op_sel:[0,0] op_sel_hi:[0,1]
    v_pk_fma_f32 v[174:175], v[172:173], v[186:187], v[194:195] op_sel:[1,1,0] op_sel_hi:[1,0,1] neg_lo:[0,1,0]
    v_cvt_pk_bf16_f32 v243, v174, v175
    ds_write_addtid_b32 v242 offset:8160
    ds_write_addtid_b32 v243 offset:8432
    ds_read_b128 a[160:163], v252 offset:0
    ds_read_b128 a[164:167], v252 offset:32
    ds_read_b128 a[168:171], v252 offset:64
    ds_read_b128 a[172:175], v252 offset:96
    ds_read_b128 a[176:179], v252 offset:128
    ds_read_b128 a[180:183], v252 offset:160
    ds_read_b128 a[184:187], v252 offset:192
    ds_read_b128 a[188:191], v252 offset:224
    v_pk_mul_f32 v[194:195], v[180:181], v[180:181] op_sel:[0,0] op_sel_hi:[0,1]
    v_pk_fma_f32 v[182:183], v[180:181], v[180:181], v[194:195] op_sel:[1,1,0] op_sel_hi:[1,0,1] neg_lo:[0,1,0]
    v_pk_mul_f32 v[194:195], v[182:183], v[182:183] op_sel:[0,0] op_sel_hi:[0,1]
    v_pk_fma_f32 v[184:185], v[182:183], v[182:183], v[194:195] op_sel:[1,1,0] op_sel_hi:[1,0,1] neg_lo:[0,1,0]
    v_cvt_pk_bf16_f32 v242, v192, -v193
    v_pk_mul_f32 v[194:195], v[192:193], v[180:181] op_sel:[0,0] op_sel_hi:[0,1]
    v_pk_fma_f32 v[174:175], v[192:193], v[180:181], v[194:195] op_sel:[1,1,0] op_sel_hi:[1,0,1] neg_lo:[0,1,0]
    v_cvt_pk_bf16_f32 v243, v174, -v175
    v_pk_mul_f32 v[194:195], v[174:175], v[180:181] op_sel:[0,0] op_sel_hi:[0,1]
    v_pk_fma_f32 v[172:173], v[174:175], v[180:181], v[194:195] op_sel:[1,1,0] op_sel_hi:[1,0,1] neg_lo:[0,1,0]
    v_cvt_pk_bf16_f32 v244, v172, -v173
    v_pk_mul_f32 v[194:195], v[172:173], v[180:181] op_sel:[0,0] op_sel_hi:[0,1]
    v_pk_fma_f32 v[174:175], v[172:173], v[180:181], v[194:195] op_sel:[1,1,0] op_sel_hi:[1,0,1] neg_lo:[0,1,0]
    v_cvt_pk_bf16_f32 v245, v174, -v175
    v_pk_mul_f32 v[194:195], v[174:175], v[180:181] op_sel:[0,0] op_sel_hi:[0,1]
    v_pk_fma_f32 v[172:173], v[174:175], v[180:181], v[194:195] op_sel:[1,1,0] op_sel_hi:[1,0,1] neg_lo:[0,1,0]
    v_cvt_pk_bf16_f32 v246, v172, -v173
    s_waitcnt vmcnt(11)
    s_waitcnt vmcnt(10)
    v_cmp_gt_u32 vcc, 1, v7
    s_nop 0
    s_and_b64 vcc, vcc, s[50:51]
    s_and_b64 vcc, vcc, 1
    s_cbranch_scc1 ps_5
pc_7:
    s_barrier
    v_lshlrev_b32 v2, 3, v4
    v_mov_b32 v5, 1
    v_cndmask_b32 v2, v4, v2, s[50:51]
    buffer_atomic_add v5, v2, s[16:19], s86 offen offset:0 sc1
    v_pk_mul_f32 v[194:195], v[172:173], v[180:181] op_sel:[0,0] op_sel_hi:[0,1]
    v_pk_fma_f32 v[174:175], v[172:173], v[180:181], v[194:195] op_sel:[1,1,0] op_sel_hi:[1,0,1] neg_lo:[0,1,0]
    v_cvt_pk_bf16_f32 v247, v174, -v175
    v_pk_mul_f32 v[194:195], v[174:175], v[180:181] op_sel:[0,0] op_sel_hi:[0,1]
    v_pk_fma_f32 v[172:173], v[174:175], v[180:181], v[194:195] op_sel:[1,1,0] op_sel_hi:[1,0,1] neg_lo:[0,1,0]
    v_cvt_pk_bf16_f32 v248, v172, -v173
    v_pk_mul_f32 v[194:195], v[172:173], v[180:181] op_sel:[0,0] op_sel_hi:[0,1]
    v_pk_fma_f32 v[174:175], v[172:173], v[180:181], v[194:195] op_sel:[1,1,0] op_sel_hi:[1,0,1] neg_lo:[0,1,0]
    v_cvt_pk_bf16_f32 v249, v174, -v175
    v_pk_mul_f32 v[194:195], v[192:193], v[190:191] op_sel:[0,0] op_sel_hi:[0,1]
    v_pk_fma_f32 v[176:177], v[192:193], v[190:191], v[194:195] op_sel:[1,1,0] op_sel_hi:[1,0,1] neg_lo:[0,1,0]
    v_cvt_pk_bf16_f32 v250, v176, -v177
    v_pk_mul_f32 v[194:195], v[176:177], v[182:183] op_sel:[0,0] op_sel_hi:[0,1]
    v_pk_fma_f32 v[174:175], v[176:177], v[182:183], v[194:195] op_sel:[1,1,0] op_sel_hi:[1,0,1] neg_lo:[0,1,0]
    v_cvt_pk_bf16_f32 v251, v174, -v175
    ds_write_addtid_b32 v242 offset:0
    ds_write_addtid_b32 v243 offset:272
    ds_write_addtid_b32 v244 offset:544
    ds_write_addtid_b32 v245 offset:816
    ds_write_addtid_b32 v246 offset:1088
    ds_write_addtid_b32 v247 offset:1360
    ds_write_addtid_b32 v248 offset:1632
    ds_write_addtid_b32 v249 offset:1904
    ds_write_addtid_b32 v250 offset:2176
    ds_write_addtid_b32 v251 offset:2448
    v_pk_mul_f32 v[194:195], v[174:175], v[182:183] op_sel:[0,0] op_sel_hi:[0,1]
    v_pk_fma_f32 v[172:173], v[174:175], v[182:183], v[194:195] op_sel:[1,1,0] op_sel_hi:[1,0,1] neg_lo:[0,1,0]
    v_cvt_pk_bf16_f32 v242, v172, -v173
    v_pk_mul_f32 v[194:195], v[172:173], v[182:183] op_sel:[0,0] op_sel_hi:[0,1]
    v_pk_fma_f32 v[174:175], v[172:173], v[182:183], v[194:195] op_sel:[1,1,0] op_sel_hi:[1,0,1] neg_lo:[0,1,0]
    v_cvt_pk_bf16_f32 v243, v174, -v175
    v_pk_mul_f32 v[194:195], v[174:175], v[182:183] op_sel:[0,0] op_sel_hi:[0,1]
    v_pk_fma_f32 v[172:173], v[174:175], v[182:183], v[194:195] op_sel:[1,1,0] op_sel_hi:[1,0,1] neg_lo:[0,1,0]
    v_cvt_pk_bf16_f32 v244, v172, -v173
    v_pk_mul_f32 v[194:195], v[176:177], v[190:191] op_sel:[0,0] op_sel_hi:[0,1]
    v_pk_fma_f32 v[178:179], v[176:177], v[190:191], v[194:195] op_sel:[1,1,0] op_sel_hi:[1,0,1] neg_lo:[0,1,0]
    v_mov_b32 v144, -1
    v_mov_b32 v145, -1
    v_mov_b32 v146, -1
    v_mov_b32 v147, -1
    v_lshlrev_b32 v148, 4, v0
    s_sub_u32 s88, s2, 0
    s_mul_i32 s88, s88, 20480
    s_min_u32 s88, s88, 5222400
    s_add_u32 s88, s88, 4194304
    buffer_store_dwordx4 v[144:147], v148, s[16:19], s88 offen sc1
    v_cvt_pk_bf16_f32 v245, v178, -v179
    v_pk_mul_f32 v[194:195], v[178:179], v[184:185] op_sel:[0,0] op_sel_hi:[0,1]
    v_pk_fma_f32 v[174:175], v[178:179], v[184:185], v[194:195] op_sel:[1,1,0] op_sel_hi:[1,0,1] neg_lo:[0,1,0]
    v_cvt_pk_bf16_f32 v246, v174, -v175
    v_pk_mul_f32 v[194:195], v[174:175], v[184:185] op_sel:[0,0] op_sel_hi:[0,1]
    v_pk_fma_f32 v[172:173], v[174:175], v[184:185], v[194:195] op_sel:[1,1,0] op_sel_hi:[1,0,1] neg_lo:[0,1,0]
    v_cvt_pk_bf16_f32 v247, v172, -v173
    v_pk_mul_f32 v[194:195], v[178:179], v[190:191] op_sel:[0,0] op_sel_hi:[0,1]
    v_pk_fma_f32 v[176:177], v[178:179], v[190:191], v[194:195] op_sel:[1,1,0] op_sel_hi:[1,0,1] neg_lo:[0,1,0]
    v_cvt_pk_bf16_f32 v248, v176, -v177
    v_pk_mul_f32 v[194:195], v[176:177], v[184:185] op_sel:[0,0] op_sel_hi:[0,1]
    v_pk_fma_f32 v[174:175], v[176:177], v[184:185], v[194:195] op_sel:[1,1,0] op_sel_hi:[1,0,1] neg_lo:[0,1,0]
    v_cvt_pk_bf16_f32 v249, v174, -v175
    v_pk_mul_f32 v[194:195], v[174:175], v[184:185] op_sel:[0,0] op_sel_hi:[0,1]
    v_pk_fma_f32 v[172:173], v[174:175], v[184:185], v[194:195] op_sel:[1,1,0] op_sel_hi:[1,0,1] neg_lo:[0,1,0]
    v_cvt_pk_bf16_f32 v250, v172, -v173
    v_pk_mul_f32 v[194:195], v[176:177], v[190:191] op_sel:[0,0] op_sel_hi:[0,1]
    v_pk_fma_f32 v[178:179], v[176:177], v[190:191], v[194:195] op_sel:[1,1,0] op_sel_hi:[1,0,1] neg_lo:[0,1,0]
    v_cvt_pk_bf16_f32 v251, v178, -v179
    ds_write_addtid_b32 v242 offset:2720
    ds_write_addtid_b32 v242 offset:3264
    ds_write_addtid_b32 v243 offset:3536
    ds_write_addtid_b32 v244 offset:3808
    ds_write_addtid_b32 v245 offset:4352
    ds_write_addtid_b32 v246 offset:4624
    ds_write_addtid_b32 v247 offset:4896
    ds_write_addtid_b32 v248 offset:5440
    ds_write_addtid_b32 v249 offset:5712
    ds_write_addtid_b32 v250 offset:5984
    ds_write_addtid_b32 v251 offset:6528
    v_pk_mul_f32 v[194:195], v[178:179], v[186:187] op_sel:[0,0] op_sel_hi:[0,1]
    v_pk_fma_f32 v[174:175], v[178:179], v[186:187], v[194:195] op_sel:[1,1,0] op_sel_hi:[1,0,1] neg_lo:[0,1,0]
    v_cvt_pk_bf16_f32 v242, v174, -v175
    v_pk_mul_f32 v[194:195], v[178:179], v[190:191] op_sel:[0,0] op_sel_hi:[0,1]
    v_pk_fma_f32 v[176:177], v[178:179], v[190:191], v[194:195] op_sel:[1,1,0] op_sel_hi:[1,0,1] neg_lo:[0,1,0]
    v_cvt_pk_bf16_f32 v243, v176, -v177
    s_add_u32 s88, s88, 4096
    buffer_store_dwordx4 v[144:147], v148, s[16:19], s88 offen sc1
    v_pk_mul_f32 v[194:195], v[176:177], v[186:187] op_sel:[0,0] op_sel_hi:[0,1]
    v_pk_fma_f32 v[174:175], v[176:177], v[186:187], v[194:195] op_sel:[1,1,0] op_sel_hi:[1,0,1] neg_lo:[0,1,0]
    v_cvt_pk_bf16_f32 v244, v174, -v175
    v_pk_mul_f32 v[194:195], v[176:177], v[190:191] op_sel:[0,0] op_sel_hi:[0,1]
    v_pk_fma_f32 v[178:179], v[176:177], v[190:191], v[194:195] op_sel:[1,1,0] op_sel_hi:[1,0,1] neg_lo:[0,1,0]
    v_cvt_pk_bf16_f32 v245, v178, -v179
    v_pk_mul_f32 v[194:195], v[178:179], v[186:187] op_sel:[0,0] op_sel_hi:[0,1]
    v_pk_fma_f32 v[174:175], v[178:179], v[186:187], v[194:195] op_sel:[1,1,0] op_sel_hi:[1,0,1] neg_lo:[0,1,0]
    v_cvt_pk_bf16_f32 v246, v174, -v175
    v_pk_mul_f32 v[194:195], v[178:179], v[190:191] op_sel:[0,0] op_sel_hi:[0,1]
    v_pk_fma_f32 v[176:177], v[178:179], v[190:191], v[194:195] op_sel:[1,1,0] op_sel_hi:[1,0,1] neg_lo:[0,1,0]
    v_cvt_pk_bf16_f32 v247, v176, -v177
    v_pk_mul_f32 v[194:195], v[176:177], v[186:187] op_sel:[0,0] op_sel_hi:[0,1]
    v_pk_fma_f32 v[174:175], v[176:177], v[186:187], v[194:195] op_sel:[1,1,0] op_sel_hi:[1,0,1] neg_lo:[0,1,0]
    v_cvt_pk_bf16_f32 v248, v174, -v175
    ds_write_addtid_b32 v242 offset:6800
    ds_write_addtid_b32 v243 offset:7072
    ds_write_addtid_b32 v244 offset:7344
    ds_write_addtid_b32 v245 offset:7616
    ds_write_addtid_b32 v246 offset:7888
    ds_write_addtid_b32 v247 offset:8160
    ds_write_addtid_b32 v248 offset:8432
    ds_read_b128 a[192:195], v252 offset:0
    ds_read_b128 a[196:199], v252 offset:32
    ds_read_b128 a[200:203], v252 offset:64
    ds_read_b128 a[204:207], v252 offset:96
    ds_read_b128 a[208:211], v252 offset:128
    ds_read_b128 a[212:215], v252 offset:160
    ds_read_b128 a[216:219], v252 offset:192
    ds_read_b128 a[220:223], v252 offset:224
    v_and_b32 v199, 0xffff0000, v232
    v_mul_f32 v199, 0x3fb8aa3b, v199
    v_exp_f32 v199, v199
    v_and_b32 v255, 0xffff0000, v233
    v_mul_f32 v255, v255, v253
    v_mul_f32_e64 v255, 0x3e22f983, v255
    s_add_u32 s88, s88, 4096
    buffer_store_dwordx4 v[144:147], v148, s[16:19], s88 offen sc1
    v_cvt_pk_bf16_f32 v199, v199, v199
    v_lshlrev_b32 v199, 16, v199
    v_mul_f32 v254, v199, v253
    v_mul_f32 v254, 0xbfb8aa3b, v254
    s_waitcnt lgkmcnt(7)
    v_mfma_f32_32x32x16_bf16 v[216:231], a[192:195], a[160:163], 0
    v_mul_f32 v182, 0x41000000, v254
    v_mul_f32 v185, 0x41000000, v255
    v_mul_f32 v184, 0x43800000, v254
    v_mul_f32 v189, 0x43800000, v255
    s_waitcnt lgkmcnt(6)
    v_mfma_f32_32x32x16_bf16 v[216:231], a[196:199], a[164:167], v[216:231]
    v_fract_f32 v185, v185
    v_fract_f32 v188, v255
    v_fract_f32 v189, v189
    v_exp_f32 v182, v182
    s_waitcnt lgkmcnt(5)
    v_mfma_f32_32x32x16_bf16 v[216:231], a[200:203], a[168:171], v[216:231]
    v_exp_f32 v183, v254
    v_exp_f32 v184, v184
    v_cos_f32 v186, v185
    v_sin_f32 v187, v185
    s_waitcnt lgkmcnt(4)
    v_mfma_f32_32x32x16_bf16 v[216:231], a[204:207], a[172:175], v[216:231]
    v_cos_f32 v180, v188
    v_sin_f32 v181, v188
    v_cos_f32 v190, v189
    v_sin_f32_e64 v191, v189
    s_waitcnt lgkmcnt(3)
    v_mfma_f32_32x32x16_bf16 v[216:231], a[208:211], a[176:179], v[216:231]
    v_and_b32 v192, 0xffff0000, v234
    v_and_b32 v193, 0xffff0000, v235
    v_add_f32 v199, v253, v253
    v_mul_f32 v192, v192, v199
    s_waitcnt lgkmcnt(2)
    v_mfma_f32_32x32x16_bf16 v[216:231], a[212:215], a[180:183], v[216:231]
    v_mul_f32 v193, v193, v199
    v_mul_f32 v186, v186, v182
    v_mul_f32 v187, v187, v182
    v_mul_f32 v180, v180, v183
    s_waitcnt lgkmcnt(1)
    v_mfma_f32_32x32x16_bf16 v[216:231], a[216:219], a[184:187], v[216:231]
    v_mul_f32_e64 v181, v181, v183
    s_add_u32 s88, s88, 4096
    buffer_store_dwordx4 v[144:147], v148, s[16:19], s88 offen sc1
    v_mul_f32 v190, v190, v184
    v_mul_f32_e64 v191, v191, v184
    s_waitcnt lgkmcnt(0)
    v_mfma_f32_32x32x16_bf16 v[216:231], a[220:223], a[188:191], v[216:231]
    v_mov_b32 v242, 0x3f80
    v_cvt_pk_bf16_f32 v243, v186, v187
    v_pk_mul_f32 v[194:195], v[186:187], v[186:187] op_sel:[0,0] op_sel_hi:[0,1]
    v_pk_fma_f32 v[172:173], v[186:187], v[186:187], v[194:195] op_sel:[1,1,0] op_sel_hi:[1,0,1] neg_lo:[0,1,0]
    v_cvt_pk_bf16_f32 v244, v172, v173
    v_pk_mul_f32 v[194:195], v[172:173], v[186:187] op_sel:[0,0] op_sel_hi:[0,1]
    v_pk_fma_f32 v[174:175], v[172:173], v[186:187], v[194:195] op_sel:[1,1,0] op_sel_hi:[1,0,1] neg_lo:[0,1,0]
    v_cvt_pk_bf16_f32 v245, v174, v175
    v_pk_mul_f32 v[194:195], v[174:175], v[186:187] op_sel:[0,0] op_sel_hi:[0,1]
    v_pk_fma_f32 v[172:173], v[174:175], v[186:187], v[194:195] op_sel:[1,1,0] op_sel_hi:[1,0,1] neg_lo:[0,1,0]
    v_cvt_pk_bf16_f32 v246, v172, v173
    v_pk_mul_f32 v[194:195], v[172:173], v[186:187] op_sel:[0,0] op_sel_hi:[0,1]
    v_pk_fma_f32 v[174:175], v[172:173], v[186:187], v[194:195] op_sel:[1,1,0] op_sel_hi:[1,0,1] neg_lo:[0,1,0]
    v_cvt_pk_bf16_f32 v247, v174, v175
    v_pk_mul_f32 v[194:195], v[174:175], v[186:187] op_sel:[0,0] op_sel_hi:[0,1]
    v_pk_fma_f32 v[172:173], v[174:175], v[186:187], v[194:195] op_sel:[1,1,0] op_sel_hi:[1,0,1] neg_lo:[0,1,0]
    v_cvt_pk_bf16_f32 v248, v172, v173
    v_pk_mul_f32 v[194:195], v[172:173], v[186:187] op_sel:[0,0] op_sel_hi:[0,1]
    v_pk_fma_f32 v[174:175], v[172:173], v[186:187], v[194:195] op_sel:[1,1,0] op_sel_hi:[1,0,1] neg_lo:[0,1,0]
    v_cvt_pk_bf16_f32 v249, v174, v175
    v_pk_mul_f32 v[194:195], v[174:175], v[186:187] op_sel:[0,0] op_sel_hi:[0,1]
    v_pk_fma_f32 v[172:173], v[174:175], v[186:187], v[194:195] op_sel:[1,1,0] op_sel_hi:[1,0,1] neg_lo:[0,1,0]
    v_cvt_pk_bf16_f32 v250, v172, v173
    v_pk_mul_f32 v[194:195], v[172:173], v[186:187] op_sel:[0,0] op_sel_hi:[0,1]
    v_pk_fma_f32 v[174:175], v[172:173], v[186:187], v[194:195] op_sel:[1,1,0] op_sel_hi:[1,0,1] neg_lo:[0,1,0]
    v_cvt_pk_bf16_f32 v251, v174, v175
    ds_write_addtid_b32 v242 offset:0
    ds_write_addtid_b32 v243 offset:272
    ds_write_addtid_b32 v244 offset:544
    ds_write_addtid_b32 v245 offset:816
    ds_write_addtid_b32 v246 offset:1088
    ds_write_addtid_b32 v247 offset:1360
    ds_write_addtid_b32 v248 offset:1632
    s_add_u32 s88, s88, 4096
    buffer_store_dwordx4 v[144:147], v148, s[16:19], s88 offen sc1
    ds_write_addtid_b32 v249 offset:1904
    ds_write_addtid_b32 v250 offset:2176
    ds_write_addtid_b32 v251 offset:2448
    v_pk_mul_f32 v[194:195], v[174:175], v[186:187] op_sel:[0,0] op_sel_hi:[0,1]
    v_pk_fma_f32 v[172:173], v[174:175], v[186:187], v[194:195] op_sel:[1,1,0] op_sel_hi:[1,0,1] neg_lo:[0,1,0]
    v_cvt_pk_bf16_f32 v242, v172, v173
    v_pk_mul_f32 v[194:195], v[172:173], v[186:187] op_sel:[0,0] op_sel_hi:[0,1]
    v_pk_fma_f32 v[174:175], v[172:173], v[186:187], v[194:195] op_sel:[1,1,0] op_sel_hi:[1,0,1] neg_lo:[0,1,0]
    v_cvt_pk_bf16_f32 v243, v174, v175
    v_pk_mul_f32 v[194:195], v[174:175], v[186:187] op_sel:[0,0] op_sel_hi:[0,1]
    v_pk_fma_f32 v[172:173], v[174:175], v[186:187], v[194:195] op_sel:[1,1,0] op_sel_hi:[1,0,1] neg_lo:[0,1,0]
    v_cvt_pk_bf16_f32 v244, v172, v173
    v_pk_mul_f32 v[194:195], v[172:173], v[186:187] op_sel:[0,0] op_sel_hi:[0,1]
    v_pk_fma_f32 v[174:175], v[172:173], v[186:187], v[194:195] op_sel:[1,1,0] op_sel_hi:[1,0,1] neg_lo:[0,1,0]
    v_cvt_pk_bf16_f32 v245, v174, v175
    v_pk_mul_f32 v[194:195], v[174:175], v[186:187] op_sel:[0,0] op_sel_hi:[0,1]
    v_pk_fma_f32 v[172:173], v[174:175], v[186:187], v[194:195] op_sel:[1,1,0] op_sel_hi:[1,0,1] neg_lo:[0,1,0]
    v_cvt_pk_bf16_f32 v246, v172, v173
    v_pk_mul_f32 v[194:195], v[172:173], v[186:187] op_sel:[0,0] op_sel_hi:[0,1]
    v_pk_fma_f32 v[174:175], v[172:173], v[186:187], v[194:195] op_sel:[1,1,0] op_sel_hi:[1,0,1] neg_lo:[0,1,0]
    v_cvt_pk_bf16_f32 v247, v174, v175
    v_pk_mul_f32 v[194:195], v[174:175], v[186:187] op_sel:[0,0] op_sel_hi:[0,1]
    v_pk_fma_f32 v[172:173], v[174:175], v[186:187], v[194:195] op_sel:[1,1,0] op_sel_hi:[1,0,1] neg_lo:[0,1,0]
    v_cvt_pk_bf16_f32 v248, v172, v173
    v_pk_mul_f32 v[194:195], v[172:173], v[186:187] op_sel:[0,0] op_sel_hi:[0,1]
    v_pk_fma_f32 v[174:175], v[172:173], v[186:187], v[194:195] op_sel:[1,1,0] op_sel_hi:[1,0,1] neg_lo:[0,1,0]
    v_cvt_pk_bf16_f32 v249, v174, v175
    v_pk_mul_f32 v[194:195], v[174:175], v[186:187] op_sel:[0,0] op_sel_hi:[0,1]
    v_pk_fma_f32 v[172:173], v[174:175], v[186:187], v[194:195] op_sel:[1,1,0] op_sel_hi:[1,0,1] neg_lo:[0,1,0]
    v_cvt_pk_bf16_f32 v250, v172, v173
    v_pk_mul_f32 v[194:195], v[172:173], v[186:187] op_sel:[0,0] op_sel_hi:[0,1]
    v_pk_fma_f32 v[174:175], v[172:173], v[186:187], v[194:195] op_sel:[1,1,0] op_sel_hi:[1,0,1] neg_lo:[0,1,0]
    v_cvt_pk_bf16_f32 v251, v174, v175
    ds_write_addtid_b32 v242 offset:2720
    ds_write_addtid_b32 v243 offset:2992
    ds_write_addtid_b32 v244 offset:3264
    ds_write_addtid_b32 v245 offset:3536
    ds_write_addtid_b32 v246 offset:3808
    ds_write_addtid_b32 v247 offset:4080
    ds_write_addtid_b32 v248 offset:4352
    v_mov_b32 v134, 0x3f803f80
    v_mov_b32 v132, 0
    v_mov_b32 v133, 0
    s_waitcnt vmcnt(10)
    v_dot2c_f32_bf16 v132, v120, v134
    v_dot2c_f32_bf16 v133, v120, v120
    v_dot2c_f32_bf16 v132, v121, v134
    v_dot2c_f32_bf16 v133, v121, v121
    v_dot2c_f32_bf16 v132, v122, v134
    v_dot2c_f32_bf16 v133, v122, v122
    v_dot2c_f32_bf16 v132, v123, v134
    v_dot2c_f32_bf16 v133, v123, v123
    s_waitcnt vmcnt(9)
    v_dot2c_f32_bf16 v132, v124, v134
    v_dot2c_f32_bf16 v133, v124, v124
    v_dot2c_f32_bf16 v132, v125, v134
    v_dot2c_f32_bf16 v133, v125, v125
    v_dot2c_f32_bf16 v132, v126, v134
    v_dot2c_f32_bf16 v133, v126, v126
    v_dot2c_f32_bf16 v132, v127, v134
    v_dot2c_f32_bf16 v133, v127, v127
    s_waitcnt vmcnt(8)
    v_dot2c_f32_bf16 v132, v128, v134
    v_dot2c_f32_bf16 v133, v128, v128
    v_dot2c_f32_bf16 v132, v129, v134
    v_dot2c_f32_bf16 v133, v129, v129
    v_dot2c_f32_bf16 v132, v130, v134
    v_dot2c_f32_bf16 v133, v130, v130
    v_dot2c_f32_bf16 v132, v131, v134
    v_dot2c_f32_bf16 v133, v131, v131
    v_lshrrev_b32 v135, 5, v0
    v_and_b32 v121, 3, v135
    v_lshrrev_b32 v135, 2, v135
    v_add_f32_dpp v132, v132, v132 row_shr:1 row_mask:0xf bank_mask:0xf bound_ctrl:0
    v_add_f32_dpp v133, v133, v133 row_shr:1 row_mask:0xf bank_mask:0xf bound_ctrl:0
    v_lshlrev_b32_e64 v135, 3, v135
    v_add_f32_dpp v132, v132, v132 row_shr:2 row_mask:0xf bank_mask:0xf bound_ctrl:0
    v_add_f32_dpp v133, v133, v133 row_shr:2 row_mask:0xf bank_mask:0xf bound_ctrl:0
    v_lshl_add_u32 v135, v121, 12, v135
    v_add_f32_dpp v132, v132, v132 row_shr:4 row_mask:0xf bank_mask:0xf bound_ctrl:0
    v_add_f32_dpp v133, v133, v133 row_shr:4 row_mask:0xf bank_mask:0xf bound_ctrl:0
    v_and_b32_e64 v121, 31, v0
    v_add_f32_dpp v132, v132, v132 row_shr:8 row_mask:0xf bank_mask:0xf bound_ctrl:0
    v_add_f32_dpp v133, v133, v133 row_shr:8 row_mask:0xf bank_mask:0xf bound_ctrl:0
    v_cmp_eq_u32_e64 vcc, 31, v121
    v_add_f32_dpp v132, v132, v132 row_bcast:15 row_mask:0xa bank_mask:0xf
    v_add_f32_dpp v133, v133, v133 row_bcast:15 row_mask:0xa bank_mask:0xf
    v_mov_b32 v121, 1073741824
    v_cndmask_b32_e64 v120, v121, v135, vcc
    s_lshl_b32 s96, s2, 4
    s_add_u32 s96, s96, 3440640
    v_mul_f32 v135, 0x3acccccd, v132
    v_mul_f32 v133, 0x3acccccd, v133
    v_fma_f32 v133, -v135, v135, v133
    v_max_f32 v133, 0, v133
    v_add_f32 v133, 0x3727c5ac, v133
    v_rsq_f32_e64 v132, v133
    s_nop 0
    v_mul_f32 v133, -v135, v132
    buffer_store_dwordx2 v[132:133], v120, s[16:19], s96 offen sc1
    ds_write_addtid_b32 v249 offset:4624
    ds_write_addtid_b32 v250 offset:4896
    ds_write_addtid_b32 v251 offset:5168
    v_pk_mul_f32 v[194:195], v[174:175], v[186:187] op_sel:[0,0] op_sel_hi:[0,1]
    v_pk_fma_f32 v[172:173], v[174:175], v[186:187], v[194:195] op_sel:[1,1,0] op_sel_hi:[1,0,1] neg_lo:[0,1,0]
    v_cvt_pk_bf16_f32 v242, v172, v173
    v_pk_mul_f32 v[194:195], v[172:173], v[186:187] op_sel:[0,0] op_sel_hi:[0,1]
    v_pk_fma_f32 v[174:175], v[172:173], v[186:187], v[194:195] op_sel:[1,1,0] op_sel_hi:[1,0,1] neg_lo:[0,1,0]
    v_cvt_pk_bf16_f32 v243, v174, v175
    v_pk_mul_f32 v[194:195], v[174:175], v[186:187] op_sel:[0,0] op_sel_hi:[0,1]
    v_pk_fma_f32 v[172:173], v[174:175], v[186:187], v[194:195] op_sel:[1,1,0] op_sel_hi:[1,0,1] neg_lo:[0,1,0]
    v_cvt_pk_bf16_f32 v244, v172, v173
    v_pk_mul_f32 v[194:195], v[172:173], v[186:187] op_sel:[0,0] op_sel_hi:[0,1]
    v_pk_fma_f32 v[174:175], v[172:173], v[186:187], v[194:195] op_sel:[1,1,0] op_sel_hi:[1,0,1] neg_lo:[0,1,0]
    v_cvt_pk_bf16_f32 v245, v174, v175
    v_pk_mul_f32 v[194:195], v[174:175], v[186:187] op_sel:[0,0] op_sel_hi:[0,1]
    v_pk_fma_f32 v[172:173], v[174:175], v[186:187], v[194:195] op_sel:[1,1,0] op_sel_hi:[1,0,1] neg_lo:[0,1,0]
    v_cvt_pk_bf16_f32 v246, v172, v173
    v_pk_mul_f32 v[194:195], v[172:173], v[186:187] op_sel:[0,0] op_sel_hi:[0,1]
    v_pk_fma_f32 v[174:175], v[172:173], v[186:187], v[194:195] op_sel:[1,1,0] op_sel_hi:[1,0,1] neg_lo:[0,1,0]
    v_cvt_pk_bf16_f32 v247, v174, v175
    v_pk_mul_f32 v[194:195], v[174:175], v[186:187] op_sel:[0,0] op_sel_hi:[0,1]
    v_pk_fma_f32 v[172:173], v[174:175], v[186:187], v[194:195] op_sel:[1,1,0] op_sel_hi:[1,0,1] neg_lo:[0,1,0]
    v_cvt_pk_bf16_f32 v248, v172, v173
    v_pk_mul_f32 v[194:195], v[172:173], v[186:187] op_sel:[0,0] op_sel_hi:[0,1]
    v_pk_fma_f32 v[174:175], v[172:173], v[186:187], v[194:195] op_sel:[1,1,0] op_sel_hi:[1,0,1] neg_lo:[0,1,0]
    v_cvt_pk_bf16_f32 v249, v174, v175
    v_pk_mul_f32 v[194:195], v[174:175], v[186:187] op_sel:[0,0] op_sel_hi:[0,1]
    v_pk_fma_f32 v[172:173], v[174:175], v[186:187], v[194:195] op_sel:[1,1,0] op_sel_hi:[1,0,1] neg_lo:[0,1,0]
    v_cvt_pk_bf16_f32 v250, v172, v173
    v_pk_mul_f32 v[194:195], v[172:173], v[186:187] op_sel:[0,0] op_sel_hi:[0,1]
    v_pk_fma_f32 v[174:175], v[172:173], v[186:187], v[194:195] op_sel:[1,1,0] op_sel_hi:[1,0,1] neg_lo:[0,1,0]
    v_cvt_pk_bf16_f32 v251, v174, v175
    ds_write_addtid_b32 v242 offset:5440
    ds_write_addtid_b32 v243 offset:5712
    ds_write_addtid_b32 v244 offset:5984
    ds_write_addtid_b32 v245 offset:6256
    ds_write_addtid_b32 v246 offset:6528
    ds_write_addtid_b32 v247 offset:6800
    ds_write_addtid_b32 v248 offset:7072
    ds_write_addtid_b32 v249 offset:7344
    ds_write_addtid_b32 v250 offset:7616
    ds_write_addtid_b32 v251 offset:7888
    v_pk_mul_f32 v[194:195], v[174:175], v[186:187] op_sel:[0,0] op_sel_hi:[0,1]
    v_pk_fma_f32 v[172:173], v[174:175], v[186:187], v[194:195] op_sel:[1,1,0] op_sel_hi:[1,0,1] neg_lo:[0,1,0]
    v_cvt_pk_bf16_f32 v242, v172, v173
    v_pk_mul_f32 v[194:195], v[172:173], v[186:187] op_sel:[0,0] op_sel_hi:[0,1]
    v_pk_fma_f32 v[174:175], v[172:173], v[186:187], v[194:195] op_sel:[1,1,0] op_sel_hi:[1,0,1] neg_lo:[0,1,0]
    v_cvt_pk_bf16_f32 v243, v174, v175
    ds_write_addtid_b32 v242 offset:8160
    ds_write_addtid_b32 v243 offset:8432
    ds_read_b128 a[160:163], v252 offset:0
    ds_read_b128 a[164:167], v252 offset:32
    ds_read_b128 a[168:171], v252 offset:64
    ds_read_b128 a[172:175], v252 offset:96
    ds_read_b128 a[176:179], v252 offset:128
    ds_read_b128 a[180:183], v252 offset:160
    ds_read_b128 a[184:187], v252 offset:192
    ds_read_b128 a[188:191], v252 offset:224
    v_pk_mul_f32 v[194:195], v[180:181], v[180:181] op_sel:[0,0] op_sel_hi:[0,1]
    buffer_load_dword v7, v4, s[16:19], s87 offen offset:0 sc1
    v_pk_fma_f32 v[182:183], v[180:181], v[180:181], v[194:195] op_sel:[1,1,0] op_sel_hi:[1,0,1] neg_lo:[0,1,0]
    v_pk_mul_f32 v[194:195], v[182:183], v[182:183] op_sel:[0,0] op_sel_hi:[0,1]
    v_pk_fma_f32 v[184:185], v[182:183], v[182:183], v[194:195] op_sel:[1,1,0] op_sel_hi:[1,0,1] neg_lo:[0,1,0]
    v_cvt_pk_bf16_f32 v242, v192, -v193
    v_pk_mul_f32 v[194:195], v[192:193], v[180:181] op_sel:[0,0] op_sel_hi:[0,1]
    v_pk_fma_f32 v[174:175], v[192:193], v[180:181], v[194:195] op_sel:[1,1,0] op_sel_hi:[1,0,1] neg_lo:[0,1,0]
    v_cvt_pk_bf16_f32 v243, v174, -v175
    v_pk_mul_f32 v[194:195], v[174:175], v[180:181] op_sel:[0,0] op_sel_hi:[0,1]
    v_pk_fma_f32 v[172:173], v[174:175], v[180:181], v[194:195] op_sel:[1,1,0] op_sel_hi:[1,0,1] neg_lo:[0,1,0]
    v_cvt_pk_bf16_f32 v244, v172, -v173
    v_pk_mul_f32 v[194:195], v[172:173], v[180:181] op_sel:[0,0] op_sel_hi:[0,1]
    v_pk_fma_f32 v[174:175], v[172:173], v[180:181], v[194:195] op_sel:[1,1,0] op_sel_hi:[1,0,1] neg_lo:[0,1,0]
    v_cvt_pk_bf16_f32 v245, v174, -v175
    v_pk_mul_f32 v[194:195], v[174:175], v[180:181] op_sel:[0,0] op_sel_hi:[0,1]
    v_pk_fma_f32 v[172:173], v[174:175], v[180:181], v[194:195] op_sel:[1,1,0] op_sel_hi:[1,0,1] neg_lo:[0,1,0]
    v_cvt_pk_bf16_f32 v246, v172, -v173
    v_pk_mul_f32 v[194:195], v[172:173], v[180:181] op_sel:[0,0] op_sel_hi:[0,1]
    v_pk_fma_f32 v[174:175], v[172:173], v[180:181], v[194:195] op_sel:[1,1,0] op_sel_hi:[1,0,1] neg_lo:[0,1,0]
    v_cvt_pk_bf16_f32 v247, v174, -v175
    v_pk_mul_f32 v[194:195], v[174:175], v[180:181] op_sel:[0,0] op_sel_hi:[0,1]
    v_pk_fma_f32 v[172:173], v[174:175], v[180:181], v[194:195] op_sel:[1,1,0] op_sel_hi:[1,0,1] neg_lo:[0,1,0]
    v_cvt_pk_bf16_f32 v248, v172, -v173
    v_pk_mul_f32 v[194:195], v[172:173], v[180:181] op_sel:[0,0] op_sel_hi:[0,1]
    v_pk_fma_f32 v[174:175], v[172:173], v[180:181], v[194:195] op_sel:[1,1,0] op_sel_hi:[1,0,1] neg_lo:[0,1,0]
    v_cvt_pk_bf16_f32 v249, v174, -v175
    v_pk_mul_f32 v[194:195], v[192:193], v[190:191] op_sel:[0,0] op_sel_hi:[0,1]
    v_pk_fma_f32 v[176:177], v[192:193], v[190:191], v[194:195] op_sel:[1,1,0] op_sel_hi:[1,0,1] neg_lo:[0,1,0]
    v_cvt_pk_bf16_f32 v250, v176, -v177
    v_pk_mul_f32 v[194:195], v[176:177], v[182:183] op_sel:[0,0] op_sel_hi:[0,1]
    v_pk_fma_f32 v[174:175], v[176:177], v[182:183], v[194:195] op_sel:[1,1,0] op_sel_hi:[1,0,1] neg_lo:[0,1,0]
    v_cvt_pk_bf16_f32 v251, v174, -v175
    ds_write_addtid_b32 v242 offset:0
    ds_write_addtid_b32 v243 offset:272
    ds_write_addtid_b32 v244 offset:544
    ds_write_addtid_b32 v245 offset:816
    ds_write_addtid_b32 v246 offset:1088
    ds_write_addtid_b32 v247 offset:1360
    ds_write_addtid_b32 v248 offset:1632
    ds_write_addtid_b32 v249 offset:1904
    ds_write_addtid_b32 v250 offset:2176
    ds_write_addtid_b32 v251 offset:2448
    v_pk_mul_f32 v[194:195], v[174:175], v[182:183] op_sel:[0,0] op_sel_hi:[0,1]
    v_pk_fma_f32 v[172:173], v[174:175], v[182:183], v[194:195] op_sel:[1,1,0] op_sel_hi:[1,0,1] neg_lo:[0,1,0]
    v_cvt_pk_bf16_f32 v242, v172, -v173
    v_pk_mul_f32 v[194:195], v[172:173], v[182:183] op_sel:[0,0] op_sel_hi:[0,1]
    v_pk_fma_f32 v[174:175], v[172:173], v[182:183], v[194:195] op_sel:[1,1,0] op_sel_hi:[1,0,1] neg_lo:[0,1,0]
    v_cvt_pk_bf16_f32 v243, v174, -v175
    v_pk_mul_f32 v[194:195], v[174:175], v[182:183] op_sel:[0,0] op_sel_hi:[0,1]
    v_pk_fma_f32 v[172:173], v[174:175], v[182:183], v[194:195] op_sel:[1,1,0] op_sel_hi:[1,0,1] neg_lo:[0,1,0]
    v_cvt_pk_bf16_f32 v244, v172, -v173
    v_pk_mul_f32 v[194:195], v[176:177], v[190:191] op_sel:[0,0] op_sel_hi:[0,1]
    v_pk_fma_f32 v[178:179], v[176:177], v[190:191], v[194:195] op_sel:[1,1,0] op_sel_hi:[1,0,1] neg_lo:[0,1,0]
    v_cvt_pk_bf16_f32 v245, v178, -v179
    v_pk_mul_f32 v[194:195], v[178:179], v[184:185] op_sel:[0,0] op_sel_hi:[0,1]
    v_pk_fma_f32 v[174:175], v[178:179], v[184:185], v[194:195] op_sel:[1,1,0] op_sel_hi:[1,0,1] neg_lo:[0,1,0]
    v_cvt_pk_bf16_f32 v246, v174, -v175
    v_pk_mul_f32 v[194:195], v[174:175], v[184:185] op_sel:[0,0] op_sel_hi:[0,1]
    v_pk_fma_f32 v[172:173], v[174:175], v[184:185], v[194:195] op_sel:[1,1,0] op_sel_hi:[1,0,1] neg_lo:[0,1,0]
    v_cvt_pk_bf16_f32 v247, v172, -v173
    v_pk_mul_f32 v[194:195], v[178:179], v[190:191] op_sel:[0,0] op_sel_hi:[0,1]
    v_pk_fma_f32 v[176:177], v[178:179], v[190:191], v[194:195] op_sel:[1,1,0] op_sel_hi:[1,0,1] neg_lo:[0,1,0]
    v_cvt_pk_bf16_f32 v248, v176, -v177
    v_pk_mul_f32 v[194:195], v[176:177], v[184:185] op_sel:[0,0] op_sel_hi:[0,1]
    v_pk_fma_f32 v[174:175], v[176:177], v[184:185], v[194:195] op_sel:[1,1,0] op_sel_hi:[1,0,1] neg_lo:[0,1,0]
    v_cvt_pk_bf16_f32 v249, v174, -v175
    v_pk_mul_f32 v[194:195], v[174:175], v[184:185] op_sel:[0,0] op_sel_hi:[0,1]
    v_pk_fma_f32 v[172:173], v[174:175], v[184:185], v[194:195] op_sel:[1,1,0] op_sel_hi:[1,0,1] neg_lo:[0,1,0]
    v_cvt_pk_bf16_f32 v250, v172, -v173
    v_pk_mul_f32 v[194:195], v[176:177], v[190:191] op_sel:[0,0] op_sel_hi:[0,1]
    v_pk_fma_f32 v[178:179], v[176:177], v[190:191], v[194:195] op_sel:[1,1,0] op_sel_hi:[1,0,1] neg_lo:[0,1,0]
    v_cvt_pk_bf16_f32 v251, v178, -v179
    ds_write_addtid_b32 v242 offset:2720
    ds_write_addtid_b32 v242 offset:3264
    ds_write_addtid_b32 v243 offset:3536
    ds_write_addtid_b32 v244 offset:3808
    ds_write_addtid_b32 v245 offset:4352
    ds_write_addtid_b32 v246 offset:4624
    ds_write_addtid_b32 v247 offset:4896
    ds_write_addtid_b32 v248 offset:5440
    ds_write_addtid_b32 v249 offset:5712
    ds_write_addtid_b32 v250 offset:5984
    ds_write_addtid_b32 v251 offset:6528
    v_pk_mul_f32 v[194:195], v[178:179], v[186:187] op_sel:[0,0] op_sel_hi:[0,1]
    v_pk_fma_f32 v[174:175], v[178:179], v[186:187], v[194:195] op_sel:[1,1,0] op_sel_hi:[1,0,1] neg_lo:[0,1,0]
    v_cvt_pk_bf16_f32 v242, v174, -v175
    v_pk_mul_f32 v[194:195], v[178:179], v[190:191] op_sel:[0,0] op_sel_hi:[0,1]
    v_pk_fma_f32 v[176:177], v[178:179], v[190:191], v[194:195] op_sel:[1,1,0] op_sel_hi:[1,0,1] neg_lo:[0,1,0]
    v_cvt_pk_bf16_f32 v243, v176, -v177
    v_pk_mul_f32 v[194:195], v[176:177], v[186:187] op_sel:[0,0] op_sel_hi:[0,1]
    v_pk_fma_f32 v[174:175], v[176:177], v[186:187], v[194:195] op_sel:[1,1,0] op_sel_hi:[1,0,1] neg_lo:[0,1,0]
    v_cvt_pk_bf16_f32 v244, v174, -v175
    v_pk_mul_f32 v[194:195], v[176:177], v[190:191] op_sel:[0,0] op_sel_hi:[0,1]
    v_pk_fma_f32 v[178:179], v[176:177], v[190:191], v[194:195] op_sel:[1,1,0] op_sel_hi:[1,0,1] neg_lo:[0,1,0]
    v_cvt_pk_bf16_f32 v245, v178, -v179
    v_pk_mul_f32 v[194:195], v[178:179], v[186:187] op_sel:[0,0] op_sel_hi:[0,1]
    v_pk_fma_f32 v[174:175], v[178:179], v[186:187], v[194:195] op_sel:[1,1,0] op_sel_hi:[1,0,1] neg_lo:[0,1,0]
    v_cvt_pk_bf16_f32 v246, v174, -v175
    v_pk_mul_f32 v[194:195], v[178:179], v[190:191] op_sel:[0,0] op_sel_hi:[0,1]
    v_pk_fma_f32 v[176:177], v[178:179], v[190:191], v[194:195] op_sel:[1,1,0] op_sel_hi:[1,0,1] neg_lo:[0,1,0]
    v_cvt_pk_bf16_f32 v247, v176, -v177
    v_pk_mul_f32 v[194:195], v[176:177], v[186:187] op_sel:[0,0] op_sel_hi:[0,1]
    v_pk_fma_f32 v[174:175], v[176:177], v[186:187], v[194:195] op_sel:[1,1,0] op_sel_hi:[1,0,1] neg_lo:[0,1,0]
    v_cvt_pk_bf16_f32 v248, v174, -v175
    ds_write_addtid_b32 v242 offset:6800
    ds_write_addtid_b32 v243 offset:7072
    ds_write_addtid_b32 v244 offset:7344
    ds_write_addtid_b32 v245 offset:7616
    ds_write_addtid_b32 v246 offset:7888
    ds_write_addtid_b32 v247 offset:8160
    ds_write_addtid_b32 v248 offset:8432
    ds_read_b128 a[192:195], v252 offset:0
    ds_read_b128 a[196:199], v252 offset:32
    ds_read_b128 a[200:203], v252 offset:64
    ds_read_b128 a[204:207], v252 offset:96
    ds_read_b128 a[208:211], v252 offset:128
    ds_read_b128 a[212:215], v252 offset:160
    ds_read_b128 a[216:219], v252 offset:192
    ds_read_b128 a[220:223], v252 offset:224
    s_add_u32 m0, s92, 36352
    s_nop 0
    buffer_load_dwordx4 v73, s[4:7], s99 offen offset:0  lds
    v_lshlrev_b32 v199, 16, v236
    v_mul_f32 v199, 0x3fb8aa3b, v199
    v_exp_f32 v199, v199
    v_lshlrev_b32 v255, 16, v237
    v_mul_f32 v255, v255, v253
    v_mul_f32 v255, 0x3e22f983, v255
    v_cvt_pk_bf16_f32 v199, v199, v199
    v_lshlrev_b32 v199, 16, v199
    v_mul_f32 v254, v199, v253
    v_mul_f32 v254, 0xbfb8aa3b, v254
    s_waitcnt lgkmcnt(7)
    v_mfma_f32_32x32x16_bf16 v[216:231], a[192:195], a[160:163], v[216:231]
    s_add_u32 m0, s92, 36352
    s_nop 0
    buffer_load_dwordx4 v74, s[4:7], s99 offen offset:1088  lds
    v_mul_f32 v182, 0x41000000, v254
    v_mul_f32 v185, 0x41000000, v255
    v_mul_f32 v184, 0x43800000, v254
    v_mul_f32 v189, 0x43800000, v255
    s_waitcnt lgkmcnt(6)
    v_mfma_f32_32x32x16_bf16 v[216:231], a[196:199], a[164:167], v[216:231]
    s_add_u32 m0, s92, 36352
    s_nop 0
    buffer_load_dwordx4 v75, s[4:7], s99 offen offset:2176  lds
    v_fract_f32 v185, v185
    v_fract_f32 v188, v255
    v_fract_f32 v189, v189
    v_exp_f32_e64 v182, v182
    s_waitcnt lgkmcnt(5)
    v_mfma_f32_32x32x16_bf16 v[216:231], a[200:203], a[168:171], v[216:231]
    s_add_u32 m0, s92, 36352
    s_nop 0
    buffer_load_dwordx4 v76, s[4:7], s99 offen offset:3264  lds
    v_exp_f32 v183, v254
    v_exp_f32 v184, v184
    v_cos_f32 v186, v185
    v_sin_f32 v187, v185
    s_waitcnt lgkmcnt(4)
    v_mfma_f32_32x32x16_bf16 v[216:231], a[204:207], a[172:175], v[216:231]
    s_add_u32 m0, s93, 53760
    s_add_u32 s99, s99, 256
    s_mov_b64 exec, s[80:81]
    buffer_load_dwordx4 v77, s[4:7], s100 offen  lds
    s_mov_b64 exec, -1
    s_add_u32 s100, s100, 256
    v_cos_f32 v180, v188
    v_sin_f32 v181, v188
    v_cos_f32 v190, v189
    v_sin_f32_e64 v191, v189
    s_waitcnt lgkmcnt(3)
    v_mfma_f32_32x32x16_bf16 v[216:231], a[208:211], a[176:179], v[216:231]
    s_add_u32 m0, s92, 55936
    s_nop 0
    buffer_load_dwordx4 v73, s[4:7], s99 offen offset:0  lds
    v_lshlrev_b32 v192, 16, v238
    v_lshlrev_b32 v193, 16, v239
    v_add_f32 v199, v253, v253
    v_mul_f32 v192, v192, v199
    s_waitcnt lgkmcnt(2)
    v_mfma_f32_32x32x16_bf16 v[216:231], a[212:215], a[180:183], v[216:231]
    s_add_u32 m0, s92, 55936
    s_nop 0
    buffer_load_dwordx4 v74, s[4:7], s99 offen offset:1088  lds
    v_mul_f32 v193, v193, v199
    v_mul_f32 v186, v186, v182
    v_mul_f32 v187, v187, v182
    v_mul_f32 v180, v180, v183
    s_waitcnt lgkmcnt(1)
    v_mfma_f32_32x32x16_bf16 v[216:231], a[216:219], a[184:187], v[216:231]
    s_add_u32 m0, s92, 55936
    s_nop 0
    buffer_load_dwordx4 v75, s[4:7], s99 offen offset:2176  lds
    v_mul_f32 v181, v181, v183
    v_mul_f32 v190, v190, v184
    v_mul_f32_e64 v191, v191, v184
    s_waitcnt lgkmcnt(0)
    v_mfma_f32_32x32x16_bf16 v[216:231], a[220:223], a[188:191], v[216:231]
    s_add_u32 m0, s92, 55936
    s_nop 0
    buffer_load_dwordx4 v76, s[4:7], s99 offen offset:3264  lds
    s_add_u32 m0, s93, 73344
    s_add_u32 s99, s99, 256
    s_mov_b64 exec, s[80:81]
    buffer_load_dwordx4 v77, s[4:7], s100 offen  lds
    s_mov_b64 exec, -1
    s_add_u32 s100, s100, 256
    s_add_u32 m0, s92, 75520
    s_nop 0
    buffer_load_dwordx4 v73, s[4:7], s99 offen offset:0  lds
    s_add_u32 m0, s92, 75520
    s_nop 0
    buffer_load_dwordx4 v74, s[4:7], s99 offen offset:1088  lds
    s_mov_b32 m0, s37
    v_mov_b32 v242, 0x3f80
    v_cvt_pk_bf16_f32 v243, v186, v187
    v_pk_mul_f32 v[194:195], v[186:187], v[186:187] op_sel:[0,0] op_sel_hi:[0,1]
    v_pk_fma_f32 v[172:173], v[186:187], v[186:187], v[194:195] op_sel:[1,1,0] op_sel_hi:[1,0,1] neg_lo:[0,1,0]
    v_cvt_pk_bf16_f32 v244, v172, v173
    v_pk_mul_f32 v[194:195], v[172:173], v[186:187] op_sel:[0,0] op_sel_hi:[0,1]
    v_pk_fma_f32 v[174:175], v[172:173], v[186:187], v[194:195] op_sel:[1,1,0] op_sel_hi:[1,0,1] neg_lo:[0,1,0]
    v_cvt_pk_bf16_f32 v245, v174, v175
    v_pk_mul_f32 v[194:195], v[174:175], v[186:187] op_sel:[0,0] op_sel_hi:[0,1]
    v_pk_fma_f32 v[172:173], v[174:175], v[186:187], v[194:195] op_sel:[1,1,0] op_sel_hi:[1,0,1] neg_lo:[0,1,0]
    v_cvt_pk_bf16_f32 v246, v172, v173
    v_pk_mul_f32 v[194:195], v[172:173], v[186:187] op_sel:[0,0] op_sel_hi:[0,1]
    v_pk_fma_f32 v[174:175], v[172:173], v[186:187], v[194:195] op_sel:[1,1,0] op_sel_hi:[1,0,1] neg_lo:[0,1,0]
    v_cvt_pk_bf16_f32 v247, v174, v175
    v_pk_mul_f32 v[194:195], v[174:175], v[186:187] op_sel:[0,0] op_sel_hi:[0,1]
    v_pk_fma_f32 v[172:173], v[174:175], v[186:187], v[194:195] op_sel:[1,1,0] op_sel_hi:[1,0,1] neg_lo:[0,1,0]
    v_cvt_pk_bf16_f32 v248, v172, v173
    v_pk_mul_f32 v[194:195], v[172:173], v[186:187] op_sel:[0,0] op_sel_hi:[0,1]
    v_pk_fma_f32 v[174:175], v[172:173], v[186:187], v[194:195] op_sel:[1,1,0] op_sel_hi:[1,0,1] neg_lo:[0,1,0]
    v_cvt_pk_bf16_f32 v249, v174, v175
    v_pk_mul_f32 v[194:195], v[174:175], v[186:187] op_sel:[0,0] op_sel_hi:[0,1]
    v_pk_fma_f32 v[172:173], v[174:175], v[186:187], v[194:195] op_sel:[1,1,0] op_sel_hi:[1,0,1] neg_lo:[0,1,0]
    v_cvt_pk_bf16_f32 v250, v172, v173
    v_pk_mul_f32 v[194:195], v[172:173], v[186:187] op_sel:[0,0] op_sel_hi:[0,1]
    s_waitcnt vmcnt(12)
    v_cmp_gt_u32 vcc, 32, v7
    s_nop 0
    s_and_b64 vcc, vcc, s[50:51]
    s_cbranch_scc1 ps_8
pc_10:
    s_barrier
    v_pk_fma_f32 v[174:175], v[172:173], v[186:187], v[194:195] op_sel:[1,1,0] op_sel_hi:[1,0,1] neg_lo:[0,1,0]
    v_cvt_pk_bf16_f32 v251, v174, v175
    ds_write_addtid_b32 v242 offset:0
    ds_write_addtid_b32 v243 offset:272
    ds_write_addtid_b32 v244 offset:544
    ds_write_addtid_b32 v245 offset:816
    ds_write_addtid_b32 v246 offset:1088
    ds_write_addtid_b32 v247 offset:1360
    ds_write_addtid_b32 v248 offset:1632
    ds_write_addtid_b32 v249 offset:1904
    ds_write_addtid_b32 v250 offset:2176
    ds_write_addtid_b32 v251 offset:2448
    v_pk_mul_f32 v[194:195], v[174:175], v[186:187] op_sel:[0,0] op_sel_hi:[0,1]
    v_pk_fma_f32 v[172:173], v[174:175], v[186:187], v[194:195] op_sel:[1,1,0] op_sel_hi:[1,0,1] neg_lo:[0,1,0]
    v_cvt_pk_bf16_f32 v242, v172, v173
    v_pk_mul_f32 v[194:195], v[172:173], v[186:187] op_sel:[0,0] op_sel_hi:[0,1]
    v_pk_fma_f32 v[174:175], v[172:173], v[186:187], v[194:195] op_sel:[1,1,0] op_sel_hi:[1,0,1] neg_lo:[0,1,0]
    v_cvt_pk_bf16_f32 v243, v174, v175
    buffer_load_dwordx4 a[0:3], v200, s[16:19], s101 offen offset:0 sc1
    v_pk_mul_f32 v[194:195], v[174:175], v[186:187] op_sel:[0,0] op_sel_hi:[0,1]
    v_pk_fma_f32 v[172:173], v[174:175], v[186:187], v[194:195] op_sel:[1,1,0] op_sel_hi:[1,0,1] neg_lo:[0,1,0]
    v_cvt_pk_bf16_f32 v244, v172, v173
    v_pk_mul_f32 v[194:195], v[172:173], v[186:187] op_sel:[0,0] op_sel_hi:[0,1]
    v_pk_fma_f32 v[174:175], v[172:173], v[186:187], v[194:195] op_sel:[1,1,0] op_sel_hi:[1,0,1] neg_lo:[0,1,0]
    v_cvt_pk_bf16_f32 v245, v174, v175
    v_pk_mul_f32 v[194:195], v[174:175], v[186:187] op_sel:[0,0] op_sel_hi:[0,1]
    v_pk_fma_f32 v[172:173], v[174:175], v[186:187], v[194:195] op_sel:[1,1,0] op_sel_hi:[1,0,1] neg_lo:[0,1,0]
    v_cvt_pk_bf16_f32 v246, v172, v173
    v_pk_mul_f32 v[194:195], v[172:173], v[186:187] op_sel:[0,0] op_sel_hi:[0,1]
    v_pk_fma_f32 v[174:175], v[172:173], v[186:187], v[194:195] op_sel:[1,1,0] op_sel_hi:[1,0,1] neg_lo:[0,1,0]
    v_cvt_pk_bf16_f32 v247, v174, v175
    v_pk_mul_f32 v[194:195], v[174:175], v[186:187] op_sel:[0,0] op_sel_hi:[0,1]
    v_pk_fma_f32 v[172:173], v[174:175], v[186:187], v[194:195] op_sel:[1,1,0] op_sel_hi:[1,0,1] neg_lo:[0,1,0]
    v_cvt_pk_bf16_f32 v248, v172, v173
    v_pk_mul_f32 v[194:195], v[172:173], v[186:187] op_sel:[0,0] op_sel_hi:[0,1]
    v_pk_fma_f32 v[174:175], v[172:173], v[186:187], v[194:195] op_sel:[1,1,0] op_sel_hi:[1,0,1] neg_lo:[0,1,0]
    v_cvt_pk_bf16_f32 v249, v174, v175
    buffer_load_dwordx4 a[4:7], v200, s[16:19], s101 offen offset:1024 sc1
    v_pk_mul_f32 v[194:195], v[174:175], v[186:187] op_sel:[0,0] op_sel_hi:[0,1]
    v_pk_fma_f32 v[172:173], v[174:175], v[186:187], v[194:195] op_sel:[1,1,0] op_sel_hi:[1,0,1] neg_lo:[0,1,0]
    v_cvt_pk_bf16_f32 v250, v172, v173
    v_pk_mul_f32 v[194:195], v[172:173], v[186:187] op_sel:[0,0] op_sel_hi:[0,1]
    v_pk_fma_f32 v[174:175], v[172:173], v[186:187], v[194:195] op_sel:[1,1,0] op_sel_hi:[1,0,1] neg_lo:[0,1,0]
    v_cvt_pk_bf16_f32 v251, v174, v175
    ds_write_addtid_b32 v242 offset:2720
    ds_write_addtid_b32 v243 offset:2992
    ds_write_addtid_b32 v244 offset:3264
    ds_write_addtid_b32 v245 offset:3536
    ds_write_addtid_b32 v246 offset:3808
    ds_write_addtid_b32 v247 offset:4080
    ds_write_addtid_b32 v248 offset:4352
    ds_write_addtid_b32 v249 offset:4624
    ds_write_addtid_b32 v250 offset:4896
    ds_write_addtid_b32 v251 offset:5168
    v_pk_mul_f32 v[194:195], v[174:175], v[186:187] op_sel:[0,0] op_sel_hi:[0,1]
    v_pk_fma_f32 v[172:173], v[174:175], v[186:187], v[194:195] op_sel:[1,1,0] op_sel_hi:[1,0,1] neg_lo:[0,1,0]
    buffer_load_dwordx4 a[8:11], v200, s[16:19], s101 offen offset:2048 sc1
    v_cvt_pk_bf16_f32 v242, v172, v173
    v_pk_mul_f32 v[194:195], v[172:173], v[186:187] op_sel:[0,0] op_sel_hi:[0,1]
    v_pk_fma_f32 v[174:175], v[172:173], v[186:187], v[194:195] op_sel:[1,1,0] op_sel_hi:[1,0,1] neg_lo:[0,1,0]
    v_cvt_pk_bf16_f32 v243, v174, v175
    v_pk_mul_f32 v[194:195], v[174:175], v[186:187] op_sel:[0,0] op_sel_hi:[0,1]
    v_pk_fma_f32 v[172:173], v[174:175], v[186:187], v[194:195] op_sel:[1,1,0] op_sel_hi:[1,0,1] neg_lo:[0,1,0]
    v_cvt_pk_bf16_f32 v244, v172, v173
    v_pk_mul_f32 v[194:195], v[172:173], v[186:187] op_sel:[0,0] op_sel_hi:[0,1]
    v_pk_fma_f32 v[174:175], v[172:173], v[186:187], v[194:195] op_sel:[1,1,0] op_sel_hi:[1,0,1] neg_lo:[0,1,0]
    v_cvt_pk_bf16_f32 v245, v174, v175
    v_pk_mul_f32 v[194:195], v[174:175], v[186:187] op_sel:[0,0] op_sel_hi:[0,1]
    v_pk_fma_f32 v[172:173], v[174:175], v[186:187], v[194:195] op_sel:[1,1,0] op_sel_hi:[1,0,1] neg_lo:[0,1,0]
    v_cvt_pk_bf16_f32 v246, v172, v173
    v_pk_mul_f32 v[194:195], v[172:173], v[186:187] op_sel:[0,0] op_sel_hi:[0,1]
    v_pk_fma_f32 v[174:175], v[172:173], v[186:187], v[194:195] op_sel:[1,1,0] op_sel_hi:[1,0,1] neg_lo:[0,1,0]
    v_cvt_pk_bf16_f32 v247, v174, v175
    v_pk_mul_f32 v[194:195], v[174:175], v[186:187] op_sel:[0,0] op_sel_hi:[0,1]
    v_pk_fma_f32 v[172:173], v[174:175], v[186:187], v[194:195] op_sel:[1,1,0] op_sel_hi:[1,0,1] neg_lo:[0,1,0]
    buffer_load_dwordx4 a[12:15], v200, s[16:19], s101 offen offset:3072 sc1
    v_cvt_pk_bf16_f32 v248, v172, v173
    v_pk_mul_f32 v[194:195], v[172:173], v[186:187] op_sel:[0,0] op_sel_hi:[0,1]
    v_pk_fma_f32 v[174:175], v[172:173], v[186:187], v[194:195] op_sel:[1,1,0] op_sel_hi:[1,0,1] neg_lo:[0,1,0]
    v_cvt_pk_bf16_f32 v249, v174, v175
    v_pk_mul_f32 v[194:195], v[174:175], v[186:187] op_sel:[0,0] op_sel_hi:[0,1]
    v_pk_fma_f32 v[172:173], v[174:175], v[186:187], v[194:195] op_sel:[1,1,0] op_sel_hi:[1,0,1] neg_lo:[0,1,0]
    v_cvt_pk_bf16_f32 v250, v172, v173
    v_pk_mul_f32 v[194:195], v[172:173], v[186:187] op_sel:[0,0] op_sel_hi:[0,1]
    v_pk_fma_f32 v[174:175], v[172:173], v[186:187], v[194:195] op_sel:[1,1,0] op_sel_hi:[1,0,1] neg_lo:[0,1,0]
    v_cvt_pk_bf16_f32 v251, v174, v175
    ds_write_addtid_b32 v242 offset:5440
    ds_write_addtid_b32 v243 offset:5712
    ds_write_addtid_b32 v244 offset:5984
    ds_write_addtid_b32 v245 offset:6256
    ds_write_addtid_b32 v246 offset:6528
    ds_write_addtid_b32 v247 offset:6800
    ds_write_addtid_b32 v248 offset:7072
    ds_write_addtid_b32 v249 offset:7344
    s_add_u32 s101, s101, 4096
    buffer_load_dwordx4 a[16:19], v200, s[16:19], s101 offen offset:0 sc1
    ds_write_addtid_b32 v250 offset:7616
    ds_write_addtid_b32 v251 offset:7888
    v_pk_mul_f32 v[194:195], v[174:175], v[186:187] op_sel:[0,0] op_sel_hi:[0,1]
    v_pk_fma_f32 v[172:173], v[174:175], v[186:187], v[194:195] op_sel:[1,1,0] op_sel_hi:[1,0,1] neg_lo:[0,1,0]
    v_cvt_pk_bf16_f32 v242, v172, v173
    v_pk_mul_f32 v[194:195], v[172:173], v[186:187] op_sel:[0,0] op_sel_hi:[0,1]
    v_pk_fma_f32 v[174:175], v[172:173], v[186:187], v[194:195] op_sel:[1,1,0] op_sel_hi:[1,0,1] neg_lo:[0,1,0]
    v_cvt_pk_bf16_f32 v243, v174, v175
    ds_write_addtid_b32 v242 offset:8160
    ds_write_addtid_b32 v243 offset:8432
    ds_read_b128 a[160:163], v252 offset:0
    ds_read_b128 a[164:167], v252 offset:32
    ds_read_b128 a[168:171], v252 offset:64
    ds_read_b128 a[172:175], v252 offset:96
    ds_read_b128 a[176:179], v252 offset:128
    ds_read_b128 a[180:183], v252 offset:160
    ds_read_b128 a[184:187], v252 offset:192
    ds_read_b128 a[188:191], v252 offset:224
    buffer_load_dwordx4 a[20:23], v200, s[16:19], s101 offen offset:1024 sc1
    v_pk_mul_f32 v[194:195], v[180:181], v[180:181] op_sel:[0,0] op_sel_hi:[0,1]
    v_pk_fma_f32 v[182:183], v[180:181], v[180:181], v[194:195] op_sel:[1,1,0] op_sel_hi:[1,0,1] neg_lo:[0,1,0]
    v_pk_mul_f32 v[194:195], v[182:183], v[182:183] op_sel:[0,0] op_sel_hi:[0,1]
    v_pk_fma_f32 v[184:185], v[182:183], v[182:183], v[194:195] op_sel:[1,1,0] op_sel_hi:[1,0,1] neg_lo:[0,1,0]
    v_cvt_pk_bf16_f32 v242, v192, -v193
    v_pk_mul_f32 v[194:195], v[192:193], v[180:181] op_sel:[0,0] op_sel_hi:[0,1]
    v_pk_fma_f32 v[174:175], v[192:193], v[180:181], v[194:195] op_sel:[1,1,0] op_sel_hi:[1,0,1] neg_lo:[0,1,0]
    v_cvt_pk_bf16_f32 v243, v174, -v175
    v_pk_mul_f32 v[194:195], v[174:175], v[180:181] op_sel:[0,0] op_sel_hi:[0,1]
    v_pk_fma_f32 v[172:173], v[174:175], v[180:181], v[194:195] op_sel:[1,1,0] op_sel_hi:[1,0,1] neg_lo:[0,1,0]
    v_cvt_pk_bf16_f32 v244, v172, -v173
    v_pk_mul_f32 v[194:195], v[172:173], v[180:181] op_sel:[0,0] op_sel_hi:[0,1]
    v_pk_fma_f32 v[174:175], v[172:173], v[180:181], v[194:195] op_sel:[1,1,0] op_sel_hi:[1,0,1] neg_lo:[0,1,0]
    v_cvt_pk_bf16_f32 v245, v174, -v175
    v_pk_mul_f32 v[194:195], v[174:175], v[180:181] op_sel:[0,0] op_sel_hi:[0,1]
    v_pk_fma_f32 v[172:173], v[174:175], v[180:181], v[194:195] op_sel:[1,1,0] op_sel_hi:[1,0,1] neg_lo:[0,1,0]
    v_cvt_pk_bf16_f32 v246, v172, -v173
    v_pk_mul_f32 v[194:195], v[172:173], v[180:181] op_sel:[0,0] op_sel_hi:[0,1]
    buffer_load_dwordx4 a[24:27], v200, s[16:19], s101 offen offset:2048 sc1
    v_pk_fma_f32 v[174:175], v[172:173], v[180:181], v[194:195] op_sel:[1,1,0] op_sel_hi:[1,0,1] neg_lo:[0,1,0]
    v_cvt_pk_bf16_f32 v247, v174, -v175
    v_pk_mul_f32 v[194:195], v[174:175], v[180:181] op_sel:[0,0] op_sel_hi:[0,1]
    v_pk_fma_f32 v[172:173], v[174:175], v[180:181], v[194:195] op_sel:[1,1,0] op_sel_hi:[1,0,1] neg_lo:[0,1,0]
    v_cvt_pk_bf16_f32 v248, v172, -v173
    v_pk_mul_f32 v[194:195], v[172:173], v[180:181] op_sel:[0,0] op_sel_hi:[0,1]
    v_pk_fma_f32 v[174:175], v[172:173], v[180:181], v[194:195] op_sel:[1,1,0] op_sel_hi:[1,0,1] neg_lo:[0,1,0]
    v_cvt_pk_bf16_f32 v249, v174, -v175
    v_pk_mul_f32 v[194:195], v[192:193], v[190:191] op_sel:[0,0] op_sel_hi:[0,1]
    v_pk_fma_f32 v[176:177], v[192:193], v[190:191], v[194:195] op_sel:[1,1,0] op_sel_hi:[1,0,1] neg_lo:[0,1,0]
    v_cvt_pk_bf16_f32 v250, v176, -v177
    v_pk_mul_f32 v[194:195], v[176:177], v[182:183] op_sel:[0,0] op_sel_hi:[0,1]
    v_pk_fma_f32 v[174:175], v[176:177], v[182:183], v[194:195] op_sel:[1,1,0] op_sel_hi:[1,0,1] neg_lo:[0,1,0]
    v_cvt_pk_bf16_f32 v251, v174, -v175
    ds_write_addtid_b32 v242 offset:0
    ds_write_addtid_b32 v243 offset:272
    ds_write_addtid_b32 v244 offset:544
    ds_write_addtid_b32 v245 offset:816
    buffer_load_dwordx4 a[28:31], v200, s[16:19], s101 offen offset:3072 sc1
    ds_write_addtid_b32 v246 offset:1088
    ds_write_addtid_b32 v247 offset:1360
    ds_write_addtid_b32 v248 offset:1632
    ds_write_addtid_b32 v249 offset:1904
    ds_write_addtid_b32 v250 offset:2176
    ds_write_addtid_b32 v251 offset:2448
    v_pk_mul_f32 v[194:195], v[174:175], v[182:183] op_sel:[0,0] op_sel_hi:[0,1]
    v_pk_fma_f32 v[172:173], v[174:175], v[182:183], v[194:195] op_sel:[1,1,0] op_sel_hi:[1,0,1] neg_lo:[0,1,0]
    v_cvt_pk_bf16_f32 v242, v172, -v173
    v_pk_mul_f32 v[194:195], v[172:173], v[182:183] op_sel:[0,0] op_sel_hi:[0,1]
    v_pk_fma_f32 v[174:175], v[172:173], v[182:183], v[194:195] op_sel:[1,1,0] op_sel_hi:[1,0,1] neg_lo:[0,1,0]
    v_cvt_pk_bf16_f32 v243, v174, -v175
    v_pk_mul_f32 v[194:195], v[174:175], v[182:183] op_sel:[0,0] op_sel_hi:[0,1]
    v_pk_fma_f32 v[172:173], v[174:175], v[182:183], v[194:195] op_sel:[1,1,0] op_sel_hi:[1,0,1] neg_lo:[0,1,0]
    v_cvt_pk_bf16_f32 v244, v172, -v173
    v_pk_mul_f32 v[194:195], v[176:177], v[190:191] op_sel:[0,0] op_sel_hi:[0,1]
    v_pk_fma_f32 v[178:179], v[176:177], v[190:191], v[194:195] op_sel:[1,1,0] op_sel_hi:[1,0,1] neg_lo:[0,1,0]
    v_cvt_pk_bf16_f32 v245, v178, -v179
    s_add_u32 s101, s101, 4096
    buffer_load_dwordx4 a[32:35], v200, s[16:19], s101 offen offset:0 sc1
    v_pk_mul_f32 v[194:195], v[178:179], v[184:185] op_sel:[0,0] op_sel_hi:[0,1]
    v_pk_fma_f32 v[174:175], v[178:179], v[184:185], v[194:195] op_sel:[1,1,0] op_sel_hi:[1,0,1] neg_lo:[0,1,0]
    v_cvt_pk_bf16_f32 v246, v174, -v175
    v_pk_mul_f32 v[194:195], v[174:175], v[184:185] op_sel:[0,0] op_sel_hi:[0,1]
    v_pk_fma_f32 v[172:173], v[174:175], v[184:185], v[194:195] op_sel:[1,1,0] op_sel_hi:[1,0,1] neg_lo:[0,1,0]
    v_cvt_pk_bf16_f32 v247, v172, -v173
    v_pk_mul_f32 v[194:195], v[178:179], v[190:191] op_sel:[0,0] op_sel_hi:[0,1]
    v_pk_fma_f32 v[176:177], v[178:179], v[190:191], v[194:195] op_sel:[1,1,0] op_sel_hi:[1,0,1] neg_lo:[0,1,0]
    v_cvt_pk_bf16_f32 v248, v176, -v177
    v_pk_mul_f32 v[194:195], v[176:177], v[184:185] op_sel:[0,0] op_sel_hi:[0,1]
    v_pk_fma_f32 v[174:175], v[176:177], v[184:185], v[194:195] op_sel:[1,1,0] op_sel_hi:[1,0,1] neg_lo:[0,1,0]
    v_cvt_pk_bf16_f32 v249, v174, -v175
    v_pk_mul_f32 v[194:195], v[174:175], v[184:185] op_sel:[0,0] op_sel_hi:[0,1]
    v_pk_fma_f32 v[172:173], v[174:175], v[184:185], v[194:195] op_sel:[1,1,0] op_sel_hi:[1,0,1] neg_lo:[0,1,0]
    v_cvt_pk_bf16_f32 v250, v172, -v173
    v_pk_mul_f32 v[194:195], v[176:177], v[190:191] op_sel:[0,0] op_sel_hi:[0,1]
    v_pk_fma_f32 v[178:179], v[176:177], v[190:191], v[194:195] op_sel:[1,1,0] op_sel_hi:[1,0,1] neg_lo:[0,1,0]
    v_cvt_pk_bf16_f32 v251, v178, -v179
    buffer_load_dwordx4 a[36:39], v200, s[16:19], s101 offen offset:1024 sc1
    ds_write_addtid_b32 v242 offset:2720
    ds_write_addtid_b32 v242 offset:3264
    ds_write_addtid_b32 v243 offset:3536
    ds_write_addtid_b32 v244 offset:3808
    ds_write_addtid_b32 v245 offset:4352
    ds_write_addtid_b32 v246 offset:4624
    ds_write_addtid_b32 v247 offset:4896
    ds_write_addtid_b32 v248 offset:5440
    ds_write_addtid_b32 v249 offset:5712
    ds_write_addtid_b32 v250 offset:5984
    ds_write_addtid_b32 v251 offset:6528
    v_pk_mul_f32 v[194:195], v[178:179], v[186:187] op_sel:[0,0] op_sel_hi:[0,1]
    v_pk_fma_f32 v[174:175], v[178:179], v[186:187], v[194:195] op_sel:[1,1,0] op_sel_hi:[1,0,1] neg_lo:[0,1,0]
    v_cvt_pk_bf16_f32 v242, v174, -v175
    v_pk_mul_f32 v[194:195], v[178:179], v[190:191] op_sel:[0,0] op_sel_hi:[0,1]
    v_pk_fma_f32 v[176:177], v[178:179], v[190:191], v[194:195] op_sel:[1,1,0] op_sel_hi:[1,0,1] neg_lo:[0,1,0]
    v_cvt_pk_bf16_f32 v243, v176, -v177
    v_pk_mul_f32 v[194:195], v[176:177], v[186:187] op_sel:[0,0] op_sel_hi:[0,1]
    buffer_load_dwordx4 a[40:43], v200, s[16:19], s101 offen offset:2048 sc1
    v_pk_fma_f32 v[174:175], v[176:177], v[186:187], v[194:195] op_sel:[1,1,0] op_sel_hi:[1,0,1] neg_lo:[0,1,0]
    v_cvt_pk_bf16_f32 v244, v174, -v175
    v_pk_mul_f32 v[194:195], v[176:177], v[190:191] op_sel:[0,0] op_sel_hi:[0,1]
    v_pk_fma_f32 v[178:179], v[176:177], v[190:191], v[194:195] op_sel:[1,1,0] op_sel_hi:[1,0,1] neg_lo:[0,1,0]
    v_cvt_pk_bf16_f32 v245, v178, -v179
    v_pk_mul_f32 v[194:195], v[178:179], v[186:187] op_sel:[0,0] op_sel_hi:[0,1]
    v_pk_fma_f32 v[174:175], v[178:179], v[186:187], v[194:195] op_sel:[1,1,0] op_sel_hi:[1,0,1] neg_lo:[0,1,0]
    v_cvt_pk_bf16_f32 v246, v174, -v175
    v_pk_mul_f32 v[194:195], v[178:179], v[190:191] op_sel:[0,0] op_sel_hi:[0,1]
    v_pk_fma_f32 v[176:177], v[178:179], v[190:191], v[194:195] op_sel:[1,1,0] op_sel_hi:[1,0,1] neg_lo:[0,1,0]
    v_cvt_pk_bf16_f32 v247, v176, -v177
    v_pk_mul_f32 v[194:195], v[176:177], v[186:187] op_sel:[0,0] op_sel_hi:[0,1]
    v_pk_fma_f32 v[174:175], v[176:177], v[186:187], v[194:195] op_sel:[1,1,0] op_sel_hi:[1,0,1] neg_lo:[0,1,0]
    v_cvt_pk_bf16_f32 v248, v174, -v175
    ds_write_addtid_b32 v242 offset:6800
    ds_write_addtid_b32 v243 offset:7072
    ds_write_addtid_b32 v244 offset:7344
    ds_write_addtid_b32 v245 offset:7616
    buffer_load_dwordx4 a[44:47], v200, s[16:19], s101 offen offset:3072 sc1
    ds_write_addtid_b32 v246 offset:7888
    ds_write_addtid_b32 v247 offset:8160
    ds_write_addtid_b32 v248 offset:8432
    ds_read_b128 a[192:195], v252 offset:0
    ds_read_b128 a[196:199], v252 offset:32
    ds_read_b128 a[200:203], v252 offset:64
    ds_read_b128 a[204:207], v252 offset:96
    ds_read_b128 a[208:211], v252 offset:128
    ds_read_b128 a[212:215], v252 offset:160
    ds_read_b128 a[216:219], v252 offset:192
    ds_read_b128 a[220:223], v252 offset:224
    s_add_u32 m0, s92, 75520
    s_nop 0
    buffer_load_dwordx4 v75, s[4:7], s99 offen offset:2176  lds
    s_waitcnt lgkmcnt(7)
    v_mfma_f32_32x32x16_bf16 v[216:231], a[192:195], a[160:163], v[216:231]
    s_add_u32 m0, s92, 75520
    s_nop 0
    buffer_load_dwordx4 v76, s[4:7], s99 offen offset:3264  lds
    s_waitcnt lgkmcnt(6)
    v_mfma_f32_32x32x16_bf16 v[216:231], a[196:199], a[164:167], v[216:231]
    s_add_u32 m0, s93, 92928
    s_add_u32 s101, s101, 4096
    buffer_load_dwordx4 a[48:51], v200, s[16:19], s101 offen offset:0 sc1
    s_add_u32 s99, s99, 256
    s_mov_b64 exec, s[80:81]
    buffer_load_dwordx4 v77, s[4:7], s100 offen  lds
    s_mov_b64 exec, -1
    s_add_u32 s100, s100, 256
    s_waitcnt lgkmcnt(5)
    v_mfma_f32_32x32x16_bf16 v[216:231], a[200:203], a[168:171], v[216:231]
    s_add_u32 m0, s92, 95104
    s_nop 0
    buffer_load_dwordx4 v73, s[4:7], s99 offen offset:0  lds
    s_waitcnt lgkmcnt(4)
    v_mfma_f32_32x32x16_bf16 v[216:231], a[204:207], a[172:175], v[216:231]
    s_add_u32 m0, s92, 95104
    s_nop 0
    buffer_load_dwordx4 v74, s[4:7], s99 offen offset:1088  lds
    s_waitcnt lgkmcnt(3)
    v_mfma_f32_32x32x16_bf16 v[216:231], a[208:211], a[176:179], v[216:231]
    s_add_u32 m0, s92, 95104
    s_nop 0
    buffer_load_dwordx4 v75, s[4:7], s99 offen offset:2176  lds
    s_waitcnt lgkmcnt(2)
    v_mfma_f32_32x32x16_bf16 v[216:231], a[212:215], a[180:183], v[216:231]
    s_add_u32 m0, s92, 95104
    s_nop 0
    buffer_load_dwordx4 v76, s[4:7], s99 offen offset:3264  lds
    s_waitcnt lgkmcnt(1)
    v_mfma_f32_32x32x16_bf16 v[216:231], a[216:219], a[184:187], v[216:231]
    buffer_load_dwordx4 a[52:55], v200, s[16:19], s101 offen offset:1024 sc1
    s_add_u32 m0, s93, 112512
    s_add_u32 s99, s99, 256
    s_mov_b64 exec, s[80:81]
    buffer_load_dwordx4 v77, s[4:7], s100 offen  lds
    s_mov_b64 exec, -1
    s_add_u32 s100, s100, 256
    s_waitcnt lgkmcnt(0)
    v_mfma_f32_32x32x16_bf16 v[216:231], a[220:223], a[188:191], v[216:231]
    s_add_u32 m0, s92, 114688
    s_nop 0
    buffer_load_dwordx4 v73, s[4:7], s99 offen offset:0  lds
    s_add_u32 m0, s92, 114688
    s_nop 0
    buffer_load_dwordx4 v74, s[4:7], s99 offen offset:1088  lds
    s_add_u32 m0, s92, 114688
    s_nop 0
    buffer_load_dwordx4 v75, s[4:7], s99 offen offset:2176  lds
    s_add_u32 m0, s92, 114688
    s_nop 0
    buffer_load_dwordx4 v76, s[4:7], s99 offen offset:3264  lds
    s_add_u32 m0, s93, 132096
    s_add_u32 s99, s99, 256
    s_mov_b64 exec, s[80:81]
    buffer_load_dwordx4 v77, s[4:7], s100 offen  lds
    s_mov_b64 exec, -1
    s_add_u32 s100, s100, 256
    s_mov_b32 m0, s37
    s_branch ec_4
nc_3:
    s_sub_u32 s33, s2, 160
    s_min_u32 s33, s33, 159
    s_mul_i32 s29, s33, 3277
    s_lshr_b32 s29, s29, 16
    s_mul_i32 s30, s29, 20
    s_sub_u32 s30, s33, s30
    s_mul_i32 s31, s30, 13108
    s_lshr_b32 s31, s31, 16
    s_mul_i32 s32, s31, 5
    s_sub_u32 s32, s30, s32
    s_lshl_b32 s28, s24, 10
    s_lshr_b32 s34, s32, 1
    s_mul_i32 s34, s34, 20
    s_and_b32 s35, s32, 1
    s_lshl_b32 s35, s35, 3
    s_add_u32 s34, s34, s35
    s_cmp_eq_u32 s32, 4
    s_cselect_b32 s34, 16, s34
    s_cselect_b32 s35, 20, 4
    s_mul_i32 s36, s31, 160
    s_add_u32 s34, s34, s36
    s_mul_i32 s34, s34, 1280
    s_mul_i32 s36, s29, 160
    s_add_u32 s34, s34, s36
    v_add_u32 v162, 0, v0
    v_mul_u32_u24 v160, 6554, v162
    v_lshrrev_b32 v160, 16, v160
    v_mul_u32_u24 v161, 10, v160
    v_sub_u32 v161, v162, v161
    v_lshrrev_b32 v163, 3, v160
    v_mul_u32_u24 v163, 40, v163
    v_bfe_u32 v164, v160, 2, 1
    v_mul_u32_u24 v164, s35, v164
    v_and_b32_e64 v160, 3, v160
    v_add3_u32 v160, v160, v163, v164
    v_mul_u32_u24 v160, 1280, v160
    v_lshl_add_u32 v162, v161, 4, v160
    s_add_u32 m0, s28, 0
    s_nop 0
    buffer_load_dwordx4 v162, s[12:15], s34 offen lds
    v_add_u32 v162, 256, v0
    v_min_u32 v162, 319, v162
    v_mul_u32_u24 v160, 6554, v162
    v_lshrrev_b32 v160, 16, v160
    v_mul_u32_u24 v161, 10, v160
    v_sub_u32 v161, v162, v161
    v_lshrrev_b32 v163, 3, v160
    v_mul_u32_u24 v163, 40, v163
    v_bfe_u32 v164, v160, 2, 1
    v_mul_u32_u24 v164, s35, v164
    v_and_b32_e64 v160, 3, v160
    v_add3_u32 v160, v160, v163, v164
    v_mul_u32_u24 v160, 1280, v160
    v_lshl_add_u32 v162, v161, 4, v160
    s_add_u32 m0, s28, 4096
    s_nop 0
    buffer_load_dwordx4 v162, s[12:15], s34 offen lds
    v_bfe_u32 v163, v0, 4, 2
    v_bfe_u32 v164, v0, 2, 2
    v_lshl_add_u32 v163, v163, 3, v164
    v_mul_u32_u24 v163, 160, v163
    v_and_b32 v164, 3, v0
    v_lshl_add_u32 v165, v164, 3, v163
    v_add_u32 v165, 0, v165
    s_lshl_b32 s36, s24, 5
    v_add_u32_e64 v166, s36, v165
    s_mul_i32 s33, s33, 5120
    s_add_u32 s33, s33, 2621440
    v_lshl_add_u32 v167, v1, 4, s33
    v_add_u32 v164, 4096, v167
    v_mov_b32 v163, 1073741824
    v_cmp_gt_u32 vcc, 64, v0
    s_sub_u32 s36, s24, s31
    s_and_b32 s36, s36, 3
    s_lshl_b32 s36, s36, 10
    v_cndmask_b32 v168, v163, v164, vcc
    v_add_u32 v167, s36, v167
    s_sub_u32 s33, s2, 64
    s_min_u32 s33, s33, 159
    s_mul_i32 s29, s33, 3277
    s_lshr_b32 s29, s29, 16
    s_mul_i32 s30, s29, 20
    s_sub_u32 s30, s33, s30
    s_mul_i32 s31, s30, 13108
    s_lshr_b32 s31, s31, 16
    s_mul_i32 s32, s31, 5
    s_sub_u32 s32, s30, s32
    s_lshl_b32 s28, s24, 10
    s_lshr_b32 s34, s32, 1
    s_mul_i32 s34, s34, 20
    s_and_b32 s35, s32, 1
    s_lshl_b32 s35, s35, 3
    s_add_u32 s34, s34, s35
    s_cmp_eq_u32 s32, 4
    s_cselect_b32 s34, 16, s34
    s_cselect_b32 s35, 20, 4
    s_mul_i32 s36, s31, 160
    s_add_u32 s34, s34, s36
    s_mul_i32 s34, s34, 1280
    s_mul_i32 s36, s29, 160
    s_add_u32 s34, s34, s36
    v_add_u32 v182, 0, v0
    v_mul_u32_u24 v180, 6554, v182
    v_lshrrev_b32 v180, 16, v180
    v_mul_u32_u24 v181, 10, v180
    v_sub_u32 v181, v182, v181
    v_lshrrev_b32 v183, 3, v180
    v_mul_u32_u24 v183, 40, v183
    v_bfe_u32 v184, v180, 2, 1
    v_mul_u32_u24 v184, s35, v184
    v_and_b32_e64 v180, 3, v180
    v_add3_u32 v180, v180, v183, v184
    v_mul_u32_u24 v180, 1280, v180
    v_lshl_add_u32 v182, v181, 4, v180
    s_add_u32 m0, s28, 8192
    s_nop 0
    buffer_load_dwordx4 v182, s[12:15], s34 offen lds
    v_add_u32 v182, 256, v0
    v_min_u32 v182, 319, v182
    v_mul_u32_u24 v180, 6554, v182
    v_lshrrev_b32 v180, 16, v180
    v_mul_u32_u24 v181, 10, v180
    v_sub_u32 v181, v182, v181
    v_lshrrev_b32 v183, 3, v180
    v_mul_u32_u24 v183, 40, v183
    v_bfe_u32 v184, v180, 2, 1
    v_mul_u32_u24 v184, s35, v184
    v_and_b32 v180, 3, v180
    v_add3_u32 v180, v180, v183, v184
    v_mul_u32_u24 v180, 1280, v180
    v_lshl_add_u32 v182, v181, 4, v180
    s_add_u32 m0, s28, 12288
    s_nop 0
    buffer_load_dwordx4 v182, s[12:15], s34 offen lds
    v_bfe_u32 v183, v0, 4, 2
    v_bfe_u32 v184, v0, 2, 2
    v_lshl_add_u32 v183, v183, 3, v184
    v_mul_u32_u24 v183, 160, v183
    v_and_b32 v184, 3, v0
    v_lshl_add_u32 v185, v184, 3, v183
    v_add_u32 v185, 8192, v185
    s_lshl_b32 s36, s24, 5
    v_add_u32 v186, s36, v185
    s_mul_i32 s33, s33, 5120
    s_add_u32 s33, s33, 2621440
    v_lshl_add_u32 v187, v1, 4, s33
    v_add_u32 v184, 4096, v187
    v_mov_b32 v183, 1073741824
    v_cmp_gt_u32 vcc, 64, v0
    s_sub_u32 s36, s24, s31
    s_and_b32 s36, s36, 3
    s_lshl_b32 s36, s36, 10
    v_cndmask_b32 v188, v183, v184, vcc
    v_add_u32 v187, s36, v187
    v_mov_b32 v216, 0
    v_mov_b32 v217, 0
    v_mov_b32 v218, 0
    v_mov_b32 v219, 0
    v_mov_b32 v220, 0
    v_mov_b32 v221, 0
    v_mov_b32 v222, 0
    v_mov_b32 v223, 0
    v_mov_b32 v224, 0
    v_mov_b32 v225, 0
    v_mov_b32 v226, 0
    v_mov_b32 v227, 0
    v_mov_b32 v228, 0
    v_mov_b32 v229, 0
    v_mov_b32 v230, 0
    v_mov_b32_e64 v231, 0
    s_waitcnt vmcnt(5)
    s_barrier
    ds_read_b64_tr_b16 v[96:97], v111
    ds_read_b64_tr_b16 v[98:99], v111 offset:2560
    ds_read_b64_tr_b16 v[100:101], v112
    ds_read_b64_tr_b16 v[102:103], v112 offset:2560
    ds_read_b64_tr_b16 v[104:105], v113
    ds_read_b64_tr_b16 v[106:107], v113 offset:2560
    s_waitcnt lgkmcnt(4)
    buffer_store_dwordx4 v[96:99], v108, s[16:19], 0 offen sc1
    s_waitcnt lgkmcnt(2)
    buffer_store_dwordx4 v[100:103], v109, s[16:19], 0 offen sc1
    s_waitcnt lgkmcnt(0)
    buffer_store_dwordx4 v[104:107], v110, s[16:19], 0 offen sc1
    global_load_dword v7, v5, s[66:67] sc1
    v_lshrrev_b32 v132, 5, v0
    v_and_b32_e64 v133, 31, v0
    v_mul_u32_u24 v132, 1280, v132
    v_lshl_add_u32 v134, v133, 4, v132
    v_mov_b32 v135, 1073741824
    v_cmp_gt_u32 vcc, 16, v133
    s_mul_i32 s96, s2, 10240
    buffer_load_dwordx4 v[120:123], v134, s[4:7], s96 offen
    v_cndmask_b32_e64 v135, v135, v134, vcc
    buffer_load_dwordx4 v[124:127], v134, s[4:7], s96 offen offset:512
    buffer_load_dwordx4 v[128:131], v135, s[4:7], s96 offen offset:1024
    s_waitcnt vmcnt(4)
    s_waitcnt vmcnt(3)
    v_cmp_gt_u32 vcc, 1, v7
    s_nop 0
    s_and_b64 vcc, vcc, s[50:51]
    s_and_b64 vcc, vcc, 1
    s_cbranch_scc1 ps_11
pc_13:
    s_barrier
    v_lshlrev_b32 v2, 3, v4
    v_mov_b32 v5, 1
    v_cndmask_b32 v2, v4, v2, s[50:51]
    buffer_atomic_add v5, v2, s[16:19], s86 offen offset:0 sc1
    ds_read_b64_tr_b16 v[172:173], v166
    ds_read_b64_tr_b16 v[174:175], v166 offset:640
    ds_read_b64_tr_b16 v[176:177], v165 offset:128
    ds_read_b64_tr_b16 v[178:179], v165 offset:768
    s_waitcnt lgkmcnt(2)
    buffer_store_dwordx4 v[172:175], v167, s[16:19], 0 offen sc1
    s_waitcnt lgkmcnt(0)
    buffer_store_dwordx4 v[176:179], v168, s[16:19], 0 offen sc1
    ds_read_b64_tr_b16 v[192:193], v186
    ds_read_b64_tr_b16 v[194:195], v186 offset:640
    ds_read_b64_tr_b16 v[196:197], v185 offset:128
    ds_read_b64_tr_b16 v[198:199], v185 offset:768
    s_waitcnt lgkmcnt(2)
    buffer_store_dwordx4 v[192:195], v187, s[16:19], 0 offen sc1
    s_waitcnt lgkmcnt(0)
    buffer_store_dwordx4 v[196:199], v188, s[16:19], 0 offen sc1
    v_mov_b32 v134, 0x3f803f80
    v_mov_b32 v132, 0
    v_mov_b32 v133, 0
    s_waitcnt vmcnt(7)
    v_dot2c_f32_bf16 v132, v120, v134
    v_dot2c_f32_bf16 v133, v120, v120
    v_dot2c_f32_bf16 v132, v121, v134
    v_dot2c_f32_bf16 v133, v121, v121
    v_dot2c_f32_bf16 v132, v122, v134
    v_dot2c_f32_bf16 v133, v122, v122
    v_dot2c_f32_bf16 v132, v123, v134
    v_dot2c_f32_bf16 v133, v123, v123
    s_waitcnt vmcnt(6)
    v_dot2c_f32_bf16 v132, v124, v134
    v_dot2c_f32_bf16 v133, v124, v124
    v_dot2c_f32_bf16 v132, v125, v134
    v_dot2c_f32_bf16 v133, v125, v125
    v_dot2c_f32_bf16 v132, v126, v134
    v_dot2c_f32_bf16 v133, v126, v126
    v_dot2c_f32_bf16 v132, v127, v134
    v_dot2c_f32_bf16 v133, v127, v127
    s_waitcnt vmcnt(5)
    v_dot2c_f32_bf16 v132, v128, v134
    v_dot2c_f32_bf16 v133, v128, v128
    v_dot2c_f32_bf16 v132, v129, v134
    v_dot2c_f32_bf16 v133, v129, v129
    v_dot2c_f32_bf16 v132, v130, v134
    v_dot2c_f32_bf16 v133, v130, v130
    v_dot2c_f32_bf16 v132, v131, v134
    v_dot2c_f32_bf16 v133, v131, v131
    v_lshrrev_b32 v135, 5, v0
    v_and_b32 v121, 3, v135
    v_lshrrev_b32 v135, 2, v135
    v_add_f32_dpp v132, v132, v132 row_shr:1 row_mask:0xf bank_mask:0xf bound_ctrl:0
    v_add_f32_dpp v133, v133, v133 row_shr:1 row_mask:0xf bank_mask:0xf bound_ctrl:0
    v_lshlrev_b32_e64 v135, 3, v135
    v_add_f32_dpp v132, v132, v132 row_shr:2 row_mask:0xf bank_mask:0xf bound_ctrl:0
    v_add_f32_dpp v133, v133, v133 row_shr:2 row_mask:0xf bank_mask:0xf bound_ctrl:0
    v_lshl_add_u32 v135, v121, 12, v135
    v_add_f32_dpp v132, v132, v132 row_shr:4 row_mask:0xf bank_mask:0xf bound_ctrl:0
    v_add_f32_dpp v133, v133, v133 row_shr:4 row_mask:0xf bank_mask:0xf bound_ctrl:0
    v_and_b32_e64 v121, 31, v0
    v_add_f32_dpp v132, v132, v132 row_shr:8 row_mask:0xf bank_mask:0xf bound_ctrl:0
    v_add_f32_dpp v133, v133, v133 row_shr:8 row_mask:0xf bank_mask:0xf bound_ctrl:0
    v_cmp_eq_u32_e64 vcc, 31, v121
    v_add_f32_dpp v132, v132, v132 row_bcast:15 row_mask:0xa bank_mask:0xf
    v_add_f32_dpp v133, v133, v133 row_bcast:15 row_mask:0xa bank_mask:0xf
    v_mov_b32 v121, 1073741824
    v_cndmask_b32_e64 v120, v121, v135, vcc
    s_lshl_b32 s96, s2, 4
    s_add_u32 s96, s96, 3440640
    v_mul_f32 v135, 0x3acccccd, v132
    v_mul_f32 v133, 0x3acccccd, v133
    v_fma_f32 v133, -v135, v135, v133
    v_max_f32 v133, 0, v133
    v_add_f32 v133, 0x3727c5ac, v133
    v_rsq_f32_e64 v132, v133
    s_nop 0
    v_mul_f32 v133, -v135, v132
    buffer_store_dwordx2 v[132:133], v120, s[16:19], s96 offen sc1
    s_add_u32 m0, s92, 36352
    s_nop 0
    s_nop 0
    buffer_load_dwordx4 v73, s[4:7], s99 offen offset:0  lds
    buffer_load_dwordx4 v74, s[4:7], s99 offen offset:1088  lds
    buffer_load_dwordx4 v75, s[4:7], s99 offen offset:2176  lds
    buffer_load_dwordx4 v76, s[4:7], s99 offen offset:3264  lds
    s_add_u32 m0, s93, 53760
    s_add_u32 s99, s99, 256
    s_mov_b64 exec, s[80:81]
    buffer_load_dwordx4 v77, s[4:7], s100 offen  lds
    s_mov_b64 exec, -1
    s_add_u32 s100, s100, 256
    s_add_u32 m0, s92, 55936
    s_nop 0
    s_nop 0
    buffer_load_dwordx4 v73, s[4:7], s99 offen offset:0  lds
    buffer_load_dwordx4 v74, s[4:7], s99 offen offset:1088  lds
    buffer_load_dwordx4 v75, s[4:7], s99 offen offset:2176  lds
    buffer_load_dwordx4 v76, s[4:7], s99 offen offset:3264  lds
    s_add_u32 m0, s93, 73344
    s_add_u32 s99, s99, 256
    s_mov_b64 exec, s[80:81]
    buffer_load_dwordx4 v77, s[4:7], s100 offen  lds
    s_mov_b64 exec, -1
    s_add_u32 s100, s100, 256
    v_mov_b32 v140, 1073741824
    v_lshlrev_b32 v141, 2, v0
    v_cmp_gt_u32 vcc, 64, v0
    s_nop 1
    v_cndmask_b32 v141, v140, v141, vcc
    v_mov_b32_e64 v140, 0
    s_lshl_b32 s97, s2, 8
    s_add_u32 s97, s97, 3473408
    buffer_store_dword v140, v141, s[16:19], s97 offen sc1
    v_mov_b32 v142, 1073741824
    v_lshlrev_b32 v143, 2, v0
    v_cmp_gt_u32 vcc, 16, v0
    s_nop 1
    v_cndmask_b32 v143, v142, v143, vcc
    v_mov_b32_e64 v142, -1
    s_lshl_b32 s97, s2, 6
    s_add_u32 s97, s97, 3457024
    buffer_store_dword v142, v143, s[16:19], s97 offen sc1
    v_mov_b32 v144, -1
    v_mov_b32 v145, -1
    v_mov_b32 v146, -1
    v_mov_b32 v147, -1
    v_lshlrev_b32 v148, 4, v0
    s_sub_u32 s88, s2, 0
    s_mul_i32 s88, s88, 20480
    s_min_u32 s88, s88, 5222400
    s_add_u32 s88, s88, 4194304
    buffer_store_dwordx4 v[144:147], v148, s[16:19], s88 offen sc1
    s_add_u32 s88, s88, 4096
    buffer_store_dwordx4 v[144:147], v148, s[16:19], s88 offen sc1
    s_add_u32 s88, s88, 4096
    buffer_store_dwordx4 v[144:147], v148, s[16:19], s88 offen sc1
    s_add_u32 s88, s88, 4096
    buffer_store_dwordx4 v[144:147], v148, s[16:19], s88 offen sc1
    s_add_u32 s88, s88, 4096
    buffer_store_dwordx4 v[144:147], v148, s[16:19], s88 offen sc1
    s_add_u32 m0, s92, 75520
    s_nop 0
    s_nop 0
    buffer_load_dwordx4 v73, s[4:7], s99 offen offset:0  lds
    buffer_load_dwordx4 v74, s[4:7], s99 offen offset:1088  lds
    buffer_load_dwordx4 v75, s[4:7], s99 offen offset:2176  lds
    buffer_load_dwordx4 v76, s[4:7], s99 offen offset:3264  lds
    s_add_u32 m0, s93, 92928
    s_add_u32 s99, s99, 256
    s_mov_b64 exec, s[80:81]
    buffer_load_dwordx4 v77, s[4:7], s100 offen  lds
    s_mov_b64 exec, -1
    s_add_u32 s100, s100, 256
    s_add_u32 m0, s92, 95104
    s_nop 0
    s_nop 0
    buffer_load_dwordx4 v73, s[4:7], s99 offen offset:0  lds
    buffer_load_dwordx4 v74, s[4:7], s99 offen offset:1088  lds
    buffer_load_dwordx4 v75, s[4:7], s99 offen offset:2176  lds
    buffer_load_dwordx4 v76, s[4:7], s99 offen offset:3264  lds
    s_add_u32 m0, s93, 112512
    s_add_u32 s99, s99, 256
    s_mov_b64 exec, s[80:81]
    buffer_load_dwordx4 v77, s[4:7], s100 offen  lds
    s_mov_b64 exec, -1
    s_add_u32 s100, s100, 256
    s_add_u32 m0, s92, 114688
    s_nop 0
    s_nop 0
    buffer_load_dwordx4 v73, s[4:7], s99 offen offset:0  lds
    buffer_load_dwordx4 v74, s[4:7], s99 offen offset:1088  lds
    buffer_load_dwordx4 v75, s[4:7], s99 offen offset:2176  lds
    buffer_load_dwordx4 v76, s[4:7], s99 offen offset:3264  lds
    s_add_u32 m0, s93, 132096
    s_add_u32 s99, s99, 256
    s_mov_b64 exec, s[80:81]
    buffer_load_dwordx4 v77, s[4:7], s100 offen  lds
    s_mov_b64 exec, -1
    s_add_u32 s100, s100, 256
    s_waitcnt vmcnt(15)
    buffer_load_dword v7, v4, s[16:19], s87 offen offset:0 sc1
    s_waitcnt vmcnt(0)
    v_cmp_gt_u32_e64 vcc, 32, v7
    s_nop 0
    s_and_b64 vcc, vcc, s[50:51]
    s_cbranch_scc1 ps_14
pc_16:
    s_barrier
    buffer_load_dwordx4 a[0:3], v200, s[16:19], s101 offen offset:0 sc1
    buffer_load_dwordx4 a[4:7], v200, s[16:19], s101 offen offset:1024 sc1
    buffer_load_dwordx4 a[8:11], v200, s[16:19], s101 offen offset:2048 sc1
    buffer_load_dwordx4 a[12:15], v200, s[16:19], s101 offen offset:3072 sc1
    s_add_u32 s101, s101, 4096
    buffer_load_dwordx4 a[16:19], v200, s[16:19], s101 offen offset:0 sc1
    buffer_load_dwordx4 a[20:23], v200, s[16:19], s101 offen offset:1024 sc1
    buffer_load_dwordx4 a[24:27], v200, s[16:19], s101 offen offset:2048 sc1
    buffer_load_dwordx4 a[28:31], v200, s[16:19], s101 offen offset:3072 sc1
    s_add_u32 s101, s101, 4096
    buffer_load_dwordx4 a[32:35], v200, s[16:19], s101 offen offset:0 sc1
    buffer_load_dwordx4 a[36:39], v200, s[16:19], s101 offen offset:1024 sc1
    buffer_load_dwordx4 a[40:43], v200, s[16:19], s101 offen offset:2048 sc1
    buffer_load_dwordx4 a[44:47], v200, s[16:19], s101 offen offset:3072 sc1
    s_add_u32 s101, s101, 4096
    buffer_load_dwordx4 a[48:51], v200, s[16:19], s101 offen offset:0 sc1
    buffer_load_dwordx4 a[52:55], v200, s[16:19], s101 offen offset:1024 sc1
ec_4:
    v_add_u32 v196, 36352, v78
    v_mov_b32 v198, v79
    v_xor_b32 v197, 32, v196
    s_waitcnt vmcnt(34)
    s_barrier
    s_add_u32 s82, s86, 16384
    v_lshlrev_b32 v2, 3, v4
    v_mov_b32 v5, 1
    v_cndmask_b32 v2, v4, v2, s[50:51]
    buffer_atomic_add v5, v2, s[16:19], s82 offen offset:8 sc1
    ds_read_b128 v[160:163], v198 offset:0
    ds_read_b128 v[164:167], v196 offset:0
    ds_read_b128 v[168:171], v196 offset:8704
    ds_read_b128 v[172:175], v198 offset:32
    ds_read_b128 v[176:179], v197 offset:0
    ds_read_b128 v[180:183], v197 offset:8704
    s_waitcnt lgkmcnt(3)
    s_waitcnt vmcnt(14)
    v_mfma_f32_16x16x32_bf16 v[112:115], a[0:3], v[160:163], 0
    ds_read_b128 v[184:187], v198 offset:64
    v_mfma_f32_32x32x16_bf16 v[80:95], a[0:3], v[164:167], 0
    ds_read_b128 v[188:191], v196 offset:64
    v_mov_b32 v208, 0
    v_mov_b32 v209, 0
    v_lshrrev_b32_e64 v210, 5, v0
    v_mul_u32_u24 v210, 1600, v210
    v_mfma_f32_32x32x16_bf16 v[96:111], a[0:3], v[168:171], 0
    ds_read_b128 v[192:195], v196 offset:8768
    buffer_load_dwordx4 a[56:59], v200, s[16:19], s101 offen offset:2048 sc1
    v_and_b32 v211, 31, v0
    v_min_u32 v211, 19, v211
    s_waitcnt lgkmcnt(3)
    s_waitcnt vmcnt(14)
    v_mfma_f32_16x16x32_bf16 v[112:115], a[4:7], v[172:175], v[112:115]
    ds_read_b128 v[160:163], v198 offset:96
    v_mfma_f32_32x32x16_bf16 v[80:95], a[4:7], v[176:179], v[80:95]
    ds_read_b128 v[164:167], v197 offset:64
    v_lshl_add_u32 v210, v211, 3, v210
    v_add_u32 v210, 6400, v210
    ds_write_b64 v210, v[208:209]
    s_mul_i32 s33, s24, 4160
    v_mfma_f32_32x32x16_bf16 v[96:111], a[4:7], v[180:183], v[96:111]
    ds_read_b128 v[168:171], v197 offset:8768
    buffer_load_dwordx4 a[60:63], v200, s[16:19], s101 offen offset:3072 sc1
    s_add_u32 s33, s33, 134272
    v_and_b32_e64 v250, 31, v1
    s_waitcnt lgkmcnt(4)
    s_waitcnt vmcnt(14)
    v_mfma_f32_16x16x32_bf16 v[112:115], a[8:11], v[184:187], v[112:115]
    ds_read_b128 v[172:175], v198 offset:128
    v_mfma_f32_32x32x16_bf16 v[80:95], a[8:11], v[188:191], v[80:95]
    ds_read_b128 v[176:179], v196 offset:128
    v_lshl_add_u32 v250, v250, 4, s33
    v_lshrrev_b32_e64 v253, 5, v1
    v_lshl_add_u32 v251, v253, 3, v250
    v_lshl_add_u32 v252, v253, 9, v250
    v_mfma_f32_32x32x16_bf16 v[96:111], a[8:11], v[192:195], v[96:111]
    ds_read_b128 v[180:183], v196 offset:8832
    s_add_u32 s101, s101, 4096
    buffer_load_dwordx4 a[64:67], v200, s[16:19], s101 offen offset:0 sc1
    v_lshl_add_u32 v250, v253, 10, v250
    s_waitcnt lgkmcnt(3)
    s_waitcnt vmcnt(14)
    v_mfma_f32_16x16x32_bf16 v[112:115], a[12:15], v[160:163], v[112:115]
    ds_read_b128 v[184:187], v198 offset:160
    v_mfma_f32_32x32x16_bf16 v[80:95], a[12:15], v[164:167], v[80:95]
    ds_read_b128 v[188:191], v197 offset:128
    v_cmp_eq_u32 vcc, 0, v1
    v_lshlrev_b32 v254, 16, v241
    v_min_u32 v253, 15, v1
    v_cndmask_b32 v254, 0, v254, vcc
    v_mfma_f32_32x32x16_bf16 v[96:111], a[12:15], v[168:171], v[96:111]
    ds_read_b128 v[192:195], v197 offset:8832
    buffer_load_dwordx4 a[68:71], v200, s[16:19], s101 offen offset:1024 sc1
    v_lshl_add_u32 v253, v253, 2, s33
    v_add_f32_e64 v216, v216, v254
    s_waitcnt lgkmcnt(3)
    s_waitcnt vmcnt(14)
    v_mfma_f32_16x16x32_bf16 v[112:115], a[16:19], v[172:175], v[112:115]
    ds_read_b128 v[160:163], v198 offset:192
    v_mfma_f32_32x32x16_bf16 v[80:95], a[16:19], v[176:179], v[80:95]
    ds_read_b128 v[164:167], v196 offset:192
    v_and_b32 v254, 1, v1
    v_cmp_eq_u32 vcc, 1, v254
    v_mov_b32_e64 v254, 0
    v_cvt_pk_bf16_f32 v242, v216, v217
    v_mfma_f32_32x32x16_bf16 v[96:111], a[16:19], v[180:183], v[96:111]
    ds_read_b128 v[168:171], v196 offset:8896
    buffer_load_dwordx4 a[72:75], v200, s[16:19], s101 offen offset:2048 sc1
    v_cvt_pk_bf16_f32 v243, v218, v219
    v_cvt_pk_bf16_f32 v244, v220, v220
    s_waitcnt lgkmcnt(3)
    s_waitcnt vmcnt(14)
    v_mfma_f32_16x16x32_bf16 v[112:115], a[20:23], v[184:187], v[112:115]
    ds_read_b128 v[172:175], v198 offset:224
    v_mfma_f32_32x32x16_bf16 v[80:95], a[20:23], v[188:191], v[80:95]
    ds_read_b128 v[176:179], v197 offset:192
    v_cvt_pk_bf16_f32 v245, v221, v222
    v_cvt_pk_bf16_f32 v246, v224, v224
    v_cvt_pk_bf16_f32 v247, v224, v225
    v_cvt_pk_bf16_f32 v248, v225, v225
    v_mfma_f32_32x32x16_bf16 v[96:111], a[20:23], v[192:195], v[96:111]
    ds_read_b128 v[180:183], v197 offset:8896
    buffer_load_dwordx4 a[76:79], v200, s[16:19], s101 offen offset:3072 sc1
    v_cvt_pk_bf16_f32 v249, v226, v226
    ds_write_b32 v253, v254
    s_barrier
    s_waitcnt lgkmcnt(4)
    s_waitcnt vmcnt(14)
    v_mfma_f32_16x16x32_bf16 v[112:115], a[24:27], v[160:163], v[112:115]
    v_add_u32 v198, v49, v198
    v_mfma_f32_32x32x16_bf16 v[80:95], a[24:27], v[164:167], v[80:95]
    v_add_u32 v196, 19584, v196
    v_add_u32 v197, 19584, v197
    ds_read_b128 v[184:187], v198 offset:0
    ds_write_b64 v251, v[242:243] offset:64
    ds_write_b64 v251, v[244:245] offset:576
    v_mfma_f32_32x32x16_bf16 v[96:111], a[24:27], v[168:171], v[96:111]
    ds_read_b128 v[188:191], v196 offset:0
    ds_read_b128 v[192:195], v196 offset:8704
    s_add_u32 s101, s101, 4096
    buffer_load_dwordx4 a[80:83], v200, s[16:19], s101 offen offset:0 sc1
    s_waitcnt lgkmcnt(6)
    s_waitcnt vmcnt(14)
    v_mfma_f32_16x16x32_bf16 v[112:115], a[28:31], v[172:175], v[112:115]
    ds_read_b128 v[160:163], v198 offset:32
    v_mfma_f32_32x32x16_bf16 v[80:95], a[28:31], v[176:179], v[80:95]
    ds_read_b128 v[164:167], v197 offset:0
    ds_write_b128 v252, v[246:249] offset:1088
    v_cndmask_b32 v255, v228, v229, vcc
    v_cvt_pk_bf16_f32 v216, v228, v228
    v_mov_b32 v217, v216
    v_mfma_f32_32x32x16_bf16 v[96:111], a[28:31], v[180:183], v[96:111]
    ds_read_b128 v[168:171], v197 offset:8704
    buffer_load_dwordx4 a[84:87], v200, s[16:19], s101 offen offset:1024 sc1
    v_cvt_pk_bf16_f32 v218, v255, v229
    v_cvt_pk_bf16_f32 v219, v229, v229
    s_waitcnt lgkmcnt(4)
    s_waitcnt vmcnt(14)
    v_mfma_f32_16x16x32_bf16 v[112:115], a[32:35], v[184:187], v[112:115]
    ds_read_b128 v[172:175], v198 offset:64
    v_mfma_f32_32x32x16_bf16 v[80:95], a[32:35], v[188:191], v[80:95]
    ds_read_b128 v[176:179], v196 offset:64
    ds_write_b128 v250, v[216:219] offset:2112
    v_cndmask_b32 v255, v230, v231, vcc
    v_cvt_pk_bf16_f32 v220, v230, v230
    v_mov_b32 v221, v220
    v_mfma_f32_32x32x16_bf16 v[96:111], a[32:35], v[192:195], v[96:111]
    ds_read_b128 v[180:183], v196 offset:8768
    buffer_load_dwordx4 a[88:91], v200, s[16:19], s101 offen offset:2048 sc1
    v_cvt_pk_bf16_f32 v222, v255, v231
    v_cvt_pk_bf16_f32 v223, v231, v231
    s_waitcnt lgkmcnt(4)
    s_waitcnt vmcnt(14)
    v_mfma_f32_16x16x32_bf16 v[112:115], a[36:39], v[160:163], v[112:115]
    ds_read_b128 v[184:187], v198 offset:96
    v_mfma_f32_32x32x16_bf16 v[80:95], a[36:39], v[164:167], v[80:95]
    ds_read_b128 v[188:191], v197 offset:64
    ds_write_b128 v250, v[220:223] offset:2624
    v_mfma_f32_32x32x16_bf16 v[96:111], a[36:39], v[168:171], v[96:111]
    ds_read_b128 v[192:195], v197 offset:8768
    buffer_load_dwordx4 a[92:95], v200, s[16:19], s101 offen offset:3072 sc1
    s_waitcnt lgkmcnt(4)
    s_waitcnt vmcnt(14)
    v_mfma_f32_16x16x32_bf16 v[112:115], a[40:43], v[172:175], v[112:115]
    ds_read_b128 v[160:163], v198 offset:128
    v_mfma_f32_32x32x16_bf16 v[80:95], a[40:43], v[176:179], v[80:95]
    ds_read_b128 v[164:167], v196 offset:128
    v_mfma_f32_32x32x16_bf16 v[96:111], a[40:43], v[180:183], v[96:111]
    ds_read_b128 v[168:171], v196 offset:8832
    s_add_u32 s101, s101, 4096
    buffer_load_dwordx4 a[96:99], v200, s[16:19], s101 offen offset:0 sc1
    s_waitcnt lgkmcnt(3)
    s_waitcnt vmcnt(14)
    v_mfma_f32_16x16x32_bf16 v[112:115], a[44:47], v[184:187], v[112:115]
    ds_read_b128 v[172:175], v198 offset:160
    v_mfma_f32_32x32x16_bf16 v[80:95], a[44:47], v[188:191], v[80:95]
    ds_read_b128 v[176:179], v197 offset:128
    v_mfma_f32_32x32x16_bf16 v[96:111], a[44:47], v[192:195], v[96:111]
    ds_read_b128 v[180:183], v197 offset:8832
    buffer_load_dwordx4 a[100:103], v200, s[16:19], s101 offen offset:1024 sc1
    s_waitcnt lgkmcnt(3)
    s_waitcnt vmcnt(14)
    v_mfma_f32_16x16x32_bf16 v[112:115], a[48:51], v[160:163], v[112:115]
    ds_read_b128 v[184:187], v198 offset:192
    v_mfma_f32_32x32x16_bf16 v[80:95], a[48:51], v[164:167], v[80:95]
    ds_read_b128 v[188:191], v196 offset:192
    v_mfma_f32_32x32x16_bf16 v[96:111], a[48:51], v[168:171], v[96:111]
    ds_read_b128 v[192:195], v196 offset:8896
    buffer_load_dwordx4 a[104:107], v200, s[16:19], s101 offen offset:2048 sc1
    s_waitcnt lgkmcnt(3)
    s_waitcnt vmcnt(14)
    v_mfma_f32_16x16x32_bf16 v[112:115], a[52:55], v[172:175], v[112:115]
    ds_read_b128 v[160:163], v198 offset:224
    v_mfma_f32_32x32x16_bf16 v[80:95], a[52:55], v[176:179], v[80:95]
    ds_read_b128 v[164:167], v197 offset:192
    v_mfma_f32_32x32x16_bf16 v[96:111], a[52:55], v[180:183], v[96:111]
    ds_read_b128 v[168:171], v197 offset:8896
    buffer_load_dwordx4 a[108:111], v200, s[16:19], s101 offen offset:3072 sc1
    s_barrier
    s_waitcnt lgkmcnt(3)
    s_waitcnt vmcnt(13)
    v_mfma_f32_16x16x32_bf16 v[112:115], a[56:59], v[184:187], v[112:115]
    v_add_u32 v198, v49, v198
    v_mfma_f32_32x32x16_bf16 v[80:95], a[56:59], v[188:191], v[80:95]
    v_add_u32 v196, 19584, v196
    v_add_u32 v197, 19584, v197
    ds_read_b128 v[172:175], v198 offset:0
    v_mfma_f32_32x32x16_bf16 v[96:111], a[56:59], v[192:195], v[96:111]
    ds_read_b128 v[176:179], v196 offset:0
    ds_read_b128 v[180:183], v196 offset:8704
    s_add_u32 s101, s101, 4096
    buffer_load_dwordx4 a[112:115], v200, s[16:19], s101 offen offset:0 sc1
    s_waitcnt lgkmcnt(3)
    s_waitcnt vmcnt(13)
    v_mfma_f32_16x16x32_bf16 v[112:115], a[60:63], v[160:163], v[112:115]
    ds_read_b128 v[184:187], v198 offset:32
    v_mfma_f32_32x32x16_bf16 v[80:95], a[60:63], v[164:167], v[80:95]
    ds_read_b128 v[188:191], v197 offset:0
    v_mfma_f32_32x32x16_bf16 v[96:111], a[60:63], v[168:171], v[96:111]
    ds_read_b128 v[192:195], v197 offset:8704
    buffer_load_dwordx4 a[116:119], v200, s[16:19], s101 offen offset:1024 sc1
    s_waitcnt lgkmcnt(3)
    s_waitcnt vmcnt(13)
    v_mfma_f32_16x16x32_bf16 v[112:115], a[64:67], v[172:175], v[112:115]
    ds_read_b128 v[160:163], v198 offset:64
    v_mfma_f32_32x32x16_bf16 v[80:95], a[64:67], v[176:179], v[80:95]
    ds_read_b128 v[164:167], v196 offset:64
    v_mfma_f32_32x32x16_bf16 v[96:111], a[64:67], v[180:183], v[96:111]
    ds_read_b128 v[168:171], v196 offset:8768
    buffer_load_dwordx4 a[120:123], v200, s[16:19], s101 offen offset:2048 sc1
    s_waitcnt lgkmcnt(3)
    s_waitcnt vmcnt(13)
    v_mfma_f32_16x16x32_bf16 v[112:115], a[68:71], v[184:187], v[112:115]
    ds_read_b128 v[172:175], v198 offset:96
    v_mfma_f32_32x32x16_bf16 v[80:95], a[68:71], v[188:191], v[80:95]
    ds_read_b128 v[176:179], v197 offset:64
    v_mfma_f32_32x32x16_bf16 v[96:111], a[68:71], v[192:195], v[96:111]
    ds_read_b128 v[180:183], v197 offset:8768
    buffer_load_dwordx4 a[124:127], v200, s[16:19], s101 offen offset:3072 sc1
    s_waitcnt lgkmcnt(3)
    s_waitcnt vmcnt(13)
    v_mfma_f32_16x16x32_bf16 v[112:115], a[72:75], v[160:163], v[112:115]
    ds_read_b128 v[184:187], v198 offset:128
    v_mfma_f32_32x32x16_bf16 v[80:95], a[72:75], v[164:167], v[80:95]
    ds_read_b128 v[188:191], v196 offset:128
    v_mfma_f32_32x32x16_bf16 v[96:111], a[72:75], v[168:171], v[96:111]
    ds_read_b128 v[192:195], v196 offset:8832
    s_add_u32 s101, s101, 4096
    buffer_load_dwordx4 a[128:131], v200, s[16:19], s101 offen offset:0 sc1
    s_waitcnt lgkmcnt(3)
    s_waitcnt vmcnt(13)
    v_mfma_f32_16x16x32_bf16 v[112:115], a[76:79], v[172:175], v[112:115]
    ds_read_b128 v[160:163], v198 offset:160
    v_mfma_f32_32x32x16_bf16 v[80:95], a[76:79], v[176:179], v[80:95]
    ds_read_b128 v[164:167], v197 offset:128
    v_mfma_f32_32x32x16_bf16 v[96:111], a[76:79], v[180:183], v[96:111]
    ds_read_b128 v[168:171], v197 offset:8832
    buffer_load_dwordx4 a[132:135], v200, s[16:19], s101 offen offset:1024 sc1
    s_waitcnt lgkmcnt(3)
    s_waitcnt vmcnt(13)
    v_mfma_f32_16x16x32_bf16 v[112:115], a[80:83], v[184:187], v[112:115]
    ds_read_b128 v[172:175], v198 offset:192
    v_mfma_f32_32x32x16_bf16 v[80:95], a[80:83], v[188:191], v[80:95]
    ds_read_b128 v[176:179], v196 offset:192
    v_mfma_f32_32x32x16_bf16 v[96:111], a[80:83], v[192:195], v[96:111]
    ds_read_b128 v[180:183], v196 offset:8896
    buffer_load_dwordx4 a[136:139], v200, s[16:19], s101 offen offset:2048 sc1
    s_waitcnt lgkmcnt(3)
    s_waitcnt vmcnt(13)
    v_mfma_f32_16x16x32_bf16 v[112:115], a[84:87], v[160:163], v[112:115]
    ds_read_b128 v[184:187], v198 offset:224
    v_mfma_f32_32x32x16_bf16 v[80:95], a[84:87], v[164:167], v[80:95]
    ds_read_b128 v[188:191], v197 offset:192
    v_mfma_f32_32x32x16_bf16 v[96:111], a[84:87], v[168:171], v[96:111]
    ds_read_b128 v[192:195], v197 offset:8896
    buffer_load_dwordx4 a[140:143], v200, s[16:19], s101 offen offset:3072 sc1
    s_barrier
    s_waitcnt lgkmcnt(3)
    s_waitcnt vmcnt(13)
    v_mfma_f32_16x16x32_bf16 v[112:115], a[88:91], v[172:175], v[112:115]
    v_add_u32 v198, v49, v198
    v_mfma_f32_32x32x16_bf16 v[80:95], a[88:91], v[176:179], v[80:95]
    v_add_u32 v196, 19584, v196
    v_add_u32 v197, 19584, v197
    ds_read_b128 v[160:163], v198 offset:0
    v_mfma_f32_32x32x16_bf16 v[96:111], a[88:91], v[180:183], v[96:111]
    ds_read_b128 v[164:167], v196 offset:0
    ds_read_b128 v[168:171], v196 offset:8704
    s_add_u32 s101, s101, 4096
    buffer_load_dword v7, v4, s[16:19], s89 offen offset:8 sc1
    s_waitcnt lgkmcnt(3)
    s_waitcnt vmcnt(13)
    v_mfma_f32_16x16x32_bf16 v[112:115], a[92:95], v[184:187], v[112:115]
    ds_read_b128 v[172:175], v198 offset:32
    v_mfma_f32_32x32x16_bf16 v[80:95], a[92:95], v[188:191], v[80:95]
    ds_read_b128 v[176:179], v197 offset:0
    v_mfma_f32_32x32x16_bf16 v[96:111], a[92:95], v[192:195], v[96:111]
    ds_read_b128 v[180:183], v197 offset:8704
    buffer_load_dwordx4 a[144:147], v200, s[16:19], s101 offen offset:0 sc1
    s_waitcnt lgkmcnt(3)
    s_waitcnt vmcnt(13)
    v_mfma_f32_16x16x32_bf16 v[112:115], a[96:99], v[160:163], v[112:115]
    ds_read_b128 v[184:187], v198 offset:64
    v_mfma_f32_32x32x16_bf16 v[80:95], a[96:99], v[164:167], v[80:95]
    ds_read_b128 v[188:191], v196 offset:64
    v_mfma_f32_32x32x16_bf16 v[96:111], a[96:99], v[168:171], v[96:111]
    ds_read_b128 v[192:195], v196 offset:8768
    buffer_load_dwordx4 a[148:151], v200, s[16:19], s101 offen offset:1024 sc1
    s_waitcnt lgkmcnt(3)
    s_waitcnt vmcnt(13)
    v_mfma_f32_16x16x32_bf16 v[112:115], a[100:103], v[172:175], v[112:115]
    ds_read_b128 v[160:163], v198 offset:96
    v_mfma_f32_32x32x16_bf16 v[80:95], a[100:103], v[176:179], v[80:95]
    ds_read_b128 v[164:167], v197 offset:64
    v_mfma_f32_32x32x16_bf16 v[96:111], a[100:103], v[180:183], v[96:111]
    ds_read_b128 v[168:171], v197 offset:8768
    buffer_load_dwordx4 a[152:155], v200, s[16:19], s101 offen offset:2048 sc1
    s_waitcnt lgkmcnt(3)
    s_waitcnt vmcnt(13)
    v_mfma_f32_16x16x32_bf16 v[112:115], a[104:107], v[184:187], v[112:115]
    ds_read_b128 v[172:175], v198 offset:128
    v_mfma_f32_32x32x16_bf16 v[80:95], a[104:107], v[188:191], v[80:95]
    ds_read_b128 v[176:179], v196 offset:128
    v_mfma_f32_32x32x16_bf16 v[96:111], a[104:107], v[192:195], v[96:111]
    ds_read_b128 v[180:183], v196 offset:8832
    buffer_load_dwordx4 a[156:159], v200, s[16:19], s101 offen offset:3072 sc1
    s_waitcnt lgkmcnt(3)
    s_waitcnt vmcnt(13)
    v_mfma_f32_16x16x32_bf16 v[112:115], a[108:111], v[160:163], v[112:115]
    ds_read_b128 v[184:187], v198 offset:160
    v_mfma_f32_32x32x16_bf16 v[80:95], a[108:111], v[164:167], v[80:95]
    ds_read_b128 v[188:191], v197 offset:128
    v_mfma_f32_32x32x16_bf16 v[96:111], a[108:111], v[168:171], v[96:111]
    ds_read_b128 v[192:195], v197 offset:8832
    s_add_u32 s101, s101, 4096
    s_lshl_b32 s25, s72, 5
    s_add_u32 s25, s25, 256
    s_sub_u32 s26, s25, 4
    s_max_i32 s26, s26, 0
    s_mul_i32 s27, s71, 1280
    s_mul_i32 s99, s25, 5120
    s_mul_i32 s100, s26, 5120
    s_mul_i32 s92, s24, 4352
    s_mul_i32 s93, s24, 544
    s_add_u32 s99, s99, s27
    s_add_u32 s100, s100, s27
    s_waitcnt lgkmcnt(3)
    s_waitcnt vmcnt(12)
    v_mfma_f32_16x16x32_bf16 v[112:115], a[112:115], v[172:175], v[112:115]
    ds_read_b128 v[160:163], v198 offset:192
    v_mfma_f32_32x32x16_bf16 v[80:95], a[112:115], v[176:179], v[80:95]
    ds_read_b128 v[164:167], v196 offset:192
    v_mfma_f32_32x32x16_bf16 v[96:111], a[112:115], v[180:183], v[96:111]
    ds_read_b128 v[168:171], v196 offset:8896
    s_waitcnt lgkmcnt(3)
    s_waitcnt vmcnt(11)
    v_mfma_f32_16x16x32_bf16 v[112:115], a[116:119], v[184:187], v[112:115]
    ds_read_b128 v[172:175], v198 offset:224
    v_mfma_f32_32x32x16_bf16 v[80:95], a[116:119], v[188:191], v[80:95]
    ds_read_b128 v[176:179], v197 offset:192
    v_mfma_f32_32x32x16_bf16 v[96:111], a[116:119], v[192:195], v[96:111]
    ds_read_b128 v[180:183], v197 offset:8896
    s_waitcnt vmcnt(4)
    v_cmp_gt_u32 vcc, 32, v7
    s_nop 0
    s_and_b64 vcc, vcc, s[50:51]
    s_cbranch_scc1 ps_17
pc_19:
    s_barrier
    s_waitcnt lgkmcnt(3)
    v_mfma_f32_16x16x32_bf16 v[112:115], a[120:123], v[160:163], v[112:115]
    v_add_u32_e64 v198, v49, v198
    v_mfma_f32_32x32x16_bf16 v[80:95], a[120:123], v[164:167], v[80:95]
    v_add_u32 v196, 19584, v196
    v_add_u32 v197, 19584, v197
    s_lshl_b32 s31, s24, 7
    s_add_u32 s31, s31, 160768
    v_bfe_u32 v132, v1, 3, 1
    v_mfma_f32_32x32x16_bf16 v[96:111], a[120:123], v[168:171], v[96:111]
    ds_read_b128 v[184:187], v198 offset:0
    ds_read_b128 v[188:191], v196 offset:0
    s_lshl_b32 s98, s72, 5
    s_add_u32 s98, s98, 0
    s_sub_u32 s95, s98, 4
    s_max_i32 s95, s95, 0
    s_lshl_b32 s94, s98, 3
    s_lshl_b32 s95, s95, 3
    s_add_u32 s94, s94, 3440640
    s_add_u32 s95, s95, 3440640
    s_add_u32 s96, s94, 8192
    buffer_load_dwordx2 v[152:153], v47, s[16:19], s94 offen sc1
    v_lshrrev_b32 v133, 4, v1
    v_lshl_add_u32 v132, v132, 2, v133
    s_waitcnt lgkmcnt(2)
    v_mfma_f32_16x16x32_bf16 v[112:115], a[124:127], v[172:175], v[112:115]
    ds_read_b128 v[192:195], v198 offset:32
    v_mfma_f32_32x32x16_bf16 v[80:95], a[124:127], v[176:179], v[80:95]
    ds_read_b128 v[160:163], v197 offset:0
    v_lshl_add_u32 v132, v132, 4, s31
    v_lshrrev_b32 v133, 5, v1
    v_lshl_add_u32 v133, v133, 4, s31
    v_mfma_f32_32x32x16_bf16 v[96:111], a[124:127], v[180:183], v[96:111]
    buffer_load_dwordx2 v[154:155], v47, s[16:19], s96 offen sc1
    s_waitcnt lgkmcnt(2)
    v_mfma_f32_16x16x32_bf16 v[112:115], a[128:131], v[184:187], v[112:115]
    ds_read_b128 v[164:167], v198 offset:64
    v_mfma_f32_32x32x16_bf16 v[80:95], a[128:131], v[188:191], v[80:95]
    ds_read_b128 v[168:171], v196 offset:64
    s_waitcnt lgkmcnt(2)
    v_mfma_f32_16x16x32_bf16 v[112:115], a[132:135], v[192:195], v[112:115]
    ds_read_b128 v[172:175], v198 offset:96
    v_mfma_f32_32x32x16_bf16 v[80:95], a[132:135], v[160:163], v[80:95]
    ds_read_b128 v[176:179], v197 offset:64
    buffer_load_dwordx2 v[156:157], v48, s[16:19], s95 offen sc1
    s_waitcnt lgkmcnt(2)
    v_mfma_f32_16x16x32_bf16 v[112:115], a[136:139], v[164:167], v[112:115]
    ds_read_b128 v[180:183], v198 offset:128
    v_mfma_f32_32x32x16_bf16 v[80:95], a[136:139], v[168:171], v[80:95]
    ds_read_b128 v[184:187], v196 offset:128
    s_waitcnt lgkmcnt(2)
    v_mfma_f32_16x16x32_bf16 v[112:115], a[140:143], v[172:175], v[112:115]
    ds_read_b128 v[188:191], v198 offset:160
    v_mfma_f32_32x32x16_bf16 v[80:95], a[140:143], v[176:179], v[80:95]
    ds_read_b128 v[192:195], v197 offset:128
    s_add_u32 m0, s92, 36352
    s_nop 0
    buffer_load_dwordx4 v73, s[4:7], s99 offen offset:0  lds
    s_waitcnt lgkmcnt(2)
    s_waitcnt vmcnt(7)
    v_mfma_f32_16x16x32_bf16 v[112:115], a[144:147], v[180:183], v[112:115]
    ds_read_b128 v[160:163], v198 offset:192
    v_mfma_f32_32x32x16_bf16 v[80:95], a[144:147], v[184:187], v[80:95]
    ds_read_b128 v[164:167], v196 offset:192
    s_waitcnt lgkmcnt(2)
    s_waitcnt vmcnt(6)
    v_mfma_f32_16x16x32_bf16 v[112:115], a[148:151], v[188:191], v[112:115]
    ds_read_b128 v[168:171], v198 offset:224
    v_mfma_f32_32x32x16_bf16 v[80:95], a[148:151], v[192:195], v[80:95]
    ds_read_b128 v[172:175], v197 offset:192
    buffer_load_dwordx4 v74, s[4:7], s99 offen offset:1088  lds
    s_waitcnt lgkmcnt(2)
    s_waitcnt vmcnt(6)
    v_mfma_f32_16x16x32_bf16 v[112:115], a[152:155], v[160:163], v[112:115]
    ds_read_b128 v[176:179], v196 offset:8704
    v_mfma_f32_32x32x16_bf16 v[80:95], a[152:155], v[164:167], v[80:95]
    ds_read_b128 v[180:183], v197 offset:8704
    s_waitcnt lgkmcnt(2)
    s_waitcnt vmcnt(5)
    v_mfma_f32_16x16x32_bf16 v[112:115], a[156:159], v[168:171], v[112:115]
    ds_read_b128 v[184:187], v196 offset:8768
    v_mfma_f32_32x32x16_bf16 v[80:95], a[156:159], v[172:175], v[80:95]
    ds_read_b128 v[188:191], v197 offset:8768
    buffer_load_dwordx4 v75, s[4:7], s99 offen offset:2176  lds
    s_waitcnt lgkmcnt(2)
    v_mfma_f32_32x32x16_bf16 v[96:111], a[128:131], v[176:179], v[96:111]
    ds_read_b128 v[192:195], v196 offset:8832
    v_mfma_f32_32x32x16_bf16 v[96:111], a[132:135], v[180:183], v[96:111]
    ds_read_b128 v[160:163], v197 offset:8832
    buffer_load_dwordx4 v76, s[4:7], s99 offen offset:3264  lds
    s_mov_b32 exec_lo, 0x01010101
    s_mov_b32 exec_hi, 0x01010101
    ds_write_b128 v132, v[112:115]
    s_mov_b64 exec, -1
    s_waitcnt lgkmcnt(3)
    v_mfma_f32_32x32x16_bf16 v[96:111], a[136:139], v[184:187], v[96:111]
    ds_read_b128 v[164:167], v196 offset:8896
    ds_read_b128 v[24:27], v132
    ds_read_b128 v[8:11], v133 offset:0
    ds_read_b128 v[12:15], v133 offset:32
    ds_read_b128 v[16:19], v133 offset:64
    v_mfma_f32_32x32x16_bf16 v[96:111], a[140:143], v[188:191], v[96:111]
    ds_read_b128 v[168:171], v197 offset:8896
    s_add_u32 m0, s93, 53760
    s_add_u32 s99, s99, 256
    s_mov_b64 exec, s[80:81]
    buffer_load_dwordx4 v77, s[4:7], s100 offen  lds
    s_mov_b64 exec, -1
    s_add_u32 s100, s100, 256
    ds_read_b128 v[20:23], v133 offset:96
    s_waitcnt vmcnt(5) lgkmcnt(5)
    v_mul_f32 v148, v24, v157
    v_mfma_f32_32x32x16_bf16 v[96:111], a[144:147], v[192:195], v[96:111]
    v_mul_f32 v149, v25, v157
    v_mul_f32 v150, v26, v157
    v_mul_f32 v151, v27, v157
    s_waitcnt lgkmcnt(4)
    v_mul_f32 v116, v8, v153
    v_mul_f32 v117, v9, v153
    v_mfma_f32_32x32x16_bf16 v[96:111], a[148:151], v[160:163], v[96:111]
    v_mul_f32 v118, v10, v153
    v_mul_f32 v119, v11, v153
    s_waitcnt lgkmcnt(3)
    v_mul_f32 v120, v12, v153
    v_mul_f32 v121, v13, v153
    s_waitcnt lgkmcnt(1)
    v_mfma_f32_32x32x16_bf16 v[96:111], a[152:155], v[164:167], v[96:111]
    v_mul_f32 v122, v14, v153
    v_mul_f32 v123, v15, v153
    v_mul_f32 v124, v16, v153
    v_mul_f32 v125, v17, v153
    v_mul_f32_e64 v126, v18, v153
    v_mfma_f32_32x32x16_bf16 v[96:111], a[156:159], v[168:171], v[96:111]
    s_add_u32 m0, s92, 55936
    s_nop 0
    buffer_load_dwordx4 v73, s[4:7], s99 offen offset:0  lds
    v_mul_f32 v127, v19, v153
    s_waitcnt lgkmcnt(0)
    v_mul_f32 v128, v20, v153
    v_mul_f32 v129, v21, v153
    v_mul_f32 v130, v22, v153
    v_mul_f32_e64 v131, v23, v153
    v_fma_f32 v112, v112, v156, v148
    v_fma_f32 v113, v113, v156, v149
    v_fma_f32 v114, v114, v156, v150
    v_fma_f32 v115, v115, v156, v151
    v_cvt_pk_bf16_f32 v112, v112, v113
    v_cvt_pk_bf16_f32 v113, v114, v115
    v_fma_f32 v80, v80, v152, v116
    v_fma_f32 v81, v81, v152, v117
    v_fma_f32 v82, v82, v152, v118
    v_fma_f32 v83, v83, v152, v119
    v_cvt_pk_bf16_f32 v80, v80, v81
    v_cvt_pk_bf16_f32 v81, v82, v83
    ds_write_b64 v40, v[112:113] offset:0
    ds_write_b64 v38, v[80:81] offset:0
    v_fma_f32 v84, v84, v152, v120
    v_fma_f32 v85, v85, v152, v121
    v_fma_f32 v86, v86, v152, v122
    v_fma_f32 v87, v87, v152, v123
    v_cvt_pk_bf16_f32 v84, v84, v85
    v_cvt_pk_bf16_f32 v85, v86, v87
    v_fma_f32 v88, v88, v152, v124
    v_fma_f32 v89, v89, v152, v125
    v_fma_f32 v90, v90, v152, v126
    v_fma_f32 v91, v91, v152, v127
    v_cvt_pk_bf16_f32 v88, v88, v89
    v_cvt_pk_bf16_f32 v89, v90, v91
    ds_write_b64 v38, v[84:85] offset:6400
    ds_write_b64 v38, v[88:89] offset:12800
    v_fma_f32 v92, v92, v152, v128
    v_fma_f32 v93, v93, v152, v129
    v_fma_f32 v94, v94, v152, v130
    v_fma_f32 v95, v95, v152, v131
    v_cvt_pk_bf16_f32 v92, v92, v93
    v_cvt_pk_bf16_f32 v93, v94, v95
    ds_write_b64 v39, v[92:93] offset:0
    v_mul_f32 v132, v8, v155
    v_mul_f32 v133, v9, v155
    v_mul_f32 v134, v10, v155
    v_mul_f32 v135, v11, v155
    v_mul_f32 v136, v12, v155
    v_mul_f32 v137, v13, v155
    v_mul_f32 v138, v14, v155
    v_mul_f32 v139, v15, v155
    v_mul_f32 v140, v16, v155
    v_mul_f32 v141, v17, v155
    v_mul_f32 v142, v18, v155
    v_mul_f32 v143, v19, v155
    v_mul_f32 v144, v20, v155
    v_mul_f32 v145, v21, v155
    v_mul_f32 v146, v22, v155
    v_mul_f32 v147, v23, v155
    v_pk_fma_f32 v[96:97], v[96:97], v[154:155], v[132:133] op_sel_hi:[1,0,1]
    v_pk_fma_f32 v[98:99], v[98:99], v[154:155], v[134:135] op_sel_hi:[1,0,1]
    v_cvt_pk_bf16_f32 v96, v96, v97
    v_cvt_pk_bf16_f32 v97, v98, v99
    v_pk_fma_f32 v[100:101], v[100:101], v[154:155], v[136:137] op_sel_hi:[1,0,1]
    v_pk_fma_f32 v[102:103], v[102:103], v[154:155], v[138:139] op_sel_hi:[1,0,1]
    v_cvt_pk_bf16_f32 v100, v100, v101
    v_cvt_pk_bf16_f32 v101, v102, v103
    ds_write_b64 v38, v[96:97] offset:1600
    ds_write_b64 v38, v[100:101] offset:8000
    v_pk_fma_f32 v[104:105], v[104:105], v[154:155], v[140:141] op_sel_hi:[1,0,1]
    v_pk_fma_f32 v[106:107], v[106:107], v[154:155], v[142:143] op_sel_hi:[1,0,1]
    v_cvt_pk_bf16_f32 v104, v104, v105
    v_cvt_pk_bf16_f32 v105, v106, v107
    v_pk_fma_f32 v[108:109], v[108:109], v[154:155], v[144:145] op_sel_hi:[1,0,1]
    v_pk_fma_f32 v[110:111], v[110:111], v[154:155], v[146:147] op_sel_hi:[1,0,1]
    v_cvt_pk_bf16_f32 v108, v108, v109
    v_cvt_pk_bf16_f32 v109, v110, v111
    ds_write_b64 v38, v[104:105] offset:14400
    ds_write_b64 v39, v[108:109] offset:1600
    s_waitcnt lgkmcnt(0)
    s_barrier
    v_mov_b32 v94, 0
    v_mov_b32 v95, 0
    v_mov_b32 v98, 0
    v_mov_b32 v99, 0
    s_mov_b64 exec, 0xffff
    ds_read_b64 v[94:95], v42 offset:320
    ds_read_b64 v[98:99], v42 offset:640
    s_mov_b64 exec, -1
    s_nop 0
    ds_read_b64 v[92:93], v41 offset:320
    ds_read_b64 v[96:97], v41 offset:640
    ds_read_b64 v[84:85], v41 offset:6720
    ds_read_b64 v[86:87], v42 offset:6720
    ds_read_b64 v[80:81], v41 offset:6400
    ds_read_b64 v[82:83], v42 offset:6400
    ds_read_b64 v[88:89], v41 offset:7040
    ds_read_b64 v[90:91], v42 offset:7040
    ds_read_b64_tr_b16 v[106:107], v44 offset:0
    ds_read_b64_tr_b16 v[100:101], v43 offset:0
    ds_read_b64_tr_b16 v[108:109], v44 offset:320
    ds_read_b64_tr_b16 v[102:103], v43 offset:320
    buffer_load_dwordx4 v74, s[4:7], s99 offen offset:1088  lds
    ds_read_b64_tr_b16 v[110:111], v44 offset:640
    ds_read_b64_tr_b16 v[104:105], v43 offset:640
    v_mov_b32 v156, 0xf149f2ca
    v_cndmask_b32 v152, v32, v156, s[90:91]
    v_cndmask_b32 v153, v33, v156, s[90:91]
    v_cndmask_b32 v154, v34, v156, s[90:91]
    v_cndmask_b32 v155, v35, v156, s[90:91]
    s_mov_b32 s82, 0x3ea52b5c
    buffer_load_dwordx4 v75, s[4:7], s99 offen offset:2176  lds
    s_lshl_b32 s25, s98, 4
    s_add_u32 s25, s25, 4194304
    s_lshl_b32 s26, s98, 3
    s_add_u32 s26, s26, 4194304
    s_waitcnt lgkmcnt(10)
    v_mfma_f32_16x16x32_bf16 v[116:119], v[84:87], v[92:95], v[28:31]
    v_mfma_f32_16x16x32_bf16 v[120:123], v[84:87], v[96:99], v[32:35]
    s_waitcnt lgkmcnt(8)
    v_mfma_f32_16x16x32_bf16 v[112:115], v[80:83], v[92:95], v[152:155]
    s_waitcnt lgkmcnt(6)
    v_mfma_f32_16x16x32_bf16 v[124:127], v[88:91], v[96:99], v[28:31]
    buffer_load_dwordx4 v76, s[4:7], s99 offen offset:3264  lds
    s_nop 4
    v_max_f32 v112, v112, v116
    v_max_f32 v113, v113, v117
    v_max_f32 v114, v114, v118
    v_max_f32 v115, v115, v119
    v_max3_f32 v156, v112, v113, v114
    v_max_f32 v156, v156, v115
    v_max_f32 v120, v120, v124
    v_max_f32_e64 v121, v121, v125
    s_add_u32 m0, s93, 73344
    s_add_u32 s99, s99, 256
    s_mov_b64 exec, s[80:81]
    buffer_load_dwordx4 v77, s[4:7], s100 offen  lds
    s_mov_b64 exec, -1
    s_add_u32 s100, s100, 256
    v_max_f32 v122, v122, v126
    v_max_f32 v123, v123, v127
    v_max3_f32 v157, v120, v121, v122
    v_max_f32 v157, v157, v123
    s_nop 1
    v_permlane16_swap_b32 v156, v157
    v_max_f32 v156, v156, v157
    v_mov_b32 v157, v156
    s_nop 1
    v_permlane32_swap_b32 v156, v157
    s_add_u32 m0, s92, 75520
    s_nop 0
    buffer_load_dwordx4 v73, s[4:7], s99 offen offset:0  lds
    v_max_f32 v156, v156, v157
    v_mul_f32 v156, s82, v156
    v_mov_b32 v157, v156
    s_nop 1
    v_permlane16_swap_b32_e64 v156, v157
    v_fma_f32 v112, v112, s82, -v156
    v_fma_f32 v113, v113, s82, -v156
    v_fma_f32 v114, v114, s82, -v156
    v_fma_f32 v115, v115, s82, -v156
    buffer_load_dwordx4 v74, s[4:7], s99 offen offset:1088  lds
    v_exp_f32 v112, v112
    v_exp_f32 v113, v113
    v_exp_f32 v114, v114
    v_exp_f32 v115, v115
    v_cvt_pk_bf16_f32 v116, v112, v113
    v_cvt_pk_bf16_f32 v117, v114, v115
    v_bfi_b32 v128, v36, 0, v116
    v_and_b32_e64 v130, v36, v116
    buffer_load_dwordx4 v75, s[4:7], s99 offen offset:2176  lds
    v_bfi_b32 v129, v37, 0, v117
    v_and_b32 v131, v37, v117
    s_waitcnt lgkmcnt(3)
    s_nop 0
    v_mfma_f32_16x16x32_bf16 v[144:147], v[106:109], v[128:131], 0
    s_waitcnt lgkmcnt(2)
    v_mfma_f32_16x16x32_bf16 v[136:139], v[100:103], v[128:131], 0
    v_fma_f32 v120, v120, s82, -v157
    v_fma_f32 v121, v121, s82, -v157
    v_fma_f32 v122, v122, s82, -v157
    v_fma_f32 v123, v123, s82, -v157
    buffer_load_dwordx4 v76, s[4:7], s99 offen offset:3264  lds
    v_exp_f32 v120, v120
    v_exp_f32 v121, v121
    v_exp_f32 v122, v122
    v_exp_f32 v123, v123
    v_cvt_pk_bf16_f32 v124, v120, v121
    v_cvt_pk_bf16_f32 v125, v122, v123
    v_bfi_b32 v132, v36, 0, v124
    v_and_b32_e64 v134, v36, v124
    s_add_u32 m0, s93, 92928
    s_add_u32 s99, s99, 256
    s_mov_b64 exec, s[80:81]
    buffer_load_dwordx4 v77, s[4:7], s100 offen  lds
    s_mov_b64 exec, -1
    s_add_u32 s100, s100, 256
    v_bfi_b32 v133, v37, 0, v125
    v_and_b32 v135, v37, v125
    s_waitcnt lgkmcnt(1)
    s_nop 0
    v_mfma_f32_16x16x32_bf16 v[148:151], v[108:111], v[132:135], 0
    s_waitcnt lgkmcnt(0)
    v_mfma_f32_16x16x32_bf16 v[140:143], v[102:105], v[132:135], 0
    v_mov_b32 v158, v144
    s_nop 1
    v_permlane16_swap_b32 v144, v158
    v_rcp_f32 v158, v158
    s_nop 0
    v_pk_mul_f32 v[136:137], v[136:137], v[158:159] op_sel_hi:[1,0]
    s_lshl_b32 s97, s73, 2
    s_add_u32 s97, s97, s24
    s_nop 0
    s_mul_i32 s97, s97, 25600
    s_add_u32 s97, s97, 2621440
    buffer_load_dwordx4 a[160:163], v58, s[16:19], s97 offen offset:0 sc1
    v_pk_mul_f32 v[138:139], v[138:139], v[158:159] op_sel_hi:[1,0]
    v_pk_mul_f32 v[144:145], v[144:145], v[158:159] op_sel_hi:[1,0]
    v_pk_mul_f32 v[146:147], v[146:147], v[158:159] op_sel_hi:[1,0]
    v_cvt_pk_bf16_f32 v112, v136, v137
    v_cvt_pk_bf16_f32 v116, v144, v145
    v_cvt_pk_bf16_f32 v113, v138, v139
    v_cvt_pk_bf16_f32 v117, v146, v147
    v_mov_b32 v160, v148
    buffer_load_dwordx4 a[164:167], v58, s[16:19], s97 offen offset:1024 sc1
    s_nop 0
    v_permlane16_swap_b32 v148, v160
    v_rcp_f32_e64 v160, v160
    s_nop 0
    v_pk_mul_f32 v[140:141], v[140:141], v[160:161] op_sel_hi:[1,0]
    v_pk_mul_f32 v[142:143], v[142:143], v[160:161] op_sel_hi:[1,0]
    v_pk_mul_f32 v[148:149], v[148:149], v[160:161] op_sel_hi:[1,0]
    v_pk_mul_f32 v[150:151], v[150:151], v[160:161] op_sel_hi:[1,0]
    v_cvt_pk_bf16_f32 v114, v140, v141
    v_cvt_pk_bf16_f32 v118, v148, v149
    buffer_load_dwordx4 a[168:171], v58, s[16:19], s97 offen offset:2048 sc1
    v_cvt_pk_bf16_f32 v115, v142, v143
    v_cvt_pk_bf16_f32 v119, v150, v151
    v_permlane16_swap_b32 v112, v114
    v_permlane16_swap_b32 v113, v115
    v_permlane16_swap_b32 v116, v118
    v_permlane16_swap_b32 v117, v119
    buffer_store_dwordx4 v[112:115], v45, s[16:19], s25 offen sc1
    s_mov_b64 exec, s[80:81]
    buffer_store_dwordx2 v[116:117], v46, s[16:19], s26 offen sc1
    s_mov_b64 exec, -1
    buffer_load_dwordx4 a[172:175], v58, s[16:19], s97 offen offset:3072 sc1
    s_add_u32 s97, s97, 4096
    buffer_load_dwordx4 a[176:179], v58, s[16:19], s97 offen offset:0 sc1
    v_add_u32 v196, 36352, v78
    v_mov_b32 v198, v79
    v_xor_b32 v197, 32, v196
    s_waitcnt vmcnt(17)
    s_barrier
    ds_read_b128 v[160:163], v198 offset:0
    ds_read_b128 v[164:167], v196 offset:0
    ds_read_b128 v[168:171], v196 offset:8704
    ds_read_b128 v[172:175], v198 offset:32
    ds_read_b128 v[176:179], v197 offset:0
    ds_read_b128 v[180:183], v197 offset:8704
    s_waitcnt lgkmcnt(3)
    v_mfma_f32_16x16x32_bf16 v[112:115], a[0:3], v[160:163], 0
    ds_read_b128 v[184:187], v198 offset:64
    v_mfma_f32_32x32x16_bf16 v[80:95], a[0:3], v[164:167], 0
    ds_read_b128 v[188:191], v196 offset:64
    s_lshl_b32 s59, s24, 12
    v_lshl_add_u32 v62, v1, 4, s59
    s_mul_i32 s59, s24, 1216
    s_add_u32 s59, s59, 192
    v_mfma_f32_32x32x16_bf16 v[96:111], a[0:3], v[168:171], 0
    ds_read_b128 v[192:195], v196 offset:8768
    s_add_u32 m0, s92, 95104
    s_nop 0
    buffer_load_dwordx4 v73, s[4:7], s99 offen offset:0  lds
    v_lshl_add_u32 v63, v1, 2, s59
    s_waitcnt lgkmcnt(3)
    v_mfma_f32_16x16x32_bf16 v[112:115], a[4:7], v[172:175], v[112:115]
    ds_read_b128 v[160:163], v198 offset:96
    v_mfma_f32_32x32x16_bf16 v[80:95], a[4:7], v[176:179], v[80:95]
    ds_read_b128 v[164:167], v197 offset:64
    s_mul_i32 s59, s24, 4864
    s_add_u32 s59, s59, 80
    v_and_b32_e64 v70, 3, v1
    v_mul_u32_u24 v70, 1216, v70
    v_mfma_f32_32x32x16_bf16 v[96:111], a[4:7], v[180:183], v[96:111]
    ds_read_b128 v[168:171], v197 offset:8768
    buffer_load_dwordx4 v74, s[4:7], s99 offen offset:1088  lds
    v_bfe_u32 v71, v1, 2, 3
    v_lshl_add_u32 v70, v71, 4, v70
    s_waitcnt lgkmcnt(3)
    v_mfma_f32_16x16x32_bf16 v[112:115], a[8:11], v[184:187], v[112:115]
    ds_read_b128 v[172:175], v198 offset:128
    v_mfma_f32_32x32x16_bf16 v[80:95], a[8:11], v[188:191], v[80:95]
    ds_read_b128 v[176:179], v196 offset:128
    v_lshrrev_b32 v71, 5, v1
    v_lshl_add_u32 v70, v71, 4, v70
    v_add_u32_e64 v64, s59, v70
    s_mul_i32 s59, s24, 4160
    v_mfma_f32_32x32x16_bf16 v[96:111], a[8:11], v[192:195], v[96:111]
    ds_read_b128 v[180:183], v196 offset:8832
    buffer_load_dwordx4 v75, s[4:7], s99 offen offset:2176  lds
    s_add_u32 s59, s59, 134368
    v_lshlrev_b32 v71, 6, v71
    s_waitcnt lgkmcnt(3)
    v_mfma_f32_16x16x32_bf16 v[112:115], a[12:15], v[160:163], v[112:115]
    ds_read_b128 v[184:187], v198 offset:160
    v_mfma_f32_32x32x16_bf16 v[80:95], a[12:15], v[164:167], v[80:95]
    ds_read_b128 v[188:191], v197 offset:128
    v_sub_u32_e64 v71, s59, v71
    v_bfe_u32 v70, v1, 4, 1
    v_lshl_add_u32 v71, v70, 5, v71
    v_and_b32_e64 v70, 3, v1
    v_mfma_f32_32x32x16_bf16 v[96:111], a[12:15], v[168:171], v[96:111]
    ds_read_b128 v[192:195], v197 offset:8832
    buffer_load_dwordx4 v76, s[4:7], s99 offen offset:3264  lds
    v_lshl_add_u32 v71, v70, 3, v71
    v_bfe_u32 v70, v1, 2, 2
    s_waitcnt lgkmcnt(3)
    v_mfma_f32_16x16x32_bf16 v[112:115], a[16:19], v[172:175], v[112:115]
    ds_read_b128 v[160:163], v198 offset:192
    v_mfma_f32_32x32x16_bf16 v[80:95], a[16:19], v[176:179], v[80:95]
    ds_read_b128 v[164:167], v196 offset:192
    v_lshlrev_b32 v70, 3, v70
    v_sub_u32_e64 v65, v71, v70
    s_mul_i32 s59, s24, 4224
    s_add_u32 s59, s59, 19456
    v_mfma_f32_32x32x16_bf16 v[96:111], a[16:19], v[180:183], v[96:111]
    ds_read_b128 v[168:171], v196 offset:8896
    s_add_u32 m0, s93, 112512
    s_add_u32 s99, s99, 256
    s_mov_b64 exec, s[80:81]
    buffer_load_dwordx4 v77, s[4:7], s100 offen  lds
    s_mov_b64 exec, -1
    s_add_u32 s100, s100, 256
    s_waitcnt lgkmcnt(3)
    v_mfma_f32_16x16x32_bf16 v[112:115], a[20:23], v[184:187], v[112:115]
    ds_read_b128 v[172:175], v198 offset:224
    v_mfma_f32_32x32x16_bf16 v[80:95], a[20:23], v[188:191], v[80:95]
    ds_read_b128 v[176:179], v197 offset:192
    v_and_b32 v70, 3, v1
    v_mul_u32_u24 v70, 1056, v70
    v_and_b32_e64 v71, 60, v1
    v_add3_u32 v66, v70, v71, s59
    v_mfma_f32_32x32x16_bf16 v[96:111], a[20:23], v[192:195], v[96:111]
    ds_read_b128 v[180:183], v197 offset:8896
    s_add_u32 m0, s92, 114688
    s_nop 0
    buffer_load_dwordx4 v73, s[4:7], s99 offen offset:0  lds
    s_mul_i32 s59, s24, 1056
    s_waitcnt vmcnt(18)
    s_barrier
    s_waitcnt lgkmcnt(3)
    v_mfma_f32_16x16x32_bf16 v[112:115], a[24:27], v[160:163], v[112:115]
    v_add_u32_e64 v198, v49, v198
    v_mfma_f32_32x32x16_bf16 v[80:95], a[24:27], v[164:167], v[80:95]
    v_add_u32 v196, 19584, v196
    v_add_u32 v197, 19584, v197
    ds_read_b128 v[184:187], v198 offset:0
    s_add_u32 s59, s59, 19456
    v_lshl_add_u32 v67, v1, 3, s59
    v_mfma_f32_32x32x16_bf16 v[96:111], a[24:27], v[168:171], v[96:111]
    ds_read_b128 v[188:191], v196 offset:0
    ds_read_b128 v[192:195], v196 offset:8704
    buffer_load_dwordx4 v74, s[4:7], s99 offen offset:1088  lds
    s_mul_i32 s59, s24, 1280
    s_waitcnt lgkmcnt(3)
    v_mfma_f32_16x16x32_bf16 v[112:115], a[28:31], v[172:175], v[112:115]
    ds_read_b128 v[160:163], v198 offset:32
    v_mfma_f32_32x32x16_bf16 v[80:95], a[28:31], v[176:179], v[80:95]
    ds_read_b128 v[164:167], v197 offset:0
    s_lshl_b32 s60, s75, 3
    s_add_u32 s59, s59, s60
    v_mul_u32_u24 v70, 10240, v1
    v_add_u32 v68, s59, v70
    v_mfma_f32_32x32x16_bf16 v[96:111], a[28:31], v[180:183], v[96:111]
    ds_read_b128 v[168:171], v197 offset:8704
    buffer_load_dwordx4 v75, s[4:7], s99 offen offset:2176  lds
    s_waitcnt lgkmcnt(3)
    v_mfma_f32_16x16x32_bf16 v[112:115], a[32:35], v[184:187], v[112:115]
    ds_read_b128 v[172:175], v198 offset:64
    v_mfma_f32_32x32x16_bf16 v[80:95], a[32:35], v[188:191], v[80:95]
    ds_read_b128 v[176:179], v196 offset:64
    v_mfma_f32_32x32x16_bf16 v[96:111], a[32:35], v[192:195], v[96:111]
    ds_read_b128 v[180:183], v196 offset:8768
    buffer_load_dwordx4 v76, s[4:7], s99 offen offset:3264  lds
    s_waitcnt lgkmcnt(3)
    v_mfma_f32_16x16x32_bf16 v[112:115], a[36:39], v[160:163], v[112:115]
    ds_read_b128 v[184:187], v198 offset:96
    v_mfma_f32_32x32x16_bf16 v[80:95], a[36:39], v[164:167], v[80:95]
    ds_read_b128 v[188:191], v197 offset:64
    v_mfma_f32_32x32x16_bf16 v[96:111], a[36:39], v[168:171], v[96:111]
    ds_read_b128 v[192:195], v197 offset:8768
    s_add_u32 m0, s93, 132096
    s_add_u32 s99, s99, 256
    s_mov_b64 exec, s[80:81]
    buffer_load_dwordx4 v77, s[4:7], s100 offen  lds
    s_mov_b64 exec, -1
    s_add_u32 s100, s100, 256
    s_waitcnt lgkmcnt(3)
    v_mfma_f32_16x16x32_bf16 v[112:115], a[40:43], v[172:175], v[112:115]
    ds_read_b128 v[160:163], v198 offset:128
    v_mfma_f32_32x32x16_bf16 v[80:95], a[40:43], v[176:179], v[80:95]
    ds_read_b128 v[164:167], v196 offset:128
    s_lshl_b32 s25, s24, 6
    s_and_b32 s35, s74, 3
    s_lshl_b32 s35, s35, 13
    s_add_u32 s35, s35, s25
    v_mfma_f32_32x32x16_bf16 v[96:111], a[40:43], v[180:183], v[96:111]
    ds_read_b128 v[168:171], v196 offset:8832
    s_lshl_b32 s98, s72, 5
    s_add_u32 s98, s98, 256
    s_sub_u32 s95, s98, 4
    s_max_i32 s95, s95, 0
    s_lshl_b32 s94, s98, 3
    s_lshl_b32 s95, s95, 3
    s_add_u32 s94, s94, 3440640
    s_add_u32 s95, s95, 3440640
    s_add_u32 s96, s94, 8192
    buffer_load_dwordx2 v[152:153], v47, s[16:19], s94 offen sc1
    s_waitcnt lgkmcnt(3)
    v_mfma_f32_16x16x32_bf16 v[112:115], a[44:47], v[184:187], v[112:115]
    ds_read_b128 v[172:175], v198 offset:160
    v_mfma_f32_32x32x16_bf16 v[80:95], a[44:47], v[188:191], v[80:95]
    ds_read_b128 v[176:179], v197 offset:128
    s_lshr_b32 s25, s74, 4
    s_lshl_b32 s25, s25, 11
    s_add_u32 s35, s35, s25
    s_and_b32 s25, s74, 12
    v_mfma_f32_32x32x16_bf16 v[96:111], a[44:47], v[192:195], v[96:111]
    ds_read_b128 v[180:183], v197 offset:8832
    buffer_load_dwordx2 v[154:155], v47, s[16:19], s96 offen sc1
    s_lshl_b32 s25, s25, 6
    s_add_u32 s35, s35, s25
    s_waitcnt lgkmcnt(3)
    v_mfma_f32_16x16x32_bf16 v[112:115], a[48:51], v[160:163], v[112:115]
    ds_read_b128 v[184:187], v198 offset:192
    v_mfma_f32_32x32x16_bf16 v[80:95], a[48:51], v[164:167], v[80:95]
    ds_read_b128 v[188:191], v196 offset:192
    s_mul_i32 s36, s73, 20
    s_add_u32 s36, s36, s24
    s_add_u32 s36, s36, 16
    s_lshl_b32 s36, s36, 14
    v_mfma_f32_32x32x16_bf16 v[96:111], a[48:51], v[168:171], v[96:111]
    ds_read_b128 v[192:195], v196 offset:8896
    buffer_load_dwordx2 v[156:157], v48, s[16:19], s95 offen sc1
    v_add_u32 v199, 36352, v58
    s_lshl_b32 s32, s24, 11
    s_waitcnt lgkmcnt(3)
    v_mfma_f32_16x16x32_bf16 v[112:115], a[52:55], v[172:175], v[112:115]
    ds_read_b128 v[160:163], v198 offset:224
    v_mfma_f32_32x32x16_bf16 v[80:95], a[52:55], v[176:179], v[80:95]
    ds_read_b128 v[164:167], v197 offset:192
    v_add_u32_e64 v203, s32, v199
    s_add_u32 s32, s24, 1
    s_and_b32 s32, s32, 3
    s_mul_i32 s32, s32, 6144
    v_mfma_f32_32x32x16_bf16 v[96:111], a[52:55], v[180:183], v[96:111]
    ds_read_b128 v[168:171], v197 offset:8896
    buffer_load_dwordx4 a[180:183], v58, s[16:19], s97 offen offset:1024 sc1
    v_add_u32 v200, s32, v199
    s_add_u32 s32, s24, 2
    s_waitcnt vmcnt(21)
    s_barrier
    s_waitcnt lgkmcnt(3)
    v_mfma_f32_16x16x32_bf16 v[112:115], a[56:59], v[184:187], v[112:115]
    v_add_u32 v198, v49, v198
    v_mfma_f32_32x32x16_bf16 v[80:95], a[56:59], v[188:191], v[80:95]
    v_add_u32 v196, 19584, v196
    v_add_u32 v197, 19584, v197
    ds_read_b128 v[172:175], v198 offset:0
    s_and_b32 s32, s32, 3
    s_mul_i32 s32, s32, 6144
    v_mfma_f32_32x32x16_bf16 v[96:111], a[56:59], v[192:195], v[96:111]
    ds_read_b128 v[176:179], v196 offset:0
    ds_read_b128 v[180:183], v196 offset:8704
    buffer_load_dwordx4 a[184:187], v58, s[16:19], s97 offen offset:2048 sc1
    v_add_u32_e64 v201, s32, v199
    s_waitcnt lgkmcnt(3)
    v_mfma_f32_16x16x32_bf16 v[112:115], a[60:63], v[160:163], v[112:115]
    ds_read_b128 v[184:187], v198 offset:32
    v_mfma_f32_32x32x16_bf16 v[80:95], a[60:63], v[164:167], v[80:95]
    ds_read_b128 v[188:191], v197 offset:0
    s_add_u32 s32, s24, 3
    s_and_b32 s32, s32, 3
    s_mul_i32 s32, s32, 6144
    v_add_u32_e64 v202, s32, v199
    v_mfma_f32_32x32x16_bf16 v[96:111], a[60:63], v[168:171], v[96:111]
    ds_read_b128 v[192:195], v197 offset:8704
    buffer_load_dwordx4 a[188:191], v58, s[16:19], s97 offen offset:3072 sc1
    s_mul_i32 s32, s24, 6144
    v_add_u32 v204, s32, v199
    s_waitcnt lgkmcnt(3)
    v_mfma_f32_16x16x32_bf16 v[112:115], a[64:67], v[172:175], v[112:115]
    ds_read_b128 v[160:163], v198 offset:64
    v_mfma_f32_32x32x16_bf16 v[80:95], a[64:67], v[176:179], v[80:95]
    ds_read_b128 v[164:167], v196 offset:64
    s_lshl_b32 s32, s24, 8
    s_add_u32 s32, s32, 36352
    v_and_b32 v214, 15, v1
    v_lshl_add_u32 v206, v214, 4, s32
    v_mfma_f32_32x32x16_bf16 v[96:111], a[64:67], v[180:183], v[96:111]
    ds_read_b128 v[168:171], v196 offset:8768
    s_add_u32 s97, s97, 4096
    buffer_load_dwordx4 a[192:195], v58, s[16:19], s97 offen offset:0 sc1
    v_lshrrev_b32 v215, 5, v1
    s_waitcnt lgkmcnt(3)
    v_mfma_f32_16x16x32_bf16 v[112:115], a[68:71], v[184:187], v[112:115]
    ds_read_b128 v[172:175], v198 offset:96
    v_mfma_f32_32x32x16_bf16 v[80:95], a[68:71], v[188:191], v[80:95]
    ds_read_b128 v[176:179], v197 offset:64
    v_lshl_add_u32 v205, v215, 10, v206
    v_bfe_u32 v215, v1, 4, 1
    v_lshl_add_u32 v205, v215, 3, v205
    v_lshlrev_b32_e64 v214, 2, v214
    v_mfma_f32_32x32x16_bf16 v[96:111], a[68:71], v[192:195], v[96:111]
    ds_read_b128 v[180:183], v197 offset:8768
    buffer_load_dwordx4 a[196:199], v58, s[16:19], s97 offen offset:1024 sc1
    v_lshl_add_u32 v214, v215, 10, v214
    s_lshl_b32 s32, s24, 6
    s_waitcnt lgkmcnt(3)
    v_mfma_f32_16x16x32_bf16 v[112:115], a[72:75], v[160:163], v[112:115]
    ds_read_b128 v[184:187], v198 offset:128
    v_mfma_f32_32x32x16_bf16 v[80:95], a[72:75], v[164:167], v[80:95]
    ds_read_b128 v[188:191], v196 offset:128
    v_lshl_add_u32 v207, v215, 3, s32
    v_and_b32 v215, 12, v1
    v_lshl_add_u32 v207, v215, 2, v207
    v_and_b32 v215, 2, v1
    v_mfma_f32_32x32x16_bf16 v[96:111], a[72:75], v[168:171], v[96:111]
    ds_read_b128 v[192:195], v196 offset:8832
    buffer_load_dwordx4 a[200:203], v58, s[16:19], s97 offen offset:2048 sc1
    v_lshl_add_u32 v207, v215, 1, v207
    v_add_u32 v207, 69120, v207
    s_waitcnt lgkmcnt(3)
    v_mfma_f32_16x16x32_bf16 v[112:115], a[76:79], v[172:175], v[112:115]
    ds_read_b128 v[160:163], v198 offset:160
    v_mfma_f32_32x32x16_bf16 v[80:95], a[76:79], v[176:179], v[80:95]
    ds_read_b128 v[164:167], v197 offset:128
    v_lshrrev_b32 v215, 4, v1
    v_lshl_add_u32 v206, v215, 2, v206
    v_mov_b32 v215, 0x3f803f80
    v_mfma_f32_32x32x16_bf16 v[96:111], a[76:79], v[180:183], v[96:111]
    ds_read_b128 v[168:171], v197 offset:8832
    buffer_load_dwordx4 a[204:207], v58, s[16:19], s97 offen offset:3072 sc1
    s_waitcnt lgkmcnt(3)
    v_mfma_f32_16x16x32_bf16 v[112:115], a[80:83], v[184:187], v[112:115]
    ds_read_b128 v[172:175], v198 offset:192
    v_mfma_f32_32x32x16_bf16 v[80:95], a[80:83], v[188:191], v[80:95]
    ds_read_b128 v[176:179], v196 offset:192
    v_mfma_f32_32x32x16_bf16 v[96:111], a[80:83], v[192:195], v[96:111]
    ds_read_b128 v[180:183], v196 offset:8896
    s_add_u32 s97, s97, 4096
    buffer_load_dwordx4 a[208:211], v58, s[16:19], s97 offen offset:0 sc1
    s_waitcnt lgkmcnt(3)
    v_mfma_f32_16x16x32_bf16 v[112:115], a[84:87], v[160:163], v[112:115]
    ds_read_b128 v[184:187], v198 offset:224
    v_mfma_f32_32x32x16_bf16 v[80:95], a[84:87], v[164:167], v[80:95]
    ds_read_b128 v[188:191], v197 offset:192
    v_mfma_f32_32x32x16_bf16 v[96:111], a[84:87], v[168:171], v[96:111]
    ds_read_b128 v[192:195], v197 offset:8896
    buffer_load_dwordx4 a[212:215], v58, s[16:19], s97 offen offset:1024 sc1
    s_waitcnt vmcnt(17)
    s_barrier
    s_waitcnt lgkmcnt(3)
    v_mfma_f32_16x16x32_bf16 v[112:115], a[88:91], v[172:175], v[112:115]
    v_add_u32 v198, v49, v198
    v_mfma_f32_32x32x16_bf16 v[80:95], a[88:91], v[176:179], v[80:95]
    v_add_u32 v196, 19584, v196
    v_add_u32 v197, 19584, v197
    ds_read_b128 v[160:163], v198 offset:0
    v_mfma_f32_32x32x16_bf16 v[96:111], a[88:91], v[180:183], v[96:111]
    ds_read_b128 v[164:167], v196 offset:0
    ds_read_b128 v[168:171], v196 offset:8704
    buffer_load_dwordx4 a[216:219], v58, s[16:19], s97 offen offset:2048 sc1
    s_waitcnt lgkmcnt(3)
    v_mfma_f32_16x16x32_bf16 v[112:115], a[92:95], v[184:187], v[112:115]
    ds_read_b128 v[172:175], v198 offset:32
    v_mfma_f32_32x32x16_bf16 v[80:95], a[92:95], v[188:191], v[80:95]
    ds_read_b128 v[176:179], v197 offset:0
    v_mfma_f32_32x32x16_bf16 v[96:111], a[92:95], v[192:195], v[96:111]
    ds_read_b128 v[180:183], v197 offset:8704
    buffer_load_dwordx4 a[220:223], v58, s[16:19], s97 offen offset:3072 sc1
    s_waitcnt lgkmcnt(3)
    v_mfma_f32_16x16x32_bf16 v[112:115], a[96:99], v[160:163], v[112:115]
    ds_read_b128 v[184:187], v198 offset:64
    v_mfma_f32_32x32x16_bf16 v[80:95], a[96:99], v[164:167], v[80:95]
    ds_read_b128 v[188:191], v196 offset:64
    v_mfma_f32_32x32x16_bf16 v[96:111], a[96:99], v[168:171], v[96:111]
    ds_read_b128 v[192:195], v196 offset:8768
    s_add_u32 s97, s97, 4096
    buffer_load_dwordx4 a[224:227], v58, s[16:19], s97 offen offset:0 sc1
    s_waitcnt lgkmcnt(3)
    v_mfma_f32_16x16x32_bf16 v[112:115], a[100:103], v[172:175], v[112:115]
    ds_read_b128 v[160:163], v198 offset:96
    v_mfma_f32_32x32x16_bf16 v[80:95], a[100:103], v[176:179], v[80:95]
    ds_read_b128 v[164:167], v197 offset:64
    v_mfma_f32_32x32x16_bf16 v[96:111], a[100:103], v[180:183], v[96:111]
    ds_read_b128 v[168:171], v197 offset:8768
    buffer_load_dwordx4 a[228:231], v58, s[16:19], s97 offen offset:1024 sc1
    s_waitcnt lgkmcnt(3)
    v_mfma_f32_16x16x32_bf16 v[112:115], a[104:107], v[184:187], v[112:115]
    ds_read_b128 v[172:175], v198 offset:128
    v_mfma_f32_32x32x16_bf16 v[80:95], a[104:107], v[188:191], v[80:95]
    ds_read_b128 v[176:179], v196 offset:128
    v_mfma_f32_32x32x16_bf16 v[96:111], a[104:107], v[192:195], v[96:111]
    ds_read_b128 v[180:183], v196 offset:8832
    buffer_load_dwordx4 a[232:235], v58, s[16:19], s97 offen offset:2048 sc1
    s_waitcnt lgkmcnt(3)
    v_mfma_f32_16x16x32_bf16 v[112:115], a[108:111], v[160:163], v[112:115]
    ds_read_b128 v[184:187], v198 offset:160
    v_mfma_f32_32x32x16_bf16 v[80:95], a[108:111], v[164:167], v[80:95]
    ds_read_b128 v[188:191], v197 offset:128
    v_mfma_f32_32x32x16_bf16 v[96:111], a[108:111], v[168:171], v[96:111]
    ds_read_b128 v[192:195], v197 offset:8832
    buffer_load_dwordx4 a[236:239], v58, s[16:19], s97 offen offset:3072 sc1
    s_waitcnt lgkmcnt(3)
    v_mfma_f32_16x16x32_bf16 v[112:115], a[112:115], v[172:175], v[112:115]
    ds_read_b128 v[160:163], v198 offset:192
    v_mfma_f32_32x32x16_bf16 v[80:95], a[112:115], v[176:179], v[80:95]
    ds_read_b128 v[164:167], v196 offset:192
    v_mfma_f32_32x32x16_bf16 v[96:111], a[112:115], v[180:183], v[96:111]
    ds_read_b128 v[168:171], v196 offset:8896
    s_add_u32 s97, s97, 4096
    buffer_load_dwordx4 a[240:243], v58, s[16:19], s97 offen offset:0 sc1
    s_waitcnt lgkmcnt(3)
    v_mfma_f32_16x16x32_bf16 v[112:115], a[116:119], v[184:187], v[112:115]
    ds_read_b128 v[172:175], v198 offset:224
    v_mfma_f32_32x32x16_bf16 v[80:95], a[116:119], v[188:191], v[80:95]
    ds_read_b128 v[176:179], v197 offset:192
    v_mfma_f32_32x32x16_bf16 v[96:111], a[116:119], v[192:195], v[96:111]
    ds_read_b128 v[180:183], v197 offset:8896
    buffer_load_dwordx4 a[244:247], v58, s[16:19], s97 offen offset:1024 sc1
    s_waitcnt vmcnt(20)
    s_barrier
    s_waitcnt lgkmcnt(3)
    v_mfma_f32_16x16x32_bf16 v[112:115], a[120:123], v[160:163], v[112:115]
    v_add_u32_e64 v198, v49, v198
    v_mfma_f32_32x32x16_bf16 v[80:95], a[120:123], v[164:167], v[80:95]
    v_add_u32 v196, 19584, v196
    v_add_u32 v197, 19584, v197
    s_waitcnt vmcnt(17)
    v_mul_f32 v148, v24, v157
    v_mul_f32 v149, v25, v157
    v_mul_f32 v150, v26, v157
    v_mfma_f32_32x32x16_bf16 v[96:111], a[120:123], v[168:171], v[96:111]
    ds_read_b128 v[184:187], v198 offset:0
    ds_read_b128 v[188:191], v196 offset:0
    buffer_load_dwordx4 a[248:251], v58, s[16:19], s97 offen offset:2048 sc1
    v_mul_f32 v151, v27, v157
    v_mul_f32_e64 v116, v8, v153
    s_waitcnt lgkmcnt(2)
    v_mfma_f32_16x16x32_bf16 v[112:115], a[124:127], v[172:175], v[112:115]
    ds_read_b128 v[192:195], v198 offset:32
    v_mfma_f32_32x32x16_bf16 v[80:95], a[124:127], v[176:179], v[80:95]
    ds_read_b128 v[160:163], v197 offset:0
    v_mul_f32 v117, v9, v153
    v_mul_f32 v118, v10, v153
    v_mul_f32 v119, v11, v153
    v_mul_f32 v120, v12, v153
    v_mfma_f32_32x32x16_bf16 v[96:111], a[124:127], v[180:183], v[96:111]
    buffer_load_dwordx4 a[252:255], v58, s[16:19], s97 offen offset:3072 sc1
    v_mul_f32 v121, v13, v153
    v_mul_f32 v122, v14, v153
    v_mul_f32 v123, v15, v153
    s_waitcnt lgkmcnt(2)
    v_mfma_f32_16x16x32_bf16 v[112:115], a[128:131], v[184:187], v[112:115]
    ds_read_b128 v[164:167], v198 offset:64
    v_mfma_f32_32x32x16_bf16 v[80:95], a[128:131], v[188:191], v[80:95]
    ds_read_b128 v[168:171], v196 offset:64
    v_mul_f32 v124, v16, v153
    v_mul_f32 v125, v17, v153
    v_mul_f32 v126, v18, v153
    s_waitcnt lgkmcnt(2)
    v_mfma_f32_16x16x32_bf16 v[112:115], a[132:135], v[192:195], v[112:115]
    ds_read_b128 v[172:175], v198 offset:96
    v_mfma_f32_32x32x16_bf16 v[80:95], a[132:135], v[160:163], v[80:95]
    ds_read_b128 v[176:179], v197 offset:64
    s_add_u32 s97, s97, 4096
    buffer_load_dwordx4 v[52:55], v58, s[16:19], s97 offen offset:0 sc1
    v_mul_f32 v127, v19, v153
    v_mul_f32_e64 v128, v20, v153
    s_waitcnt lgkmcnt(2)
    v_mfma_f32_16x16x32_bf16 v[112:115], a[136:139], v[164:167], v[112:115]
    ds_read_b128 v[180:183], v198 offset:128
    v_mfma_f32_32x32x16_bf16 v[80:95], a[136:139], v[168:171], v[80:95]
    ds_read_b128 v[184:187], v196 offset:128
    v_mul_f32 v129, v21, v153
    v_mul_f32 v130, v22, v153
    v_mul_f32 v131, v23, v153
    s_waitcnt lgkmcnt(2)
    v_mfma_f32_16x16x32_bf16 v[112:115], a[140:143], v[172:175], v[112:115]
    ds_read_b128 v[188:191], v198 offset:160
    v_mfma_f32_32x32x16_bf16 v[80:95], a[140:143], v[176:179], v[80:95]
    ds_read_b128 v[192:195], v197 offset:128
    s_mov_b32 s96, 4194304
    buffer_load_dwordx4 v[216:219], v56, s[16:19], s96 offen offset:0 sc1
    v_mul_f32 v132, v8, v155
    v_mul_f32_e64 v133, v9, v155
    s_waitcnt lgkmcnt(2)
    v_mfma_f32_16x16x32_bf16 v[112:115], a[144:147], v[180:183], v[112:115]
    ds_read_b128 v[160:163], v198 offset:192
    v_mfma_f32_32x32x16_bf16 v[80:95], a[144:147], v[184:187], v[80:95]
    ds_read_b128 v[164:167], v196 offset:192
    v_mul_f32 v134, v10, v155
    v_mul_f32 v135, v11, v155
    v_mul_f32 v136, v12, v155
    s_waitcnt lgkmcnt(2)
    v_mfma_f32_16x16x32_bf16 v[112:115], a[148:151], v[188:191], v[112:115]
    ds_read_b128 v[168:171], v198 offset:224
    v_mfma_f32_32x32x16_bf16 v[80:95], a[148:151], v[192:195], v[80:95]
    ds_read_b128 v[172:175], v197 offset:192
    buffer_load_dwordx4 v[220:223], v56, s[16:19], s96 offen offset:256 sc1
    v_mul_f32 v137, v13, v155
    v_mul_f32_e64 v138, v14, v155
    s_waitcnt lgkmcnt(2)
    v_mfma_f32_16x16x32_bf16 v[112:115], a[152:155], v[160:163], v[112:115]
    ds_read_b128 v[176:179], v196 offset:8704
    v_mfma_f32_32x32x16_bf16 v[80:95], a[152:155], v[164:167], v[80:95]
    ds_read_b128 v[180:183], v197 offset:8704
    v_mul_f32 v139, v15, v155
    v_mul_f32 v140, v16, v155
    v_mul_f32 v141, v17, v155
    s_waitcnt lgkmcnt(2)
    v_mfma_f32_16x16x32_bf16 v[112:115], a[156:159], v[168:171], v[112:115]
    ds_read_b128 v[184:187], v196 offset:8768
    v_mfma_f32_32x32x16_bf16 v[80:95], a[156:159], v[172:175], v[80:95]
    ds_read_b128 v[188:191], v197 offset:8768
    s_mov_b32 s96, 4227072
    buffer_load_dwordx4 v[224:227], v56, s[16:19], s96 offen offset:0 sc1
    v_mul_f32 v142, v18, v155
    v_mul_f32 v143, v19, v155
    v_mul_f32 v144, v20, v155
    v_mul_f32 v145, v21, v155
    v_mul_f32 v146, v22, v155
    v_mul_f32_e64 v147, v23, v155
    s_waitcnt lgkmcnt(2)
    v_mfma_f32_32x32x16_bf16 v[96:111], a[128:131], v[176:179], v[96:111]
    ds_read_b128 v[192:195], v196 offset:8832
    v_mfma_f32_32x32x16_bf16 v[96:111], a[132:135], v[180:183], v[96:111]
    ds_read_b128 v[160:163], v197 offset:8832
    buffer_load_dwordx4 v[228:231], v56, s[16:19], s96 offen offset:256 sc1
    v_fma_f32 v112, v112, v156, v148
    v_fma_f32 v113, v113, v156, v149
    s_waitcnt lgkmcnt(2)
    v_mfma_f32_32x32x16_bf16 v[96:111], a[136:139], v[184:187], v[96:111]
    ds_read_b128 v[164:167], v196 offset:8896
    v_fma_f32 v114, v114, v156, v150
    v_fma_f32 v115, v115, v156, v151
    v_cvt_pk_bf16_f32 v112, v112, v113
    v_cvt_pk_bf16_f32 v113, v114, v115
    v_mfma_f32_32x32x16_bf16 v[96:111], a[140:143], v[188:191], v[96:111]
    ds_read_b128 v[168:171], v197 offset:8896
    s_mov_b32 s96, 4259840
    buffer_load_dwordx4 v[232:235], v56, s[16:19], s96 offen offset:0 sc1
    v_fma_f32 v80, v80, v152, v116
    v_fma_f32 v81, v81, v152, v117
    s_waitcnt lgkmcnt(2)
    v_mfma_f32_32x32x16_bf16 v[96:111], a[144:147], v[192:195], v[96:111]
    v_fma_f32 v82, v82, v152, v118
    v_fma_f32 v83, v83, v152, v119
    v_cvt_pk_bf16_f32 v80, v80, v81
    v_cvt_pk_bf16_f32 v81, v82, v83
    ds_write_b64 v40, v[112:113] offset:0
    v_mfma_f32_32x32x16_bf16 v[96:111], a[148:151], v[160:163], v[96:111]
    ds_write_b64 v38, v[80:81] offset:0
    v_fma_f32 v84, v84, v152, v120
    v_fma_f32 v85, v85, v152, v121
    v_fma_f32 v86, v86, v152, v122
    s_waitcnt lgkmcnt(2)
    v_mfma_f32_32x32x16_bf16 v[96:111], a[152:155], v[164:167], v[96:111]
    v_fma_f32 v87, v87, v152, v123
    v_cvt_pk_bf16_f32 v84, v84, v85
    v_cvt_pk_bf16_f32 v85, v86, v87
    v_fma_f32 v88, v88, v152, v124
    v_fma_f32 v89, v89, v152, v125
    v_mfma_f32_32x32x16_bf16 v[96:111], a[156:159], v[168:171], v[96:111]
    buffer_load_dwordx4 v[236:239], v56, s[16:19], s96 offen offset:256 sc1
    v_fma_f32 v90, v90, v152, v126
    v_fma_f32 v91, v91, v152, v127
    v_cvt_pk_bf16_f32 v88, v88, v89
    v_cvt_pk_bf16_f32 v89, v90, v91
    ds_write_b64 v38, v[84:85] offset:6400
    ds_write_b64 v38, v[88:89] offset:12800
    v_fma_f32 v92, v92, v152, v128
    v_fma_f32 v93, v93, v152, v129
    v_fma_f32 v94, v94, v152, v130
    v_fma_f32 v95, v95, v152, v131
    v_cvt_pk_bf16_f32 v92, v92, v93
    v_cvt_pk_bf16_f32 v93, v94, v95
    ds_write_b64 v39, v[92:93] offset:0
    v_pk_fma_f32 v[96:97], v[96:97], v[154:155], v[132:133] op_sel_hi:[1,0,1]
    v_pk_fma_f32 v[98:99], v[98:99], v[154:155], v[134:135] op_sel_hi:[1,0,1]
    v_cvt_pk_bf16_f32 v96, v96, v97
    v_cvt_pk_bf16_f32 v97, v98, v99
    v_pk_fma_f32 v[100:101], v[100:101], v[154:155], v[136:137] op_sel_hi:[1,0,1]
    v_pk_fma_f32 v[102:103], v[102:103], v[154:155], v[138:139] op_sel_hi:[1,0,1]
    v_cvt_pk_bf16_f32 v100, v100, v101
    v_cvt_pk_bf16_f32 v101, v102, v103
    ds_write_b64 v38, v[96:97] offset:1600
    ds_write_b64 v38, v[100:101] offset:8000
    v_pk_fma_f32 v[104:105], v[104:105], v[154:155], v[140:141] op_sel_hi:[1,0,1]
    v_pk_fma_f32 v[106:107], v[106:107], v[154:155], v[142:143] op_sel_hi:[1,0,1]
    v_cvt_pk_bf16_f32 v104, v104, v105
    v_cvt_pk_bf16_f32 v105, v106, v107
    v_pk_fma_f32 v[108:109], v[108:109], v[154:155], v[144:145] op_sel_hi:[1,0,1]
    v_pk_fma_f32 v[110:111], v[110:111], v[154:155], v[146:147] op_sel_hi:[1,0,1]
    v_cvt_pk_bf16_f32 v108, v108, v109
    v_cvt_pk_bf16_f32 v109, v110, v111
    ds_write_b64 v38, v[104:105] offset:14400
    ds_write_b64 v39, v[108:109] offset:1600
    s_waitcnt lgkmcnt(0)
    s_barrier
    v_mov_b32 v94, 0
    v_mov_b32 v95, 0
    v_mov_b32 v98, 0
    v_mov_b32_e64 v99, 0
    s_mov_b64 exec, 0xffff
    ds_read_b64 v[94:95], v42 offset:320
    ds_read_b64 v[98:99], v42 offset:640
    s_mov_b64 exec, -1
    s_nop 0
    ds_read_b64 v[92:93], v41 offset:320
    ds_read_b64 v[96:97], v41 offset:640
    ds_read_b64 v[84:85], v41 offset:6720
    ds_read_b64 v[86:87], v42 offset:6720
    ds_read_b64 v[80:81], v41 offset:6400
    ds_read_b64 v[82:83], v42 offset:6400
    ds_read_b64 v[88:89], v41 offset:7040
    ds_read_b64 v[90:91], v42 offset:7040
    ds_read_b64_tr_b16 v[106:107], v44 offset:0
    ds_read_b64_tr_b16 v[100:101], v43 offset:0
    ds_read_b64_tr_b16 v[108:109], v44 offset:320
    ds_read_b64_tr_b16 v[102:103], v43 offset:320
    s_mov_b32 s96, 4292608
    buffer_load_dwordx4 v[240:243], v56, s[16:19], s96 offen offset:0 sc1
    ds_read_b64_tr_b16 v[110:111], v44 offset:640
    ds_read_b64_tr_b16 v[104:105], v43 offset:640
    s_mov_b32 s82, 0x3ea52b5c
    s_lshl_b32 s25, s98, 4
    s_add_u32 s25, s25, 4194304
    s_lshl_b32 s26, s98, 3
    s_add_u32 s26, s26, 4194304
    s_waitcnt lgkmcnt(10)
    v_mfma_f32_16x16x32_bf16 v[116:119], v[84:87], v[92:95], v[28:31]
    buffer_load_dwordx4 v[244:247], v56, s[16:19], s96 offen offset:256 sc1
    v_mfma_f32_16x16x32_bf16 v[120:123], v[84:87], v[96:99], v[32:35]
    s_waitcnt lgkmcnt(8)
    v_mfma_f32_16x16x32_bf16 v[112:115], v[80:83], v[92:95], v[32:35]
    s_waitcnt lgkmcnt(6)
    v_mfma_f32_16x16x32_bf16 v[124:127], v[88:91], v[96:99], v[28:31]
    s_nop 5
    v_max_f32 v112, v112, v116
    v_max_f32 v113, v113, v117
    v_max_f32 v114, v114, v118
    v_max_f32 v115, v115, v119
    v_max3_f32 v156, v112, v113, v114
    s_mov_b32 s96, 4194304
    buffer_load_dwordx2 v[248:249], v57, s[16:19], s96 offen offset:0 sc1
    v_max_f32 v156, v156, v115
    v_max_f32 v120, v120, v124
    v_max_f32 v121, v121, v125
    v_max_f32 v122, v122, v126
    v_max_f32 v123, v123, v127
    v_max3_f32 v157, v120, v121, v122
    v_max_f32 v157, v157, v123
    s_nop 1
    v_permlane16_swap_b32 v156, v157
    buffer_load_dwordx2 v[252:253], v57, s[16:19], s96 offen offset:128 sc1
    v_max_f32 v156, v156, v157
    v_mov_b32 v157, v156
    s_nop 1
    v_permlane32_swap_b32 v156, v157
    v_max_f32 v156, v156, v157
    v_mul_f32 v156, s82, v156
    v_mov_b32 v157, v156
    s_nop 1
    v_permlane16_swap_b32_e64 v156, v157
    v_fma_f32 v112, v112, s82, -v156
    s_mov_b32 s96, 4210688
    buffer_load_dwordx2 v[250:251], v57, s[16:19], s96 offen offset:0 sc1
    v_fma_f32 v113, v113, s82, -v156
    v_fma_f32 v114, v114, s82, -v156
    v_fma_f32 v115, v115, s82, -v156
    v_exp_f32 v112, v112
    v_exp_f32 v113, v113
    v_exp_f32 v114, v114
    v_exp_f32 v115, v115
    v_cvt_pk_bf16_f32 v116, v112, v113
    buffer_load_dwordx2 v[254:255], v57, s[16:19], s96 offen offset:128 sc1
    v_cvt_pk_bf16_f32 v117, v114, v115
    v_bfi_b32 v128, v36, 0, v116
    v_and_b32 v130, v36, v116
    v_bfi_b32 v129, v37, 0, v117
    v_and_b32 v131, v37, v117
    s_waitcnt lgkmcnt(3)
    s_nop 0
    v_mfma_f32_16x16x32_bf16 v[144:147], v[106:109], v[128:131], 0
    s_waitcnt lgkmcnt(2)
    v_mfma_f32_16x16x32_bf16 v[136:139], v[100:103], v[128:131], 0
    v_fma_f32 v120, v120, s82, -v157
    s_mov_b32 s96, 0
    s_mov_b32 s97, 5120
    buffer_load_dwordx2 v[208:209], v60, s[4:7], s96 offen
    v_fma_f32 v121, v121, s82, -v157
    v_fma_f32 v122, v122, s82, -v157
    v_fma_f32 v123, v123, s82, -v157
    v_exp_f32 v120, v120
    v_exp_f32 v121, v121
    v_exp_f32 v122, v122
    v_exp_f32 v123, v123
    v_cvt_pk_bf16_f32 v124, v120, v121
    buffer_load_dwordx2 v[210:211], v60, s[4:7], s97 offen
    v_cvt_pk_bf16_f32 v125, v122, v123
    v_bfi_b32 v132, v36, 0, v124
    v_and_b32 v134, v36, v124
    v_bfi_b32 v133, v37, 0, v125
    v_and_b32 v135, v37, v125
    s_waitcnt lgkmcnt(1)
    s_nop 0
    v_mfma_f32_16x16x32_bf16 v[148:151], v[108:111], v[132:135], 0
    s_waitcnt lgkmcnt(0)
    v_mfma_f32_16x16x32_bf16 v[140:143], v[102:105], v[132:135], 0
    v_mov_b32 v158, v144
    v_lshrrev_b32_e64 v212, 5, v1
    v_mul_u32_u24 v212, 5104, v212
    v_bfe_u32 v213, v1, 4, 1
    v_lshlrev_b32 v213, 2, v213
    v_sub_u32 v212, v212, v213
    v_add_u32 v212, v212, v60
    s_mul_i32 s97, s24, 24
    s_sub_u32 s97, 128, s97
    buffer_load_dword v212, v212, s[4:7], s97 offen
    v_permlane16_swap_b32 v144, v158
    v_rcp_f32_e64 v158, v158
    s_nop 0
    v_pk_mul_f32 v[136:137], v[136:137], v[158:159] op_sel_hi:[1,0]
    v_pk_mul_f32 v[138:139], v[138:139], v[158:159] op_sel_hi:[1,0]
    v_pk_mul_f32 v[144:145], v[144:145], v[158:159] op_sel_hi:[1,0]
    v_pk_mul_f32 v[146:147], v[146:147], v[158:159] op_sel_hi:[1,0]
    v_cvt_pk_bf16_f32 v112, v136, v137
    v_cvt_pk_bf16_f32 v116, v144, v145
    v_cvt_pk_bf16_f32 v113, v138, v139
    v_cvt_pk_bf16_f32 v117, v146, v147
    v_mov_b32 v160, v148
    s_nop 1
    v_permlane16_swap_b32 v148, v160
    v_rcp_f32_e64 v160, v160
    s_nop 0
    v_pk_mul_f32 v[140:141], v[140:141], v[160:161] op_sel_hi:[1,0]
    v_pk_mul_f32 v[142:143], v[142:143], v[160:161] op_sel_hi:[1,0]
    v_pk_mul_f32 v[148:149], v[148:149], v[160:161] op_sel_hi:[1,0]
    v_pk_mul_f32 v[150:151], v[150:151], v[160:161] op_sel_hi:[1,0]
    v_cvt_pk_bf16_f32 v114, v140, v141
    v_cvt_pk_bf16_f32 v118, v148, v149
    v_cvt_pk_bf16_f32 v115, v142, v143
    v_cvt_pk_bf16_f32 v119, v150, v151
    v_permlane16_swap_b32 v112, v114
    v_permlane16_swap_b32 v113, v115
    v_permlane16_swap_b32 v116, v118
    v_permlane16_swap_b32 v117, v119
    buffer_store_dwordx4 v[112:115], v45, s[16:19], s25 offen sc1
    s_mov_b64 exec, s[80:81]
    buffer_store_dwordx2 v[116:117], v46, s[16:19], s26 offen sc1
    s_mov_b64 exec, -1
oe_20:
    s_waitcnt vmcnt(16)
    v_mfma_f32_16x16x32_bf16 v[112:115], a[176:179], v[216:219], 0
    v_mov_b32 v136, 0
    v_mov_b32 v137, 0
    s_waitcnt vmcnt(15)
    v_mfma_f32_16x16x32_bf16 v[116:119], a[176:179], v[220:223], 0
    v_mov_b32 v138, 0
    v_mov_b32 v139, 0
    s_waitcnt vmcnt(14)
    v_mfma_f32_16x16x32_bf16 v[112:115], a[196:199], v[224:227], v[112:115]
    v_mov_b32 v140, 0
    v_mov_b32 v141, 0
    s_waitcnt vmcnt(13)
    v_mfma_f32_16x16x32_bf16 v[116:119], a[196:199], v[228:231], v[116:119]
    s_mov_b32 s25, 6815744
    s_add_u32 s26, s36, 6815744
    s_waitcnt vmcnt(12)
    v_mfma_f32_16x16x32_bf16 v[112:115], a[216:219], v[232:235], v[112:115]
    s_add_u32 s27, s35, 3473408
    s_mov_b32 s28, 0x99999999
    s_waitcnt vmcnt(11)
    v_mfma_f32_16x16x32_bf16 v[116:119], a[216:219], v[236:239], v[116:119]
    s_mov_b32 s29, 0x99999999
    s_waitcnt vmcnt(10)
    v_mfma_f32_16x16x32_bf16 v[112:115], a[236:239], v[240:243], v[112:115]
    s_waitcnt vmcnt(9)
    v_mfma_f32_16x16x32_bf16 v[116:119], a[236:239], v[244:247], v[116:119]
    s_waitcnt vmcnt(6)
    v_mfma_f32_16x16x32_bf16 v[112:115], v[52:55], v[248:251], v[112:115]
    s_waitcnt vmcnt(5)
    v_mfma_f32_16x16x32_bf16 v[116:119], v[52:55], v[252:255], v[116:119]
    v_mfma_f32_16x16x32_bf16 v[88:91], a[164:167], v[216:219], 0
    v_mfma_f32_16x16x32_bf16 v[92:95], a[164:167], v[220:223], 0
    v_mfma_f32_16x16x32_bf16 v[88:91], a[184:187], v[224:227], v[88:91]
    v_mfma_f32_16x16x32_bf16 v[92:95], a[184:187], v[228:231], v[92:95]
    v_mfma_f32_16x16x32_bf16 v[88:91], a[204:207], v[232:235], v[88:91]
    v_mfma_f32_16x16x32_bf16 v[92:95], a[204:207], v[236:239], v[92:95]
    s_nop 1
    v_cmp_u_f32 vcc, v112, v116
    s_nop 0
    s_cbranch_vccnz rd_21
rc_22:
    v_mfma_f32_16x16x32_bf16 v[88:91], a[224:227], v[240:243], v[88:91]
    ds_write_b128 v203, v[112:115] offset:24576
    v_mfma_f32_16x16x32_bf16 v[92:95], a[224:227], v[244:247], v[92:95]
    v_mfma_f32_16x16x32_bf16 v[88:91], a[244:247], v[248:251], v[88:91]
    ds_write_b128 v203, v[116:119] offset:25600
    v_mfma_f32_16x16x32_bf16 v[92:95], a[244:247], v[252:255], v[92:95]
    v_mfma_f32_16x16x32_bf16 v[96:99], a[168:171], v[216:219], 0
    s_waitcnt vmcnt(4)
    v_lshlrev_b32 v120, 16, v208
    v_and_b32 v121, 0xffff0000, v208
    v_mfma_f32_16x16x32_bf16 v[100:103], a[168:171], v[220:223], 0
    v_lshlrev_b32_e64 v122, 16, v209
    v_and_b32 v123, 0xffff0000, v209
    v_mfma_f32_16x16x32_bf16 v[96:99], a[188:191], v[224:227], v[96:99]
    s_waitcnt vmcnt(3)
    v_lshlrev_b32 v124, 16, v210
    v_and_b32 v125, 0xffff0000, v210
    v_mfma_f32_16x16x32_bf16 v[100:103], a[188:191], v[228:231], v[100:103]
    v_lshlrev_b32_e64 v126, 16, v211
    v_and_b32 v127, 0xffff0000, v211
    v_mfma_f32_16x16x32_bf16 v[96:99], a[208:211], v[232:235], v[96:99]
    s_waitcnt vmcnt(2)
    v_lshlrev_b32 v128, 16, v212
    v_and_b32 v129, 0xffff0000, v212
    v_mfma_f32_16x16x32_bf16 v[100:103], a[208:211], v[236:239], v[100:103]
    v_mfma_f32_16x16x32_bf16 v[96:99], a[228:231], v[240:243], v[96:99]
    ds_write_b128 v200, v[88:91] offset:0
    v_mfma_f32_16x16x32_bf16 v[100:103], a[228:231], v[244:247], v[100:103]
    v_mfma_f32_16x16x32_bf16 v[96:99], a[248:251], v[248:251], v[96:99]
    ds_write_b128 v200, v[92:95] offset:1024
    v_mfma_f32_16x16x32_bf16 v[100:103], a[248:251], v[252:255], v[100:103]
    v_mfma_f32_16x16x32_bf16 v[104:107], a[172:175], v[216:219], 0
    v_mfma_f32_16x16x32_bf16 v[108:111], a[172:175], v[220:223], 0
    v_mfma_f32_16x16x32_bf16 v[104:107], a[192:195], v[224:227], v[104:107]
    v_mfma_f32_16x16x32_bf16 v[108:111], a[192:195], v[228:231], v[108:111]
    v_mfma_f32_16x16x32_bf16 v[104:107], a[212:215], v[232:235], v[104:107]
    v_mfma_f32_16x16x32_bf16 v[108:111], a[212:215], v[236:239], v[108:111]
    v_mfma_f32_16x16x32_bf16 v[104:107], a[232:235], v[240:243], v[104:107]
    ds_write_b128 v201, v[96:99] offset:2048
    v_mfma_f32_16x16x32_bf16 v[108:111], a[232:235], v[244:247], v[108:111]
    v_mfma_f32_16x16x32_bf16 v[104:107], a[252:255], v[248:251], v[104:107]
    ds_write_b128 v201, v[100:103] offset:3072
    v_mfma_f32_16x16x32_bf16 v[108:111], a[252:255], v[252:255], v[108:111]
    v_mfma_f32_16x16x32_bf16 v[80:83], a[160:163], v[216:219], v[120:123]
    v_mfma_f32_16x16x32_bf16 v[84:87], a[160:163], v[220:223], v[124:127]
    v_mfma_f32_16x16x32_bf16 v[80:83], a[180:183], v[224:227], v[80:83]
    v_mfma_f32_16x16x32_bf16 v[84:87], a[180:183], v[228:231], v[84:87]
    v_mfma_f32_16x16x32_bf16 v[80:83], a[200:203], v[232:235], v[80:83]
    s_nop 0
    ds_write_b128 v202, v[104:107] offset:4096
    v_mfma_f32_16x16x32_bf16 v[84:87], a[200:203], v[236:239], v[84:87]
    ds_write_b128 v202, v[108:111] offset:5120
    v_mfma_f32_16x16x32_bf16 v[80:83], a[220:223], v[240:243], v[80:83]
    v_mfma_f32_16x16x32_bf16 v[84:87], a[220:223], v[244:247], v[84:87]
    v_mfma_f32_16x16x32_bf16 v[80:83], a[240:243], v[248:251], v[80:83]
    v_mfma_f32_16x16x32_bf16 v[84:87], a[240:243], v[252:255], v[84:87]
    s_waitcnt lgkmcnt(0)
    s_barrier
    s_nop 0
    ds_read_b128 v[88:91], v204 offset:0
    ds_read_b128 v[92:95], v204 offset:1024
    ds_read_b128 v[96:99], v204 offset:2048
    ds_read_b128 v[100:103], v204 offset:3072
    ds_read_b128 v[104:107], v204 offset:4096
    ds_read_b128 v[108:111], v204 offset:5120
    ds_read_b64 v[112:113], v205 offset:24576
    ds_read_b64 v[114:115], v205 offset:26624
    ds_read_b64 v[116:117], v205 offset:28672
    ds_read_b64 v[118:119], v205 offset:30720
    s_waitcnt lgkmcnt(9)
    v_pk_add_f32 v[80:81], v[80:81], v[88:89]
    v_pk_add_f32 v[82:83], v[82:83], v[90:91]
    s_waitcnt lgkmcnt(8)
    v_pk_add_f32 v[84:85], v[84:85], v[92:93]
    v_pk_add_f32 v[86:87], v[86:87], v[94:95]
    s_waitcnt lgkmcnt(7)
    v_pk_add_f32 v[80:81], v[80:81], v[96:97]
    v_pk_add_f32 v[82:83], v[82:83], v[98:99]
    s_waitcnt lgkmcnt(6)
    v_pk_add_f32 v[84:85], v[84:85], v[100:101]
    v_pk_add_f32 v[86:87], v[86:87], v[102:103]
    s_waitcnt lgkmcnt(5)
    v_pk_add_f32 v[80:81], v[80:81], v[104:105]
    v_pk_add_f32 v[82:83], v[82:83], v[106:107]
    s_waitcnt lgkmcnt(4)
    v_pk_add_f32 v[84:85], v[84:85], v[108:109]
    v_pk_add_f32 v[86:87], v[86:87], v[110:111]
    v_cvt_pk_bf16_f32 v132, v80, v81
    v_cvt_pk_bf16_f32 v133, v82, v83
    v_cvt_pk_bf16_f32 v134, v84, v85
    v_cvt_pk_bf16_f32 v135, v86, v87
    s_waitcnt lgkmcnt(3)
    v_pk_add_f32 v[128:129], v[128:129], v[112:113]
    s_waitcnt lgkmcnt(2)
    v_pk_add_f32 v[128:129], v[128:129], v[114:115]
    s_waitcnt lgkmcnt(1)
    v_pk_add_f32 v[128:129], v[128:129], v[116:117]
    s_waitcnt lgkmcnt(0)
    v_pk_add_f32 v[128:129], v[128:129], v[118:119]
    v_cvt_pk_bf16_f32 v130, v128, v129
    buffer_store_dwordx4 v[132:135], v59, s[16:19], s25 offen sc1
    buffer_store_dword v130, v61, s[16:19], s26 offen sc1
    v_dot2c_f32_bf16 v136, v132, v215
    v_dot2c_f32_bf16 v137, v132, v132
    v_dot2c_f32_bf16 v136, v133, v215
    v_dot2c_f32_bf16 v137, v133, v133
    v_dot2c_f32_bf16 v138, v134, v215
    v_dot2c_f32_bf16 v139, v134, v134
    v_dot2c_f32_bf16 v138, v135, v215
    v_dot2c_f32_bf16 v139, v135, v135
    v_dot2c_f32_bf16 v140, v130, v215
    v_dot2c_f32_bf16 v141, v130, v130
    v_permlane32_swap_b32 v136, v138
    v_permlane32_swap_b32 v137, v139
    v_pk_add_f32 v[136:137], v[136:137], v[138:139]
    v_pk_add_f32 v[136:137], v[136:137], v[140:141]
    s_nop 1
    v_permlane16_swap_b32 v136, v137
    v_add_f32_e64 v136, v136, v137
    ds_write_b32 v206, v136 offset:32768
    s_mov_b32 s96, 4198400
    buffer_load_dwordx4 v[216:219], v56, s[16:19], s96 offen offset:0 sc1
    buffer_load_dwordx4 v[220:223], v56, s[16:19], s96 offen offset:256 sc1
    s_mov_b32 s96, 4231168
    buffer_load_dwordx4 v[224:227], v56, s[16:19], s96 offen offset:0 sc1
    buffer_load_dwordx4 v[228:231], v56, s[16:19], s96 offen offset:256 sc1
    s_mov_b32 s96, 4263936
    buffer_load_dwordx4 v[232:235], v56, s[16:19], s96 offen offset:0 sc1
    buffer_load_dwordx4 v[236:239], v56, s[16:19], s96 offen offset:256 sc1
    s_mov_b32 s96, 4296704
    buffer_load_dwordx4 v[240:243], v56, s[16:19], s96 offen offset:0 sc1
    buffer_load_dwordx4 v[244:247], v56, s[16:19], s96 offen offset:256 sc1
    s_mov_b32 s96, 4196352
    buffer_load_dwordx2 v[248:249], v57, s[16:19], s96 offen offset:0 sc1
    buffer_load_dwordx2 v[252:253], v57, s[16:19], s96 offen offset:128 sc1
    s_mov_b32 s96, 4212736
    buffer_load_dwordx2 v[250:251], v57, s[16:19], s96 offen offset:0 sc1
    buffer_load_dwordx2 v[254:255], v57, s[16:19], s96 offen offset:128 sc1
    s_mov_b32 s96, 1310720
    s_mov_b32 s97, 1315840
    buffer_load_dwordx2 v[208:209], v60, s[4:7], s96 offen
    buffer_load_dwordx2 v[210:211], v60, s[4:7], s97 offen
    v_lshrrev_b32_e64 v212, 5, v1
    v_mul_u32_u24 v212, 5104, v212
    v_bfe_u32 v213, v1, 4, 1
    v_lshlrev_b32 v213, 2, v213
    v_sub_u32 v212, v212, v213
    v_add_u32 v212, v212, v60
    s_mul_i32 s97, s24, 24
    s_sub_u32 s97, 1310848, s97
    buffer_load_dword v212, v212, s[4:7], s97 offen
    s_waitcnt lgkmcnt(0)
    s_barrier
    ds_read2st64_b32 v[136:137], v207 offset0:0 offset1:1
    ds_read2st64_b32 v[138:139], v207 offset0:2 offset1:3
    ds_read_b64_tr_b16 v[144:145], v65 offset:32
    ds_read_b64_tr_b16 v[146:147], v65 offset:0
    ds_read_b64_tr_b16 v[148:149], v65 offset:160
    ds_read_b64_tr_b16 v[150:151], v65 offset:128
    ds_read_b64_tr_b16 v[152:153], v65 offset:288
    ds_read_b64_tr_b16 v[154:155], v65 offset:256
    ds_read_b64_tr_b16 v[156:157], v65 offset:416
    ds_read_b64_tr_b16 v[158:159], v65 offset:384
    ds_read_b64_tr_b16 v[160:161], v65 offset:544
    ds_read_b64_tr_b16 v[162:163], v65 offset:512
    ds_read_b64_tr_b16 v[164:165], v65 offset:672
    ds_read_b64_tr_b16 v[166:167], v65 offset:640
    ds_read_b64_tr_b16 v[168:169], v65 offset:800
    ds_read_b64_tr_b16 v[170:171], v65 offset:768
    ds_read_b64_tr_b16 v[172:173], v65 offset:928
    ds_read_b64_tr_b16 v[174:175], v65 offset:896
    s_waitcnt lgkmcnt(15)
    v_pk_add_f32 v[136:137], v[136:137], v[138:139]
    v_add_f32 v136, v136, v137
    v_cndmask_b32 v136, v136, 1.0, s[28:29]
    s_mov_b64 exec, s[80:81]
    buffer_atomic_add_f32 v136, v214, s[16:19], s27 offen sc1
    s_mov_b64 exec, -1
    v_lshrrev_b32 v176, 4, v0
    v_mul_u32_u24 v176, 1216, v176
    v_and_b32 v177, 15, v0
    v_lshl_add_u32 v176, v177, 3, v176
    v_add_u32 v176, 64, v176
    v_mov_b32 v178, 0
    v_mov_b32 v179, 0
    ds_write_b64 v176, v[178:179]
    v_mov_b32 v70, 0
    v_mov_b32 v71, 0
    v_mov_b32 v72, 0
    s_lshl_b32 s25, s24, 17
    v_lshrrev_b32 v176, 5, v1
    v_lshl_add_u32 v176, v176, 14, s25
    v_bfe_u32 v177, v1, 4, 1
    v_lshl_add_u32 v176, v177, 13, v176
    v_and_b32_e64 v177, 15, v1
    v_lshl_add_u32 v73, v177, 4, v176
    v_bfe_u32 v176, v1, 2, 3
    v_lshl_add_u32 v176, v176, 14, s25
    v_bfe_u32 v177, v1, 1, 1
    v_lshl_add_u32 v176, v177, 13, v176
    v_and_b32 v177, 1, v1
    v_lshl_add_u32 v77, v177, 4, v176
    v_lshrrev_b32 v177, 5, v1
    v_and_b32 v176, 31, v1
    v_lshlrev_b32 v176, 3, v176
    v_lshl_add_u32 v78, v177, 10, v176
    v_and_b32 v176, 7, v1
    v_lshlrev_b32 v176, 3, v176
    v_lshl_add_u32 v178, v177, 7, v176
    v_add_u32 v74, 31744, v73
    v_add_u32 v75, 63488, v73
    v_add_u32 v76, 95232, v73
    v_add_u32 v178, 53760, v178
    v_and_b32 v176, 31, v1
    v_cmp_eq_u32 vcc, 0, v176
    v_cmp_eq_u32 s[82:83], 24, v176
    s_nop 0
    s_or_b64 vcc, vcc, s[82:83]
    v_mov_b32 v176, 155712
    v_mov_b32 v177, 158288
    v_cndmask_b32 v176, v176, v177, vcc
    v_cndmask_b32 v79, v176, v178, s[78:79]
oe_23:
    s_waitcnt vmcnt(15)
    v_mfma_f32_16x16x32_bf16 v[112:115], a[176:179], v[216:219], 0
    v_mov_b32 v136, 0
    v_mov_b32 v137, 0
    s_waitcnt vmcnt(14)
    v_mfma_f32_16x16x32_bf16 v[116:119], a[176:179], v[220:223], 0
    v_mov_b32 v138, 0
    v_mov_b32 v139, 0
    s_waitcnt vmcnt(13)
    v_mfma_f32_16x16x32_bf16 v[112:115], a[196:199], v[224:227], v[112:115]
    v_mov_b32 v140, 0
    v_mov_b32_e64 v141, 0
    s_waitcnt vmcnt(12)
    v_mfma_f32_16x16x32_bf16 v[116:119], a[196:199], v[228:231], v[116:119]
    s_mov_b32 s25, 6817792
    s_add_u32 s26, s36, 6817792
    s_waitcnt vmcnt(11)
    v_mfma_f32_16x16x32_bf16 v[112:115], a[216:219], v[232:235], v[112:115]
    s_add_u32 s27, s35, 3477504
    s_mov_b32 s28, 0x99999999
    s_waitcnt vmcnt(10)
    v_mfma_f32_16x16x32_bf16 v[116:119], a[216:219], v[236:239], v[116:119]
    s_mov_b32 s29, 0x99999999
    s_waitcnt vmcnt(9)
    v_mfma_f32_16x16x32_bf16 v[112:115], a[236:239], v[240:243], v[112:115]
    s_waitcnt vmcnt(8)
    v_mfma_f32_16x16x32_bf16 v[116:119], a[236:239], v[244:247], v[116:119]
    s_waitcnt vmcnt(5)
    v_mfma_f32_16x16x32_bf16 v[112:115], v[52:55], v[248:251], v[112:115]
    s_waitcnt vmcnt(4)
    v_mfma_f32_16x16x32_bf16 v[116:119], v[52:55], v[252:255], v[116:119]
    v_mfma_f32_16x16x32_bf16 v[88:91], a[164:167], v[216:219], 0
    v_mfma_f32_16x16x32_bf16 v[92:95], a[164:167], v[220:223], 0
    v_mfma_f32_16x16x32_bf16 v[88:91], a[184:187], v[224:227], v[88:91]
    v_mfma_f32_16x16x32_bf16 v[92:95], a[184:187], v[228:231], v[92:95]
    v_mfma_f32_16x16x32_bf16 v[88:91], a[204:207], v[232:235], v[88:91]
    v_mfma_f32_16x16x32_bf16 v[92:95], a[204:207], v[236:239], v[92:95]
    s_nop 1
    v_cmp_u_f32 vcc, v112, v116
    s_nop 0
    s_cbranch_vccnz rd_24
rc_25:
    v_mfma_f32_16x16x32_bf16 v[88:91], a[224:227], v[240:243], v[88:91]
    ds_write_b128 v203, v[112:115] offset:24576
    v_mfma_f32_16x16x32_bf16 v[92:95], a[224:227], v[244:247], v[92:95]
    v_mfma_f32_16x16x32_bf16 v[88:91], a[244:247], v[248:251], v[88:91]
    ds_write_b128 v203, v[116:119] offset:25600
    v_mfma_f32_16x16x32_bf16 v[92:95], a[244:247], v[252:255], v[92:95]
    v_mfma_f32_16x16x32_bf16 v[96:99], a[168:171], v[216:219], 0
    s_waitcnt vmcnt(3)
    v_lshlrev_b32 v120, 16, v208
    v_and_b32 v121, 0xffff0000, v208
    v_mfma_f32_16x16x32_bf16 v[100:103], a[168:171], v[220:223], 0
    v_lshlrev_b32_e64 v122, 16, v209
    v_and_b32 v123, 0xffff0000, v209
    v_mfma_f32_16x16x32_bf16 v[96:99], a[188:191], v[224:227], v[96:99]
    s_waitcnt vmcnt(2)
    v_lshlrev_b32 v124, 16, v210
    v_and_b32 v125, 0xffff0000, v210
    v_mfma_f32_16x16x32_bf16 v[100:103], a[188:191], v[228:231], v[100:103]
    v_lshlrev_b32_e64 v126, 16, v211
    v_and_b32 v127, 0xffff0000, v211
    v_mfma_f32_16x16x32_bf16 v[96:99], a[208:211], v[232:235], v[96:99]
    s_waitcnt vmcnt(1)
    v_lshlrev_b32 v128, 16, v212
    v_and_b32 v129, 0xffff0000, v212
    v_mfma_f32_16x16x32_bf16 v[100:103], a[208:211], v[236:239], v[100:103]
    v_mfma_f32_16x16x32_bf16 v[96:99], a[228:231], v[240:243], v[96:99]
    ds_write_b128 v200, v[88:91] offset:0
    v_mfma_f32_16x16x32_bf16 v[100:103], a[228:231], v[244:247], v[100:103]
    v_mfma_f32_16x16x32_bf16 v[96:99], a[248:251], v[248:251], v[96:99]
    ds_write_b128 v200, v[92:95] offset:1024
    v_mfma_f32_16x16x32_bf16 v[100:103], a[248:251], v[252:255], v[100:103]
    v_mfma_f32_16x16x32_bf16 v[104:107], a[172:175], v[216:219], 0
    v_mfma_f32_16x16x32_bf16 v[108:111], a[172:175], v[220:223], 0
    v_mfma_f32_16x16x32_bf16 v[104:107], a[192:195], v[224:227], v[104:107]
    v_mfma_f32_16x16x32_bf16 v[108:111], a[192:195], v[228:231], v[108:111]
    v_mfma_f32_16x16x32_bf16 v[104:107], a[212:215], v[232:235], v[104:107]
    v_mfma_f32_16x16x32_bf16 v[108:111], a[212:215], v[236:239], v[108:111]
    v_mfma_f32_16x16x32_bf16 v[104:107], a[232:235], v[240:243], v[104:107]
    ds_write_b128 v201, v[96:99] offset:2048
    v_mfma_f32_16x16x32_bf16 v[108:111], a[232:235], v[244:247], v[108:111]
    v_mfma_f32_16x16x32_bf16 v[104:107], a[252:255], v[248:251], v[104:107]
    ds_write_b128 v201, v[100:103] offset:3072
    v_mfma_f32_16x16x32_bf16 v[108:111], a[252:255], v[252:255], v[108:111]
    v_mfma_f32_16x16x32_bf16 v[80:83], a[160:163], v[216:219], v[120:123]
    v_mfma_f32_16x16x32_bf16 v[84:87], a[160:163], v[220:223], v[124:127]
    v_mfma_f32_16x16x32_bf16 v[80:83], a[180:183], v[224:227], v[80:83]
    v_mfma_f32_16x16x32_bf16 v[84:87], a[180:183], v[228:231], v[84:87]
    v_mfma_f32_16x16x32_bf16 v[80:83], a[200:203], v[232:235], v[80:83]
    s_nop 0
    ds_write_b128 v202, v[104:107] offset:4096
    v_mfma_f32_16x16x32_bf16 v[84:87], a[200:203], v[236:239], v[84:87]
    ds_write_b128 v202, v[108:111] offset:5120
    v_mfma_f32_16x16x32_bf16 v[80:83], a[220:223], v[240:243], v[80:83]
    v_mfma_f32_16x16x32_bf16 v[84:87], a[220:223], v[244:247], v[84:87]
    v_mfma_f32_16x16x32_bf16 v[80:83], a[240:243], v[248:251], v[80:83]
    v_mfma_f32_16x16x32_bf16 v[84:87], a[240:243], v[252:255], v[84:87]
    s_waitcnt lgkmcnt(0)
    s_barrier
    s_nop 0
    ds_read_b128 v[88:91], v204 offset:0
    ds_read_b128 v[92:95], v204 offset:1024
    ds_read_b128 v[96:99], v204 offset:2048
    ds_read_b128 v[100:103], v204 offset:3072
    ds_read_b128 v[104:107], v204 offset:4096
    ds_read_b128 v[108:111], v204 offset:5120
    ds_read_b64 v[112:113], v205 offset:24576
    ds_read_b64 v[114:115], v205 offset:26624
    ds_read_b64 v[116:117], v205 offset:28672
    ds_read_b64 v[118:119], v205 offset:30720
    s_lshl_b32 s96, s75, 14
    s_add_u32 s96, s96, 6815744
    s_lshl_b32 s97, s24, 12
    s_add_u32 s97, s97, 3473408
    buffer_load_dwordx4 v[176:179], v62, s[16:19], s96 offen offset:0 sc1
    buffer_load_dwordx4 v[180:183], v62, s[16:19], s96 offen offset:1024 sc1
    s_waitcnt lgkmcnt(9)
    v_pk_add_f32 v[80:81], v[80:81], v[88:89]
    v_pk_add_f32 v[82:83], v[82:83], v[90:91]
    s_waitcnt lgkmcnt(8)
    v_pk_add_f32 v[84:85], v[84:85], v[92:93]
    v_pk_add_f32 v[86:87], v[86:87], v[94:95]
    s_waitcnt lgkmcnt(7)
    v_pk_add_f32 v[80:81], v[80:81], v[96:97]
    v_pk_add_f32 v[82:83], v[82:83], v[98:99]
    s_waitcnt lgkmcnt(6)
    v_pk_add_f32 v[84:85], v[84:85], v[100:101]
    v_pk_add_f32 v[86:87], v[86:87], v[102:103]
    s_waitcnt lgkmcnt(5)
    v_pk_add_f32 v[80:81], v[80:81], v[104:105]
    v_pk_add_f32 v[82:83], v[82:83], v[106:107]
    s_waitcnt lgkmcnt(4)
    v_pk_add_f32 v[84:85], v[84:85], v[108:109]
    v_pk_add_f32 v[86:87], v[86:87], v[110:111]
    v_cvt_pk_bf16_f32 v132, v80, v81
    v_cvt_pk_bf16_f32 v133, v82, v83
    v_cvt_pk_bf16_f32 v134, v84, v85
    v_cvt_pk_bf16_f32 v135, v86, v87
    s_waitcnt lgkmcnt(3)
    v_pk_add_f32 v[128:129], v[128:129], v[112:113]
    s_waitcnt lgkmcnt(2)
    v_pk_add_f32 v[128:129], v[128:129], v[114:115]
    s_waitcnt lgkmcnt(1)
    v_pk_add_f32 v[128:129], v[128:129], v[116:117]
    s_waitcnt lgkmcnt(0)
    v_pk_add_f32 v[128:129], v[128:129], v[118:119]
    v_cvt_pk_bf16_f32 v130, v128, v129
    buffer_store_dwordx4 v[132:135], v59, s[16:19], s25 offen sc1
    buffer_store_dword v130, v61, s[16:19], s26 offen sc1
    v_dot2c_f32_bf16 v136, v132, v215
    v_dot2c_f32_bf16 v137, v132, v132
    v_dot2c_f32_bf16 v136, v133, v215
    v_dot2c_f32_bf16 v137, v133, v133
    v_dot2c_f32_bf16 v138, v134, v215
    v_dot2c_f32_bf16 v139, v134, v134
    v_dot2c_f32_bf16 v138, v135, v215
    v_dot2c_f32_bf16 v139, v135, v135
    v_dot2c_f32_bf16 v140, v130, v215
    v_dot2c_f32_bf16 v141, v130, v130
    v_permlane32_swap_b32 v136, v138
    v_permlane32_swap_b32 v137, v139
    v_pk_add_f32 v[136:137], v[136:137], v[138:139]
    v_pk_add_f32 v[136:137], v[136:137], v[140:141]
    s_nop 1
    v_permlane16_swap_b32 v136, v137
    v_add_f32_e64 v136, v136, v137
    ds_write_b32 v206, v136 offset:32768
    buffer_load_dwordx4 v[184:187], v62, s[16:19], s97 offen offset:0 sc1
    buffer_load_dwordx4 v[188:191], v62, s[16:19], s97 offen offset:1024 sc1
    buffer_load_dwordx4 v[192:195], v62, s[16:19], s97 offen offset:2048 sc1
    buffer_load_dwordx4 v[196:199], v62, s[16:19], s97 offen offset:3072 sc1
    s_waitcnt lgkmcnt(0)
    s_barrier
    ds_read2st64_b32 v[136:137], v207 offset0:0 offset1:1
    ds_read2st64_b32 v[138:139], v207 offset0:2 offset1:3
    s_waitcnt lgkmcnt(0)
    v_pk_add_f32 v[136:137], v[136:137], v[138:139]
    v_add_f32 v136, v136, v137
    v_cndmask_b32 v136, v136, 1.0, s[28:29]
    s_mov_b64 exec, s[80:81]
    buffer_atomic_add_f32 v136, v214, s[16:19], s27 offen sc1
    s_mov_b64 exec, -1
    s_cmp_ge_u32 s2, 160
    s_cbranch_scc1 nc_26
    v_mov_b32 v248, -1
    v_mov_b32 v249, -1
    v_mov_b32 v250, -1
    v_mov_b32 v251, -1
    s_lshl_b32 s88, s75, 14
    s_add_u32 s88, s88, 9437184
    buffer_store_dwordx4 v[248:251], v62, s[16:19], s88 offen offset:0 sc1
    buffer_store_dwordx4 v[248:251], v62, s[16:19], s88 offen offset:1024 sc1
    s_waitcnt vmcnt(3)
ce_28:
    v_max3_u32 v208, v176, v177, v178
    v_max3_u32 v208, v208, v179, v180
    v_max3_u32 v208, v208, v181, v182
    v_max_u32 v208, v208, v183
    v_cmp_eq_u32 s[82:83], -1, v208
    v_min3_f32 v209, v184, v187, v188
    v_min3_f32 v209, v209, v191, v192
    v_min3_f32 v209, v209, v195, v196
    v_min_f32 v209, v209, v199
    v_cmp_neq_f32 vcc, 0x41000000, v209
    s_nop 0
    s_or_b64 vcc, vcc, s[82:83]
    s_cbranch_vccnz rd_29
rc_30:
    v_mul_f32 v208, 0x3acccccd, v185
    v_mul_f32 v209, 0x3acccccd, v189
    v_mul_f32 v186, 0x3acccccd, v186
    v_mul_f32 v190, 0x3acccccd, v190
    v_fma_f32 v186, -v208, v208, v186
    v_fma_f32 v190, -v209, v209, v190
    v_max_f32 v186, 0, v186
    v_max_f32 v190, 0, v190
    v_add_f32 v186, 0x3727c5ac, v186
    v_add_f32 v190, 0x3727c5ac, v190
    v_rsq_f32 v185, v186
    v_rsq_f32 v189, v190
    v_mul_f32 v186, -v208, v185
    v_mul_f32 v190, -v209, v189
    v_lshlrev_b32 v80, 16, v176
    v_and_b32 v82, 0xffff0000, v176
    v_lshlrev_b32 v84, 16, v177
    v_and_b32 v86, 0xffff0000, v177
    v_lshlrev_b32 v81, 16, v178
    v_and_b32 v83, 0xffff0000, v178
    v_lshlrev_b32 v85, 16, v179
    v_and_b32 v87, 0xffff0000, v179
    v_fma_f32 v208, v80, v185, v186
    v_fma_f32 v209, v81, v189, v190
    v_cvt_pk_bf16_f32 v176, v208, v209
    v_fma_f32 v208, v82, v185, v186
    v_fma_f32 v209, v83, v189, v190
    v_cvt_pk_bf16_f32 v177, v208, v209
    v_fma_f32 v208, v84, v185, v186
    v_fma_f32 v209, v85, v189, v190
    v_cvt_pk_bf16_f32 v178, v208, v209
    v_fma_f32 v208, v86, v185, v186
    v_fma_f32 v209, v87, v189, v190
    v_cvt_pk_bf16_f32 v179, v208, v209
    ds_write_b32 v63, v176 offset:0
    ds_write_b32 v63, v177 offset:4864
    ds_write_b32 v63, v178 offset:9728
    ds_write_b32 v63, v179 offset:14592
    v_mul_f32 v208, 0x3acccccd, v193
    v_mul_f32 v209, 0x3acccccd, v197
    v_mul_f32 v194, 0x3acccccd, v194
    v_mul_f32 v198, 0x3acccccd, v198
    v_fma_f32 v194, -v208, v208, v194
    v_fma_f32 v198, -v209, v209, v198
    v_max_f32 v194, 0, v194
    v_max_f32 v198, 0, v198
    v_add_f32 v194, 0x3727c5ac, v194
    v_add_f32 v198, 0x3727c5ac, v198
    v_rsq_f32 v193, v194
    v_rsq_f32 v197, v198
    v_mul_f32 v194, -v208, v193
    v_mul_f32 v198, -v209, v197
    v_lshlrev_b32 v88, 16, v180
    v_and_b32 v90, 0xffff0000, v180
    v_lshlrev_b32 v92, 16, v181
    v_and_b32 v94, 0xffff0000, v181
    v_lshlrev_b32 v89, 16, v182
    v_and_b32 v91, 0xffff0000, v182
    v_lshlrev_b32 v93, 16, v183
    v_and_b32 v95, 0xffff0000, v183
    v_fma_f32 v208, v88, v193, v194
    v_fma_f32 v209, v89, v197, v198
    v_cvt_pk_bf16_f32 v180, v208, v209
    v_fma_f32 v208, v90, v193, v194
    v_fma_f32 v209, v91, v197, v198
    v_cvt_pk_bf16_f32 v181, v208, v209
    v_fma_f32 v208, v92, v193, v194
    v_fma_f32 v209, v93, v197, v198
    v_cvt_pk_bf16_f32 v182, v208, v209
    v_fma_f32 v208, v94, v193, v194
    v_fma_f32 v209, v95, v197, v198
    v_cvt_pk_bf16_f32 v183, v208, v209
    ds_write_b32 v63, v180 offset:256
    ds_write_b32 v63, v181 offset:5120
    ds_write_b32 v63, v182 offset:9984
    ds_write_b32 v63, v183 offset:14848
    s_waitcnt lgkmcnt(0)
    s_barrier
    ds_read_b128 v[212:215], v64 offset:96
    ds_read_b128 v[216:219], v64 offset:64
    ds_read_b128 v[220:223], v64 offset:32
    ds_read_b128 v[224:227], v64 offset:0
    s_waitcnt lgkmcnt(3)
    v_mfma_f32_32x32x16_bf16 v[96:111], v[212:215], v[144:147], 0
    ds_read_b128 v[228:231], v64 offset:224
    ds_read_b64_tr_b16 v[176:177], v65 offset:1056
    ds_read_b64_tr_b16 v[178:179], v65 offset:1024
    ds_read_b64_tr_b16 v[180:181], v65 offset:1184
    ds_read_b64_tr_b16 v[182:183], v65 offset:1152
    s_waitcnt lgkmcnt(7)
    v_mfma_f32_32x32x16_bf16 v[96:111], v[216:219], v[148:151], v[96:111]
    ds_read_b128 v[232:235], v64 offset:192
    ds_read_b64_tr_b16 v[184:185], v65 offset:1312
    ds_read_b64_tr_b16 v[186:187], v65 offset:1280
    ds_read_b64_tr_b16 v[188:189], v65 offset:1440
    ds_read_b64_tr_b16 v[190:191], v65 offset:1408
    s_waitcnt lgkmcnt(11)
    v_mfma_f32_32x32x16_bf16 v[96:111], v[220:223], v[152:155], v[96:111]
    ds_read_b128 v[236:239], v64 offset:160
    ds_read_b64_tr_b16 v[192:193], v65 offset:1568
    ds_read_b64_tr_b16 v[194:195], v65 offset:1536
    ds_read_b64_tr_b16 v[196:197], v65 offset:1696
    ds_read_b64_tr_b16 v[198:199], v65 offset:1664
    s_waitcnt lgkmcnt(15)
    v_mfma_f32_32x32x16_bf16 v[96:111], v[224:227], v[156:159], v[96:111]
    ds_read_b128 v[240:243], v64 offset:128
    ds_read_b64_tr_b16 v[200:201], v65 offset:1824
    ds_read_b64_tr_b16 v[202:203], v65 offset:1792
    ds_read_b64_tr_b16 v[204:205], v65 offset:1952
    ds_read_b64_tr_b16 v[206:207], v65 offset:1920
    s_waitcnt lgkmcnt(15)
    v_mfma_f32_32x32x16_bf16 v[112:127], v[228:231], v[144:147], 0
    buffer_store_dwordx4 v[248:251], v62, s[16:19], s88 offen offset:2048 sc1
    s_nop 3
    s_waitcnt lgkmcnt(14)
    v_mfma_f32_32x32x16_bf16 v[112:127], v[232:235], v[148:151], v[112:127]
    v_cndmask_b32 v208, v99, v72, s[76:77]
    v_cndmask_b32 v209, v103, v99, s[76:77]
    v_cndmask_b32 v210, v107, v103, s[76:77]
    v_cndmask_b32 v211, v111, v107, s[76:77]
    v_mov_b32_e64 v72, v111
    s_waitcnt lgkmcnt(9)
    v_mfma_f32_32x32x16_bf16 v[112:127], v[236:239], v[152:155], v[112:127]
    v_add_f32_dpp v98, v208, v98 wave_ror:1 row_mask:0xf bank_mask:0xf
    v_add_f32_dpp v102, v209, v102 wave_ror:1 row_mask:0xf bank_mask:0xf
    v_add_f32_dpp v106, v210, v106 wave_ror:1 row_mask:0xf bank_mask:0xf
    v_add_f32_dpp v110, v211, v110 wave_ror:1 row_mask:0xf bank_mask:0xf
    v_cndmask_b32 v208, v98, v71, s[76:77]
    s_waitcnt lgkmcnt(4)
    v_mfma_f32_32x32x16_bf16 v[112:127], v[240:243], v[156:159], v[112:127]
    v_cndmask_b32 v209, v102, v98, s[76:77]
    v_cndmask_b32 v210, v106, v102, s[76:77]
    v_cndmask_b32 v211, v110, v106, s[76:77]
    v_mov_b32 v71, v110
    v_add_f32_dpp v97, v208, v97 wave_ror:1 row_mask:0xf bank_mask:0xf
    v_add_f32_dpp v101, v209, v101 wave_ror:1 row_mask:0xf bank_mask:0xf
    v_mfma_f32_32x32x16_bf16 v[112:127], v[212:215], v[160:163], v[112:127]
    ds_read_b128 v[244:247], v64 offset:352
    v_add_f32_dpp v105, v210, v105 wave_ror:1 row_mask:0xf bank_mask:0xf
    v_add_f32_dpp v109, v211, v109 wave_ror:1 row_mask:0xf bank_mask:0xf
    v_cndmask_b32 v208, v97, v70, s[76:77]
    v_cndmask_b32 v209, v101, v97, s[76:77]
    v_cndmask_b32 v210, v105, v101, s[76:77]
    v_mfma_f32_32x32x16_bf16 v[112:127], v[216:219], v[164:167], v[112:127]
    ds_read_b128 v[216:219], v64 offset:320
    v_cndmask_b32 v211, v109, v105, s[76:77]
    v_mov_b32_e64 v70, v109
    v_add_f32_dpp v96, v208, v96 wave_ror:1 row_mask:0xf bank_mask:0xf
    v_add_f32_dpp v100, v209, v100 wave_ror:1 row_mask:0xf bank_mask:0xf
    v_add_f32_dpp v104, v210, v104 wave_ror:1 row_mask:0xf bank_mask:0xf
    v_mfma_f32_32x32x16_bf16 v[112:127], v[220:223], v[168:171], v[112:127]
    ds_read_b128 v[220:223], v64 offset:288
    buffer_store_dwordx4 v[248:251], v62, s[16:19], s88 offen offset:3072 sc1
    v_add_f32_dpp v108, v211, v108 wave_ror:1 row_mask:0xf bank_mask:0xf
    v_mfma_f32_32x32x16_bf16 v[112:127], v[224:227], v[172:175], v[112:127]
    ds_read_b128 v[224:227], v64 offset:256
    ds_write_b32 v66, v96 offset:0
    ds_write_b32 v66, v100 offset:64
    s_waitcnt lgkmcnt(5)
    v_mfma_f32_32x32x16_bf16 v[128:143], v[244:247], v[144:147], 0
    ds_write_b32 v66, v104 offset:128
    ds_write_b32 v66, v108 offset:192
    s_nop 0
    s_waitcnt lgkmcnt(6)
    v_mfma_f32_32x32x16_bf16 v[128:143], v[216:219], v[148:151], v[128:143]
    s_nop 3
    v_cndmask_b32 v208, v115, v72, s[76:77]
    s_waitcnt lgkmcnt(5)
    v_mfma_f32_32x32x16_bf16 v[128:143], v[220:223], v[152:155], v[128:143]
    v_cndmask_b32 v209, v119, v115, s[76:77]
    v_cndmask_b32 v210, v123, v119, s[76:77]
    v_cndmask_b32 v211, v127, v123, s[76:77]
    v_mov_b32 v72, v127
    v_add_f32_dpp v114, v208, v114 wave_ror:1 row_mask:0xf bank_mask:0xf
    s_waitcnt lgkmcnt(4)
    v_mfma_f32_32x32x16_bf16 v[128:143], v[224:227], v[156:159], v[128:143]
    v_add_f32_dpp v118, v209, v118 wave_ror:1 row_mask:0xf bank_mask:0xf
    v_add_f32_dpp v122, v210, v122 wave_ror:1 row_mask:0xf bank_mask:0xf
    v_add_f32_dpp v126, v211, v126 wave_ror:1 row_mask:0xf bank_mask:0xf
    v_cndmask_b32 v208, v114, v71, s[76:77]
    v_cndmask_b32 v209, v118, v114, s[76:77]
    v_cndmask_b32 v210, v122, v118, s[76:77]
    v_mfma_f32_32x32x16_bf16 v[128:143], v[228:231], v[160:163], v[128:143]
    v_cndmask_b32 v211, v126, v122, s[76:77]
    v_mov_b32 v71, v126
    v_add_f32_dpp v113, v208, v113 wave_ror:1 row_mask:0xf bank_mask:0xf
    v_add_f32_dpp v117, v209, v117 wave_ror:1 row_mask:0xf bank_mask:0xf
    v_add_f32_dpp v121, v210, v121 wave_ror:1 row_mask:0xf bank_mask:0xf
    v_add_f32_dpp v125, v211, v125 wave_ror:1 row_mask:0xf bank_mask:0xf
    v_mfma_f32_32x32x16_bf16 v[128:143], v[232:235], v[164:167], v[128:143]
    ds_read_b128 v[232:235], v64 offset:64
    v_cndmask_b32 v208, v113, v70, s[76:77]
    v_cndmask_b32 v209, v117, v113, s[76:77]
    v_cndmask_b32 v210, v121, v117, s[76:77]
    v_cndmask_b32 v211, v125, v121, s[76:77]
    v_mov_b32_e64 v70, v125
    v_mfma_f32_32x32x16_bf16 v[128:143], v[236:239], v[168:171], v[128:143]
    ds_read_b128 v[236:239], v64 offset:32
    v_add_f32_dpp v112, v208, v112 wave_ror:1 row_mask:0xf bank_mask:0xf
    v_add_f32_dpp v116, v209, v116 wave_ror:1 row_mask:0xf bank_mask:0xf
    v_add_f32_dpp v120, v210, v120 wave_ror:1 row_mask:0xf bank_mask:0xf
    v_add_f32_dpp v124, v211, v124 wave_ror:1 row_mask:0xf bank_mask:0xf
    v_mfma_f32_32x32x16_bf16 v[128:143], v[240:243], v[172:175], v[128:143]
    ds_read_b128 v[240:243], v64 offset:0
    ds_write_b32 v66, v112 offset:256
    ds_write_b32 v66, v116 offset:320
    v_mfma_f32_32x32x16_bf16 v[128:143], v[212:215], v[176:179], v[128:143]
    ds_read_b128 v[212:215], v64 offset:480
    ds_write_b32 v66, v120 offset:384
    ds_write_b32 v66, v124 offset:448
    s_waitcnt lgkmcnt(7)
    v_mfma_f32_32x32x16_bf16 v[128:143], v[232:235], v[180:183], v[128:143]
    ds_read_b128 v[232:235], v64 offset:448
    s_waitcnt lgkmcnt(7)
    v_mfma_f32_32x32x16_bf16 v[128:143], v[236:239], v[184:187], v[128:143]
    ds_read_b128 v[236:239], v64 offset:416
    s_waitcnt lgkmcnt(7)
    v_mfma_f32_32x32x16_bf16 v[128:143], v[240:243], v[188:191], v[128:143]
    ds_read_b128 v[240:243], v64 offset:384
    s_nop 3
    s_waitcnt lgkmcnt(5)
    v_mfma_f32_32x32x16_bf16 v[112:127], v[212:215], v[144:147], 0
    s_nop 4
    s_waitcnt lgkmcnt(2)
    v_mfma_f32_32x32x16_bf16 v[112:127], v[232:235], v[148:151], v[112:127]
    v_cndmask_b32 v208, v131, v72, s[76:77]
    v_cndmask_b32 v209, v135, v131, s[76:77]
    v_cndmask_b32 v210, v139, v135, s[76:77]
    v_cndmask_b32 v211, v143, v139, s[76:77]
    v_mov_b32_e64 v72, v143
    s_waitcnt lgkmcnt(1)
    v_mfma_f32_32x32x16_bf16 v[112:127], v[236:239], v[152:155], v[112:127]
    v_add_f32_dpp v130, v208, v130 wave_ror:1 row_mask:0xf bank_mask:0xf
    v_add_f32_dpp v134, v209, v134 wave_ror:1 row_mask:0xf bank_mask:0xf
    v_add_f32_dpp v138, v210, v138 wave_ror:1 row_mask:0xf bank_mask:0xf
    v_add_f32_dpp v142, v211, v142 wave_ror:1 row_mask:0xf bank_mask:0xf
    v_cndmask_b32 v208, v130, v71, s[76:77]
    s_waitcnt lgkmcnt(0)
    v_mfma_f32_32x32x16_bf16 v[112:127], v[240:243], v[156:159], v[112:127]
    v_cndmask_b32 v209, v134, v130, s[76:77]
    v_cndmask_b32 v210, v138, v134, s[76:77]
    v_cndmask_b32 v211, v142, v138, s[76:77]
    v_mov_b32 v71, v142
    v_add_f32_dpp v129, v208, v129 wave_ror:1 row_mask:0xf bank_mask:0xf
    v_add_f32_dpp v133, v209, v133 wave_ror:1 row_mask:0xf bank_mask:0xf
    v_mfma_f32_32x32x16_bf16 v[112:127], v[244:247], v[160:163], v[112:127]
    v_add_f32_dpp v137, v210, v137 wave_ror:1 row_mask:0xf bank_mask:0xf
    v_add_f32_dpp v141, v211, v141 wave_ror:1 row_mask:0xf bank_mask:0xf
    v_cndmask_b32 v208, v129, v70, s[76:77]
    v_cndmask_b32 v209, v133, v129, s[76:77]
    v_cndmask_b32 v210, v137, v133, s[76:77]
    v_cndmask_b32 v211, v141, v137, s[76:77]
    v_mfma_f32_32x32x16_bf16 v[112:127], v[216:219], v[164:167], v[112:127]
    ds_read_b128 v[240:243], v64 offset:192
    v_mov_b32_e64 v70, v141
    v_add_f32_dpp v128, v208, v128 wave_ror:1 row_mask:0xf bank_mask:0xf
    v_add_f32_dpp v132, v209, v132 wave_ror:1 row_mask:0xf bank_mask:0xf
    v_add_f32_dpp v136, v210, v136 wave_ror:1 row_mask:0xf bank_mask:0xf
    v_add_f32_dpp v140, v211, v140 wave_ror:1 row_mask:0xf bank_mask:0xf
    v_mfma_f32_32x32x16_bf16 v[112:127], v[220:223], v[168:171], v[112:127]
    ds_read_b128 v[220:223], v64 offset:160
    ds_write_b32 v66, v128 offset:512
    ds_write_b32 v66, v132 offset:576
    v_mfma_f32_32x32x16_bf16 v[112:127], v[224:227], v[172:175], v[112:127]
    ds_read_b128 v[224:227], v64 offset:128
    ds_write_b32 v66, v136 offset:640
    ds_write_b32 v66, v140 offset:704
    v_mfma_f32_32x32x16_bf16 v[112:127], v[228:231], v[176:179], v[112:127]
    ds_read_b128 v[236:239], v64 offset:96
    s_waitcnt lgkmcnt(7)
    v_mfma_f32_32x32x16_bf16 v[112:127], v[240:243], v[180:183], v[112:127]
    ds_read_b128 v[240:243], v64 offset:64
    s_waitcnt lgkmcnt(7)
    v_mfma_f32_32x32x16_bf16 v[112:127], v[220:223], v[184:187], v[112:127]
    ds_read_b128 v[220:223], v64 offset:32
    s_waitcnt lgkmcnt(5)
    v_mfma_f32_32x32x16_bf16 v[112:127], v[224:227], v[188:191], v[112:127]
    ds_read_b128 v[224:227], v64 offset:0
    s_waitcnt lgkmcnt(3)
    v_mfma_f32_32x32x16_bf16 v[112:127], v[236:239], v[192:195], v[112:127]
    ds_read_b64_tr_b16 v[216:217], v65 offset:544
    ds_read_b64_tr_b16 v[218:219], v65 offset:512
    s_waitcnt lgkmcnt(4)
    v_mfma_f32_32x32x16_bf16 v[112:127], v[240:243], v[196:199], v[112:127]
    ds_read_b64_tr_b16 v[240:241], v65 offset:1056
    ds_read_b64_tr_b16 v[242:243], v65 offset:1024
    s_waitcnt lgkmcnt(5)
    v_mfma_f32_32x32x16_bf16 v[112:127], v[220:223], v[200:203], v[112:127]
    s_waitcnt lgkmcnt(4)
    v_mfma_f32_32x32x16_bf16 v[112:127], v[224:227], v[204:207], v[112:127]
    ds_read_b64_tr_b16 v[224:225], v65 offset:1568
    ds_read_b64_tr_b16 v[226:227], v65 offset:1536
    s_lshl_b32 s96, s75, 14
    s_add_u32 s96, s96, 6815744
    s_lshl_b32 s97, s24, 12
    s_add_u32 s97, s97, 3477504
    buffer_load_dwordx4 v[248:251], v62, s[16:19], s96 offen offset:2048 sc1
    s_waitcnt lgkmcnt(4)
    v_mfma_f32_32x32x16_bf16 v[144:159], v[212:215], v[216:219], 0
    s_nop 3
    v_cndmask_b32 v208, v115, v72, s[76:77]
    s_waitcnt lgkmcnt(2)
    v_mfma_f32_32x32x16_bf16 v[144:159], v[244:247], v[240:243], v[144:159]
    buffer_load_dwordx4 v[252:255], v62, s[16:19], s96 offen offset:3072 sc1
    v_cndmask_b32 v209, v119, v115, s[76:77]
    v_cndmask_b32 v210, v123, v119, s[76:77]
    v_cndmask_b32 v211, v127, v123, s[76:77]
    v_mov_b32_e64 v72, v127
    v_add_f32_dpp v114, v208, v114 wave_ror:1 row_mask:0xf bank_mask:0xf
    v_mfma_f32_32x32x16_bf16 v[160:175], v[212:215], v[240:243], 0
    ds_read_b64_tr_b16 v[216:217], v65 offset:2080
    ds_read_b64_tr_b16 v[218:219], v65 offset:2048
    v_add_f32_dpp v118, v209, v118 wave_ror:1 row_mask:0xf bank_mask:0xf
    v_add_f32_dpp v122, v210, v122 wave_ror:1 row_mask:0xf bank_mask:0xf
    v_add_f32_dpp v126, v211, v126 wave_ror:1 row_mask:0xf bank_mask:0xf
    s_waitcnt lgkmcnt(2)
    v_mfma_f32_32x32x16_bf16 v[144:159], v[228:231], v[224:227], v[144:159]
    buffer_load_dwordx4 v[96:99], v62, s[16:19], s97 offen offset:0 sc1
    v_cndmask_b32 v208, v114, v71, s[76:77]
    v_cndmask_b32 v209, v118, v114, s[76:77]
    v_cndmask_b32 v210, v122, v118, s[76:77]
    v_cndmask_b32 v211, v126, v122, s[76:77]
    v_mov_b32 v71, v126
    v_mfma_f32_32x32x16_bf16 v[160:175], v[244:247], v[224:227], v[160:175]
    v_add_f32_dpp v113, v208, v113 wave_ror:1 row_mask:0xf bank_mask:0xf
    v_add_f32_dpp v117, v209, v117 wave_ror:1 row_mask:0xf bank_mask:0xf
    v_add_f32_dpp v121, v210, v121 wave_ror:1 row_mask:0xf bank_mask:0xf
    v_add_f32_dpp v125, v211, v125 wave_ror:1 row_mask:0xf bank_mask:0xf
    v_cndmask_b32 v208, v113, v70, s[76:77]
    v_cndmask_b32 v209, v117, v113, s[76:77]
    v_mfma_f32_32x32x16_bf16 v[176:191], v[212:215], v[224:227], 0
    buffer_load_dwordx4 v[100:103], v62, s[16:19], s97 offen offset:1024 sc1
    v_cndmask_b32 v210, v121, v117, s[76:77]
    v_cndmask_b32 v211, v125, v121, s[76:77]
    v_mov_b32 v70, v125
    v_add_f32_dpp v112, v208, v112 wave_ror:1 row_mask:0xf bank_mask:0xf
    s_waitcnt lgkmcnt(0)
    v_mfma_f32_32x32x16_bf16 v[144:159], v[236:239], v[216:219], v[144:159]
    ds_read_b64_tr_b16 v[240:241], v65 offset:2592
    ds_read_b64_tr_b16 v[242:243], v65 offset:2560
    v_add_f32_dpp v116, v209, v116 wave_ror:1 row_mask:0xf bank_mask:0xf
    v_add_f32_dpp v120, v210, v120 wave_ror:1 row_mask:0xf bank_mask:0xf
    v_add_f32_dpp v124, v211, v124 wave_ror:1 row_mask:0xf bank_mask:0xf
    v_mfma_f32_32x32x16_bf16 v[160:175], v[228:231], v[216:219], v[160:175]
    buffer_load_dwordx4 v[104:107], v62, s[16:19], s97 offen offset:2048 sc1
    ds_write_b32 v66, v112 offset:768
    ds_write_b32 v66, v116 offset:832
    v_mfma_f32_32x32x16_bf16 v[176:191], v[244:247], v[216:219], v[176:191]
    ds_write_b32 v66, v120 offset:896
    ds_write_b32 v66, v124 offset:960
    v_mfma_f32_32x32x16_bf16 v[192:207], v[212:215], v[216:219], 0
    ds_read_b64_tr_b16 v[212:213], v65 offset:3104
    ds_read_b64_tr_b16 v[214:215], v65 offset:3072
    buffer_load_dwordx4 v[108:111], v62, s[16:19], s97 offen offset:3072 sc1
    s_waitcnt lgkmcnt(6)
    v_mfma_f32_32x32x16_bf16 v[160:175], v[236:239], v[240:243], v[160:175]
    v_mfma_f32_32x32x16_bf16 v[176:191], v[228:231], v[240:243], v[176:191]
    ds_read_b64_tr_b16 v[224:225], v65 offset:3616
    ds_read_b64_tr_b16 v[226:227], v65 offset:3584
    s_waitcnt vmcnt(6) lgkmcnt(4)
    s_barrier
    v_mfma_f32_32x32x16_bf16 v[192:207], v[244:247], v[240:243], v[192:207]
    ds_read_b64_tr_b16 v[244:245], v65 offset:672
    ds_read_b64_tr_b16 v[246:247], v65 offset:640
    ds_read_b64 v[112:113], v67 offset:0
    ds_read_b64 v[114:115], v67 offset:4224
    ds_read_b64 v[116:117], v67 offset:8448
    s_waitcnt lgkmcnt(7)
    v_mfma_f32_32x32x16_bf16 v[176:191], v[236:239], v[212:215], v[176:191]
    ds_read_b128 v[216:219], v64 offset:320
    ds_read_b64_tr_b16 v[240:241], v65 offset:1184
    ds_read_b64_tr_b16 v[242:243], v65 offset:1152
    ds_read_b64 v[118:119], v67 offset:12672
    ds_read_b64 v[120:121], v67 offset:512
    ds_read_b64 v[122:123], v67 offset:4736
    v_mfma_f32_32x32x16_bf16 v[192:207], v[228:231], v[212:215], v[192:207]
    ds_read_b64 v[124:125], v67 offset:8960
    ds_read_b64 v[126:127], v67 offset:13184
    s_lshl_b32 s25, s75, 14
    s_add_u32 s25, s25, 9437184
    s_waitcnt lgkmcnt(13)
    v_mfma_f32_32x32x16_bf16 v[192:207], v[236:239], v[224:227], v[192:207]
    ds_read_b128 v[228:231], v64 offset:192
    ds_read_b64_tr_b16 v[236:237], v65 offset:1696
    ds_read_b64_tr_b16 v[238:239], v65 offset:1664
    s_waitcnt lgkmcnt(14)
    v_mfma_f32_32x32x16_bf16 v[144:159], v[232:235], v[244:247], v[144:159]
    v_mov_b32 v5, 1
    s_add_u32 s82, s86, 24576
    buffer_atomic_add v5, v6, s[16:19], s82 offen offset:0 sc0 sc1
    s_waitcnt lgkmcnt(8)
    v_mfma_f32_32x32x16_bf16 v[144:159], v[216:219], v[240:243], v[144:159]
    v_mfma_f32_32x32x16_bf16 v[160:175], v[232:235], v[240:243], v[160:175]
    ds_read_b128 v[212:215], v64 offset:64
    ds_read_b64_tr_b16 v[224:225], v65 offset:2208
    ds_read_b64_tr_b16 v[226:227], v65 offset:2176
    s_waitcnt lgkmcnt(3)
    v_mfma_f32_32x32x16_bf16 v[144:159], v[228:231], v[236:239], v[144:159]
    v_mfma_f32_32x32x16_bf16 v[160:175], v[216:219], v[236:239], v[160:175]
    v_add_f32 v112, v112, v80
    v_add_f32 v113, v113, v81
    v_add_f32 v114, v114, v82
    v_add_f32 v115, v115, v83
    v_add_f32 v116, v116, v84
    v_mfma_f32_32x32x16_bf16 v[176:191], v[232:235], v[236:239], v[176:191]
    v_add_f32 v117, v117, v85
    v_add_f32 v118, v118, v86
    v_add_f32 v119, v119, v87
    v_cvt_pk_bf16_f32 v128, v112, v114
    v_cvt_pk_bf16_f32 v129, v116, v118
    s_waitcnt lgkmcnt(0)
    v_mfma_f32_32x32x16_bf16 v[144:159], v[212:215], v[224:227], v[144:159]
    ds_read_b64_tr_b16 v[244:245], v65 offset:2720
    ds_read_b64_tr_b16 v[246:247], v65 offset:2688
    v_cvt_pk_bf16_f32 v130, v113, v115
    v_cvt_pk_bf16_f32 v131, v117, v119
    v_mfma_f32_32x32x16_bf16 v[160:175], v[228:231], v[224:227], v[160:175]
    buffer_store_dwordx4 v[128:131], v62, s[16:19], s25 offen offset:0 sc1
    v_add_f32 v120, v120, v88
    v_add_f32 v121, v121, v89
    v_add_f32 v122, v122, v90
    v_add_f32 v123, v123, v91
    v_add_f32 v124, v124, v92
    v_mfma_f32_32x32x16_bf16 v[176:191], v[216:219], v[224:227], v[176:191]
    v_add_f32 v125, v125, v93
    v_add_f32 v126, v126, v94
    v_add_f32_e64 v127, v127, v95
    v_cvt_pk_bf16_f32 v132, v120, v122
    v_cvt_pk_bf16_f32 v133, v124, v126
    v_cvt_pk_bf16_f32 v134, v121, v123
    v_mfma_f32_32x32x16_bf16 v[192:207], v[232:235], v[224:227], v[192:207]
    ds_read_b64_tr_b16 v[232:233], v65 offset:3232
    ds_read_b64_tr_b16 v[234:235], v65 offset:3200
    v_cvt_pk_bf16_f32 v135, v125, v127
    s_waitcnt lgkmcnt(2)
    v_mfma_f32_32x32x16_bf16 v[160:175], v[212:215], v[244:247], v[160:175]
    buffer_store_dwordx4 v[132:135], v62, s[16:19], s25 offen offset:1024 sc1
    ds_read_b64_tr_b16 v[112:113], v65 offset:32
    ds_read_b64_tr_b16 v[114:115], v65 offset:0
    ds_read_b64_tr_b16 v[116:117], v65 offset:160
    ds_read_b64_tr_b16 v[118:119], v65 offset:128
    ds_read_b64_tr_b16 v[120:121], v65 offset:288
    v_mfma_f32_32x32x16_bf16 v[176:191], v[228:231], v[244:247], v[176:191]
    ds_read_b64_tr_b16 v[240:241], v65 offset:3744
    ds_read_b64_tr_b16 v[242:243], v65 offset:3712
    ds_read_b64_tr_b16 v[122:123], v65 offset:256
    ds_read_b64_tr_b16 v[124:125], v65 offset:416
    ds_read_b64_tr_b16 v[126:127], v65 offset:384
    ds_read_b64_tr_b16 v[128:129], v65 offset:544
    v_mfma_f32_32x32x16_bf16 v[192:207], v[216:219], v[244:247], v[192:207]
    ds_read_b128 v[216:219], v64 offset:416
    ds_read_b64_tr_b16 v[236:237], v65 offset:800
    ds_read_b64_tr_b16 v[238:239], v65 offset:768
    ds_read_b64_tr_b16 v[130:131], v65 offset:512
    ds_read_b64_tr_b16 v[132:133], v65 offset:672
    s_waitcnt lgkmcnt(15)
    v_mfma_f32_32x32x16_bf16 v[176:191], v[212:215], v[232:235], v[176:191]
    ds_read_b128 v[224:227], v64 offset:288
    ds_read_b64_tr_b16 v[244:245], v65 offset:1312
    ds_read_b64_tr_b16 v[246:247], v65 offset:1280
    ds_read_b64_tr_b16 v[134:135], v65 offset:640
    ds_read_b64_tr_b16 v[136:137], v65 offset:800
    ds_read_b64_tr_b16 v[138:139], v65 offset:768
    v_mfma_f32_32x32x16_bf16 v[192:207], v[228:231], v[232:235], v[192:207]
    ds_read_b64_tr_b16 v[140:141], v65 offset:928
    ds_read_b64_tr_b16 v[142:143], v65 offset:896
    s_waitcnt lgkmcnt(15)
    v_mfma_f32_32x32x16_bf16 v[192:207], v[212:215], v[240:243], v[192:207]
    ds_read_b128 v[228:231], v64 offset:160
    ds_read_b64_tr_b16 v[212:213], v65 offset:1824
    ds_read_b64_tr_b16 v[214:215], v65 offset:1792
    s_waitcnt vmcnt(3)
ce_31:
    v_max3_u32 v208, v248, v249, v250
    v_max3_u32 v208, v208, v251, v252
    v_max3_u32 v208, v208, v253, v254
    v_max_u32_e64 v208, v208, v255
    v_cmp_eq_u32 s[82:83], -1, v208
    v_min3_f32 v209, v96, v99, v100
    v_min3_f32 v209, v209, v103, v104
    v_min3_f32 v209, v209, v107, v108
    v_min_f32 v209, v209, v111
    v_cmp_neq_f32 vcc, 0x41000000, v209
    s_nop 0
    s_or_b64 vcc, vcc, s[82:83]
    s_cbranch_vccnz rd_32
rc_33:
    s_waitcnt lgkmcnt(13)
    v_mfma_f32_32x32x16_bf16 v[144:159], v[216:219], v[236:239], v[144:159]
    v_mul_f32 v208, 0x3acccccd, v97
    v_mul_f32 v209, 0x3acccccd, v101
    v_mul_f32 v98, 0x3acccccd, v98
    v_mul_f32 v102, 0x3acccccd, v102
    v_fma_f32 v98, -v208, v208, v98
    s_waitcnt lgkmcnt(8)
    v_mfma_f32_32x32x16_bf16 v[144:159], v[224:227], v[244:247], v[144:159]
    v_fma_f32 v102, -v209, v209, v102
    v_max_f32 v98, 0, v98
    v_max_f32 v102, 0, v102
    v_add_f32 v98, 0x3727c5ac, v98
    v_add_f32 v102, 0x3727c5ac, v102
    v_mfma_f32_32x32x16_bf16 v[160:175], v[216:219], v[244:247], v[160:175]
    ds_read_b64_tr_b16 v[232:233], v65 offset:2336
    ds_read_b64_tr_b16 v[234:235], v65 offset:2304
    v_rsq_f32 v97, v98
    s_waitcnt lgkmcnt(2)
    v_mfma_f32_32x32x16_bf16 v[144:159], v[228:231], v[212:215], v[144:159]
    v_rsq_f32_e64 v101, v102
    v_mul_f32 v98, -v208, v97
    v_mul_f32 v102, -v209, v101
    v_lshlrev_b32_e64 v80, 16, v248
    v_and_b32 v82, 0xffff0000, v248
    v_mfma_f32_32x32x16_bf16 v[160:175], v[224:227], v[212:215], v[160:175]
    v_lshlrev_b32 v84, 16, v249
    v_and_b32 v86, 0xffff0000, v249
    v_lshlrev_b32 v81, 16, v250
    v_and_b32 v83, 0xffff0000, v250
    v_lshlrev_b32_e64 v85, 16, v251
    v_and_b32 v87, 0xffff0000, v251
    v_mfma_f32_32x32x16_bf16 v[176:191], v[216:219], v[212:215], v[176:191]
    v_fma_f32 v208, v80, v97, v98
    v_fma_f32 v209, v81, v101, v102
    v_cvt_pk_bf16_f32 v248, v208, v209
    v_fma_f32 v208, v82, v97, v98
    v_fma_f32 v209, v83, v101, v102
    s_waitcnt lgkmcnt(0)
    v_mfma_f32_32x32x16_bf16 v[144:159], v[220:223], v[232:235], v[144:159]
    ds_read_b64_tr_b16 v[240:241], v65 offset:2848
    ds_read_b64_tr_b16 v[242:243], v65 offset:2816
    v_cvt_pk_bf16_f32 v249, v208, v209
    v_fma_f32 v208, v84, v97, v98
    v_fma_f32 v209, v85, v101, v102
    v_cvt_pk_bf16_f32 v250, v208, v209
    v_mfma_f32_32x32x16_bf16 v[160:175], v[228:231], v[232:235], v[160:175]
    v_fma_f32 v208, v86, v97, v98
    v_fma_f32 v209, v87, v101, v102
    v_cvt_pk_bf16_f32 v251, v208, v209
    v_mfma_f32_32x32x16_bf16 v[176:191], v[224:227], v[232:235], v[176:191]
    ds_write_b32 v63, v248 offset:512
    ds_write_b32 v63, v249 offset:5376
    ds_write_b32 v63, v250 offset:10240
    v_mfma_f32_32x32x16_bf16 v[192:207], v[216:219], v[232:235], v[192:207]
    ds_read_b64_tr_b16 v[216:217], v65 offset:3360
    ds_read_b64_tr_b16 v[218:219], v65 offset:3328
    ds_write_b32 v63, v251 offset:15104
    v_mul_f32 v208, 0x3acccccd, v105
    s_waitcnt lgkmcnt(6)
    v_mfma_f32_32x32x16_bf16 v[160:175], v[220:223], v[240:243], v[160:175]
    v_mul_f32 v209, 0x3acccccd, v109
    v_mul_f32 v106, 0x3acccccd, v106
    v_mul_f32 v110, 0x3acccccd, v110
    v_fma_f32 v106, -v208, v208, v106
    v_fma_f32 v110, -v209, v209, v110
    v_max_f32_e64 v106, 0, v106
    v_mfma_f32_32x32x16_bf16 v[176:191], v[228:231], v[240:243], v[176:191]
    ds_read_b64_tr_b16 v[236:237], v65 offset:3872
    ds_read_b64_tr_b16 v[238:239], v65 offset:3840
    v_max_f32_e64 v110, 0, v110
    v_add_f32 v106, 0x3727c5ac, v106
    v_add_f32 v110, 0x3727c5ac, v110
    v_mfma_f32_32x32x16_bf16 v[192:207], v[224:227], v[240:243], v[192:207]
    ds_read_b128 v[224:227], v64 offset:384
    ds_read_b64_tr_b16 v[244:245], v65 offset:928
    ds_read_b64_tr_b16 v[246:247], v65 offset:896
    v_rsq_f32 v105, v106
    s_waitcnt lgkmcnt(6)
    v_mfma_f32_32x32x16_bf16 v[176:191], v[220:223], v[216:219], v[176:191]
    ds_read_b128 v[212:215], v64 offset:256
    ds_read_b64_tr_b16 v[232:233], v65 offset:1440
    ds_read_b64_tr_b16 v[234:235], v65 offset:1408
    v_rsq_f32_e64 v109, v110
    v_mul_f32 v106, -v208, v105
    v_mfma_f32_32x32x16_bf16 v[192:207], v[228:231], v[216:219], v[192:207]
    v_mul_f32 v110, -v209, v109
    v_lshlrev_b32 v88, 16, v252
    v_and_b32 v90, 0xffff0000, v252
    v_lshlrev_b32 v92, 16, v253
    v_and_b32 v94, 0xffff0000, v253
    s_waitcnt lgkmcnt(6)
    v_mfma_f32_32x32x16_bf16 v[192:207], v[220:223], v[236:239], v[192:207]
    ds_read_b128 v[220:223], v64 offset:128
    ds_read_b64_tr_b16 v[228:229], v65 offset:1952
    ds_read_b64_tr_b16 v[230:231], v65 offset:1920
    v_lshlrev_b32 v89, 16, v254
    v_and_b32 v91, 0xffff0000, v254
    s_waitcnt lgkmcnt(6)
    v_mfma_f32_32x32x16_bf16 v[144:159], v[224:227], v[244:247], v[144:159]
    v_lshlrev_b32 v93, 16, v255
    v_and_b32 v95, 0xffff0000, v255
    v_fma_f32 v208, v88, v105, v106
    v_fma_f32 v209, v89, v109, v110
    v_cvt_pk_bf16_f32 v252, v208, v209
    s_waitcnt lgkmcnt(3)
    v_mfma_f32_32x32x16_bf16 v[144:159], v[212:215], v[232:235], v[144:159]
    v_fma_f32 v208, v90, v105, v106
    v_fma_f32 v209, v91, v109, v110
    v_cvt_pk_bf16_f32 v253, v208, v209
    v_fma_f32 v208, v92, v105, v106
    v_fma_f32 v209, v93, v109, v110
    v_cvt_pk_bf16_f32 v254, v208, v209
    v_mfma_f32_32x32x16_bf16 v[160:175], v[224:227], v[232:235], v[160:175]
    ds_read_b128 v[240:243], v64 offset:0
    ds_read_b64_tr_b16 v[216:217], v65 offset:2464
    ds_read_b64_tr_b16 v[218:219], v65 offset:2432
    v_fma_f32 v208, v94, v105, v106
    v_fma_f32 v209, v95, v109, v110
    s_waitcnt lgkmcnt(3)
    v_mfma_f32_32x32x16_bf16 v[144:159], v[220:223], v[228:231], v[144:159]
    v_cvt_pk_bf16_f32 v255, v208, v209
    ds_write_b32 v63, v252 offset:768
    v_mfma_f32_32x32x16_bf16 v[160:175], v[212:215], v[228:231], v[160:175]
    ds_write_b32 v63, v253 offset:5632
    ds_write_b32 v63, v254 offset:10496
    ds_write_b32 v63, v255 offset:15360
    v_mfma_f32_32x32x16_bf16 v[176:191], v[224:227], v[228:231], v[176:191]
    s_waitcnt vmcnt(2)
    v_cmp_eq_u32 vcc, 19, v5
    s_nop 0
    s_cbranch_vccnz gl_34
gc_35:
    s_lshl_b32 s25, s72, 5
    s_add_u32 s25, s25, 0
    s_sub_u32 s26, s25, 4
    s_waitcnt lgkmcnt(4)
    v_mfma_f32_32x32x16_bf16 v[144:159], v[240:243], v[216:219], v[144:159]
    ds_read_b64_tr_b16 v[236:237], v65 offset:2976
    ds_read_b64_tr_b16 v[238:239], v65 offset:2944
    s_max_i32 s26, s26, 0
    s_lshl_b32 s27, s71, 12
    s_add_u32 s27, s27, 9437184
    s_lshl_b32 s99, s25, 3
    v_mfma_f32_32x32x16_bf16 v[160:175], v[220:223], v[216:219], v[160:175]
    s_lshl_b32 s100, s26, 3
    s_lshl_b32 s92, s24, 12
    s_lshl_b32 s93, s24, 9
    s_add_u32 s99, s99, s27
    s_add_u32 s100, s100, s27
    v_mfma_f32_32x32x16_bf16 v[176:191], v[212:215], v[216:219], v[176:191]
    v_mfma_f32_32x32x16_bf16 v[192:207], v[224:227], v[216:219], v[192:207]
    ds_read_b64_tr_b16 v[224:225], v65 offset:3488
    ds_read_b64_tr_b16 v[226:227], v65 offset:3456
    s_waitcnt lgkmcnt(2)
    v_mfma_f32_32x32x16_bf16 v[160:175], v[240:243], v[236:239], v[160:175]
    v_mfma_f32_32x32x16_bf16 v[176:191], v[220:223], v[236:239], v[176:191]
    ds_read_b64_tr_b16 v[244:245], v65 offset:4000
    ds_read_b64_tr_b16 v[246:247], v65 offset:3968
    v_mfma_f32_32x32x16_bf16 v[192:207], v[212:215], v[236:239], v[192:207]
    s_waitcnt lgkmcnt(2)
    v_mfma_f32_32x32x16_bf16 v[176:191], v[240:243], v[224:227], v[176:191]
    v_mfma_f32_32x32x16_bf16 v[192:207], v[220:223], v[224:227], v[192:207]
    s_waitcnt lgkmcnt(0)
    v_mfma_f32_32x32x16_bf16 v[192:207], v[240:243], v[244:247], v[192:207]
    s_waitcnt lgkmcnt(0)
    s_barrier
    ds_read_b128 v[212:215], v64 offset:608
    ds_read_b128 v[216:219], v64 offset:576
    ds_read_b128 v[220:223], v64 offset:544
    ds_read_b128 v[224:227], v64 offset:512
    s_waitcnt lgkmcnt(3)
    v_mfma_f32_32x32x16_bf16 v[144:159], v[212:215], v[112:115], v[144:159]
    ds_read_b128 v[228:231], v64 offset:736
    s_waitcnt lgkmcnt(3)
    v_mfma_f32_32x32x16_bf16 v[144:159], v[216:219], v[116:119], v[144:159]
    ds_read_b128 v[232:235], v64 offset:704
    s_waitcnt lgkmcnt(3)
    v_mfma_f32_32x32x16_bf16 v[144:159], v[220:223], v[120:123], v[144:159]
    ds_read_b128 v[236:239], v64 offset:672
    s_waitcnt lgkmcnt(3)
    v_mfma_f32_32x32x16_bf16 v[144:159], v[224:227], v[124:127], v[144:159]
    ds_read_b128 v[240:243], v64 offset:640
    s_nop 3
    s_waitcnt lgkmcnt(3)
    v_mfma_f32_32x32x16_bf16 v[160:175], v[228:231], v[112:115], v[160:175]
    s_nop 4
    s_waitcnt lgkmcnt(2)
    v_mfma_f32_32x32x16_bf16 v[160:175], v[232:235], v[116:119], v[160:175]
    v_cndmask_b32 v208, v147, v72, s[76:77]
    v_cndmask_b32 v209, v151, v147, s[76:77]
    v_cndmask_b32 v210, v155, v151, s[76:77]
    v_cndmask_b32 v211, v159, v155, s[76:77]
    v_mov_b32_e64 v72, v159
    s_waitcnt lgkmcnt(1)
    v_mfma_f32_32x32x16_bf16 v[160:175], v[236:239], v[120:123], v[160:175]
    v_add_f32_dpp v146, v208, v146 wave_ror:1 row_mask:0xf bank_mask:0xf
    v_add_f32_dpp v150, v209, v150 wave_ror:1 row_mask:0xf bank_mask:0xf
    v_add_f32_dpp v154, v210, v154 wave_ror:1 row_mask:0xf bank_mask:0xf
    v_add_f32_dpp v158, v211, v158 wave_ror:1 row_mask:0xf bank_mask:0xf
    v_cndmask_b32 v208, v146, v71, s[76:77]
    s_waitcnt lgkmcnt(0)
    v_mfma_f32_32x32x16_bf16 v[160:175], v[240:243], v[124:127], v[160:175]
    v_cndmask_b32 v209, v150, v146, s[76:77]
    v_cndmask_b32 v210, v154, v150, s[76:77]
    v_cndmask_b32 v211, v158, v154, s[76:77]
    v_mov_b32 v71, v158
    v_add_f32_dpp v145, v208, v145 wave_ror:1 row_mask:0xf bank_mask:0xf
    v_add_f32_dpp v149, v209, v149 wave_ror:1 row_mask:0xf bank_mask:0xf
    v_mfma_f32_32x32x16_bf16 v[160:175], v[212:215], v[128:131], v[160:175]
    ds_read_b128 v[244:247], v64 offset:864
    v_add_f32_dpp v153, v210, v153 wave_ror:1 row_mask:0xf bank_mask:0xf
    v_add_f32_dpp v157, v211, v157 wave_ror:1 row_mask:0xf bank_mask:0xf
    v_cndmask_b32 v208, v145, v70, s[76:77]
    v_cndmask_b32 v209, v149, v145, s[76:77]
    v_cndmask_b32 v210, v153, v149, s[76:77]
    v_mfma_f32_32x32x16_bf16 v[160:175], v[216:219], v[132:135], v[160:175]
    ds_read_b128 v[248:251], v64 offset:832
    v_cndmask_b32 v211, v157, v153, s[76:77]
    v_mov_b32_e64 v70, v157
    v_add_f32_dpp v144, v208, v144 wave_ror:1 row_mask:0xf bank_mask:0xf
    v_add_f32_dpp v148, v209, v148 wave_ror:1 row_mask:0xf bank_mask:0xf
    v_add_f32_dpp v152, v210, v152 wave_ror:1 row_mask:0xf bank_mask:0xf
    v_mfma_f32_32x32x16_bf16 v[160:175], v[220:223], v[136:139], v[160:175]
    ds_read_b128 v[252:255], v64 offset:800
    v_add_f32_dpp v156, v211, v156 wave_ror:1 row_mask:0xf bank_mask:0xf
    ds_write_b32 v66, v144 offset:0
    v_mfma_f32_32x32x16_bf16 v[160:175], v[224:227], v[140:143], v[160:175]
    ds_read_b128 v[224:227], v64 offset:768
    ds_write_b32 v66, v148 offset:64
    ds_write_b32 v66, v152 offset:128
    s_waitcnt lgkmcnt(6)
    v_mfma_f32_32x32x16_bf16 v[176:191], v[244:247], v[112:115], v[176:191]
    ds_write_b32 v66, v156 offset:192
    s_nop 2
    s_waitcnt lgkmcnt(6)
    v_mfma_f32_32x32x16_bf16 v[176:191], v[248:251], v[116:119], v[176:191]
    s_nop 2
    v_cndmask_b32 v208, v163, v72, s[76:77]
    v_cndmask_b32 v209, v167, v163, s[76:77]
    s_waitcnt lgkmcnt(5)
    v_mfma_f32_32x32x16_bf16 v[176:191], v[252:255], v[120:123], v[176:191]
    v_cndmask_b32 v210, v171, v167, s[76:77]
    v_cndmask_b32 v211, v175, v171, s[76:77]
    v_mov_b32 v72, v175
    v_add_f32_dpp v162, v208, v162 wave_ror:1 row_mask:0xf bank_mask:0xf
    v_add_f32_dpp v166, v209, v166 wave_ror:1 row_mask:0xf bank_mask:0xf
    s_waitcnt lgkmcnt(3)
    v_mfma_f32_32x32x16_bf16 v[176:191], v[224:227], v[124:127], v[176:191]
    v_add_f32_dpp v170, v210, v170 wave_ror:1 row_mask:0xf bank_mask:0xf
    v_add_f32_dpp v174, v211, v174 wave_ror:1 row_mask:0xf bank_mask:0xf
    v_cndmask_b32 v208, v162, v71, s[76:77]
    v_cndmask_b32 v209, v166, v162, s[76:77]
    v_cndmask_b32 v210, v170, v166, s[76:77]
    v_cndmask_b32 v211, v174, v170, s[76:77]
    v_mfma_f32_32x32x16_bf16 v[176:191], v[228:231], v[128:131], v[176:191]
    ds_read_b64_tr_b16 v[228:229], v65 offset:1056
    ds_read_b64_tr_b16 v[230:231], v65 offset:1024
    v_mov_b32 v71, v174
    v_add_f32_dpp v161, v208, v161 wave_ror:1 row_mask:0xf bank_mask:0xf
    v_add_f32_dpp v165, v209, v165 wave_ror:1 row_mask:0xf bank_mask:0xf
    v_add_f32_dpp v169, v210, v169 wave_ror:1 row_mask:0xf bank_mask:0xf
    v_mfma_f32_32x32x16_bf16 v[176:191], v[232:235], v[132:135], v[176:191]
    ds_read_b64_tr_b16 v[232:233], v65 offset:1184
    ds_read_b64_tr_b16 v[234:235], v65 offset:1152
    v_add_f32_dpp v173, v211, v173 wave_ror:1 row_mask:0xf bank_mask:0xf
    v_cndmask_b32 v208, v161, v70, s[76:77]
    v_cndmask_b32 v209, v165, v161, s[76:77]
    v_cndmask_b32 v210, v169, v165, s[76:77]
    v_mfma_f32_32x32x16_bf16 v[176:191], v[236:239], v[136:139], v[176:191]
    ds_read_b64_tr_b16 v[236:237], v65 offset:1312
    ds_read_b64_tr_b16 v[238:239], v65 offset:1280
    v_cndmask_b32 v211, v173, v169, s[76:77]
    v_mov_b32_e64 v70, v173
    v_add_f32_dpp v160, v208, v160 wave_ror:1 row_mask:0xf bank_mask:0xf
    v_add_f32_dpp v164, v209, v164 wave_ror:1 row_mask:0xf bank_mask:0xf
    v_mfma_f32_32x32x16_bf16 v[176:191], v[240:243], v[140:143], v[176:191]
    ds_read_b128 v[240:243], v64 offset:512
    ds_read_b64_tr_b16 v[224:225], v65 offset:1440
    ds_read_b64_tr_b16 v[226:227], v65 offset:1408
    v_add_f32_dpp v168, v210, v168 wave_ror:1 row_mask:0xf bank_mask:0xf
    v_add_f32_dpp v172, v211, v172 wave_ror:1 row_mask:0xf bank_mask:0xf
    s_waitcnt lgkmcnt(7)
    v_mfma_f32_32x32x16_bf16 v[176:191], v[212:215], v[228:231], v[176:191]
    ds_read_b128 v[212:215], v64 offset:992
    ds_write_b32 v66, v160 offset:256
    ds_write_b32 v66, v164 offset:320
    s_waitcnt lgkmcnt(8)
    v_mfma_f32_32x32x16_bf16 v[176:191], v[216:219], v[232:235], v[176:191]
    ds_read_b128 v[216:219], v64 offset:960
    ds_write_b32 v66, v168 offset:384
    ds_write_b32 v66, v172 offset:448
    s_waitcnt lgkmcnt(9)
    v_mfma_f32_32x32x16_bf16 v[176:191], v[220:223], v[236:239], v[176:191]
    ds_read_b128 v[220:223], v64 offset:928
    s_waitcnt lgkmcnt(7)
    v_mfma_f32_32x32x16_bf16 v[176:191], v[240:243], v[224:227], v[176:191]
    ds_read_b128 v[240:243], v64 offset:896
    s_waitcnt lgkmcnt(2)
    s_barrier
    v_mfma_f32_32x32x16_bf16 v[192:207], v[212:215], v[112:115], v[192:207]
    ds_read_b64 v[144:145], v67 offset:0
    ds_read_b64 v[146:147], v67 offset:4224
    ds_read_b64 v[148:149], v67 offset:8448
    ds_read_b64 v[150:151], v67 offset:12672
    s_lshl_b32 s25, s75, 14
    v_mfma_f32_32x32x16_bf16 v[192:207], v[216:219], v[116:119], v[192:207]
    buffer_load_dword v7, v4, s[16:19], s89 offen offset:0 sc1
    s_add_u32 s25, s25, 9437184
    s_nop 0
    v_cndmask_b32 v208, v179, v72, s[76:77]
    v_cndmask_b32 v209, v183, v179, s[76:77]
    s_waitcnt lgkmcnt(5)
    v_mfma_f32_32x32x16_bf16 v[192:207], v[220:223], v[120:123], v[192:207]
    v_cndmask_b32 v210, v187, v183, s[76:77]
    v_cndmask_b32 v211, v191, v187, s[76:77]
    v_mov_b32 v72, v191
    v_add_f32_dpp v178, v208, v178 wave_ror:1 row_mask:0xf bank_mask:0xf
    v_add_f32_dpp v182, v209, v182 wave_ror:1 row_mask:0xf bank_mask:0xf
    s_waitcnt lgkmcnt(4)
    v_mfma_f32_32x32x16_bf16 v[192:207], v[240:243], v[124:127], v[192:207]
    ds_read_b128 v[212:215], v64 offset:768
    v_add_f32_dpp v186, v210, v186 wave_ror:1 row_mask:0xf bank_mask:0xf
    v_add_f32_dpp v190, v211, v190 wave_ror:1 row_mask:0xf bank_mask:0xf
    v_cndmask_b32 v208, v178, v71, s[76:77]
    v_cndmask_b32 v209, v182, v178, s[76:77]
    v_cndmask_b32 v210, v186, v182, s[76:77]
    v_mfma_f32_32x32x16_bf16 v[192:207], v[244:247], v[128:131], v[192:207]
    ds_read_b128 v[244:247], v64 offset:736
    v_cndmask_b32 v211, v190, v186, s[76:77]
    v_mov_b32 v71, v190
    v_add_f32_dpp v177, v208, v177 wave_ror:1 row_mask:0xf bank_mask:0xf
    v_add_f32_dpp v181, v209, v181 wave_ror:1 row_mask:0xf bank_mask:0xf
    v_add_f32_dpp v185, v210, v185 wave_ror:1 row_mask:0xf bank_mask:0xf
    v_mfma_f32_32x32x16_bf16 v[192:207], v[248:251], v[132:135], v[192:207]
    ds_read_b128 v[248:251], v64 offset:704
    v_add_f32_dpp v189, v211, v189 wave_ror:1 row_mask:0xf bank_mask:0xf
    v_cndmask_b32 v208, v177, v70, s[76:77]
    v_cndmask_b32 v209, v181, v177, s[76:77]
    v_cndmask_b32 v210, v185, v181, s[76:77]
    v_cndmask_b32 v211, v189, v185, s[76:77]
    v_mfma_f32_32x32x16_bf16 v[192:207], v[252:255], v[136:139], v[192:207]
    ds_read_b128 v[252:255], v64 offset:672
    v_mov_b32_e64 v70, v189
    v_add_f32_dpp v176, v208, v176 wave_ror:1 row_mask:0xf bank_mask:0xf
    v_add_f32_dpp v180, v209, v180 wave_ror:1 row_mask:0xf bank_mask:0xf
    v_add_f32_dpp v184, v210, v184 wave_ror:1 row_mask:0xf bank_mask:0xf
    s_waitcnt lgkmcnt(3)
    v_mfma_f32_32x32x16_bf16 v[192:207], v[212:215], v[140:143], v[192:207]
    ds_read_b128 v[216:219], v64 offset:640
    v_add_f32_dpp v188, v211, v188 wave_ror:1 row_mask:0xf bank_mask:0xf
    s_waitcnt lgkmcnt(3)
    v_mfma_f32_32x32x16_bf16 v[192:207], v[244:247], v[228:231], v[192:207]
    ds_read_b128 v[228:231], v64 offset:608
    ds_read_b64_tr_b16 v[220:221], v65 offset:1568
    ds_read_b64_tr_b16 v[222:223], v65 offset:1536
    ds_write_b32 v66, v176 offset:512
    s_waitcnt lgkmcnt(6)
    v_mfma_f32_32x32x16_bf16 v[192:207], v[248:251], v[232:235], v[192:207]
    ds_read_b128 v[232:235], v64 offset:576
    ds_read_b64_tr_b16 v[240:241], v65 offset:1696
    ds_read_b64_tr_b16 v[242:243], v65 offset:1664
    ds_write_b32 v66, v180 offset:576
    s_waitcnt lgkmcnt(9)
    v_mfma_f32_32x32x16_bf16 v[192:207], v[252:255], v[236:239], v[192:207]
    ds_read_b128 v[236:239], v64 offset:544
    ds_read_b64_tr_b16 v[212:213], v65 offset:1824
    ds_read_b64_tr_b16 v[214:215], v65 offset:1792
    ds_write_b32 v66, v184 offset:640
    s_waitcnt lgkmcnt(12)
    v_mfma_f32_32x32x16_bf16 v[192:207], v[216:219], v[224:227], v[192:207]
    ds_read_b128 v[224:227], v64 offset:512
    ds_read_b64_tr_b16 v[244:245], v65 offset:1952
    ds_read_b64_tr_b16 v[246:247], v65 offset:1920
    ds_write_b32 v66, v188 offset:704
    s_waitcnt lgkmcnt(13)
    v_mfma_f32_32x32x16_bf16 v[192:207], v[228:231], v[220:223], v[192:207]
    v_add_f32 v144, v144, v80
    v_add_f32 v145, v145, v81
    v_add_f32 v146, v146, v82
    v_add_f32 v147, v147, v83
    s_waitcnt lgkmcnt(9)
    v_mfma_f32_32x32x16_bf16 v[192:207], v[232:235], v[240:243], v[192:207]
    v_add_f32 v148, v148, v84
    v_add_f32 v149, v149, v85
    v_add_f32 v150, v150, v86
    v_add_f32 v151, v151, v87
    v_cvt_pk_bf16_f32 v160, v144, v146
    s_waitcnt lgkmcnt(5)
    v_mfma_f32_32x32x16_bf16 v[192:207], v[236:239], v[212:215], v[192:207]
    v_cvt_pk_bf16_f32 v161, v148, v150
    v_cvt_pk_bf16_f32 v162, v145, v147
    v_cvt_pk_bf16_f32 v163, v149, v151
    s_waitcnt lgkmcnt(1)
    v_mfma_f32_32x32x16_bf16 v[192:207], v[224:227], v[244:247], v[192:207]
    buffer_store_dwordx4 v[160:163], v62, s[16:19], s25 offen offset:2048 sc1
    s_nop 10
    v_cndmask_b32 v208, v195, v72, s[76:77]
    v_cndmask_b32 v209, v199, v195, s[76:77]
    v_cndmask_b32 v210, v203, v199, s[76:77]
    v_cndmask_b32 v211, v207, v203, s[76:77]
    v_mov_b32_e64 v72, v207
    v_add_f32_dpp v194, v208, v194 wave_ror:1 row_mask:0xf bank_mask:0xf
    v_add_f32_dpp v198, v209, v198 wave_ror:1 row_mask:0xf bank_mask:0xf
    v_add_f32_dpp v202, v210, v202 wave_ror:1 row_mask:0xf bank_mask:0xf
    v_add_f32_dpp v206, v211, v206 wave_ror:1 row_mask:0xf bank_mask:0xf
    v_cndmask_b32 v208, v194, v71, s[76:77]
    v_cndmask_b32 v209, v198, v194, s[76:77]
    v_cndmask_b32 v210, v202, v198, s[76:77]
    v_cndmask_b32 v211, v206, v202, s[76:77]
    v_mov_b32_e64 v71, v206
    v_add_f32_dpp v193, v208, v193 wave_ror:1 row_mask:0xf bank_mask:0xf
    v_add_f32_dpp v197, v209, v197 wave_ror:1 row_mask:0xf bank_mask:0xf
    v_add_f32_dpp v201, v210, v201 wave_ror:1 row_mask:0xf bank_mask:0xf
    v_add_f32_dpp v205, v211, v205 wave_ror:1 row_mask:0xf bank_mask:0xf
    v_cndmask_b32 v208, v193, v70, s[76:77]
    v_cndmask_b32 v209, v197, v193, s[76:77]
    v_cndmask_b32 v210, v201, v197, s[76:77]
    v_cndmask_b32 v211, v205, v201, s[76:77]
    v_mov_b32_e64 v70, v205
    v_add_f32_dpp v192, v208, v192 wave_ror:1 row_mask:0xf bank_mask:0xf
    v_add_f32_dpp v196, v209, v196 wave_ror:1 row_mask:0xf bank_mask:0xf
    v_add_f32_dpp v200, v210, v200 wave_ror:1 row_mask:0xf bank_mask:0xf
    v_add_f32_dpp v204, v211, v204 wave_ror:1 row_mask:0xf bank_mask:0xf
    ds_write_b32 v66, v192 offset:768
    ds_write_b32 v66, v196 offset:832
    ds_write_b32 v66, v200 offset:896
    ds_write_b32 v66, v204 offset:960
    s_waitcnt lgkmcnt(0)
    s_waitcnt vmcnt(1)
    v_cmp_gt_u32_e64 vcc, 1, v7
    s_nop 0
    s_and_b64 vcc, vcc, s[50:51]
    s_cbranch_scc1 ps_36
pc_38:
    s_barrier
    ds_read_b64 v[152:153], v67 offset:512
    ds_read_b64 v[154:155], v67 offset:4736
    ds_read_b64 v[156:157], v67 offset:8960
    ds_read_b64 v[158:159], v67 offset:13184
    s_add_u32 m0, s92, 36352
    s_nop 0
    s_nop 0
    buffer_load_dwordx4 v73, s[16:19], s99 offen offset:0 sc1 lds
    buffer_load_dwordx4 v74, s[16:19], s99 offen offset:1024 sc1 lds
    buffer_load_dwordx4 v75, s[16:19], s99 offen offset:2048 sc1 lds
    buffer_load_dwordx4 v76, s[16:19], s99 offen offset:3072 sc1 lds
    s_add_u32 m0, s93, 53760
    s_add_u32 s99, s99, 524288
    s_mov_b64 exec, s[80:81]
    buffer_load_dwordx4 v77, s[16:19], s100 offen sc1 lds
    s_mov_b64 exec, -1
    s_add_u32 s100, s100, 524288
    s_lshl_b32 s25, s75, 14
    s_add_u32 s25, s25, 9437184
    s_waitcnt lgkmcnt(0)
    v_add_f32 v152, v152, v88
    v_add_f32 v153, v153, v89
    v_add_f32 v154, v154, v90
    v_add_f32 v155, v155, v91
    v_add_f32 v156, v156, v92
    v_add_f32 v157, v157, v93
    v_add_f32 v158, v158, v94
    v_add_f32 v159, v159, v95
    v_cvt_pk_bf16_f32 v164, v152, v154
    v_cvt_pk_bf16_f32 v165, v156, v158
    v_cvt_pk_bf16_f32 v166, v153, v155
    v_cvt_pk_bf16_f32 v167, v157, v159
    buffer_store_dwordx4 v[164:167], v62, s[16:19], s25 offen offset:3072 sc1
    v_mov_b32_e64 v5, 1
    s_add_u32 s82, s86, 24576
    buffer_atomic_add v5, v6, s[16:19], s82 offen offset:4 sc0 sc1
    s_add_u32 m0, s92, 55936
    s_nop 0
    s_nop 0
    buffer_load_dwordx4 v73, s[16:19], s99 offen offset:0 sc1 lds
    buffer_load_dwordx4 v74, s[16:19], s99 offen offset:1024 sc1 lds
    buffer_load_dwordx4 v75, s[16:19], s99 offen offset:2048 sc1 lds
    buffer_load_dwordx4 v76, s[16:19], s99 offen offset:3072 sc1 lds
    s_add_u32 m0, s93, 73344
    s_add_u32 s99, s99, 524288
    s_mov_b64 exec, s[80:81]
    buffer_load_dwordx4 v77, s[16:19], s100 offen sc1 lds
    s_mov_b64 exec, -1
    s_add_u32 s100, s100, 524288
    s_branch ec_27
nc_26:
    v_lshlrev_b32 v2, 3, v4
    v_mov_b32_e64 v5, 1
    v_cndmask_b32 v2, v4, v2, s[50:51]
    buffer_atomic_add v5, v2, s[16:19], s86 offen offset:8 sc1
    buffer_load_dword v7, v4, s[16:19], s87 offen offset:8 sc1
    s_waitcnt vmcnt(0)
    v_cmp_gt_u32 vcc, 12, v7
    s_nop 0
    s_and_b64 vcc, vcc, s[50:51]
    s_cbranch_scc1 ps_39
pc_41:
    v_mov_b32 v100, -1
    v_mov_b32 v101, -1
    v_mov_b32 v102, -1
    v_mov_b32 v103, -1
    v_lshlrev_b32 v104, 4, v0
    s_sub_u32 s88, s2, 160
    s_mul_i32 s88, s88, 57344
    s_min_u32 s88, s88, 5185536
    s_add_u32 s88, s88, 12058624
    buffer_store_dwordx4 v[100:103], v104, s[16:19], s88 offen sc1
    s_add_u32 s88, s88, 4096
    buffer_store_dwordx4 v[100:103], v104, s[16:19], s88 offen sc1
    s_add_u32 s88, s88, 4096
    buffer_store_dwordx4 v[100:103], v104, s[16:19], s88 offen sc1
    s_add_u32 s88, s88, 4096
    buffer_store_dwordx4 v[100:103], v104, s[16:19], s88 offen sc1
    s_add_u32 s88, s88, 4096
    buffer_store_dwordx4 v[100:103], v104, s[16:19], s88 offen sc1
    s_add_u32 s88, s88, 4096
    buffer_store_dwordx4 v[100:103], v104, s[16:19], s88 offen sc1
    s_add_u32 s88, s88, 4096
    buffer_store_dwordx4 v[100:103], v104, s[16:19], s88 offen sc1
    s_add_u32 s88, s88, 4096
    buffer_store_dwordx4 v[100:103], v104, s[16:19], s88 offen sc1
    s_add_u32 s88, s88, 4096
    buffer_store_dwordx4 v[100:103], v104, s[16:19], s88 offen sc1
    s_add_u32 s88, s88, 4096
    buffer_store_dwordx4 v[100:103], v104, s[16:19], s88 offen sc1
    s_add_u32 s88, s88, 4096
    buffer_store_dwordx4 v[100:103], v104, s[16:19], s88 offen sc1
    s_add_u32 s88, s88, 4096
    buffer_store_dwordx4 v[100:103], v104, s[16:19], s88 offen sc1
    s_add_u32 s88, s88, 4096
    buffer_store_dwordx4 v[100:103], v104, s[16:19], s88 offen sc1
    s_add_u32 s88, s88, 4096
    buffer_store_dwordx4 v[100:103], v104, s[16:19], s88 offen sc1
    s_waitcnt vmcnt(0)
    s_barrier
    v_mov_b32_e64 v5, 1
    s_add_u32 s82, s86, 8192
    buffer_atomic_add v5, v6, s[16:19], s82 offen offset:12 sc0 sc1
    s_waitcnt vmcnt(0)
    v_cmp_eq_u32 vcc, 11, v5
    s_nop 0
    s_cbranch_vccnz gl_42
gc_43:
    buffer_load_dword v7, v4, s[16:19], s89 offen offset:0 sc1
    s_waitcnt vmcnt(0)
    v_cmp_gt_u32 vcc, 1, v7
    s_nop 0
    s_and_b64 vcc, vcc, s[50:51]
    s_cbranch_scc1 ps_44
pc_46:
    s_barrier
    s_sub_u32 s3, s2, 160
    s_and_b32 s3, s3, 63
    s_add_u32 s3, s3, 0
    s_and_b32 s25, s3, 3
    s_lshl_b32 s25, s25, 12
    s_lshr_b32 s26, s3, 2
    s_lshl_b32 s26, s26, 7
    s_add_u32 s3, s25, s26
    v_lshrrev_b32 v236, 3, v0
    v_and_b32 v237, 7, v0
    v_lshlrev_b32 v237, 4, v237
    v_lshl_add_u32 v236, v236, 14, v237
    s_sub_u32 s25, s2, 160
    s_cmp_lt_u32 s25, 64
    s_cselect_b32 s25, 0, 1073741824
    v_add_u32_e64 v236, s25, v236
    s_add_u32 s26, s3, 9437184
    buffer_load_dwordx4 v[216:219], v236, s[16:19], s26 offen sc1
    s_add_u32 s26, s26, 524288
    buffer_load_dwordx4 v[220:223], v236, s[16:19], s26 offen sc1
    s_add_u32 s26, s26, 524288
    buffer_load_dwordx4 v[224:227], v236, s[16:19], s26 offen sc1
    s_add_u32 s26, s26, 524288
    buffer_load_dwordx4 v[228:231], v236, s[16:19], s26 offen sc1
    s_add_u32 s26, s26, 524288
    buffer_load_dwordx4 v[232:235], v236, s[16:19], s26 offen sc1
    s_lshl_b32 s25, s72, 5
    s_add_u32 s25, s25, 0
    s_sub_u32 s26, s25, 4
    s_max_i32 s26, s26, 0
    s_lshl_b32 s27, s71, 12
    s_add_u32 s27, s27, 9437184
    s_lshl_b32 s99, s25, 3
    s_lshl_b32 s100, s26, 3
    s_lshl_b32 s92, s24, 12
    s_lshl_b32 s93, s24, 9
    s_add_u32 s99, s99, s27
    s_add_u32 s100, s100, s27
    s_add_u32 m0, s92, 36352
    s_nop 0
    buffer_load_dwordx4 v73, s[16:19], s99 offen offset:0 sc1 lds
    buffer_load_dwordx4 v74, s[16:19], s99 offen offset:1024 sc1 lds
    buffer_load_dwordx4 v75, s[16:19], s99 offen offset:2048 sc1 lds
    buffer_load_dwordx4 v76, s[16:19], s99 offen offset:3072 sc1 lds
    s_add_u32 m0, s93, 53760
    s_add_u32 s99, s99, 524288
    s_mov_b64 exec, s[80:81]
    buffer_load_dwordx4 v77, s[16:19], s100 offen sc1 lds
    s_mov_b64 exec, -1
    s_add_u32 s100, s100, 524288
    s_add_u32 m0, s92, 55936
    s_nop 0
    s_nop 0
    buffer_load_dwordx4 v73, s[16:19], s99 offen offset:0 sc1 lds
    buffer_load_dwordx4 v74, s[16:19], s99 offen offset:1024 sc1 lds
    buffer_load_dwordx4 v75, s[16:19], s99 offen offset:2048 sc1 lds
    buffer_load_dwordx4 v76, s[16:19], s99 offen offset:3072 sc1 lds
    s_add_u32 m0, s93, 73344
    s_add_u32 s99, s99, 524288
    s_mov_b64 exec, s[80:81]
    buffer_load_dwordx4 v77, s[16:19], s100 offen sc1 lds
    s_mov_b64 exec, -1
    s_add_u32 s100, s100, 524288
    s_sub_u32 s85, s2, 160
    s_cmp_ge_u32 s85, 64
    s_cbranch_scc1 s2_47
    v_mov_b32 v238, 0x3f803f80
    s_lshl_b32 s25, s24, 7
    s_add_u32 s25, s25, 134272
    v_lshrrev_b32 v239, 4, v1
    v_lshl_add_u32 v237, v239, 2, v237
    v_add_u32 v237, s25, v237
se_48:
    v_mov_b32 v240, 0
    v_mov_b32 v241, 0
    v_mov_b32 v242, 0
    v_mov_b32 v243, 0
    s_waitcnt vmcnt(14)
    v_dot2c_f32_bf16 v240, v216, v238
    v_dot2c_f32_bf16 v241, v216, v216
    v_dot2c_f32_bf16 v240, v217, v238
    v_dot2c_f32_bf16 v241, v217, v217
    v_dot2c_f32_bf16 v242, v218, v238
    v_dot2c_f32_bf16 v243, v218, v218
    v_dot2c_f32_bf16 v242, v219, v238
    v_dot2c_f32_bf16 v243, v219, v219
    s_waitcnt vmcnt(13)
    v_dot2c_f32_bf16 v240, v220, v238
    v_dot2c_f32_bf16 v241, v220, v220
    v_dot2c_f32_bf16 v240, v221, v238
    v_dot2c_f32_bf16 v241, v221, v221
    v_dot2c_f32_bf16 v242, v222, v238
    v_dot2c_f32_bf16 v243, v222, v222
    v_dot2c_f32_bf16 v242, v223, v238
    v_dot2c_f32_bf16 v243, v223, v223
    s_waitcnt vmcnt(12)
    v_dot2c_f32_bf16 v240, v224, v238
    v_dot2c_f32_bf16 v241, v224, v224
    v_dot2c_f32_bf16 v240, v225, v238
    v_dot2c_f32_bf16 v241, v225, v225
    v_dot2c_f32_bf16 v242, v226, v238
    v_dot2c_f32_bf16 v243, v226, v226
    v_dot2c_f32_bf16 v242, v227, v238
    v_dot2c_f32_bf16 v243, v227, v227
    s_waitcnt vmcnt(11)
    v_dot2c_f32_bf16 v240, v228, v238
    v_dot2c_f32_bf16 v241, v228, v228
    v_dot2c_f32_bf16 v240, v229, v238
    v_dot2c_f32_bf16 v241, v229, v229
    v_dot2c_f32_bf16 v242, v230, v238
    v_dot2c_f32_bf16 v243, v230, v230
    v_dot2c_f32_bf16 v242, v231, v238
    v_dot2c_f32_bf16 v243, v231, v231
    s_waitcnt vmcnt(10)
    v_dot2c_f32_bf16 v240, v232, v238
    v_dot2c_f32_bf16 v241, v232, v232
    v_dot2c_f32_bf16 v240, v233, v238
    v_dot2c_f32_bf16 v241, v233, v233
    v_dot2c_f32_bf16 v242, v234, v238
    v_dot2c_f32_bf16 v243, v234, v234
    v_dot2c_f32_bf16 v242, v235, v238
    v_dot2c_f32_bf16 v243, v235, v235
    s_nop 2
    v_cmp_u_f32 vcc, v241, v243
    s_nop 0
    s_cbranch_vccnz rd_49
rc_50:
    v_permlane32_swap_b32 v240, v242
    v_permlane32_swap_b32 v241, v243
    v_pk_add_f32 v[240:241], v[240:241], v[242:243]
    s_nop 1
    v_permlane16_swap_b32 v240, v241
    v_add_f32 v240, v240, v241
    s_nop 1
    v_add_f32_dpp v240, v240, v240 row_ror:8 row_mask:0xf bank_mask:0xf
    ds_write_b32 v237, v240
    v_and_b32 v236, 15, v0
    v_lshlrev_b32 v236, 3, v236
    v_add_u32 v237, 134272, v236
    v_mov_b32 v239, 1073741824
    v_cmp_gt_u32 vcc, 16, v0
    s_nop 1
    v_cndmask_b32 v236, v239, v236, vcc
    s_add_u32 s25, s3, 3457024
    s_waitcnt lgkmcnt(0)
    s_barrier
    ds_read_b64 v[216:217], v237 offset:0
    ds_read_b64 v[218:219], v237 offset:128
    ds_read_b64 v[220:221], v237 offset:256
    ds_read_b64 v[222:223], v237 offset:384
    s_waitcnt lgkmcnt(2)
    v_pk_add_f32 v[216:217], v[216:217], v[218:219]
    s_waitcnt lgkmcnt(0)
    v_pk_add_f32 v[220:221], v[220:221], v[222:223]
    v_pk_add_f32 v[216:217], v[216:217], v[220:221]
    v_mul_f32 v239, 0x3acccccd, v216
    v_mul_f32 v217, 0x3acccccd, v217
    v_fma_f32 v217, -v239, v239, v217
    v_max_f32 v217, 0, v217
    v_add_f32 v217, 0x3727c5ac, v217
    v_rsq_f32_e64 v216, v217
    s_nop 0
    v_mul_f32 v217, -v239, v216
    buffer_store_dwordx2 v[216:217], v236, s[16:19], s25 offen sc1
s2_47:
ec_27:
ge_51:
    v_add_u32 v196, 36352, v78
    v_mov_b32_e64 v198, v79
    s_waitcnt vmcnt(5)
    s_barrier
    ds_read_b64 v[160:161], v198 offset:0
    ds_read_b64 v[162:163], v198 offset:64
    ds_read_b64 v[164:165], v196 offset:0
    ds_read_b64 v[166:167], v196 offset:512
    ds_read_b64 v[168:169], v196 offset:256
    ds_read_b64 v[170:171], v196 offset:768
    ds_read_b64 v[172:173], v198 offset:256
    ds_read_b64 v[174:175], v198 offset:320
    ds_read_b64 v[176:177], v196 offset:2048
    ds_read_b64 v[178:179], v196 offset:2560
    ds_read_b64 v[180:181], v196 offset:2304
    ds_read_b64 v[182:183], v196 offset:2816
    s_waitcnt lgkmcnt(6)
    v_mfma_f32_16x16x32_bf16 v[112:115], a[0:3], v[160:163], 0
    ds_read_b64 v[184:185], v198 offset:512
    v_mfma_f32_32x32x16_bf16 v[80:95], a[0:3], v[164:167], 0
    ds_read_b64 v[186:187], v198 offset:576
    ds_read_b64 v[188:189], v196 offset:4096
    ds_read_b64 v[190:191], v196 offset:4608
    v_mov_b32 v208, 0
    v_mov_b32_e64 v209, 0
    v_mfma_f32_32x32x16_bf16 v[96:111], a[0:3], v[168:171], 0
    ds_read_b64 v[192:193], v196 offset:4352
    ds_read_b64 v[194:195], v196 offset:4864
    s_add_u32 m0, s92, 75520
    s_nop 0
    buffer_load_dwordx4 v73, s[16:19], s99 offen offset:0 sc1 lds
    s_waitcnt lgkmcnt(6)
    v_mfma_f32_16x16x32_bf16 v[112:115], a[4:7], v[172:175], v[112:115]
    ds_read_b64 v[160:161], v198 offset:768
    v_mfma_f32_32x32x16_bf16 v[80:95], a[4:7], v[176:179], v[80:95]
    ds_read_b64 v[162:163], v198 offset:832
    ds_read_b64 v[164:165], v196 offset:6144
    ds_read_b64 v[166:167], v196 offset:6656
    v_lshrrev_b32_e64 v210, 5, v0
    v_mul_u32_u24 v210, 1600, v210
    v_mfma_f32_32x32x16_bf16 v[96:111], a[4:7], v[180:183], v[96:111]
    ds_read_b64 v[168:169], v196 offset:6400
    ds_read_b64 v[170:171], v196 offset:6912
    buffer_load_dwordx4 v74, s[16:19], s99 offen offset:1024 sc1 lds
    v_and_b32 v211, 31, v0
    s_waitcnt lgkmcnt(6)
    v_mfma_f32_16x16x32_bf16 v[112:115], a[8:11], v[184:187], v[112:115]
    ds_read_b64 v[172:173], v198 offset:1024
    v_mfma_f32_32x32x16_bf16 v[80:95], a[8:11], v[188:191], v[80:95]
    ds_read_b64 v[174:175], v198 offset:1088
    ds_read_b64 v[176:177], v196 offset:8192
    ds_read_b64 v[178:179], v196 offset:8704
    v_min_u32_e64 v211, 19, v211
    v_lshl_add_u32 v210, v211, 3, v210
    v_mfma_f32_32x32x16_bf16 v[96:111], a[8:11], v[192:195], v[96:111]
    ds_read_b64 v[180:181], v196 offset:8448
    ds_read_b64 v[182:183], v196 offset:8960
    buffer_load_dwordx4 v75, s[16:19], s99 offen offset:2048 sc1 lds
    v_add_u32 v210, 6400, v210
    s_waitcnt lgkmcnt(6)
    v_mfma_f32_16x16x32_bf16 v[112:115], a[12:15], v[160:163], v[112:115]
    ds_read_b64 v[184:185], v198 offset:1280
    v_mfma_f32_32x32x16_bf16 v[80:95], a[12:15], v[164:167], v[80:95]
    ds_read_b64 v[186:187], v198 offset:1344
    ds_read_b64 v[188:189], v196 offset:10240
    ds_read_b64 v[190:191], v196 offset:10752
    ds_write_b64 v210, v[208:209]
    v_mfma_f32_32x32x16_bf16 v[96:111], a[12:15], v[168:171], v[96:111]
    ds_read_b64 v[192:193], v196 offset:10496
    ds_read_b64 v[194:195], v196 offset:11008
    buffer_load_dwordx4 v76, s[16:19], s99 offen offset:3072 sc1 lds
    s_waitcnt lgkmcnt(7)
    v_mfma_f32_16x16x32_bf16 v[112:115], a[16:19], v[172:175], v[112:115]
    ds_read_b64 v[160:161], v198 offset:1536
    v_mfma_f32_32x32x16_bf16 v[80:95], a[16:19], v[176:179], v[80:95]
    ds_read_b64 v[162:163], v198 offset:1600
    ds_read_b64 v[164:165], v196 offset:12288
    ds_read_b64 v[166:167], v196 offset:12800
    v_mfma_f32_32x32x16_bf16 v[96:111], a[16:19], v[180:183], v[96:111]
    ds_read_b64 v[168:169], v196 offset:12544
    ds_read_b64 v[170:171], v196 offset:13056
    s_add_u32 m0, s93, 92928
    s_add_u32 s99, s99, 524288
    s_mov_b64 exec, s[80:81]
    buffer_load_dwordx4 v77, s[16:19], s100 offen sc1 lds
    s_mov_b64 exec, -1
    s_add_u32 s100, s100, 524288
    s_waitcnt lgkmcnt(6)
    v_mfma_f32_16x16x32_bf16 v[112:115], a[20:23], v[184:187], v[112:115]
    ds_read_b64 v[172:173], v198 offset:1792
    v_mfma_f32_32x32x16_bf16 v[80:95], a[20:23], v[188:191], v[80:95]
    ds_read_b64 v[174:175], v198 offset:1856
    ds_read_b64 v[176:177], v196 offset:14336
    ds_read_b64 v[178:179], v196 offset:14848
    v_mfma_f32_32x32x16_bf16 v[96:111], a[20:23], v[192:195], v[96:111]
    ds_read_b64 v[180:181], v196 offset:14592
    ds_read_b64 v[182:183], v196 offset:15104
    buffer_load_dword v7, v4, s[16:19], s87 offen offset:12 sc1
    v_cmp_eq_u32 vcc, 19, v5
    s_nop 0
    s_cbranch_vccnz gl_52
gc_53:
    s_waitcnt vmcnt(6)
    s_barrier
    s_waitcnt lgkmcnt(6)
    v_mfma_f32_16x16x32_bf16 v[112:115], a[24:27], v[160:163], v[112:115]
    v_add_u32 v198, v49, v198
    v_mfma_f32_32x32x16_bf16 v[80:95], a[24:27], v[164:167], v[80:95]
    v_add_u32 v196, 19584, v196
    ds_read_b64 v[184:185], v198 offset:0
    ds_read_b64 v[186:187], v198 offset:64
    ds_read_b64 v[188:189], v196 offset:0
    v_mfma_f32_32x32x16_bf16 v[96:111], a[24:27], v[168:171], v[96:111]
    ds_read_b64 v[190:191], v196 offset:512
    ds_read_b64 v[192:193], v196 offset:256
    ds_read_b64 v[194:195], v196 offset:768
    s_add_u32 m0, s92, 95104
    s_nop 0
    buffer_load_dwordx4 v73, s[16:19], s99 offen offset:0 sc1 lds
    s_waitcnt lgkmcnt(6)
    v_mfma_f32_16x16x32_bf16 v[112:115], a[28:31], v[172:175], v[112:115]
    ds_read_b64 v[160:161], v198 offset:256
    v_mfma_f32_32x32x16_bf16 v[80:95], a[28:31], v[176:179], v[80:95]
    ds_read_b64 v[162:163], v198 offset:320
    ds_read_b64 v[164:165], v196 offset:2048
    ds_read_b64 v[166:167], v196 offset:2560
    v_mfma_f32_32x32x16_bf16 v[96:111], a[28:31], v[180:183], v[96:111]
    ds_read_b64 v[168:169], v196 offset:2304
    ds_read_b64 v[170:171], v196 offset:2816
    buffer_load_dwordx4 v74, s[16:19], s99 offen offset:1024 sc1 lds
    s_waitcnt lgkmcnt(6)
    v_mfma_f32_16x16x32_bf16 v[112:115], a[32:35], v[184:187], v[112:115]
    ds_read_b64 v[172:173], v198 offset:512
    v_mfma_f32_32x32x16_bf16 v[80:95], a[32:35], v[188:191], v[80:95]
    ds_read_b64 v[174:175], v198 offset:576
    ds_read_b64 v[176:177], v196 offset:4096
    ds_read_b64 v[178:179], v196 offset:4608
    v_mfma_f32_32x32x16_bf16 v[96:111], a[32:35], v[192:195], v[96:111]
    ds_read_b64 v[180:181], v196 offset:4352
    ds_read_b64 v[182:183], v196 offset:4864
    buffer_load_dwordx4 v75, s[16:19], s99 offen offset:2048 sc1 lds
    s_waitcnt lgkmcnt(6)
    v_mfma_f32_16x16x32_bf16 v[112:115], a[36:39], v[160:163], v[112:115]
    ds_read_b64 v[184:185], v198 offset:768
    v_mfma_f32_32x32x16_bf16 v[80:95], a[36:39], v[164:167], v[80:95]
    ds_read_b64 v[186:187], v198 offset:832
    ds_read_b64 v[188:189], v196 offset:6144
    ds_read_b64 v[190:191], v196 offset:6656
    v_mfma_f32_32x32x16_bf16 v[96:111], a[36:39], v[168:171], v[96:111]
    ds_read_b64 v[192:193], v196 offset:6400
    ds_read_b64 v[194:195], v196 offset:6912
    buffer_load_dwordx4 v76, s[16:19], s99 offen offset:3072 sc1 lds
    s_waitcnt lgkmcnt(6)
    v_mfma_f32_16x16x32_bf16 v[112:115], a[40:43], v[172:175], v[112:115]
    ds_read_b64 v[160:161], v198 offset:1024
    v_mfma_f32_32x32x16_bf16 v[80:95], a[40:43], v[176:179], v[80:95]
    ds_read_b64 v[162:163], v198 offset:1088
    ds_read_b64 v[164:165], v196 offset:8192
    ds_read_b64 v[166:167], v196 offset:8704
    v_mfma_f32_32x32x16_bf16 v[96:111], a[40:43], v[180:183], v[96:111]
    ds_read_b64 v[168:169], v196 offset:8448
    ds_read_b64 v[170:171], v196 offset:8960
    s_add_u32 m0, s93, 112512
    s_add_u32 s99, s99, 524288
    s_mov_b64 exec, s[80:81]
    buffer_load_dwordx4 v77, s[16:19], s100 offen sc1 lds
    s_mov_b64 exec, -1
    s_add_u32 s100, s100, 524288
    s_waitcnt lgkmcnt(6)
    v_mfma_f32_16x16x32_bf16 v[112:115], a[44:47], v[184:187], v[112:115]
    ds_read_b64 v[172:173], v198 offset:1280
    v_mfma_f32_32x32x16_bf16 v[80:95], a[44:47], v[188:191], v[80:95]
    ds_read_b64 v[174:175], v198 offset:1344
    ds_read_b64 v[176:177], v196 offset:10240
    ds_read_b64 v[178:179], v196 offset:10752
    v_mfma_f32_32x32x16_bf16 v[96:111], a[44:47], v[192:195], v[96:111]
    ds_read_b64 v[180:181], v196 offset:10496
    ds_read_b64 v[182:183], v196 offset:11008
    s_add_u32 m0, s92, 114688
    s_nop 0
    buffer_load_dwordx4 v73, s[16:19], s99 offen offset:0 sc1 lds
    s_waitcnt lgkmcnt(6)
    v_mfma_f32_16x16x32_bf16 v[112:115], a[48:51], v[160:163], v[112:115]
    ds_read_b64 v[184:185], v198 offset:1536
    v_mfma_f32_32x32x16_bf16 v[80:95], a[48:51], v[164:167], v[80:95]
    ds_read_b64 v[186:187], v198 offset:1600
    ds_read_b64 v[188:189], v196 offset:12288
    ds_read_b64 v[190:191], v196 offset:12800
    v_mfma_f32_32x32x16_bf16 v[96:111], a[48:51], v[168:171], v[96:111]
    ds_read_b64 v[192:193], v196 offset:12544
    ds_read_b64 v[194:195], v196 offset:13056
    buffer_load_dwordx4 v74, s[16:19], s99 offen offset:1024 sc1 lds
    s_waitcnt lgkmcnt(6)
    v_mfma_f32_16x16x32_bf16 v[112:115], a[52:55], v[172:175], v[112:115]
    ds_read_b64 v[160:161], v198 offset:1792
    v_mfma_f32_32x32x16_bf16 v[80:95], a[52:55], v[176:179], v[80:95]
    ds_read_b64 v[162:163], v198 offset:1856
    ds_read_b64 v[164:165], v196 offset:14336
    ds_read_b64 v[166:167], v196 offset:14848
    v_mfma_f32_32x32x16_bf16 v[96:111], a[52:55], v[180:183], v[96:111]
    ds_read_b64 v[168:169], v196 offset:14592
    ds_read_b64 v[170:171], v196 offset:15104
    buffer_load_dwordx4 v75, s[16:19], s99 offen offset:2048 sc1 lds
    s_waitcnt vmcnt(8)
    v_cmp_gt_u32 vcc, 1, v7
    s_nop 0
    s_and_b64 vcc, vcc, s[50:51]
    s_cbranch_scc1 ps_54
pc_56:
    s_barrier
    s_waitcnt lgkmcnt(6)
    v_mfma_f32_16x16x32_bf16 v[112:115], a[56:59], v[184:187], v[112:115]
    v_add_u32_e64 v198, v49, v198
    v_mfma_f32_32x32x16_bf16 v[80:95], a[56:59], v[188:191], v[80:95]
    v_add_u32 v196, 19584, v196
    ds_read_b64 v[172:173], v198 offset:0
    ds_read_b64 v[174:175], v198 offset:64
    ds_read_b64 v[176:177], v196 offset:0
    v_mfma_f32_32x32x16_bf16 v[96:111], a[56:59], v[192:195], v[96:111]
    ds_read_b64 v[178:179], v196 offset:512
    ds_read_b64 v[180:181], v196 offset:256
    ds_read_b64 v[182:183], v196 offset:768
    buffer_load_dwordx4 v76, s[16:19], s99 offen offset:3072 sc1 lds
    s_waitcnt lgkmcnt(6)
    v_mfma_f32_16x16x32_bf16 v[112:115], a[60:63], v[160:163], v[112:115]
    ds_read_b64 v[184:185], v198 offset:256
    v_mfma_f32_32x32x16_bf16 v[80:95], a[60:63], v[164:167], v[80:95]
    ds_read_b64 v[186:187], v198 offset:320
    ds_read_b64 v[188:189], v196 offset:2048
    ds_read_b64 v[190:191], v196 offset:2560
    v_mfma_f32_32x32x16_bf16 v[96:111], a[60:63], v[168:171], v[96:111]
    ds_read_b64 v[192:193], v196 offset:2304
    ds_read_b64 v[194:195], v196 offset:2816
    s_add_u32 m0, s93, 132096
    s_add_u32 s99, s99, 524288
    s_mov_b64 exec, s[80:81]
    buffer_load_dwordx4 v77, s[16:19], s100 offen sc1 lds
    s_mov_b64 exec, -1
    s_add_u32 s100, s100, 524288
    s_waitcnt lgkmcnt(6)
    v_mfma_f32_16x16x32_bf16 v[112:115], a[64:67], v[172:175], v[112:115]
    ds_read_b64 v[160:161], v198 offset:512
    v_mfma_f32_32x32x16_bf16 v[80:95], a[64:67], v[176:179], v[80:95]
    ds_read_b64 v[162:163], v198 offset:576
    ds_read_b64 v[164:165], v196 offset:4096
    ds_read_b64 v[166:167], v196 offset:4608
    v_mfma_f32_32x32x16_bf16 v[96:111], a[64:67], v[180:183], v[96:111]
    ds_read_b64 v[168:169], v196 offset:4352
    ds_read_b64 v[170:171], v196 offset:4864
    s_lshl_b32 s25, s72, 5
    s_add_u32 s25, s25, 256
    s_sub_u32 s26, s25, 4
    s_max_i32 s26, s26, 0
    s_lshl_b32 s27, s71, 12
    s_add_u32 s27, s27, 9437184
    s_lshl_b32 s99, s25, 3
    s_lshl_b32 s100, s26, 3
    s_lshl_b32 s92, s24, 12
    s_lshl_b32 s93, s24, 9
    s_add_u32 s99, s99, s27
    s_add_u32 s100, s100, s27
    s_waitcnt lgkmcnt(6)
    v_mfma_f32_16x16x32_bf16 v[112:115], a[68:71], v[184:187], v[112:115]
    ds_read_b64 v[172:173], v198 offset:768
    v_mfma_f32_32x32x16_bf16 v[80:95], a[68:71], v[188:191], v[80:95]
    ds_read_b64 v[174:175], v198 offset:832
    ds_read_b64 v[176:177], v196 offset:6144
    ds_read_b64 v[178:179], v196 offset:6656
    v_mfma_f32_32x32x16_bf16 v[96:111], a[68:71], v[192:195], v[96:111]
    ds_read_b64 v[180:181], v196 offset:6400
    ds_read_b64 v[182:183], v196 offset:6912
    s_waitcnt lgkmcnt(6)
    v_mfma_f32_16x16x32_bf16 v[112:115], a[72:75], v[160:163], v[112:115]
    ds_read_b64 v[184:185], v198 offset:1024
    v_mfma_f32_32x32x16_bf16 v[80:95], a[72:75], v[164:167], v[80:95]
    ds_read_b64 v[186:187], v198 offset:1088
    ds_read_b64 v[188:189], v196 offset:8192
    ds_read_b64 v[190:191], v196 offset:8704
    v_mfma_f32_32x32x16_bf16 v[96:111], a[72:75], v[168:171], v[96:111]
    ds_read_b64 v[192:193], v196 offset:8448
    ds_read_b64 v[194:195], v196 offset:8960
    s_waitcnt lgkmcnt(6)
    v_mfma_f32_16x16x32_bf16 v[112:115], a[76:79], v[172:175], v[112:115]
    ds_read_b64 v[160:161], v198 offset:1280
    v_mfma_f32_32x32x16_bf16 v[80:95], a[76:79], v[176:179], v[80:95]
    ds_read_b64 v[162:163], v198 offset:1344
    ds_read_b64 v[164:165], v196 offset:10240
    ds_read_b64 v[166:167], v196 offset:10752
    v_mfma_f32_32x32x16_bf16 v[96:111], a[76:79], v[180:183], v[96:111]
    ds_read_b64 v[168:169], v196 offset:10496
    ds_read_b64 v[170:171], v196 offset:11008
    s_waitcnt lgkmcnt(6)
    v_mfma_f32_16x16x32_bf16 v[112:115], a[80:83], v[184:187], v[112:115]
    ds_read_b64 v[172:173], v198 offset:1536
    v_mfma_f32_32x32x16_bf16 v[80:95], a[80:83], v[188:191], v[80:95]
    ds_read_b64 v[174:175], v198 offset:1600
    ds_read_b64 v[176:177], v196 offset:12288
    ds_read_b64 v[178:179], v196 offset:12800
    v_mfma_f32_32x32x16_bf16 v[96:111], a[80:83], v[192:195], v[96:111]
    ds_read_b64 v[180:181], v196 offset:12544
    ds_read_b64 v[182:183], v196 offset:13056
    s_lshl_b32 s98, s72, 5
    s_add_u32 s98, s98, 0
    s_sub_u32 s95, s98, 4
    s_max_i32 s95, s95, 0
    s_lshl_b32 s94, s98, 3
    s_lshl_b32 s95, s95, 3
    s_add_u32 s94, s94, 3457024
    s_add_u32 s95, s95, 3457024
    s_add_u32 s96, s94, 8192
    buffer_load_dwordx2 v[152:153], v47, s[16:19], s94 offen sc1
    s_waitcnt lgkmcnt(6)
    v_mfma_f32_16x16x32_bf16 v[112:115], a[84:87], v[160:163], v[112:115]
    ds_read_b64 v[184:185], v198 offset:1792
    v_mfma_f32_32x32x16_bf16 v[80:95], a[84:87], v[164:167], v[80:95]
    ds_read_b64 v[186:187], v198 offset:1856
    ds_read_b64 v[188:189], v196 offset:14336
    ds_read_b64 v[190:191], v196 offset:14848
    v_mfma_f32_32x32x16_bf16 v[96:111], a[84:87], v[168:171], v[96:111]
    ds_read_b64 v[192:193], v196 offset:14592
    ds_read_b64 v[194:195], v196 offset:15104
    buffer_load_dwordx2 v[154:155], v47, s[16:19], s96 offen sc1
    s_waitcnt vmcnt(7)
    s_barrier
    s_waitcnt lgkmcnt(6)
    v_mfma_f32_16x16x32_bf16 v[112:115], a[88:91], v[172:175], v[112:115]
    v_add_u32_e64 v198, v49, v198
    v_mfma_f32_32x32x16_bf16 v[80:95], a[88:91], v[176:179], v[80:95]
    v_add_u32 v196, 19584, v196
    ds_read_b64 v[160:161], v198 offset:0
    ds_read_b64 v[162:163], v198 offset:64
    ds_read_b64 v[164:165], v196 offset:0
    v_mfma_f32_32x32x16_bf16 v[96:111], a[88:91], v[180:183], v[96:111]
    ds_read_b64 v[166:167], v196 offset:512
    ds_read_b64 v[168:169], v196 offset:256
    ds_read_b64 v[170:171], v196 offset:768
    buffer_load_dwordx2 v[156:157], v48, s[16:19], s95 offen sc1
    s_waitcnt lgkmcnt(6)
    v_mfma_f32_16x16x32_bf16 v[112:115], a[92:95], v[184:187], v[112:115]
    ds_read_b64 v[172:173], v198 offset:256
    v_mfma_f32_32x32x16_bf16 v[80:95], a[92:95], v[188:191], v[80:95]
    ds_read_b64 v[174:175], v198 offset:320
    ds_read_b64 v[176:177], v196 offset:2048
    ds_read_b64 v[178:179], v196 offset:2560
    v_mfma_f32_32x32x16_bf16 v[96:111], a[92:95], v[192:195], v[96:111]
    ds_read_b64 v[180:181], v196 offset:2304
    ds_read_b64 v[182:183], v196 offset:2816
    buffer_load_dword v7, v4, s[16:19], s89 offen offset:4 sc1
    s_waitcnt lgkmcnt(6)
    v_mfma_f32_16x16x32_bf16 v[112:115], a[96:99], v[160:163], v[112:115]
    ds_read_b64 v[184:185], v198 offset:512
    v_mfma_f32_32x32x16_bf16 v[80:95], a[96:99], v[164:167], v[80:95]
    ds_read_b64 v[186:187], v198 offset:576
    ds_read_b64 v[188:189], v196 offset:4096
    ds_read_b64 v[190:191], v196 offset:4608
    v_mfma_f32_32x32x16_bf16 v[96:111], a[96:99], v[168:171], v[96:111]
    ds_read_b64 v[192:193], v196 offset:4352
    ds_read_b64 v[194:195], v196 offset:4864
    s_waitcnt lgkmcnt(6)
    v_mfma_f32_16x16x32_bf16 v[112:115], a[100:103], v[172:175], v[112:115]
    ds_read_b64 v[160:161], v198 offset:768
    v_mfma_f32_32x32x16_bf16 v[80:95], a[100:103], v[176:179], v[80:95]
    ds_read_b64 v[162:163], v198 offset:832
    ds_read_b64 v[164:165], v196 offset:6144
    ds_read_b64 v[166:167], v196 offset:6656
    v_mfma_f32_32x32x16_bf16 v[96:111], a[100:103], v[180:183], v[96:111]
    ds_read_b64 v[168:169], v196 offset:6400
    ds_read_b64 v[170:171], v196 offset:6912
    s_waitcnt lgkmcnt(6)
    v_mfma_f32_16x16x32_bf16 v[112:115], a[104:107], v[184:187], v[112:115]
    ds_read_b64 v[172:173], v198 offset:1024
    v_mfma_f32_32x32x16_bf16 v[80:95], a[104:107], v[188:191], v[80:95]
    ds_read_b64 v[174:175], v198 offset:1088
    ds_read_b64 v[176:177], v196 offset:8192
    ds_read_b64 v[178:179], v196 offset:8704
    v_mfma_f32_32x32x16_bf16 v[96:111], a[104:107], v[192:195], v[96:111]
    ds_read_b64 v[180:181], v196 offset:8448
    ds_read_b64 v[182:183], v196 offset:8960
    s_waitcnt lgkmcnt(6)
    v_mfma_f32_16x16x32_bf16 v[112:115], a[108:111], v[160:163], v[112:115]
    ds_read_b64 v[184:185], v198 offset:1280
    v_mfma_f32_32x32x16_bf16 v[80:95], a[108:111], v[164:167], v[80:95]
    ds_read_b64 v[186:187], v198 offset:1344
    ds_read_b64 v[188:189], v196 offset:10240
    ds_read_b64 v[190:191], v196 offset:10752
    v_mfma_f32_32x32x16_bf16 v[96:111], a[108:111], v[168:171], v[96:111]
    ds_read_b64 v[192:193], v196 offset:10496
    ds_read_b64 v[194:195], v196 offset:11008
    s_waitcnt lgkmcnt(6)
    v_mfma_f32_16x16x32_bf16 v[112:115], a[112:115], v[172:175], v[112:115]
    ds_read_b64 v[160:161], v198 offset:1536
    v_mfma_f32_32x32x16_bf16 v[80:95], a[112:115], v[176:179], v[80:95]
    ds_read_b64 v[162:163], v198 offset:1600
    ds_read_b64 v[164:165], v196 offset:12288
    ds_read_b64 v[166:167], v196 offset:12800
    v_mfma_f32_32x32x16_bf16 v[96:111], a[112:115], v[180:183], v[96:111]
    ds_read_b64 v[168:169], v196 offset:12544
    ds_read_b64 v[170:171], v196 offset:13056
    s_waitcnt lgkmcnt(6)
    v_mfma_f32_16x16x32_bf16 v[112:115], a[116:119], v[184:187], v[112:115]
    ds_read_b64 v[172:173], v198 offset:1792
    v_mfma_f32_32x32x16_bf16 v[80:95], a[116:119], v[188:191], v[80:95]
    ds_read_b64 v[174:175], v198 offset:1856
    ds_read_b64 v[176:177], v196 offset:14336
    ds_read_b64 v[178:179], v196 offset:14848
    v_mfma_f32_32x32x16_bf16 v[96:111], a[116:119], v[192:195], v[96:111]
    ds_read_b64 v[180:181], v196 offset:14592
    ds_read_b64 v[182:183], v196 offset:15104
sl_57:
    s_waitcnt vmcnt(2)
    v_max3_u32 v2, v152, v153, v154
    s_waitcnt vmcnt(1)
    v_max3_u32 v2, v2, v155, v156
    v_max_u32 v2, v2, v157
    v_cmp_eq_u32 vcc, -1, v2
    s_nop 0
    s_cbranch_vccnz rd_58
rc_59:
    s_waitcnt vmcnt(0)
    v_cmp_gt_u32 vcc, 1, v7
    s_nop 0
    s_and_b64 vcc, vcc, s[50:51]
    s_cbranch_scc1 ps_60
pc_62:
    s_barrier
    s_waitcnt lgkmcnt(6)
    v_mfma_f32_16x16x32_bf16 v[112:115], a[120:123], v[160:163], v[112:115]
    v_add_u32_e64 v198, v49, v198
    v_mfma_f32_32x32x16_bf16 v[80:95], a[120:123], v[164:167], v[80:95]
    v_add_u32 v196, 19584, v196
    ds_read_b64 v[184:185], v198 offset:0
    ds_read_b64 v[186:187], v198 offset:64
    v_mul_f32 v148, v24, v157
    v_mul_f32 v149, v25, v157
    v_mfma_f32_32x32x16_bf16 v[96:111], a[120:123], v[168:171], v[96:111]
    ds_read_b64 v[188:189], v196 offset:0
    ds_read_b64 v[190:191], v196 offset:512
    s_sub_u32 s3, s2, 160
    s_and_b32 s3, s3, 63
    s_add_u32 s3, s3, 64
    s_and_b32 s25, s3, 3
    s_lshl_b32 s25, s25, 12
    s_lshr_b32 s26, s3, 2
    s_lshl_b32 s26, s26, 7
    s_add_u32 s3, s25, s26
    v_lshrrev_b32 v236, 3, v0
    v_and_b32 v237, 7, v0
    v_lshlrev_b32 v237, 4, v237
    v_lshl_add_u32 v236, v236, 14, v237
    s_sub_u32 s25, s2, 160
    s_cmp_lt_u32 s25, 64
    s_cselect_b32 s25, 0, 1073741824
    v_add_u32_e64 v236, s25, v236
    s_add_u32 s26, s3, 9437184
    buffer_load_dwordx4 v[216:219], v236, s[16:19], s26 offen sc1
    v_mul_f32 v150, v26, v157
    v_mul_f32_e64 v151, v27, v157
    s_waitcnt lgkmcnt(4)
    v_mfma_f32_16x16x32_bf16 v[112:115], a[124:127], v[172:175], v[112:115]
    ds_read_b64 v[192:193], v198 offset:256
    v_mfma_f32_32x32x16_bf16 v[80:95], a[124:127], v[176:179], v[80:95]
    ds_read_b64 v[194:195], v198 offset:320
    ds_read_b64 v[160:161], v196 offset:2048
    v_mul_f32 v116, v8, v153
    v_mul_f32 v117, v9, v153
    v_mul_f32_e64 v118, v10, v153
    v_mfma_f32_32x32x16_bf16 v[96:111], a[124:127], v[180:183], v[96:111]
    ds_read_b64 v[162:163], v196 offset:2560
    s_add_u32 s26, s26, 524288
    buffer_load_dwordx4 v[220:223], v236, s[16:19], s26 offen sc1
    v_mul_f32 v119, v11, v153
    v_mul_f32_e64 v120, v12, v153
    s_waitcnt lgkmcnt(4)
    v_mfma_f32_16x16x32_bf16 v[112:115], a[128:131], v[184:187], v[112:115]
    ds_read_b64 v[164:165], v198 offset:512
    v_mfma_f32_32x32x16_bf16 v[80:95], a[128:131], v[188:191], v[80:95]
    ds_read_b64 v[166:167], v198 offset:576
    ds_read_b64 v[168:169], v196 offset:4096
    ds_read_b64 v[170:171], v196 offset:4608
    v_mul_f32 v121, v13, v153
    v_mul_f32_e64 v122, v14, v153
    s_waitcnt lgkmcnt(4)
    v_mfma_f32_16x16x32_bf16 v[112:115], a[132:135], v[192:195], v[112:115]
    ds_read_b64 v[172:173], v198 offset:768
    v_mfma_f32_32x32x16_bf16 v[80:95], a[132:135], v[160:163], v[80:95]
    ds_read_b64 v[174:175], v198 offset:832
    ds_read_b64 v[176:177], v196 offset:6144
    ds_read_b64 v[178:179], v196 offset:6656
    s_add_u32 s26, s26, 524288
    buffer_load_dwordx4 v[224:227], v236, s[16:19], s26 offen sc1
    v_mul_f32 v123, v15, v153
    v_mul_f32_e64 v124, v16, v153
    s_waitcnt lgkmcnt(4)
    v_mfma_f32_16x16x32_bf16 v[112:115], a[136:139], v[164:167], v[112:115]
    ds_read_b64 v[180:181], v198 offset:1024
    v_mfma_f32_32x32x16_bf16 v[80:95], a[136:139], v[168:171], v[80:95]
    ds_read_b64 v[182:183], v198 offset:1088
    ds_read_b64 v[184:185], v196 offset:8192
    ds_read_b64 v[186:187], v196 offset:8704
    v_mul_f32 v125, v17, v153
    v_mul_f32_e64 v126, v18, v153
    s_waitcnt lgkmcnt(4)
    v_mfma_f32_16x16x32_bf16 v[112:115], a[140:143], v[172:175], v[112:115]
    ds_read_b64 v[188:189], v198 offset:1280
    v_mfma_f32_32x32x16_bf16 v[80:95], a[140:143], v[176:179], v[80:95]
    ds_read_b64 v[190:191], v198 offset:1344
    ds_read_b64 v[192:193], v196 offset:10240
    ds_read_b64 v[194:195], v196 offset:10752
    s_add_u32 s26, s26, 524288
    buffer_load_dwordx4 v[228:231], v236, s[16:19], s26 offen sc1
    v_mul_f32 v127, v19, v153
    v_mul_f32_e64 v128, v20, v153
    s_waitcnt lgkmcnt(4)
    v_mfma_f32_16x16x32_bf16 v[112:115], a[144:147], v[180:183], v[112:115]
    ds_read_b64 v[160:161], v198 offset:1536
    v_mfma_f32_32x32x16_bf16 v[80:95], a[144:147], v[184:187], v[80:95]
    ds_read_b64 v[162:163], v198 offset:1600
    ds_read_b64 v[164:165], v196 offset:12288
    ds_read_b64 v[166:167], v196 offset:12800
    v_mul_f32 v129, v21, v153
    v_mul_f32_e64 v130, v22, v153
    s_waitcnt lgkmcnt(4)
    v_mfma_f32_16x16x32_bf16 v[112:115], a[148:151], v[188:191], v[112:115]
    ds_read_b64 v[168:169], v198 offset:1792
    v_mfma_f32_32x32x16_bf16 v[80:95], a[148:151], v[192:195], v[80:95]
    ds_read_b64 v[170:171], v198 offset:1856
    ds_read_b64 v[172:173], v196 offset:14336
    ds_read_b64 v[174:175], v196 offset:14848
    s_add_u32 s26, s26, 524288
    buffer_load_dwordx4 v[232:235], v236, s[16:19], s26 offen sc1
    v_mul_f32 v131, v23, v153
    v_mul_f32_e64 v132, v8, v155
    s_waitcnt lgkmcnt(4)
    v_mfma_f32_16x16x32_bf16 v[112:115], a[152:155], v[160:163], v[112:115]
    ds_read_b64 v[176:177], v196 offset:256
    v_mfma_f32_32x32x16_bf16 v[80:95], a[152:155], v[164:167], v[80:95]
    ds_read_b64 v[178:179], v196 offset:768
    ds_read_b64 v[180:181], v196 offset:2304
    ds_read_b64 v[182:183], v196 offset:2816
    v_mul_f32 v133, v9, v155
    v_mul_f32_e64 v134, v10, v155
    s_waitcnt lgkmcnt(4)
    v_mfma_f32_16x16x32_bf16 v[112:115], a[156:159], v[168:171], v[112:115]
    ds_read_b64 v[184:185], v196 offset:4352
    v_mfma_f32_32x32x16_bf16 v[80:95], a[156:159], v[172:175], v[80:95]
    ds_read_b64 v[186:187], v196 offset:4864
    ds_read_b64 v[188:189], v196 offset:6400
    ds_read_b64 v[190:191], v196 offset:6912
    s_add_u32 m0, s92, 36352
    s_nop 0
    buffer_load_dwordx4 v73, s[16:19], s99 offen offset:0 sc1 lds
    v_mul_f32 v135, v11, v155
    v_mul_f32 v136, v12, v155
    v_mul_f32 v137, v13, v155
    v_mul_f32 v138, v14, v155
    v_mul_f32 v139, v15, v155
    v_mul_f32 v140, v16, v155
    v_mul_f32 v141, v17, v155
    v_mul_f32 v142, v18, v155
    v_mul_f32 v143, v19, v155
    v_mul_f32 v144, v20, v155
    v_mul_f32 v145, v21, v155
    v_mul_f32 v146, v22, v155
    v_mul_f32_e64 v147, v23, v155
    s_waitcnt lgkmcnt(4)
    v_mfma_f32_32x32x16_bf16 v[96:111], a[128:131], v[176:179], v[96:111]
    ds_read_b64 v[192:193], v196 offset:8448
    ds_read_b64 v[194:195], v196 offset:8960
    v_mfma_f32_32x32x16_bf16 v[96:111], a[132:135], v[180:183], v[96:111]
    ds_read_b64 v[160:161], v196 offset:10496
    ds_read_b64 v[162:163], v196 offset:11008
    buffer_load_dwordx4 v74, s[16:19], s99 offen offset:1024 sc1 lds
    v_fma_f32 v112, v112, v156, v148
    v_fma_f32 v113, v113, v156, v149
    s_waitcnt lgkmcnt(4)
    v_mfma_f32_32x32x16_bf16 v[96:111], a[136:139], v[184:187], v[96:111]
    ds_read_b64 v[164:165], v196 offset:12544
    ds_read_b64 v[166:167], v196 offset:13056
    v_fma_f32 v114, v114, v156, v150
    v_fma_f32 v115, v115, v156, v151
    v_cvt_pk_bf16_f32 v112, v112, v113
    v_mfma_f32_32x32x16_bf16 v[96:111], a[140:143], v[188:191], v[96:111]
    ds_read_b64 v[168:169], v196 offset:14592
    ds_read_b64 v[170:171], v196 offset:15104
    buffer_load_dwordx4 v75, s[16:19], s99 offen offset:2048 sc1 lds
    v_cvt_pk_bf16_f32 v113, v114, v115
    v_fma_f32 v80, v80, v152, v116
    s_waitcnt lgkmcnt(4)
    v_mfma_f32_32x32x16_bf16 v[96:111], a[144:147], v[192:195], v[96:111]
    v_fma_f32 v81, v81, v152, v117
    v_fma_f32 v82, v82, v152, v118
    v_fma_f32 v83, v83, v152, v119
    v_cvt_pk_bf16_f32 v80, v80, v81
    v_cvt_pk_bf16_f32 v81, v82, v83
    v_mfma_f32_32x32x16_bf16 v[96:111], a[148:151], v[160:163], v[96:111]
    ds_write_b64 v40, v[112:113] offset:0
    ds_write_b64 v38, v[80:81] offset:0
    v_fma_f32 v84, v84, v152, v120
    v_fma_f32 v85, v85, v152, v121
    s_waitcnt lgkmcnt(2)
    v_mfma_f32_32x32x16_bf16 v[96:111], a[152:155], v[164:167], v[96:111]
    v_fma_f32 v86, v86, v152, v122
    v_fma_f32 v87, v87, v152, v123
    v_cvt_pk_bf16_f32 v84, v84, v85
    v_cvt_pk_bf16_f32 v85, v86, v87
    v_fma_f32 v88, v88, v152, v124
    v_mfma_f32_32x32x16_bf16 v[96:111], a[156:159], v[168:171], v[96:111]
    buffer_load_dwordx4 v76, s[16:19], s99 offen offset:3072 sc1 lds
    v_fma_f32 v89, v89, v152, v125
    v_fma_f32 v90, v90, v152, v126
    v_fma_f32 v91, v91, v152, v127
    v_cvt_pk_bf16_f32 v88, v88, v89
    v_cvt_pk_bf16_f32 v89, v90, v91
    ds_write_b64 v38, v[84:85] offset:6400
    ds_write_b64 v38, v[88:89] offset:12800
    v_fma_f32 v92, v92, v152, v128
    v_fma_f32 v93, v93, v152, v129
    v_fma_f32 v94, v94, v152, v130
    v_fma_f32 v95, v95, v152, v131
    v_cvt_pk_bf16_f32 v92, v92, v93
    v_cvt_pk_bf16_f32 v93, v94, v95
    ds_write_b64 v39, v[92:93] offset:0
    v_pk_fma_f32 v[96:97], v[96:97], v[154:155], v[132:133] op_sel_hi:[1,0,1]
    v_pk_fma_f32 v[98:99], v[98:99], v[154:155], v[134:135] op_sel_hi:[1,0,1]
    v_cvt_pk_bf16_f32 v96, v96, v97
    v_cvt_pk_bf16_f32 v97, v98, v99
    v_pk_fma_f32 v[100:101], v[100:101], v[154:155], v[136:137] op_sel_hi:[1,0,1]
    v_pk_fma_f32 v[102:103], v[102:103], v[154:155], v[138:139] op_sel_hi:[1,0,1]
    v_cvt_pk_bf16_f32 v100, v100, v101
    v_cvt_pk_bf16_f32 v101, v102, v103
    ds_write_b64 v38, v[96:97] offset:1600
    ds_write_b64 v38, v[100:101] offset:8000
    v_pk_fma_f32 v[104:105], v[104:105], v[154:155], v[140:141] op_sel_hi:[1,0,1]
    v_pk_fma_f32 v[106:107], v[106:107], v[154:155], v[142:143] op_sel_hi:[1,0,1]
    v_cvt_pk_bf16_f32 v104, v104, v105
    v_cvt_pk_bf16_f32 v105, v106, v107
    v_pk_fma_f32 v[108:109], v[108:109], v[154:155], v[144:145] op_sel_hi:[1,0,1]
    v_pk_fma_f32 v[110:111], v[110:111], v[154:155], v[146:147] op_sel_hi:[1,0,1]
    v_cvt_pk_bf16_f32 v108, v108, v109
    v_cvt_pk_bf16_f32 v109, v110, v111
    ds_write_b64 v38, v[104:105] offset:14400
    ds_write_b64 v39, v[108:109] offset:1600
    v_cmp_u_f32 vcc, v82, v114
    v_cmp_u_f32 s[82:83], v98, v98
    s_lshl_b32 s25, s24, 2
    s_add_u32 s25, s25, 161280
    s_or_b64 vcc, vcc, s[82:83]
    s_cselect_b32 s26, 1, 0
    v_mov_b32 v196, s25
    v_mov_b32 v197, s26
    ds_write_b32 v196, v197
    s_waitcnt lgkmcnt(0)
    s_barrier
    s_sub_u32 s85, s2, 160
    s_cmp_ge_u32 s85, 64
    s_cbranch_scc1 s2_63
    v_mov_b32 v238, 0x3f803f80
    s_lshl_b32 s25, s24, 7
    s_add_u32 s25, s25, 134272
    v_lshrrev_b32 v239, 4, v1
    v_lshl_add_u32 v237, v239, 2, v237
    v_add_u32 v237, s25, v237
se_64:
    v_mov_b32 v240, 0
    v_mov_b32 v241, 0
    v_mov_b32 v242, 0
    v_mov_b32 v243, 0
    s_waitcnt vmcnt(8)
    v_dot2c_f32_bf16 v240, v216, v238
    v_dot2c_f32_bf16 v241, v216, v216
    v_dot2c_f32_bf16 v240, v217, v238
    v_dot2c_f32_bf16 v241, v217, v217
    v_dot2c_f32_bf16 v242, v218, v238
    v_dot2c_f32_bf16 v243, v218, v218
    v_dot2c_f32_bf16 v242, v219, v238
    v_dot2c_f32_bf16 v243, v219, v219
    s_waitcnt vmcnt(7)
    v_dot2c_f32_bf16 v240, v220, v238
    v_dot2c_f32_bf16 v241, v220, v220
    v_dot2c_f32_bf16 v240, v221, v238
    v_dot2c_f32_bf16 v241, v221, v221
    v_dot2c_f32_bf16 v242, v222, v238
    v_dot2c_f32_bf16 v243, v222, v222
    v_dot2c_f32_bf16 v242, v223, v238
    v_dot2c_f32_bf16 v243, v223, v223
    s_waitcnt vmcnt(6)
    v_dot2c_f32_bf16 v240, v224, v238
    v_dot2c_f32_bf16 v241, v224, v224
    v_dot2c_f32_bf16 v240, v225, v238
    v_dot2c_f32_bf16 v241, v225, v225
    v_dot2c_f32_bf16 v242, v226, v238
    v_dot2c_f32_bf16 v243, v226, v226
    v_dot2c_f32_bf16 v242, v227, v238
    v_dot2c_f32_bf16 v243, v227, v227
    s_waitcnt vmcnt(5)
    v_dot2c_f32_bf16 v240, v228, v238
    v_dot2c_f32_bf16 v241, v228, v228
    v_dot2c_f32_bf16 v240, v229, v238
    v_dot2c_f32_bf16 v241, v229, v229
    v_dot2c_f32_bf16 v242, v230, v238
    v_dot2c_f32_bf16 v243, v230, v230
    v_dot2c_f32_bf16 v242, v231, v238
    v_dot2c_f32_bf16 v243, v231, v231
    s_waitcnt vmcnt(4)
    v_dot2c_f32_bf16 v240, v232, v238
    v_dot2c_f32_bf16 v241, v232, v232
    v_dot2c_f32_bf16 v240, v233, v238
    v_dot2c_f32_bf16 v241, v233, v233
    v_dot2c_f32_bf16 v242, v234, v238
    v_dot2c_f32_bf16 v243, v234, v234
    v_dot2c_f32_bf16 v242, v235, v238
    v_dot2c_f32_bf16 v243, v235, v235
    s_nop 2
    v_cmp_u_f32 vcc, v241, v243
    s_nop 0
    s_cbranch_vccnz rd_65
rc_66:
    v_permlane32_swap_b32 v240, v242
    v_permlane32_swap_b32 v241, v243
    v_pk_add_f32 v[240:241], v[240:241], v[242:243]
    s_nop 1
    v_permlane16_swap_b32 v240, v241
    v_add_f32_e64 v240, v240, v241
    s_nop 1
    v_add_f32_dpp v240, v240, v240 row_ror:8 row_mask:0xf bank_mask:0xf
    ds_write_b32 v237, v240
    v_and_b32 v236, 15, v0
    v_lshlrev_b32 v236, 3, v236
    v_add_u32 v237, 134272, v236
    v_mov_b32 v239, 1073741824
    v_cmp_gt_u32 vcc, 16, v0
    s_nop 1
    v_cndmask_b32 v236, v239, v236, vcc
    s_add_u32 s25, s3, 3457024
    s_waitcnt lgkmcnt(0)
    s_barrier
    ds_read_b64 v[216:217], v237 offset:0
    ds_read_b64 v[218:219], v237 offset:128
    ds_read_b64 v[220:221], v237 offset:256
    ds_read_b64 v[222:223], v237 offset:384
    s_waitcnt lgkmcnt(2)
    v_pk_add_f32 v[216:217], v[216:217], v[218:219]
    s_waitcnt lgkmcnt(0)
    v_pk_add_f32 v[220:221], v[220:221], v[222:223]
    v_pk_add_f32 v[216:217], v[216:217], v[220:221]
    v_mul_f32 v239, 0x3acccccd, v216
    v_mul_f32 v217, 0x3acccccd, v217
    v_fma_f32 v217, -v239, v239, v217
    v_max_f32 v217, 0, v217
    v_add_f32 v217, 0x3727c5ac, v217
    v_rsq_f32_e64 v216, v217
    s_nop 0
    v_mul_f32 v217, -v239, v216
    buffer_store_dwordx2 v[216:217], v236, s[16:19], s25 offen sc1
s2_63:
    v_mov_b32 v158, 161280
    ds_read_b128 v[128:131], v158
    v_mov_b32 v94, 0
    v_mov_b32 v95, 0
    v_mov_b32 v98, 0
    v_mov_b32 v99, 0
    s_mov_b64 exec, 0xffff
    ds_read_b64 v[94:95], v42 offset:320
    ds_read_b64 v[98:99], v42 offset:640
    s_mov_b64 exec, -1
    s_nop 0
    ds_read_b64 v[92:93], v41 offset:320
    ds_read_b64 v[96:97], v41 offset:640
    ds_read_b64 v[84:85], v41 offset:6720
    ds_read_b64 v[86:87], v42 offset:6720
    ds_read_b64 v[80:81], v41 offset:6400
    ds_read_b64 v[82:83], v42 offset:6400
    ds_read_b64 v[88:89], v41 offset:7040
    ds_read_b64 v[90:91], v42 offset:7040
    ds_read_b64_tr_b16 v[106:107], v44 offset:0
    ds_read_b64_tr_b16 v[100:101], v43 offset:0
    s_add_u32 m0, s93, 53760
    s_add_u32 s99, s99, 524288
    s_mov_b64 exec, s[80:81]
    buffer_load_dwordx4 v77, s[16:19], s100 offen sc1 lds
    s_mov_b64 exec, -1
    s_add_u32 s100, s100, 524288
    ds_read_b64_tr_b16 v[108:109], v44 offset:320
    ds_read_b64_tr_b16 v[102:103], v43 offset:320
    ds_read_b64_tr_b16 v[110:111], v44 offset:640
    ds_read_b64_tr_b16 v[104:105], v43 offset:640
    v_mov_b32 v156, 0xf149f2ca
    v_cndmask_b32 v152, v32, v156, s[90:91]
    v_cndmask_b32 v153, v33, v156, s[90:91]
    v_cndmask_b32 v154, v34, v156, s[90:91]
    s_add_u32 m0, s92, 55936
    s_nop 0
    buffer_load_dwordx4 v73, s[16:19], s99 offen offset:0 sc1 lds
    v_cndmask_b32 v155, v35, v156, s[90:91]
    s_mov_b32 s82, 0x3ea52b5c
    s_lshl_b32 s25, s98, 4
    s_add_u32 s25, s25, 12058624
    s_lshl_b32 s26, s98, 3
    s_add_u32 s26, s26, 12058624
    s_waitcnt lgkmcnt(15)
    v_or3_b32 v128, v128, v129, v130
    v_or_b32 v128, v128, v131
    buffer_load_dwordx4 v74, s[16:19], s99 offen offset:1024 sc1 lds
    v_cmp_ne_u32_e64 vcc, 0, v128
    s_nop 0
    s_cbranch_vccnz rd_67
rc_68:
    s_waitcnt lgkmcnt(10)
    v_mfma_f32_16x16x32_bf16 v[116:119], v[84:87], v[92:95], v[28:31]
    v_mfma_f32_16x16x32_bf16 v[120:123], v[84:87], v[96:99], v[32:35]
    s_waitcnt lgkmcnt(8)
    v_mfma_f32_16x16x32_bf16 v[112:115], v[80:83], v[92:95], v[152:155]
    s_waitcnt lgkmcnt(6)
    v_mfma_f32_16x16x32_bf16 v[124:127], v[88:91], v[96:99], v[28:31]
    s_nop 5
    v_max_f32 v112, v112, v116
    v_max_f32 v113, v113, v117
    v_max_f32 v114, v114, v118
    buffer_load_dwordx4 v75, s[16:19], s99 offen offset:2048 sc1 lds
    v_max_f32 v115, v115, v119
    v_max3_f32 v156, v112, v113, v114
    v_max_f32 v156, v156, v115
    v_max_f32 v120, v120, v124
    v_max_f32 v121, v121, v125
    v_max_f32 v122, v122, v126
    v_max_f32 v123, v123, v127
    v_max3_f32 v157, v120, v121, v122
    buffer_load_dwordx4 v76, s[16:19], s99 offen offset:3072 sc1 lds
    v_max_f32 v157, v157, v123
    s_nop 1
    v_permlane16_swap_b32 v156, v157
    v_max_f32 v156, v156, v157
    v_mov_b32 v157, v156
    s_nop 1
    v_permlane32_swap_b32 v156, v157
    v_max_f32 v156, v156, v157
    v_mul_f32 v156, s82, v156
    v_mov_b32 v157, v156
    s_add_u32 m0, s93, 73344
    s_add_u32 s99, s99, 524288
    s_mov_b64 exec, s[80:81]
    buffer_load_dwordx4 v77, s[16:19], s100 offen sc1 lds
    s_mov_b64 exec, -1
    s_add_u32 s100, s100, 524288
    v_permlane16_swap_b32_e64 v156, v157
    v_fma_f32 v112, v112, s82, -v156
    v_fma_f32 v113, v113, s82, -v156
    v_fma_f32 v114, v114, s82, -v156
    v_fma_f32 v115, v115, s82, -v156
    v_exp_f32 v112, v112
    v_exp_f32 v113, v113
    v_exp_f32 v114, v114
    s_add_u32 m0, s92, 75520
    s_nop 0
    buffer_load_dwordx4 v73, s[16:19], s99 offen offset:0 sc1 lds
    v_exp_f32_e64 v115, v115
    v_cvt_pk_bf16_f32 v116, v112, v113
    v_cvt_pk_bf16_f32 v117, v114, v115
    v_bfi_b32 v128, v36, 0, v116
    v_and_b32 v130, v36, v116
    v_bfi_b32 v129, v37, 0, v117
    v_and_b32 v131, v37, v117
    s_waitcnt lgkmcnt(3)
    s_nop 0
    v_mfma_f32_16x16x32_bf16 v[144:147], v[106:109], v[128:131], 0
    buffer_load_dwordx4 v74, s[16:19], s99 offen offset:1024 sc1 lds
    s_waitcnt lgkmcnt(2)
    v_mfma_f32_16x16x32_bf16 v[136:139], v[100:103], v[128:131], 0
    v_fma_f32 v120, v120, s82, -v157
    v_fma_f32 v121, v121, s82, -v157
    v_fma_f32 v122, v122, s82, -v157
    v_fma_f32 v123, v123, s82, -v157
    v_exp_f32 v120, v120
    v_exp_f32 v121, v121
    v_exp_f32 v122, v122
    buffer_load_dwordx4 v75, s[16:19], s99 offen offset:2048 sc1 lds
    v_exp_f32_e64 v123, v123
    v_cvt_pk_bf16_f32 v124, v120, v121
    v_cvt_pk_bf16_f32 v125, v122, v123
    v_bfi_b32 v132, v36, 0, v124
    v_and_b32 v134, v36, v124
    v_bfi_b32 v133, v37, 0, v125
    v_and_b32 v135, v37, v125
    s_waitcnt lgkmcnt(1)
    s_nop 0
    v_mfma_f32_16x16x32_bf16 v[148:151], v[108:111], v[132:135], 0
    buffer_load_dwordx4 v76, s[16:19], s99 offen offset:3072 sc1 lds
    s_waitcnt lgkmcnt(0)
    v_mfma_f32_16x16x32_bf16 v[140:143], v[102:105], v[132:135], 0
    v_mov_b32 v158, v144
    s_nop 1
    v_permlane16_swap_b32 v144, v158
    v_rcp_f32 v158, v158
    s_nop 0
    v_pk_mul_f32 v[136:137], v[136:137], v[158:159] op_sel_hi:[1,0]
    v_pk_mul_f32 v[138:139], v[138:139], v[158:159] op_sel_hi:[1,0]
    v_pk_mul_f32 v[144:145], v[144:145], v[158:159] op_sel_hi:[1,0]
    v_pk_mul_f32 v[146:147], v[146:147], v[158:159] op_sel_hi:[1,0]
    s_add_u32 m0, s93, 92928
    s_add_u32 s99, s99, 524288
    s_mov_b64 exec, s[80:81]
    buffer_load_dwordx4 v77, s[16:19], s100 offen sc1 lds
    s_mov_b64 exec, -1
    s_add_u32 s100, s100, 524288
    v_cvt_pk_bf16_f32 v112, v136, v137
    v_cvt_pk_bf16_f32 v116, v144, v145
    v_cvt_pk_bf16_f32 v113, v138, v139
    v_cvt_pk_bf16_f32 v117, v146, v147
    v_mov_b32 v160, v148
    s_nop 1
    v_permlane16_swap_b32 v148, v160
    v_rcp_f32_e64 v160, v160
    s_nop 0
    v_pk_mul_f32 v[140:141], v[140:141], v[160:161] op_sel_hi:[1,0]
    v_pk_mul_f32 v[142:143], v[142:143], v[160:161] op_sel_hi:[1,0]
    v_pk_mul_f32 v[148:149], v[148:149], v[160:161] op_sel_hi:[1,0]
    v_pk_mul_f32 v[150:151], v[150:151], v[160:161] op_sel_hi:[1,0]
    v_cvt_pk_bf16_f32 v114, v140, v141
    v_cvt_pk_bf16_f32 v118, v148, v149
    v_cvt_pk_bf16_f32 v115, v142, v143
    v_cvt_pk_bf16_f32 v119, v150, v151
    v_permlane16_swap_b32 v112, v114
    v_permlane16_swap_b32 v113, v115
    v_permlane16_swap_b32 v116, v118
    v_permlane16_swap_b32 v117, v119
    buffer_store_dwordx4 v[112:115], v45, s[16:19], s25 offen sc1
    s_mov_b64 exec, s[80:81]
    buffer_store_dwordx2 v[116:117], v46, s[16:19], s26 offen sc1
    s_mov_b64 exec, -1
ge_69:
    v_add_u32 v196, 36352, v78
    v_mov_b32_e64 v198, v79
    s_waitcnt vmcnt(12)
    s_barrier
    ds_read_b64 v[160:161], v198 offset:0
    ds_read_b64 v[162:163], v198 offset:64
    ds_read_b64 v[164:165], v196 offset:0
    ds_read_b64 v[166:167], v196 offset:512
    ds_read_b64 v[168:169], v196 offset:256
    ds_read_b64 v[170:171], v196 offset:768
    ds_read_b64 v[172:173], v198 offset:256
    ds_read_b64 v[174:175], v198 offset:320
    ds_read_b64 v[176:177], v196 offset:2048
    ds_read_b64 v[178:179], v196 offset:2560
    ds_read_b64 v[180:181], v196 offset:2304
    ds_read_b64 v[182:183], v196 offset:2816
    s_waitcnt lgkmcnt(6)
    v_mfma_f32_16x16x32_bf16 v[112:115], a[0:3], v[160:163], 0
    ds_read_b64 v[184:185], v198 offset:512
    v_mfma_f32_32x32x16_bf16 v[80:95], a[0:3], v[164:167], 0
    ds_read_b64 v[186:187], v198 offset:576
    ds_read_b64 v[188:189], v196 offset:4096
    ds_read_b64 v[190:191], v196 offset:4608
    v_mfma_f32_32x32x16_bf16 v[96:111], a[0:3], v[168:171], 0
    ds_read_b64 v[192:193], v196 offset:4352
    ds_read_b64 v[194:195], v196 offset:4864
    s_add_u32 m0, s92, 95104
    s_nop 0
    buffer_load_dwordx4 v73, s[16:19], s99 offen offset:0 sc1 lds
    s_waitcnt lgkmcnt(6)
    v_mfma_f32_16x16x32_bf16 v[112:115], a[4:7], v[172:175], v[112:115]
    ds_read_b64 v[160:161], v198 offset:768
    v_mfma_f32_32x32x16_bf16 v[80:95], a[4:7], v[176:179], v[80:95]
    ds_read_b64 v[162:163], v198 offset:832
    ds_read_b64 v[164:165], v196 offset:6144
    ds_read_b64 v[166:167], v196 offset:6656
    v_mfma_f32_32x32x16_bf16 v[96:111], a[4:7], v[180:183], v[96:111]
    ds_read_b64 v[168:169], v196 offset:6400
    ds_read_b64 v[170:171], v196 offset:6912
    buffer_load_dwordx4 v74, s[16:19], s99 offen offset:1024 sc1 lds
    s_waitcnt lgkmcnt(6)
    v_mfma_f32_16x16x32_bf16 v[112:115], a[8:11], v[184:187], v[112:115]
    ds_read_b64 v[172:173], v198 offset:1024
    v_mfma_f32_32x32x16_bf16 v[80:95], a[8:11], v[188:191], v[80:95]
    ds_read_b64 v[174:175], v198 offset:1088
    ds_read_b64 v[176:177], v196 offset:8192
    ds_read_b64 v[178:179], v196 offset:8704
    v_mfma_f32_32x32x16_bf16 v[96:111], a[8:11], v[192:195], v[96:111]
    ds_read_b64 v[180:181], v196 offset:8448
    ds_read_b64 v[182:183], v196 offset:8960
    buffer_load_dwordx4 v75, s[16:19], s99 offen offset:2048 sc1 lds
    s_waitcnt lgkmcnt(6)
    v_mfma_f32_16x16x32_bf16 v[112:115], a[12:15], v[160:163], v[112:115]
    ds_read_b64 v[184:185], v198 offset:1280
    v_mfma_f32_32x32x16_bf16 v[80:95], a[12:15], v[164:167], v[80:95]
    ds_read_b64 v[186:187], v198 offset:1344
    ds_read_b64 v[188:189], v196 offset:10240
    ds_read_b64 v[190:191], v196 offset:10752
    v_mfma_f32_32x32x16_bf16 v[96:111], a[12:15], v[168:171], v[96:111]
    ds_read_b64 v[192:193], v196 offset:10496
    ds_read_b64 v[194:195], v196 offset:11008
    buffer_load_dwordx4 v76, s[16:19], s99 offen offset:3072 sc1 lds
    s_waitcnt lgkmcnt(6)
    v_mfma_f32_16x16x32_bf16 v[112:115], a[16:19], v[172:175], v[112:115]
    ds_read_b64 v[160:161], v198 offset:1536
    v_mfma_f32_32x32x16_bf16 v[80:95], a[16:19], v[176:179], v[80:95]
    ds_read_b64 v[162:163], v198 offset:1600
    ds_read_b64 v[164:165], v196 offset:12288
    ds_read_b64 v[166:167], v196 offset:12800
    v_mfma_f32_32x32x16_bf16 v[96:111], a[16:19], v[180:183], v[96:111]
    ds_read_b64 v[168:169], v196 offset:12544
    ds_read_b64 v[170:171], v196 offset:13056
    s_add_u32 m0, s93, 112512
    s_add_u32 s99, s99, 524288
    s_mov_b64 exec, s[80:81]
    buffer_load_dwordx4 v77, s[16:19], s100 offen sc1 lds
    s_mov_b64 exec, -1
    s_add_u32 s100, s100, 524288
    s_waitcnt lgkmcnt(6)
    v_mfma_f32_16x16x32_bf16 v[112:115], a[20:23], v[184:187], v[112:115]
    ds_read_b64 v[172:173], v198 offset:1792
    v_mfma_f32_32x32x16_bf16 v[80:95], a[20:23], v[188:191], v[80:95]
    ds_read_b64 v[174:175], v198 offset:1856
    ds_read_b64 v[176:177], v196 offset:14336
    ds_read_b64 v[178:179], v196 offset:14848
    v_mfma_f32_32x32x16_bf16 v[96:111], a[20:23], v[192:195], v[96:111]
    ds_read_b64 v[180:181], v196 offset:14592
    ds_read_b64 v[182:183], v196 offset:15104
    s_add_u32 m0, s92, 114688
    s_nop 0
    buffer_load_dwordx4 v73, s[16:19], s99 offen offset:0 sc1 lds
    s_waitcnt vmcnt(13)
    s_barrier
    s_waitcnt lgkmcnt(6)
    v_mfma_f32_16x16x32_bf16 v[112:115], a[24:27], v[160:163], v[112:115]
    v_add_u32 v198, v49, v198
    v_mfma_f32_32x32x16_bf16 v[80:95], a[24:27], v[164:167], v[80:95]
    v_add_u32 v196, 19584, v196
    ds_read_b64 v[184:185], v198 offset:0
    ds_read_b64 v[186:187], v198 offset:64
    ds_read_b64 v[188:189], v196 offset:0
    v_mfma_f32_32x32x16_bf16 v[96:111], a[24:27], v[168:171], v[96:111]
    ds_read_b64 v[190:191], v196 offset:512
    ds_read_b64 v[192:193], v196 offset:256
    ds_read_b64 v[194:195], v196 offset:768
    buffer_load_dwordx4 v74, s[16:19], s99 offen offset:1024 sc1 lds
    s_waitcnt lgkmcnt(6)
    v_mfma_f32_16x16x32_bf16 v[112:115], a[28:31], v[172:175], v[112:115]
    ds_read_b64 v[160:161], v198 offset:256
    v_mfma_f32_32x32x16_bf16 v[80:95], a[28:31], v[176:179], v[80:95]
    ds_read_b64 v[162:163], v198 offset:320
    ds_read_b64 v[164:165], v196 offset:2048
    ds_read_b64 v[166:167], v196 offset:2560
    v_mfma_f32_32x32x16_bf16 v[96:111], a[28:31], v[180:183], v[96:111]
    ds_read_b64 v[168:169], v196 offset:2304
    ds_read_b64 v[170:171], v196 offset:2816
    buffer_load_dwordx4 v75, s[16:19], s99 offen offset:2048 sc1 lds
    s_waitcnt lgkmcnt(6)
    v_mfma_f32_16x16x32_bf16 v[112:115], a[32:35], v[184:187], v[112:115]
    ds_read_b64 v[172:173], v198 offset:512
    v_mfma_f32_32x32x16_bf16 v[80:95], a[32:35], v[188:191], v[80:95]
    ds_read_b64 v[174:175], v198 offset:576
    ds_read_b64 v[176:177], v196 offset:4096
    ds_read_b64 v[178:179], v196 offset:4608
    v_mfma_f32_32x32x16_bf16 v[96:111], a[32:35], v[192:195], v[96:111]
    ds_read_b64 v[180:181], v196 offset:4352
    ds_read_b64 v[182:183], v196 offset:4864
    buffer_load_dwordx4 v76, s[16:19], s99 offen offset:3072 sc1 lds
    s_waitcnt lgkmcnt(6)
    v_mfma_f32_16x16x32_bf16 v[112:115], a[36:39], v[160:163], v[112:115]
    ds_read_b64 v[184:185], v198 offset:768
    v_mfma_f32_32x32x16_bf16 v[80:95], a[36:39], v[164:167], v[80:95]
    ds_read_b64 v[186:187], v198 offset:832
    ds_read_b64 v[188:189], v196 offset:6144
    ds_read_b64 v[190:191], v196 offset:6656
    v_mfma_f32_32x32x16_bf16 v[96:111], a[36:39], v[168:171], v[96:111]
    ds_read_b64 v[192:193], v196 offset:6400
    ds_read_b64 v[194:195], v196 offset:6912
    s_add_u32 m0, s93, 132096
    s_add_u32 s99, s99, 524288
    s_mov_b64 exec, s[80:81]
    buffer_load_dwordx4 v77, s[16:19], s100 offen sc1 lds
    s_mov_b64 exec, -1
    s_add_u32 s100, s100, 524288
    s_waitcnt lgkmcnt(6)
    v_mfma_f32_16x16x32_bf16 v[112:115], a[40:43], v[172:175], v[112:115]
    ds_read_b64 v[160:161], v198 offset:1024
    v_mfma_f32_32x32x16_bf16 v[80:95], a[40:43], v[176:179], v[80:95]
    ds_read_b64 v[162:163], v198 offset:1088
    ds_read_b64 v[164:165], v196 offset:8192
    ds_read_b64 v[166:167], v196 offset:8704
    v_add_u32 v199, 36352, v58
    s_lshl_b32 s32, s24, 11
    v_mfma_f32_32x32x16_bf16 v[96:111], a[40:43], v[180:183], v[96:111]
    ds_read_b64 v[168:169], v196 offset:8448
    ds_read_b64 v[170:171], v196 offset:8960
    v_add_u32 v203, s32, v199
    s_add_u32 s32, s24, 1
    s_waitcnt lgkmcnt(6)
    v_mfma_f32_16x16x32_bf16 v[112:115], a[44:47], v[184:187], v[112:115]
    ds_read_b64 v[172:173], v198 offset:1280
    v_mfma_f32_32x32x16_bf16 v[80:95], a[44:47], v[188:191], v[80:95]
    ds_read_b64 v[174:175], v198 offset:1344
    ds_read_b64 v[176:177], v196 offset:10240
    ds_read_b64 v[178:179], v196 offset:10752
    s_and_b32 s32, s32, 3
    s_mul_i32 s32, s32, 6144
    v_mfma_f32_32x32x16_bf16 v[96:111], a[44:47], v[192:195], v[96:111]
    ds_read_b64 v[180:181], v196 offset:10496
    ds_read_b64 v[182:183], v196 offset:11008
    v_add_u32 v200, s32, v199
    s_add_u32 s32, s24, 2
    s_waitcnt lgkmcnt(6)
    v_mfma_f32_16x16x32_bf16 v[112:115], a[48:51], v[160:163], v[112:115]
    ds_read_b64 v[184:185], v198 offset:1536
    v_mfma_f32_32x32x16_bf16 v[80:95], a[48:51], v[164:167], v[80:95]
    ds_read_b64 v[186:187], v198 offset:1600
    ds_read_b64 v[188:189], v196 offset:12288
    ds_read_b64 v[190:191], v196 offset:12800
    s_and_b32 s32, s32, 3
    s_mul_i32 s32, s32, 6144
    v_mfma_f32_32x32x16_bf16 v[96:111], a[48:51], v[168:171], v[96:111]
    ds_read_b64 v[192:193], v196 offset:12544
    ds_read_b64 v[194:195], v196 offset:13056
    v_add_u32 v201, s32, v199
    s_add_u32 s32, s24, 3
    s_waitcnt lgkmcnt(6)
    v_mfma_f32_16x16x32_bf16 v[112:115], a[52:55], v[172:175], v[112:115]
    ds_read_b64 v[160:161], v198 offset:1792
    v_mfma_f32_32x32x16_bf16 v[80:95], a[52:55], v[176:179], v[80:95]
    ds_read_b64 v[162:163], v198 offset:1856
    ds_read_b64 v[164:165], v196 offset:14336
    ds_read_b64 v[166:167], v196 offset:14848
    s_and_b32 s32, s32, 3
    s_mul_i32 s32, s32, 6144
    v_mfma_f32_32x32x16_bf16 v[96:111], a[52:55], v[180:183], v[96:111]
    ds_read_b64 v[168:169], v196 offset:14592
    ds_read_b64 v[170:171], v196 offset:15104
    v_add_u32 v202, s32, v199
    s_mul_i32 s32, s24, 6144
    s_waitcnt vmcnt(12)
    s_barrier
    s_waitcnt lgkmcnt(6)
    v_mfma_f32_16x16x32_bf16 v[112:115], a[56:59], v[184:187], v[112:115]
    v_add_u32 v198, v49, v198
    v_mfma_f32_32x32x16_bf16 v[80:95], a[56:59], v[188:191], v[80:95]
    v_add_u32 v196, 19584, v196
    ds_read_b64 v[172:173], v198 offset:0
    ds_read_b64 v[174:175], v198 offset:64
    ds_read_b64 v[176:177], v196 offset:0
    v_add_u32_e64 v204, s32, v199
    v_mfma_f32_32x32x16_bf16 v[96:111], a[56:59], v[192:195], v[96:111]
    ds_read_b64 v[178:179], v196 offset:512
    ds_read_b64 v[180:181], v196 offset:256
    ds_read_b64 v[182:183], v196 offset:768
    s_lshl_b32 s32, s24, 8
    s_waitcnt lgkmcnt(6)
    v_mfma_f32_16x16x32_bf16 v[112:115], a[60:63], v[160:163], v[112:115]
    ds_read_b64 v[184:185], v198 offset:256
    v_mfma_f32_32x32x16_bf16 v[80:95], a[60:63], v[164:167], v[80:95]
    ds_read_b64 v[186:187], v198 offset:320
    ds_read_b64 v[188:189], v196 offset:2048
    ds_read_b64 v[190:191], v196 offset:2560
    s_add_u32 s32, s32, 36352
    v_and_b32_e64 v214, 15, v1
    v_mfma_f32_32x32x16_bf16 v[96:111], a[60:63], v[168:171], v[96:111]
    ds_read_b64 v[192:193], v196 offset:2304
    ds_read_b64 v[194:195], v196 offset:2816
    v_lshl_add_u32 v206, v214, 4, s32
    v_lshrrev_b32 v215, 5, v1
    s_waitcnt lgkmcnt(6)
    v_mfma_f32_16x16x32_bf16 v[112:115], a[64:67], v[172:175], v[112:115]
    ds_read_b64 v[160:161], v198 offset:512
    v_mfma_f32_32x32x16_bf16 v[80:95], a[64:67], v[176:179], v[80:95]
    ds_read_b64 v[162:163], v198 offset:576
    ds_read_b64 v[164:165], v196 offset:4096
    ds_read_b64 v[166:167], v196 offset:4608
    v_lshl_add_u32 v205, v215, 10, v206
    v_bfe_u32 v215, v1, 4, 1
    v_mfma_f32_32x32x16_bf16 v[96:111], a[64:67], v[180:183], v[96:111]
    ds_read_b64 v[168:169], v196 offset:4352
    ds_read_b64 v[170:171], v196 offset:4864
    v_lshl_add_u32 v205, v215, 3, v205
    v_lshlrev_b32 v214, 2, v214
    s_waitcnt lgkmcnt(6)
    v_mfma_f32_16x16x32_bf16 v[112:115], a[68:71], v[184:187], v[112:115]
    ds_read_b64 v[172:173], v198 offset:768
    v_mfma_f32_32x32x16_bf16 v[80:95], a[68:71], v[188:191], v[80:95]
    ds_read_b64 v[174:175], v198 offset:832
    ds_read_b64 v[176:177], v196 offset:6144
    ds_read_b64 v[178:179], v196 offset:6656
    v_lshl_add_u32 v214, v215, 10, v214
    s_lshl_b32 s32, s24, 6
    v_mfma_f32_32x32x16_bf16 v[96:111], a[68:71], v[192:195], v[96:111]
    ds_read_b64 v[180:181], v196 offset:6400
    ds_read_b64 v[182:183], v196 offset:6912
    v_lshl_add_u32 v207, v215, 3, s32
    v_and_b32_e64 v215, 12, v1
    s_waitcnt lgkmcnt(6)
    v_mfma_f32_16x16x32_bf16 v[112:115], a[72:75], v[160:163], v[112:115]
    ds_read_b64 v[184:185], v198 offset:1024
    v_mfma_f32_32x32x16_bf16 v[80:95], a[72:75], v[164:167], v[80:95]
    ds_read_b64 v[186:187], v198 offset:1088
    ds_read_b64 v[188:189], v196 offset:8192
    ds_read_b64 v[190:191], v196 offset:8704
    v_lshl_add_u32 v207, v215, 2, v207
    v_and_b32_e64 v215, 2, v1
    v_mfma_f32_32x32x16_bf16 v[96:111], a[72:75], v[168:171], v[96:111]
    ds_read_b64 v[192:193], v196 offset:8448
    ds_read_b64 v[194:195], v196 offset:8960
    s_lshl_b32 s98, s72, 5
    s_add_u32 s98, s98, 256
    s_sub_u32 s95, s98, 4
    s_max_i32 s95, s95, 0
    s_lshl_b32 s94, s98, 3
    s_lshl_b32 s95, s95, 3
    s_add_u32 s94, s94, 3457024
    s_add_u32 s95, s95, 3457024
    s_add_u32 s96, s94, 8192
    buffer_load_dwordx2 v[152:153], v47, s[16:19], s94 offen sc1
    s_waitcnt lgkmcnt(6)
    v_mfma_f32_16x16x32_bf16 v[112:115], a[76:79], v[172:175], v[112:115]
    ds_read_b64 v[160:161], v198 offset:1280
    v_mfma_f32_32x32x16_bf16 v[80:95], a[76:79], v[176:179], v[80:95]
    ds_read_b64 v[162:163], v198 offset:1344
    ds_read_b64 v[164:165], v196 offset:10240
    ds_read_b64 v[166:167], v196 offset:10752
    v_lshl_add_u32 v207, v215, 1, v207
    v_add_u32 v207, 69120, v207
    v_mfma_f32_32x32x16_bf16 v[96:111], a[76:79], v[180:183], v[96:111]
    ds_read_b64 v[168:169], v196 offset:10496
    ds_read_b64 v[170:171], v196 offset:11008
    buffer_load_dwordx2 v[154:155], v47, s[16:19], s96 offen sc1
    v_lshrrev_b32 v215, 4, v1
    s_waitcnt lgkmcnt(6)
    v_mfma_f32_16x16x32_bf16 v[112:115], a[80:83], v[184:187], v[112:115]
    ds_read_b64 v[172:173], v198 offset:1536
    v_mfma_f32_32x32x16_bf16 v[80:95], a[80:83], v[188:191], v[80:95]
    ds_read_b64 v[174:175], v198 offset:1600
    ds_read_b64 v[176:177], v196 offset:12288
    ds_read_b64 v[178:179], v196 offset:12800
    v_lshl_add_u32 v206, v215, 2, v206
    v_mov_b32 v215, 0x3f803f80
    v_mfma_f32_32x32x16_bf16 v[96:111], a[80:83], v[192:195], v[96:111]
    ds_read_b64 v[180:181], v196 offset:12544
    ds_read_b64 v[182:183], v196 offset:13056
    buffer_load_dwordx2 v[156:157], v48, s[16:19], s95 offen sc1
    s_waitcnt lgkmcnt(6)
    v_mfma_f32_16x16x32_bf16 v[112:115], a[84:87], v[160:163], v[112:115]
    ds_read_b64 v[184:185], v198 offset:1792
    v_mfma_f32_32x32x16_bf16 v[80:95], a[84:87], v[164:167], v[80:95]
    ds_read_b64 v[186:187], v198 offset:1856
    ds_read_b64 v[188:189], v196 offset:14336
    ds_read_b64 v[190:191], v196 offset:14848
    v_mfma_f32_32x32x16_bf16 v[96:111], a[84:87], v[168:171], v[96:111]
    ds_read_b64 v[192:193], v196 offset:14592
    ds_read_b64 v[194:195], v196 offset:15104
    s_waitcnt vmcnt(8)
    s_barrier
    s_waitcnt lgkmcnt(6)
    v_mfma_f32_16x16x32_bf16 v[112:115], a[88:91], v[172:175], v[112:115]
    v_add_u32_e64 v198, v49, v198
    v_mfma_f32_32x32x16_bf16 v[80:95], a[88:91], v[176:179], v[80:95]
    v_add_u32 v196, 19584, v196
    ds_read_b64 v[160:161], v198 offset:0
    ds_read_b64 v[162:163], v198 offset:64
    ds_read_b64 v[164:165], v196 offset:0
    v_mfma_f32_32x32x16_bf16 v[96:111], a[88:91], v[180:183], v[96:111]
    ds_read_b64 v[166:167], v196 offset:512
    ds_read_b64 v[168:169], v196 offset:256
    ds_read_b64 v[170:171], v196 offset:768
    s_waitcnt lgkmcnt(6)
    v_mfma_f32_16x16x32_bf16 v[112:115], a[92:95], v[184:187], v[112:115]
    ds_read_b64 v[172:173], v198 offset:256
    v_mfma_f32_32x32x16_bf16 v[80:95], a[92:95], v[188:191], v[80:95]
    ds_read_b64 v[174:175], v198 offset:320
    ds_read_b64 v[176:177], v196 offset:2048
    ds_read_b64 v[178:179], v196 offset:2560
    v_mfma_f32_32x32x16_bf16 v[96:111], a[92:95], v[192:195], v[96:111]
    ds_read_b64 v[180:181], v196 offset:2304
    ds_read_b64 v[182:183], v196 offset:2816
    s_waitcnt lgkmcnt(6)
    v_mfma_f32_16x16x32_bf16 v[112:115], a[96:99], v[160:163], v[112:115]
    ds_read_b64 v[184:185], v198 offset:512
    v_mfma_f32_32x32x16_bf16 v[80:95], a[96:99], v[164:167], v[80:95]
    ds_read_b64 v[186:187], v198 offset:576
    ds_read_b64 v[188:189], v196 offset:4096
    ds_read_b64 v[190:191], v196 offset:4608
    v_mfma_f32_32x32x16_bf16 v[96:111], a[96:99], v[168:171], v[96:111]
    ds_read_b64 v[192:193], v196 offset:4352
    ds_read_b64 v[194:195], v196 offset:4864
    s_waitcnt lgkmcnt(6)
    v_mfma_f32_16x16x32_bf16 v[112:115], a[100:103], v[172:175], v[112:115]
    ds_read_b64 v[160:161], v198 offset:768
    v_mfma_f32_32x32x16_bf16 v[80:95], a[100:103], v[176:179], v[80:95]
    ds_read_b64 v[162:163], v198 offset:832
    ds_read_b64 v[164:165], v196 offset:6144
    ds_read_b64 v[166:167], v196 offset:6656
    v_mfma_f32_32x32x16_bf16 v[96:111], a[100:103], v[180:183], v[96:111]
    ds_read_b64 v[168:169], v196 offset:6400
    ds_read_b64 v[170:171], v196 offset:6912
    s_waitcnt lgkmcnt(6)
    v_mfma_f32_16x16x32_bf16 v[112:115], a[104:107], v[184:187], v[112:115]
    ds_read_b64 v[172:173], v198 offset:1024
    v_mfma_f32_32x32x16_bf16 v[80:95], a[104:107], v[188:191], v[80:95]
    ds_read_b64 v[174:175], v198 offset:1088
    ds_read_b64 v[176:177], v196 offset:8192
    ds_read_b64 v[178:179], v196 offset:8704
    v_mfma_f32_32x32x16_bf16 v[96:111], a[104:107], v[192:195], v[96:111]
    ds_read_b64 v[180:181], v196 offset:8448
    ds_read_b64 v[182:183], v196 offset:8960
    s_waitcnt lgkmcnt(6)
    v_mfma_f32_16x16x32_bf16 v[112:115], a[108:111], v[160:163], v[112:115]
    ds_read_b64 v[184:185], v198 offset:1280
    v_mfma_f32_32x32x16_bf16 v[80:95], a[108:111], v[164:167], v[80:95]
    ds_read_b64 v[186:187], v198 offset:1344
    ds_read_b64 v[188:189], v196 offset:10240
    ds_read_b64 v[190:191], v196 offset:10752
    v_mfma_f32_32x32x16_bf16 v[96:111], a[108:111], v[168:171], v[96:111]
    ds_read_b64 v[192:193], v196 offset:10496
    ds_read_b64 v[194:195], v196 offset:11008
    s_waitcnt lgkmcnt(6)
    v_mfma_f32_16x16x32_bf16 v[112:115], a[112:115], v[172:175], v[112:115]
    ds_read_b64 v[160:161], v198 offset:1536
    v_mfma_f32_32x32x16_bf16 v[80:95], a[112:115], v[176:179], v[80:95]
    ds_read_b64 v[162:163], v198 offset:1600
    ds_read_b64 v[164:165], v196 offset:12288
    ds_read_b64 v[166:167], v196 offset:12800
    v_mfma_f32_32x32x16_bf16 v[96:111], a[112:115], v[180:183], v[96:111]
    ds_read_b64 v[168:169], v196 offset:12544
    ds_read_b64 v[170:171], v196 offset:13056
    s_waitcnt lgkmcnt(6)
    v_mfma_f32_16x16x32_bf16 v[112:115], a[116:119], v[184:187], v[112:115]
    ds_read_b64 v[172:173], v198 offset:1792
    v_mfma_f32_32x32x16_bf16 v[80:95], a[116:119], v[188:191], v[80:95]
    ds_read_b64 v[174:175], v198 offset:1856
    ds_read_b64 v[176:177], v196 offset:14336
    ds_read_b64 v[178:179], v196 offset:14848
    v_mfma_f32_32x32x16_bf16 v[96:111], a[116:119], v[192:195], v[96:111]
    ds_read_b64 v[180:181], v196 offset:14592
    ds_read_b64 v[182:183], v196 offset:15104
sl_70:
    s_waitcnt vmcnt(1)
    v_max3_u32 v2, v152, v153, v154
    s_waitcnt vmcnt(0)
    v_max3_u32 v2, v2, v155, v156
    v_max_u32 v2, v2, v157
    v_cmp_eq_u32 vcc, -1, v2
    s_nop 0
    s_cbranch_vccnz rd_71
rc_72:
    s_barrier
    s_waitcnt lgkmcnt(6)
    v_mfma_f32_16x16x32_bf16 v[112:115], a[120:123], v[160:163], v[112:115]
    v_add_u32 v198, v49, v198
    v_mfma_f32_32x32x16_bf16 v[80:95], a[120:123], v[164:167], v[80:95]
    v_add_u32 v196, 19584, v196
    ds_read_b64 v[184:185], v198 offset:0
    ds_read_b64 v[186:187], v198 offset:64
    v_mul_f32 v148, v24, v157
    v_mul_f32 v149, v25, v157
    v_mfma_f32_32x32x16_bf16 v[96:111], a[120:123], v[168:171], v[96:111]
    ds_read_b64 v[188:189], v196 offset:0
    ds_read_b64 v[190:191], v196 offset:512
    s_mov_b32 s96, 12058624
    buffer_load_dwordx4 v[216:219], v56, s[16:19], s96 offen offset:0 sc1
    v_mul_f32 v150, v26, v157
    v_mul_f32_e64 v151, v27, v157
    s_waitcnt lgkmcnt(4)
    v_mfma_f32_16x16x32_bf16 v[112:115], a[124:127], v[172:175], v[112:115]
    ds_read_b64 v[192:193], v198 offset:256
    v_mfma_f32_32x32x16_bf16 v[80:95], a[124:127], v[176:179], v[80:95]
    ds_read_b64 v[194:195], v198 offset:320
    ds_read_b64 v[160:161], v196 offset:2048
    v_mul_f32 v116, v8, v153
    v_mul_f32 v117, v9, v153
    v_mul_f32_e64 v118, v10, v153
    v_mfma_f32_32x32x16_bf16 v[96:111], a[124:127], v[180:183], v[96:111]
    ds_read_b64 v[162:163], v196 offset:2560
    buffer_load_dwordx4 v[220:223], v56, s[16:19], s96 offen offset:256 sc1
    v_mul_f32 v119, v11, v153
    v_mul_f32_e64 v120, v12, v153
    s_waitcnt lgkmcnt(4)
    v_mfma_f32_16x16x32_bf16 v[112:115], a[128:131], v[184:187], v[112:115]
    ds_read_b64 v[164:165], v198 offset:512
    v_mfma_f32_32x32x16_bf16 v[80:95], a[128:131], v[188:191], v[80:95]
    ds_read_b64 v[166:167], v198 offset:576
    ds_read_b64 v[168:169], v196 offset:4096
    ds_read_b64 v[170:171], v196 offset:4608
    v_mul_f32 v121, v13, v153
    v_mul_f32_e64 v122, v14, v153
    s_waitcnt lgkmcnt(4)
    v_mfma_f32_16x16x32_bf16 v[112:115], a[132:135], v[192:195], v[112:115]
    ds_read_b64 v[172:173], v198 offset:768
    v_mfma_f32_32x32x16_bf16 v[80:95], a[132:135], v[160:163], v[80:95]
    ds_read_b64 v[174:175], v198 offset:832
    ds_read_b64 v[176:177], v196 offset:6144
    ds_read_b64 v[178:179], v196 offset:6656
    s_mov_b32 s96, 12091392
    buffer_load_dwordx4 v[224:227], v56, s[16:19], s96 offen offset:0 sc1
    v_mul_f32 v123, v15, v153
    v_mul_f32_e64 v124, v16, v153
    s_waitcnt lgkmcnt(4)
    v_mfma_f32_16x16x32_bf16 v[112:115], a[136:139], v[164:167], v[112:115]
    ds_read_b64 v[180:181], v198 offset:1024
    v_mfma_f32_32x32x16_bf16 v[80:95], a[136:139], v[168:171], v[80:95]
    ds_read_b64 v[182:183], v198 offset:1088
    ds_read_b64 v[184:185], v196 offset:8192
    ds_read_b64 v[186:187], v196 offset:8704
    v_mul_f32 v125, v17, v153
    v_mul_f32_e64 v126, v18, v153
    s_waitcnt lgkmcnt(4)
    v_mfma_f32_16x16x32_bf16 v[112:115], a[140:143], v[172:175], v[112:115]
    ds_read_b64 v[188:189], v198 offset:1280
    v_mfma_f32_32x32x16_bf16 v[80:95], a[140:143], v[176:179], v[80:95]
    ds_read_b64 v[190:191], v198 offset:1344
    ds_read_b64 v[192:193], v196 offset:10240
    ds_read_b64 v[194:195], v196 offset:10752
    buffer_load_dwordx4 v[228:231], v56, s[16:19], s96 offen offset:256 sc1
    v_mul_f32 v127, v19, v153
    v_mul_f32_e64 v128, v20, v153
    s_waitcnt lgkmcnt(4)
    v_mfma_f32_16x16x32_bf16 v[112:115], a[144:147], v[180:183], v[112:115]
    ds_read_b64 v[160:161], v198 offset:1536
    v_mfma_f32_32x32x16_bf16 v[80:95], a[144:147], v[184:187], v[80:95]
    ds_read_b64 v[162:163], v198 offset:1600
    ds_read_b64 v[164:165], v196 offset:12288
    ds_read_b64 v[166:167], v196 offset:12800
    v_mul_f32 v129, v21, v153
    v_mul_f32_e64 v130, v22, v153
    s_waitcnt lgkmcnt(4)
    v_mfma_f32_16x16x32_bf16 v[112:115], a[148:151], v[188:191], v[112:115]
    ds_read_b64 v[168:169], v198 offset:1792
    v_mfma_f32_32x32x16_bf16 v[80:95], a[148:151], v[192:195], v[80:95]
    ds_read_b64 v[170:171], v198 offset:1856
    ds_read_b64 v[172:173], v196 offset:14336
    ds_read_b64 v[174:175], v196 offset:14848
    s_mov_b32 s96, 12124160
    buffer_load_dwordx4 v[232:235], v56, s[16:19], s96 offen offset:0 sc1
    v_mul_f32 v131, v23, v153
    v_mul_f32_e64 v132, v8, v155
    s_waitcnt lgkmcnt(4)
    v_mfma_f32_16x16x32_bf16 v[112:115], a[152:155], v[160:163], v[112:115]
    ds_read_b64 v[176:177], v196 offset:256
    v_mfma_f32_32x32x16_bf16 v[80:95], a[152:155], v[164:167], v[80:95]
    ds_read_b64 v[178:179], v196 offset:768
    ds_read_b64 v[180:181], v196 offset:2304
    ds_read_b64 v[182:183], v196 offset:2816
    v_mul_f32 v133, v9, v155
    v_mul_f32_e64 v134, v10, v155
    s_waitcnt lgkmcnt(4)
    v_mfma_f32_16x16x32_bf16 v[112:115], a[156:159], v[168:171], v[112:115]
    ds_read_b64 v[184:185], v196 offset:4352
    v_mfma_f32_32x32x16_bf16 v[80:95], a[156:159], v[172:175], v[80:95]
    ds_read_b64 v[186:187], v196 offset:4864
    ds_read_b64 v[188:189], v196 offset:6400
    ds_read_b64 v[190:191], v196 offset:6912
    buffer_load_dwordx4 v[236:239], v56, s[16:19], s96 offen offset:256 sc1
    v_mul_f32 v135, v11, v155
    v_mul_f32 v136, v12, v155
    v_mul_f32 v137, v13, v155
    v_mul_f32 v138, v14, v155
    v_mul_f32 v139, v15, v155
    v_mul_f32 v140, v16, v155
    v_mul_f32 v141, v17, v155
    v_mul_f32 v142, v18, v155
    v_mul_f32 v143, v19, v155
    v_mul_f32 v144, v20, v155
    v_mul_f32 v145, v21, v155
    v_mul_f32 v146, v22, v155
    v_mul_f32 v147, v23, v155
    s_waitcnt lgkmcnt(4)
    v_mfma_f32_32x32x16_bf16 v[96:111], a[128:131], v[176:179], v[96:111]
    ds_read_b64 v[192:193], v196 offset:8448
    ds_read_b64 v[194:195], v196 offset:8960
    v_mfma_f32_32x32x16_bf16 v[96:111], a[132:135], v[180:183], v[96:111]
    ds_read_b64 v[160:161], v196 offset:10496
    ds_read_b64 v[162:163], v196 offset:11008
    s_mov_b32 s96, 12156928
    buffer_load_dwordx4 v[240:243], v56, s[16:19], s96 offen offset:0 sc1
    v_fma_f32 v112, v112, v156, v148
    v_fma_f32 v113, v113, v156, v149
    s_waitcnt lgkmcnt(4)
    v_mfma_f32_32x32x16_bf16 v[96:111], a[136:139], v[184:187], v[96:111]
    ds_read_b64 v[164:165], v196 offset:12544
    ds_read_b64 v[166:167], v196 offset:13056
    v_fma_f32 v114, v114, v156, v150
    v_fma_f32 v115, v115, v156, v151
    v_cvt_pk_bf16_f32 v112, v112, v113
    v_mfma_f32_32x32x16_bf16 v[96:111], a[140:143], v[188:191], v[96:111]
    ds_read_b64 v[168:169], v196 offset:14592
    ds_read_b64 v[170:171], v196 offset:15104
    buffer_load_dwordx4 v[244:247], v56, s[16:19], s96 offen offset:256 sc1
    v_cvt_pk_bf16_f32 v113, v114, v115
    v_fma_f32 v80, v80, v152, v116
    s_waitcnt lgkmcnt(4)
    v_mfma_f32_32x32x16_bf16 v[96:111], a[144:147], v[192:195], v[96:111]
    v_fma_f32 v81, v81, v152, v117
    v_fma_f32 v82, v82, v152, v118
    v_fma_f32 v83, v83, v152, v119
    v_cvt_pk_bf16_f32 v80, v80, v81
    v_cvt_pk_bf16_f32 v81, v82, v83
    v_mfma_f32_32x32x16_bf16 v[96:111], a[148:151], v[160:163], v[96:111]
    ds_write_b64 v40, v[112:113] offset:0
    ds_write_b64 v38, v[80:81] offset:0
    v_fma_f32 v84, v84, v152, v120
    v_fma_f32 v85, v85, v152, v121
    s_waitcnt lgkmcnt(2)
    v_mfma_f32_32x32x16_bf16 v[96:111], a[152:155], v[164:167], v[96:111]
    v_fma_f32 v86, v86, v152, v122
    v_fma_f32 v87, v87, v152, v123
    v_cvt_pk_bf16_f32 v84, v84, v85
    v_cvt_pk_bf16_f32 v85, v86, v87
    v_fma_f32 v88, v88, v152, v124
    v_mfma_f32_32x32x16_bf16 v[96:111], a[156:159], v[168:171], v[96:111]
    s_mov_b32 s96, 12058624
    buffer_load_dwordx2 v[248:249], v57, s[16:19], s96 offen offset:0 sc1
    v_fma_f32 v89, v89, v152, v125
    v_fma_f32 v90, v90, v152, v126
    v_fma_f32 v91, v91, v152, v127
    v_cvt_pk_bf16_f32 v88, v88, v89
    v_cvt_pk_bf16_f32 v89, v90, v91
    ds_write_b64 v38, v[84:85] offset:6400
    ds_write_b64 v38, v[88:89] offset:12800
    v_fma_f32 v92, v92, v152, v128
    v_fma_f32 v93, v93, v152, v129
    v_fma_f32 v94, v94, v152, v130
    v_fma_f32 v95, v95, v152, v131
    v_cvt_pk_bf16_f32 v92, v92, v93
    v_cvt_pk_bf16_f32 v93, v94, v95
    ds_write_b64 v39, v[92:93] offset:0
    v_pk_fma_f32 v[96:97], v[96:97], v[154:155], v[132:133] op_sel_hi:[1,0,1]
    v_pk_fma_f32 v[98:99], v[98:99], v[154:155], v[134:135] op_sel_hi:[1,0,1]
    v_cvt_pk_bf16_f32 v96, v96, v97
    v_cvt_pk_bf16_f32 v97, v98, v99
    v_pk_fma_f32 v[100:101], v[100:101], v[154:155], v[136:137] op_sel_hi:[1,0,1]
    v_pk_fma_f32 v[102:103], v[102:103], v[154:155], v[138:139] op_sel_hi:[1,0,1]
    v_cvt_pk_bf16_f32 v100, v100, v101
    v_cvt_pk_bf16_f32 v101, v102, v103
    ds_write_b64 v38, v[96:97] offset:1600
    ds_write_b64 v38, v[100:101] offset:8000
    v_pk_fma_f32 v[104:105], v[104:105], v[154:155], v[140:141] op_sel_hi:[1,0,1]
    v_pk_fma_f32 v[106:107], v[106:107], v[154:155], v[142:143] op_sel_hi:[1,0,1]
    v_cvt_pk_bf16_f32 v104, v104, v105
    v_cvt_pk_bf16_f32 v105, v106, v107
    v_pk_fma_f32 v[108:109], v[108:109], v[154:155], v[144:145] op_sel_hi:[1,0,1]
    v_pk_fma_f32 v[110:111], v[110:111], v[154:155], v[146:147] op_sel_hi:[1,0,1]
    v_cvt_pk_bf16_f32 v108, v108, v109
    v_cvt_pk_bf16_f32 v109, v110, v111
    ds_write_b64 v38, v[104:105] offset:14400
    ds_write_b64 v39, v[108:109] offset:1600
    v_cmp_u_f32 vcc, v82, v114
    v_cmp_u_f32 s[82:83], v98, v98
    s_lshl_b32 s25, s24, 2
    s_add_u32 s25, s25, 161280
    s_or_b64 vcc, vcc, s[82:83]
    s_cselect_b32 s26, 1, 0
    v_mov_b32 v196, s25
    v_mov_b32 v197, s26
    ds_write_b32 v196, v197
    s_waitcnt lgkmcnt(0)
    s_barrier
    v_mov_b32 v158, 161280
    ds_read_b128 v[128:131], v158
    v_mov_b32 v94, 0
    v_mov_b32 v95, 0
    v_mov_b32 v98, 0
    v_mov_b32_e64 v99, 0
    s_mov_b64 exec, 0xffff
    ds_read_b64 v[94:95], v42 offset:320
    ds_read_b64 v[98:99], v42 offset:640
    s_mov_b64 exec, -1
    s_nop 0
    ds_read_b64 v[92:93], v41 offset:320
    ds_read_b64 v[96:97], v41 offset:640
    ds_read_b64 v[84:85], v41 offset:6720
    ds_read_b64 v[86:87], v42 offset:6720
    ds_read_b64 v[80:81], v41 offset:6400
    ds_read_b64 v[82:83], v42 offset:6400
    ds_read_b64 v[88:89], v41 offset:7040
    ds_read_b64 v[90:91], v42 offset:7040
    ds_read_b64_tr_b16 v[106:107], v44 offset:0
    ds_read_b64_tr_b16 v[100:101], v43 offset:0
    buffer_load_dwordx2 v[252:253], v57, s[16:19], s96 offen offset:128 sc1
    ds_read_b64_tr_b16 v[108:109], v44 offset:320
    ds_read_b64_tr_b16 v[102:103], v43 offset:320
    ds_read_b64_tr_b16 v[110:111], v44 offset:640
    ds_read_b64_tr_b16 v[104:105], v43 offset:640
    s_mov_b32 s82, 0x3ea52b5c
    s_lshl_b32 s25, s98, 4
    s_add_u32 s25, s25, 12058624
    s_lshl_b32 s26, s98, 3
    s_mov_b32 s96, 12075008
    buffer_load_dwordx2 v[250:251], v57, s[16:19], s96 offen offset:0 sc1
    s_add_u32 s26, s26, 12058624
    s_waitcnt lgkmcnt(15)
    v_or3_b32 v128, v128, v129, v130
    v_or_b32 v128, v128, v131
    v_cmp_ne_u32 vcc, 0, v128
    s_nop 0
    s_cbranch_vccnz rd_73
rc_74:
    s_waitcnt lgkmcnt(10)
    v_mfma_f32_16x16x32_bf16 v[116:119], v[84:87], v[92:95], v[28:31]
    v_mfma_f32_16x16x32_bf16 v[120:123], v[84:87], v[96:99], v[32:35]
    s_waitcnt lgkmcnt(8)
    v_mfma_f32_16x16x32_bf16 v[112:115], v[80:83], v[92:95], v[32:35]
    s_waitcnt lgkmcnt(6)
    v_mfma_f32_16x16x32_bf16 v[124:127], v[88:91], v[96:99], v[28:31]
    buffer_load_dwordx2 v[254:255], v57, s[16:19], s96 offen offset:128 sc1
    s_nop 4
    v_max_f32 v112, v112, v116
    v_max_f32 v113, v113, v117
    v_max_f32 v114, v114, v118
    v_max_f32 v115, v115, v119
    v_max3_f32 v156, v112, v113, v114
    v_max_f32 v156, v156, v115
    v_max_f32 v120, v120, v124
    v_max_f32 v121, v121, v125
    s_mov_b32 s96, 9437184
    buffer_load_dwordx4 v[208:211], v59, s[16:19], s96 offen sc1
    v_max_f32 v122, v122, v126
    v_max_f32 v123, v123, v127
    v_max3_f32 v157, v120, v121, v122
    v_max_f32 v157, v157, v123
    s_nop 1
    v_permlane16_swap_b32 v156, v157
    v_max_f32 v156, v156, v157
    v_mov_b32 v157, v156
    s_nop 1
    v_permlane32_swap_b32_e64 v156, v157
    s_add_u32 s97, s36, 9437184
    buffer_load_dword v212, v61, s[16:19], s97 offen sc1
    v_max_f32 v156, v156, v157
    v_mul_f32 v156, s82, v156
    v_mov_b32 v157, v156
    s_nop 1
    v_permlane16_swap_b32_e64 v156, v157
    v_fma_f32 v112, v112, s82, -v156
    v_fma_f32 v113, v113, s82, -v156
    v_fma_f32 v114, v114, s82, -v156
    v_fma_f32 v115, v115, s82, -v156
    v_exp_f32 v112, v112
    v_exp_f32 v113, v113
    v_exp_f32 v114, v114
    v_exp_f32 v115, v115
    v_cvt_pk_bf16_f32 v116, v112, v113
    v_cvt_pk_bf16_f32 v117, v114, v115
    v_bfi_b32 v128, v36, 0, v116
    v_and_b32 v130, v36, v116
    v_bfi_b32 v129, v37, 0, v117
    v_and_b32 v131, v37, v117
    s_waitcnt lgkmcnt(3)
    s_nop 0
    v_mfma_f32_16x16x32_bf16 v[144:147], v[106:109], v[128:131], 0
    s_waitcnt lgkmcnt(2)
    v_mfma_f32_16x16x32_bf16 v[136:139], v[100:103], v[128:131], 0
    v_fma_f32 v120, v120, s82, -v157
    v_fma_f32 v121, v121, s82, -v157
    v_fma_f32 v122, v122, s82, -v157
    v_fma_f32 v123, v123, s82, -v157
    v_exp_f32 v120, v120
    v_exp_f32 v121, v121
    v_exp_f32 v122, v122
    v_exp_f32_e64 v123, v123
    v_cvt_pk_bf16_f32 v124, v120, v121
    v_cvt_pk_bf16_f32 v125, v122, v123
    v_bfi_b32 v132, v36, 0, v124
    v_and_b32 v134, v36, v124
    v_bfi_b32 v133, v37, 0, v125
    v_and_b32 v135, v37, v125
    s_waitcnt lgkmcnt(1)
    s_nop 0
    v_mfma_f32_16x16x32_bf16 v[148:151], v[108:111], v[132:135], 0
    s_waitcnt lgkmcnt(0)
    v_mfma_f32_16x16x32_bf16 v[140:143], v[102:105], v[132:135], 0
    v_mov_b32 v158, v144
    s_nop 1
    v_permlane16_swap_b32 v144, v158
    v_rcp_f32 v158, v158
    s_nop 0
    v_pk_mul_f32 v[136:137], v[136:137], v[158:159] op_sel_hi:[1,0]
    v_pk_mul_f32 v[138:139], v[138:139], v[158:159] op_sel_hi:[1,0]
    v_pk_mul_f32 v[144:145], v[144:145], v[158:159] op_sel_hi:[1,0]
    v_pk_mul_f32 v[146:147], v[146:147], v[158:159] op_sel_hi:[1,0]
    v_cvt_pk_bf16_f32 v112, v136, v137
    v_cvt_pk_bf16_f32 v116, v144, v145
    v_cvt_pk_bf16_f32 v113, v138, v139
    v_cvt_pk_bf16_f32 v117, v146, v147
    v_mov_b32 v160, v148
    s_nop 1
    v_permlane16_swap_b32 v148, v160
    v_rcp_f32_e64 v160, v160
    s_nop 0
    v_pk_mul_f32 v[140:141], v[140:141], v[160:161] op_sel_hi:[1,0]
    v_pk_mul_f32 v[142:143], v[142:143], v[160:161] op_sel_hi:[1,0]
    v_pk_mul_f32 v[148:149], v[148:149], v[160:161] op_sel_hi:[1,0]
    v_pk_mul_f32 v[150:151], v[150:151], v[160:161] op_sel_hi:[1,0]
    v_cvt_pk_bf16_f32 v114, v140, v141
    v_cvt_pk_bf16_f32 v118, v148, v149
    v_cvt_pk_bf16_f32 v115, v142, v143
    v_cvt_pk_bf16_f32 v119, v150, v151
    v_permlane16_swap_b32 v112, v114
    v_permlane16_swap_b32 v113, v115
    v_permlane16_swap_b32 v116, v118
    v_permlane16_swap_b32 v117, v119
    buffer_store_dwordx4 v[112:115], v45, s[16:19], s25 offen sc1
    s_mov_b64 exec, s[80:81]
    buffer_store_dwordx2 v[116:117], v46, s[16:19], s26 offen sc1
    s_mov_b64 exec, -1
oe_75:
    s_waitcnt vmcnt(15)
    v_mfma_f32_16x16x32_bf16 v[112:115], a[176:179], v[216:219], 0
    v_mov_b32 v136, 0
    v_mov_b32 v137, 0
    s_waitcnt vmcnt(14)
    v_mfma_f32_16x16x32_bf16 v[116:119], a[176:179], v[220:223], 0
    v_mov_b32 v138, 0
    v_mov_b32 v139, 0
    s_waitcnt vmcnt(13)
    v_mfma_f32_16x16x32_bf16 v[112:115], a[196:199], v[224:227], v[112:115]
    v_mov_b32 v140, 0
    v_mov_b32 v141, 0
    s_waitcnt vmcnt(12)
    v_mfma_f32_16x16x32_bf16 v[116:119], a[196:199], v[228:231], v[116:119]
    s_mov_b32 s25, 14680064
    s_add_u32 s26, s36, 14680064
    s_waitcnt vmcnt(11)
    v_mfma_f32_16x16x32_bf16 v[112:115], a[216:219], v[232:235], v[112:115]
    s_add_u32 s27, s35, 3506176
    s_mov_b32 s28, 0x99999999
    s_waitcnt vmcnt(10)
    v_mfma_f32_16x16x32_bf16 v[116:119], a[216:219], v[236:239], v[116:119]
    s_mov_b32 s29, 0x99999999
    s_waitcnt vmcnt(9)
    v_mfma_f32_16x16x32_bf16 v[112:115], a[236:239], v[240:243], v[112:115]
    s_waitcnt vmcnt(8)
    v_mfma_f32_16x16x32_bf16 v[116:119], a[236:239], v[244:247], v[116:119]
    s_waitcnt vmcnt(5)
    v_mfma_f32_16x16x32_bf16 v[112:115], v[52:55], v[248:251], v[112:115]
    s_waitcnt vmcnt(4)
    v_mfma_f32_16x16x32_bf16 v[116:119], v[52:55], v[252:255], v[116:119]
    v_mfma_f32_16x16x32_bf16 v[88:91], a[164:167], v[216:219], 0
    v_mfma_f32_16x16x32_bf16 v[92:95], a[164:167], v[220:223], 0
    v_mfma_f32_16x16x32_bf16 v[88:91], a[184:187], v[224:227], v[88:91]
    s_waitcnt vmcnt(3)
    v_max3_u32 v132, v208, v209, v210
    s_waitcnt vmcnt(2)
    v_max3_u32 v132, v132, v211, v212
    v_mfma_f32_16x16x32_bf16 v[92:95], a[184:187], v[228:231], v[92:95]
    v_cmp_eq_u32 s[82:83], -1, v132
    v_mfma_f32_16x16x32_bf16 v[88:91], a[204:207], v[232:235], v[88:91]
    v_mfma_f32_16x16x32_bf16 v[92:95], a[204:207], v[236:239], v[92:95]
    v_cmp_u_f32 vcc, v112, v116
    s_nop 0
    s_or_b64 vcc, vcc, s[82:83]
    s_cbranch_vccnz rd_76
rc_77:
    v_mfma_f32_16x16x32_bf16 v[88:91], a[224:227], v[240:243], v[88:91]
    ds_write_b128 v203, v[112:115] offset:24576
    v_mfma_f32_16x16x32_bf16 v[92:95], a[224:227], v[244:247], v[92:95]
    v_mfma_f32_16x16x32_bf16 v[88:91], a[244:247], v[248:251], v[88:91]
    ds_write_b128 v203, v[116:119] offset:25600
    v_mfma_f32_16x16x32_bf16 v[92:95], a[244:247], v[252:255], v[92:95]
    v_mfma_f32_16x16x32_bf16 v[96:99], a[168:171], v[216:219], 0
    v_lshlrev_b32_e64 v120, 16, v208
    v_and_b32 v121, 0xffff0000, v208
    v_mfma_f32_16x16x32_bf16 v[100:103], a[168:171], v[220:223], 0
    v_lshlrev_b32_e64 v122, 16, v209
    v_and_b32 v123, 0xffff0000, v209
    v_mfma_f32_16x16x32_bf16 v[96:99], a[188:191], v[224:227], v[96:99]
    v_lshlrev_b32_e64 v124, 16, v210
    v_and_b32 v125, 0xffff0000, v210
    v_mfma_f32_16x16x32_bf16 v[100:103], a[188:191], v[228:231], v[100:103]
    v_lshlrev_b32_e64 v126, 16, v211
    v_and_b32 v127, 0xffff0000, v211
    v_mfma_f32_16x16x32_bf16 v[96:99], a[208:211], v[232:235], v[96:99]
    v_lshlrev_b32_e64 v128, 16, v212
    v_and_b32 v129, 0xffff0000, v212
    v_mfma_f32_16x16x32_bf16 v[100:103], a[208:211], v[236:239], v[100:103]
    v_mfma_f32_16x16x32_bf16 v[96:99], a[228:231], v[240:243], v[96:99]
    ds_write_b128 v200, v[88:91] offset:0
    v_mfma_f32_16x16x32_bf16 v[100:103], a[228:231], v[244:247], v[100:103]
    v_mfma_f32_16x16x32_bf16 v[96:99], a[248:251], v[248:251], v[96:99]
    ds_write_b128 v200, v[92:95] offset:1024
    v_mfma_f32_16x16x32_bf16 v[100:103], a[248:251], v[252:255], v[100:103]
    v_mfma_f32_16x16x32_bf16 v[104:107], a[172:175], v[216:219], 0
    v_mfma_f32_16x16x32_bf16 v[108:111], a[172:175], v[220:223], 0
    v_mfma_f32_16x16x32_bf16 v[104:107], a[192:195], v[224:227], v[104:107]
    v_mfma_f32_16x16x32_bf16 v[108:111], a[192:195], v[228:231], v[108:111]
    v_mfma_f32_16x16x32_bf16 v[104:107], a[212:215], v[232:235], v[104:107]
    v_mfma_f32_16x16x32_bf16 v[108:111], a[212:215], v[236:239], v[108:111]
    v_mfma_f32_16x16x32_bf16 v[104:107], a[232:235], v[240:243], v[104:107]
    ds_write_b128 v201, v[96:99] offset:2048
    v_mfma_f32_16x16x32_bf16 v[108:111], a[232:235], v[244:247], v[108:111]
    v_mfma_f32_16x16x32_bf16 v[104:107], a[252:255], v[248:251], v[104:107]
    ds_write_b128 v201, v[100:103] offset:3072
    v_mfma_f32_16x16x32_bf16 v[108:111], a[252:255], v[252:255], v[108:111]
    v_mfma_f32_16x16x32_bf16 v[80:83], a[160:163], v[216:219], v[120:123]
    v_mfma_f32_16x16x32_bf16 v[84:87], a[160:163], v[220:223], v[124:127]
    v_mfma_f32_16x16x32_bf16 v[80:83], a[180:183], v[224:227], v[80:83]
    v_mfma_f32_16x16x32_bf16 v[84:87], a[180:183], v[228:231], v[84:87]
    v_mfma_f32_16x16x32_bf16 v[80:83], a[200:203], v[232:235], v[80:83]
    s_nop 0
    ds_write_b128 v202, v[104:107] offset:4096
    v_mfma_f32_16x16x32_bf16 v[84:87], a[200:203], v[236:239], v[84:87]
    ds_write_b128 v202, v[108:111] offset:5120
    v_mfma_f32_16x16x32_bf16 v[80:83], a[220:223], v[240:243], v[80:83]
    v_mfma_f32_16x16x32_bf16 v[84:87], a[220:223], v[244:247], v[84:87]
    v_mfma_f32_16x16x32_bf16 v[80:83], a[240:243], v[248:251], v[80:83]
    v_mfma_f32_16x16x32_bf16 v[84:87], a[240:243], v[252:255], v[84:87]
    s_waitcnt lgkmcnt(0)
    s_barrier
    s_nop 0
    ds_read_b128 v[88:91], v204 offset:0
    ds_read_b128 v[92:95], v204 offset:1024
    ds_read_b128 v[96:99], v204 offset:2048
    ds_read_b128 v[100:103], v204 offset:3072
    ds_read_b128 v[104:107], v204 offset:4096
    ds_read_b128 v[108:111], v204 offset:5120
    ds_read_b64 v[112:113], v205 offset:24576
    ds_read_b64 v[114:115], v205 offset:26624
    ds_read_b64 v[116:117], v205 offset:28672
    ds_read_b64 v[118:119], v205 offset:30720
    s_mov_b32 s96, 12062720
    buffer_load_dwordx4 v[216:219], v56, s[16:19], s96 offen offset:0 sc1
    buffer_load_dwordx4 v[220:223], v56, s[16:19], s96 offen offset:256 sc1
    s_mov_b32 s96, 12095488
    buffer_load_dwordx4 v[224:227], v56, s[16:19], s96 offen offset:0 sc1
    s_waitcnt lgkmcnt(9)
    v_pk_add_f32 v[80:81], v[80:81], v[88:89]
    v_pk_add_f32 v[82:83], v[82:83], v[90:91]
    s_waitcnt lgkmcnt(8)
    v_pk_add_f32 v[84:85], v[84:85], v[92:93]
    v_pk_add_f32 v[86:87], v[86:87], v[94:95]
    s_waitcnt lgkmcnt(7)
    v_pk_add_f32 v[80:81], v[80:81], v[96:97]
    v_pk_add_f32 v[82:83], v[82:83], v[98:99]
    s_waitcnt lgkmcnt(6)
    v_pk_add_f32 v[84:85], v[84:85], v[100:101]
    v_pk_add_f32 v[86:87], v[86:87], v[102:103]
    s_waitcnt lgkmcnt(5)
    v_pk_add_f32 v[80:81], v[80:81], v[104:105]
    v_pk_add_f32 v[82:83], v[82:83], v[106:107]
    s_waitcnt lgkmcnt(4)
    v_pk_add_f32 v[84:85], v[84:85], v[108:109]
    v_pk_add_f32 v[86:87], v[86:87], v[110:111]
    v_cvt_pk_bf16_f32 v132, v80, v81
    v_cvt_pk_bf16_f32 v133, v82, v83
    v_cvt_pk_bf16_f32 v134, v84, v85
    v_cvt_pk_bf16_f32 v135, v86, v87
    s_waitcnt lgkmcnt(3)
    v_pk_add_f32 v[128:129], v[128:129], v[112:113]
    s_waitcnt lgkmcnt(2)
    v_pk_add_f32 v[128:129], v[128:129], v[114:115]
    s_waitcnt lgkmcnt(1)
    v_pk_add_f32 v[128:129], v[128:129], v[116:117]
    s_waitcnt lgkmcnt(0)
    v_pk_add_f32 v[128:129], v[128:129], v[118:119]
    v_cvt_pk_bf16_f32 v130, v128, v129
    buffer_store_dwordx4 v[132:135], v59, s[16:19], s25 offen sc1
    buffer_store_dword v130, v61, s[16:19], s26 offen sc1
    v_dot2c_f32_bf16 v136, v132, v215
    v_dot2c_f32_bf16 v137, v132, v132
    v_dot2c_f32_bf16 v136, v133, v215
    v_dot2c_f32_bf16 v137, v133, v133
    v_dot2c_f32_bf16 v138, v134, v215
    v_dot2c_f32_bf16 v139, v134, v134
    v_dot2c_f32_bf16 v138, v135, v215
    v_dot2c_f32_bf16 v139, v135, v135
    v_dot2c_f32_bf16 v140, v130, v215
    v_dot2c_f32_bf16 v141, v130, v130
    v_permlane32_swap_b32 v136, v138
    v_permlane32_swap_b32 v137, v139
    v_pk_add_f32 v[136:137], v[136:137], v[138:139]
    v_pk_add_f32 v[136:137], v[136:137], v[140:141]
    s_nop 1
    v_permlane16_swap_b32 v136, v137
    v_add_f32_e64 v136, v136, v137
    ds_write_b32 v206, v136 offset:32768
    buffer_load_dwordx4 v[228:231], v56, s[16:19], s96 offen offset:256 sc1
    s_mov_b32 s96, 12128256
    buffer_load_dwordx4 v[232:235], v56, s[16:19], s96 offen offset:0 sc1
    buffer_load_dwordx4 v[236:239], v56, s[16:19], s96 offen offset:256 sc1
    s_mov_b32 s96, 12161024
    buffer_load_dwordx4 v[240:243], v56, s[16:19], s96 offen offset:0 sc1
    buffer_load_dwordx4 v[244:247], v56, s[16:19], s96 offen offset:256 sc1
    s_mov_b32 s96, 12060672
    buffer_load_dwordx2 v[248:249], v57, s[16:19], s96 offen offset:0 sc1
    buffer_load_dwordx2 v[252:253], v57, s[16:19], s96 offen offset:128 sc1
    s_mov_b32 s96, 12077056
    buffer_load_dwordx2 v[250:251], v57, s[16:19], s96 offen offset:0 sc1
    buffer_load_dwordx2 v[254:255], v57, s[16:19], s96 offen offset:128 sc1
    s_mov_b32 s96, 9439232
    buffer_load_dwordx4 v[208:211], v59, s[16:19], s96 offen sc1
    s_add_u32 s97, s36, 9439232
    buffer_load_dword v212, v61, s[16:19], s97 offen sc1
    s_waitcnt lgkmcnt(0)
    s_barrier
    ds_read2st64_b32 v[136:137], v207 offset0:0 offset1:1
    ds_read2st64_b32 v[138:139], v207 offset0:2 offset1:3
    ds_read_b64_tr_b16 v[144:145], v65 offset:32
    ds_read_b64_tr_b16 v[146:147], v65 offset:0
    ds_read_b64_tr_b16 v[148:149], v65 offset:160
    ds_read_b64_tr_b16 v[150:151], v65 offset:128
    ds_read_b64_tr_b16 v[152:153], v65 offset:288
    ds_read_b64_tr_b16 v[154:155], v65 offset:256
    ds_read_b64_tr_b16 v[156:157], v65 offset:416
    ds_read_b64_tr_b16 v[158:159], v65 offset:384
    ds_read_b64_tr_b16 v[160:161], v65 offset:544
    ds_read_b64_tr_b16 v[162:163], v65 offset:512
    ds_read_b64_tr_b16 v[164:165], v65 offset:672
    ds_read_b64_tr_b16 v[166:167], v65 offset:640
    ds_read_b64_tr_b16 v[168:169], v65 offset:800
    ds_read_b64_tr_b16 v[170:171], v65 offset:768
    ds_read_b64_tr_b16 v[172:173], v65 offset:928
    ds_read_b64_tr_b16 v[174:175], v65 offset:896
    s_waitcnt lgkmcnt(15)
    v_pk_add_f32 v[136:137], v[136:137], v[138:139]
    v_add_f32 v136, v136, v137
    v_cndmask_b32 v136, v136, 1.0, s[28:29]
    s_mov_b64 exec, s[80:81]
    buffer_atomic_add_f32 v136, v214, s[16:19], s27 offen sc1
    s_mov_b64 exec, -1
    v_lshrrev_b32 v176, 4, v0
    v_mul_u32_u24 v176, 1216, v176
    v_and_b32 v177, 15, v0
    v_lshl_add_u32 v176, v177, 3, v176
    v_add_u32 v176, 64, v176
    v_mov_b32 v178, 0
    v_mov_b32 v179, 0
    ds_write_b64 v176, v[178:179]
    v_mov_b32 v70, 0
    v_mov_b32 v71, 0
    v_mov_b32 v72, 0
oe_78:
    s_waitcnt vmcnt(16)
    v_mfma_f32_16x16x32_bf16 v[112:115], a[176:179], v[216:219], 0
    v_mov_b32 v136, 0
    v_mov_b32 v137, 0
    s_waitcnt vmcnt(15)
    v_mfma_f32_16x16x32_bf16 v[116:119], a[176:179], v[220:223], 0
    v_mov_b32 v138, 0
    v_mov_b32 v139, 0
    s_waitcnt vmcnt(14)
    v_mfma_f32_16x16x32_bf16 v[112:115], a[196:199], v[224:227], v[112:115]
    v_mov_b32 v140, 0
    v_mov_b32 v141, 0
    s_waitcnt vmcnt(11)
    v_mfma_f32_16x16x32_bf16 v[116:119], a[196:199], v[228:231], v[116:119]
    s_mov_b32 s25, 14682112
    s_add_u32 s26, s36, 14682112
    s_waitcnt vmcnt(10)
    v_mfma_f32_16x16x32_bf16 v[112:115], a[216:219], v[232:235], v[112:115]
    s_add_u32 s27, s35, 3510272
    s_mov_b32 s28, 0x99999999
    s_waitcnt vmcnt(9)
    v_mfma_f32_16x16x32_bf16 v[116:119], a[216:219], v[236:239], v[116:119]
    s_mov_b32 s29, 0x99999999
    s_waitcnt vmcnt(8)
    v_mfma_f32_16x16x32_bf16 v[112:115], a[236:239], v[240:243], v[112:115]
    s_waitcnt vmcnt(7)
    v_mfma_f32_16x16x32_bf16 v[116:119], a[236:239], v[244:247], v[116:119]
    s_waitcnt vmcnt(4)
    v_mfma_f32_16x16x32_bf16 v[112:115], v[52:55], v[248:251], v[112:115]
    s_waitcnt vmcnt(3)
    v_mfma_f32_16x16x32_bf16 v[116:119], v[52:55], v[252:255], v[116:119]
    v_mfma_f32_16x16x32_bf16 v[88:91], a[164:167], v[216:219], 0
    v_mfma_f32_16x16x32_bf16 v[92:95], a[164:167], v[220:223], 0
    v_mfma_f32_16x16x32_bf16 v[88:91], a[184:187], v[224:227], v[88:91]
    s_waitcnt vmcnt(2)
    v_max3_u32 v132, v208, v209, v210
    s_waitcnt vmcnt(1)
    v_max3_u32 v132, v132, v211, v212
    v_mfma_f32_16x16x32_bf16 v[92:95], a[184:187], v[228:231], v[92:95]
    v_cmp_eq_u32 s[82:83], -1, v132
    v_mfma_f32_16x16x32_bf16 v[88:91], a[204:207], v[232:235], v[88:91]
    v_mfma_f32_16x16x32_bf16 v[92:95], a[204:207], v[236:239], v[92:95]
    v_cmp_u_f32 vcc, v112, v116
    s_nop 0
    s_or_b64 vcc, vcc, s[82:83]
    s_cbranch_vccnz rd_79
rc_80:
    v_mfma_f32_16x16x32_bf16 v[88:91], a[224:227], v[240:243], v[88:91]
    ds_write_b128 v203, v[112:115] offset:24576
    v_mfma_f32_16x16x32_bf16 v[92:95], a[224:227], v[244:247], v[92:95]
    v_mfma_f32_16x16x32_bf16 v[88:91], a[244:247], v[248:251], v[88:91]
    ds_write_b128 v203, v[116:119] offset:25600
    v_mfma_f32_16x16x32_bf16 v[92:95], a[244:247], v[252:255], v[92:95]
    v_mfma_f32_16x16x32_bf16 v[96:99], a[168:171], v[216:219], 0
    v_lshlrev_b32_e64 v120, 16, v208
    v_and_b32 v121, 0xffff0000, v208
    v_mfma_f32_16x16x32_bf16 v[100:103], a[168:171], v[220:223], 0
    v_lshlrev_b32_e64 v122, 16, v209
    v_and_b32 v123, 0xffff0000, v209
    v_mfma_f32_16x16x32_bf16 v[96:99], a[188:191], v[224:227], v[96:99]
    v_lshlrev_b32_e64 v124, 16, v210
    v_and_b32 v125, 0xffff0000, v210
    v_mfma_f32_16x16x32_bf16 v[100:103], a[188:191], v[228:231], v[100:103]
    v_lshlrev_b32_e64 v126, 16, v211
    v_and_b32 v127, 0xffff0000, v211
    v_mfma_f32_16x16x32_bf16 v[96:99], a[208:211], v[232:235], v[96:99]
    v_lshlrev_b32_e64 v128, 16, v212
    v_and_b32 v129, 0xffff0000, v212
    v_mfma_f32_16x16x32_bf16 v[100:103], a[208:211], v[236:239], v[100:103]
    v_mfma_f32_16x16x32_bf16 v[96:99], a[228:231], v[240:243], v[96:99]
    ds_write_b128 v200, v[88:91] offset:0
    v_mfma_f32_16x16x32_bf16 v[100:103], a[228:231], v[244:247], v[100:103]
    v_mfma_f32_16x16x32_bf16 v[96:99], a[248:251], v[248:251], v[96:99]
    ds_write_b128 v200, v[92:95] offset:1024
    v_mfma_f32_16x16x32_bf16 v[100:103], a[248:251], v[252:255], v[100:103]
    v_mfma_f32_16x16x32_bf16 v[104:107], a[172:175], v[216:219], 0
    v_mfma_f32_16x16x32_bf16 v[108:111], a[172:175], v[220:223], 0
    v_mfma_f32_16x16x32_bf16 v[104:107], a[192:195], v[224:227], v[104:107]
    v_mfma_f32_16x16x32_bf16 v[108:111], a[192:195], v[228:231], v[108:111]
    v_mfma_f32_16x16x32_bf16 v[104:107], a[212:215], v[232:235], v[104:107]
    v_mfma_f32_16x16x32_bf16 v[108:111], a[212:215], v[236:239], v[108:111]
    v_mfma_f32_16x16x32_bf16 v[104:107], a[232:235], v[240:243], v[104:107]
    ds_write_b128 v201, v[96:99] offset:2048
    v_mfma_f32_16x16x32_bf16 v[108:111], a[232:235], v[244:247], v[108:111]
    v_mfma_f32_16x16x32_bf16 v[104:107], a[252:255], v[248:251], v[104:107]
    ds_write_b128 v201, v[100:103] offset:3072
    v_mfma_f32_16x16x32_bf16 v[108:111], a[252:255], v[252:255], v[108:111]
    v_mfma_f32_16x16x32_bf16 v[80:83], a[160:163], v[216:219], v[120:123]
    v_mfma_f32_16x16x32_bf16 v[84:87], a[160:163], v[220:223], v[124:127]
    v_mfma_f32_16x16x32_bf16 v[80:83], a[180:183], v[224:227], v[80:83]
    v_mfma_f32_16x16x32_bf16 v[84:87], a[180:183], v[228:231], v[84:87]
    v_mfma_f32_16x16x32_bf16 v[80:83], a[200:203], v[232:235], v[80:83]
    s_nop 0
    ds_write_b128 v202, v[104:107] offset:4096
    v_mfma_f32_16x16x32_bf16 v[84:87], a[200:203], v[236:239], v[84:87]
    ds_write_b128 v202, v[108:111] offset:5120
    v_mfma_f32_16x16x32_bf16 v[80:83], a[220:223], v[240:243], v[80:83]
    v_mfma_f32_16x16x32_bf16 v[84:87], a[220:223], v[244:247], v[84:87]
    v_mfma_f32_16x16x32_bf16 v[80:83], a[240:243], v[248:251], v[80:83]
    v_mfma_f32_16x16x32_bf16 v[84:87], a[240:243], v[252:255], v[84:87]
    s_waitcnt lgkmcnt(0)
    s_barrier
    s_nop 0
    ds_read_b128 v[88:91], v204 offset:0
    ds_read_b128 v[92:95], v204 offset:1024
    ds_read_b128 v[96:99], v204 offset:2048
    ds_read_b128 v[100:103], v204 offset:3072
    ds_read_b128 v[104:107], v204 offset:4096
    ds_read_b128 v[108:111], v204 offset:5120
    ds_read_b64 v[112:113], v205 offset:24576
    ds_read_b64 v[114:115], v205 offset:26624
    ds_read_b64 v[116:117], v205 offset:28672
    ds_read_b64 v[118:119], v205 offset:30720
    s_lshl_b32 s96, s75, 14
    s_add_u32 s96, s96, 14680064
    s_lshl_b32 s97, s24, 12
    s_add_u32 s97, s97, 3506176
    buffer_load_dwordx4 v[176:179], v62, s[16:19], s96 offen offset:0 sc1
    buffer_load_dwordx4 v[180:183], v62, s[16:19], s96 offen offset:1024 sc1
    buffer_load_dwordx4 v[184:187], v62, s[16:19], s97 offen offset:0 sc1
    buffer_load_dwordx4 v[188:191], v62, s[16:19], s97 offen offset:1024 sc1
    buffer_load_dwordx4 v[192:195], v62, s[16:19], s97 offen offset:2048 sc1
    buffer_load_dwordx4 v[196:199], v62, s[16:19], s97 offen offset:3072 sc1
    s_waitcnt lgkmcnt(9)
    v_pk_add_f32 v[80:81], v[80:81], v[88:89]
    v_pk_add_f32 v[82:83], v[82:83], v[90:91]
    s_waitcnt lgkmcnt(8)
    v_pk_add_f32 v[84:85], v[84:85], v[92:93]
    v_pk_add_f32 v[86:87], v[86:87], v[94:95]
    s_waitcnt lgkmcnt(7)
    v_pk_add_f32 v[80:81], v[80:81], v[96:97]
    v_pk_add_f32 v[82:83], v[82:83], v[98:99]
    s_waitcnt lgkmcnt(6)
    v_pk_add_f32 v[84:85], v[84:85], v[100:101]
    v_pk_add_f32 v[86:87], v[86:87], v[102:103]
    s_waitcnt lgkmcnt(5)
    v_pk_add_f32 v[80:81], v[80:81], v[104:105]
    v_pk_add_f32 v[82:83], v[82:83], v[106:107]
    s_waitcnt lgkmcnt(4)
    v_pk_add_f32 v[84:85], v[84:85], v[108:109]
    v_pk_add_f32 v[86:87], v[86:87], v[110:111]
    v_cvt_pk_bf16_f32 v132, v80, v81
    v_cvt_pk_bf16_f32 v133, v82, v83
    v_cvt_pk_bf16_f32 v134, v84, v85
    v_cvt_pk_bf16_f32 v135, v86, v87
    s_waitcnt lgkmcnt(3)
    v_pk_add_f32 v[128:129], v[128:129], v[112:113]
    s_waitcnt lgkmcnt(2)
    v_pk_add_f32 v[128:129], v[128:129], v[114:115]
    s_waitcnt lgkmcnt(1)
    v_pk_add_f32 v[128:129], v[128:129], v[116:117]
    s_waitcnt lgkmcnt(0)
    v_pk_add_f32 v[128:129], v[128:129], v[118:119]
    v_cvt_pk_bf16_f32 v130, v128, v129
    buffer_store_dwordx4 v[132:135], v59, s[16:19], s25 offen sc1
    buffer_store_dword v130, v61, s[16:19], s26 offen sc1
    v_dot2c_f32_bf16 v136, v132, v215
    v_dot2c_f32_bf16 v137, v132, v132
    v_dot2c_f32_bf16 v136, v133, v215
    v_dot2c_f32_bf16 v137, v133, v133
    v_dot2c_f32_bf16 v138, v134, v215
    v_dot2c_f32_bf16 v139, v134, v134
    v_dot2c_f32_bf16 v138, v135, v215
    v_dot2c_f32_bf16 v139, v135, v135
    v_dot2c_f32_bf16 v140, v130, v215
    v_dot2c_f32_bf16 v141, v130, v130
    v_permlane32_swap_b32 v136, v138
    v_permlane32_swap_b32 v137, v139
    v_pk_add_f32 v[136:137], v[136:137], v[138:139]
    v_pk_add_f32 v[136:137], v[136:137], v[140:141]
    s_nop 1
    v_permlane16_swap_b32 v136, v137
    v_add_f32 v136, v136, v137
    ds_write_b32 v206, v136 offset:32768
    s_waitcnt lgkmcnt(0)
    s_barrier
    ds_read2st64_b32 v[136:137], v207 offset0:0 offset1:1
    ds_read2st64_b32 v[138:139], v207 offset0:2 offset1:3
    s_waitcnt lgkmcnt(0)
    v_pk_add_f32 v[136:137], v[136:137], v[138:139]
    v_add_f32 v136, v136, v137
    v_cndmask_b32 v136, v136, 1.0, s[28:29]
    s_mov_b64 exec, s[80:81]
    buffer_atomic_add_f32 v136, v214, s[16:19], s27 offen sc1
    s_mov_b64 exec, -1
    s_cmp_ge_u32 s2, 160
    s_cbranch_scc1 nc_81
    s_waitcnt vmcnt(3)
ce_83:
    v_max3_u32 v208, v176, v177, v178
    v_max3_u32 v208, v208, v179, v180
    v_max3_u32 v208, v208, v181, v182
    v_max_u32 v208, v208, v183
    v_cmp_eq_u32 s[82:83], -1, v208
    v_min3_f32 v209, v184, v187, v188
    v_min3_f32 v209, v209, v191, v192
    v_min3_f32 v209, v209, v195, v196
    v_min_f32 v209, v209, v199
    v_cmp_neq_f32 vcc, 0x41000000, v209
    s_nop 0
    s_or_b64 vcc, vcc, s[82:83]
    s_cbranch_vccnz rd_84
rc_85:
    v_mul_f32 v208, 0x3acccccd, v185
    v_mul_f32 v209, 0x3acccccd, v189
    v_mul_f32 v186, 0x3acccccd, v186
    v_mul_f32 v190, 0x3acccccd, v190
    v_fma_f32 v186, -v208, v208, v186
    v_fma_f32 v190, -v209, v209, v190
    v_max_f32 v186, 0, v186
    v_max_f32 v190, 0, v190
    v_add_f32 v186, 0x3727c5ac, v186
    v_add_f32 v190, 0x3727c5ac, v190
    v_rsq_f32 v185, v186
    v_rsq_f32 v189, v190
    v_mul_f32 v186, -v208, v185
    v_mul_f32 v190, -v209, v189
    v_lshlrev_b32 v80, 16, v176
    v_and_b32 v82, 0xffff0000, v176
    v_lshlrev_b32 v84, 16, v177
    v_and_b32 v86, 0xffff0000, v177
    v_lshlrev_b32 v81, 16, v178
    v_and_b32 v83, 0xffff0000, v178
    v_lshlrev_b32 v85, 16, v179
    v_and_b32 v87, 0xffff0000, v179
    v_fma_f32 v208, v80, v185, v186
    v_fma_f32 v209, v81, v189, v190
    v_cvt_pk_bf16_f32 v176, v208, v209
    v_fma_f32 v208, v82, v185, v186
    v_fma_f32 v209, v83, v189, v190
    v_cvt_pk_bf16_f32 v177, v208, v209
    v_fma_f32 v208, v84, v185, v186
    v_fma_f32 v209, v85, v189, v190
    v_cvt_pk_bf16_f32 v178, v208, v209
    v_fma_f32 v208, v86, v185, v186
    v_fma_f32 v209, v87, v189, v190
    v_cvt_pk_bf16_f32 v179, v208, v209
    ds_write_b32 v63, v176 offset:0
    ds_write_b32 v63, v177 offset:4864
    ds_write_b32 v63, v178 offset:9728
    ds_write_b32 v63, v179 offset:14592
    v_mul_f32 v208, 0x3acccccd, v193
    v_mul_f32 v209, 0x3acccccd, v197
    v_mul_f32 v194, 0x3acccccd, v194
    v_mul_f32 v198, 0x3acccccd, v198
    v_fma_f32 v194, -v208, v208, v194
    v_fma_f32 v198, -v209, v209, v198
    v_max_f32 v194, 0, v194
    v_max_f32 v198, 0, v198
    v_add_f32 v194, 0x3727c5ac, v194
    v_add_f32 v198, 0x3727c5ac, v198
    v_rsq_f32 v193, v194
    v_rsq_f32 v197, v198
    v_mul_f32 v194, -v208, v193
    v_mul_f32 v198, -v209, v197
    v_lshlrev_b32 v88, 16, v180
    v_and_b32 v90, 0xffff0000, v180
    v_lshlrev_b32 v92, 16, v181
    v_and_b32 v94, 0xffff0000, v181
    v_lshlrev_b32 v89, 16, v182
    v_and_b32 v91, 0xffff0000, v182
    v_lshlrev_b32 v93, 16, v183
    v_and_b32 v95, 0xffff0000, v183
    v_fma_f32 v208, v88, v193, v194
    v_fma_f32 v209, v89, v197, v198
    v_cvt_pk_bf16_f32 v180, v208, v209
    v_fma_f32 v208, v90, v193, v194
    v_fma_f32 v209, v91, v197, v198
    v_cvt_pk_bf16_f32 v181, v208, v209
    v_fma_f32 v208, v92, v193, v194
    v_fma_f32 v209, v93, v197, v198
    v_cvt_pk_bf16_f32 v182, v208, v209
    v_fma_f32 v208, v94, v193, v194
    v_fma_f32 v209, v95, v197, v198
    v_cvt_pk_bf16_f32 v183, v208, v209
    ds_write_b32 v63, v180 offset:256
    ds_write_b32 v63, v181 offset:5120
    ds_write_b32 v63, v182 offset:9984
    ds_write_b32 v63, v183 offset:14848
    s_waitcnt lgkmcnt(0)
    s_barrier
    ds_read_b128 v[212:215], v64 offset:96
    ds_read_b128 v[216:219], v64 offset:64
    ds_read_b128 v[220:223], v64 offset:32
    ds_read_b128 v[224:227], v64 offset:0
    s_waitcnt lgkmcnt(3)
    v_mfma_f32_32x32x16_bf16 v[96:111], v[212:215], v[144:147], 0
    ds_read_b128 v[228:231], v64 offset:224
    ds_read_b64_tr_b16 v[176:177], v65 offset:1056
    ds_read_b64_tr_b16 v[178:179], v65 offset:1024
    ds_read_b64_tr_b16 v[180:181], v65 offset:1184
    ds_read_b64_tr_b16 v[182:183], v65 offset:1152
    s_waitcnt lgkmcnt(7)
    v_mfma_f32_32x32x16_bf16 v[96:111], v[216:219], v[148:151], v[96:111]
    ds_read_b128 v[232:235], v64 offset:192
    ds_read_b64_tr_b16 v[184:185], v65 offset:1312
    ds_read_b64_tr_b16 v[186:187], v65 offset:1280
    ds_read_b64_tr_b16 v[188:189], v65 offset:1440
    ds_read_b64_tr_b16 v[190:191], v65 offset:1408
    s_waitcnt lgkmcnt(11)
    v_mfma_f32_32x32x16_bf16 v[96:111], v[220:223], v[152:155], v[96:111]
    ds_read_b128 v[236:239], v64 offset:160
    ds_read_b64_tr_b16 v[192:193], v65 offset:1568
    ds_read_b64_tr_b16 v[194:195], v65 offset:1536
    ds_read_b64_tr_b16 v[196:197], v65 offset:1696
    ds_read_b64_tr_b16 v[198:199], v65 offset:1664
    s_waitcnt lgkmcnt(15)
    v_mfma_f32_32x32x16_bf16 v[96:111], v[224:227], v[156:159], v[96:111]
    ds_read_b128 v[240:243], v64 offset:128
    ds_read_b64_tr_b16 v[200:201], v65 offset:1824
    ds_read_b64_tr_b16 v[202:203], v65 offset:1792
    ds_read_b64_tr_b16 v[204:205], v65 offset:1952
    ds_read_b64_tr_b16 v[206:207], v65 offset:1920
    s_waitcnt lgkmcnt(15)
    v_mfma_f32_32x32x16_bf16 v[112:127], v[228:231], v[144:147], 0
    s_nop 4
    s_waitcnt lgkmcnt(14)
    v_mfma_f32_32x32x16_bf16 v[112:127], v[232:235], v[148:151], v[112:127]
    v_cndmask_b32 v208, v99, v72, s[76:77]
    v_cndmask_b32 v209, v103, v99, s[76:77]
    v_cndmask_b32 v210, v107, v103, s[76:77]
    v_cndmask_b32 v211, v111, v107, s[76:77]
    v_mov_b32_e64 v72, v111
    s_waitcnt lgkmcnt(9)
    v_mfma_f32_32x32x16_bf16 v[112:127], v[236:239], v[152:155], v[112:127]
    v_add_f32_dpp v98, v208, v98 wave_ror:1 row_mask:0xf bank_mask:0xf
    v_add_f32_dpp v102, v209, v102 wave_ror:1 row_mask:0xf bank_mask:0xf
    v_add_f32_dpp v106, v210, v106 wave_ror:1 row_mask:0xf bank_mask:0xf
    v_add_f32_dpp v110, v211, v110 wave_ror:1 row_mask:0xf bank_mask:0xf
    v_cndmask_b32 v208, v98, v71, s[76:77]
    s_waitcnt lgkmcnt(4)
    v_mfma_f32_32x32x16_bf16 v[112:127], v[240:243], v[156:159], v[112:127]
    v_cndmask_b32 v209, v102, v98, s[76:77]
    v_cndmask_b32 v210, v106, v102, s[76:77]
    v_cndmask_b32 v211, v110, v106, s[76:77]
    v_mov_b32 v71, v110
    v_add_f32_dpp v97, v208, v97 wave_ror:1 row_mask:0xf bank_mask:0xf
    v_add_f32_dpp v101, v209, v101 wave_ror:1 row_mask:0xf bank_mask:0xf
    v_mfma_f32_32x32x16_bf16 v[112:127], v[212:215], v[160:163], v[112:127]
    ds_read_b128 v[244:247], v64 offset:352
    v_add_f32_dpp v105, v210, v105 wave_ror:1 row_mask:0xf bank_mask:0xf
    v_add_f32_dpp v109, v211, v109 wave_ror:1 row_mask:0xf bank_mask:0xf
    v_cndmask_b32 v208, v97, v70, s[76:77]
    v_cndmask_b32 v209, v101, v97, s[76:77]
    v_cndmask_b32 v210, v105, v101, s[76:77]
    v_mfma_f32_32x32x16_bf16 v[112:127], v[216:219], v[164:167], v[112:127]
    ds_read_b128 v[216:219], v64 offset:320
    v_cndmask_b32 v211, v109, v105, s[76:77]
    v_mov_b32_e64 v70, v109
    v_add_f32_dpp v96, v208, v96 wave_ror:1 row_mask:0xf bank_mask:0xf
    v_add_f32_dpp v100, v209, v100 wave_ror:1 row_mask:0xf bank_mask:0xf
    v_add_f32_dpp v104, v210, v104 wave_ror:1 row_mask:0xf bank_mask:0xf
    v_mfma_f32_32x32x16_bf16 v[112:127], v[220:223], v[168:171], v[112:127]
    ds_read_b128 v[220:223], v64 offset:288
    v_add_f32_dpp v108, v211, v108 wave_ror:1 row_mask:0xf bank_mask:0xf
    ds_write_b32 v66, v96 offset:0
    v_mfma_f32_32x32x16_bf16 v[112:127], v[224:227], v[172:175], v[112:127]
    ds_read_b128 v[224:227], v64 offset:256
    ds_write_b32 v66, v100 offset:64
    ds_write_b32 v66, v104 offset:128
    s_waitcnt lgkmcnt(6)
    v_mfma_f32_32x32x16_bf16 v[128:143], v[244:247], v[144:147], 0
    ds_write_b32 v66, v108 offset:192
    s_nop 2
    s_waitcnt lgkmcnt(6)
    v_mfma_f32_32x32x16_bf16 v[128:143], v[216:219], v[148:151], v[128:143]
    s_nop 2
    v_cndmask_b32 v208, v115, v72, s[76:77]
    v_cndmask_b32 v209, v119, v115, s[76:77]
    s_waitcnt lgkmcnt(5)
    v_mfma_f32_32x32x16_bf16 v[128:143], v[220:223], v[152:155], v[128:143]
    v_cndmask_b32 v210, v123, v119, s[76:77]
    v_cndmask_b32 v211, v127, v123, s[76:77]
    v_mov_b32 v72, v127
    v_add_f32_dpp v114, v208, v114 wave_ror:1 row_mask:0xf bank_mask:0xf
    v_add_f32_dpp v118, v209, v118 wave_ror:1 row_mask:0xf bank_mask:0xf
    s_waitcnt lgkmcnt(3)
    v_mfma_f32_32x32x16_bf16 v[128:143], v[224:227], v[156:159], v[128:143]
    v_add_f32_dpp v122, v210, v122 wave_ror:1 row_mask:0xf bank_mask:0xf
    v_add_f32_dpp v126, v211, v126 wave_ror:1 row_mask:0xf bank_mask:0xf
    v_cndmask_b32 v208, v114, v71, s[76:77]
    v_cndmask_b32 v209, v118, v114, s[76:77]
    v_cndmask_b32 v210, v122, v118, s[76:77]
    v_cndmask_b32 v211, v126, v122, s[76:77]
    v_mfma_f32_32x32x16_bf16 v[128:143], v[228:231], v[160:163], v[128:143]
    v_mov_b32 v71, v126
    v_add_f32_dpp v113, v208, v113 wave_ror:1 row_mask:0xf bank_mask:0xf
    v_add_f32_dpp v117, v209, v117 wave_ror:1 row_mask:0xf bank_mask:0xf
    v_add_f32_dpp v121, v210, v121 wave_ror:1 row_mask:0xf bank_mask:0xf
    v_add_f32_dpp v125, v211, v125 wave_ror:1 row_mask:0xf bank_mask:0xf
    v_cndmask_b32 v208, v113, v70, s[76:77]
    v_mfma_f32_32x32x16_bf16 v[128:143], v[232:235], v[164:167], v[128:143]
    ds_read_b128 v[232:235], v64 offset:64
    v_cndmask_b32 v209, v117, v113, s[76:77]
    v_cndmask_b32 v210, v121, v117, s[76:77]
    v_cndmask_b32 v211, v125, v121, s[76:77]
    v_mov_b32_e64 v70, v125
    v_add_f32_dpp v112, v208, v112 wave_ror:1 row_mask:0xf bank_mask:0xf
    v_mfma_f32_32x32x16_bf16 v[128:143], v[236:239], v[168:171], v[128:143]
    ds_read_b128 v[236:239], v64 offset:32
    v_add_f32_dpp v116, v209, v116 wave_ror:1 row_mask:0xf bank_mask:0xf
    v_add_f32_dpp v120, v210, v120 wave_ror:1 row_mask:0xf bank_mask:0xf
    v_add_f32_dpp v124, v211, v124 wave_ror:1 row_mask:0xf bank_mask:0xf
    v_mfma_f32_32x32x16_bf16 v[128:143], v[240:243], v[172:175], v[128:143]
    ds_read_b128 v[240:243], v64 offset:0
    ds_write_b32 v66, v112 offset:256
    ds_write_b32 v66, v116 offset:320
    v_mfma_f32_32x32x16_bf16 v[128:143], v[212:215], v[176:179], v[128:143]
    ds_read_b128 v[212:215], v64 offset:480
    ds_write_b32 v66, v120 offset:384
    ds_write_b32 v66, v124 offset:448
    s_waitcnt lgkmcnt(7)
    v_mfma_f32_32x32x16_bf16 v[128:143], v[232:235], v[180:183], v[128:143]
    ds_read_b128 v[232:235], v64 offset:448
    s_waitcnt lgkmcnt(7)
    v_mfma_f32_32x32x16_bf16 v[128:143], v[236:239], v[184:187], v[128:143]
    ds_read_b128 v[236:239], v64 offset:416
    s_waitcnt lgkmcnt(7)
    v_mfma_f32_32x32x16_bf16 v[128:143], v[240:243], v[188:191], v[128:143]
    ds_read_b128 v[240:243], v64 offset:384
    s_nop 3
    s_waitcnt lgkmcnt(5)
    v_mfma_f32_32x32x16_bf16 v[112:127], v[212:215], v[144:147], 0
    s_nop 4
    s_waitcnt lgkmcnt(2)
    v_mfma_f32_32x32x16_bf16 v[112:127], v[232:235], v[148:151], v[112:127]
    v_cndmask_b32 v208, v131, v72, s[76:77]
    v_cndmask_b32 v209, v135, v131, s[76:77]
    v_cndmask_b32 v210, v139, v135, s[76:77]
    v_cndmask_b32 v211, v143, v139, s[76:77]
    v_mov_b32_e64 v72, v143
    s_waitcnt lgkmcnt(1)
    v_mfma_f32_32x32x16_bf16 v[112:127], v[236:239], v[152:155], v[112:127]
    v_add_f32_dpp v130, v208, v130 wave_ror:1 row_mask:0xf bank_mask:0xf
    v_add_f32_dpp v134, v209, v134 wave_ror:1 row_mask:0xf bank_mask:0xf
    v_add_f32_dpp v138, v210, v138 wave_ror:1 row_mask:0xf bank_mask:0xf
    v_add_f32_dpp v142, v211, v142 wave_ror:1 row_mask:0xf bank_mask:0xf
    v_cndmask_b32 v208, v130, v71, s[76:77]
    s_waitcnt lgkmcnt(0)
    v_mfma_f32_32x32x16_bf16 v[112:127], v[240:243], v[156:159], v[112:127]
    v_cndmask_b32 v209, v134, v130, s[76:77]
    v_cndmask_b32 v210, v138, v134, s[76:77]
    v_cndmask_b32 v211, v142, v138, s[76:77]
    v_mov_b32 v71, v142
    v_add_f32_dpp v129, v208, v129 wave_ror:1 row_mask:0xf bank_mask:0xf
    v_add_f32_dpp v133, v209, v133 wave_ror:1 row_mask:0xf bank_mask:0xf
    v_mfma_f32_32x32x16_bf16 v[112:127], v[244:247], v[160:163], v[112:127]
    v_add_f32_dpp v137, v210, v137 wave_ror:1 row_mask:0xf bank_mask:0xf
    v_add_f32_dpp v141, v211, v141 wave_ror:1 row_mask:0xf bank_mask:0xf
    v_cndmask_b32 v208, v129, v70, s[76:77]
    v_cndmask_b32 v209, v133, v129, s[76:77]
    v_cndmask_b32 v210, v137, v133, s[76:77]
    v_cndmask_b32 v211, v141, v137, s[76:77]
    v_mfma_f32_32x32x16_bf16 v[112:127], v[216:219], v[164:167], v[112:127]
    ds_read_b128 v[240:243], v64 offset:192
    v_mov_b32_e64 v70, v141
    v_add_f32_dpp v128, v208, v128 wave_ror:1 row_mask:0xf bank_mask:0xf
    v_add_f32_dpp v132, v209, v132 wave_ror:1 row_mask:0xf bank_mask:0xf
    v_add_f32_dpp v136, v210, v136 wave_ror:1 row_mask:0xf bank_mask:0xf
    v_add_f32_dpp v140, v211, v140 wave_ror:1 row_mask:0xf bank_mask:0xf
    v_mfma_f32_32x32x16_bf16 v[112:127], v[220:223], v[168:171], v[112:127]
    ds_read_b128 v[220:223], v64 offset:160
    ds_write_b32 v66, v128 offset:512
    ds_write_b32 v66, v132 offset:576
    v_mfma_f32_32x32x16_bf16 v[112:127], v[224:227], v[172:175], v[112:127]
    ds_read_b128 v[224:227], v64 offset:128
    ds_write_b32 v66, v136 offset:640
    ds_write_b32 v66, v140 offset:704
    v_mfma_f32_32x32x16_bf16 v[112:127], v[228:231], v[176:179], v[112:127]
    ds_read_b128 v[236:239], v64 offset:96
    s_waitcnt lgkmcnt(7)
    v_mfma_f32_32x32x16_bf16 v[112:127], v[240:243], v[180:183], v[112:127]
    ds_read_b128 v[240:243], v64 offset:64
    s_waitcnt lgkmcnt(7)
    v_mfma_f32_32x32x16_bf16 v[112:127], v[220:223], v[184:187], v[112:127]
    ds_read_b128 v[220:223], v64 offset:32
    s_waitcnt lgkmcnt(5)
    v_mfma_f32_32x32x16_bf16 v[112:127], v[224:227], v[188:191], v[112:127]
    ds_read_b128 v[224:227], v64 offset:0
    s_waitcnt lgkmcnt(3)
    v_mfma_f32_32x32x16_bf16 v[112:127], v[236:239], v[192:195], v[112:127]
    ds_read_b64_tr_b16 v[216:217], v65 offset:544
    ds_read_b64_tr_b16 v[218:219], v65 offset:512
    s_waitcnt lgkmcnt(4)
    v_mfma_f32_32x32x16_bf16 v[112:127], v[240:243], v[196:199], v[112:127]
    ds_read_b64_tr_b16 v[240:241], v65 offset:1056
    ds_read_b64_tr_b16 v[242:243], v65 offset:1024
    s_waitcnt lgkmcnt(5)
    v_mfma_f32_32x32x16_bf16 v[112:127], v[220:223], v[200:203], v[112:127]
    s_waitcnt lgkmcnt(4)
    v_mfma_f32_32x32x16_bf16 v[112:127], v[224:227], v[204:207], v[112:127]
    ds_read_b64_tr_b16 v[224:225], v65 offset:1568
    ds_read_b64_tr_b16 v[226:227], v65 offset:1536
    s_lshl_b32 s96, s75, 14
    s_add_u32 s96, s96, 14680064
    s_lshl_b32 s97, s24, 12
    s_add_u32 s97, s97, 3510272
    buffer_load_dwordx4 v[248:251], v62, s[16:19], s96 offen offset:2048 sc1
    s_waitcnt lgkmcnt(4)
    v_mfma_f32_32x32x16_bf16 v[144:159], v[212:215], v[216:219], 0
    s_nop 3
    v_cndmask_b32 v208, v115, v72, s[76:77]
    s_waitcnt lgkmcnt(2)
    v_mfma_f32_32x32x16_bf16 v[144:159], v[244:247], v[240:243], v[144:159]
    buffer_load_dwordx4 v[252:255], v62, s[16:19], s96 offen offset:3072 sc1
    v_cndmask_b32 v209, v119, v115, s[76:77]
    v_cndmask_b32 v210, v123, v119, s[76:77]
    v_cndmask_b32 v211, v127, v123, s[76:77]
    v_mov_b32_e64 v72, v127
    v_add_f32_dpp v114, v208, v114 wave_ror:1 row_mask:0xf bank_mask:0xf
    v_mfma_f32_32x32x16_bf16 v[160:175], v[212:215], v[240:243], 0
    ds_read_b64_tr_b16 v[216:217], v65 offset:2080
    ds_read_b64_tr_b16 v[218:219], v65 offset:2048
    v_add_f32_dpp v118, v209, v118 wave_ror:1 row_mask:0xf bank_mask:0xf
    v_add_f32_dpp v122, v210, v122 wave_ror:1 row_mask:0xf bank_mask:0xf
    v_add_f32_dpp v126, v211, v126 wave_ror:1 row_mask:0xf bank_mask:0xf
    s_waitcnt lgkmcnt(2)
    v_mfma_f32_32x32x16_bf16 v[144:159], v[228:231], v[224:227], v[144:159]
    buffer_load_dwordx4 v[96:99], v62, s[16:19], s97 offen offset:0 sc1
    v_cndmask_b32 v208, v114, v71, s[76:77]
    v_cndmask_b32 v209, v118, v114, s[76:77]
    v_cndmask_b32 v210, v122, v118, s[76:77]
    v_cndmask_b32 v211, v126, v122, s[76:77]
    v_mov_b32 v71, v126
    v_mfma_f32_32x32x16_bf16 v[160:175], v[244:247], v[224:227], v[160:175]
    v_add_f32_dpp v113, v208, v113 wave_ror:1 row_mask:0xf bank_mask:0xf
    v_add_f32_dpp v117, v209, v117 wave_ror:1 row_mask:0xf bank_mask:0xf
    v_add_f32_dpp v121, v210, v121 wave_ror:1 row_mask:0xf bank_mask:0xf
    v_add_f32_dpp v125, v211, v125 wave_ror:1 row_mask:0xf bank_mask:0xf
    v_cndmask_b32 v208, v113, v70, s[76:77]
    v_cndmask_b32 v209, v117, v113, s[76:77]
    v_mfma_f32_32x32x16_bf16 v[176:191], v[212:215], v[224:227], 0
    buffer_load_dwordx4 v[100:103], v62, s[16:19], s97 offen offset:1024 sc1
    v_cndmask_b32 v210, v121, v117, s[76:77]
    v_cndmask_b32 v211, v125, v121, s[76:77]
    v_mov_b32 v70, v125
    v_add_f32_dpp v112, v208, v112 wave_ror:1 row_mask:0xf bank_mask:0xf
    s_waitcnt lgkmcnt(0)
    v_mfma_f32_32x32x16_bf16 v[144:159], v[236:239], v[216:219], v[144:159]
    ds_read_b64_tr_b16 v[240:241], v65 offset:2592
    ds_read_b64_tr_b16 v[242:243], v65 offset:2560
    v_add_f32_dpp v116, v209, v116 wave_ror:1 row_mask:0xf bank_mask:0xf
    v_add_f32_dpp v120, v210, v120 wave_ror:1 row_mask:0xf bank_mask:0xf
    v_add_f32_dpp v124, v211, v124 wave_ror:1 row_mask:0xf bank_mask:0xf
    v_mfma_f32_32x32x16_bf16 v[160:175], v[228:231], v[216:219], v[160:175]
    buffer_load_dwordx4 v[104:107], v62, s[16:19], s97 offen offset:2048 sc1
    ds_write_b32 v66, v112 offset:768
    ds_write_b32 v66, v116 offset:832
    v_mfma_f32_32x32x16_bf16 v[176:191], v[244:247], v[216:219], v[176:191]
    ds_write_b32 v66, v120 offset:896
    ds_write_b32 v66, v124 offset:960
    v_mfma_f32_32x32x16_bf16 v[192:207], v[212:215], v[216:219], 0
    ds_read_b64_tr_b16 v[212:213], v65 offset:3104
    ds_read_b64_tr_b16 v[214:215], v65 offset:3072
    buffer_load_dwordx4 v[108:111], v62, s[16:19], s97 offen offset:3072 sc1
    s_waitcnt lgkmcnt(6)
    v_mfma_f32_32x32x16_bf16 v[160:175], v[236:239], v[240:243], v[160:175]
    v_mfma_f32_32x32x16_bf16 v[176:191], v[228:231], v[240:243], v[176:191]
    ds_read_b64_tr_b16 v[224:225], v65 offset:3616
    ds_read_b64_tr_b16 v[226:227], v65 offset:3584
    s_waitcnt lgkmcnt(4)
    s_barrier
    v_mfma_f32_32x32x16_bf16 v[192:207], v[244:247], v[240:243], v[192:207]
    ds_read_b64_tr_b16 v[244:245], v65 offset:672
    ds_read_b64_tr_b16 v[246:247], v65 offset:640
    ds_read_b64 v[112:113], v67 offset:0
    ds_read_b64 v[114:115], v67 offset:4224
    ds_read_b64 v[116:117], v67 offset:8448
    s_waitcnt lgkmcnt(7)
    v_mfma_f32_32x32x16_bf16 v[176:191], v[236:239], v[212:215], v[176:191]
    ds_read_b128 v[216:219], v64 offset:320
    ds_read_b64_tr_b16 v[240:241], v65 offset:1184
    ds_read_b64_tr_b16 v[242:243], v65 offset:1152
    ds_read_b64 v[118:119], v67 offset:12672
    ds_read_b64 v[120:121], v67 offset:512
    ds_read_b64 v[122:123], v67 offset:4736
    v_mfma_f32_32x32x16_bf16 v[192:207], v[228:231], v[212:215], v[192:207]
    ds_read_b64 v[124:125], v67 offset:8960
    ds_read_b64 v[126:127], v67 offset:13184
    s_waitcnt lgkmcnt(13)
    v_mfma_f32_32x32x16_bf16 v[192:207], v[236:239], v[224:227], v[192:207]
    ds_read_b128 v[228:231], v64 offset:192
    ds_read_b64_tr_b16 v[236:237], v65 offset:1696
    ds_read_b64_tr_b16 v[238:239], v65 offset:1664
    s_waitcnt lgkmcnt(14)
    v_mfma_f32_32x32x16_bf16 v[144:159], v[232:235], v[244:247], v[144:159]
    s_waitcnt lgkmcnt(8)
    v_mfma_f32_32x32x16_bf16 v[144:159], v[216:219], v[240:243], v[144:159]
    v_mfma_f32_32x32x16_bf16 v[160:175], v[232:235], v[240:243], v[160:175]
    ds_read_b128 v[212:215], v64 offset:64
    ds_read_b64_tr_b16 v[224:225], v65 offset:2208
    ds_read_b64_tr_b16 v[226:227], v65 offset:2176
    s_waitcnt lgkmcnt(6)
    v_add_f32 v112, v112, v80
    s_waitcnt lgkmcnt(3)
    v_mfma_f32_32x32x16_bf16 v[144:159], v[228:231], v[236:239], v[144:159]
    v_add_f32 v113, v113, v81
    v_add_f32 v114, v114, v82
    v_add_f32 v115, v115, v83
    v_add_f32 v116, v116, v84
    v_add_f32 v117, v117, v85
    v_add_f32 v118, v118, v86
    v_mfma_f32_32x32x16_bf16 v[160:175], v[216:219], v[236:239], v[160:175]
    v_add_f32_e64 v119, v119, v87
    v_cvt_pk_bf16_f32 v128, v112, v114
    v_cvt_pk_bf16_f32 v129, v116, v118
    v_cvt_pk_bf16_f32 v130, v113, v115
    v_cvt_pk_bf16_f32 v131, v117, v119
    s_mov_b32 s25, 0
    v_mfma_f32_32x32x16_bf16 v[176:191], v[232:235], v[236:239], v[176:191]
    buffer_store_dwordx2 v[128:129], v68, s[20:23], s25 offen
    s_mov_b32 s25, 5120
    buffer_store_dwordx2 v[130:131], v68, s[20:23], s25 offen
    v_add_f32 v120, v120, v88
    v_add_f32 v121, v121, v89
    s_waitcnt lgkmcnt(0)
    v_mfma_f32_32x32x16_bf16 v[144:159], v[212:215], v[224:227], v[144:159]
    ds_read_b64_tr_b16 v[244:245], v65 offset:2720
    ds_read_b64_tr_b16 v[246:247], v65 offset:2688
    v_add_f32 v122, v122, v90
    v_add_f32 v123, v123, v91
    v_add_f32 v124, v124, v92
    v_add_f32 v125, v125, v93
    v_mfma_f32_32x32x16_bf16 v[160:175], v[228:231], v[224:227], v[160:175]
    v_add_f32 v126, v126, v94
    v_add_f32 v127, v127, v95
    v_cvt_pk_bf16_f32 v132, v120, v122
    v_cvt_pk_bf16_f32 v133, v124, v126
    v_cvt_pk_bf16_f32 v134, v121, v123
    v_cvt_pk_bf16_f32 v135, v125, v127
    v_mfma_f32_32x32x16_bf16 v[176:191], v[216:219], v[224:227], v[176:191]
    s_mov_b32 s25, 655360
    buffer_store_dwordx2 v[132:133], v68, s[20:23], s25 offen
    s_mov_b32 s25, 660480
    buffer_store_dwordx2 v[134:135], v68, s[20:23], s25 offen
    ds_read_b64_tr_b16 v[112:113], v65 offset:32
    ds_read_b64_tr_b16 v[114:115], v65 offset:0
    v_mfma_f32_32x32x16_bf16 v[192:207], v[232:235], v[224:227], v[192:207]
    ds_read_b64_tr_b16 v[232:233], v65 offset:3232
    ds_read_b64_tr_b16 v[234:235], v65 offset:3200
    ds_read_b64_tr_b16 v[116:117], v65 offset:160
    ds_read_b64_tr_b16 v[118:119], v65 offset:128
    ds_read_b64_tr_b16 v[120:121], v65 offset:288
    s_waitcnt lgkmcnt(7)
    v_mfma_f32_32x32x16_bf16 v[160:175], v[212:215], v[244:247], v[160:175]
    ds_read_b64_tr_b16 v[122:123], v65 offset:256
    ds_read_b64_tr_b16 v[124:125], v65 offset:416
    ds_read_b64_tr_b16 v[126:127], v65 offset:384
    ds_read_b64_tr_b16 v[128:129], v65 offset:544
    ds_read_b64_tr_b16 v[130:131], v65 offset:512
    ds_read_b64_tr_b16 v[132:133], v65 offset:672
    v_mfma_f32_32x32x16_bf16 v[176:191], v[228:231], v[244:247], v[176:191]
    ds_read_b64_tr_b16 v[240:241], v65 offset:3744
    ds_read_b64_tr_b16 v[242:243], v65 offset:3712
    ds_read_b64_tr_b16 v[134:135], v65 offset:640
    ds_read_b64_tr_b16 v[136:137], v65 offset:800
    ds_read_b64_tr_b16 v[138:139], v65 offset:768
    ds_read_b64_tr_b16 v[140:141], v65 offset:928
    v_mfma_f32_32x32x16_bf16 v[192:207], v[216:219], v[244:247], v[192:207]
    ds_read_b128 v[216:219], v64 offset:416
    ds_read_b64_tr_b16 v[236:237], v65 offset:800
    ds_read_b64_tr_b16 v[238:239], v65 offset:768
    ds_read_b64_tr_b16 v[142:143], v65 offset:896
    s_waitcnt lgkmcnt(15)
    v_mfma_f32_32x32x16_bf16 v[176:191], v[212:215], v[232:235], v[176:191]
    ds_read_b128 v[224:227], v64 offset:288
    ds_read_b64_tr_b16 v[244:245], v65 offset:1312
    ds_read_b64_tr_b16 v[246:247], v65 offset:1280
    s_waitcnt vmcnt(4)
ce_86:
    v_max3_u32 v208, v248, v249, v250
    v_max3_u32 v208, v208, v251, v252
    v_max3_u32 v208, v208, v253, v254
    v_max_u32 v208, v208, v255
    v_cmp_eq_u32 s[82:83], -1, v208
    v_min3_f32 v209, v96, v99, v100
    v_min3_f32 v209, v209, v103, v104
    v_min3_f32 v209, v209, v107, v108
    v_min_f32 v209, v209, v111
    v_cmp_neq_f32 vcc, 0x41000000, v209
    s_nop 0
    s_or_b64 vcc, vcc, s[82:83]
    s_cbranch_vccnz rd_87
rc_88:
    v_mfma_f32_32x32x16_bf16 v[192:207], v[228:231], v[232:235], v[192:207]
    v_mul_f32 v208, 0x3acccccd, v97
    v_mul_f32 v209, 0x3acccccd, v101
    v_mul_f32 v98, 0x3acccccd, v98
    v_mul_f32 v102, 0x3acccccd, v102
    v_fma_f32 v98, -v208, v208, v98
    s_waitcnt lgkmcnt(11)
    v_mfma_f32_32x32x16_bf16 v[192:207], v[212:215], v[240:243], v[192:207]
    ds_read_b128 v[228:231], v64 offset:160
    ds_read_b64_tr_b16 v[212:213], v65 offset:1824
    ds_read_b64_tr_b16 v[214:215], v65 offset:1792
    v_fma_f32 v102, -v209, v209, v102
    v_max_f32 v98, 0, v98
    s_waitcnt lgkmcnt(7)
    v_mfma_f32_32x32x16_bf16 v[144:159], v[216:219], v[236:239], v[144:159]
    v_max_f32 v102, 0, v102
    v_add_f32 v98, 0x3727c5ac, v98
    v_add_f32 v102, 0x3727c5ac, v102
    v_rsq_f32 v97, v98
    s_waitcnt lgkmcnt(3)
    v_mfma_f32_32x32x16_bf16 v[144:159], v[224:227], v[244:247], v[144:159]
    v_rsq_f32_e64 v101, v102
    v_mul_f32 v98, -v208, v97
    v_mul_f32 v102, -v209, v101
    v_lshlrev_b32_e64 v80, 16, v248
    v_and_b32 v82, 0xffff0000, v248
    v_mfma_f32_32x32x16_bf16 v[160:175], v[216:219], v[244:247], v[160:175]
    ds_read_b64_tr_b16 v[232:233], v65 offset:2336
    ds_read_b64_tr_b16 v[234:235], v65 offset:2304
    v_lshlrev_b32 v84, 16, v249
    v_and_b32 v86, 0xffff0000, v249
    v_lshlrev_b32_e64 v81, 16, v250
    s_waitcnt lgkmcnt(2)
    v_mfma_f32_32x32x16_bf16 v[144:159], v[228:231], v[212:215], v[144:159]
    v_and_b32 v83, 0xffff0000, v250
    v_lshlrev_b32_e64 v85, 16, v251
    v_and_b32 v87, 0xffff0000, v251
    v_fma_f32 v208, v80, v97, v98
    v_fma_f32 v209, v81, v101, v102
    v_cvt_pk_bf16_f32 v248, v208, v209
    v_mfma_f32_32x32x16_bf16 v[160:175], v[224:227], v[212:215], v[160:175]
    v_fma_f32 v208, v82, v97, v98
    v_fma_f32 v209, v83, v101, v102
    v_cvt_pk_bf16_f32 v249, v208, v209
    v_fma_f32 v208, v84, v97, v98
    v_fma_f32 v209, v85, v101, v102
    v_cvt_pk_bf16_f32 v250, v208, v209
    v_mfma_f32_32x32x16_bf16 v[176:191], v[216:219], v[212:215], v[176:191]
    v_fma_f32 v208, v86, v97, v98
    v_fma_f32 v209, v87, v101, v102
    v_cvt_pk_bf16_f32 v251, v208, v209
    s_waitcnt lgkmcnt(0)
    v_mfma_f32_32x32x16_bf16 v[144:159], v[220:223], v[232:235], v[144:159]
    ds_read_b64_tr_b16 v[240:241], v65 offset:2848
    ds_read_b64_tr_b16 v[242:243], v65 offset:2816
    ds_write_b32 v63, v248 offset:512
    ds_write_b32 v63, v249 offset:5376
    v_mfma_f32_32x32x16_bf16 v[160:175], v[228:231], v[232:235], v[160:175]
    ds_write_b32 v63, v250 offset:10240
    ds_write_b32 v63, v251 offset:15104
    v_mul_f32 v208, 0x3acccccd, v105
    v_mul_f32 v209, 0x3acccccd, v109
    v_mfma_f32_32x32x16_bf16 v[176:191], v[224:227], v[232:235], v[176:191]
    v_mul_f32 v106, 0x3acccccd, v106
    v_mul_f32 v110, 0x3acccccd, v110
    v_fma_f32 v106, -v208, v208, v106
    v_fma_f32 v110, -v209, v209, v110
    v_max_f32 v106, 0, v106
    v_max_f32_e64 v110, 0, v110
    v_mfma_f32_32x32x16_bf16 v[192:207], v[216:219], v[232:235], v[192:207]
    ds_read_b64_tr_b16 v[216:217], v65 offset:3360
    ds_read_b64_tr_b16 v[218:219], v65 offset:3328
    v_add_f32 v106, 0x3727c5ac, v106
    v_add_f32 v110, 0x3727c5ac, v110
    s_waitcnt lgkmcnt(6)
    v_mfma_f32_32x32x16_bf16 v[160:175], v[220:223], v[240:243], v[160:175]
    v_rsq_f32 v105, v106
    v_rsq_f32_e64 v109, v110
    v_mul_f32 v106, -v208, v105
    v_mul_f32 v110, -v209, v109
    v_mfma_f32_32x32x16_bf16 v[176:191], v[228:231], v[240:243], v[176:191]
    ds_read_b64_tr_b16 v[236:237], v65 offset:3872
    ds_read_b64_tr_b16 v[238:239], v65 offset:3840
    v_lshlrev_b32 v88, 16, v252
    v_and_b32 v90, 0xffff0000, v252
    v_lshlrev_b32 v92, 16, v253
    v_and_b32 v94, 0xffff0000, v253
    v_mfma_f32_32x32x16_bf16 v[192:207], v[224:227], v[240:243], v[192:207]
    ds_read_b128 v[224:227], v64 offset:384
    ds_read_b64_tr_b16 v[244:245], v65 offset:928
    ds_read_b64_tr_b16 v[246:247], v65 offset:896
    v_lshlrev_b32 v89, 16, v254
    v_and_b32 v91, 0xffff0000, v254
    s_waitcnt lgkmcnt(5)
    v_mfma_f32_32x32x16_bf16 v[176:191], v[220:223], v[216:219], v[176:191]
    ds_read_b128 v[212:215], v64 offset:256
    ds_read_b64_tr_b16 v[232:233], v65 offset:1440
    ds_read_b64_tr_b16 v[234:235], v65 offset:1408
    v_lshlrev_b32_e64 v93, 16, v255
    v_and_b32 v95, 0xffff0000, v255
    v_fma_f32 v208, v88, v105, v106
    v_mfma_f32_32x32x16_bf16 v[192:207], v[228:231], v[216:219], v[192:207]
    v_fma_f32 v209, v89, v109, v110
    v_cvt_pk_bf16_f32 v252, v208, v209
    v_fma_f32 v208, v90, v105, v106
    v_fma_f32 v209, v91, v109, v110
    v_cvt_pk_bf16_f32 v253, v208, v209
    s_waitcnt lgkmcnt(6)
    v_mfma_f32_32x32x16_bf16 v[192:207], v[220:223], v[236:239], v[192:207]
    ds_read_b128 v[220:223], v64 offset:128
    ds_read_b64_tr_b16 v[228:229], v65 offset:1952
    ds_read_b64_tr_b16 v[230:231], v65 offset:1920
    v_fma_f32 v208, v92, v105, v106
    v_fma_f32 v209, v93, v109, v110
    s_waitcnt lgkmcnt(6)
    v_mfma_f32_32x32x16_bf16 v[144:159], v[224:227], v[244:247], v[144:159]
    v_cvt_pk_bf16_f32 v254, v208, v209
    v_fma_f32 v208, v94, v105, v106
    v_fma_f32 v209, v95, v109, v110
    v_cvt_pk_bf16_f32 v255, v208, v209
    s_waitcnt lgkmcnt(3)
    v_mfma_f32_32x32x16_bf16 v[144:159], v[212:215], v[232:235], v[144:159]
    ds_write_b32 v63, v252 offset:768
    ds_write_b32 v63, v253 offset:5632
    ds_write_b32 v63, v254 offset:10496
    v_mfma_f32_32x32x16_bf16 v[160:175], v[224:227], v[232:235], v[160:175]
    ds_read_b128 v[240:243], v64 offset:0
    ds_read_b64_tr_b16 v[216:217], v65 offset:2464
    ds_read_b64_tr_b16 v[218:219], v65 offset:2432
    ds_write_b32 v63, v255 offset:15360
    s_waitcnt lgkmcnt(7)
    v_mfma_f32_32x32x16_bf16 v[144:159], v[220:223], v[228:231], v[144:159]
    v_mfma_f32_32x32x16_bf16 v[160:175], v[212:215], v[228:231], v[160:175]
    v_mfma_f32_32x32x16_bf16 v[176:191], v[224:227], v[228:231], v[176:191]
    s_waitcnt lgkmcnt(1)
    v_mfma_f32_32x32x16_bf16 v[144:159], v[240:243], v[216:219], v[144:159]
    ds_read_b64_tr_b16 v[236:237], v65 offset:2976
    ds_read_b64_tr_b16 v[238:239], v65 offset:2944
    v_mfma_f32_32x32x16_bf16 v[160:175], v[220:223], v[216:219], v[160:175]
    v_mfma_f32_32x32x16_bf16 v[176:191], v[212:215], v[216:219], v[176:191]
    v_mfma_f32_32x32x16_bf16 v[192:207], v[224:227], v[216:219], v[192:207]
    ds_read_b64_tr_b16 v[224:225], v65 offset:3488
    ds_read_b64_tr_b16 v[226:227], v65 offset:3456
    s_waitcnt lgkmcnt(2)
    v_mfma_f32_32x32x16_bf16 v[160:175], v[240:243], v[236:239], v[160:175]
    v_mfma_f32_32x32x16_bf16 v[176:191], v[220:223], v[236:239], v[176:191]
    ds_read_b64_tr_b16 v[244:245], v65 offset:4000
    ds_read_b64_tr_b16 v[246:247], v65 offset:3968
    v_mfma_f32_32x32x16_bf16 v[192:207], v[212:215], v[236:239], v[192:207]
    s_waitcnt lgkmcnt(2)
    v_mfma_f32_32x32x16_bf16 v[176:191], v[240:243], v[224:227], v[176:191]
    v_mfma_f32_32x32x16_bf16 v[192:207], v[220:223], v[224:227], v[192:207]
    s_waitcnt lgkmcnt(0)
    v_mfma_f32_32x32x16_bf16 v[192:207], v[240:243], v[244:247], v[192:207]
    s_waitcnt lgkmcnt(0)
    s_barrier
    ds_read_b128 v[212:215], v64 offset:608
    ds_read_b128 v[216:219], v64 offset:576
    ds_read_b128 v[220:223], v64 offset:544
    ds_read_b128 v[224:227], v64 offset:512
    s_waitcnt lgkmcnt(3)
    v_mfma_f32_32x32x16_bf16 v[144:159], v[212:215], v[112:115], v[144:159]
    ds_read_b128 v[228:231], v64 offset:736
    s_waitcnt lgkmcnt(3)
    v_mfma_f32_32x32x16_bf16 v[144:159], v[216:219], v[116:119], v[144:159]
    ds_read_b128 v[232:235], v64 offset:704
    s_waitcnt lgkmcnt(3)
    v_mfma_f32_32x32x16_bf16 v[144:159], v[220:223], v[120:123], v[144:159]
    ds_read_b128 v[236:239], v64 offset:672
    s_waitcnt lgkmcnt(3)
    v_mfma_f32_32x32x16_bf16 v[144:159], v[224:227], v[124:127], v[144:159]
    ds_read_b128 v[240:243], v64 offset:640
    s_nop 3
    s_waitcnt lgkmcnt(3)
    v_mfma_f32_32x32x16_bf16 v[160:175], v[228:231], v[112:115], v[160:175]
    s_nop 4
    s_waitcnt lgkmcnt(2)
    v_mfma_f32_32x32x16_bf16 v[160:175], v[232:235], v[116:119], v[160:175]
    v_cndmask_b32 v208, v147, v72, s[76:77]
    v_cndmask_b32 v209, v151, v147, s[76:77]
    v_cndmask_b32 v210, v155, v151, s[76:77]
    v_cndmask_b32 v211, v159, v155, s[76:77]
    v_mov_b32 v72, v159
    s_waitcnt lgkmcnt(1)
    v_mfma_f32_32x32x16_bf16 v[160:175], v[236:239], v[120:123], v[160:175]
    v_add_f32_dpp v146, v208, v146 wave_ror:1 row_mask:0xf bank_mask:0xf
    v_add_f32_dpp v150, v209, v150 wave_ror:1 row_mask:0xf bank_mask:0xf
    v_add_f32_dpp v154, v210, v154 wave_ror:1 row_mask:0xf bank_mask:0xf
    v_add_f32_dpp v158, v211, v158 wave_ror:1 row_mask:0xf bank_mask:0xf
    v_cndmask_b32 v208, v146, v71, s[76:77]
    s_waitcnt lgkmcnt(0)
    v_mfma_f32_32x32x16_bf16 v[160:175], v[240:243], v[124:127], v[160:175]
    v_cndmask_b32 v209, v150, v146, s[76:77]
    v_cndmask_b32 v210, v154, v150, s[76:77]
    v_cndmask_b32 v211, v158, v154, s[76:77]
    v_mov_b32 v71, v158
    v_add_f32_dpp v145, v208, v145 wave_ror:1 row_mask:0xf bank_mask:0xf
    v_add_f32_dpp v149, v209, v149 wave_ror:1 row_mask:0xf bank_mask:0xf
    v_mfma_f32_32x32x16_bf16 v[160:175], v[212:215], v[128:131], v[160:175]
    ds_read_b128 v[244:247], v64 offset:864
    v_add_f32_dpp v153, v210, v153 wave_ror:1 row_mask:0xf bank_mask:0xf
    v_add_f32_dpp v157, v211, v157 wave_ror:1 row_mask:0xf bank_mask:0xf
    v_cndmask_b32 v208, v145, v70, s[76:77]
    v_cndmask_b32 v209, v149, v145, s[76:77]
    v_cndmask_b32 v210, v153, v149, s[76:77]
    v_mfma_f32_32x32x16_bf16 v[160:175], v[216:219], v[132:135], v[160:175]
    ds_read_b128 v[248:251], v64 offset:832
    v_cndmask_b32 v211, v157, v153, s[76:77]
    v_mov_b32_e64 v70, v157
    v_add_f32_dpp v144, v208, v144 wave_ror:1 row_mask:0xf bank_mask:0xf
    v_add_f32_dpp v148, v209, v148 wave_ror:1 row_mask:0xf bank_mask:0xf
    v_add_f32_dpp v152, v210, v152 wave_ror:1 row_mask:0xf bank_mask:0xf
    v_mfma_f32_32x32x16_bf16 v[160:175], v[220:223], v[136:139], v[160:175]
    ds_read_b128 v[252:255], v64 offset:800
    v_add_f32_dpp v156, v211, v156 wave_ror:1 row_mask:0xf bank_mask:0xf
    ds_write_b32 v66, v144 offset:0
    v_mfma_f32_32x32x16_bf16 v[160:175], v[224:227], v[140:143], v[160:175]
    ds_read_b128 v[224:227], v64 offset:768
    ds_write_b32 v66, v148 offset:64
    ds_write_b32 v66, v152 offset:128
    s_waitcnt lgkmcnt(6)
    v_mfma_f32_32x32x16_bf16 v[176:191], v[244:247], v[112:115], v[176:191]
    ds_write_b32 v66, v156 offset:192
    s_nop 2
    s_waitcnt lgkmcnt(6)
    v_mfma_f32_32x32x16_bf16 v[176:191], v[248:251], v[116:119], v[176:191]
    s_nop 2
    v_cndmask_b32 v208, v163, v72, s[76:77]
    v_cndmask_b32 v209, v167, v163, s[76:77]
    s_waitcnt lgkmcnt(5)
    v_mfma_f32_32x32x16_bf16 v[176:191], v[252:255], v[120:123], v[176:191]
    v_cndmask_b32 v210, v171, v167, s[76:77]
    v_cndmask_b32 v211, v175, v171, s[76:77]
    v_mov_b32 v72, v175
    v_add_f32_dpp v162, v208, v162 wave_ror:1 row_mask:0xf bank_mask:0xf
    v_add_f32_dpp v166, v209, v166 wave_ror:1 row_mask:0xf bank_mask:0xf
    s_waitcnt lgkmcnt(3)
    v_mfma_f32_32x32x16_bf16 v[176:191], v[224:227], v[124:127], v[176:191]
    v_add_f32_dpp v170, v210, v170 wave_ror:1 row_mask:0xf bank_mask:0xf
    v_add_f32_dpp v174, v211, v174 wave_ror:1 row_mask:0xf bank_mask:0xf
    v_cndmask_b32 v208, v162, v71, s[76:77]
    v_cndmask_b32 v209, v166, v162, s[76:77]
    v_cndmask_b32 v210, v170, v166, s[76:77]
    v_cndmask_b32 v211, v174, v170, s[76:77]
    v_mfma_f32_32x32x16_bf16 v[176:191], v[228:231], v[128:131], v[176:191]
    ds_read_b64_tr_b16 v[228:229], v65 offset:1056
    ds_read_b64_tr_b16 v[230:231], v65 offset:1024
    v_mov_b32 v71, v174
    v_add_f32_dpp v161, v208, v161 wave_ror:1 row_mask:0xf bank_mask:0xf
    v_add_f32_dpp v165, v209, v165 wave_ror:1 row_mask:0xf bank_mask:0xf
    v_add_f32_dpp v169, v210, v169 wave_ror:1 row_mask:0xf bank_mask:0xf
    v_mfma_f32_32x32x16_bf16 v[176:191], v[232:235], v[132:135], v[176:191]
    ds_read_b64_tr_b16 v[232:233], v65 offset:1184
    ds_read_b64_tr_b16 v[234:235], v65 offset:1152
    v_add_f32_dpp v173, v211, v173 wave_ror:1 row_mask:0xf bank_mask:0xf
    v_cndmask_b32 v208, v161, v70, s[76:77]
    v_cndmask_b32 v209, v165, v161, s[76:77]
    v_cndmask_b32 v210, v169, v165, s[76:77]
    v_mfma_f32_32x32x16_bf16 v[176:191], v[236:239], v[136:139], v[176:191]
    ds_read_b64_tr_b16 v[236:237], v65 offset:1312
    ds_read_b64_tr_b16 v[238:239], v65 offset:1280
    v_cndmask_b32 v211, v173, v169, s[76:77]
    v_mov_b32_e64 v70, v173
    v_add_f32_dpp v160, v208, v160 wave_ror:1 row_mask:0xf bank_mask:0xf
    v_add_f32_dpp v164, v209, v164 wave_ror:1 row_mask:0xf bank_mask:0xf
    v_mfma_f32_32x32x16_bf16 v[176:191], v[240:243], v[140:143], v[176:191]
    ds_read_b128 v[240:243], v64 offset:512
    ds_read_b64_tr_b16 v[224:225], v65 offset:1440
    ds_read_b64_tr_b16 v[226:227], v65 offset:1408
    v_add_f32_dpp v168, v210, v168 wave_ror:1 row_mask:0xf bank_mask:0xf
    v_add_f32_dpp v172, v211, v172 wave_ror:1 row_mask:0xf bank_mask:0xf
    s_waitcnt lgkmcnt(7)
    v_mfma_f32_32x32x16_bf16 v[176:191], v[212:215], v[228:231], v[176:191]
    ds_read_b128 v[212:215], v64 offset:992
    ds_write_b32 v66, v160 offset:256
    ds_write_b32 v66, v164 offset:320
    s_waitcnt lgkmcnt(8)
    v_mfma_f32_32x32x16_bf16 v[176:191], v[216:219], v[232:235], v[176:191]
    ds_read_b128 v[216:219], v64 offset:960
    ds_write_b32 v66, v168 offset:384
    ds_write_b32 v66, v172 offset:448
    s_waitcnt lgkmcnt(9)
    v_mfma_f32_32x32x16_bf16 v[176:191], v[220:223], v[236:239], v[176:191]
    ds_read_b128 v[220:223], v64 offset:928
    s_waitcnt lgkmcnt(7)
    v_mfma_f32_32x32x16_bf16 v[176:191], v[240:243], v[224:227], v[176:191]
    ds_read_b128 v[240:243], v64 offset:896
    s_waitcnt lgkmcnt(2)
    s_barrier
    v_mfma_f32_32x32x16_bf16 v[192:207], v[212:215], v[112:115], v[192:207]
    ds_read_b64 v[144:145], v67 offset:0
    ds_read_b64 v[146:147], v67 offset:4224
    ds_read_b64 v[148:149], v67 offset:8448
    ds_read_b64 v[150:151], v67 offset:12672
    s_nop 0
    v_mfma_f32_32x32x16_bf16 v[192:207], v[216:219], v[116:119], v[192:207]
    s_nop 2
    v_cndmask_b32 v208, v179, v72, s[76:77]
    v_cndmask_b32 v209, v183, v179, s[76:77]
    s_waitcnt lgkmcnt(5)
    v_mfma_f32_32x32x16_bf16 v[192:207], v[220:223], v[120:123], v[192:207]
    v_cndmask_b32 v210, v187, v183, s[76:77]
    v_cndmask_b32 v211, v191, v187, s[76:77]
    v_mov_b32 v72, v191
    v_add_f32_dpp v178, v208, v178 wave_ror:1 row_mask:0xf bank_mask:0xf
    v_add_f32_dpp v182, v209, v182 wave_ror:1 row_mask:0xf bank_mask:0xf
    s_waitcnt lgkmcnt(4)
    v_mfma_f32_32x32x16_bf16 v[192:207], v[240:243], v[124:127], v[192:207]
    ds_read_b128 v[212:215], v64 offset:768
    v_add_f32_dpp v186, v210, v186 wave_ror:1 row_mask:0xf bank_mask:0xf
    v_add_f32_dpp v190, v211, v190 wave_ror:1 row_mask:0xf bank_mask:0xf
    v_cndmask_b32 v208, v178, v71, s[76:77]
    v_cndmask_b32 v209, v182, v178, s[76:77]
    v_cndmask_b32 v210, v186, v182, s[76:77]
    v_mfma_f32_32x32x16_bf16 v[192:207], v[244:247], v[128:131], v[192:207]
    ds_read_b128 v[244:247], v64 offset:736
    v_cndmask_b32 v211, v190, v186, s[76:77]
    v_mov_b32 v71, v190
    v_add_f32_dpp v177, v208, v177 wave_ror:1 row_mask:0xf bank_mask:0xf
    v_add_f32_dpp v181, v209, v181 wave_ror:1 row_mask:0xf bank_mask:0xf
    v_add_f32_dpp v185, v210, v185 wave_ror:1 row_mask:0xf bank_mask:0xf
    v_mfma_f32_32x32x16_bf16 v[192:207], v[248:251], v[132:135], v[192:207]
    ds_read_b128 v[248:251], v64 offset:704
    v_add_f32_dpp v189, v211, v189 wave_ror:1 row_mask:0xf bank_mask:0xf
    v_cndmask_b32 v208, v177, v70, s[76:77]
    v_cndmask_b32 v209, v181, v177, s[76:77]
    v_cndmask_b32 v210, v185, v181, s[76:77]
    v_cndmask_b32 v211, v189, v185, s[76:77]
    v_mfma_f32_32x32x16_bf16 v[192:207], v[252:255], v[136:139], v[192:207]
    ds_read_b128 v[252:255], v64 offset:672
    v_mov_b32_e64 v70, v189
    v_add_f32_dpp v176, v208, v176 wave_ror:1 row_mask:0xf bank_mask:0xf
    v_add_f32_dpp v180, v209, v180 wave_ror:1 row_mask:0xf bank_mask:0xf
    v_add_f32_dpp v184, v210, v184 wave_ror:1 row_mask:0xf bank_mask:0xf
    s_waitcnt lgkmcnt(3)
    v_mfma_f32_32x32x16_bf16 v[192:207], v[212:215], v[140:143], v[192:207]
    ds_read_b128 v[216:219], v64 offset:640
    v_add_f32_dpp v188, v211, v188 wave_ror:1 row_mask:0xf bank_mask:0xf
    s_waitcnt lgkmcnt(3)
    v_mfma_f32_32x32x16_bf16 v[192:207], v[244:247], v[228:231], v[192:207]
    ds_read_b128 v[228:231], v64 offset:608
    ds_read_b64_tr_b16 v[220:221], v65 offset:1568
    ds_read_b64_tr_b16 v[222:223], v65 offset:1536
    ds_write_b32 v66, v176 offset:512
    s_waitcnt lgkmcnt(6)
    v_mfma_f32_32x32x16_bf16 v[192:207], v[248:251], v[232:235], v[192:207]
    ds_read_b128 v[232:235], v64 offset:576
    ds_read_b64_tr_b16 v[240:241], v65 offset:1696
    ds_read_b64_tr_b16 v[242:243], v65 offset:1664
    ds_write_b32 v66, v180 offset:576
    s_waitcnt lgkmcnt(9)
    v_mfma_f32_32x32x16_bf16 v[192:207], v[252:255], v[236:239], v[192:207]
    ds_read_b128 v[236:239], v64 offset:544
    ds_read_b64_tr_b16 v[212:213], v65 offset:1824
    ds_read_b64_tr_b16 v[214:215], v65 offset:1792
    ds_write_b32 v66, v184 offset:640
    s_waitcnt lgkmcnt(12)
    v_mfma_f32_32x32x16_bf16 v[192:207], v[216:219], v[224:227], v[192:207]
    ds_read_b128 v[224:227], v64 offset:512
    ds_read_b64_tr_b16 v[244:245], v65 offset:1952
    ds_read_b64_tr_b16 v[246:247], v65 offset:1920
    ds_write_b32 v66, v188 offset:704
    s_waitcnt lgkmcnt(13)
    v_mfma_f32_32x32x16_bf16 v[192:207], v[228:231], v[220:223], v[192:207]
    v_add_f32 v144, v144, v80
    v_add_f32 v145, v145, v81
    v_add_f32 v146, v146, v82
    v_add_f32 v147, v147, v83
    s_waitcnt lgkmcnt(9)
    v_mfma_f32_32x32x16_bf16 v[192:207], v[232:235], v[240:243], v[192:207]
    v_add_f32 v148, v148, v84
    v_add_f32 v149, v149, v85
    v_add_f32 v150, v150, v86
    v_add_f32 v151, v151, v87
    v_cvt_pk_bf16_f32 v160, v144, v146
    s_waitcnt lgkmcnt(5)
    v_mfma_f32_32x32x16_bf16 v[192:207], v[236:239], v[212:215], v[192:207]
    v_cvt_pk_bf16_f32 v161, v148, v150
    v_cvt_pk_bf16_f32 v162, v145, v147
    v_cvt_pk_bf16_f32 v163, v149, v151
    s_mov_b32 s25, 1310720
    s_waitcnt lgkmcnt(1)
    v_mfma_f32_32x32x16_bf16 v[192:207], v[224:227], v[244:247], v[192:207]
    buffer_store_dwordx2 v[160:161], v68, s[20:23], s25 offen
    s_mov_b32 s25, 1315840
    buffer_store_dwordx2 v[162:163], v68, s[20:23], s25 offen
    s_nop 8
    v_cndmask_b32 v208, v195, v72, s[76:77]
    v_cndmask_b32 v209, v199, v195, s[76:77]
    v_cndmask_b32 v210, v203, v199, s[76:77]
    v_cndmask_b32 v211, v207, v203, s[76:77]
    v_mov_b32_e64 v72, v207
    v_add_f32_dpp v194, v208, v194 wave_ror:1 row_mask:0xf bank_mask:0xf
    v_add_f32_dpp v198, v209, v198 wave_ror:1 row_mask:0xf bank_mask:0xf
    v_add_f32_dpp v202, v210, v202 wave_ror:1 row_mask:0xf bank_mask:0xf
    v_add_f32_dpp v206, v211, v206 wave_ror:1 row_mask:0xf bank_mask:0xf
    v_cndmask_b32 v208, v194, v71, s[76:77]
    v_cndmask_b32 v209, v198, v194, s[76:77]
    v_cndmask_b32 v210, v202, v198, s[76:77]
    v_cndmask_b32 v211, v206, v202, s[76:77]
    v_mov_b32_e64 v71, v206
    v_add_f32_dpp v193, v208, v193 wave_ror:1 row_mask:0xf bank_mask:0xf
    v_add_f32_dpp v197, v209, v197 wave_ror:1 row_mask:0xf bank_mask:0xf
    v_add_f32_dpp v201, v210, v201 wave_ror:1 row_mask:0xf bank_mask:0xf
    v_add_f32_dpp v205, v211, v205 wave_ror:1 row_mask:0xf bank_mask:0xf
    v_cndmask_b32 v208, v193, v70, s[76:77]
    v_cndmask_b32 v209, v197, v193, s[76:77]
    v_cndmask_b32 v210, v201, v197, s[76:77]
    v_cndmask_b32 v211, v205, v201, s[76:77]
    v_mov_b32_e64 v70, v205
    v_add_f32_dpp v192, v208, v192 wave_ror:1 row_mask:0xf bank_mask:0xf
    v_add_f32_dpp v196, v209, v196 wave_ror:1 row_mask:0xf bank_mask:0xf
    v_add_f32_dpp v200, v210, v200 wave_ror:1 row_mask:0xf bank_mask:0xf
    v_add_f32_dpp v204, v211, v204 wave_ror:1 row_mask:0xf bank_mask:0xf
    ds_write_b32 v66, v192 offset:768
    ds_write_b32 v66, v196 offset:832
    ds_write_b32 v66, v200 offset:896
    ds_write_b32 v66, v204 offset:960
    s_waitcnt lgkmcnt(0)
    s_barrier
    ds_read_b64 v[152:153], v67 offset:512
    ds_read_b64 v[154:155], v67 offset:4736
    ds_read_b64 v[156:157], v67 offset:8960
    ds_read_b64 v[158:159], v67 offset:13184
    s_waitcnt lgkmcnt(0)
    v_add_f32 v152, v152, v88
    v_add_f32 v153, v153, v89
    v_add_f32 v154, v154, v90
    v_add_f32 v155, v155, v91
    v_add_f32 v156, v156, v92
    v_add_f32 v157, v157, v93
    v_add_f32 v158, v158, v94
    v_add_f32_e64 v159, v159, v95
    v_cvt_pk_bf16_f32 v164, v152, v154
    v_cvt_pk_bf16_f32 v165, v156, v158
    v_cvt_pk_bf16_f32 v166, v153, v155
    v_cvt_pk_bf16_f32 v167, v157, v159
    s_mov_b32 s25, 1966080
    buffer_store_dwordx2 v[164:165], v68, s[20:23], s25 offen
    s_mov_b32 s25, 1971200
    buffer_store_dwordx2 v[166:167], v68, s[20:23], s25 offen
    s_branch ec_82
nc_81:
ec_82:
L_end:
    s_endpgm
ps_5:
    s_mov_b32 s84, 1048576
pl_6:
    global_load_dword v7, v5, s[66:67] sc1
    s_waitcnt vmcnt(0)
    s_sub_u32 s84, s84, 1
    s_cbranch_scc1 pc_7
    v_cmp_gt_u32_e64 vcc, 1, v7
    s_nop 0
    s_and_b64 vcc, vcc, s[50:51]
    s_and_b64 vcc, vcc, 1
    s_cbranch_scc1 pl_6
    s_branch pc_7
ps_8:
    s_mov_b32 s84, 1048576
pl_9:
    buffer_load_dword v7, v4, s[16:19], s87 offen offset:0 sc1
    s_waitcnt vmcnt(0)
    s_sub_u32 s84, s84, 1
    s_cbranch_scc1 pc_10
    v_cmp_gt_u32 vcc, 32, v7
    s_nop 0
    s_and_b64 vcc, vcc, s[50:51]
    s_cbranch_scc1 pl_9
    s_branch pc_10
ps_11:
    s_mov_b32 s84, 1048576
pl_12:
    global_load_dword v7, v5, s[66:67] sc1
    s_waitcnt vmcnt(0)
    s_sub_u32 s84, s84, 1
    s_cbranch_scc1 pc_13
    v_cmp_gt_u32_e64 vcc, 1, v7
    s_nop 0
    s_and_b64 vcc, vcc, s[50:51]
    s_and_b64 vcc, vcc, 1
    s_cbranch_scc1 pl_12
    s_branch pc_13
ps_14:
    s_mov_b32 s84, 1048576
pl_15:
    buffer_load_dword v7, v4, s[16:19], s87 offen offset:0 sc1
    s_waitcnt vmcnt(0)
    s_sub_u32 s84, s84, 1
    s_cbranch_scc1 pc_16
    v_cmp_gt_u32 vcc, 32, v7
    s_nop 0
    s_and_b64 vcc, vcc, s[50:51]
    s_cbranch_scc1 pl_15
    s_branch pc_16
ps_17:
    s_mov_b32 s84, 1048576
pl_18:
    buffer_load_dword v7, v4, s[16:19], s89 offen offset:8 sc1
    s_waitcnt vmcnt(0)
    s_sub_u32 s84, s84, 1
    s_cbranch_scc1 pc_19
    v_cmp_gt_u32_e64 vcc, 32, v7
    s_nop 0
    s_and_b64 vcc, vcc, s[50:51]
    s_cbranch_scc1 pl_18
    s_branch pc_19
rd_21:
    s_cmp_eq_u32 s38, 0
    s_cbranch_scc1 rc_22
    s_sub_u32 s38, s38, 1
    s_nop 7
    s_nop 7
    s_sleep 4
    s_mov_b64 exec, vcc
    s_mov_b32 s96, 4194304
    buffer_load_dwordx4 v[216:219], v56, s[16:19], s96 offen offset:0 sc1
    buffer_load_dwordx4 v[220:223], v56, s[16:19], s96 offen offset:256 sc1
    s_mov_b32 s96, 4227072
    buffer_load_dwordx4 v[224:227], v56, s[16:19], s96 offen offset:0 sc1
    buffer_load_dwordx4 v[228:231], v56, s[16:19], s96 offen offset:256 sc1
    s_mov_b32 s96, 4259840
    buffer_load_dwordx4 v[232:235], v56, s[16:19], s96 offen offset:0 sc1
    buffer_load_dwordx4 v[236:239], v56, s[16:19], s96 offen offset:256 sc1
    s_mov_b32 s96, 4292608
    buffer_load_dwordx4 v[240:243], v56, s[16:19], s96 offen offset:0 sc1
    buffer_load_dwordx4 v[244:247], v56, s[16:19], s96 offen offset:256 sc1
    s_mov_b32 s96, 4194304
    buffer_load_dwordx2 v[248:249], v57, s[16:19], s96 offen offset:0 sc1
    buffer_load_dwordx2 v[252:253], v57, s[16:19], s96 offen offset:128 sc1
    s_mov_b32 s96, 4210688
    buffer_load_dwordx2 v[250:251], v57, s[16:19], s96 offen offset:0 sc1
    buffer_load_dwordx2 v[254:255], v57, s[16:19], s96 offen offset:128 sc1
    s_mov_b32 s96, 0
    s_mov_b32 s97, 5120
    s_waitcnt vmcnt(16)
    buffer_load_dwordx2 v[208:209], v60, s[4:7], s96 offen
    s_waitcnt vmcnt(16)
    buffer_load_dwordx2 v[210:211], v60, s[4:7], s97 offen
    s_waitcnt vmcnt(16)
    v_lshrrev_b32_e64 v212, 5, v1
    v_mul_u32_u24 v212, 5104, v212
    v_bfe_u32 v213, v1, 4, 1
    v_lshlrev_b32 v213, 2, v213
    v_sub_u32 v212, v212, v213
    v_add_u32 v212, v212, v60
    s_mul_i32 s97, s24, 24
    s_sub_u32 s97, 128, s97
    buffer_load_dword v212, v212, s[4:7], s97 offen
    s_mov_b64 exec, -1
    s_waitcnt vmcnt(0) lgkmcnt(0)
    s_branch oe_20
rd_24:
    s_cmp_eq_u32 s38, 0
    s_cbranch_scc1 rc_25
    s_sub_u32 s38, s38, 1
    s_nop 7
    s_nop 7
    s_sleep 4
    s_mov_b64 exec, vcc
    s_mov_b32 s96, 4198400
    buffer_load_dwordx4 v[216:219], v56, s[16:19], s96 offen offset:0 sc1
    buffer_load_dwordx4 v[220:223], v56, s[16:19], s96 offen offset:256 sc1
    s_mov_b32 s96, 4231168
    buffer_load_dwordx4 v[224:227], v56, s[16:19], s96 offen offset:0 sc1
    buffer_load_dwordx4 v[228:231], v56, s[16:19], s96 offen offset:256 sc1
    s_mov_b32 s96, 4263936
    buffer_load_dwordx4 v[232:235], v56, s[16:19], s96 offen offset:0 sc1
    buffer_load_dwordx4 v[236:239], v56, s[16:19], s96 offen offset:256 sc1
    s_mov_b32 s96, 4296704
    buffer_load_dwordx4 v[240:243], v56, s[16:19], s96 offen offset:0 sc1
    buffer_load_dwordx4 v[244:247], v56, s[16:19], s96 offen offset:256 sc1
    s_mov_b32 s96, 4196352
    buffer_load_dwordx2 v[248:249], v57, s[16:19], s96 offen offset:0 sc1
    buffer_load_dwordx2 v[252:253], v57, s[16:19], s96 offen offset:128 sc1
    s_mov_b32 s96, 4212736
    buffer_load_dwordx2 v[250:251], v57, s[16:19], s96 offen offset:0 sc1
    buffer_load_dwordx2 v[254:255], v57, s[16:19], s96 offen offset:128 sc1
    s_mov_b32 s96, 1310720
    s_mov_b32 s97, 1315840
    s_waitcnt vmcnt(15)
    buffer_load_dwordx2 v[208:209], v60, s[4:7], s96 offen
    s_waitcnt vmcnt(15)
    buffer_load_dwordx2 v[210:211], v60, s[4:7], s97 offen
    s_waitcnt vmcnt(15)
    v_lshrrev_b32 v212, 5, v1
    v_mul_u32_u24 v212, 5104, v212
    v_bfe_u32 v213, v1, 4, 1
    v_lshlrev_b32 v213, 2, v213
    v_sub_u32 v212, v212, v213
    v_add_u32 v212, v212, v60
    s_mul_i32 s97, s24, 24
    s_sub_u32 s97, 1310848, s97
    buffer_load_dword v212, v212, s[4:7], s97 offen
    s_mov_b64 exec, -1
    s_waitcnt vmcnt(0) lgkmcnt(0)
    s_branch oe_23
rd_29:
    s_cmp_eq_u32 s38, 0
    s_cbranch_scc1 rc_30
    s_sub_u32 s38, s38, 1
    s_nop 7
    s_nop 7
    s_sleep 4
    s_mov_b64 exec, vcc
    s_lshl_b32 s96, s75, 14
    s_add_u32 s96, s96, 6815744
    s_lshl_b32 s97, s24, 12
    s_add_u32 s97, s97, 3473408
    buffer_load_dwordx4 v[176:179], v62, s[16:19], s96 offen offset:0 sc1
    buffer_load_dwordx4 v[180:183], v62, s[16:19], s96 offen offset:1024 sc1
    buffer_load_dwordx4 v[184:187], v62, s[16:19], s97 offen offset:0 sc1
    buffer_load_dwordx4 v[188:191], v62, s[16:19], s97 offen offset:1024 sc1
    buffer_load_dwordx4 v[192:195], v62, s[16:19], s97 offen offset:2048 sc1
    buffer_load_dwordx4 v[196:199], v62, s[16:19], s97 offen offset:3072 sc1
    s_mov_b64 exec, -1
    s_waitcnt vmcnt(0) lgkmcnt(0)
    s_branch ce_28
rd_32:
    s_cmp_eq_u32 s38, 0
    s_cbranch_scc1 rc_33
    s_sub_u32 s38, s38, 1
    s_nop 7
    s_nop 7
    s_sleep 4
    s_mov_b64 exec, vcc
    s_lshl_b32 s96, s75, 14
    s_add_u32 s96, s96, 6815744
    s_lshl_b32 s97, s24, 12
    s_add_u32 s97, s97, 3477504
    buffer_load_dwordx4 v[248:251], v62, s[16:19], s96 offen offset:2048 sc1
    buffer_load_dwordx4 v[252:255], v62, s[16:19], s96 offen offset:3072 sc1
    buffer_load_dwordx4 v[96:99], v62, s[16:19], s97 offen offset:0 sc1
    buffer_load_dwordx4 v[100:103], v62, s[16:19], s97 offen offset:1024 sc1
    buffer_load_dwordx4 v[104:107], v62, s[16:19], s97 offen offset:2048 sc1
    buffer_load_dwordx4 v[108:111], v62, s[16:19], s97 offen offset:3072 sc1
    s_mov_b64 exec, -1
    s_waitcnt vmcnt(0) lgkmcnt(0)
    s_branch ce_31
gl_34:
    s_add_u32 s82, s86, 16384
    v_lshlrev_b32 v2, 10, v1
    v_mov_b32_e64 v5, 1
    s_mov_b64 exec, 255
    buffer_store_dword v5, v2, s[16:19], s82 offen offset:0 sc1
    s_mov_b64 exec, -1
    s_branch gc_35
ps_36:
    s_mov_b32 s84, 1048576
pl_37:
    buffer_load_dword v7, v4, s[16:19], s89 offen offset:0 sc1
    s_waitcnt vmcnt(0)
    s_sub_u32 s84, s84, 1
    s_cbranch_scc1 pc_38
    v_cmp_gt_u32 vcc, 1, v7
    s_nop 0
    s_and_b64 vcc, vcc, s[50:51]
    s_cbranch_scc1 pl_37
    s_branch pc_38
ps_39:
    s_mov_b32 s84, 1048576
pl_40:
    buffer_load_dword v7, v4, s[16:19], s87 offen offset:8 sc1
    s_waitcnt vmcnt(0)
    s_sub_u32 s84, s84, 1
    s_cbranch_scc1 pc_41
    v_cmp_gt_u32 vcc, 12, v7
    s_nop 0
    s_and_b64 vcc, vcc, s[50:51]
    s_cbranch_scc1 pl_40
    s_branch pc_41
gl_42:
    s_add_u32 s82, s86, 0
    v_lshlrev_b32 v2, 10, v1
    v_mov_b32_e64 v5, 1
    s_mov_b64 exec, 255
    buffer_store_dword v5, v2, s[16:19], s82 offen offset:12 sc1
    s_mov_b64 exec, -1
    s_branch gc_43
ps_44:
    s_mov_b32 s84, 1048576
pl_45:
    buffer_load_dword v7, v4, s[16:19], s89 offen offset:0 sc1
    s_waitcnt vmcnt(0)
    s_sub_u32 s84, s84, 1
    s_cbranch_scc1 pc_46
    v_cmp_gt_u32_e64 vcc, 1, v7
    s_nop 0
    s_and_b64 vcc, vcc, s[50:51]
    s_cbranch_scc1 pl_45
    s_branch pc_46
rd_49:
    s_cmp_eq_u32 s38, 0
    s_cbranch_scc1 rc_50
    s_sub_u32 s38, s38, 1
    s_nop 7
    s_nop 7
    s_sleep 4
    s_mov_b64 exec, vcc
    s_add_u32 s26, s3, 9437184
    buffer_load_dwordx4 v[216:219], v236, s[16:19], s26 offen sc1
    s_add_u32 s26, s26, 524288
    buffer_load_dwordx4 v[220:223], v236, s[16:19], s26 offen sc1
    s_add_u32 s26, s26, 524288
    buffer_load_dwordx4 v[224:227], v236, s[16:19], s26 offen sc1
    s_add_u32 s26, s26, 524288
    buffer_load_dwordx4 v[228:231], v236, s[16:19], s26 offen sc1
    s_add_u32 s26, s26, 524288
    buffer_load_dwordx4 v[232:235], v236, s[16:19], s26 offen sc1
    s_mov_b64 exec, -1
    s_waitcnt vmcnt(0) lgkmcnt(0)
    s_branch se_48
gl_52:
    s_add_u32 s82, s86, 16384
    v_lshlrev_b32 v2, 10, v1
    v_mov_b32_e64 v5, 1
    s_mov_b64 exec, 255
    buffer_store_dword v5, v2, s[16:19], s82 offen offset:4 sc1
    s_mov_b64 exec, -1
    s_branch gc_53
ps_54:
    s_mov_b32 s84, 1048576
pl_55:
    buffer_load_dword v7, v4, s[16:19], s87 offen offset:12 sc1
    s_waitcnt vmcnt(0)
    s_sub_u32 s84, s84, 1
    s_cbranch_scc1 pc_56
    v_cmp_gt_u32_e64 vcc, 1, v7
    s_nop 0
    s_and_b64 vcc, vcc, s[50:51]
    s_cbranch_scc1 pl_55
    s_branch pc_56
rd_58:
    s_cmp_eq_u32 s38, 0
    s_cbranch_scc1 rc_59
    s_sub_u32 s38, s38, 1
    s_nop 7
    s_nop 7
    s_sleep 4
    s_mov_b64 exec, vcc
    s_lshl_b32 s98, s72, 5
    s_add_u32 s98, s98, 0
    s_sub_u32 s95, s98, 4
    s_max_i32 s95, s95, 0
    s_lshl_b32 s94, s98, 3
    s_lshl_b32 s95, s95, 3
    s_add_u32 s94, s94, 3457024
    s_add_u32 s95, s95, 3457024
    s_add_u32 s96, s94, 8192
    buffer_load_dwordx2 v[152:153], v47, s[16:19], s94 offen sc1
    buffer_load_dwordx2 v[154:155], v47, s[16:19], s96 offen sc1
    buffer_load_dwordx2 v[156:157], v48, s[16:19], s95 offen sc1
    s_mov_b64 exec, -1
    s_waitcnt vmcnt(0) lgkmcnt(0)
    s_branch sl_57
ps_60:
    s_mov_b32 s84, 1048576
pl_61:
    buffer_load_dword v7, v4, s[16:19], s89 offen offset:4 sc1
    s_waitcnt vmcnt(0)
    s_sub_u32 s84, s84, 1
    s_cbranch_scc1 pc_62
    v_cmp_gt_u32 vcc, 1, v7
    s_nop 0
    s_and_b64 vcc, vcc, s[50:51]
    s_cbranch_scc1 pl_61
    s_branch pc_62
rd_65:
    s_cmp_eq_u32 s38, 0
    s_cbranch_scc1 rc_66
    s_sub_u32 s38, s38, 1
    s_nop 7
    s_nop 7
    s_sleep 4
    s_mov_b64 exec, vcc
    s_add_u32 s26, s3, 9437184
    buffer_load_dwordx4 v[216:219], v236, s[16:19], s26 offen sc1
    s_add_u32 s26, s26, 524288
    buffer_load_dwordx4 v[220:223], v236, s[16:19], s26 offen sc1
    s_add_u32 s26, s26, 524288
    buffer_load_dwordx4 v[224:227], v236, s[16:19], s26 offen sc1
    s_add_u32 s26, s26, 524288
    buffer_load_dwordx4 v[228:231], v236, s[16:19], s26 offen sc1
    s_add_u32 s26, s26, 524288
    buffer_load_dwordx4 v[232:235], v236, s[16:19], s26 offen sc1
    s_mov_b64 exec, -1
    s_waitcnt vmcnt(0) lgkmcnt(0)
    s_branch se_64
rd_67:
    s_cmp_eq_u32 s39, 0
    s_cbranch_scc1 rc_68
    s_sub_u32 s39, s39, 1
    s_nop 7
    s_nop 7
    s_waitcnt vmcnt(0) lgkmcnt(0)
    s_barrier
    s_lshl_b32 s25, s72, 5
    s_add_u32 s25, s25, 0
    s_sub_u32 s26, s25, 4
    s_max_i32 s26, s26, 0
    s_lshl_b32 s27, s71, 12
    s_add_u32 s27, s27, 9437184
    s_lshl_b32 s99, s25, 3
    s_lshl_b32 s100, s26, 3
    s_lshl_b32 s92, s24, 12
    s_lshl_b32 s93, s24, 9
    s_add_u32 s99, s99, s27
    s_add_u32 s100, s100, s27
    s_add_u32 m0, s92, 36352
    s_nop 0
    buffer_load_dwordx4 v73, s[16:19], s99 offen offset:0 sc1 lds
    buffer_load_dwordx4 v74, s[16:19], s99 offen offset:1024 sc1 lds
    buffer_load_dwordx4 v75, s[16:19], s99 offen offset:2048 sc1 lds
    buffer_load_dwordx4 v76, s[16:19], s99 offen offset:3072 sc1 lds
    s_add_u32 m0, s93, 53760
    s_add_u32 s99, s99, 524288
    s_mov_b64 exec, s[80:81]
    buffer_load_dwordx4 v77, s[16:19], s100 offen sc1 lds
    s_mov_b64 exec, -1
    s_add_u32 s100, s100, 524288
    s_add_u32 m0, s92, 55936
    s_nop 0
    s_nop 0
    buffer_load_dwordx4 v73, s[16:19], s99 offen offset:0 sc1 lds
    buffer_load_dwordx4 v74, s[16:19], s99 offen offset:1024 sc1 lds
    buffer_load_dwordx4 v75, s[16:19], s99 offen offset:2048 sc1 lds
    buffer_load_dwordx4 v76, s[16:19], s99 offen offset:3072 sc1 lds
    s_add_u32 m0, s93, 73344
    s_add_u32 s99, s99, 524288
    s_mov_b64 exec, s[80:81]
    buffer_load_dwordx4 v77, s[16:19], s100 offen sc1 lds
    s_mov_b64 exec, -1
    s_add_u32 s100, s100, 524288
    s_mov_b64 exec, -1
    s_waitcnt vmcnt(0) lgkmcnt(0)
    s_branch ge_51
rd_71:
    s_cmp_eq_u32 s38, 0
    s_cbranch_scc1 rc_72
    s_sub_u32 s38, s38, 1
    s_nop 7
    s_nop 7
    s_sleep 4
    s_mov_b64 exec, vcc
    s_lshl_b32 s98, s72, 5
    s_add_u32 s98, s98, 256
    s_sub_u32 s95, s98, 4
    s_max_i32 s95, s95, 0
    s_lshl_b32 s94, s98, 3
    s_lshl_b32 s95, s95, 3
    s_nop 0
    s_add_u32 s94, s94, 3457024
    s_add_u32 s95, s95, 3457024
    s_add_u32 s96, s94, 8192
    buffer_load_dwordx2 v[152:153], v47, s[16:19], s94 offen sc1
    buffer_load_dwordx2 v[154:155], v47, s[16:19], s96 offen sc1
    buffer_load_dwordx2 v[156:157], v48, s[16:19], s95 offen sc1
    s_mov_b64 exec, -1
    s_waitcnt vmcnt(0) lgkmcnt(0)
    s_branch sl_70
rd_73:
    s_cmp_eq_u32 s39, 0
    s_cbranch_scc1 rc_74
    s_sub_u32 s39, s39, 1
    s_nop 7
    s_nop 7
    s_waitcnt vmcnt(0) lgkmcnt(0)
    s_barrier
    s_lshl_b32 s25, s72, 5
    s_add_u32 s25, s25, 256
    s_sub_u32 s26, s25, 4
    s_max_i32 s26, s26, 0
    s_lshl_b32 s27, s71, 12
    s_add_u32 s27, s27, 9437184
    s_lshl_b32 s99, s25, 3
    s_lshl_b32 s100, s26, 3
    s_lshl_b32 s92, s24, 12
    s_lshl_b32 s93, s24, 9
    s_add_u32 s99, s99, s27
    s_add_u32 s100, s100, s27
    s_add_u32 m0, s92, 36352
    s_nop 0
    s_nop 0
    buffer_load_dwordx4 v73, s[16:19], s99 offen offset:0 sc1 lds
    buffer_load_dwordx4 v74, s[16:19], s99 offen offset:1024 sc1 lds
    buffer_load_dwordx4 v75, s[16:19], s99 offen offset:2048 sc1 lds
    buffer_load_dwordx4 v76, s[16:19], s99 offen offset:3072 sc1 lds
    s_add_u32 m0, s93, 53760
    s_add_u32 s99, s99, 524288
    s_mov_b64 exec, s[80:81]
    buffer_load_dwordx4 v77, s[16:19], s100 offen sc1 lds
    s_mov_b64 exec, -1
    s_add_u32 s100, s100, 524288
    s_add_u32 m0, s92, 55936
    s_nop 0
    s_nop 0
    buffer_load_dwordx4 v73, s[16:19], s99 offen offset:0 sc1 lds
    buffer_load_dwordx4 v74, s[16:19], s99 offen offset:1024 sc1 lds
    buffer_load_dwordx4 v75, s[16:19], s99 offen offset:2048 sc1 lds
    buffer_load_dwordx4 v76, s[16:19], s99 offen offset:3072 sc1 lds
    s_add_u32 m0, s93, 73344
    s_add_u32 s99, s99, 524288
    s_mov_b64 exec, s[80:81]
    buffer_load_dwordx4 v77, s[16:19], s100 offen sc1 lds
    s_mov_b64 exec, -1
    s_add_u32 s100, s100, 524288
    s_add_u32 m0, s92, 75520
    s_nop 0
    s_nop 0
    buffer_load_dwordx4 v73, s[16:19], s99 offen offset:0 sc1 lds
    buffer_load_dwordx4 v74, s[16:19], s99 offen offset:1024 sc1 lds
    buffer_load_dwordx4 v75, s[16:19], s99 offen offset:2048 sc1 lds
    buffer_load_dwordx4 v76, s[16:19], s99 offen offset:3072 sc1 lds
    s_add_u32 m0, s93, 92928
    s_add_u32 s99, s99, 524288
    s_mov_b64 exec, s[80:81]
    buffer_load_dwordx4 v77, s[16:19], s100 offen sc1 lds
    s_mov_b64 exec, -1
    s_add_u32 s100, s100, 524288
    s_mov_b64 exec, -1
    s_waitcnt vmcnt(0) lgkmcnt(0)
    s_branch ge_69
rd_76:
    s_cmp_eq_u32 s38, 0
    s_cbranch_scc1 rc_77
    s_sub_u32 s38, s38, 1
    s_nop 7
    s_nop 7
    s_sleep 4
    s_mov_b64 exec, vcc
    s_mov_b32 s96, 12058624
    buffer_load_dwordx4 v[216:219], v56, s[16:19], s96 offen offset:0 sc1
    buffer_load_dwordx4 v[220:223], v56, s[16:19], s96 offen offset:256 sc1
    s_mov_b32 s96, 12091392
    buffer_load_dwordx4 v[224:227], v56, s[16:19], s96 offen offset:0 sc1
    buffer_load_dwordx4 v[228:231], v56, s[16:19], s96 offen offset:256 sc1
    s_mov_b32 s96, 12124160
    buffer_load_dwordx4 v[232:235], v56, s[16:19], s96 offen offset:0 sc1
    buffer_load_dwordx4 v[236:239], v56, s[16:19], s96 offen offset:256 sc1
    s_mov_b32 s96, 12156928
    buffer_load_dwordx4 v[240:243], v56, s[16:19], s96 offen offset:0 sc1
    buffer_load_dwordx4 v[244:247], v56, s[16:19], s96 offen offset:256 sc1
    s_mov_b32 s96, 12058624
    buffer_load_dwordx2 v[248:249], v57, s[16:19], s96 offen offset:0 sc1
    buffer_load_dwordx2 v[252:253], v57, s[16:19], s96 offen offset:128 sc1
    s_mov_b32 s96, 12075008
    buffer_load_dwordx2 v[250:251], v57, s[16:19], s96 offen offset:0 sc1
    buffer_load_dwordx2 v[254:255], v57, s[16:19], s96 offen offset:128 sc1
    s_mov_b32 s96, 9437184
    buffer_load_dwordx4 v[208:211], v59, s[16:19], s96 offen sc1
    s_add_u32 s97, s36, 9437184
    buffer_load_dword v212, v61, s[16:19], s97 offen sc1
    s_mov_b64 exec, -1
    s_waitcnt vmcnt(0) lgkmcnt(0)
    s_branch oe_75
rd_79:
    s_cmp_eq_u32 s38, 0
    s_cbranch_scc1 rc_80
    s_sub_u32 s38, s38, 1
    s_nop 7
    s_nop 7
    s_sleep 4
    s_mov_b64 exec, vcc
    s_mov_b32 s96, 12062720
    buffer_load_dwordx4 v[216:219], v56, s[16:19], s96 offen offset:0 sc1
    buffer_load_dwordx4 v[220:223], v56, s[16:19], s96 offen offset:256 sc1
    s_mov_b32 s96, 12095488
    buffer_load_dwordx4 v[224:227], v56, s[16:19], s96 offen offset:0 sc1
    buffer_load_dwordx4 v[228:231], v56, s[16:19], s96 offen offset:256 sc1
    s_mov_b32 s96, 12128256
    buffer_load_dwordx4 v[232:235], v56, s[16:19], s96 offen offset:0 sc1
    buffer_load_dwordx4 v[236:239], v56, s[16:19], s96 offen offset:256 sc1
    s_mov_b32 s96, 12161024
    buffer_load_dwordx4 v[240:243], v56, s[16:19], s96 offen offset:0 sc1
    buffer_load_dwordx4 v[244:247], v56, s[16:19], s96 offen offset:256 sc1
    s_mov_b32 s96, 12060672
    buffer_load_dwordx2 v[248:249], v57, s[16:19], s96 offen offset:0 sc1
    buffer_load_dwordx2 v[252:253], v57, s[16:19], s96 offen offset:128 sc1
    s_mov_b32 s96, 12077056
    buffer_load_dwordx2 v[250:251], v57, s[16:19], s96 offen offset:0 sc1
    buffer_load_dwordx2 v[254:255], v57, s[16:19], s96 offen offset:128 sc1
    s_mov_b32 s96, 9439232
    buffer_load_dwordx4 v[208:211], v59, s[16:19], s96 offen sc1
    s_add_u32 s97, s36, 9439232
    buffer_load_dword v212, v61, s[16:19], s97 offen sc1
    s_mov_b64 exec, -1
    s_waitcnt vmcnt(0) lgkmcnt(0)
    s_branch oe_78
rd_84:
    s_cmp_eq_u32 s38, 0
    s_cbranch_scc1 rc_85
    s_sub_u32 s38, s38, 1
    s_nop 7
    s_nop 7
    s_sleep 4
    s_mov_b64 exec, vcc
    s_lshl_b32 s96, s75, 14
    s_add_u32 s96, s96, 14680064
    s_lshl_b32 s97, s24, 12
    s_add_u32 s97, s97, 3506176
    buffer_load_dwordx4 v[176:179], v62, s[16:19], s96 offen offset:0 sc1
    buffer_load_dwordx4 v[180:183], v62, s[16:19], s96 offen offset:1024 sc1
    buffer_load_dwordx4 v[184:187], v62, s[16:19], s97 offen offset:0 sc1
    buffer_load_dwordx4 v[188:191], v62, s[16:19], s97 offen offset:1024 sc1
    buffer_load_dwordx4 v[192:195], v62, s[16:19], s97 offen offset:2048 sc1
    buffer_load_dwordx4 v[196:199], v62, s[16:19], s97 offen offset:3072 sc1
    s_mov_b64 exec, -1
    s_waitcnt vmcnt(0) lgkmcnt(0)
    s_branch ce_83
rd_87:
    s_cmp_eq_u32 s38, 0
    s_cbranch_scc1 rc_88
    s_sub_u32 s38, s38, 1
    s_nop 7
    s_nop 7
    s_sleep 4
    s_mov_b64 exec, vcc
    s_lshl_b32 s96, s75, 14
    s_add_u32 s96, s96, 14680064
    s_lshl_b32 s97, s24, 12
    s_add_u32 s97, s97, 3510272
    buffer_load_dwordx4 v[248:251], v62, s[16:19], s96 offen offset:2048 sc1
    buffer_load_dwordx4 v[252:255], v62, s[16:19], s96 offen offset:3072 sc1
    buffer_load_dwordx4 v[96:99], v62, s[16:19], s97 offen offset:0 sc1
    buffer_load_dwordx4 v[100:103], v62, s[16:19], s97 offen offset:1024 sc1
    buffer_load_dwordx4 v[104:107], v62, s[16:19], s97 offen offset:2048 sc1
    buffer_load_dwordx4 v[108:111], v62, s[16:19], s97 offen offset:3072 sc1
    s_mov_b64 exec, -1
    s_waitcnt vmcnt(0) lgkmcnt(0)
    s_branch ce_86
L_last:
    s_endpgm
.section .rodata,"a"
.p2align 6
.amdhsa_kernel interleave_layers__sliding_local_dilated__ssm_conv_s4d__prompt_kernel
  .amdhsa_next_free_vgpr 512
  .amdhsa_next_free_sgpr 102
  .amdhsa_accum_offset 256
  .amdhsa_group_segment_fixed_size 0
  .amdhsa_kernarg_size 104
  .amdhsa_user_sgpr_count 2
  .amdhsa_user_sgpr_kernarg_segment_ptr 1
  .amdhsa_system_sgpr_workgroup_id_x 1
.end_amdhsa_kernel
```

```asm
; @launch grid=(256,1,1) block=(256,1,1) lds=163840
.amdgcn_target "amdgcn-amd-amdhsa--gfx950"
.text
.globl interleave_layers__sliding_local_dilated__ssm_conv_s4d__prompt_kernel
.p2align 8
.type interleave_layers__sliding_local_dilated__ssm_conv_s4d__prompt_kernel,@function
interleave_layers__sliding_local_dilated__ssm_conv_s4d__prompt_kernel:
    s_getpc_b64 s[42:43]
L_start:
    s_cmp_ge_u32 s2, 256
    s_cbranch_scc1 L_end
    s_load_dwordx16 s[44:59], s[0:1], 0
    s_load_dwordx8 s[60:67], s[0:1], 64
    s_load_dwordx2 s[68:69], s[0:1], 96
    v_and_b32 v1, 63, v0
    v_lshrrev_b32 v2, 6, v0
    s_nop 0
    v_readfirstlane_b32 s24, v2
    s_bfe_u32 s82, s2, 0x40003
    s_lshl_b32 s82, s82, 13
    v_lshrrev_b32 v159, 2, v0
    v_lshl_add_u32 v159, v159, 7, s82
    v_min_u32 v159, L_last-L_start, v159
    global_load_dword v159, v159, s[42:43]
    s_and_b32 s25, s2, 7
    s_lshr_b32 s26, s2, 3
    s_and_b32 s27, s26, 3
    s_lshr_b32 s28, s26, 4
    s_lshl_b32 s28, s28, 2
    s_add_u32 s3, s27, s28
    s_lshl_b32 s27, s3, 2
    s_lshr_b32 s70, 0x75206431, s27
    s_and_b32 s70, s70, 7
    s_and_b32 s27, s25, 1
    s_lshl_b32 s27, s27, 3
    s_add_u32 s70, s70, s27
    s_bfe_u32 s71, s26, 0x10002
    s_bfe_u32 s28, s26, 0x10003
    s_and_b32 s72, s25, 6
    s_add_u32 s72, s72, s28
    s_and_b32 s73, s26, 7
    s_lshr_b32 s28, s26, 3
    s_lshl_b32 s74, s25, 2
    s_add_u32 s74, s74, s28
    s_mul_i32 s75, s25, 20
    s_add_u32 s75, s75, s26
    s_min_u32 s27, s2, 239
    s_mul_i32 s25, s27, 10923
    s_lshr_b32 s25, s25, 16
    s_mul_i32 s26, s25, 6
    s_sub_u32 s26, s27, s26
    s_mul_i32 s27, s25, 61440
    s_mul_i32 s28, s26, 640
    s_add_u32 s27, s27, s28
    s_lshl_b32 s28, s24, 10
    v_add_u32 v85, 0, v0
    v_mul_u32_u24 v84, 1639, v85
    v_lshrrev_b32 v84, 16, v84
    v_mul_u32_u24 v84, 3200, v84
    v_lshl_add_u32 v85, v85, 4, v84
    v_add_u32 v86, 256, v0
    v_mul_u32_u24 v84, 1639, v86
    v_lshrrev_b32_e64 v84, 16, v84
    v_mul_u32_u24 v84, 3200, v84
    v_lshl_add_u32 v86, v86, 4, v84
    v_add_u32 v87, 512, v0
    v_min_u32 v87, 639, v87
    v_mul_u32_u24 v84, 1639, v87
    v_lshrrev_b32_e64 v84, 16, v84
    v_mul_u32_u24 v84, 3200, v84
    v_lshl_add_u32 v87, v87, 4, v84
    s_mov_b32 s76, 0
    s_mov_b32 s77, 0x80000000
    s_mov_b32 s80, -1
    s_mov_b32 s81, 0
    s_nop 0
    s_mov_b32 s78, 0xfe0000fe
    s_mov_b32 s79, 0xfe0000fe
    s_mov_b32 s6, 2621440
    s_mov_b32 s7, 0x20000
    s_mov_b32 s10, 2457600
    s_mov_b32 s11, 0x20000
    s_mov_b32 s14, 819200
    s_mov_b32 s15, 0x20000
    s_mov_b32 s18, 22061056
    s_mov_b32 s19, 0x20000
    s_mov_b32 s22, 2621440
    s_mov_b32 s23, 0x20000
    s_waitcnt lgkmcnt(0)
    s_mov_b32 s4, s44
    s_and_b32 s5, s45, 0xffff
    s_mov_b32 s8, s46
    s_and_b32 s9, s47, 0xffff
    s_mov_b32 s12, s48
    s_and_b32 s13, s49, 0xffff
    s_mov_b32 s16, s68
    s_and_b32 s17, s69, 0xffff
    s_mov_b32 s20, s64
    s_and_b32 s21, s65, 0xffff
    s_cmp_lg_u32 s2, 255
    s_cbranch_scc1 fz_1
    v_mov_b32 v120, 0
    v_mov_b32 v121, 0
    v_mov_b32 v122, 0
    v_mov_b32 v123, 0
    v_lshlrev_b32 v124, 4, v0
    s_mov_b32 s88, 3538944
    buffer_store_dwordx4 v[120:123], v124, s[16:19], s88 offen sc1
    s_mov_b32 s88, 3543040
    buffer_store_dwordx4 v[120:123], v124, s[16:19], s88 offen sc1
    s_mov_b32 s88, 3547136
    buffer_store_dwordx4 v[120:123], v124, s[16:19], s88 offen sc1
    s_mov_b32 s88, 3555328
    buffer_store_dwordx4 v[120:123], v124, s[16:19], s88 offen sc1
    s_mov_b32 s88, 3559424
    buffer_store_dwordx4 v[120:123], v124, s[16:19], s88 offen sc1
    s_mov_b32 s88, 3563520
    buffer_store_dwordx4 v[120:123], v124, s[16:19], s88 offen sc1
fz_1:
    s_min_u32 s96, s75, 159
    s_lshl_b32 s96, s96, 2
    s_add_u32 s96, s96, s24
    s_mul_i32 s97, s96, 384
    s_lshl_b32 s96, s96, 1
    v_lshl_add_u32 v2, v1, 2, s97
    v_mov_b32 v241, s96
    global_load_dword v232, v2, s[52:53]
    global_load_dword v233, v2, s[54:55]
    global_load_dword v234, v2, s[56:57]
    global_load_dword v235, v2, s[58:59]
    global_load_ushort v240, v241, s[60:61]
    s_add_u32 m0, s28, 134272
    s_nop 0
    buffer_load_dwordx4 v85, s[8:11], s27 offen lds
    s_add_u32 m0, s28, 138368
    s_nop 0
    buffer_load_dwordx4 v86, s[8:11], s27 offen lds
    s_add_u32 m0, s28, 142464
    s_nop 0
    buffer_load_dwordx4 v87, s[8:11], s27 offen lds
    s_lshr_b32 s29, s26, 1
    s_and_b32 s30, s26, 1
    s_lshl_b32 s30, s30, 3
    s_lshl_b32 s31, s25, 10
    s_add_u32 s31, s31, 0
    s_cmp_ge_u32 s2, 240
    s_cselect_b32 s31, 1073741824, s31
    v_bfe_u32 v93, v0, 2, 2
    v_bfe_u32 v92, v0, 1, 1
    v_lshl_add_u32 v92, v92, 3, v93
    v_mul_u32_u24 v92, 640, v92
    v_and_b32 v93, 1, v0
    v_mul_u32_u24 v93, 40, v93
    v_add_u32 v91, v92, v93
    v_add_u32 v91, 134272, v91
    v_lshrrev_b32 v88, 4, v0
    v_add_u32 v88, 0, v88
    v_cmp_gt_u32 vcc, 40, v88
    v_min_u32 v88, 39, v88
    v_mul_u32_u24 v89, 13108, v88
    v_lshrrev_b32 v89, 16, v89
    v_mul_u32_u24 v90, 5, v89
    v_sub_u32_e64 v90, v88, v90
    v_mul_u32_u24 v92, 80, v89
    v_lshl_add_u32 v92, v90, 3, v92
    v_add_u32 v111, v92, v91
    v_add_u32 v89, s30, v89
    v_cmp_eq_u32 s[82:83], 4, v90
    v_mov_b32 v92, s29
    s_nop 0
    v_cndmask_b32 v93, v90, v92, s[82:83]
    v_cndmask_b32 v92, v92, 3, s[82:83]
    v_lshl_add_u32 v89, v89, 2, v93
    v_mul_u32_u24 v89, 40960, v89
    v_lshl_add_u32 v89, v92, 8, v89
    v_and_b32 v92, 15, v0
    v_lshl_add_u32 v89, v92, 4, v89
    v_mov_b32 v92, 1073741824
    v_cndmask_b32 v89, v92, v89, vcc
    v_add_u32 v108, s31, v89
    v_lshrrev_b32 v88, 4, v0
    v_add_u32 v88, 16, v88
    v_cmp_gt_u32 vcc, 40, v88
    v_min_u32 v88, 39, v88
    v_mul_u32_u24 v89, 13108, v88
    v_lshrrev_b32 v89, 16, v89
    v_mul_u32_u24 v90, 5, v89
    v_sub_u32_e64 v90, v88, v90
    v_mul_u32_u24 v92, 80, v89
    v_lshl_add_u32 v92, v90, 3, v92
    v_add_u32 v112, v92, v91
    v_add_u32 v89, s30, v89
    v_cmp_eq_u32 s[82:83], 4, v90
    v_mov_b32 v92, s29
    s_nop 0
    v_cndmask_b32 v93, v90, v92, s[82:83]
    v_cndmask_b32 v92, v92, 3, s[82:83]
    v_lshl_add_u32 v89, v89, 2, v93
    v_mul_u32_u24 v89, 40960, v89
    v_lshl_add_u32 v89, v92, 8, v89
    v_and_b32 v92, 15, v0
    v_lshl_add_u32 v89, v92, 4, v89
    v_mov_b32 v92, 1073741824
    v_cndmask_b32 v89, v92, v89, vcc
    v_add_u32 v109, s31, v89
    v_lshrrev_b32 v88, 4, v0
    v_add_u32 v88, 32, v88
    v_cmp_gt_u32 vcc, 40, v88
    v_min_u32 v88, 39, v88
    v_mul_u32_u24 v89, 13108, v88
    v_lshrrev_b32 v89, 16, v89
    v_mul_u32_u24 v90, 5, v89
    v_sub_u32_e64 v90, v88, v90
    v_mul_u32_u24 v92, 80, v89
    v_lshl_add_u32 v92, v90, 3, v92
    v_add_u32 v113, v92, v91
    v_add_u32 v89, s30, v89
    v_cmp_eq_u32 s[82:83], 4, v90
    v_mov_b32 v92, s29
    s_nop 0
    v_cndmask_b32 v93, v90, v92, s[82:83]
    v_cndmask_b32 v92, v92, 3, s[82:83]
    v_lshl_add_u32 v89, v89, 2, v93
    v_mul_u32_u24 v89, 40960, v89
    v_lshl_add_u32 v89, v92, 8, v89
    v_and_b32 v92, 15, v0
    v_lshl_add_u32 v89, v92, 4, v89
    v_mov_b32 v92, 1073741824
    v_cndmask_b32 v89, v92, v89, vcc
    v_add_u32 v110, s31, v89
    s_mul_i32 s25, s3, 18
    s_lshl_b32 s26, s72, 7
    s_add_u32 s25, s25, s26
    s_add_u32 s25, s25, s71
    s_add_u32 s25, s25, -16
    s_max_i32 s25, s25, 0
    s_mul_i32 s25, s25, 1280
    v_lshrrev_b32_e64 v204, 1, v0
    v_min_u32 v204, 89, v204
    v_mul_u32_u24 v205, 6554, v204
    v_lshrrev_b32_e64 v205, 16, v205
    v_mul_u32_u24 v205, 1280, v205
    v_lshl_add_u32 v204, v204, 7, v205
    buffer_load_dword v204, v204, s[4:7], s25 offen
    s_and_b32 s25, s2, 7
    s_lshl_b32 s86, s25, 7
    s_add_u32 s86, s86, 3538944
    s_lshl_b32 s87, s25, 10
    s_add_u32 s87, s87, 3538944
    s_add_u32 s89, s87, 16384
    v_cmp_gt_u32 s[50:51], 8, v0
    v_cmp_eq_u32 vcc, 0, v0
    v_lshlrev_b32 v4, 7, v1
    v_mov_b32 v6, 1073741824
    v_cndmask_b32 v4, v6, v4, s[50:51]
    v_cndmask_b32 v6, v6, 0, vcc
    v_mov_b32 v5, 0
    s_cmp_lg_u32 s2, 255
    s_cbranch_scc1 fr_2
    v_mov_b32 v2, 1
    s_waitcnt vmcnt(9)
    s_barrier
    s_mov_b64 exec, 1
    global_store_dword v5, v2, s[66:67] sc1
    s_mov_b64 exec, -1
fr_2:
    v_mov_b32 v140, 0
    v_mov_b32_e64 v141, 0
    v_mov_b32 v142, 0x3f803f80
    v_mov_b32 v143, 0x3f803f80
    v_lshlrev_b32_e64 v144, 3, v0
    v_add_u32 v144, 155648, v144
    ds_write_b64 v144, v[140:141]
    ds_write_b64 v144, v[140:141] offset:512
    ds_write_b64 v144, v[142:143] offset:2560
    ds_write_b64 v144, v[142:143] offset:3072
    v_and_b32 v50, 31, v1
    v_lshrrev_b32 v51, 5, v1
    v_mul_u32_u24 v52, 40, v50
    v_mul_u32_u24 v53, 3200, v51
    v_add_u32 v53, v52, v53
    s_lshl_b32 s25, s24, 3
    s_add_u32 s25, s25, 320
    v_add_u32 v38, s25, v53
    s_mul_i32 s25, s24, 6400
    s_add_u32 s25, s25, 352
    v_add_u32 v39, s25, v53
    s_lshl_b32 s31, s71, 12
    v_lshl_add_u32 v47, v50, 3, s31
    v_bfe_u32 v52, v1, 2, 1
    v_and_b32 v53, 3, v1
    v_lshlrev_b32 v54, 13, v52
    v_lshl_add_u32 v54, v53, 3, v54
    v_add_u32_e64 v48, s31, v54
    v_bfe_u32 v54, v1, 4, 1
    v_lshl_add_u32 v52, v54, 1, v52
    v_mul_u32_u24 v52, 40, v52
    v_add_u32 v52, v52, v53
    v_mul_u32_u24_e64 v52, 40, v52
    v_bfe_u32 v53, v1, 3, 1
    v_cmp_eq_u32 s[82:83], v53, v54
    v_lshl_add_u32 v53, v53, 1, v51
    v_cmp_eq_u32 vcc, 3, v53
    v_mov_b32 v54, s24
    s_nop 0
    v_cndmask_b32 v53, v53, v54, vcc
    v_cndmask_b32 v54, v54, 4, vcc
    v_mul_u32_u24 v53, 6400, v53
    v_lshl_add_u32 v52, v54, 3, v52
    v_add_u32_e64 v52, v52, v53
    v_add_u32 v40, 160, v52
    v_mov_b32 v52, 19584
    v_mov_b32 v53, 128
    v_cndmask_b32 v49, v53, v52, s[78:79]
    v_and_b32 v50, 15, v1
    v_lshrrev_b32 v51, 4, v1
    s_and_b32 s25, s24, 1
    s_and_b32 s26, s24, 2
    s_mul_i32 s27, s25, 3200
    s_mul_i32 s28, s26, 320
    s_add_u32 s27, s27, s28
    s_add_u32 s27, s27, 0
    v_and_b32 v52, 1, v1
    v_mul_u32_u24 v52, 1600, v52
    v_lshrrev_b32 v53, 1, v50
    v_mul_u32_u24_e64 v54, 40, v53
    v_add3_u32 v52, v52, v54, s27
    v_lshl_add_u32 v41, v51, 3, v52
    v_add_u32_e64 v42, 32, v52
    v_bfe_u32 v52, v1, 2, 1
    v_mul_u32_u24 v52, 1600, v52
    v_lshrrev_b32 v54, 3, v1
    v_mul_u32_u24 v54, 40, v54
    v_add3_u32 v52, v52, v54, s27
    v_add_u32 v52, 12800, v52
    v_and_b32 v54, 3, v1
    v_lshl_add_u32 v43, v54, 3, v52
    v_add_u32 v52, 32, v52
    v_cmp_eq_u32 vcc, 0, v54
    v_mov_b32 v54, 158208
    s_nop 0
    v_cndmask_b32 v44, v54, v52, vcc
    v_and_b32 v52, 1, v51
    v_add_u32 v52, s26, v52
    v_lshrrev_b32 v54, 2, v50
    v_lshl_add_u32 v52, v52, 2, v54
    v_and_b32 v53, 1, v53
    v_lshl_add_u32 v52, v53, 4, v52
    v_and_b32 v53, 1, v50
    v_lshl_add_u32 v52, v53, 10, v52
    s_lshl_b32 s30, s70, 1
    s_add_u32 s30, s30, s25
    s_lshl_b32 s29, s30, 3
    s_add_u32 s29, s29, s71
    s_lshl_b32 s29, s29, 13
    v_lshrrev_b32 v53, 1, v51
    v_lshlrev_b32 v53, 15, v53
    v_lshl_add_u32 v53, v52, 4, v53
    v_add_u32_e64 v45, s29, v53
    s_lshl_b32 s29, s30, 2
    s_add_u32 s29, s29, s71
    s_lshl_b32 s29, s29, 12
    s_add_u32 s29, s29, 2097152
    v_lshl_add_u32 v46, v52, 3, s29
    s_or_b32 s29, s26, s72
    s_cmp_eq_u32 s29, 0
    s_cselect_b64 s[90:91], -1, 0
    v_lshlrev_b32 v52, 2, v51
    v_sub_u32 v52, v50, v52
    v_mov_b32 v55, 0xf149f2ca
    v_subrev_u32 v53, 0, v52
    v_cmp_lt_u32 vcc, 7, v53
    s_nop 1
    v_cndmask_b32 v28, 0, v55, vcc
    v_cmp_lt_i32 vcc, -9, v53
    s_nop 1
    v_cndmask_b32 v32, 0, v55, vcc
    v_cmp_le_i32 vcc, 0, v53
    v_mov_b32 v54, 0xffff
    s_nop 0
    v_cndmask_b32 v54, 0, v54, vcc
    v_mov_b32 v36, v54
    v_subrev_u32 v53, 1, v52
    v_cmp_lt_u32 vcc, 7, v53
    s_nop 1
    v_cndmask_b32 v29, 0, v55, vcc
    v_cmp_lt_i32 vcc, -9, v53
    s_nop 1
    v_cndmask_b32 v33, 0, v55, vcc
    v_cmp_le_i32 vcc, 0, v53
    v_mov_b32 v54, 0xffff0000
    s_nop 0
    v_cndmask_b32 v54, 0, v54, vcc
    v_or_b32 v36, v36, v54
    v_subrev_u32 v53, 2, v52
    v_cmp_lt_u32 vcc, 7, v53
    s_nop 1
    v_cndmask_b32 v30, 0, v55, vcc
    v_cmp_lt_i32 vcc, -9, v53
    s_nop 1
    v_cndmask_b32 v34, 0, v55, vcc
    v_cmp_le_i32 vcc, 0, v53
    v_mov_b32 v54, 0xffff
    s_nop 0
    v_cndmask_b32 v54, 0, v54, vcc
    v_mov_b32 v37, v54
    v_subrev_u32 v53, 3, v52
    v_cmp_lt_u32 vcc, 7, v53
    s_nop 1
    v_cndmask_b32 v31, 0, v55, vcc
    v_cmp_lt_i32 vcc, -9, v53
    s_nop 1
    v_cndmask_b32 v35, 0, v55, vcc
    v_cmp_le_i32 vcc, 0, v53
    v_mov_b32 v54, 0xffff0000
    s_nop 0
    v_cndmask_b32 v54, 0, v54, vcc
    v_or_b32 v37, v37, v54
    v_and_b32 v62, 15, v1
    v_lshrrev_b32 v63, 4, v1
    s_and_b32 s25, s74, 3
    s_lshr_b32 s26, s74, 2
    s_lshl_b32 s27, s24, 6
    s_add_u32 s27, s27, s25
    s_lshl_b32 s27, s27, 13
    s_lshl_b32 s28, s26, 9
    s_add_u32 s27, s27, s28
    v_lshl_add_u32 v64, v63, 17, s27
    v_lshl_add_u32 v56, v62, 4, v64
    s_lshl_b32 s27, s24, 5
    s_add_u32 s27, s27, s25
    s_lshl_b32 s27, s27, 12
    s_lshl_b32 s28, s26, 8
    s_add_u32 s27, s27, s28
    s_add_u32 s27, s27, 2097152
    v_lshl_add_u32 v64, v63, 15, s27
    v_lshl_add_u32 v57, v62, 3, v64
    v_lshlrev_b32 v58, 4, v1
    s_lshl_b32 s29, s25, 12
    s_add_u32 s29, s29, s28
    v_lshl_add_u32 v64, v62, 4, s29
    v_lshl_add_u32 v61, v63, 2, v64
    s_mul_i32 s30, s73, 20
    s_lshl_b32 s31, s24, 2
    s_add_u32 s30, s30, s31
    s_lshl_b32 s31, s30, 14
    v_lshl_add_u32 v64, v63, 14, v64
    v_add_u32 v59, s31, v64
    s_lshl_b32 s31, s26, 7
    s_add_u32 s31, s31, s25
    s_mul_i32 s31, s31, 1280
    s_lshl_b32 s30, s30, 3
    s_add_u32 s31, s31, s30
    v_mul_u32_u24 v64, 10240, v62
    v_lshl_add_u32 v64, v63, 3, v64
    v_add_u32 v60, s31, v64
    s_and_b32 s25, s24, 1
    s_lshl_b32 s25, s25, 6
    s_and_b32 s26, s24, 2
    s_add_u32 s25, s25, s26
    s_mul_i32 s25, s25, 1280
    v_lshrrev_b32 v140, 4, v1
    v_and_b32 v141, 15, v1
    v_xor_b32 v141, v140, v141
    v_lshlrev_b32 v141, 4, v141
    v_mul_u32_u24 v142, 5120, v140
    v_add3_u32 v73, v141, v142, s25
    s_and_b32 s25, s24, 1
    s_lshl_b32 s25, s25, 3
    s_add_u32 s25, s25, s26
    s_mul_i32 s25, s25, 1280
    v_add3_u32 v77, v141, v142, s25
    v_lshrrev_b32 v141, 5, v1
    v_and_b32 v140, 3, v1
    v_xor_b32 v142, v140, v141
    v_lshlrev_b32_e64 v142, 4, v142
    v_lshl_add_u32 v142, v140, 8, v142
    v_bfe_u32 v140, v1, 2, 3
    v_mul_u32_u24 v140, 1088, v140
    v_add_u32 v78, v140, v142
    v_and_b32 v140, 1, v1
    v_xor_b32 v142, v140, v141
    v_lshlrev_b32 v142, 4, v142
    v_lshl_add_u32 v142, v140, 8, v142
    v_bfe_u32 v140, v1, 1, 2
    v_mul_u32_u24 v140, 544, v140
    v_add_u32_e64 v142, v140, v142
    v_add_u32 v74, 19392, v73
    v_add_u32 v75, 38784, v73
    v_add_u32 v76, 58176, v73
    v_add_u32 v142, 53760, v142
    v_and_b32 v140, 31, v1
    v_cmp_eq_u32 vcc, 0, v140
    v_cmp_eq_u32 s[82:83], 24, v140
    s_nop 0
    s_or_b64 vcc, vcc, s[82:83]
    v_mov_b32 v140, 155776
    v_mov_b32 v141, 158400
    v_cndmask_b32_e64 v140, v140, v141, vcc
    v_cndmask_b32 v79, v140, v142, s[78:79]
    v_bfe_u32 v201, v1, 3, 2
    v_and_b32 v202, s24, v201
    v_cmp_eq_u32 vcc, 3, v202
    v_lshrrev_b32 v202, 5, v1
    v_lshl_add_u32 v201, v201, 1, v202
    v_and_b32 v202, 7, v1
    v_lshl_add_u32 v201, v201, 3, v202
    v_lshlrev_b32 v200, 4, v201
    v_mov_b32 v201, 1073741824
    v_cndmask_b32 v200, v200, v201, vcc
    s_lshl_b32 s101, s70, 2
    s_add_u32 s101, s101, s24
    s_mul_i32 s101, s101, 40960
    s_add_u32 s101, s101, 0
    s_lshl_b32 s25, s72, 5
    s_add_u32 s25, s25, 0
    s_sub_u32 s26, s25, 4
    s_max_i32 s26, s26, 0
    s_mul_i32 s27, s71, 1280
    s_mul_i32 s99, s25, 5120
    s_mul_i32 s100, s26, 5120
    s_mul_i32 s92, s24, 4352
    s_mul_i32 s93, s24, 544
    s_add_u32 s99, s99, s27
    s_add_u32 s100, s100, s27
    s_mov_b32 s38, 0x10000
    s_mov_b32 s39, 0x1000
    s_cmp_ge_u32 s2, 160
    s_cbranch_scc1 nc_3
    s_waitcnt vmcnt(1)
    s_barrier
    s_nop 0
    ds_read_b64_tr_b16 v[96:97], v111
    ds_read_b64_tr_b16 v[98:99], v111 offset:2560
    ds_read_b64_tr_b16 v[100:101], v112
    ds_read_b64_tr_b16 v[102:103], v112 offset:2560
    ds_read_b64_tr_b16 v[104:105], v113
    ds_read_b64_tr_b16 v[106:107], v113 offset:2560
    s_waitcnt lgkmcnt(4)
    buffer_store_dwordx4 v[96:99], v108, s[16:19], 0 offen sc1
    s_waitcnt lgkmcnt(2)
    buffer_store_dwordx4 v[100:103], v109, s[16:19], 0 offen sc1
    s_waitcnt lgkmcnt(0)
    buffer_store_dwordx4 v[104:107], v110, s[16:19], 0 offen sc1
    global_load_dword v7, v5, s[66:67] sc1
    s_mul_i32 s37, s24, 8704
    s_add_u32 s25, s37, 0
    s_add_u32 s37, s37, 0
    s_mov_b32 m0, s37
    v_and_b32 v199, 31, v1
    v_mul_u32_u24 v199, 272, v199
    v_lshrrev_b32 v215, 5, v1
    v_lshl_add_u32 v199, v215, 4, v199
    v_add_u32 v252, s25, v199
    v_lshlrev_b32 v253, 16, v240
    v_mul_f32 v253, 0x3fb8aa3b, v253
    v_exp_f32 v253, v253
    s_nop 0
    v_cvt_pk_bf16_f32 v253, v253, v253
    v_lshlrev_b32 v253, 16, v253
    v_lshlrev_b32 v199, 16, v232
    v_mul_f32 v199, 0x3fb8aa3b, v199
    v_exp_f32 v199, v199
    v_lshlrev_b32 v255, 16, v233
    v_mul_f32 v255, v255, v253
    v_mul_f32 v255, 0x3e22f983, v255
    v_cvt_pk_bf16_f32 v199, v199, v199
    v_lshlrev_b32 v199, 16, v199
    v_mul_f32 v254, v199, v253
    v_mul_f32 v254, 0xbfb8aa3b, v254
    v_mul_f32 v182, 0x41000000, v254
    v_mul_f32 v185, 0x41000000, v255
    v_mul_f32 v184, 0x43800000, v254
    v_mul_f32 v189, 0x43800000, v255
    v_fract_f32 v185, v185
    v_fract_f32 v188, v255
    v_fract_f32 v189, v189
    v_exp_f32 v182, v182
    v_exp_f32 v183, v254
    v_exp_f32 v184, v184
    v_cos_f32 v186, v185
    v_sin_f32 v187, v185
    v_cos_f32 v180, v188
    v_sin_f32 v181, v188
    v_cos_f32 v190, v189
    v_sin_f32 v191, v189
    s_min_u32 s96, s75, 159
    s_lshl_b32 s96, s96, 2
    s_add_u32 s96, s96, s24
    s_mul_i32 s97, s96, 384
    s_lshl_b32 s96, s96, 1
    v_lshl_add_u32 v2, v1, 1, s97
    v_mov_b32 v241, s96
    global_load_ushort v236, v2, s[52:53] offset:256
    global_load_ushort v237, v2, s[54:55] offset:256
    global_load_ushort v238, v2, s[56:57] offset:256
    global_load_ushort v239, v2, s[58:59] offset:256
    global_load_ushort v241, v241, s[62:63]
    v_lshlrev_b32 v192, 16, v234
    v_lshlrev_b32 v193, 16, v235
    v_add_f32 v199, v253, v253
    v_mul_f32 v192, v192, v199
    v_mul_f32 v193, v193, v199
    v_mul_f32 v186, v186, v182
    v_mul_f32 v187, v187, v182
    v_mul_f32 v180, v180, v183
    v_mul_f32 v181, v181, v183
    v_mul_f32 v190, v190, v184
    v_mul_f32_e64 v191, v191, v184
    v_mov_b32 v242, 0x3f80
    v_cvt_pk_bf16_f32 v243, v186, v187
    v_pk_mul_f32 v[194:195], v[186:187], v[186:187] op_sel:[0,0] op_sel_hi:[0,1]
    v_pk_fma_f32 v[172:173], v[186:187], v[186:187], v[194:195] op_sel:[1,1,0] op_sel_hi:[1,0,1] neg_lo:[0,1,0]
    v_cvt_pk_bf16_f32 v244, v172, v173
    v_pk_mul_f32 v[194:195], v[172:173], v[186:187] op_sel:[0,0] op_sel_hi:[0,1]
    v_pk_fma_f32 v[174:175], v[172:173], v[186:187], v[194:195] op_sel:[1,1,0] op_sel_hi:[1,0,1] neg_lo:[0,1,0]
    v_cvt_pk_bf16_f32 v245, v174, v175
    v_pk_mul_f32 v[194:195], v[174:175], v[186:187] op_sel:[0,0] op_sel_hi:[0,1]
    v_pk_fma_f32 v[172:173], v[174:175], v[186:187], v[194:195] op_sel:[1,1,0] op_sel_hi:[1,0,1] neg_lo:[0,1,0]
    v_cvt_pk_bf16_f32 v246, v172, v173
    v_pk_mul_f32 v[194:195], v[172:173], v[186:187] op_sel:[0,0] op_sel_hi:[0,1]
    v_pk_fma_f32 v[174:175], v[172:173], v[186:187], v[194:195] op_sel:[1,1,0] op_sel_hi:[1,0,1] neg_lo:[0,1,0]
    v_cvt_pk_bf16_f32 v247, v174, v175
    v_pk_mul_f32 v[194:195], v[174:175], v[186:187] op_sel:[0,0] op_sel_hi:[0,1]
    v_pk_fma_f32 v[172:173], v[174:175], v[186:187], v[194:195] op_sel:[1,1,0] op_sel_hi:[1,0,1] neg_lo:[0,1,0]
    v_cvt_pk_bf16_f32 v248, v172, v173
    v_pk_mul_f32 v[194:195], v[172:173], v[186:187] op_sel:[0,0] op_sel_hi:[0,1]
    v_pk_fma_f32 v[174:175], v[172:173], v[186:187], v[194:195] op_sel:[1,1,0] op_sel_hi:[1,0,1] neg_lo:[0,1,0]
    v_cvt_pk_bf16_f32 v249, v174, v175
    v_pk_mul_f32 v[194:195], v[174:175], v[186:187] op_sel:[0,0] op_sel_hi:[0,1]
    v_pk_fma_f32 v[172:173], v[174:175], v[186:187], v[194:195] op_sel:[1,1,0] op_sel_hi:[1,0,1] neg_lo:[0,1,0]
    v_cvt_pk_bf16_f32 v250, v172, v173
    v_pk_mul_f32 v[194:195], v[172:173], v[186:187] op_sel:[0,0] op_sel_hi:[0,1]
    v_pk_fma_f32 v[174:175], v[172:173], v[186:187], v[194:195] op_sel:[1,1,0] op_sel_hi:[1,0,1] neg_lo:[0,1,0]
    v_cvt_pk_bf16_f32 v251, v174, v175
    ds_write_addtid_b32 v242 offset:0
    ds_write_addtid_b32 v243 offset:272
    ds_write_addtid_b32 v244 offset:544
    v_lshrrev_b32 v132, 5, v0
    v_and_b32 v133, 31, v0
    v_mul_u32_u24 v132, 1280, v132
    v_lshl_add_u32 v134, v133, 4, v132
    v_mov_b32 v135, 1073741824
    v_cmp_gt_u32 vcc, 16, v133
    s_mul_i32 s96, s2, 10240
    buffer_load_dwordx4 v[120:123], v134, s[4:7], s96 offen
    v_cndmask_b32_e64 v135, v135, v134, vcc
    buffer_load_dwordx4 v[124:127], v134, s[4:7], s96 offen offset:512
    buffer_load_dwordx4 v[128:131], v135, s[4:7], s96 offen offset:1024
    ds_write_addtid_b32 v245 offset:816
    ds_write_addtid_b32 v246 offset:1088
    ds_write_addtid_b32 v247 offset:1360
    ds_write_addtid_b32 v248 offset:1632
    ds_write_addtid_b32 v249 offset:1904
    ds_write_addtid_b32 v250 offset:2176
    ds_write_addtid_b32 v251 offset:2448
    v_pk_mul_f32 v[194:195], v[174:175], v[186:187] op_sel:[0,0] op_sel_hi:[0,1]
    v_pk_fma_f32 v[172:173], v[174:175], v[186:187], v[194:195] op_sel:[1,1,0] op_sel_hi:[1,0,1] neg_lo:[0,1,0]
    v_cvt_pk_bf16_f32 v242, v172, v173
    v_pk_mul_f32 v[194:195], v[172:173], v[186:187] op_sel:[0,0] op_sel_hi:[0,1]
    v_pk_fma_f32 v[174:175], v[172:173], v[186:187], v[194:195] op_sel:[1,1,0] op_sel_hi:[1,0,1] neg_lo:[0,1,0]
    v_cvt_pk_bf16_f32 v243, v174, v175
    v_pk_mul_f32 v[194:195], v[174:175], v[186:187] op_sel:[0,0] op_sel_hi:[0,1]
    v_pk_fma_f32 v[172:173], v[174:175], v[186:187], v[194:195] op_sel:[1,1,0] op_sel_hi:[1,0,1] neg_lo:[0,1,0]
    v_cvt_pk_bf16_f32 v244, v172, v173
    v_pk_mul_f32 v[194:195], v[172:173], v[186:187] op_sel:[0,0] op_sel_hi:[0,1]
    v_pk_fma_f32 v[174:175], v[172:173], v[186:187], v[194:195] op_sel:[1,1,0] op_sel_hi:[1,0,1] neg_lo:[0,1,0]
    v_cvt_pk_bf16_f32 v245, v174, v175
    v_pk_mul_f32 v[194:195], v[174:175], v[186:187] op_sel:[0,0] op_sel_hi:[0,1]
    v_pk_fma_f32 v[172:173], v[174:175], v[186:187], v[194:195] op_sel:[1,1,0] op_sel_hi:[1,0,1] neg_lo:[0,1,0]
    v_cvt_pk_bf16_f32 v246, v172, v173
    v_pk_mul_f32 v[194:195], v[172:173], v[186:187] op_sel:[0,0] op_sel_hi:[0,1]
    v_pk_fma_f32 v[174:175], v[172:173], v[186:187], v[194:195] op_sel:[1,1,0] op_sel_hi:[1,0,1] neg_lo:[0,1,0]
    v_cvt_pk_bf16_f32 v247, v174, v175
    v_pk_mul_f32 v[194:195], v[174:175], v[186:187] op_sel:[0,0] op_sel_hi:[0,1]
    v_pk_fma_f32 v[172:173], v[174:175], v[186:187], v[194:195] op_sel:[1,1,0] op_sel_hi:[1,0,1] neg_lo:[0,1,0]
    v_cvt_pk_bf16_f32 v248, v172, v173
    v_pk_mul_f32 v[194:195], v[172:173], v[186:187] op_sel:[0,0] op_sel_hi:[0,1]
    v_pk_fma_f32 v[174:175], v[172:173], v[186:187], v[194:195] op_sel:[1,1,0] op_sel_hi:[1,0,1] neg_lo:[0,1,0]
    v_cvt_pk_bf16_f32 v249, v174, v175
    v_pk_mul_f32 v[194:195], v[174:175], v[186:187] op_sel:[0,0] op_sel_hi:[0,1]
    v_pk_fma_f32 v[172:173], v[174:175], v[186:187], v[194:195] op_sel:[1,1,0] op_sel_hi:[1,0,1] neg_lo:[0,1,0]
    v_cvt_pk_bf16_f32 v250, v172, v173
    v_pk_mul_f32 v[194:195], v[172:173], v[186:187] op_sel:[0,0] op_sel_hi:[0,1]
    v_pk_fma_f32 v[174:175], v[172:173], v[186:187], v[194:195] op_sel:[1,1,0] op_sel_hi:[1,0,1] neg_lo:[0,1,0]
    v_cvt_pk_bf16_f32 v251, v174, v175
    ds_write_addtid_b32 v242 offset:2720
    ds_write_addtid_b32 v243 offset:2992
    ds_write_addtid_b32 v244 offset:3264
    v_mov_b32 v140, 1073741824
    v_lshlrev_b32 v141, 2, v0
    v_cmp_gt_u32 vcc, 64, v0
    s_nop 1
    v_cndmask_b32 v141, v140, v141, vcc
    v_mov_b32_e64 v140, 0
    s_lshl_b32 s97, s2, 8
    s_add_u32 s97, s97, 3473408
    buffer_store_dword v140, v141, s[16:19], s97 offen sc1
    ds_write_addtid_b32 v245 offset:3536
    ds_write_addtid_b32 v246 offset:3808
    ds_write_addtid_b32 v247 offset:4080
    ds_write_addtid_b32 v248 offset:4352
    ds_write_addtid_b32 v249 offset:4624
    ds_write_addtid_b32 v250 offset:4896
    ds_write_addtid_b32 v251 offset:5168
    v_pk_mul_f32 v[194:195], v[174:175], v[186:187] op_sel:[0,0] op_sel_hi:[0,1]
    v_pk_fma_f32 v[172:173], v[174:175], v[186:187], v[194:195] op_sel:[1,1,0] op_sel_hi:[1,0,1] neg_lo:[0,1,0]
    v_cvt_pk_bf16_f32 v242, v172, v173
    v_pk_mul_f32 v[194:195], v[172:173], v[186:187] op_sel:[0,0] op_sel_hi:[0,1]
    v_pk_fma_f32 v[174:175], v[172:173], v[186:187], v[194:195] op_sel:[1,1,0] op_sel_hi:[1,0,1] neg_lo:[0,1,0]
    v_cvt_pk_bf16_f32 v243, v174, v175
    v_pk_mul_f32 v[194:195], v[174:175], v[186:187] op_sel:[0,0] op_sel_hi:[0,1]
    v_pk_fma_f32 v[172:173], v[174:175], v[186:187], v[194:195] op_sel:[1,1,0] op_sel_hi:[1,0,1] neg_lo:[0,1,0]
    v_cvt_pk_bf16_f32 v244, v172, v173
    v_pk_mul_f32 v[194:195], v[172:173], v[186:187] op_sel:[0,0] op_sel_hi:[0,1]
    v_pk_fma_f32 v[174:175], v[172:173], v[186:187], v[194:195] op_sel:[1,1,0] op_sel_hi:[1,0,1] neg_lo:[0,1,0]
    v_cvt_pk_bf16_f32 v245, v174, v175
    v_pk_mul_f32 v[194:195], v[174:175], v[186:187] op_sel:[0,0] op_sel_hi:[0,1]
    v_pk_fma_f32 v[172:173], v[174:175], v[186:187], v[194:195] op_sel:[1,1,0] op_sel_hi:[1,0,1] neg_lo:[0,1,0]
    v_cvt_pk_bf16_f32 v246, v172, v173
    v_pk_mul_f32 v[194:195], v[172:173], v[186:187] op_sel:[0,0] op_sel_hi:[0,1]
    v_pk_fma_f32 v[174:175], v[172:173], v[186:187], v[194:195] op_sel:[1,1,0] op_sel_hi:[1,0,1] neg_lo:[0,1,0]
    v_cvt_pk_bf16_f32 v247, v174, v175
    v_pk_mul_f32 v[194:195], v[174:175], v[186:187] op_sel:[0,0] op_sel_hi:[0,1]
    v_pk_fma_f32 v[172:173], v[174:175], v[186:187], v[194:195] op_sel:[1,1,0] op_sel_hi:[1,0,1] neg_lo:[0,1,0]
    v_cvt_pk_bf16_f32 v248, v172, v173
    v_pk_mul_f32 v[194:195], v[172:173], v[186:187] op_sel:[0,0] op_sel_hi:[0,1]
    v_pk_fma_f32 v[174:175], v[172:173], v[186:187], v[194:195] op_sel:[1,1,0] op_sel_hi:[1,0,1] neg_lo:[0,1,0]
    v_cvt_pk_bf16_f32 v249, v174, v175
    v_pk_mul_f32 v[194:195], v[174:175], v[186:187] op_sel:[0,0] op_sel_hi:[0,1]
    v_pk_fma_f32 v[172:173], v[174:175], v[186:187], v[194:195] op_sel:[1,1,0] op_sel_hi:[1,0,1] neg_lo:[0,1,0]
    v_cvt_pk_bf16_f32 v250, v172, v173
    v_pk_mul_f32 v[194:195], v[172:173], v[186:187] op_sel:[0,0] op_sel_hi:[0,1]
    v_pk_fma_f32 v[174:175], v[172:173], v[186:187], v[194:195] op_sel:[1,1,0] op_sel_hi:[1,0,1] neg_lo:[0,1,0]
    v_cvt_pk_bf16_f32 v251, v174, v175
    ds_write_addtid_b32 v242 offset:5440
    ds_write_addtid_b32 v243 offset:5712
    ds_write_addtid_b32 v244 offset:5984
    v_mov_b32 v142, 1073741824
    v_lshlrev_b32 v143, 2, v0
    v_cmp_gt_u32 vcc, 16, v0
    s_nop 1
    v_cndmask_b32 v143, v142, v143, vcc
    v_mov_b32_e64 v142, -1
    s_lshl_b32 s97, s2, 6
    s_add_u32 s97, s97, 3457024
    buffer_store_dword v142, v143, s[16:19], s97 offen sc1
    ds_write_addtid_b32 v245 offset:6256
    ds_write_addtid_b32 v246 offset:6528
    ds_write_addtid_b32 v247 offset:6800
    ds_write_addtid_b32 v248 offset:7072
    ds_write_addtid_b32 v249 offset:7344
    ds_write_addtid_b32 v250 offset:7616
    ds_write_addtid_b32 v251 offset:7888
    v_pk_mul_f32 v[194:195], v[174:175], v[186:187] op_sel:[0,0] op_sel_hi:[0,1]
    v_pk_fma_f32 v[172:173], v[174:175], v[186:187], v[194:195] op_sel:[1,1,0] op_sel_hi:[1,0,1] neg_lo:[0,1,0]
    v_cvt_pk_bf16_f32 v242, v172, v173
    v_pk_mul_f32 v[194:195], v[172:173], v[186:187] op_sel:[0,0] op_sel_hi:[0,1]
    v_pk_fma_f32 v[174:175], v[172:173], v[186:187], v[194:195] op_sel:[1,1,0] op_sel_hi:[1,0,1] neg_lo:[0,1,0]
    v_cvt_pk_bf16_f32 v243, v174, v175
    ds_write_addtid_b32 v242 offset:8160
    ds_write_addtid_b32 v243 offset:8432
    ds_read_b128 a[160:163], v252 offset:0
    ds_read_b128 a[164:167], v252 offset:32
    ds_read_b128 a[168:171], v252 offset:64
    ds_read_b128 a[172:175], v252 offset:96
    ds_read_b128 a[176:179], v252 offset:128
    ds_read_b128 a[180:183], v252 offset:160
    ds_read_b128 a[184:187], v252 offset:192
    ds_read_b128 a[188:191], v252 offset:224
    v_pk_mul_f32 v[194:195], v[180:181], v[180:181] op_sel:[0,0] op_sel_hi:[0,1]
    v_pk_fma_f32 v[182:183], v[180:181], v[180:181], v[194:195] op_sel:[1,1,0] op_sel_hi:[1,0,1] neg_lo:[0,1,0]
    v_pk_mul_f32 v[194:195], v[182:183], v[182:183] op_sel:[0,0] op_sel_hi:[0,1]
    v_pk_fma_f32 v[184:185], v[182:183], v[182:183], v[194:195] op_sel:[1,1,0] op_sel_hi:[1,0,1] neg_lo:[0,1,0]
    v_cvt_pk_bf16_f32 v242, v192, -v193
    v_pk_mul_f32 v[194:195], v[192:193], v[180:181] op_sel:[0,0] op_sel_hi:[0,1]
    v_pk_fma_f32 v[174:175], v[192:193], v[180:181], v[194:195] op_sel:[1,1,0] op_sel_hi:[1,0,1] neg_lo:[0,1,0]
    v_cvt_pk_bf16_f32 v243, v174, -v175
    v_pk_mul_f32 v[194:195], v[174:175], v[180:181] op_sel:[0,0] op_sel_hi:[0,1]
    v_pk_fma_f32 v[172:173], v[174:175], v[180:181], v[194:195] op_sel:[1,1,0] op_sel_hi:[1,0,1] neg_lo:[0,1,0]
    v_cvt_pk_bf16_f32 v244, v172, -v173
    v_pk_mul_f32 v[194:195], v[172:173], v[180:181] op_sel:[0,0] op_sel_hi:[0,1]
    v_pk_fma_f32 v[174:175], v[172:173], v[180:181], v[194:195] op_sel:[1,1,0] op_sel_hi:[1,0,1] neg_lo:[0,1,0]
    v_cvt_pk_bf16_f32 v245, v174, -v175
    v_pk_mul_f32 v[194:195], v[174:175], v[180:181] op_sel:[0,0] op_sel_hi:[0,1]
    v_pk_fma_f32 v[172:173], v[174:175], v[180:181], v[194:195] op_sel:[1,1,0] op_sel_hi:[1,0,1] neg_lo:[0,1,0]
    v_cvt_pk_bf16_f32 v246, v172, -v173
    s_waitcnt vmcnt(11)
    s_waitcnt vmcnt(10)
    v_cmp_gt_u32 vcc, 1, v7
    s_nop 0
    s_and_b64 vcc, vcc, s[50:51]
    s_and_b64 vcc, vcc, 1
    s_cbranch_scc1 ps_5
pc_7:
    s_barrier
    v_lshlrev_b32 v2, 3, v4
    v_mov_b32 v5, 1
    v_cndmask_b32 v2, v4, v2, s[50:51]
    buffer_atomic_add v5, v2, s[16:19], s86 offen offset:0 sc1
    v_pk_mul_f32 v[194:195], v[172:173], v[180:181] op_sel:[0,0] op_sel_hi:[0,1]
    v_pk_fma_f32 v[174:175], v[172:173], v[180:181], v[194:195] op_sel:[1,1,0] op_sel_hi:[1,0,1] neg_lo:[0,1,0]
    v_cvt_pk_bf16_f32 v247, v174, -v175
    v_pk_mul_f32 v[194:195], v[174:175], v[180:181] op_sel:[0,0] op_sel_hi:[0,1]
    v_pk_fma_f32 v[172:173], v[174:175], v[180:181], v[194:195] op_sel:[1,1,0] op_sel_hi:[1,0,1] neg_lo:[0,1,0]
    v_cvt_pk_bf16_f32 v248, v172, -v173
    v_pk_mul_f32 v[194:195], v[172:173], v[180:181] op_sel:[0,0] op_sel_hi:[0,1]
    v_pk_fma_f32 v[174:175], v[172:173], v[180:181], v[194:195] op_sel:[1,1,0] op_sel_hi:[1,0,1] neg_lo:[0,1,0]
    v_cvt_pk_bf16_f32 v249, v174, -v175
    v_pk_mul_f32 v[194:195], v[192:193], v[190:191] op_sel:[0,0] op_sel_hi:[0,1]
    v_pk_fma_f32 v[176:177], v[192:193], v[190:191], v[194:195] op_sel:[1,1,0] op_sel_hi:[1,0,1] neg_lo:[0,1,0]
    v_cvt_pk_bf16_f32 v250, v176, -v177
    v_pk_mul_f32 v[194:195], v[176:177], v[182:183] op_sel:[0,0] op_sel_hi:[0,1]
    v_pk_fma_f32 v[174:175], v[176:177], v[182:183], v[194:195] op_sel:[1,1,0] op_sel_hi:[1,0,1] neg_lo:[0,1,0]
    v_cvt_pk_bf16_f32 v251, v174, -v175
    ds_write_addtid_b32 v242 offset:0
    ds_write_addtid_b32 v243 offset:272
    ds_write_addtid_b32 v244 offset:544
    ds_write_addtid_b32 v245 offset:816
    ds_write_addtid_b32 v246 offset:1088
    ds_write_addtid_b32 v247 offset:1360
    ds_write_addtid_b32 v248 offset:1632
    ds_write_addtid_b32 v249 offset:1904
    ds_write_addtid_b32 v250 offset:2176
    ds_write_addtid_b32 v251 offset:2448
    v_pk_mul_f32 v[194:195], v[174:175], v[182:183] op_sel:[0,0] op_sel_hi:[0,1]
    v_pk_fma_f32 v[172:173], v[174:175], v[182:183], v[194:195] op_sel:[1,1,0] op_sel_hi:[1,0,1] neg_lo:[0,1,0]
    v_cvt_pk_bf16_f32 v242, v172, -v173
    v_pk_mul_f32 v[194:195], v[172:173], v[182:183] op_sel:[0,0] op_sel_hi:[0,1]
    v_pk_fma_f32 v[174:175], v[172:173], v[182:183], v[194:195] op_sel:[1,1,0] op_sel_hi:[1,0,1] neg_lo:[0,1,0]
    v_cvt_pk_bf16_f32 v243, v174, -v175
    v_pk_mul_f32 v[194:195], v[174:175], v[182:183] op_sel:[0,0] op_sel_hi:[0,1]
    v_pk_fma_f32 v[172:173], v[174:175], v[182:183], v[194:195] op_sel:[1,1,0] op_sel_hi:[1,0,1] neg_lo:[0,1,0]
    v_cvt_pk_bf16_f32 v244, v172, -v173
    v_pk_mul_f32 v[194:195], v[176:177], v[190:191] op_sel:[0,0] op_sel_hi:[0,1]
    v_pk_fma_f32 v[178:179], v[176:177], v[190:191], v[194:195] op_sel:[1,1,0] op_sel_hi:[1,0,1] neg_lo:[0,1,0]
    v_mov_b32 v144, -1
    v_mov_b32 v145, -1
    v_mov_b32 v146, -1
    v_mov_b32 v147, -1
    v_lshlrev_b32 v148, 4, v0
    s_sub_u32 s88, s2, 0
    s_mul_i32 s88, s88, 20480
    s_min_u32 s88, s88, 5222400
    s_add_u32 s88, s88, 4194304
    buffer_store_dwordx4 v[144:147], v148, s[16:19], s88 offen sc1
    v_cvt_pk_bf16_f32 v245, v178, -v179
    v_pk_mul_f32 v[194:195], v[178:179], v[184:185] op_sel:[0,0] op_sel_hi:[0,1]
    v_pk_fma_f32 v[174:175], v[178:179], v[184:185], v[194:195] op_sel:[1,1,0] op_sel_hi:[1,0,1] neg_lo:[0,1,0]
    v_cvt_pk_bf16_f32 v246, v174, -v175
    v_pk_mul_f32 v[194:195], v[174:175], v[184:185] op_sel:[0,0] op_sel_hi:[0,1]
    v_pk_fma_f32 v[172:173], v[174:175], v[184:185], v[194:195] op_sel:[1,1,0] op_sel_hi:[1,0,1] neg_lo:[0,1,0]
    v_cvt_pk_bf16_f32 v247, v172, -v173
    v_pk_mul_f32 v[194:195], v[178:179], v[190:191] op_sel:[0,0] op_sel_hi:[0,1]
    v_pk_fma_f32 v[176:177], v[178:179], v[190:191], v[194:195] op_sel:[1,1,0] op_sel_hi:[1,0,1] neg_lo:[0,1,0]
    v_cvt_pk_bf16_f32 v248, v176, -v177
    v_pk_mul_f32 v[194:195], v[176:177], v[184:185] op_sel:[0,0] op_sel_hi:[0,1]
    v_pk_fma_f32 v[174:175], v[176:177], v[184:185], v[194:195] op_sel:[1,1,0] op_sel_hi:[1,0,1] neg_lo:[0,1,0]
    v_cvt_pk_bf16_f32 v249, v174, -v175
    v_pk_mul_f32 v[194:195], v[174:175], v[184:185] op_sel:[0,0] op_sel_hi:[0,1]
    v_pk_fma_f32 v[172:173], v[174:175], v[184:185], v[194:195] op_sel:[1,1,0] op_sel_hi:[1,0,1] neg_lo:[0,1,0]
    v_cvt_pk_bf16_f32 v250, v172, -v173
    v_pk_mul_f32 v[194:195], v[176:177], v[190:191] op_sel:[0,0] op_sel_hi:[0,1]
    v_pk_fma_f32 v[178:179], v[176:177], v[190:191], v[194:195] op_sel:[1,1,0] op_sel_hi:[1,0,1] neg_lo:[0,1,0]
    v_cvt_pk_bf16_f32 v251, v178, -v179
    ds_write_addtid_b32 v242 offset:2720
    ds_write_addtid_b32 v242 offset:3264
    ds_write_addtid_b32 v243 offset:3536
    ds_write_addtid_b32 v244 offset:3808
    ds_write_addtid_b32 v245 offset:4352
    ds_write_addtid_b32 v246 offset:4624
    ds_write_addtid_b32 v247 offset:4896
    ds_write_addtid_b32 v248 offset:5440
    ds_write_addtid_b32 v249 offset:5712
    ds_write_addtid_b32 v250 offset:5984
    ds_write_addtid_b32 v251 offset:6528
    v_pk_mul_f32 v[194:195], v[178:179], v[186:187] op_sel:[0,0] op_sel_hi:[0,1]
    v_pk_fma_f32 v[174:175], v[178:179], v[186:187], v[194:195] op_sel:[1,1,0] op_sel_hi:[1,0,1] neg_lo:[0,1,0]
    v_cvt_pk_bf16_f32 v242, v174, -v175
    v_pk_mul_f32 v[194:195], v[178:179], v[190:191] op_sel:[0,0] op_sel_hi:[0,1]
    v_pk_fma_f32 v[176:177], v[178:179], v[190:191], v[194:195] op_sel:[1,1,0] op_sel_hi:[1,0,1] neg_lo:[0,1,0]
    v_cvt_pk_bf16_f32 v243, v176, -v177
    s_add_u32 s88, s88, 4096
    buffer_store_dwordx4 v[144:147], v148, s[16:19], s88 offen sc1
    v_pk_mul_f32 v[194:195], v[176:177], v[186:187] op_sel:[0,0] op_sel_hi:[0,1]
    v_pk_fma_f32 v[174:175], v[176:177], v[186:187], v[194:195] op_sel:[1,1,0] op_sel_hi:[1,0,1] neg_lo:[0,1,0]
    v_cvt_pk_bf16_f32 v244, v174, -v175
    v_pk_mul_f32 v[194:195], v[176:177], v[190:191] op_sel:[0,0] op_sel_hi:[0,1]
    v_pk_fma_f32 v[178:179], v[176:177], v[190:191], v[194:195] op_sel:[1,1,0] op_sel_hi:[1,0,1] neg_lo:[0,1,0]
    v_cvt_pk_bf16_f32 v245, v178, -v179
    v_pk_mul_f32 v[194:195], v[178:179], v[186:187] op_sel:[0,0] op_sel_hi:[0,1]
    v_pk_fma_f32 v[174:175], v[178:179], v[186:187], v[194:195] op_sel:[1,1,0] op_sel_hi:[1,0,1] neg_lo:[0,1,0]
    v_cvt_pk_bf16_f32 v246, v174, -v175
    v_pk_mul_f32 v[194:195], v[178:179], v[190:191] op_sel:[0,0] op_sel_hi:[0,1]
    v_pk_fma_f32 v[176:177], v[178:179], v[190:191], v[194:195] op_sel:[1,1,0] op_sel_hi:[1,0,1] neg_lo:[0,1,0]
    v_cvt_pk_bf16_f32 v247, v176, -v177
    v_pk_mul_f32 v[194:195], v[176:177], v[186:187] op_sel:[0,0] op_sel_hi:[0,1]
    v_pk_fma_f32 v[174:175], v[176:177], v[186:187], v[194:195] op_sel:[1,1,0] op_sel_hi:[1,0,1] neg_lo:[0,1,0]
    v_cvt_pk_bf16_f32 v248, v174, -v175
    ds_write_addtid_b32 v242 offset:6800
    ds_write_addtid_b32 v243 offset:7072
    ds_write_addtid_b32 v244 offset:7344
    ds_write_addtid_b32 v245 offset:7616
    ds_write_addtid_b32 v246 offset:7888
    ds_write_addtid_b32 v247 offset:8160
    ds_write_addtid_b32 v248 offset:8432
    ds_read_b128 a[192:195], v252 offset:0
    ds_read_b128 a[196:199], v252 offset:32
    ds_read_b128 a[200:203], v252 offset:64
    ds_read_b128 a[204:207], v252 offset:96
    ds_read_b128 a[208:211], v252 offset:128
    ds_read_b128 a[212:215], v252 offset:160
    ds_read_b128 a[216:219], v252 offset:192
    ds_read_b128 a[220:223], v252 offset:224
    v_and_b32 v199, 0xffff0000, v232
    v_mul_f32 v199, 0x3fb8aa3b, v199
    v_exp_f32 v199, v199
    v_and_b32 v255, 0xffff0000, v233
    v_mul_f32 v255, v255, v253
    v_mul_f32_e64 v255, 0x3e22f983, v255
    s_add_u32 s88, s88, 4096
    buffer_store_dwordx4 v[144:147], v148, s[16:19], s88 offen sc1
    v_cvt_pk_bf16_f32 v199, v199, v199
    v_lshlrev_b32 v199, 16, v199
    v_mul_f32 v254, v199, v253
    v_mul_f32 v254, 0xbfb8aa3b, v254
    s_waitcnt lgkmcnt(7)
    v_mfma_f32_32x32x16_bf16 v[216:231], a[192:195], a[160:163], 0
    v_mul_f32 v182, 0x41000000, v254
    v_mul_f32 v185, 0x41000000, v255
    v_mul_f32 v184, 0x43800000, v254
    v_mul_f32 v189, 0x43800000, v255
    s_waitcnt lgkmcnt(6)
    v_mfma_f32_32x32x16_bf16 v[216:231], a[196:199], a[164:167], v[216:231]
    v_fract_f32 v185, v185
    v_fract_f32 v188, v255
    v_fract_f32 v189, v189
    v_exp_f32 v182, v182
    s_waitcnt lgkmcnt(5)
    v_mfma_f32_32x32x16_bf16 v[216:231], a[200:203], a[168:171], v[216:231]
    v_exp_f32 v183, v254
    v_exp_f32 v184, v184
    v_cos_f32 v186, v185
    v_sin_f32 v187, v185
    s_waitcnt lgkmcnt(4)
    v_mfma_f32_32x32x16_bf16 v[216:231], a[204:207], a[172:175], v[216:231]
    v_cos_f32 v180, v188
    v_sin_f32 v181, v188
    v_cos_f32 v190, v189
    v_sin_f32_e64 v191, v189
    s_waitcnt lgkmcnt(3)
    v_mfma_f32_32x32x16_bf16 v[216:231], a[208:211], a[176:179], v[216:231]
    v_and_b32 v192, 0xffff0000, v234
    v_and_b32 v193, 0xffff0000, v235
    v_add_f32 v199, v253, v253
    v_mul_f32 v192, v192, v199
    s_waitcnt lgkmcnt(2)
    v_mfma_f32_32x32x16_bf16 v[216:231], a[212:215], a[180:183], v[216:231]
    v_mul_f32 v193, v193, v199
    v_mul_f32 v186, v186, v182
    v_mul_f32 v187, v187, v182
    v_mul_f32 v180, v180, v183
    s_waitcnt lgkmcnt(1)
    v_mfma_f32_32x32x16_bf16 v[216:231], a[216:219], a[184:187], v[216:231]
    v_mul_f32_e64 v181, v181, v183
    s_add_u32 s88, s88, 4096
    buffer_store_dwordx4 v[144:147], v148, s[16:19], s88 offen sc1
    v_mul_f32 v190, v190, v184
    v_mul_f32_e64 v191, v191, v184
    s_waitcnt lgkmcnt(0)
    v_mfma_f32_32x32x16_bf16 v[216:231], a[220:223], a[188:191], v[216:231]
    v_mov_b32 v242, 0x3f80
    v_cvt_pk_bf16_f32 v243, v186, v187
    v_pk_mul_f32 v[194:195], v[186:187], v[186:187] op_sel:[0,0] op_sel_hi:[0,1]
    v_pk_fma_f32 v[172:173], v[186:187], v[186:187], v[194:195] op_sel:[1,1,0] op_sel_hi:[1,0,1] neg_lo:[0,1,0]
    v_cvt_pk_bf16_f32 v244, v172, v173
    v_pk_mul_f32 v[194:195], v[172:173], v[186:187] op_sel:[0,0] op_sel_hi:[0,1]
    v_pk_fma_f32 v[174:175], v[172:173], v[186:187], v[194:195] op_sel:[1,1,0] op_sel_hi:[1,0,1] neg_lo:[0,1,0]
    v_cvt_pk_bf16_f32 v245, v174, v175
    v_pk_mul_f32 v[194:195], v[174:175], v[186:187] op_sel:[0,0] op_sel_hi:[0,1]
    v_pk_fma_f32 v[172:173], v[174:175], v[186:187], v[194:195] op_sel:[1,1,0] op_sel_hi:[1,0,1] neg_lo:[0,1,0]
    v_cvt_pk_bf16_f32 v246, v172, v173
    v_pk_mul_f32 v[194:195], v[172:173], v[186:187] op_sel:[0,0] op_sel_hi:[0,1]
    v_pk_fma_f32 v[174:175], v[172:173], v[186:187], v[194:195] op_sel:[1,1,0] op_sel_hi:[1,0,1] neg_lo:[0,1,0]
    v_cvt_pk_bf16_f32 v247, v174, v175
    v_pk_mul_f32 v[194:195], v[174:175], v[186:187] op_sel:[0,0] op_sel_hi:[0,1]
    v_pk_fma_f32 v[172:173], v[174:175], v[186:187], v[194:195] op_sel:[1,1,0] op_sel_hi:[1,0,1] neg_lo:[0,1,0]
    v_cvt_pk_bf16_f32 v248, v172, v173
    v_pk_mul_f32 v[194:195], v[172:173], v[186:187] op_sel:[0,0] op_sel_hi:[0,1]
    v_pk_fma_f32 v[174:175], v[172:173], v[186:187], v[194:195] op_sel:[1,1,0] op_sel_hi:[1,0,1] neg_lo:[0,1,0]
    v_cvt_pk_bf16_f32 v249, v174, v175
    v_pk_mul_f32 v[194:195], v[174:175], v[186:187] op_sel:[0,0] op_sel_hi:[0,1]
    v_pk_fma_f32 v[172:173], v[174:175], v[186:187], v[194:195] op_sel:[1,1,0] op_sel_hi:[1,0,1] neg_lo:[0,1,0]
    v_cvt_pk_bf16_f32 v250, v172, v173
    v_pk_mul_f32 v[194:195], v[172:173], v[186:187] op_sel:[0,0] op_sel_hi:[0,1]
    v_pk_fma_f32 v[174:175], v[172:173], v[186:187], v[194:195] op_sel:[1,1,0] op_sel_hi:[1,0,1] neg_lo:[0,1,0]
    v_cvt_pk_bf16_f32 v251, v174, v175
    ds_write_addtid_b32 v242 offset:0
    ds_write_addtid_b32 v243 offset:272
    ds_write_addtid_b32 v244 offset:544
    ds_write_addtid_b32 v245 offset:816
    ds_write_addtid_b32 v246 offset:1088
    ds_write_addtid_b32 v247 offset:1360
    ds_write_addtid_b32 v248 offset:1632
    s_add_u32 s88, s88, 4096
    buffer_store_dwordx4 v[144:147], v148, s[16:19], s88 offen sc1
    ds_write_addtid_b32 v249 offset:1904
    ds_write_addtid_b32 v250 offset:2176
    ds_write_addtid_b32 v251 offset:2448
    v_pk_mul_f32 v[194:195], v[174:175], v[186:187] op_sel:[0,0] op_sel_hi:[0,1]
    v_pk_fma_f32 v[172:173], v[174:175], v[186:187], v[194:195] op_sel:[1,1,0] op_sel_hi:[1,0,1] neg_lo:[0,1,0]
    v_cvt_pk_bf16_f32 v242, v172, v173
    v_pk_mul_f32 v[194:195], v[172:173], v[186:187] op_sel:[0,0] op_sel_hi:[0,1]
    v_pk_fma_f32 v[174:175], v[172:173], v[186:187], v[194:195] op_sel:[1,1,0] op_sel_hi:[1,0,1] neg_lo:[0,1,0]
    v_cvt_pk_bf16_f32 v243, v174, v175
    v_pk_mul_f32 v[194:195], v[174:175], v[186:187] op_sel:[0,0] op_sel_hi:[0,1]
    v_pk_fma_f32 v[172:173], v[174:175], v[186:187], v[194:195] op_sel:[1,1,0] op_sel_hi:[1,0,1] neg_lo:[0,1,0]
    v_cvt_pk_bf16_f32 v244, v172, v173
    v_pk_mul_f32 v[194:195], v[172:173], v[186:187] op_sel:[0,0] op_sel_hi:[0,1]
    v_pk_fma_f32 v[174:175], v[172:173], v[186:187], v[194:195] op_sel:[1,1,0] op_sel_hi:[1,0,1] neg_lo:[0,1,0]
    v_cvt_pk_bf16_f32 v245, v174, v175
    v_pk_mul_f32 v[194:195], v[174:175], v[186:187] op_sel:[0,0] op_sel_hi:[0,1]
    v_pk_fma_f32 v[172:173], v[174:175], v[186:187], v[194:195] op_sel:[1,1,0] op_sel_hi:[1,0,1] neg_lo:[0,1,0]
    v_cvt_pk_bf16_f32 v246, v172, v173
    v_pk_mul_f32 v[194:195], v[172:173], v[186:187] op_sel:[0,0] op_sel_hi:[0,1]
    v_pk_fma_f32 v[174:175], v[172:173], v[186:187], v[194:195] op_sel:[1,1,0] op_sel_hi:[1,0,1] neg_lo:[0,1,0]
    v_cvt_pk_bf16_f32 v247, v174, v175
    v_pk_mul_f32 v[194:195], v[174:175], v[186:187] op_sel:[0,0] op_sel_hi:[0,1]
    v_pk_fma_f32 v[172:173], v[174:175], v[186:187], v[194:195] op_sel:[1,1,0] op_sel_hi:[1,0,1] neg_lo:[0,1,0]
    v_cvt_pk_bf16_f32 v248, v172, v173
    v_pk_mul_f32 v[194:195], v[172:173], v[186:187] op_sel:[0,0] op_sel_hi:[0,1]
    v_pk_fma_f32 v[174:175], v[172:173], v[186:187], v[194:195] op_sel:[1,1,0] op_sel_hi:[1,0,1] neg_lo:[0,1,0]
    v_cvt_pk_bf16_f32 v249, v174, v175
    v_pk_mul_f32 v[194:195], v[174:175], v[186:187] op_sel:[0,0] op_sel_hi:[0,1]
    v_pk_fma_f32 v[172:173], v[174:175], v[186:187], v[194:195] op_sel:[1,1,0] op_sel_hi:[1,0,1] neg_lo:[0,1,0]
    v_cvt_pk_bf16_f32 v250, v172, v173
    v_pk_mul_f32 v[194:195], v[172:173], v[186:187] op_sel:[0,0] op_sel_hi:[0,1]
    v_pk_fma_f32 v[174:175], v[172:173], v[186:187], v[194:195] op_sel:[1,1,0] op_sel_hi:[1,0,1] neg_lo:[0,1,0]
    v_cvt_pk_bf16_f32 v251, v174, v175
    ds_write_addtid_b32 v242 offset:2720
    ds_write_addtid_b32 v243 offset:2992
    ds_write_addtid_b32 v244 offset:3264
    ds_write_addtid_b32 v245 offset:3536
    ds_write_addtid_b32 v246 offset:3808
    ds_write_addtid_b32 v247 offset:4080
    ds_write_addtid_b32 v248 offset:4352
    v_mov_b32 v134, 0x3f803f80
    v_mov_b32 v132, 0
    v_mov_b32 v133, 0
    s_waitcnt vmcnt(10)
    v_dot2c_f32_bf16 v132, v120, v134
    v_dot2c_f32_bf16 v133, v120, v120
    v_dot2c_f32_bf16 v132, v121, v134
    v_dot2c_f32_bf16 v133, v121, v121
    v_dot2c_f32_bf16 v132, v122, v134
    v_dot2c_f32_bf16 v133, v122, v122
    v_dot2c_f32_bf16 v132, v123, v134
    v_dot2c_f32_bf16 v133, v123, v123
    s_waitcnt vmcnt(9)
    v_dot2c_f32_bf16 v132, v124, v134
    v_dot2c_f32_bf16 v133, v124, v124
    v_dot2c_f32_bf16 v132, v125, v134
    v_dot2c_f32_bf16 v133, v125, v125
    v_dot2c_f32_bf16 v132, v126, v134
    v_dot2c_f32_bf16 v133, v126, v126
    v_dot2c_f32_bf16 v132, v127, v134
    v_dot2c_f32_bf16 v133, v127, v127
    s_waitcnt vmcnt(8)
    v_dot2c_f32_bf16 v132, v128, v134
    v_dot2c_f32_bf16 v133, v128, v128
    v_dot2c_f32_bf16 v132, v129, v134
    v_dot2c_f32_bf16 v133, v129, v129
    v_dot2c_f32_bf16 v132, v130, v134
    v_dot2c_f32_bf16 v133, v130, v130
    v_dot2c_f32_bf16 v132, v131, v134
    v_dot2c_f32_bf16 v133, v131, v131
    v_lshrrev_b32 v135, 5, v0
    v_and_b32 v121, 3, v135
    v_lshrrev_b32 v135, 2, v135
    v_add_f32_dpp v132, v132, v132 row_shr:1 row_mask:0xf bank_mask:0xf bound_ctrl:0
    v_add_f32_dpp v133, v133, v133 row_shr:1 row_mask:0xf bank_mask:0xf bound_ctrl:0
    v_lshlrev_b32_e64 v135, 3, v135
    v_add_f32_dpp v132, v132, v132 row_shr:2 row_mask:0xf bank_mask:0xf bound_ctrl:0
    v_add_f32_dpp v133, v133, v133 row_shr:2 row_mask:0xf bank_mask:0xf bound_ctrl:0
    v_lshl_add_u32 v135, v121, 12, v135
    v_add_f32_dpp v132, v132, v132 row_shr:4 row_mask:0xf bank_mask:0xf bound_ctrl:0
    v_add_f32_dpp v133, v133, v133 row_shr:4 row_mask:0xf bank_mask:0xf bound_ctrl:0
    v_and_b32_e64 v121, 31, v0
    v_add_f32_dpp v132, v132, v132 row_shr:8 row_mask:0xf bank_mask:0xf bound_ctrl:0
    v_add_f32_dpp v133, v133, v133 row_shr:8 row_mask:0xf bank_mask:0xf bound_ctrl:0
    v_cmp_eq_u32_e64 vcc, 31, v121
    v_add_f32_dpp v132, v132, v132 row_bcast:15 row_mask:0xa bank_mask:0xf
    v_add_f32_dpp v133, v133, v133 row_bcast:15 row_mask:0xa bank_mask:0xf
    v_mov_b32 v121, 1073741824
    v_cndmask_b32_e64 v120, v121, v135, vcc
    s_lshl_b32 s96, s2, 4
    s_add_u32 s96, s96, 3440640
    v_mul_f32 v135, 0x3acccccd, v132
    v_mul_f32 v133, 0x3acccccd, v133
    v_fma_f32 v133, -v135, v135, v133
    v_max_f32 v133, 0, v133
    v_add_f32 v133, 0x3727c5ac, v133
    v_rsq_f32_e64 v132, v133
    s_nop 0
    v_mul_f32 v133, -v135, v132
    buffer_store_dwordx2 v[132:133], v120, s[16:19], s96 offen sc1
    ds_write_addtid_b32 v249 offset:4624
    ds_write_addtid_b32 v250 offset:4896
    ds_write_addtid_b32 v251 offset:5168
    v_pk_mul_f32 v[194:195], v[174:175], v[186:187] op_sel:[0,0] op_sel_hi:[0,1]
    v_pk_fma_f32 v[172:173], v[174:175], v[186:187], v[194:195] op_sel:[1,1,0] op_sel_hi:[1,0,1] neg_lo:[0,1,0]
    v_cvt_pk_bf16_f32 v242, v172, v173
    v_pk_mul_f32 v[194:195], v[172:173], v[186:187] op_sel:[0,0] op_sel_hi:[0,1]
    v_pk_fma_f32 v[174:175], v[172:173], v[186:187], v[194:195] op_sel:[1,1,0] op_sel_hi:[1,0,1] neg_lo:[0,1,0]
    v_cvt_pk_bf16_f32 v243, v174, v175
    v_pk_mul_f32 v[194:195], v[174:175], v[186:187] op_sel:[0,0] op_sel_hi:[0,1]
    v_pk_fma_f32 v[172:173], v[174:175], v[186:187], v[194:195] op_sel:[1,1,0] op_sel_hi:[1,0,1] neg_lo:[0,1,0]
    v_cvt_pk_bf16_f32 v244, v172, v173
    v_pk_mul_f32 v[194:195], v[172:173], v[186:187] op_sel:[0,0] op_sel_hi:[0,1]
    v_pk_fma_f32 v[174:175], v[172:173], v[186:187], v[194:195] op_sel:[1,1,0] op_sel_hi:[1,0,1] neg_lo:[0,1,0]
    v_cvt_pk_bf16_f32 v245, v174, v175
    v_pk_mul_f32 v[194:195], v[174:175], v[186:187] op_sel:[0,0] op_sel_hi:[0,1]
    v_pk_fma_f32 v[172:173], v[174:175], v[186:187], v[194:195] op_sel:[1,1,0] op_sel_hi:[1,0,1] neg_lo:[0,1,0]
    v_cvt_pk_bf16_f32 v246, v172, v173
    v_pk_mul_f32 v[194:195], v[172:173], v[186:187] op_sel:[0,0] op_sel_hi:[0,1]
    v_pk_fma_f32 v[174:175], v[172:173], v[186:187], v[194:195] op_sel:[1,1,0] op_sel_hi:[1,0,1] neg_lo:[0,1,0]
    v_cvt_pk_bf16_f32 v247, v174, v175
    v_pk_mul_f32 v[194:195], v[174:175], v[186:187] op_sel:[0,0] op_sel_hi:[0,1]
    v_pk_fma_f32 v[172:173], v[174:175], v[186:187], v[194:195] op_sel:[1,1,0] op_sel_hi:[1,0,1] neg_lo:[0,1,0]
    v_cvt_pk_bf16_f32 v248, v172, v173
    v_pk_mul_f32 v[194:195], v[172:173], v[186:187] op_sel:[0,0] op_sel_hi:[0,1]
    v_pk_fma_f32 v[174:175], v[172:173], v[186:187], v[194:195] op_sel:[1,1,0] op_sel_hi:[1,0,1] neg_lo:[0,1,0]
    v_cvt_pk_bf16_f32 v249, v174, v175
    v_pk_mul_f32 v[194:195], v[174:175], v[186:187] op_sel:[0,0] op_sel_hi:[0,1]
    v_pk_fma_f32 v[172:173], v[174:175], v[186:187], v[194:195] op_sel:[1,1,0] op_sel_hi:[1,0,1] neg_lo:[0,1,0]
    v_cvt_pk_bf16_f32 v250, v172, v173
    v_pk_mul_f32 v[194:195], v[172:173], v[186:187] op_sel:[0,0] op_sel_hi:[0,1]
    v_pk_fma_f32 v[174:175], v[172:173], v[186:187], v[194:195] op_sel:[1,1,0] op_sel_hi:[1,0,1] neg_lo:[0,1,0]
    v_cvt_pk_bf16_f32 v251, v174, v175
    ds_write_addtid_b32 v242 offset:5440
    ds_write_addtid_b32 v243 offset:5712
    ds_write_addtid_b32 v244 offset:5984
    ds_write_addtid_b32 v245 offset:6256
    ds_write_addtid_b32 v246 offset:6528
    ds_write_addtid_b32 v247 offset:6800
    ds_write_addtid_b32 v248 offset:7072
    ds_write_addtid_b32 v249 offset:7344
    ds_write_addtid_b32 v250 offset:7616
    ds_write_addtid_b32 v251 offset:7888
    v_pk_mul_f32 v[194:195], v[174:175], v[186:187] op_sel:[0,0] op_sel_hi:[0,1]
    v_pk_fma_f32 v[172:173], v[174:175], v[186:187], v[194:195] op_sel:[1,1,0] op_sel_hi:[1,0,1] neg_lo:[0,1,0]
    v_cvt_pk_bf16_f32 v242, v172, v173
    v_pk_mul_f32 v[194:195], v[172:173], v[186:187] op_sel:[0,0] op_sel_hi:[0,1]
    v_pk_fma_f32 v[174:175], v[172:173], v[186:187], v[194:195] op_sel:[1,1,0] op_sel_hi:[1,0,1] neg_lo:[0,1,0]
    v_cvt_pk_bf16_f32 v243, v174, v175
    ds_write_addtid_b32 v242 offset:8160
    ds_write_addtid_b32 v243 offset:8432
    ds_read_b128 a[160:163], v252 offset:0
    ds_read_b128 a[164:167], v252 offset:32
    ds_read_b128 a[168:171], v252 offset:64
    ds_read_b128 a[172:175], v252 offset:96
    ds_read_b128 a[176:179], v252 offset:128
    ds_read_b128 a[180:183], v252 offset:160
    ds_read_b128 a[184:187], v252 offset:192
    ds_read_b128 a[188:191], v252 offset:224
    v_pk_mul_f32 v[194:195], v[180:181], v[180:181] op_sel:[0,0] op_sel_hi:[0,1]
    buffer_load_dword v7, v4, s[16:19], s87 offen offset:0 sc1
    v_pk_fma_f32 v[182:183], v[180:181], v[180:181], v[194:195] op_sel:[1,1,0] op_sel_hi:[1,0,1] neg_lo:[0,1,0]
    v_pk_mul_f32 v[194:195], v[182:183], v[182:183] op_sel:[0,0] op_sel_hi:[0,1]
    v_pk_fma_f32 v[184:185], v[182:183], v[182:183], v[194:195] op_sel:[1,1,0] op_sel_hi:[1,0,1] neg_lo:[0,1,0]
    v_cvt_pk_bf16_f32 v242, v192, -v193
    v_pk_mul_f32 v[194:195], v[192:193], v[180:181] op_sel:[0,0] op_sel_hi:[0,1]
    v_pk_fma_f32 v[174:175], v[192:193], v[180:181], v[194:195] op_sel:[1,1,0] op_sel_hi:[1,0,1] neg_lo:[0,1,0]
    v_cvt_pk_bf16_f32 v243, v174, -v175
    v_pk_mul_f32 v[194:195], v[174:175], v[180:181] op_sel:[0,0] op_sel_hi:[0,1]
    v_pk_fma_f32 v[172:173], v[174:175], v[180:181], v[194:195] op_sel:[1,1,0] op_sel_hi:[1,0,1] neg_lo:[0,1,0]
    v_cvt_pk_bf16_f32 v244, v172, -v173
    v_pk_mul_f32 v[194:195], v[172:173], v[180:181] op_sel:[0,0] op_sel_hi:[0,1]
    v_pk_fma_f32 v[174:175], v[172:173], v[180:181], v[194:195] op_sel:[1,1,0] op_sel_hi:[1,0,1] neg_lo:[0,1,0]
    v_cvt_pk_bf16_f32 v245, v174, -v175
    v_pk_mul_f32 v[194:195], v[174:175], v[180:181] op_sel:[0,0] op_sel_hi:[0,1]
    v_pk_fma_f32 v[172:173], v[174:175], v[180:181], v[194:195] op_sel:[1,1,0] op_sel_hi:[1,0,1] neg_lo:[0,1,0]
    v_cvt_pk_bf16_f32 v246, v172, -v173
    v_pk_mul_f32 v[194:195], v[172:173], v[180:181] op_sel:[0,0] op_sel_hi:[0,1]
    v_pk_fma_f32 v[174:175], v[172:173], v[180:181], v[194:195] op_sel:[1,1,0] op_sel_hi:[1,0,1] neg_lo:[0,1,0]
    v_cvt_pk_bf16_f32 v247, v174, -v175
    v_pk_mul_f32 v[194:195], v[174:175], v[180:181] op_sel:[0,0] op_sel_hi:[0,1]
    v_pk_fma_f32 v[172:173], v[174:175], v[180:181], v[194:195] op_sel:[1,1,0] op_sel_hi:[1,0,1] neg_lo:[0,1,0]
    v_cvt_pk_bf16_f32 v248, v172, -v173
    v_pk_mul_f32 v[194:195], v[172:173], v[180:181] op_sel:[0,0] op_sel_hi:[0,1]
    v_pk_fma_f32 v[174:175], v[172:173], v[180:181], v[194:195] op_sel:[1,1,0] op_sel_hi:[1,0,1] neg_lo:[0,1,0]
    v_cvt_pk_bf16_f32 v249, v174, -v175
    v_pk_mul_f32 v[194:195], v[192:193], v[190:191] op_sel:[0,0] op_sel_hi:[0,1]
    v_pk_fma_f32 v[176:177], v[192:193], v[190:191], v[194:195] op_sel:[1,1,0] op_sel_hi:[1,0,1] neg_lo:[0,1,0]
    v_cvt_pk_bf16_f32 v250, v176, -v177
    v_pk_mul_f32 v[194:195], v[176:177], v[182:183] op_sel:[0,0] op_sel_hi:[0,1]
    v_pk_fma_f32 v[174:175], v[176:177], v[182:183], v[194:195] op_sel:[1,1,0] op_sel_hi:[1,0,1] neg_lo:[0,1,0]
    v_cvt_pk_bf16_f32 v251, v174, -v175
    ds_write_addtid_b32 v242 offset:0
    ds_write_addtid_b32 v243 offset:272
    ds_write_addtid_b32 v244 offset:544
    ds_write_addtid_b32 v245 offset:816
    ds_write_addtid_b32 v246 offset:1088
    ds_write_addtid_b32 v247 offset:1360
    ds_write_addtid_b32 v248 offset:1632
    ds_write_addtid_b32 v249 offset:1904
    ds_write_addtid_b32 v250 offset:2176
    ds_write_addtid_b32 v251 offset:2448
    v_pk_mul_f32 v[194:195], v[174:175], v[182:183] op_sel:[0,0] op_sel_hi:[0,1]
    v_pk_fma_f32 v[172:173], v[174:175], v[182:183], v[194:195] op_sel:[1,1,0] op_sel_hi:[1,0,1] neg_lo:[0,1,0]
    v_cvt_pk_bf16_f32 v242, v172, -v173
    v_pk_mul_f32 v[194:195], v[172:173], v[182:183] op_sel:[0,0] op_sel_hi:[0,1]
    v_pk_fma_f32 v[174:175], v[172:173], v[182:183], v[194:195] op_sel:[1,1,0] op_sel_hi:[1,0,1] neg_lo:[0,1,0]
    v_cvt_pk_bf16_f32 v243, v174, -v175
    v_pk_mul_f32 v[194:195], v[174:175], v[182:183] op_sel:[0,0] op_sel_hi:[0,1]
    v_pk_fma_f32 v[172:173], v[174:175], v[182:183], v[194:195] op_sel:[1,1,0] op_sel_hi:[1,0,1] neg_lo:[0,1,0]
    v_cvt_pk_bf16_f32 v244, v172, -v173
    v_pk_mul_f32 v[194:195], v[176:177], v[190:191] op_sel:[0,0] op_sel_hi:[0,1]
    v_pk_fma_f32 v[178:179], v[176:177], v[190:191], v[194:195] op_sel:[1,1,0] op_sel_hi:[1,0,1] neg_lo:[0,1,0]
    v_cvt_pk_bf16_f32 v245, v178, -v179
    v_pk_mul_f32 v[194:195], v[178:179], v[184:185] op_sel:[0,0] op_sel_hi:[0,1]
    v_pk_fma_f32 v[174:175], v[178:179], v[184:185], v[194:195] op_sel:[1,1,0] op_sel_hi:[1,0,1] neg_lo:[0,1,0]
    v_cvt_pk_bf16_f32 v246, v174, -v175
    v_pk_mul_f32 v[194:195], v[174:175], v[184:185] op_sel:[0,0] op_sel_hi:[0,1]
    v_pk_fma_f32 v[172:173], v[174:175], v[184:185], v[194:195] op_sel:[1,1,0] op_sel_hi:[1,0,1] neg_lo:[0,1,0]
    v_cvt_pk_bf16_f32 v247, v172, -v173
    v_pk_mul_f32 v[194:195], v[178:179], v[190:191] op_sel:[0,0] op_sel_hi:[0,1]
    v_pk_fma_f32 v[176:177], v[178:179], v[190:191], v[194:195] op_sel:[1,1,0] op_sel_hi:[1,0,1] neg_lo:[0,1,0]
    v_cvt_pk_bf16_f32 v248, v176, -v177
    v_pk_mul_f32 v[194:195], v[176:177], v[184:185] op_sel:[0,0] op_sel_hi:[0,1]
    v_pk_fma_f32 v[174:175], v[176:177], v[184:185], v[194:195] op_sel:[1,1,0] op_sel_hi:[1,0,1] neg_lo:[0,1,0]
    v_cvt_pk_bf16_f32 v249, v174, -v175
    v_pk_mul_f32 v[194:195], v[174:175], v[184:185] op_sel:[0,0] op_sel_hi:[0,1]
    v_pk_fma_f32 v[172:173], v[174:175], v[184:185], v[194:195] op_sel:[1,1,0] op_sel_hi:[1,0,1] neg_lo:[0,1,0]
    v_cvt_pk_bf16_f32 v250, v172, -v173
    v_pk_mul_f32 v[194:195], v[176:177], v[190:191] op_sel:[0,0] op_sel_hi:[0,1]
    v_pk_fma_f32 v[178:179], v[176:177], v[190:191], v[194:195] op_sel:[1,1,0] op_sel_hi:[1,0,1] neg_lo:[0,1,0]
    v_cvt_pk_bf16_f32 v251, v178, -v179
    ds_write_addtid_b32 v242 offset:2720
    ds_write_addtid_b32 v242 offset:3264
    ds_write_addtid_b32 v243 offset:3536
    ds_write_addtid_b32 v244 offset:3808
    ds_write_addtid_b32 v245 offset:4352
    ds_write_addtid_b32 v246 offset:4624
    ds_write_addtid_b32 v247 offset:4896
    ds_write_addtid_b32 v248 offset:5440
    ds_write_addtid_b32 v249 offset:5712
    ds_write_addtid_b32 v250 offset:5984
    ds_write_addtid_b32 v251 offset:6528
    v_pk_mul_f32 v[194:195], v[178:179], v[186:187] op_sel:[0,0] op_sel_hi:[0,1]
    v_pk_fma_f32 v[174:175], v[178:179], v[186:187], v[194:195] op_sel:[1,1,0] op_sel_hi:[1,0,1] neg_lo:[0,1,0]
    v_cvt_pk_bf16_f32 v242, v174, -v175
    v_pk_mul_f32 v[194:195], v[178:179], v[190:191] op_sel:[0,0] op_sel_hi:[0,1]
    v_pk_fma_f32 v[176:177], v[178:179], v[190:191], v[194:195] op_sel:[1,1,0] op_sel_hi:[1,0,1] neg_lo:[0,1,0]
    v_cvt_pk_bf16_f32 v243, v176, -v177
    v_pk_mul_f32 v[194:195], v[176:177], v[186:187] op_sel:[0,0] op_sel_hi:[0,1]
    v_pk_fma_f32 v[174:175], v[176:177], v[186:187], v[194:195] op_sel:[1,1,0] op_sel_hi:[1,0,1] neg_lo:[0,1,0]
    v_cvt_pk_bf16_f32 v244, v174, -v175
    v_pk_mul_f32 v[194:195], v[176:177], v[190:191] op_sel:[0,0] op_sel_hi:[0,1]
    v_pk_fma_f32 v[178:179], v[176:177], v[190:191], v[194:195] op_sel:[1,1,0] op_sel_hi:[1,0,1] neg_lo:[0,1,0]
    v_cvt_pk_bf16_f32 v245, v178, -v179
    v_pk_mul_f32 v[194:195], v[178:179], v[186:187] op_sel:[0,0] op_sel_hi:[0,1]
    v_pk_fma_f32 v[174:175], v[178:179], v[186:187], v[194:195] op_sel:[1,1,0] op_sel_hi:[1,0,1] neg_lo:[0,1,0]
    v_cvt_pk_bf16_f32 v246, v174, -v175
    v_pk_mul_f32 v[194:195], v[178:179], v[190:191] op_sel:[0,0] op_sel_hi:[0,1]
    v_pk_fma_f32 v[176:177], v[178:179], v[190:191], v[194:195] op_sel:[1,1,0] op_sel_hi:[1,0,1] neg_lo:[0,1,0]
    v_cvt_pk_bf16_f32 v247, v176, -v177
    v_pk_mul_f32 v[194:195], v[176:177], v[186:187] op_sel:[0,0] op_sel_hi:[0,1]
    v_pk_fma_f32 v[174:175], v[176:177], v[186:187], v[194:195] op_sel:[1,1,0] op_sel_hi:[1,0,1] neg_lo:[0,1,0]
    v_cvt_pk_bf16_f32 v248, v174, -v175
    ds_write_addtid_b32 v242 offset:6800
    ds_write_addtid_b32 v243 offset:7072
    ds_write_addtid_b32 v244 offset:7344
    ds_write_addtid_b32 v245 offset:7616
    ds_write_addtid_b32 v246 offset:7888
    ds_write_addtid_b32 v247 offset:8160
    ds_write_addtid_b32 v248 offset:8432
    ds_read_b128 a[192:195], v252 offset:0
    ds_read_b128 a[196:199], v252 offset:32
    ds_read_b128 a[200:203], v252 offset:64
    ds_read_b128 a[204:207], v252 offset:96
    ds_read_b128 a[208:211], v252 offset:128
    ds_read_b128 a[212:215], v252 offset:160
    ds_read_b128 a[216:219], v252 offset:192
    ds_read_b128 a[220:223], v252 offset:224
    s_add_u32 m0, s92, 36352
    s_nop 0
    buffer_load_dwordx4 v73, s[4:7], s99 offen offset:0  lds
    v_lshlrev_b32 v199, 16, v236
    v_mul_f32 v199, 0x3fb8aa3b, v199
    v_exp_f32 v199, v199
    v_lshlrev_b32 v255, 16, v237
    v_mul_f32 v255, v255, v253
    v_mul_f32 v255, 0x3e22f983, v255
    v_cvt_pk_bf16_f32 v199, v199, v199
    v_lshlrev_b32 v199, 16, v199
    v_mul_f32 v254, v199, v253
    v_mul_f32 v254, 0xbfb8aa3b, v254
    s_waitcnt lgkmcnt(7)
    v_mfma_f32_32x32x16_bf16 v[216:231], a[192:195], a[160:163], v[216:231]
    s_add_u32 m0, s92, 36352
    s_nop 0
    buffer_load_dwordx4 v74, s[4:7], s99 offen offset:1088  lds
    v_mul_f32 v182, 0x41000000, v254
    v_mul_f32 v185, 0x41000000, v255
    v_mul_f32 v184, 0x43800000, v254
    v_mul_f32 v189, 0x43800000, v255
    s_waitcnt lgkmcnt(6)
    v_mfma_f32_32x32x16_bf16 v[216:231], a[196:199], a[164:167], v[216:231]
    s_add_u32 m0, s92, 36352
    s_nop 0
    buffer_load_dwordx4 v75, s[4:7], s99 offen offset:2176  lds
    v_fract_f32 v185, v185
    v_fract_f32 v188, v255
    v_fract_f32 v189, v189
    v_exp_f32_e64 v182, v182
    s_waitcnt lgkmcnt(5)
    v_mfma_f32_32x32x16_bf16 v[216:231], a[200:203], a[168:171], v[216:231]
    s_add_u32 m0, s92, 36352
    s_nop 0
    buffer_load_dwordx4 v76, s[4:7], s99 offen offset:3264  lds
    v_exp_f32 v183, v254
    v_exp_f32 v184, v184
    v_cos_f32 v186, v185
    v_sin_f32 v187, v185
    s_waitcnt lgkmcnt(4)
    v_mfma_f32_32x32x16_bf16 v[216:231], a[204:207], a[172:175], v[216:231]
    s_add_u32 m0, s93, 53760
    s_add_u32 s99, s99, 256
    s_mov_b64 exec, s[80:81]
    buffer_load_dwordx4 v77, s[4:7], s100 offen  lds
    s_mov_b64 exec, -1
    s_add_u32 s100, s100, 256
    v_cos_f32 v180, v188
    v_sin_f32 v181, v188
    v_cos_f32 v190, v189
    v_sin_f32_e64 v191, v189
    s_waitcnt lgkmcnt(3)
    v_mfma_f32_32x32x16_bf16 v[216:231], a[208:211], a[176:179], v[216:231]
    s_add_u32 m0, s92, 55936
    s_nop 0
    buffer_load_dwordx4 v73, s[4:7], s99 offen offset:0  lds
    v_lshlrev_b32 v192, 16, v238
    v_lshlrev_b32 v193, 16, v239
    v_add_f32 v199, v253, v253
    v_mul_f32 v192, v192, v199
    s_waitcnt lgkmcnt(2)
    v_mfma_f32_32x32x16_bf16 v[216:231], a[212:215], a[180:183], v[216:231]
    s_add_u32 m0, s92, 55936
    s_nop 0
    buffer_load_dwordx4 v74, s[4:7], s99 offen offset:1088  lds
    v_mul_f32 v193, v193, v199
    v_mul_f32 v186, v186, v182
    v_mul_f32 v187, v187, v182
    v_mul_f32 v180, v180, v183
    s_waitcnt lgkmcnt(1)
    v_mfma_f32_32x32x16_bf16 v[216:231], a[216:219], a[184:187], v[216:231]
    s_add_u32 m0, s92, 55936
    s_nop 0
    buffer_load_dwordx4 v75, s[4:7], s99 offen offset:2176  lds
    v_mul_f32 v181, v181, v183
    v_mul_f32 v190, v190, v184
    v_mul_f32_e64 v191, v191, v184
    s_waitcnt lgkmcnt(0)
    v_mfma_f32_32x32x16_bf16 v[216:231], a[220:223], a[188:191], v[216:231]
    s_add_u32 m0, s92, 55936
    s_nop 0
    buffer_load_dwordx4 v76, s[4:7], s99 offen offset:3264  lds
    s_add_u32 m0, s93, 73344
    s_add_u32 s99, s99, 256
    s_mov_b64 exec, s[80:81]
    buffer_load_dwordx4 v77, s[4:7], s100 offen  lds
    s_mov_b64 exec, -1
    s_add_u32 s100, s100, 256
    s_add_u32 m0, s92, 75520
    s_nop 0
    buffer_load_dwordx4 v73, s[4:7], s99 offen offset:0  lds
    s_add_u32 m0, s92, 75520
    s_nop 0
    buffer_load_dwordx4 v74, s[4:7], s99 offen offset:1088  lds
    s_mov_b32 m0, s37
    v_mov_b32 v242, 0x3f80
    v_cvt_pk_bf16_f32 v243, v186, v187
    v_pk_mul_f32 v[194:195], v[186:187], v[186:187] op_sel:[0,0] op_sel_hi:[0,1]
    v_pk_fma_f32 v[172:173], v[186:187], v[186:187], v[194:195] op_sel:[1,1,0] op_sel_hi:[1,0,1] neg_lo:[0,1,0]
    v_cvt_pk_bf16_f32 v244, v172, v173
    v_pk_mul_f32 v[194:195], v[172:173], v[186:187] op_sel:[0,0] op_sel_hi:[0,1]
    v_pk_fma_f32 v[174:175], v[172:173], v[186:187], v[194:195] op_sel:[1,1,0] op_sel_hi:[1,0,1] neg_lo:[0,1,0]
    v_cvt_pk_bf16_f32 v245, v174, v175
    v_pk_mul_f32 v[194:195], v[174:175], v[186:187] op_sel:[0,0] op_sel_hi:[0,1]
    v_pk_fma_f32 v[172:173], v[174:175], v[186:187], v[194:195] op_sel:[1,1,0] op_sel_hi:[1,0,1] neg_lo:[0,1,0]
    v_cvt_pk_bf16_f32 v246, v172, v173
    v_pk_mul_f32 v[194:195], v[172:173], v[186:187] op_sel:[0,0] op_sel_hi:[0,1]
    v_pk_fma_f32 v[174:175], v[172:173], v[186:187], v[194:195] op_sel:[1,1,0] op_sel_hi:[1,0,1] neg_lo:[0,1,0]
    v_cvt_pk_bf16_f32 v247, v174, v175
    v_pk_mul_f32 v[194:195], v[174:175], v[186:187] op_sel:[0,0] op_sel_hi:[0,1]
    v_pk_fma_f32 v[172:173], v[174:175], v[186:187], v[194:195] op_sel:[1,1,0] op_sel_hi:[1,0,1] neg_lo:[0,1,0]
    v_cvt_pk_bf16_f32 v248, v172, v173
    v_pk_mul_f32 v[194:195], v[172:173], v[186:187] op_sel:[0,0] op_sel_hi:[0,1]
    v_pk_fma_f32 v[174:175], v[172:173], v[186:187], v[194:195] op_sel:[1,1,0] op_sel_hi:[1,0,1] neg_lo:[0,1,0]
    v_cvt_pk_bf16_f32 v249, v174, v175
    v_pk_mul_f32 v[194:195], v[174:175], v[186:187] op_sel:[0,0] op_sel_hi:[0,1]
    v_pk_fma_f32 v[172:173], v[174:175], v[186:187], v[194:195] op_sel:[1,1,0] op_sel_hi:[1,0,1] neg_lo:[0,1,0]
    v_cvt_pk_bf16_f32 v250, v172, v173
    v_pk_mul_f32 v[194:195], v[172:173], v[186:187] op_sel:[0,0] op_sel_hi:[0,1]
    s_waitcnt vmcnt(12)
    v_cmp_gt_u32 vcc, 32, v7
    s_nop 0
    s_and_b64 vcc, vcc, s[50:51]
    s_cbranch_scc1 ps_8
pc_10:
    s_barrier
    v_pk_fma_f32 v[174:175], v[172:173], v[186:187], v[194:195] op_sel:[1,1,0] op_sel_hi:[1,0,1] neg_lo:[0,1,0]
    v_cvt_pk_bf16_f32 v251, v174, v175
    ds_write_addtid_b32 v242 offset:0
    ds_write_addtid_b32 v243 offset:272
    ds_write_addtid_b32 v244 offset:544
    ds_write_addtid_b32 v245 offset:816
    ds_write_addtid_b32 v246 offset:1088
    ds_write_addtid_b32 v247 offset:1360
    ds_write_addtid_b32 v248 offset:1632
    ds_write_addtid_b32 v249 offset:1904
    ds_write_addtid_b32 v250 offset:2176
    ds_write_addtid_b32 v251 offset:2448
    v_pk_mul_f32 v[194:195], v[174:175], v[186:187] op_sel:[0,0] op_sel_hi:[0,1]
    v_pk_fma_f32 v[172:173], v[174:175], v[186:187], v[194:195] op_sel:[1,1,0] op_sel_hi:[1,0,1] neg_lo:[0,1,0]
    v_cvt_pk_bf16_f32 v242, v172, v173
    v_pk_mul_f32 v[194:195], v[172:173], v[186:187] op_sel:[0,0] op_sel_hi:[0,1]
    v_pk_fma_f32 v[174:175], v[172:173], v[186:187], v[194:195] op_sel:[1,1,0] op_sel_hi:[1,0,1] neg_lo:[0,1,0]
    v_cvt_pk_bf16_f32 v243, v174, v175
    buffer_load_dwordx4 a[0:3], v200, s[16:19], s101 offen offset:0 sc1
    v_pk_mul_f32 v[194:195], v[174:175], v[186:187] op_sel:[0,0] op_sel_hi:[0,1]
    v_pk_fma_f32 v[172:173], v[174:175], v[186:187], v[194:195] op_sel:[1,1,0] op_sel_hi:[1,0,1] neg_lo:[0,1,0]
    v_cvt_pk_bf16_f32 v244, v172, v173
    v_pk_mul_f32 v[194:195], v[172:173], v[186:187] op_sel:[0,0] op_sel_hi:[0,1]
    v_pk_fma_f32 v[174:175], v[172:173], v[186:187], v[194:195] op_sel:[1,1,0] op_sel_hi:[1,0,1] neg_lo:[0,1,0]
    v_cvt_pk_bf16_f32 v245, v174, v175
    v_pk_mul_f32 v[194:195], v[174:175], v[186:187] op_sel:[0,0] op_sel_hi:[0,1]
    v_pk_fma_f32 v[172:173], v[174:175], v[186:187], v[194:195] op_sel:[1,1,0] op_sel_hi:[1,0,1] neg_lo:[0,1,0]
    v_cvt_pk_bf16_f32 v246, v172, v173
    v_pk_mul_f32 v[194:195], v[172:173], v[186:187] op_sel:[0,0] op_sel_hi:[0,1]
    v_pk_fma_f32 v[174:175], v[172:173], v[186:187], v[194:195] op_sel:[1,1,0] op_sel_hi:[1,0,1] neg_lo:[0,1,0]
    v_cvt_pk_bf16_f32 v247, v174, v175
    v_pk_mul_f32 v[194:195], v[174:175], v[186:187] op_sel:[0,0] op_sel_hi:[0,1]
    v_pk_fma_f32 v[172:173], v[174:175], v[186:187], v[194:195] op_sel:[1,1,0] op_sel_hi:[1,0,1] neg_lo:[0,1,0]
    v_cvt_pk_bf16_f32 v248, v172, v173
    v_pk_mul_f32 v[194:195], v[172:173], v[186:187] op_sel:[0,0] op_sel_hi:[0,1]
    v_pk_fma_f32 v[174:175], v[172:173], v[186:187], v[194:195] op_sel:[1,1,0] op_sel_hi:[1,0,1] neg_lo:[0,1,0]
    v_cvt_pk_bf16_f32 v249, v174, v175
    buffer_load_dwordx4 a[4:7], v200, s[16:19], s101 offen offset:1024 sc1
    v_pk_mul_f32 v[194:195], v[174:175], v[186:187] op_sel:[0,0] op_sel_hi:[0,1]
    v_pk_fma_f32 v[172:173], v[174:175], v[186:187], v[194:195] op_sel:[1,1,0] op_sel_hi:[1,0,1] neg_lo:[0,1,0]
    v_cvt_pk_bf16_f32 v250, v172, v173
    v_pk_mul_f32 v[194:195], v[172:173], v[186:187] op_sel:[0,0] op_sel_hi:[0,1]
    v_pk_fma_f32 v[174:175], v[172:173], v[186:187], v[194:195] op_sel:[1,1,0] op_sel_hi:[1,0,1] neg_lo:[0,1,0]
    v_cvt_pk_bf16_f32 v251, v174, v175
    ds_write_addtid_b32 v242 offset:2720
    ds_write_addtid_b32 v243 offset:2992
    ds_write_addtid_b32 v244 offset:3264
    ds_write_addtid_b32 v245 offset:3536
    ds_write_addtid_b32 v246 offset:3808
    ds_write_addtid_b32 v247 offset:4080
    ds_write_addtid_b32 v248 offset:4352
    ds_write_addtid_b32 v249 offset:4624
    ds_write_addtid_b32 v250 offset:4896
    ds_write_addtid_b32 v251 offset:5168
    v_pk_mul_f32 v[194:195], v[174:175], v[186:187] op_sel:[0,0] op_sel_hi:[0,1]
    v_pk_fma_f32 v[172:173], v[174:175], v[186:187], v[194:195] op_sel:[1,1,0] op_sel_hi:[1,0,1] neg_lo:[0,1,0]
    buffer_load_dwordx4 a[8:11], v200, s[16:19], s101 offen offset:2048 sc1
    v_cvt_pk_bf16_f32 v242, v172, v173
    v_pk_mul_f32 v[194:195], v[172:173], v[186:187] op_sel:[0,0] op_sel_hi:[0,1]
    v_pk_fma_f32 v[174:175], v[172:173], v[186:187], v[194:195] op_sel:[1,1,0] op_sel_hi:[1,0,1] neg_lo:[0,1,0]
    v_cvt_pk_bf16_f32 v243, v174, v175
    v_pk_mul_f32 v[194:195], v[174:175], v[186:187] op_sel:[0,0] op_sel_hi:[0,1]
    v_pk_fma_f32 v[172:173], v[174:175], v[186:187], v[194:195] op_sel:[1,1,0] op_sel_hi:[1,0,1] neg_lo:[0,1,0]
    v_cvt_pk_bf16_f32 v244, v172, v173
    v_pk_mul_f32 v[194:195], v[172:173], v[186:187] op_sel:[0,0] op_sel_hi:[0,1]
    v_pk_fma_f32 v[174:175], v[172:173], v[186:187], v[194:195] op_sel:[1,1,0] op_sel_hi:[1,0,1] neg_lo:[0,1,0]
    v_cvt_pk_bf16_f32 v245, v174, v175
    v_pk_mul_f32 v[194:195], v[174:175], v[186:187] op_sel:[0,0] op_sel_hi:[0,1]
    v_pk_fma_f32 v[172:173], v[174:175], v[186:187], v[194:195] op_sel:[1,1,0] op_sel_hi:[1,0,1] neg_lo:[0,1,0]
    v_cvt_pk_bf16_f32 v246, v172, v173
    v_pk_mul_f32 v[194:195], v[172:173], v[186:187] op_sel:[0,0] op_sel_hi:[0,1]
    v_pk_fma_f32 v[174:175], v[172:173], v[186:187], v[194:195] op_sel:[1,1,0] op_sel_hi:[1,0,1] neg_lo:[0,1,0]
    v_cvt_pk_bf16_f32 v247, v174, v175
    v_pk_mul_f32 v[194:195], v[174:175], v[186:187] op_sel:[0,0] op_sel_hi:[0,1]
    v_pk_fma_f32 v[172:173], v[174:175], v[186:187], v[194:195] op_sel:[1,1,0] op_sel_hi:[1,0,1] neg_lo:[0,1,0]
    buffer_load_dwordx4 a[12:15], v200, s[16:19], s101 offen offset:3072 sc1
    v_cvt_pk_bf16_f32 v248, v172, v173
    v_pk_mul_f32 v[194:195], v[172:173], v[186:187] op_sel:[0,0] op_sel_hi:[0,1]
    v_pk_fma_f32 v[174:175], v[172:173], v[186:187], v[194:195] op_sel:[1,1,0] op_sel_hi:[1,0,1] neg_lo:[0,1,0]
    v_cvt_pk_bf16_f32 v249, v174, v175
    v_pk_mul_f32 v[194:195], v[174:175], v[186:187] op_sel:[0,0] op_sel_hi:[0,1]
    v_pk_fma_f32 v[172:173], v[174:175], v[186:187], v[194:195] op_sel:[1,1,0] op_sel_hi:[1,0,1] neg_lo:[0,1,0]
    v_cvt_pk_bf16_f32 v250, v172, v173
    v_pk_mul_f32 v[194:195], v[172:173], v[186:187] op_sel:[0,0] op_sel_hi:[0,1]
    v_pk_fma_f32 v[174:175], v[172:173], v[186:187], v[194:195] op_sel:[1,1,0] op_sel_hi:[1,0,1] neg_lo:[0,1,0]
    v_cvt_pk_bf16_f32 v251, v174, v175
    ds_write_addtid_b32 v242 offset:5440
    ds_write_addtid_b32 v243 offset:5712
    ds_write_addtid_b32 v244 offset:5984
    ds_write_addtid_b32 v245 offset:6256
    ds_write_addtid_b32 v246 offset:6528
    ds_write_addtid_b32 v247 offset:6800
    ds_write_addtid_b32 v248 offset:7072
    ds_write_addtid_b32 v249 offset:7344
    s_add_u32 s101, s101, 4096
    buffer_load_dwordx4 a[16:19], v200, s[16:19], s101 offen offset:0 sc1
    ds_write_addtid_b32 v250 offset:7616
    ds_write_addtid_b32 v251 offset:7888
    v_pk_mul_f32 v[194:195], v[174:175], v[186:187] op_sel:[0,0] op_sel_hi:[0,1]
    v_pk_fma_f32 v[172:173], v[174:175], v[186:187], v[194:195] op_sel:[1,1,0] op_sel_hi:[1,0,1] neg_lo:[0,1,0]
    v_cvt_pk_bf16_f32 v242, v172, v173
    v_pk_mul_f32 v[194:195], v[172:173], v[186:187] op_sel:[0,0] op_sel_hi:[0,1]
    v_pk_fma_f32 v[174:175], v[172:173], v[186:187], v[194:195] op_sel:[1,1,0] op_sel_hi:[1,0,1] neg_lo:[0,1,0]
    v_cvt_pk_bf16_f32 v243, v174, v175
    ds_write_addtid_b32 v242 offset:8160
    ds_write_addtid_b32 v243 offset:8432
    ds_read_b128 a[160:163], v252 offset:0
    ds_read_b128 a[164:167], v252 offset:32
    ds_read_b128 a[168:171], v252 offset:64
    ds_read_b128 a[172:175], v252 offset:96
    ds_read_b128 a[176:179], v252 offset:128
    ds_read_b128 a[180:183], v252 offset:160
    ds_read_b128 a[184:187], v252 offset:192
    ds_read_b128 a[188:191], v252 offset:224
    buffer_load_dwordx4 a[20:23], v200, s[16:19], s101 offen offset:1024 sc1
    v_pk_mul_f32 v[194:195], v[180:181], v[180:181] op_sel:[0,0] op_sel_hi:[0,1]
    v_pk_fma_f32 v[182:183], v[180:181], v[180:181], v[194:195] op_sel:[1,1,0] op_sel_hi:[1,0,1] neg_lo:[0,1,0]
    v_pk_mul_f32 v[194:195], v[182:183], v[182:183] op_sel:[0,0] op_sel_hi:[0,1]
    v_pk_fma_f32 v[184:185], v[182:183], v[182:183], v[194:195] op_sel:[1,1,0] op_sel_hi:[1,0,1] neg_lo:[0,1,0]
    v_cvt_pk_bf16_f32 v242, v192, -v193
    v_pk_mul_f32 v[194:195], v[192:193], v[180:181] op_sel:[0,0] op_sel_hi:[0,1]
    v_pk_fma_f32 v[174:175], v[192:193], v[180:181], v[194:195] op_sel:[1,1,0] op_sel_hi:[1,0,1] neg_lo:[0,1,0]
    v_cvt_pk_bf16_f32 v243, v174, -v175
    v_pk_mul_f32 v[194:195], v[174:175], v[180:181] op_sel:[0,0] op_sel_hi:[0,1]
    v_pk_fma_f32 v[172:173], v[174:175], v[180:181], v[194:195] op_sel:[1,1,0] op_sel_hi:[1,0,1] neg_lo:[0,1,0]
    v_cvt_pk_bf16_f32 v244, v172, -v173
    v_pk_mul_f32 v[194:195], v[172:173], v[180:181] op_sel:[0,0] op_sel_hi:[0,1]
    v_pk_fma_f32 v[174:175], v[172:173], v[180:181], v[194:195] op_sel:[1,1,0] op_sel_hi:[1,0,1] neg_lo:[0,1,0]
    v_cvt_pk_bf16_f32 v245, v174, -v175
    v_pk_mul_f32 v[194:195], v[174:175], v[180:181] op_sel:[0,0] op_sel_hi:[0,1]
    v_pk_fma_f32 v[172:173], v[174:175], v[180:181], v[194:195] op_sel:[1,1,0] op_sel_hi:[1,0,1] neg_lo:[0,1,0]
    v_cvt_pk_bf16_f32 v246, v172, -v173
    v_pk_mul_f32 v[194:195], v[172:173], v[180:181] op_sel:[0,0] op_sel_hi:[0,1]
    buffer_load_dwordx4 a[24:27], v200, s[16:19], s101 offen offset:2048 sc1
    v_pk_fma_f32 v[174:175], v[172:173], v[180:181], v[194:195] op_sel:[1,1,0] op_sel_hi:[1,0,1] neg_lo:[0,1,0]
    v_cvt_pk_bf16_f32 v247, v174, -v175
    v_pk_mul_f32 v[194:195], v[174:175], v[180:181] op_sel:[0,0] op_sel_hi:[0,1]
    v_pk_fma_f32 v[172:173], v[174:175], v[180:181], v[194:195] op_sel:[1,1,0] op_sel_hi:[1,0,1] neg_lo:[0,1,0]
    v_cvt_pk_bf16_f32 v248, v172, -v173
    v_pk_mul_f32 v[194:195], v[172:173], v[180:181] op_sel:[0,0] op_sel_hi:[0,1]
    v_pk_fma_f32 v[174:175], v[172:173], v[180:181], v[194:195] op_sel:[1,1,0] op_sel_hi:[1,0,1] neg_lo:[0,1,0]
    v_cvt_pk_bf16_f32 v249, v174, -v175
    v_pk_mul_f32 v[194:195], v[192:193], v[190:191] op_sel:[0,0] op_sel_hi:[0,1]
    v_pk_fma_f32 v[176:177], v[192:193], v[190:191], v[194:195] op_sel:[1,1,0] op_sel_hi:[1,0,1] neg_lo:[0,1,0]
    v_cvt_pk_bf16_f32 v250, v176, -v177
    v_pk_mul_f32 v[194:195], v[176:177], v[182:183] op_sel:[0,0] op_sel_hi:[0,1]
    v_pk_fma_f32 v[174:175], v[176:177], v[182:183], v[194:195] op_sel:[1,1,0] op_sel_hi:[1,0,1] neg_lo:[0,1,0]
    v_cvt_pk_bf16_f32 v251, v174, -v175
    ds_write_addtid_b32 v242 offset:0
    ds_write_addtid_b32 v243 offset:272
    ds_write_addtid_b32 v244 offset:544
    ds_write_addtid_b32 v245 offset:816
    buffer_load_dwordx4 a[28:31], v200, s[16:19], s101 offen offset:3072 sc1
    ds_write_addtid_b32 v246 offset:1088
    ds_write_addtid_b32 v247 offset:1360
    ds_write_addtid_b32 v248 offset:1632
    ds_write_addtid_b32 v249 offset:1904
    ds_write_addtid_b32 v250 offset:2176
    ds_write_addtid_b32 v251 offset:2448
    v_pk_mul_f32 v[194:195], v[174:175], v[182:183] op_sel:[0,0] op_sel_hi:[0,1]
    v_pk_fma_f32 v[172:173], v[174:175], v[182:183], v[194:195] op_sel:[1,1,0] op_sel_hi:[1,0,1] neg_lo:[0,1,0]
    v_cvt_pk_bf16_f32 v242, v172, -v173
    v_pk_mul_f32 v[194:195], v[172:173], v[182:183] op_sel:[0,0] op_sel_hi:[0,1]
    v_pk_fma_f32 v[174:175], v[172:173], v[182:183], v[194:195] op_sel:[1,1,0] op_sel_hi:[1,0,1] neg_lo:[0,1,0]
    v_cvt_pk_bf16_f32 v243, v174, -v175
    v_pk_mul_f32 v[194:195], v[174:175], v[182:183] op_sel:[0,0] op_sel_hi:[0,1]
    v_pk_fma_f32 v[172:173], v[174:175], v[182:183], v[194:195] op_sel:[1,1,0] op_sel_hi:[1,0,1] neg_lo:[0,1,0]
    v_cvt_pk_bf16_f32 v244, v172, -v173
    v_pk_mul_f32 v[194:195], v[176:177], v[190:191] op_sel:[0,0] op_sel_hi:[0,1]
    v_pk_fma_f32 v[178:179], v[176:177], v[190:191], v[194:195] op_sel:[1,1,0] op_sel_hi:[1,0,1] neg_lo:[0,1,0]
    v_cvt_pk_bf16_f32 v245, v178, -v179
    s_add_u32 s101, s101, 4096
    buffer_load_dwordx4 a[32:35], v200, s[16:19], s101 offen offset:0 sc1
    v_pk_mul_f32 v[194:195], v[178:179], v[184:185] op_sel:[0,0] op_sel_hi:[0,1]
    v_pk_fma_f32 v[174:175], v[178:179], v[184:185], v[194:195] op_sel:[1,1,0] op_sel_hi:[1,0,1] neg_lo:[0,1,0]
    v_cvt_pk_bf16_f32 v246, v174, -v175
    v_pk_mul_f32 v[194:195], v[174:175], v[184:185] op_sel:[0,0] op_sel_hi:[0,1]
    v_pk_fma_f32 v[172:173], v[174:175], v[184:185], v[194:195] op_sel:[1,1,0] op_sel_hi:[1,0,1] neg_lo:[0,1,0]
    v_cvt_pk_bf16_f32 v247, v172, -v173
    v_pk_mul_f32 v[194:195], v[178:179], v[190:191] op_sel:[0,0] op_sel_hi:[0,1]
    v_pk_fma_f32 v[176:177], v[178:179], v[190:191], v[194:195] op_sel:[1,1,0] op_sel_hi:[1,0,1] neg_lo:[0,1,0]
    v_cvt_pk_bf16_f32 v248, v176, -v177
    v_pk_mul_f32 v[194:195], v[176:177], v[184:185] op_sel:[0,0] op_sel_hi:[0,1]
    v_pk_fma_f32 v[174:175], v[176:177], v[184:185], v[194:195] op_sel:[1,1,0] op_sel_hi:[1,0,1] neg_lo:[0,1,0]
    v_cvt_pk_bf16_f32 v249, v174, -v175
    v_pk_mul_f32 v[194:195], v[174:175], v[184:185] op_sel:[0,0] op_sel_hi:[0,1]
    v_pk_fma_f32 v[172:173], v[174:175], v[184:185], v[194:195] op_sel:[1,1,0] op_sel_hi:[1,0,1] neg_lo:[0,1,0]
    v_cvt_pk_bf16_f32 v250, v172, -v173
    v_pk_mul_f32 v[194:195], v[176:177], v[190:191] op_sel:[0,0] op_sel_hi:[0,1]
    v_pk_fma_f32 v[178:179], v[176:177], v[190:191], v[194:195] op_sel:[1,1,0] op_sel_hi:[1,0,1] neg_lo:[0,1,0]
    v_cvt_pk_bf16_f32 v251, v178, -v179
    buffer_load_dwordx4 a[36:39], v200, s[16:19], s101 offen offset:1024 sc1
    ds_write_addtid_b32 v242 offset:2720
    ds_write_addtid_b32 v242 offset:3264
    ds_write_addtid_b32 v243 offset:3536
    ds_write_addtid_b32 v244 offset:3808
    ds_write_addtid_b32 v245 offset:4352
    ds_write_addtid_b32 v246 offset:4624
    ds_write_addtid_b32 v247 offset:4896
    ds_write_addtid_b32 v248 offset:5440
    ds_write_addtid_b32 v249 offset:5712
    ds_write_addtid_b32 v250 offset:5984
    ds_write_addtid_b32 v251 offset:6528
    v_pk_mul_f32 v[194:195], v[178:179], v[186:187] op_sel:[0,0] op_sel_hi:[0,1]
    v_pk_fma_f32 v[174:175], v[178:179], v[186:187], v[194:195] op_sel:[1,1,0] op_sel_hi:[1,0,1] neg_lo:[0,1,0]
    v_cvt_pk_bf16_f32 v242, v174, -v175
    v_pk_mul_f32 v[194:195], v[178:179], v[190:191] op_sel:[0,0] op_sel_hi:[0,1]
    v_pk_fma_f32 v[176:177], v[178:179], v[190:191], v[194:195] op_sel:[1,1,0] op_sel_hi:[1,0,1] neg_lo:[0,1,0]
    v_cvt_pk_bf16_f32 v243, v176, -v177
    v_pk_mul_f32 v[194:195], v[176:177], v[186:187] op_sel:[0,0] op_sel_hi:[0,1]
    buffer_load_dwordx4 a[40:43], v200, s[16:19], s101 offen offset:2048 sc1
    v_pk_fma_f32 v[174:175], v[176:177], v[186:187], v[194:195] op_sel:[1,1,0] op_sel_hi:[1,0,1] neg_lo:[0,1,0]
    v_cvt_pk_bf16_f32 v244, v174, -v175
    v_pk_mul_f32 v[194:195], v[176:177], v[190:191] op_sel:[0,0] op_sel_hi:[0,1]
    v_pk_fma_f32 v[178:179], v[176:177], v[190:191], v[194:195] op_sel:[1,1,0] op_sel_hi:[1,0,1] neg_lo:[0,1,0]
    v_cvt_pk_bf16_f32 v245, v178, -v179
    v_pk_mul_f32 v[194:195], v[178:179], v[186:187] op_sel:[0,0] op_sel_hi:[0,1]
    v_pk_fma_f32 v[174:175], v[178:179], v[186:187], v[194:195] op_sel:[1,1,0] op_sel_hi:[1,0,1] neg_lo:[0,1,0]
    v_cvt_pk_bf16_f32 v246, v174, -v175
    v_pk_mul_f32 v[194:195], v[178:179], v[190:191] op_sel:[0,0] op_sel_hi:[0,1]
    v_pk_fma_f32 v[176:177], v[178:179], v[190:191], v[194:195] op_sel:[1,1,0] op_sel_hi:[1,0,1] neg_lo:[0,1,0]
    v_cvt_pk_bf16_f32 v247, v176, -v177
    v_pk_mul_f32 v[194:195], v[176:177], v[186:187] op_sel:[0,0] op_sel_hi:[0,1]
    v_pk_fma_f32 v[174:175], v[176:177], v[186:187], v[194:195] op_sel:[1,1,0] op_sel_hi:[1,0,1] neg_lo:[0,1,0]
    v_cvt_pk_bf16_f32 v248, v174, -v175
    ds_write_addtid_b32 v242 offset:6800
    ds_write_addtid_b32 v243 offset:7072
    ds_write_addtid_b32 v244 offset:7344
    ds_write_addtid_b32 v245 offset:7616
    buffer_load_dwordx4 a[44:47], v200, s[16:19], s101 offen offset:3072 sc1
    ds_write_addtid_b32 v246 offset:7888
    ds_write_addtid_b32 v247 offset:8160
    ds_write_addtid_b32 v248 offset:8432
    ds_read_b128 a[192:195], v252 offset:0
    ds_read_b128 a[196:199], v252 offset:32
    ds_read_b128 a[200:203], v252 offset:64
    ds_read_b128 a[204:207], v252 offset:96
    ds_read_b128 a[208:211], v252 offset:128
    ds_read_b128 a[212:215], v252 offset:160
    ds_read_b128 a[216:219], v252 offset:192
    ds_read_b128 a[220:223], v252 offset:224
    s_add_u32 m0, s92, 75520
    s_nop 0
    buffer_load_dwordx4 v75, s[4:7], s99 offen offset:2176  lds
    s_waitcnt lgkmcnt(7)
    v_mfma_f32_32x32x16_bf16 v[216:231], a[192:195], a[160:163], v[216:231]
    s_add_u32 m0, s92, 75520
    s_nop 0
    buffer_load_dwordx4 v76, s[4:7], s99 offen offset:3264  lds
    s_waitcnt lgkmcnt(6)
    v_mfma_f32_32x32x16_bf16 v[216:231], a[196:199], a[164:167], v[216:231]
    s_add_u32 m0, s93, 92928
    s_add_u32 s101, s101, 4096
    buffer_load_dwordx4 a[48:51], v200, s[16:19], s101 offen offset:0 sc1
    s_add_u32 s99, s99, 256
    s_mov_b64 exec, s[80:81]
    buffer_load_dwordx4 v77, s[4:7], s100 offen  lds
    s_mov_b64 exec, -1
    s_add_u32 s100, s100, 256
    s_waitcnt lgkmcnt(5)
    v_mfma_f32_32x32x16_bf16 v[216:231], a[200:203], a[168:171], v[216:231]
    s_add_u32 m0, s92, 95104
    s_nop 0
    buffer_load_dwordx4 v73, s[4:7], s99 offen offset:0  lds
    s_waitcnt lgkmcnt(4)
    v_mfma_f32_32x32x16_bf16 v[216:231], a[204:207], a[172:175], v[216:231]
    s_add_u32 m0, s92, 95104
    s_nop 0
    buffer_load_dwordx4 v74, s[4:7], s99 offen offset:1088  lds
    s_waitcnt lgkmcnt(3)
    v_mfma_f32_32x32x16_bf16 v[216:231], a[208:211], a[176:179], v[216:231]
    s_add_u32 m0, s92, 95104
    s_nop 0
    buffer_load_dwordx4 v75, s[4:7], s99 offen offset:2176  lds
    s_waitcnt lgkmcnt(2)
    v_mfma_f32_32x32x16_bf16 v[216:231], a[212:215], a[180:183], v[216:231]
    s_add_u32 m0, s92, 95104
    s_nop 0
    buffer_load_dwordx4 v76, s[4:7], s99 offen offset:3264  lds
    s_waitcnt lgkmcnt(1)
    v_mfma_f32_32x32x16_bf16 v[216:231], a[216:219], a[184:187], v[216:231]
    buffer_load_dwordx4 a[52:55], v200, s[16:19], s101 offen offset:1024 sc1
    s_add_u32 m0, s93, 112512
    s_add_u32 s99, s99, 256
    s_mov_b64 exec, s[80:81]
    buffer_load_dwordx4 v77, s[4:7], s100 offen  lds
    s_mov_b64 exec, -1
    s_add_u32 s100, s100, 256
    s_waitcnt lgkmcnt(0)
    v_mfma_f32_32x32x16_bf16 v[216:231], a[220:223], a[188:191], v[216:231]
    s_add_u32 m0, s92, 114688
    s_nop 0
    buffer_load_dwordx4 v73, s[4:7], s99 offen offset:0  lds
    s_add_u32 m0, s92, 114688
    s_nop 0
    buffer_load_dwordx4 v74, s[4:7], s99 offen offset:1088  lds
    s_add_u32 m0, s92, 114688
    s_nop 0
    buffer_load_dwordx4 v75, s[4:7], s99 offen offset:2176  lds
    s_add_u32 m0, s92, 114688
    s_nop 0
    buffer_load_dwordx4 v76, s[4:7], s99 offen offset:3264  lds
    s_add_u32 m0, s93, 132096
    s_add_u32 s99, s99, 256
    s_mov_b64 exec, s[80:81]
    buffer_load_dwordx4 v77, s[4:7], s100 offen  lds
    s_mov_b64 exec, -1
    s_add_u32 s100, s100, 256
    s_mov_b32 m0, s37
    s_branch ec_4
nc_3:
    s_sub_u32 s33, s2, 160
    s_min_u32 s33, s33, 159
    s_mul_i32 s29, s33, 3277
    s_lshr_b32 s29, s29, 16
    s_mul_i32 s30, s29, 20
    s_sub_u32 s30, s33, s30
    s_mul_i32 s31, s30, 13108
    s_lshr_b32 s31, s31, 16
    s_mul_i32 s32, s31, 5
    s_sub_u32 s32, s30, s32
    s_lshl_b32 s28, s24, 10
    s_lshr_b32 s34, s32, 1
    s_mul_i32 s34, s34, 20
    s_and_b32 s35, s32, 1
    s_lshl_b32 s35, s35, 3
    s_add_u32 s34, s34, s35
    s_cmp_eq_u32 s32, 4
    s_cselect_b32 s34, 16, s34
    s_cselect_b32 s35, 20, 4
    s_mul_i32 s36, s31, 160
    s_add_u32 s34, s34, s36
    s_mul_i32 s34, s34, 1280
    s_mul_i32 s36, s29, 160
    s_add_u32 s34, s34, s36
    v_add_u32 v162, 0, v0
    v_mul_u32_u24 v160, 6554, v162
    v_lshrrev_b32 v160, 16, v160
    v_mul_u32_u24 v161, 10, v160
    v_sub_u32 v161, v162, v161
    v_lshrrev_b32 v163, 3, v160
    v_mul_u32_u24 v163, 40, v163
    v_bfe_u32 v164, v160, 2, 1
    v_mul_u32_u24 v164, s35, v164
    v_and_b32_e64 v160, 3, v160
    v_add3_u32 v160, v160, v163, v164
    v_mul_u32_u24 v160, 1280, v160
    v_lshl_add_u32 v162, v161, 4, v160
    s_add_u32 m0, s28, 0
    s_nop 0
    buffer_load_dwordx4 v162, s[12:15], s34 offen lds
    v_add_u32 v162, 256, v0
    v_min_u32 v162, 319, v162
    v_mul_u32_u24 v160, 6554, v162
    v_lshrrev_b32 v160, 16, v160
    v_mul_u32_u24 v161, 10, v160
    v_sub_u32 v161, v162, v161
    v_lshrrev_b32 v163, 3, v160
    v_mul_u32_u24 v163, 40, v163
    v_bfe_u32 v164, v160, 2, 1
    v_mul_u32_u24 v164, s35, v164
    v_and_b32_e64 v160, 3, v160
    v_add3_u32 v160, v160, v163, v164
    v_mul_u32_u24 v160, 1280, v160
    v_lshl_add_u32 v162, v161, 4, v160
    s_add_u32 m0, s28, 4096
    s_nop 0
    buffer_load_dwordx4 v162, s[12:15], s34 offen lds
    v_bfe_u32 v163, v0, 4, 2
    v_bfe_u32 v164, v0, 2, 2
    v_lshl_add_u32 v163, v163, 3, v164
    v_mul_u32_u24 v163, 160, v163
    v_and_b32 v164, 3, v0
    v_lshl_add_u32 v165, v164, 3, v163
    v_add_u32 v165, 0, v165
    s_lshl_b32 s36, s24, 5
    v_add_u32_e64 v166, s36, v165
    s_mul_i32 s33, s33, 5120
    s_add_u32 s33, s33, 2621440
    v_lshl_add_u32 v167, v1, 4, s33
    v_add_u32 v164, 4096, v167
    v_mov_b32 v163, 1073741824
    v_cmp_gt_u32 vcc, 64, v0
    s_sub_u32 s36, s24, s31
    s_and_b32 s36, s36, 3
    s_lshl_b32 s36, s36, 10
    v_cndmask_b32 v168, v163, v164, vcc
    v_add_u32 v167, s36, v167
    s_sub_u32 s33, s2, 64
    s_min_u32 s33, s33, 159
    s_mul_i32 s29, s33, 3277
    s_lshr_b32 s29, s29, 16
    s_mul_i32 s30, s29, 20
    s_sub_u32 s30, s33, s30
    s_mul_i32 s31, s30, 13108
    s_lshr_b32 s31, s31, 16
    s_mul_i32 s32, s31, 5
    s_sub_u32 s32, s30, s32
    s_lshl_b32 s28, s24, 10
    s_lshr_b32 s34, s32, 1
    s_mul_i32 s34, s34, 20
    s_and_b32 s35, s32, 1
    s_lshl_b32 s35, s35, 3
    s_add_u32 s34, s34, s35
    s_cmp_eq_u32 s32, 4
    s_cselect_b32 s34, 16, s34
    s_cselect_b32 s35, 20, 4
    s_mul_i32 s36, s31, 160
    s_add_u32 s34, s34, s36
    s_mul_i32 s34, s34, 1280
    s_mul_i32 s36, s29, 160
    s_add_u32 s34, s34, s36
    v_add_u32 v182, 0, v0
    v_mul_u32_u24 v180, 6554, v182
    v_lshrrev_b32 v180, 16, v180
    v_mul_u32_u24 v181, 10, v180
    v_sub_u32 v181, v182, v181
    v_lshrrev_b32 v183, 3, v180
    v_mul_u32_u24 v183, 40, v183
    v_bfe_u32 v184, v180, 2, 1
    v_mul_u32_u24 v184, s35, v184
    v_and_b32_e64 v180, 3, v180
    v_add3_u32 v180, v180, v183, v184
    v_mul_u32_u24 v180, 1280, v180
    v_lshl_add_u32 v182, v181, 4, v180
    s_add_u32 m0, s28, 8192
    s_nop 0
    buffer_load_dwordx4 v182, s[12:15], s34 offen lds
    v_add_u32 v182, 256, v0
    v_min_u32 v182, 319, v182
    v_mul_u32_u24 v180, 6554, v182
    v_lshrrev_b32 v180, 16, v180
    v_mul_u32_u24 v181, 10, v180
    v_sub_u32 v181, v182, v181
    v_lshrrev_b32 v183, 3, v180
    v_mul_u32_u24 v183, 40, v183
    v_bfe_u32 v184, v180, 2, 1
    v_mul_u32_u24 v184, s35, v184
    v_and_b32 v180, 3, v180
    v_add3_u32 v180, v180, v183, v184
    v_mul_u32_u24 v180, 1280, v180
    v_lshl_add_u32 v182, v181, 4, v180
    s_add_u32 m0, s28, 12288
    s_nop 0
    buffer_load_dwordx4 v182, s[12:15], s34 offen lds
    v_bfe_u32 v183, v0, 4, 2
    v_bfe_u32 v184, v0, 2, 2
    v_lshl_add_u32 v183, v183, 3, v184
    v_mul_u32_u24 v183, 160, v183
    v_and_b32 v184, 3, v0
    v_lshl_add_u32 v185, v184, 3, v183
    v_add_u32 v185, 8192, v185
    s_lshl_b32 s36, s24, 5
    v_add_u32 v186, s36, v185
    s_mul_i32 s33, s33, 5120
    s_add_u32 s33, s33, 2621440
    v_lshl_add_u32 v187, v1, 4, s33
    v_add_u32 v184, 4096, v187
    v_mov_b32 v183, 1073741824
    v_cmp_gt_u32 vcc, 64, v0
    s_sub_u32 s36, s24, s31
    s_and_b32 s36, s36, 3
    s_lshl_b32 s36, s36, 10
    v_cndmask_b32 v188, v183, v184, vcc
    v_add_u32 v187, s36, v187
    v_mov_b32 v216, 0
    v_mov_b32 v217, 0
    v_mov_b32 v218, 0
    v_mov_b32 v219, 0
    v_mov_b32 v220, 0
    v_mov_b32 v221, 0
    v_mov_b32 v222, 0
    v_mov_b32 v223, 0
    v_mov_b32 v224, 0
    v_mov_b32 v225, 0
    v_mov_b32 v226, 0
    v_mov_b32 v227, 0
    v_mov_b32 v228, 0
    v_mov_b32 v229, 0
    v_mov_b32 v230, 0
    v_mov_b32_e64 v231, 0
    s_waitcnt vmcnt(5)
    s_barrier
    ds_read_b64_tr_b16 v[96:97], v111
    ds_read_b64_tr_b16 v[98:99], v111 offset:2560
    ds_read_b64_tr_b16 v[100:101], v112
    ds_read_b64_tr_b16 v[102:103], v112 offset:2560
    ds_read_b64_tr_b16 v[104:105], v113
    ds_read_b64_tr_b16 v[106:107], v113 offset:2560
    s_waitcnt lgkmcnt(4)
    buffer_store_dwordx4 v[96:99], v108, s[16:19], 0 offen sc1
    s_waitcnt lgkmcnt(2)
    buffer_store_dwordx4 v[100:103], v109, s[16:19], 0 offen sc1
    s_waitcnt lgkmcnt(0)
    buffer_store_dwordx4 v[104:107], v110, s[16:19], 0 offen sc1
    global_load_dword v7, v5, s[66:67] sc1
    v_lshrrev_b32 v132, 5, v0
    v_and_b32_e64 v133, 31, v0
    v_mul_u32_u24 v132, 1280, v132
    v_lshl_add_u32 v134, v133, 4, v132
    v_mov_b32 v135, 1073741824
    v_cmp_gt_u32 vcc, 16, v133
    s_mul_i32 s96, s2, 10240
    buffer_load_dwordx4 v[120:123], v134, s[4:7], s96 offen
    v_cndmask_b32_e64 v135, v135, v134, vcc
    buffer_load_dwordx4 v[124:127], v134, s[4:7], s96 offen offset:512
    buffer_load_dwordx4 v[128:131], v135, s[4:7], s96 offen offset:1024
    s_waitcnt vmcnt(4)
    s_waitcnt vmcnt(3)
    v_cmp_gt_u32 vcc, 1, v7
    s_nop 0
    s_and_b64 vcc, vcc, s[50:51]
    s_and_b64 vcc, vcc, 1
    s_cbranch_scc1 ps_11
pc_13:
    s_barrier
    v_lshlrev_b32 v2, 3, v4
    v_mov_b32 v5, 1
    v_cndmask_b32 v2, v4, v2, s[50:51]
    buffer_atomic_add v5, v2, s[16:19], s86 offen offset:0 sc1
    ds_read_b64_tr_b16 v[172:173], v166
    ds_read_b64_tr_b16 v[174:175], v166 offset:640
    ds_read_b64_tr_b16 v[176:177], v165 offset:128
    ds_read_b64_tr_b16 v[178:179], v165 offset:768
    s_waitcnt lgkmcnt(2)
    buffer_store_dwordx4 v[172:175], v167, s[16:19], 0 offen sc1
    s_waitcnt lgkmcnt(0)
    buffer_store_dwordx4 v[176:179], v168, s[16:19], 0 offen sc1
    ds_read_b64_tr_b16 v[192:193], v186
    ds_read_b64_tr_b16 v[194:195], v186 offset:640
    ds_read_b64_tr_b16 v[196:197], v185 offset:128
    ds_read_b64_tr_b16 v[198:199], v185 offset:768
    s_waitcnt lgkmcnt(2)
    buffer_store_dwordx4 v[192:195], v187, s[16:19], 0 offen sc1
    s_waitcnt lgkmcnt(0)
    buffer_store_dwordx4 v[196:199], v188, s[16:19], 0 offen sc1
    v_mov_b32 v134, 0x3f803f80
    v_mov_b32 v132, 0
    v_mov_b32 v133, 0
    s_waitcnt vmcnt(7)
    v_dot2c_f32_bf16 v132, v120, v134
    v_dot2c_f32_bf16 v133, v120, v120
    v_dot2c_f32_bf16 v132, v121, v134
    v_dot2c_f32_bf16 v133, v121, v121
    v_dot2c_f32_bf16 v132, v122, v134
    v_dot2c_f32_bf16 v133, v122, v122
    v_dot2c_f32_bf16 v132, v123, v134
    v_dot2c_f32_bf16 v133, v123, v123
    s_waitcnt vmcnt(6)
    v_dot2c_f32_bf16 v132, v124, v134
    v_dot2c_f32_bf16 v133, v124, v124
    v_dot2c_f32_bf16 v132, v125, v134
    v_dot2c_f32_bf16 v133, v125, v125
    v_dot2c_f32_bf16 v132, v126, v134
    v_dot2c_f32_bf16 v133, v126, v126
    v_dot2c_f32_bf16 v132, v127, v134
    v_dot2c_f32_bf16 v133, v127, v127
    s_waitcnt vmcnt(5)
    v_dot2c_f32_bf16 v132, v128, v134
    v_dot2c_f32_bf16 v133, v128, v128
    v_dot2c_f32_bf16 v132, v129, v134
    v_dot2c_f32_bf16 v133, v129, v129
    v_dot2c_f32_bf16 v132, v130, v134
    v_dot2c_f32_bf16 v133, v130, v130
    v_dot2c_f32_bf16 v132, v131, v134
    v_dot2c_f32_bf16 v133, v131, v131
    v_lshrrev_b32 v135, 5, v0
    v_and_b32 v121, 3, v135
    v_lshrrev_b32 v135, 2, v135
    v_add_f32_dpp v132, v132, v132 row_shr:1 row_mask:0xf bank_mask:0xf bound_ctrl:0
    v_add_f32_dpp v133, v133, v133 row_shr:1 row_mask:0xf bank_mask:0xf bound_ctrl:0
    v_lshlrev_b32_e64 v135, 3, v135
    v_add_f32_dpp v132, v132, v132 row_shr:2 row_mask:0xf bank_mask:0xf bound_ctrl:0
    v_add_f32_dpp v133, v133, v133 row_shr:2 row_mask:0xf bank_mask:0xf bound_ctrl:0
    v_lshl_add_u32 v135, v121, 12, v135
    v_add_f32_dpp v132, v132, v132 row_shr:4 row_mask:0xf bank_mask:0xf bound_ctrl:0
    v_add_f32_dpp v133, v133, v133 row_shr:4 row_mask:0xf bank_mask:0xf bound_ctrl:0
    v_and_b32_e64 v121, 31, v0
    v_add_f32_dpp v132, v132, v132 row_shr:8 row_mask:0xf bank_mask:0xf bound_ctrl:0
    v_add_f32_dpp v133, v133, v133 row_shr:8 row_mask:0xf bank_mask:0xf bound_ctrl:0
    v_cmp_eq_u32_e64 vcc, 31, v121
    v_add_f32_dpp v132, v132, v132 row_bcast:15 row_mask:0xa bank_mask:0xf
    v_add_f32_dpp v133, v133, v133 row_bcast:15 row_mask:0xa bank_mask:0xf
    v_mov_b32 v121, 1073741824
    v_cndmask_b32_e64 v120, v121, v135, vcc
    s_lshl_b32 s96, s2, 4
    s_add_u32 s96, s96, 3440640
    v_mul_f32 v135, 0x3acccccd, v132
    v_mul_f32 v133, 0x3acccccd, v133
    v_fma_f32 v133, -v135, v135, v133
    v_max_f32 v133, 0, v133
    v_add_f32 v133, 0x3727c5ac, v133
    v_rsq_f32_e64 v132, v133
    s_nop 0
    v_mul_f32 v133, -v135, v132
    buffer_store_dwordx2 v[132:133], v120, s[16:19], s96 offen sc1
    s_add_u32 m0, s92, 36352
    s_nop 0
    s_nop 0
    buffer_load_dwordx4 v73, s[4:7], s99 offen offset:0  lds
    buffer_load_dwordx4 v74, s[4:7], s99 offen offset:1088  lds
    buffer_load_dwordx4 v75, s[4:7], s99 offen offset:2176  lds
    buffer_load_dwordx4 v76, s[4:7], s99 offen offset:3264  lds
    s_add_u32 m0, s93, 53760
    s_add_u32 s99, s99, 256
    s_mov_b64 exec, s[80:81]
    buffer_load_dwordx4 v77, s[4:7], s100 offen  lds
    s_mov_b64 exec, -1
    s_add_u32 s100, s100, 256
    s_add_u32 m0, s92, 55936
    s_nop 0
    s_nop 0
    buffer_load_dwordx4 v73, s[4:7], s99 offen offset:0  lds
    buffer_load_dwordx4 v74, s[4:7], s99 offen offset:1088  lds
    buffer_load_dwordx4 v75, s[4:7], s99 offen offset:2176  lds
    buffer_load_dwordx4 v76, s[4:7], s99 offen offset:3264  lds
    s_add_u32 m0, s93, 73344
    s_add_u32 s99, s99, 256
    s_mov_b64 exec, s[80:81]
    buffer_load_dwordx4 v77, s[4:7], s100 offen  lds
    s_mov_b64 exec, -1
    s_add_u32 s100, s100, 256
    v_mov_b32 v140, 1073741824
    v_lshlrev_b32 v141, 2, v0
    v_cmp_gt_u32 vcc, 64, v0
    s_nop 1
    v_cndmask_b32 v141, v140, v141, vcc
    v_mov_b32_e64 v140, 0
    s_lshl_b32 s97, s2, 8
    s_add_u32 s97, s97, 3473408
    buffer_store_dword v140, v141, s[16:19], s97 offen sc1
    v_mov_b32 v142, 1073741824
    v_lshlrev_b32 v143, 2, v0
    v_cmp_gt_u32 vcc, 16, v0
    s_nop 1
    v_cndmask_b32 v143, v142, v143, vcc
    v_mov_b32_e64 v142, -1
    s_lshl_b32 s97, s2, 6
    s_add_u32 s97, s97, 3457024
    buffer_store_dword v142, v143, s[16:19], s97 offen sc1
    v_mov_b32 v144, -1
    v_mov_b32 v145, -1
    v_mov_b32 v146, -1
    v_mov_b32 v147, -1
    v_lshlrev_b32 v148, 4, v0
    s_sub_u32 s88, s2, 0
    s_mul_i32 s88, s88, 20480
    s_min_u32 s88, s88, 5222400
    s_add_u32 s88, s88, 4194304
    buffer_store_dwordx4 v[144:147], v148, s[16:19], s88 offen sc1
    s_add_u32 s88, s88, 4096
    buffer_store_dwordx4 v[144:147], v148, s[16:19], s88 offen sc1
    s_add_u32 s88, s88, 4096
    buffer_store_dwordx4 v[144:147], v148, s[16:19], s88 offen sc1
    s_add_u32 s88, s88, 4096
    buffer_store_dwordx4 v[144:147], v148, s[16:19], s88 offen sc1
    s_add_u32 s88, s88, 4096
    buffer_store_dwordx4 v[144:147], v148, s[16:19], s88 offen sc1
    s_add_u32 m0, s92, 75520
    s_nop 0
    s_nop 0
    buffer_load_dwordx4 v73, s[4:7], s99 offen offset:0  lds
    buffer_load_dwordx4 v74, s[4:7], s99 offen offset:1088  lds
    buffer_load_dwordx4 v75, s[4:7], s99 offen offset:2176  lds
    buffer_load_dwordx4 v76, s[4:7], s99 offen offset:3264  lds
    s_add_u32 m0, s93, 92928
    s_add_u32 s99, s99, 256
    s_mov_b64 exec, s[80:81]
    buffer_load_dwordx4 v77, s[4:7], s100 offen  lds
    s_mov_b64 exec, -1
    s_add_u32 s100, s100, 256
    s_add_u32 m0, s92, 95104
    s_nop 0
    s_nop 0
    buffer_load_dwordx4 v73, s[4:7], s99 offen offset:0  lds
    buffer_load_dwordx4 v74, s[4:7], s99 offen offset:1088  lds
    buffer_load_dwordx4 v75, s[4:7], s99 offen offset:2176  lds
    buffer_load_dwordx4 v76, s[4:7], s99 offen offset:3264  lds
    s_add_u32 m0, s93, 112512
    s_add_u32 s99, s99, 256
    s_mov_b64 exec, s[80:81]
    buffer_load_dwordx4 v77, s[4:7], s100 offen  lds
    s_mov_b64 exec, -1
    s_add_u32 s100, s100, 256
    s_add_u32 m0, s92, 114688
    s_nop 0
    s_nop 0
    buffer_load_dwordx4 v73, s[4:7], s99 offen offset:0  lds
    buffer_load_dwordx4 v74, s[4:7], s99 offen offset:1088  lds
    buffer_load_dwordx4 v75, s[4:7], s99 offen offset:2176  lds
    buffer_load_dwordx4 v76, s[4:7], s99 offen offset:3264  lds
    s_add_u32 m0, s93, 132096
    s_add_u32 s99, s99, 256
    s_mov_b64 exec, s[80:81]
    buffer_load_dwordx4 v77, s[4:7], s100 offen  lds
    s_mov_b64 exec, -1
    s_add_u32 s100, s100, 256
    s_waitcnt vmcnt(15)
    buffer_load_dword v7, v4, s[16:19], s87 offen offset:0 sc1
    s_waitcnt vmcnt(0)
    v_cmp_gt_u32_e64 vcc, 32, v7
    s_nop 0
    s_and_b64 vcc, vcc, s[50:51]
    s_cbranch_scc1 ps_14
pc_16:
    s_barrier
    buffer_load_dwordx4 a[0:3], v200, s[16:19], s101 offen offset:0 sc1
    buffer_load_dwordx4 a[4:7], v200, s[16:19], s101 offen offset:1024 sc1
    buffer_load_dwordx4 a[8:11], v200, s[16:19], s101 offen offset:2048 sc1
    buffer_load_dwordx4 a[12:15], v200, s[16:19], s101 offen offset:3072 sc1
    s_add_u32 s101, s101, 4096
    buffer_load_dwordx4 a[16:19], v200, s[16:19], s101 offen offset:0 sc1
    buffer_load_dwordx4 a[20:23], v200, s[16:19], s101 offen offset:1024 sc1
    buffer_load_dwordx4 a[24:27], v200, s[16:19], s101 offen offset:2048 sc1
    buffer_load_dwordx4 a[28:31], v200, s[16:19], s101 offen offset:3072 sc1
    s_add_u32 s101, s101, 4096
    buffer_load_dwordx4 a[32:35], v200, s[16:19], s101 offen offset:0 sc1
    buffer_load_dwordx4 a[36:39], v200, s[16:19], s101 offen offset:1024 sc1
    buffer_load_dwordx4 a[40:43], v200, s[16:19], s101 offen offset:2048 sc1
    buffer_load_dwordx4 a[44:47], v200, s[16:19], s101 offen offset:3072 sc1
    s_add_u32 s101, s101, 4096
    buffer_load_dwordx4 a[48:51], v200, s[16:19], s101 offen offset:0 sc1
    buffer_load_dwordx4 a[52:55], v200, s[16:19], s101 offen offset:1024 sc1
ec_4:
    v_add_u32 v196, 36352, v78
    v_mov_b32 v198, v79
    v_xor_b32 v197, 32, v196
    s_waitcnt vmcnt(34)
    s_barrier
    s_add_u32 s82, s86, 16384
    v_lshlrev_b32 v2, 3, v4
    v_mov_b32 v5, 1
    v_cndmask_b32 v2, v4, v2, s[50:51]
    buffer_atomic_add v5, v2, s[16:19], s82 offen offset:8 sc1
    ds_read_b128 v[160:163], v198 offset:0
    ds_read_b128 v[164:167], v196 offset:0
    ds_read_b128 v[168:171], v196 offset:8704
    ds_read_b128 v[172:175], v198 offset:32
    ds_read_b128 v[176:179], v197 offset:0
    ds_read_b128 v[180:183], v197 offset:8704
    s_waitcnt lgkmcnt(3)
    s_waitcnt vmcnt(14)
    v_mfma_f32_16x16x32_bf16 v[112:115], a[0:3], v[160:163], 0
    ds_read_b128 v[184:187], v198 offset:64
    v_mfma_f32_32x32x16_bf16 v[80:95], a[0:3], v[164:167], 0
    ds_read_b128 v[188:191], v196 offset:64
    v_mov_b32 v208, 0
    v_mov_b32 v209, 0
    v_lshrrev_b32_e64 v210, 5, v0
    v_mul_u32_u24 v210, 1600, v210
    v_mfma_f32_32x32x16_bf16 v[96:111], a[0:3], v[168:171], 0
    ds_read_b128 v[192:195], v196 offset:8768
    buffer_load_dwordx4 a[56:59], v200, s[16:19], s101 offen offset:2048 sc1
    v_and_b32 v211, 31, v0
    v_min_u32 v211, 19, v211
    s_waitcnt lgkmcnt(3)
    s_waitcnt vmcnt(14)
    v_mfma_f32_16x16x32_bf16 v[112:115], a[4:7], v[172:175], v[112:115]
    ds_read_b128 v[160:163], v198 offset:96
    v_mfma_f32_32x32x16_bf16 v[80:95], a[4:7], v[176:179], v[80:95]
    ds_read_b128 v[164:167], v197 offset:64
    v_lshl_add_u32 v210, v211, 3, v210
    v_add_u32 v210, 6400, v210
    ds_write_b64 v210, v[208:209]
    s_mul_i32 s33, s24, 4160
    v_mfma_f32_32x32x16_bf16 v[96:111], a[4:7], v[180:183], v[96:111]
    ds_read_b128 v[168:171], v197 offset:8768
    buffer_load_dwordx4 a[60:63], v200, s[16:19], s101 offen offset:3072 sc1
    s_add_u32 s33, s33, 134272
    v_and_b32_e64 v250, 31, v1
    s_waitcnt lgkmcnt(4)
    s_waitcnt vmcnt(14)
    v_mfma_f32_16x16x32_bf16 v[112:115], a[8:11], v[184:187], v[112:115]
    ds_read_b128 v[172:175], v198 offset:128
    v_mfma_f32_32x32x16_bf16 v[80:95], a[8:11], v[188:191], v[80:95]
    ds_read_b128 v[176:179], v196 offset:128
    v_lshl_add_u32 v250, v250, 4, s33
    v_lshrrev_b32_e64 v253, 5, v1
    v_lshl_add_u32 v251, v253, 3, v250
    v_lshl_add_u32 v252, v253, 9, v250
    v_mfma_f32_32x32x16_bf16 v[96:111], a[8:11], v[192:195], v[96:111]
    ds_read_b128 v[180:183], v196 offset:8832
    s_add_u32 s101, s101, 4096
    buffer_load_dwordx4 a[64:67], v200, s[16:19], s101 offen offset:0 sc1
    v_lshl_add_u32 v250, v253, 10, v250
    s_waitcnt lgkmcnt(3)
    s_waitcnt vmcnt(14)
    v_mfma_f32_16x16x32_bf16 v[112:115], a[12:15], v[160:163], v[112:115]
    ds_read_b128 v[184:187], v198 offset:160
    v_mfma_f32_32x32x16_bf16 v[80:95], a[12:15], v[164:167], v[80:95]
    ds_read_b128 v[188:191], v197 offset:128
    v_cmp_eq_u32 vcc, 0, v1
    v_lshlrev_b32 v254, 16, v241
    v_min_u32 v253, 15, v1
    v_cndmask_b32 v254, 0, v254, vcc
    v_mfma_f32_32x32x16_bf16 v[96:111], a[12:15], v[168:171], v[96:111]
    ds_read_b128 v[192:195], v197 offset:8832
    buffer_load_dwordx4 a[68:71], v200, s[16:19], s101 offen offset:1024 sc1
    v_lshl_add_u32 v253, v253, 2, s33
    v_add_f32_e64 v216, v216, v254
    s_waitcnt lgkmcnt(3)
    s_waitcnt vmcnt(14)
    v_mfma_f32_16x16x32_bf16 v[112:115], a[16:19], v[172:175], v[112:115]
    ds_read_b128 v[160:163], v198 offset:192
    v_mfma_f32_32x32x16_bf16 v[80:95], a[16:19], v[176:179], v[80:95]
    ds_read_b128 v[164:167], v196 offset:192
    v_and_b32 v254, 1, v1
    v_cmp_eq_u32 vcc, 1, v254
    v_mov_b32_e64 v254, 0
    v_cvt_pk_bf16_f32 v242, v216, v217
    v_mfma_f32_32x32x16_bf16 v[96:111], a[16:19], v[180:183], v[96:111]
    ds_read_b128 v[168:171], v196 offset:8896
    buffer_load_dwordx4 a[72:75], v200, s[16:19], s101 offen offset:2048 sc1
    v_cvt_pk_bf16_f32 v243, v218, v219
    v_cvt_pk_bf16_f32 v244, v220, v220
    s_waitcnt lgkmcnt(3)
    s_waitcnt vmcnt(14)
    v_mfma_f32_16x16x32_bf16 v[112:115], a[20:23], v[184:187], v[112:115]
    ds_read_b128 v[172:175], v198 offset:224
    v_mfma_f32_32x32x16_bf16 v[80:95], a[20:23], v[188:191], v[80:95]
    ds_read_b128 v[176:179], v197 offset:192
    v_cvt_pk_bf16_f32 v245, v221, v222
    v_cvt_pk_bf16_f32 v246, v224, v224
    v_cvt_pk_bf16_f32 v247, v224, v225
    v_cvt_pk_bf16_f32 v248, v225, v225
    v_mfma_f32_32x32x16_bf16 v[96:111], a[20:23], v[192:195], v[96:111]
    ds_read_b128 v[180:183], v197 offset:8896
    buffer_load_dwordx4 a[76:79], v200, s[16:19], s101 offen offset:3072 sc1
    v_cvt_pk_bf16_f32 v249, v226, v226
    ds_write_b32 v253, v254
    s_barrier
    s_waitcnt lgkmcnt(4)
    s_waitcnt vmcnt(14)
    v_mfma_f32_16x16x32_bf16 v[112:115], a[24:27], v[160:163], v[112:115]
    v_add_u32 v198, v49, v198
    v_mfma_f32_32x32x16_bf16 v[80:95], a[24:27], v[164:167], v[80:95]
    v_add_u32 v196, 19584, v196
    v_add_u32 v197, 19584, v197
    ds_read_b128 v[184:187], v198 offset:0
    ds_write_b64 v251, v[242:243] offset:64
    ds_write_b64 v251, v[244:245] offset:576
    v_mfma_f32_32x32x16_bf16 v[96:111], a[24:27], v[168:171], v[96:111]
    ds_read_b128 v[188:191], v196 offset:0
    ds_read_b128 v[192:195], v196 offset:8704
    s_add_u32 s101, s101, 4096
    buffer_load_dwordx4 a[80:83], v200, s[16:19], s101 offen offset:0 sc1
    s_waitcnt lgkmcnt(6)
    s_waitcnt vmcnt(14)
    v_mfma_f32_16x16x32_bf16 v[112:115], a[28:31], v[172:175], v[112:115]
    ds_read_b128 v[160:163], v198 offset:32
    v_mfma_f32_32x32x16_bf16 v[80:95], a[28:31], v[176:179], v[80:95]
    ds_read_b128 v[164:167], v197 offset:0
    ds_write_b128 v252, v[246:249] offset:1088
    v_cndmask_b32 v255, v228, v229, vcc
    v_cvt_pk_bf16_f32 v216, v228, v228
    v_mov_b32 v217, v216
    v_mfma_f32_32x32x16_bf16 v[96:111], a[28:31], v[180:183], v[96:111]
    ds_read_b128 v[168:171], v197 offset:8704
    buffer_load_dwordx4 a[84:87], v200, s[16:19], s101 offen offset:1024 sc1
    v_cvt_pk_bf16_f32 v218, v255, v229
    v_cvt_pk_bf16_f32 v219, v229, v229
    s_waitcnt lgkmcnt(4)
    s_waitcnt vmcnt(14)
    v_mfma_f32_16x16x32_bf16 v[112:115], a[32:35], v[184:187], v[112:115]
    ds_read_b128 v[172:175], v198 offset:64
    v_mfma_f32_32x32x16_bf16 v[80:95], a[32:35], v[188:191], v[80:95]
    ds_read_b128 v[176:179], v196 offset:64
    ds_write_b128 v250, v[216:219] offset:2112
    v_cndmask_b32 v255, v230, v231, vcc
    v_cvt_pk_bf16_f32 v220, v230, v230
    v_mov_b32 v221, v220
    v_mfma_f32_32x32x16_bf16 v[96:111], a[32:35], v[192:195], v[96:111]
    ds_read_b128 v[180:183], v196 offset:8768
    buffer_load_dwordx4 a[88:91], v200, s[16:19], s101 offen offset:2048 sc1
    v_cvt_pk_bf16_f32 v222, v255, v231
    v_cvt_pk_bf16_f32 v223, v231, v231
    s_waitcnt lgkmcnt(4)
    s_waitcnt vmcnt(14)
    v_mfma_f32_16x16x32_bf16 v[112:115], a[36:39], v[160:163], v[112:115]
    ds_read_b128 v[184:187], v198 offset:96
    v_mfma_f32_32x32x16_bf16 v[80:95], a[36:39], v[164:167], v[80:95]
    ds_read_b128 v[188:191], v197 offset:64
    ds_write_b128 v250, v[220:223] offset:2624
    v_mfma_f32_32x32x16_bf16 v[96:111], a[36:39], v[168:171], v[96:111]
    ds_read_b128 v[192:195], v197 offset:8768
    buffer_load_dwordx4 a[92:95], v200, s[16:19], s101 offen offset:3072 sc1
    s_waitcnt lgkmcnt(4)
    s_waitcnt vmcnt(14)
    v_mfma_f32_16x16x32_bf16 v[112:115], a[40:43], v[172:175], v[112:115]
    ds_read_b128 v[160:163], v198 offset:128
    v_mfma_f32_32x32x16_bf16 v[80:95], a[40:43], v[176:179], v[80:95]
    ds_read_b128 v[164:167], v196 offset:128
    v_mfma_f32_32x32x16_bf16 v[96:111], a[40:43], v[180:183], v[96:111]
    ds_read_b128 v[168:171], v196 offset:8832
    s_add_u32 s101, s101, 4096
    buffer_load_dwordx4 a[96:99], v200, s[16:19], s101 offen offset:0 sc1
    s_waitcnt lgkmcnt(3)
    s_waitcnt vmcnt(14)
    v_mfma_f32_16x16x32_bf16 v[112:115], a[44:47], v[184:187], v[112:115]
    ds_read_b128 v[172:175], v198 offset:160
    v_mfma_f32_32x32x16_bf16 v[80:95], a[44:47], v[188:191], v[80:95]
    ds_read_b128 v[176:179], v197 offset:128
    v_mfma_f32_32x32x16_bf16 v[96:111], a[44:47], v[192:195], v[96:111]
    ds_read_b128 v[180:183], v197 offset:8832
    buffer_load_dwordx4 a[100:103], v200, s[16:19], s101 offen offset:1024 sc1
    s_waitcnt lgkmcnt(3)
    s_waitcnt vmcnt(14)
    v_mfma_f32_16x16x32_bf16 v[112:115], a[48:51], v[160:163], v[112:115]
    ds_read_b128 v[184:187], v198 offset:192
    v_mfma_f32_32x32x16_bf16 v[80:95], a[48:51], v[164:167], v[80:95]
    ds_read_b128 v[188:191], v196 offset:192
    v_mfma_f32_32x32x16_bf16 v[96:111], a[48:51], v[168:171], v[96:111]
    ds_read_b128 v[192:195], v196 offset:8896
    buffer_load_dwordx4 a[104:107], v200, s[16:19], s101 offen offset:2048 sc1
    s_waitcnt lgkmcnt(3)
    s_waitcnt vmcnt(14)
    v_mfma_f32_16x16x32_bf16 v[112:115], a[52:55], v[172:175], v[112:115]
    ds_read_b128 v[160:163], v198 offset:224
    v_mfma_f32_32x32x16_bf16 v[80:95], a[52:55], v[176:179], v[80:95]
    ds_read_b128 v[164:167], v197 offset:192
    v_mfma_f32_32x32x16_bf16 v[96:111], a[52:55], v[180:183], v[96:111]
    ds_read_b128 v[168:171], v197 offset:8896
    buffer_load_dwordx4 a[108:111], v200, s[16:19], s101 offen offset:3072 sc1
    s_barrier
    s_waitcnt lgkmcnt(3)
    s_waitcnt vmcnt(13)
    v_mfma_f32_16x16x32_bf16 v[112:115], a[56:59], v[184:187], v[112:115]
    v_add_u32 v198, v49, v198
    v_mfma_f32_32x32x16_bf16 v[80:95], a[56:59], v[188:191], v[80:95]
    v_add_u32 v196, 19584, v196
    v_add_u32 v197, 19584, v197
    ds_read_b128 v[172:175], v198 offset:0
    v_mfma_f32_32x32x16_bf16 v[96:111], a[56:59], v[192:195], v[96:111]
    ds_read_b128 v[176:179], v196 offset:0
    ds_read_b128 v[180:183], v196 offset:8704
    s_add_u32 s101, s101, 4096
    buffer_load_dwordx4 a[112:115], v200, s[16:19], s101 offen offset:0 sc1
    s_waitcnt lgkmcnt(3)
    s_waitcnt vmcnt(13)
    v_mfma_f32_16x16x32_bf16 v[112:115], a[60:63], v[160:163], v[112:115]
    ds_read_b128 v[184:187], v198 offset:32
    v_mfma_f32_32x32x16_bf16 v[80:95], a[60:63], v[164:167], v[80:95]
    ds_read_b128 v[188:191], v197 offset:0
    v_mfma_f32_32x32x16_bf16 v[96:111], a[60:63], v[168:171], v[96:111]
    ds_read_b128 v[192:195], v197 offset:8704
    buffer_load_dwordx4 a[116:119], v200, s[16:19], s101 offen offset:1024 sc1
    s_waitcnt lgkmcnt(3)
    s_waitcnt vmcnt(13)
    v_mfma_f32_16x16x32_bf16 v[112:115], a[64:67], v[172:175], v[112:115]
    ds_read_b128 v[160:163], v198 offset:64
    v_mfma_f32_32x32x16_bf16 v[80:95], a[64:67], v[176:179], v[80:95]
    ds_read_b128 v[164:167], v196 offset:64
    v_mfma_f32_32x32x16_bf16 v[96:111], a[64:67], v[180:183], v[96:111]
    ds_read_b128 v[168:171], v196 offset:8768
    buffer_load_dwordx4 a[120:123], v200, s[16:19], s101 offen offset:2048 sc1
    s_waitcnt lgkmcnt(3)
    s_waitcnt vmcnt(13)
    v_mfma_f32_16x16x32_bf16 v[112:115], a[68:71], v[184:187], v[112:115]
    ds_read_b128 v[172:175], v198 offset:96
    v_mfma_f32_32x32x16_bf16 v[80:95], a[68:71], v[188:191], v[80:95]
    ds_read_b128 v[176:179], v197 offset:64
    v_mfma_f32_32x32x16_bf16 v[96:111], a[68:71], v[192:195], v[96:111]
    ds_read_b128 v[180:183], v197 offset:8768
    buffer_load_dwordx4 a[124:127], v200, s[16:19], s101 offen offset:3072 sc1
    s_waitcnt lgkmcnt(3)
    s_waitcnt vmcnt(13)
    v_mfma_f32_16x16x32_bf16 v[112:115], a[72:75], v[160:163], v[112:115]
    ds_read_b128 v[184:187], v198 offset:128
    v_mfma_f32_32x32x16_bf16 v[80:95], a[72:75], v[164:167], v[80:95]
    ds_read_b128 v[188:191], v196 offset:128
    v_mfma_f32_32x32x16_bf16 v[96:111], a[72:75], v[168:171], v[96:111]
    ds_read_b128 v[192:195], v196 offset:8832
    s_add_u32 s101, s101, 4096
    buffer_load_dwordx4 a[128:131], v200, s[16:19], s101 offen offset:0 sc1
    s_waitcnt lgkmcnt(3)
    s_waitcnt vmcnt(13)
    v_mfma_f32_16x16x32_bf16 v[112:115], a[76:79], v[172:175], v[112:115]
    ds_read_b128 v[160:163], v198 offset:160
    v_mfma_f32_32x32x16_bf16 v[80:95], a[76:79], v[176:179], v[80:95]
    ds_read_b128 v[164:167], v197 offset:128
    v_mfma_f32_32x32x16_bf16 v[96:111], a[76:79], v[180:183], v[96:111]
    ds_read_b128 v[168:171], v197 offset:8832
    buffer_load_dwordx4 a[132:135], v200, s[16:19], s101 offen offset:1024 sc1
    s_waitcnt lgkmcnt(3)
    s_waitcnt vmcnt(13)
    v_mfma_f32_16x16x32_bf16 v[112:115], a[80:83], v[184:187], v[112:115]
    ds_read_b128 v[172:175], v198 offset:192
    v_mfma_f32_32x32x16_bf16 v[80:95], a[80:83], v[188:191], v[80:95]
    ds_read_b128 v[176:179], v196 offset:192
    v_mfma_f32_32x32x16_bf16 v[96:111], a[80:83], v[192:195], v[96:111]
    ds_read_b128 v[180:183], v196 offset:8896
    buffer_load_dwordx4 a[136:139], v200, s[16:19], s101 offen offset:2048 sc1
    s_waitcnt lgkmcnt(3)
    s_waitcnt vmcnt(13)
    v_mfma_f32_16x16x32_bf16 v[112:115], a[84:87], v[160:163], v[112:115]
    ds_read_b128 v[184:187], v198 offset:224
    v_mfma_f32_32x32x16_bf16 v[80:95], a[84:87], v[164:167], v[80:95]
    ds_read_b128 v[188:191], v197 offset:192
    v_mfma_f32_32x32x16_bf16 v[96:111], a[84:87], v[168:171], v[96:111]
    ds_read_b128 v[192:195], v197 offset:8896
    buffer_load_dwordx4 a[140:143], v200, s[16:19], s101 offen offset:3072 sc1
    s_barrier
    s_waitcnt lgkmcnt(3)
    s_waitcnt vmcnt(13)
    v_mfma_f32_16x16x32_bf16 v[112:115], a[88:91], v[172:175], v[112:115]
    v_add_u32 v198, v49, v198
    v_mfma_f32_32x32x16_bf16 v[80:95], a[88:91], v[176:179], v[80:95]
    v_add_u32 v196, 19584, v196
    v_add_u32 v197, 19584, v197
    ds_read_b128 v[160:163], v198 offset:0
    v_mfma_f32_32x32x16_bf16 v[96:111], a[88:91], v[180:183], v[96:111]
    ds_read_b128 v[164:167], v196 offset:0
    ds_read_b128 v[168:171], v196 offset:8704
    s_add_u32 s101, s101, 4096
    buffer_load_dword v7, v4, s[16:19], s89 offen offset:8 sc1
    s_waitcnt lgkmcnt(3)
    s_waitcnt vmcnt(13)
    v_mfma_f32_16x16x32_bf16 v[112:115], a[92:95], v[184:187], v[112:115]
    ds_read_b128 v[172:175], v198 offset:32
    v_mfma_f32_32x32x16_bf16 v[80:95], a[92:95], v[188:191], v[80:95]
    ds_read_b128 v[176:179], v197 offset:0
    v_mfma_f32_32x32x16_bf16 v[96:111], a[92:95], v[192:195], v[96:111]
    ds_read_b128 v[180:183], v197 offset:8704
    buffer_load_dwordx4 a[144:147], v200, s[16:19], s101 offen offset:0 sc1
    s_waitcnt lgkmcnt(3)
    s_waitcnt vmcnt(13)
    v_mfma_f32_16x16x32_bf16 v[112:115], a[96:99], v[160:163], v[112:115]
    ds_read_b128 v[184:187], v198 offset:64
    v_mfma_f32_32x32x16_bf16 v[80:95], a[96:99], v[164:167], v[80:95]
    ds_read_b128 v[188:191], v196 offset:64
    v_mfma_f32_32x32x16_bf16 v[96:111], a[96:99], v[168:171], v[96:111]
    ds_read_b128 v[192:195], v196 offset:8768
    buffer_load_dwordx4 a[148:151], v200, s[16:19], s101 offen offset:1024 sc1
    s_waitcnt lgkmcnt(3)
    s_waitcnt vmcnt(13)
    v_mfma_f32_16x16x32_bf16 v[112:115], a[100:103], v[172:175], v[112:115]
    ds_read_b128 v[160:163], v198 offset:96
    v_mfma_f32_32x32x16_bf16 v[80:95], a[100:103], v[176:179], v[80:95]
    ds_read_b128 v[164:167], v197 offset:64
    v_mfma_f32_32x32x16_bf16 v[96:111], a[100:103], v[180:183], v[96:111]
    ds_read_b128 v[168:171], v197 offset:8768
    buffer_load_dwordx4 a[152:155], v200, s[16:19], s101 offen offset:2048 sc1
    s_waitcnt lgkmcnt(3)
    s_waitcnt vmcnt(13)
    v_mfma_f32_16x16x32_bf16 v[112:115], a[104:107], v[184:187], v[112:115]
    ds_read_b128 v[172:175], v198 offset:128
    v_mfma_f32_32x32x16_bf16 v[80:95], a[104:107], v[188:191], v[80:95]
    ds_read_b128 v[176:179], v196 offset:128
    v_mfma_f32_32x32x16_bf16 v[96:111], a[104:107], v[192:195], v[96:111]
    ds_read_b128 v[180:183], v196 offset:8832
    buffer_load_dwordx4 a[156:159], v200, s[16:19], s101 offen offset:3072 sc1
    s_waitcnt lgkmcnt(3)
    s_waitcnt vmcnt(13)
    v_mfma_f32_16x16x32_bf16 v[112:115], a[108:111], v[160:163], v[112:115]
    ds_read_b128 v[184:187], v198 offset:160
    v_mfma_f32_32x32x16_bf16 v[80:95], a[108:111], v[164:167], v[80:95]
    ds_read_b128 v[188:191], v197 offset:128
    v_mfma_f32_32x32x16_bf16 v[96:111], a[108:111], v[168:171], v[96:111]
    ds_read_b128 v[192:195], v197 offset:8832
    s_add_u32 s101, s101, 4096
    s_lshl_b32 s25, s72, 5
    s_add_u32 s25, s25, 256
    s_sub_u32 s26, s25, 4
    s_max_i32 s26, s26, 0
    s_mul_i32 s27, s71, 1280
    s_mul_i32 s99, s25, 5120
    s_mul_i32 s100, s26, 5120
    s_mul_i32 s92, s24, 4352
    s_mul_i32 s93, s24, 544
    s_add_u32 s99, s99, s27
    s_add_u32 s100, s100, s27
    s_waitcnt lgkmcnt(3)
    s_waitcnt vmcnt(12)
    v_mfma_f32_16x16x32_bf16 v[112:115], a[112:115], v[172:175], v[112:115]
    ds_read_b128 v[160:163], v198 offset:192
    v_mfma_f32_32x32x16_bf16 v[80:95], a[112:115], v[176:179], v[80:95]
    ds_read_b128 v[164:167], v196 offset:192
    v_mfma_f32_32x32x16_bf16 v[96:111], a[112:115], v[180:183], v[96:111]
    ds_read_b128 v[168:171], v196 offset:8896
    s_waitcnt lgkmcnt(3)
    s_waitcnt vmcnt(11)
    v_mfma_f32_16x16x32_bf16 v[112:115], a[116:119], v[184:187], v[112:115]
    ds_read_b128 v[172:175], v198 offset:224
    v_mfma_f32_32x32x16_bf16 v[80:95], a[116:119], v[188:191], v[80:95]
    ds_read_b128 v[176:179], v197 offset:192
    v_mfma_f32_32x32x16_bf16 v[96:111], a[116:119], v[192:195], v[96:111]
    ds_read_b128 v[180:183], v197 offset:8896
    s_waitcnt vmcnt(4)
    v_cmp_gt_u32 vcc, 32, v7
    s_nop 0
    s_and_b64 vcc, vcc, s[50:51]
    s_cbranch_scc1 ps_17
pc_19:
    s_barrier
    s_waitcnt lgkmcnt(3)
    v_mfma_f32_16x16x32_bf16 v[112:115], a[120:123], v[160:163], v[112:115]
    v_add_u32_e64 v198, v49, v198
    v_mfma_f32_32x32x16_bf16 v[80:95], a[120:123], v[164:167], v[80:95]
    v_add_u32 v196, 19584, v196
    v_add_u32 v197, 19584, v197
    s_lshl_b32 s31, s24, 7
    s_add_u32 s31, s31, 160768
    v_bfe_u32 v132, v1, 3, 1
    v_mfma_f32_32x32x16_bf16 v[96:111], a[120:123], v[168:171], v[96:111]
    ds_read_b128 v[184:187], v198 offset:0
    ds_read_b128 v[188:191], v196 offset:0
    s_lshl_b32 s98, s72, 5
    s_add_u32 s98, s98, 0
    s_sub_u32 s95, s98, 4
    s_max_i32 s95, s95, 0
    s_lshl_b32 s94, s98, 3
    s_lshl_b32 s95, s95, 3
    s_add_u32 s94, s94, 3440640
    s_add_u32 s95, s95, 3440640
    s_add_u32 s96, s94, 8192
    buffer_load_dwordx2 v[152:153], v47, s[16:19], s94 offen sc1
    v_lshrrev_b32 v133, 4, v1
    v_lshl_add_u32 v132, v132, 2, v133
    s_waitcnt lgkmcnt(2)
    v_mfma_f32_16x16x32_bf16 v[112:115], a[124:127], v[172:175], v[112:115]
    ds_read_b128 v[192:195], v198 offset:32
    v_mfma_f32_32x32x16_bf16 v[80:95], a[124:127], v[176:179], v[80:95]
    ds_read_b128 v[160:163], v197 offset:0
    v_lshl_add_u32 v132, v132, 4, s31
    v_lshrrev_b32 v133, 5, v1
    v_lshl_add_u32 v133, v133, 4, s31
    v_mfma_f32_32x32x16_bf16 v[96:111], a[124:127], v[180:183], v[96:111]
    buffer_load_dwordx2 v[154:155], v47, s[16:19], s96 offen sc1
    s_waitcnt lgkmcnt(2)
    v_mfma_f32_16x16x32_bf16 v[112:115], a[128:131], v[184:187], v[112:115]
    ds_read_b128 v[164:167], v198 offset:64
    v_mfma_f32_32x32x16_bf16 v[80:95], a[128:131], v[188:191], v[80:95]
    ds_read_b128 v[168:171], v196 offset:64
    s_waitcnt lgkmcnt(2)
    v_mfma_f32_16x16x32_bf16 v[112:115], a[132:135], v[192:195], v[112:115]
    ds_read_b128 v[172:175], v198 offset:96
    v_mfma_f32_32x32x16_bf16 v[80:95], a[132:135], v[160:163], v[80:95]
    ds_read_b128 v[176:179], v197 offset:64
    buffer_load_dwordx2 v[156:157], v48, s[16:19], s95 offen sc1
    s_waitcnt lgkmcnt(2)
    v_mfma_f32_16x16x32_bf16 v[112:115], a[136:139], v[164:167], v[112:115]
    ds_read_b128 v[180:183], v198 offset:128
    v_mfma_f32_32x32x16_bf16 v[80:95], a[136:139], v[168:171], v[80:95]
    ds_read_b128 v[184:187], v196 offset:128
    s_waitcnt lgkmcnt(2)
    v_mfma_f32_16x16x32_bf16 v[112:115], a[140:143], v[172:175], v[112:115]
    ds_read_b128 v[188:191], v198 offset:160
    v_mfma_f32_32x32x16_bf16 v[80:95], a[140:143], v[176:179], v[80:95]
    ds_read_b128 v[192:195], v197 offset:128
    s_add_u32 m0, s92, 36352
    s_nop 0
    buffer_load_dwordx4 v73, s[4:7], s99 offen offset:0  lds
    s_waitcnt lgkmcnt(2)
    s_waitcnt vmcnt(7)
    v_mfma_f32_16x16x32_bf16 v[112:115], a[144:147], v[180:183], v[112:115]
    ds_read_b128 v[160:163], v198 offset:192
    v_mfma_f32_32x32x16_bf16 v[80:95], a[144:147], v[184:187], v[80:95]
    ds_read_b128 v[164:167], v196 offset:192
    s_waitcnt lgkmcnt(2)
    s_waitcnt vmcnt(6)
    v_mfma_f32_16x16x32_bf16 v[112:115], a[148:151], v[188:191], v[112:115]
    ds_read_b128 v[168:171], v198 offset:224
    v_mfma_f32_32x32x16_bf16 v[80:95], a[148:151], v[192:195], v[80:95]
    ds_read_b128 v[172:175], v197 offset:192
    buffer_load_dwordx4 v74, s[4:7], s99 offen offset:1088  lds
    s_waitcnt lgkmcnt(2)
    s_waitcnt vmcnt(6)
    v_mfma_f32_16x16x32_bf16 v[112:115], a[152:155], v[160:163], v[112:115]
    ds_read_b128 v[176:179], v196 offset:8704
    v_mfma_f32_32x32x16_bf16 v[80:95], a[152:155], v[164:167], v[80:95]
    ds_read_b128 v[180:183], v197 offset:8704
    s_waitcnt lgkmcnt(2)
    s_waitcnt vmcnt(5)
    v_mfma_f32_16x16x32_bf16 v[112:115], a[156:159], v[168:171], v[112:115]
    ds_read_b128 v[184:187], v196 offset:8768
    v_mfma_f32_32x32x16_bf16 v[80:95], a[156:159], v[172:175], v[80:95]
    ds_read_b128 v[188:191], v197 offset:8768
    buffer_load_dwordx4 v75, s[4:7], s99 offen offset:2176  lds
    s_waitcnt lgkmcnt(2)
    v_mfma_f32_32x32x16_bf16 v[96:111], a[128:131], v[176:179], v[96:111]
    ds_read_b128 v[192:195], v196 offset:8832
    v_mfma_f32_32x32x16_bf16 v[96:111], a[132:135], v[180:183], v[96:111]
    ds_read_b128 v[160:163], v197 offset:8832
    buffer_load_dwordx4 v76, s[4:7], s99 offen offset:3264  lds
    s_mov_b32 exec_lo, 0x01010101
    s_mov_b32 exec_hi, 0x01010101
    ds_write_b128 v132, v[112:115]
    s_mov_b64 exec, -1
    s_waitcnt lgkmcnt(3)
    v_mfma_f32_32x32x16_bf16 v[96:111], a[136:139], v[184:187], v[96:111]
    ds_read_b128 v[164:167], v196 offset:8896
    ds_read_b128 v[24:27], v132
    ds_read_b128 v[8:11], v133 offset:0
    ds_read_b128 v[12:15], v133 offset:32
    ds_read_b128 v[16:19], v133 offset:64
    v_mfma_f32_32x32x16_bf16 v[96:111], a[140:143], v[188:191], v[96:111]
    ds_read_b128 v[168:171], v197 offset:8896
    s_add_u32 m0, s93, 53760
    s_add_u32 s99, s99, 256
    s_mov_b64 exec, s[80:81]
    buffer_load_dwordx4 v77, s[4:7], s100 offen  lds
    s_mov_b64 exec, -1
    s_add_u32 s100, s100, 256
    ds_read_b128 v[20:23], v133 offset:96
    s_waitcnt vmcnt(5) lgkmcnt(5)
    v_mul_f32 v148, v24, v157
    v_mfma_f32_32x32x16_bf16 v[96:111], a[144:147], v[192:195], v[96:111]
    v_mul_f32 v149, v25, v157
    v_mul_f32 v150, v26, v157
    v_mul_f32 v151, v27, v157
    s_waitcnt lgkmcnt(4)
    v_mul_f32 v116, v8, v153
    v_mul_f32 v117, v9, v153
    v_mfma_f32_32x32x16_bf16 v[96:111], a[148:151], v[160:163], v[96:111]
    v_mul_f32 v118, v10, v153
    v_mul_f32 v119, v11, v153
    s_waitcnt lgkmcnt(3)
    v_mul_f32 v120, v12, v153
    v_mul_f32 v121, v13, v153
    s_waitcnt lgkmcnt(1)
    v_mfma_f32_32x32x16_bf16 v[96:111], a[152:155], v[164:167], v[96:111]
    v_mul_f32 v122, v14, v153
    v_mul_f32 v123, v15, v153
    v_mul_f32 v124, v16, v153
    v_mul_f32 v125, v17, v153
    v_mul_f32_e64 v126, v18, v153
    v_mfma_f32_32x32x16_bf16 v[96:111], a[156:159], v[168:171], v[96:111]
    s_add_u32 m0, s92, 55936
    s_nop 0
    buffer_load_dwordx4 v73, s[4:7], s99 offen offset:0  lds
    v_mul_f32 v127, v19, v153
    s_waitcnt lgkmcnt(0)
    v_mul_f32 v128, v20, v153
    v_mul_f32 v129, v21, v153
    v_mul_f32 v130, v22, v153
    v_mul_f32_e64 v131, v23, v153
    v_fma_f32 v112, v112, v156, v148
    v_fma_f32 v113, v113, v156, v149
    v_fma_f32 v114, v114, v156, v150
    v_fma_f32 v115, v115, v156, v151
    v_cvt_pk_bf16_f32 v112, v112, v113
    v_cvt_pk_bf16_f32 v113, v114, v115
    v_fma_f32 v80, v80, v152, v116
    v_fma_f32 v81, v81, v152, v117
    v_fma_f32 v82, v82, v152, v118
    v_fma_f32 v83, v83, v152, v119
    v_cvt_pk_bf16_f32 v80, v80, v81
    v_cvt_pk_bf16_f32 v81, v82, v83
    ds_write_b64 v40, v[112:113] offset:0
    ds_write_b64 v38, v[80:81] offset:0
    v_fma_f32 v84, v84, v152, v120
    v_fma_f32 v85, v85, v152, v121
    v_fma_f32 v86, v86, v152, v122
    v_fma_f32 v87, v87, v152, v123
    v_cvt_pk_bf16_f32 v84, v84, v85
    v_cvt_pk_bf16_f32 v85, v86, v87
    v_fma_f32 v88, v88, v152, v124
    v_fma_f32 v89, v89, v152, v125
    v_fma_f32 v90, v90, v152, v126
    v_fma_f32 v91, v91, v152, v127
    v_cvt_pk_bf16_f32 v88, v88, v89
    v_cvt_pk_bf16_f32 v89, v90, v91
    ds_write_b64 v38, v[84:85] offset:6400
    ds_write_b64 v38, v[88:89] offset:12800
    v_fma_f32 v92, v92, v152, v128
    v_fma_f32 v93, v93, v152, v129
    v_fma_f32 v94, v94, v152, v130
    v_fma_f32 v95, v95, v152, v131
    v_cvt_pk_bf16_f32 v92, v92, v93
    v_cvt_pk_bf16_f32 v93, v94, v95
    ds_write_b64 v39, v[92:93] offset:0
    v_mul_f32 v132, v8, v155
    v_mul_f32 v133, v9, v155
    v_mul_f32 v134, v10, v155
    v_mul_f32 v135, v11, v155
    v_mul_f32 v136, v12, v155
    v_mul_f32 v137, v13, v155
    v_mul_f32 v138, v14, v155
    v_mul_f32 v139, v15, v155
    v_mul_f32 v140, v16, v155
    v_mul_f32 v141, v17, v155
    v_mul_f32 v142, v18, v155
    v_mul_f32 v143, v19, v155
    v_mul_f32 v144, v20, v155
    v_mul_f32 v145, v21, v155
    v_mul_f32 v146, v22, v155
    v_mul_f32 v147, v23, v155
    v_pk_fma_f32 v[96:97], v[96:97], v[154:155], v[132:133] op_sel_hi:[1,0,1]
    v_pk_fma_f32 v[98:99], v[98:99], v[154:155], v[134:135] op_sel_hi:[1,0,1]
    v_cvt_pk_bf16_f32 v96, v96, v97
    v_cvt_pk_bf16_f32 v97, v98, v99
    v_pk_fma_f32 v[100:101], v[100:101], v[154:155], v[136:137] op_sel_hi:[1,0,1]
    v_pk_fma_f32 v[102:103], v[102:103], v[154:155], v[138:139] op_sel_hi:[1,0,1]
    v_cvt_pk_bf16_f32 v100, v100, v101
    v_cvt_pk_bf16_f32 v101, v102, v103
    ds_write_b64 v38, v[96:97] offset:1600
    ds_write_b64 v38, v[100:101] offset:8000
    v_pk_fma_f32 v[104:105], v[104:105], v[154:155], v[140:141] op_sel_hi:[1,0,1]
    v_pk_fma_f32 v[106:107], v[106:107], v[154:155], v[142:143] op_sel_hi:[1,0,1]
    v_cvt_pk_bf16_f32 v104, v104, v105
    v_cvt_pk_bf16_f32 v105, v106, v107
    v_pk_fma_f32 v[108:109], v[108:109], v[154:155], v[144:145] op_sel_hi:[1,0,1]
    v_pk_fma_f32 v[110:111], v[110:111], v[154:155], v[146:147] op_sel_hi:[1,0,1]
    v_cvt_pk_bf16_f32 v108, v108, v109
    v_cvt_pk_bf16_f32 v109, v110, v111
    ds_write_b64 v38, v[104:105] offset:14400
    ds_write_b64 v39, v[108:109] offset:1600
    s_waitcnt lgkmcnt(0)
    s_barrier
    v_mov_b32 v94, 0
    v_mov_b32 v95, 0
    v_mov_b32 v98, 0
    v_mov_b32 v99, 0
    s_mov_b64 exec, 0xffff
    ds_read_b64 v[94:95], v42 offset:320
    ds_read_b64 v[98:99], v42 offset:640
    s_mov_b64 exec, -1
    s_nop 0
    ds_read_b64 v[92:93], v41 offset:320
    ds_read_b64 v[96:97], v41 offset:640
    ds_read_b64 v[84:85], v41 offset:6720
    ds_read_b64 v[86:87], v42 offset:6720
    ds_read_b64 v[80:81], v41 offset:6400
    ds_read_b64 v[82:83], v42 offset:6400
    ds_read_b64 v[88:89], v41 offset:7040
    ds_read_b64 v[90:91], v42 offset:7040
    ds_read_b64_tr_b16 v[106:107], v44 offset:0
    ds_read_b64_tr_b16 v[100:101], v43 offset:0
    ds_read_b64_tr_b16 v[108:109], v44 offset:320
    ds_read_b64_tr_b16 v[102:103], v43 offset:320
    buffer_load_dwordx4 v74, s[4:7], s99 offen offset:1088  lds
    ds_read_b64_tr_b16 v[110:111], v44 offset:640
    ds_read_b64_tr_b16 v[104:105], v43 offset:640
    v_mov_b32 v156, 0xf149f2ca
    v_cndmask_b32 v152, v32, v156, s[90:91]
    v_cndmask_b32 v153, v33, v156, s[90:91]
    v_cndmask_b32 v154, v34, v156, s[90:91]
    v_cndmask_b32 v155, v35, v156, s[90:91]
    s_mov_b32 s82, 0x3ea52b5c
    buffer_load_dwordx4 v75, s[4:7], s99 offen offset:2176  lds
    s_lshl_b32 s25, s98, 4
    s_add_u32 s25, s25, 4194304
    s_lshl_b32 s26, s98, 3
    s_add_u32 s26, s26, 4194304
    s_waitcnt lgkmcnt(10)
    v_mfma_f32_16x16x32_bf16 v[116:119], v[84:87], v[92:95], v[28:31]
    v_mfma_f32_16x16x32_bf16 v[120:123], v[84:87], v[96:99], v[32:35]
    s_waitcnt lgkmcnt(8)
    v_mfma_f32_16x16x32_bf16 v[112:115], v[80:83], v[92:95], v[152:155]
    s_waitcnt lgkmcnt(6)
    v_mfma_f32_16x16x32_bf16 v[124:127], v[88:91], v[96:99], v[28:31]
    buffer_load_dwordx4 v76, s[4:7], s99 offen offset:3264  lds
    s_nop 4
    v_max_f32 v112, v112, v116
    v_max_f32 v113, v113, v117
    v_max_f32 v114, v114, v118
    v_max_f32 v115, v115, v119
    v_max3_f32 v156, v112, v113, v114
    v_max_f32 v156, v156, v115
    v_max_f32 v120, v120, v124
    v_max_f32_e64 v121, v121, v125
    s_add_u32 m0, s93, 73344
    s_add_u32 s99, s99, 256
    s_mov_b64 exec, s[80:81]
    buffer_load_dwordx4 v77, s[4:7], s100 offen  lds
    s_mov_b64 exec, -1
    s_add_u32 s100, s100, 256
    v_max_f32 v122, v122, v126
    v_max_f32 v123, v123, v127
    v_max3_f32 v157, v120, v121, v122
    v_max_f32 v157, v157, v123
    s_nop 1
    v_permlane16_swap_b32 v156, v157
    v_max_f32 v156, v156, v157
    v_mov_b32 v157, v156
    s_nop 1
    v_permlane32_swap_b32 v156, v157
    s_add_u32 m0, s92, 75520
    s_nop 0
    buffer_load_dwordx4 v73, s[4:7], s99 offen offset:0  lds
    v_max_f32 v156, v156, v157
    v_mul_f32 v156, s82, v156
    v_mov_b32 v157, v156
    s_nop 1
    v_permlane16_swap_b32_e64 v156, v157
    v_fma_f32 v112, v112, s82, -v156
    v_fma_f32 v113, v113, s82, -v156
    v_fma_f32 v114, v114, s82, -v156
    v_fma_f32 v115, v115, s82, -v156
    buffer_load_dwordx4 v74, s[4:7], s99 offen offset:1088  lds
    v_exp_f32 v112, v112
    v_exp_f32 v113, v113
    v_exp_f32 v114, v114
    v_exp_f32 v115, v115
    v_cvt_pk_bf16_f32 v116, v112, v113
    v_cvt_pk_bf16_f32 v117, v114, v115
    v_bfi_b32 v128, v36, 0, v116
    v_and_b32_e64 v130, v36, v116
    buffer_load_dwordx4 v75, s[4:7], s99 offen offset:2176  lds
    v_bfi_b32 v129, v37, 0, v117
    v_and_b32 v131, v37, v117
    s_waitcnt lgkmcnt(3)
    s_nop 0
    v_mfma_f32_16x16x32_bf16 v[144:147], v[106:109], v[128:131], 0
    s_waitcnt lgkmcnt(2)
    v_mfma_f32_16x16x32_bf16 v[136:139], v[100:103], v[128:131], 0
    v_fma_f32 v120, v120, s82, -v157
    v_fma_f32 v121, v121, s82, -v157
    v_fma_f32 v122, v122, s82, -v157
    v_fma_f32 v123, v123, s82, -v157
    buffer_load_dwordx4 v76, s[4:7], s99 offen offset:3264  lds
    v_exp_f32 v120, v120
    v_exp_f32 v121, v121
    v_exp_f32 v122, v122
    v_exp_f32 v123, v123
    v_cvt_pk_bf16_f32 v124, v120, v121
    v_cvt_pk_bf16_f32 v125, v122, v123
    v_bfi_b32 v132, v36, 0, v124
    v_and_b32_e64 v134, v36, v124
    s_add_u32 m0, s93, 92928
    s_add_u32 s99, s99, 256
    s_mov_b64 exec, s[80:81]
    buffer_load_dwordx4 v77, s[4:7], s100 offen  lds
    s_mov_b64 exec, -1
    s_add_u32 s100, s100, 256
    v_bfi_b32 v133, v37, 0, v125
    v_and_b32 v135, v37, v125
    s_waitcnt lgkmcnt(1)
    s_nop 0
    v_mfma_f32_16x16x32_bf16 v[148:151], v[108:111], v[132:135], 0
    s_waitcnt lgkmcnt(0)
    v_mfma_f32_16x16x32_bf16 v[140:143], v[102:105], v[132:135], 0
    v_mov_b32 v158, v144
    s_nop 1
    v_permlane16_swap_b32 v144, v158
    v_rcp_f32 v158, v158
    s_nop 0
    v_pk_mul_f32 v[136:137], v[136:137], v[158:159] op_sel_hi:[1,0]
    s_lshl_b32 s97, s73, 2
    s_add_u32 s97, s97, s24
    s_nop 0
    s_mul_i32 s97, s97, 25600
    s_add_u32 s97, s97, 2621440
    buffer_load_dwordx4 a[160:163], v58, s[16:19], s97 offen offset:0 sc1
    v_pk_mul_f32 v[138:139], v[138:139], v[158:159] op_sel_hi:[1,0]
    v_pk_mul_f32 v[144:145], v[144:145], v[158:159] op_sel_hi:[1,0]
    v_pk_mul_f32 v[146:147], v[146:147], v[158:159] op_sel_hi:[1,0]
    v_cvt_pk_bf16_f32 v112, v136, v137
    v_cvt_pk_bf16_f32 v116, v144, v145
    v_cvt_pk_bf16_f32 v113, v138, v139
    v_cvt_pk_bf16_f32 v117, v146, v147
    v_mov_b32 v160, v148
    buffer_load_dwordx4 a[164:167], v58, s[16:19], s97 offen offset:1024 sc1
    s_nop 0
    v_permlane16_swap_b32 v148, v160
    v_rcp_f32_e64 v160, v160
    s_nop 0
    v_pk_mul_f32 v[140:141], v[140:141], v[160:161] op_sel_hi:[1,0]
    v_pk_mul_f32 v[142:143], v[142:143], v[160:161] op_sel_hi:[1,0]
    v_pk_mul_f32 v[148:149], v[148:149], v[160:161] op_sel_hi:[1,0]
    v_pk_mul_f32 v[150:151], v[150:151], v[160:161] op_sel_hi:[1,0]
    v_cvt_pk_bf16_f32 v114, v140, v141
    v_cvt_pk_bf16_f32 v118, v148, v149
    buffer_load_dwordx4 a[168:171], v58, s[16:19], s97 offen offset:2048 sc1
    v_cvt_pk_bf16_f32 v115, v142, v143
    v_cvt_pk_bf16_f32 v119, v150, v151
    v_permlane16_swap_b32 v112, v114
    v_permlane16_swap_b32 v113, v115
    v_permlane16_swap_b32 v116, v118
    v_permlane16_swap_b32 v117, v119
    buffer_store_dwordx4 v[112:115], v45, s[16:19], s25 offen sc1
    s_mov_b64 exec, s[80:81]
    buffer_store_dwordx2 v[116:117], v46, s[16:19], s26 offen sc1
    s_mov_b64 exec, -1
    buffer_load_dwordx4 a[172:175], v58, s[16:19], s97 offen offset:3072 sc1
    s_add_u32 s97, s97, 4096
    buffer_load_dwordx4 a[176:179], v58, s[16:19], s97 offen offset:0 sc1
    v_add_u32 v196, 36352, v78
    v_mov_b32 v198, v79
    v_xor_b32 v197, 32, v196
    s_waitcnt vmcnt(17)
    s_barrier
    ds_read_b128 v[160:163], v198 offset:0
    ds_read_b128 v[164:167], v196 offset:0
    ds_read_b128 v[168:171], v196 offset:8704
    ds_read_b128 v[172:175], v198 offset:32
    ds_read_b128 v[176:179], v197 offset:0
    ds_read_b128 v[180:183], v197 offset:8704
    s_waitcnt lgkmcnt(3)
    v_mfma_f32_16x16x32_bf16 v[112:115], a[0:3], v[160:163], 0
    ds_read_b128 v[184:187], v198 offset:64
    v_mfma_f32_32x32x16_bf16 v[80:95], a[0:3], v[164:167], 0
    ds_read_b128 v[188:191], v196 offset:64
    s_lshl_b32 s59, s24, 12
    v_lshl_add_u32 v62, v1, 4, s59
    s_mul_i32 s59, s24, 1216
    s_add_u32 s59, s59, 192
    v_mfma_f32_32x32x16_bf16 v[96:111], a[0:3], v[168:171], 0
    ds_read_b128 v[192:195], v196 offset:8768
    s_add_u32 m0, s92, 95104
    s_nop 0
    buffer_load_dwordx4 v73, s[4:7], s99 offen offset:0  lds
    v_lshl_add_u32 v63, v1, 2, s59
    s_waitcnt lgkmcnt(3)
    v_mfma_f32_16x16x32_bf16 v[112:115], a[4:7], v[172:175], v[112:115]
    ds_read_b128 v[160:163], v198 offset:96
    v_mfma_f32_32x32x16_bf16 v[80:95], a[4:7], v[176:179], v[80:95]
    ds_read_b128 v[164:167], v197 offset:64
    s_mul_i32 s59, s24, 4864
    s_add_u32 s59, s59, 80
    v_and_b32_e64 v70, 3, v1
    v_mul_u32_u24 v70, 1216, v70
    v_mfma_f32_32x32x16_bf16 v[96:111], a[4:7], v[180:183], v[96:111]
    ds_read_b128 v[168:171], v197 offset:8768
    buffer_load_dwordx4 v74, s[4:7], s99 offen offset:1088  lds
    v_bfe_u32 v71, v1, 2, 3
    v_lshl_add_u32 v70, v71, 4, v70
    s_waitcnt lgkmcnt(3)
    v_mfma_f32_16x16x32_bf16 v[112:115], a[8:11], v[184:187], v[112:115]
    ds_read_b128 v[172:175], v198 offset:128
    v_mfma_f32_32x32x16_bf16 v[80:95], a[8:11], v[188:191], v[80:95]
    ds_read_b128 v[176:179], v196 offset:128
    v_lshrrev_b32 v71, 5, v1
    v_lshl_add_u32 v70, v71, 4, v70
    v_add_u32_e64 v64, s59, v70
    s_mul_i32 s59, s24, 4160
    v_mfma_f32_32x32x16_bf16 v[96:111], a[8:11], v[192:195], v[96:111]
    ds_read_b128 v[180:183], v196 offset:8832
    buffer_load_dwordx4 v75, s[4:7], s99 offen offset:2176  lds
    s_add_u32 s59, s59, 134368
    v_lshlrev_b32 v71, 6, v71
    s_waitcnt lgkmcnt(3)
    v_mfma_f32_16x16x32_bf16 v[112:115], a[12:15], v[160:163], v[112:115]
    ds_read_b128 v[184:187], v198 offset:160
    v_mfma_f32_32x32x16_bf16 v[80:95], a[12:15], v[164:167], v[80:95]
    ds_read_b128 v[188:191], v197 offset:128
    v_sub_u32_e64 v71, s59, v71
    v_bfe_u32 v70, v1, 4, 1
    v_lshl_add_u32 v71, v70, 5, v71
    v_and_b32_e64 v70, 3, v1
    v_mfma_f32_32x32x16_bf16 v[96:111], a[12:15], v[168:171], v[96:111]
    ds_read_b128 v[192:195], v197 offset:8832
    buffer_load_dwordx4 v76, s[4:7], s99 offen offset:3264  lds
    v_lshl_add_u32 v71, v70, 3, v71
    v_bfe_u32 v70, v1, 2, 2
    s_waitcnt lgkmcnt(3)
    v_mfma_f32_16x16x32_bf16 v[112:115], a[16:19], v[172:175], v[112:115]
    ds_read_b128 v[160:163], v198 offset:192
    v_mfma_f32_32x32x16_bf16 v[80:95], a[16:19], v[176:179], v[80:95]
    ds_read_b128 v[164:167], v196 offset:192
    v_lshlrev_b32 v70, 3, v70
    v_sub_u32_e64 v65, v71, v70
    s_mul_i32 s59, s24, 4224
    s_add_u32 s59, s59, 19456
    v_mfma_f32_32x32x16_bf16 v[96:111], a[16:19], v[180:183], v[96:111]
    ds_read_b128 v[168:171], v196 offset:8896
    s_add_u32 m0, s93, 112512
    s_add_u32 s99, s99, 256
    s_mov_b64 exec, s[80:81]
    buffer_load_dwordx4 v77, s[4:7], s100 offen  lds
    s_mov_b64 exec, -1
    s_add_u32 s100, s100, 256
    s_waitcnt lgkmcnt(3)
    v_mfma_f32_16x16x32_bf16 v[112:115], a[20:23], v[184:187], v[112:115]
    ds_read_b128 v[172:175], v198 offset:224
    v_mfma_f32_32x32x16_bf16 v[80:95], a[20:23], v[188:191], v[80:95]
    ds_read_b128 v[176:179], v197 offset:192
    v_and_b32 v70, 3, v1
    v_mul_u32_u24 v70, 1056, v70
    v_and_b32_e64 v71, 60, v1
    v_add3_u32 v66, v70, v71, s59
    v_mfma_f32_32x32x16_bf16 v[96:111], a[20:23], v[192:195], v[96:111]
    ds_read_b128 v[180:183], v197 offset:8896
    s_add_u32 m0, s92, 114688
    s_nop 0
    buffer_load_dwordx4 v73, s[4:7], s99 offen offset:0  lds
    s_mul_i32 s59, s24, 1056
    s_waitcnt vmcnt(18)
    s_barrier
    s_waitcnt lgkmcnt(3)
    v_mfma_f32_16x16x32_bf16 v[112:115], a[24:27], v[160:163], v[112:115]
    v_add_u32_e64 v198, v49, v198
    v_mfma_f32_32x32x16_bf16 v[80:95], a[24:27], v[164:167], v[80:95]
    v_add_u32 v196, 19584, v196
    v_add_u32 v197, 19584, v197
    ds_read_b128 v[184:187], v198 offset:0
    s_add_u32 s59, s59, 19456
    v_lshl_add_u32 v67, v1, 3, s59
    v_mfma_f32_32x32x16_bf16 v[96:111], a[24:27], v[168:171], v[96:111]
    ds_read_b128 v[188:191], v196 offset:0
    ds_read_b128 v[192:195], v196 offset:8704
    buffer_load_dwordx4 v74, s[4:7], s99 offen offset:1088  lds
    s_mul_i32 s59, s24, 1280
    s_waitcnt lgkmcnt(3)
    v_mfma_f32_16x16x32_bf16 v[112:115], a[28:31], v[172:175], v[112:115]
    ds_read_b128 v[160:163], v198 offset:32
    v_mfma_f32_32x32x16_bf16 v[80:95], a[28:31], v[176:179], v[80:95]
    ds_read_b128 v[164:167], v197 offset:0
    s_lshl_b32 s60, s75, 3
    s_add_u32 s59, s59, s60
    v_mul_u32_u24 v70, 10240, v1
    v_add_u32 v68, s59, v70
    v_mfma_f32_32x32x16_bf16 v[96:111], a[28:31], v[180:183], v[96:111]
    ds_read_b128 v[168:171], v197 offset:8704
    buffer_load_dwordx4 v75, s[4:7], s99 offen offset:2176  lds
    s_waitcnt lgkmcnt(3)
    v_mfma_f32_16x16x32_bf16 v[112:115], a[32:35], v[184:187], v[112:115]
    ds_read_b128 v[172:175], v198 offset:64
    v_mfma_f32_32x32x16_bf16 v[80:95], a[32:35], v[188:191], v[80:95]
    ds_read_b128 v[176:179], v196 offset:64
    v_mfma_f32_32x32x16_bf16 v[96:111], a[32:35], v[192:195], v[96:111]
    ds_read_b128 v[180:183], v196 offset:8768
    buffer_load_dwordx4 v76, s[4:7], s99 offen offset:3264  lds
    s_waitcnt lgkmcnt(3)
    v_mfma_f32_16x16x32_bf16 v[112:115], a[36:39], v[160:163], v[112:115]
    ds_read_b128 v[184:187], v198 offset:96
    v_mfma_f32_32x32x16_bf16 v[80:95], a[36:39], v[164:167], v[80:95]
    ds_read_b128 v[188:191], v197 offset:64
    v_mfma_f32_32x32x16_bf16 v[96:111], a[36:39], v[168:171], v[96:111]
    ds_read_b128 v[192:195], v197 offset:8768
    s_add_u32 m0, s93, 132096
    s_add_u32 s99, s99, 256
    s_mov_b64 exec, s[80:81]
    buffer_load_dwordx4 v77, s[4:7], s100 offen  lds
    s_mov_b64 exec, -1
    s_add_u32 s100, s100, 256
    s_waitcnt lgkmcnt(3)
    v_mfma_f32_16x16x32_bf16 v[112:115], a[40:43], v[172:175], v[112:115]
    ds_read_b128 v[160:163], v198 offset:128
    v_mfma_f32_32x32x16_bf16 v[80:95], a[40:43], v[176:179], v[80:95]
    ds_read_b128 v[164:167], v196 offset:128
    s_lshl_b32 s25, s24, 6
    s_and_b32 s35, s74, 3
    s_lshl_b32 s35, s35, 13
    s_add_u32 s35, s35, s25
    v_mfma_f32_32x32x16_bf16 v[96:111], a[40:43], v[180:183], v[96:111]
    ds_read_b128 v[168:171], v196 offset:8832
    s_lshl_b32 s98, s72, 5
    s_add_u32 s98, s98, 256
    s_sub_u32 s95, s98, 4
    s_max_i32 s95, s95, 0
    s_lshl_b32 s94, s98, 3
    s_lshl_b32 s95, s95, 3
    s_add_u32 s94, s94, 3440640
    s_add_u32 s95, s95, 3440640
    s_add_u32 s96, s94, 8192
    buffer_load_dwordx2 v[152:153], v47, s[16:19], s94 offen sc1
    s_waitcnt lgkmcnt(3)
    v_mfma_f32_16x16x32_bf16 v[112:115], a[44:47], v[184:187], v[112:115]
    ds_read_b128 v[172:175], v198 offset:160
    v_mfma_f32_32x32x16_bf16 v[80:95], a[44:47], v[188:191], v[80:95]
    ds_read_b128 v[176:179], v197 offset:128
    s_lshr_b32 s25, s74, 4
    s_lshl_b32 s25, s25, 11
    s_add_u32 s35, s35, s25
    s_and_b32 s25, s74, 12
    v_mfma_f32_32x32x16_bf16 v[96:111], a[44:47], v[192:195], v[96:111]
    ds_read_b128 v[180:183], v197 offset:8832
    buffer_load_dwordx2 v[154:155], v47, s[16:19], s96 offen sc1
    s_lshl_b32 s25, s25, 6
    s_add_u32 s35, s35, s25
    s_waitcnt lgkmcnt(3)
    v_mfma_f32_16x16x32_bf16 v[112:115], a[48:51], v[160:163], v[112:115]
    ds_read_b128 v[184:187], v198 offset:192
    v_mfma_f32_32x32x16_bf16 v[80:95], a[48:51], v[164:167], v[80:95]
    ds_read_b128 v[188:191], v196 offset:192
    s_mul_i32 s36, s73, 20
    s_add_u32 s36, s36, s24
    s_add_u32 s36, s36, 16
    s_lshl_b32 s36, s36, 14
    v_mfma_f32_32x32x16_bf16 v[96:111], a[48:51], v[168:171], v[96:111]
    ds_read_b128 v[192:195], v196 offset:8896
    buffer_load_dwordx2 v[156:157], v48, s[16:19], s95 offen sc1
    v_add_u32 v199, 36352, v58
    s_lshl_b32 s32, s24, 11
    s_waitcnt lgkmcnt(3)
    v_mfma_f32_16x16x32_bf16 v[112:115], a[52:55], v[172:175], v[112:115]
    ds_read_b128 v[160:163], v198 offset:224
    v_mfma_f32_32x32x16_bf16 v[80:95], a[52:55], v[176:179], v[80:95]
    ds_read_b128 v[164:167], v197 offset:192
    v_add_u32_e64 v203, s32, v199
    s_add_u32 s32, s24, 1
    s_and_b32 s32, s32, 3
    s_mul_i32 s32, s32, 6144
    v_mfma_f32_32x32x16_bf16 v[96:111], a[52:55], v[180:183], v[96:111]
    ds_read_b128 v[168:171], v197 offset:8896
    buffer_load_dwordx4 a[180:183], v58, s[16:19], s97 offen offset:1024 sc1
    v_add_u32 v200, s32, v199
    s_add_u32 s32, s24, 2
    s_waitcnt vmcnt(21)
    s_barrier
    s_waitcnt lgkmcnt(3)
    v_mfma_f32_16x16x32_bf16 v[112:115], a[56:59], v[184:187], v[112:115]
    v_add_u32 v198, v49, v198
    v_mfma_f32_32x32x16_bf16 v[80:95], a[56:59], v[188:191], v[80:95]
    v_add_u32 v196, 19584, v196
    v_add_u32 v197, 19584, v197
    ds_read_b128 v[172:175], v198 offset:0
    s_and_b32 s32, s32, 3
    s_mul_i32 s32, s32, 6144
    v_mfma_f32_32x32x16_bf16 v[96:111], a[56:59], v[192:195], v[96:111]
    ds_read_b128 v[176:179], v196 offset:0
    ds_read_b128 v[180:183], v196 offset:8704
    buffer_load_dwordx4 a[184:187], v58, s[16:19], s97 offen offset:2048 sc1
    v_add_u32_e64 v201, s32, v199
    s_waitcnt lgkmcnt(3)
    v_mfma_f32_16x16x32_bf16 v[112:115], a[60:63], v[160:163], v[112:115]
    ds_read_b128 v[184:187], v198 offset:32
    v_mfma_f32_32x32x16_bf16 v[80:95], a[60:63], v[164:167], v[80:95]
    ds_read_b128 v[188:191], v197 offset:0
    s_add_u32 s32, s24, 3
    s_and_b32 s32, s32, 3
    s_mul_i32 s32, s32, 6144
    v_add_u32_e64 v202, s32, v199
    v_mfma_f32_32x32x16_bf16 v[96:111], a[60:63], v[168:171], v[96:111]
    ds_read_b128 v[192:195], v197 offset:8704
    buffer_load_dwordx4 a[188:191], v58, s[16:19], s97 offen offset:3072 sc1
    s_mul_i32 s32, s24, 6144
    v_add_u32 v204, s32, v199
    s_waitcnt lgkmcnt(3)
    v_mfma_f32_16x16x32_bf16 v[112:115], a[64:67], v[172:175], v[112:115]
    ds_read_b128 v[160:163], v198 offset:64
    v_mfma_f32_32x32x16_bf16 v[80:95], a[64:67], v[176:179], v[80:95]
    ds_read_b128 v[164:167], v196 offset:64
    s_lshl_b32 s32, s24, 8
    s_add_u32 s32, s32, 36352
    v_and_b32 v214, 15, v1
    v_lshl_add_u32 v206, v214, 4, s32
    v_mfma_f32_32x32x16_bf16 v[96:111], a[64:67], v[180:183], v[96:111]
    ds_read_b128 v[168:171], v196 offset:8768
    s_add_u32 s97, s97, 4096
    buffer_load_dwordx4 a[192:195], v58, s[16:19], s97 offen offset:0 sc1
    v_lshrrev_b32 v215, 5, v1
    s_waitcnt lgkmcnt(3)
    v_mfma_f32_16x16x32_bf16 v[112:115], a[68:71], v[184:187], v[112:115]
    ds_read_b128 v[172:175], v198 offset:96
    v_mfma_f32_32x32x16_bf16 v[80:95], a[68:71], v[188:191], v[80:95]
    ds_read_b128 v[176:179], v197 offset:64
    v_lshl_add_u32 v205, v215, 10, v206
    v_bfe_u32 v215, v1, 4, 1
    v_lshl_add_u32 v205, v215, 3, v205
    v_lshlrev_b32_e64 v214, 2, v214
    v_mfma_f32_32x32x16_bf16 v[96:111], a[68:71], v[192:195], v[96:111]
    ds_read_b128 v[180:183], v197 offset:8768
    buffer_load_dwordx4 a[196:199], v58, s[16:19], s97 offen offset:1024 sc1
    v_lshl_add_u32 v214, v215, 10, v214
    s_lshl_b32 s32, s24, 6
    s_waitcnt lgkmcnt(3)
    v_mfma_f32_16x16x32_bf16 v[112:115], a[72:75], v[160:163], v[112:115]
    ds_read_b128 v[184:187], v198 offset:128
    v_mfma_f32_32x32x16_bf16 v[80:95], a[72:75], v[164:167], v[80:95]
    ds_read_b128 v[188:191], v196 offset:128
    v_lshl_add_u32 v207, v215, 3, s32
    v_and_b32 v215, 12, v1
    v_lshl_add_u32 v207, v215, 2, v207
    v_and_b32 v215, 2, v1
    v_mfma_f32_32x32x16_bf16 v[96:111], a[72:75], v[168:171], v[96:111]
    ds_read_b128 v[192:195], v196 offset:8832
    buffer_load_dwordx4 a[200:203], v58, s[16:19], s97 offen offset:2048 sc1
    v_lshl_add_u32 v207, v215, 1, v207
    v_add_u32 v207, 69120, v207
    s_waitcnt lgkmcnt(3)
    v_mfma_f32_16x16x32_bf16 v[112:115], a[76:79], v[172:175], v[112:115]
    ds_read_b128 v[160:163], v198 offset:160
    v_mfma_f32_32x32x16_bf16 v[80:95], a[76:79], v[176:179], v[80:95]
    ds_read_b128 v[164:167], v197 offset:128
    v_lshrrev_b32 v215, 4, v1
    v_lshl_add_u32 v206, v215, 2, v206
    v_mov_b32 v215, 0x3f803f80
    v_mfma_f32_32x32x16_bf16 v[96:111], a[76:79], v[180:183], v[96:111]
    ds_read_b128 v[168:171], v197 offset:8832
    buffer_load_dwordx4 a[204:207], v58, s[16:19], s97 offen offset:3072 sc1
    s_waitcnt lgkmcnt(3)
    v_mfma_f32_16x16x32_bf16 v[112:115], a[80:83], v[184:187], v[112:115]
    ds_read_b128 v[172:175], v198 offset:192
    v_mfma_f32_32x32x16_bf16 v[80:95], a[80:83], v[188:191], v[80:95]
    ds_read_b128 v[176:179], v196 offset:192
    v_mfma_f32_32x32x16_bf16 v[96:111], a[80:83], v[192:195], v[96:111]
    ds_read_b128 v[180:183], v196 offset:8896
    s_add_u32 s97, s97, 4096
    buffer_load_dwordx4 a[208:211], v58, s[16:19], s97 offen offset:0 sc1
    s_waitcnt lgkmcnt(3)
    v_mfma_f32_16x16x32_bf16 v[112:115], a[84:87], v[160:163], v[112:115]
    ds_read_b128 v[184:187], v198 offset:224
    v_mfma_f32_32x32x16_bf16 v[80:95], a[84:87], v[164:167], v[80:95]
    ds_read_b128 v[188:191], v197 offset:192
    v_mfma_f32_32x32x16_bf16 v[96:111], a[84:87], v[168:171], v[96:111]
    ds_read_b128 v[192:195], v197 offset:8896
    buffer_load_dwordx4 a[212:215], v58, s[16:19], s97 offen offset:1024 sc1
    s_waitcnt vmcnt(17)
    s_barrier
    s_waitcnt lgkmcnt(3)
    v_mfma_f32_16x16x32_bf16 v[112:115], a[88:91], v[172:175], v[112:115]
    v_add_u32 v198, v49, v198
    v_mfma_f32_32x32x16_bf16 v[80:95], a[88:91], v[176:179], v[80:95]
    v_add_u32 v196, 19584, v196
    v_add_u32 v197, 19584, v197
    ds_read_b128 v[160:163], v198 offset:0
    v_mfma_f32_32x32x16_bf16 v[96:111], a[88:91], v[180:183], v[96:111]
    ds_read_b128 v[164:167], v196 offset:0
    ds_read_b128 v[168:171], v196 offset:8704
    buffer_load_dwordx4 a[216:219], v58, s[16:19], s97 offen offset:2048 sc1
    s_waitcnt lgkmcnt(3)
    v_mfma_f32_16x16x32_bf16 v[112:115], a[92:95], v[184:187], v[112:115]
    ds_read_b128 v[172:175], v198 offset:32
    v_mfma_f32_32x32x16_bf16 v[80:95], a[92:95], v[188:191], v[80:95]
    ds_read_b128 v[176:179], v197 offset:0
    v_mfma_f32_32x32x16_bf16 v[96:111], a[92:95], v[192:195], v[96:111]
    ds_read_b128 v[180:183], v197 offset:8704
    buffer_load_dwordx4 a[220:223], v58, s[16:19], s97 offen offset:3072 sc1
    s_waitcnt lgkmcnt(3)
    v_mfma_f32_16x16x32_bf16 v[112:115], a[96:99], v[160:163], v[112:115]
    ds_read_b128 v[184:187], v198 offset:64
    v_mfma_f32_32x32x16_bf16 v[80:95], a[96:99], v[164:167], v[80:95]
    ds_read_b128 v[188:191], v196 offset:64
    v_mfma_f32_32x32x16_bf16 v[96:111], a[96:99], v[168:171], v[96:111]
    ds_read_b128 v[192:195], v196 offset:8768
    s_add_u32 s97, s97, 4096
    buffer_load_dwordx4 a[224:227], v58, s[16:19], s97 offen offset:0 sc1
    s_waitcnt lgkmcnt(3)
    v_mfma_f32_16x16x32_bf16 v[112:115], a[100:103], v[172:175], v[112:115]
    ds_read_b128 v[160:163], v198 offset:96
    v_mfma_f32_32x32x16_bf16 v[80:95], a[100:103], v[176:179], v[80:95]
    ds_read_b128 v[164:167], v197 offset:64
    v_mfma_f32_32x32x16_bf16 v[96:111], a[100:103], v[180:183], v[96:111]
    ds_read_b128 v[168:171], v197 offset:8768
    buffer_load_dwordx4 a[228:231], v58, s[16:19], s97 offen offset:1024 sc1
    s_waitcnt lgkmcnt(3)
    v_mfma_f32_16x16x32_bf16 v[112:115], a[104:107], v[184:187], v[112:115]
    ds_read_b128 v[172:175], v198 offset:128
    v_mfma_f32_32x32x16_bf16 v[80:95], a[104:107], v[188:191], v[80:95]
    ds_read_b128 v[176:179], v196 offset:128
    s_waitcnt vmcnt(13)
    v_mul_f32 v148, v24, v157
    v_mul_f32 v149, v25, v157
    v_mul_f32 v150, v26, v157
    v_mul_f32_e64 v151, v27, v157
    v_mfma_f32_32x32x16_bf16 v[96:111], a[104:107], v[192:195], v[96:111]
    ds_read_b128 v[180:183], v196 offset:8832
    buffer_load_dwordx4 a[232:235], v58, s[16:19], s97 offen offset:2048 sc1
    v_mul_f32 v116, v8, v153
    v_mul_f32_e64 v117, v9, v153
    s_waitcnt lgkmcnt(3)
    v_mfma_f32_16x16x32_bf16 v[112:115], a[108:111], v[160:163], v[112:115]
    ds_read_b128 v[184:187], v198 offset:160
    v_mfma_f32_32x32x16_bf16 v[80:95], a[108:111], v[164:167], v[80:95]
    ds_read_b128 v[188:191], v197 offset:128
    v_mul_f32 v118, v10, v153
    v_mul_f32 v119, v11, v153
    v_mul_f32 v120, v12, v153
    v_mul_f32 v121, v13, v153
    v_mfma_f32_32x32x16_bf16 v[96:111], a[108:111], v[168:171], v[96:111]
    ds_read_b128 v[192:195], v197 offset:8832
    buffer_load_dwordx4 a[236:239], v58, s[16:19], s97 offen offset:3072 sc1
    v_mul_f32 v122, v14, v153
    v_mul_f32_e64 v123, v15, v153
    s_waitcnt lgkmcnt(3)
    v_mfma_f32_16x16x32_bf16 v[112:115], a[112:115], v[172:175], v[112:115]
    ds_read_b128 v[160:163], v198 offset:192
    v_mfma_f32_32x32x16_bf16 v[80:95], a[112:115], v[176:179], v[80:95]
    ds_read_b128 v[164:167], v196 offset:192
    v_mul_f32 v124, v16, v153
    v_mul_f32 v125, v17, v153
    v_mul_f32 v126, v18, v153
    v_mul_f32 v127, v19, v153
    v_mfma_f32_32x32x16_bf16 v[96:111], a[112:115], v[180:183], v[96:111]
    ds_read_b128 v[168:171], v196 offset:8896
    s_add_u32 s97, s97, 4096
    buffer_load_dwordx4 a[240:243], v58, s[16:19], s97 offen offset:0 sc1
    v_mul_f32 v128, v20, v153
    s_waitcnt lgkmcnt(3)
    v_mfma_f32_16x16x32_bf16 v[112:115], a[116:119], v[184:187], v[112:115]
    ds_read_b128 v[172:175], v198 offset:224
    v_mfma_f32_32x32x16_bf16 v[80:95], a[116:119], v[188:191], v[80:95]
    ds_read_b128 v[176:179], v197 offset:192
    v_mul_f32 v129, v21, v153
    v_mul_f32 v130, v22, v153
    v_mul_f32 v131, v23, v153
    v_mul_f32 v132, v8, v155
    v_mfma_f32_32x32x16_bf16 v[96:111], a[116:119], v[192:195], v[96:111]
    ds_read_b128 v[180:183], v197 offset:8896
    buffer_load_dwordx4 a[244:247], v58, s[16:19], s97 offen offset:1024 sc1
    v_mul_f32 v133, v9, v155
    v_mul_f32 v134, v10, v155
    s_barrier
    s_waitcnt lgkmcnt(3)
    v_mfma_f32_16x16x32_bf16 v[112:115], a[120:123], v[160:163], v[112:115]
    v_add_u32_e64 v198, v49, v198
    v_mfma_f32_32x32x16_bf16 v[80:95], a[120:123], v[164:167], v[80:95]
    v_add_u32 v196, 19584, v196
    v_add_u32 v197, 19584, v197
    v_mul_f32 v135, v11, v155
    v_mul_f32 v136, v12, v155
    v_mul_f32_e64 v137, v13, v155
    v_mfma_f32_32x32x16_bf16 v[96:111], a[120:123], v[168:171], v[96:111]
    ds_read_b128 v[184:187], v198 offset:0
    ds_read_b128 v[188:191], v196 offset:0
    buffer_load_dwordx4 a[248:251], v58, s[16:19], s97 offen offset:2048 sc1
    v_mul_f32 v138, v14, v155
    v_mul_f32_e64 v139, v15, v155
    s_waitcnt lgkmcnt(2)
    v_mfma_f32_16x16x32_bf16 v[112:115], a[124:127], v[172:175], v[112:115]
    ds_read_b128 v[192:195], v198 offset:32
    v_mfma_f32_32x32x16_bf16 v[80:95], a[124:127], v[176:179], v[80:95]
    ds_read_b128 v[160:163], v197 offset:0
    v_mul_f32 v140, v16, v155
    v_mul_f32 v141, v17, v155
    v_mul_f32 v142, v18, v155
    v_mul_f32 v143, v19, v155
    v_mfma_f32_32x32x16_bf16 v[96:111], a[124:127], v[180:183], v[96:111]
    buffer_load_dwordx4 a[252:255], v58, s[16:19], s97 offen offset:3072 sc1
    v_mul_f32 v144, v20, v155
    v_mul_f32 v145, v21, v155
    v_mul_f32 v146, v22, v155
    s_waitcnt lgkmcnt(2)
    v_mfma_f32_16x16x32_bf16 v[112:115], a[128:131], v[184:187], v[112:115]
    ds_read_b128 v[164:167], v198 offset:64
    v_mfma_f32_32x32x16_bf16 v[80:95], a[128:131], v[188:191], v[80:95]
    ds_read_b128 v[168:171], v196 offset:64
    v_mul_f32 v147, v23, v155
    s_waitcnt lgkmcnt(2)
    v_mfma_f32_16x16x32_bf16 v[112:115], a[132:135], v[192:195], v[112:115]
    ds_read_b128 v[172:175], v198 offset:96
    v_mfma_f32_32x32x16_bf16 v[80:95], a[132:135], v[160:163], v[80:95]
    ds_read_b128 v[176:179], v197 offset:64
    s_add_u32 s97, s97, 4096
    buffer_load_dwordx4 v[52:55], v58, s[16:19], s97 offen offset:0 sc1
    s_waitcnt lgkmcnt(2)
    v_mfma_f32_16x16x32_bf16 v[112:115], a[136:139], v[164:167], v[112:115]
    ds_read_b128 v[180:183], v198 offset:128
    v_mfma_f32_32x32x16_bf16 v[80:95], a[136:139], v[168:171], v[80:95]
    ds_read_b128 v[184:187], v196 offset:128
    s_waitcnt lgkmcnt(2)
    v_mfma_f32_16x16x32_bf16 v[112:115], a[140:143], v[172:175], v[112:115]
    ds_read_b128 v[188:191], v198 offset:160
    v_mfma_f32_32x32x16_bf16 v[80:95], a[140:143], v[176:179], v[80:95]
    ds_read_b128 v[192:195], v197 offset:128
    s_mov_b32 s96, 4194304
    buffer_load_dwordx4 v[216:219], v56, s[16:19], s96 offen offset:0 sc1
    s_waitcnt lgkmcnt(2)
    v_mfma_f32_16x16x32_bf16 v[112:115], a[144:147], v[180:183], v[112:115]
    ds_read_b128 v[160:163], v198 offset:192
    v_mfma_f32_32x32x16_bf16 v[80:95], a[144:147], v[184:187], v[80:95]
    ds_read_b128 v[164:167], v196 offset:192
    s_waitcnt lgkmcnt(2)
    v_mfma_f32_16x16x32_bf16 v[112:115], a[148:151], v[188:191], v[112:115]
    ds_read_b128 v[168:171], v198 offset:224
    v_mfma_f32_32x32x16_bf16 v[80:95], a[148:151], v[192:195], v[80:95]
    ds_read_b128 v[172:175], v197 offset:192
    buffer_load_dwordx4 v[220:223], v56, s[16:19], s96 offen offset:256 sc1
    s_waitcnt lgkmcnt(2)
    v_mfma_f32_16x16x32_bf16 v[112:115], a[152:155], v[160:163], v[112:115]
    ds_read_b128 v[176:179], v196 offset:8704
    v_mfma_f32_32x32x16_bf16 v[80:95], a[152:155], v[164:167], v[80:95]
    ds_read_b128 v[180:183], v197 offset:8704
    s_waitcnt lgkmcnt(2)
    v_mfma_f32_16x16x32_bf16 v[112:115], a[156:159], v[168:171], v[112:115]
    ds_read_b128 v[184:187], v196 offset:8768
    v_mfma_f32_32x32x16_bf16 v[80:95], a[156:159], v[172:175], v[80:95]
    ds_read_b128 v[188:191], v197 offset:8768
    s_mov_b32 s96, 4227072
    buffer_load_dwordx4 v[224:227], v56, s[16:19], s96 offen offset:0 sc1
    s_waitcnt lgkmcnt(2)
    v_mfma_f32_32x32x16_bf16 v[96:111], a[128:131], v[176:179], v[96:111]
    ds_read_b128 v[192:195], v196 offset:8832
    v_mfma_f32_32x32x16_bf16 v[96:111], a[132:135], v[180:183], v[96:111]
    ds_read_b128 v[160:163], v197 offset:8832
    buffer_load_dwordx4 v[228:231], v56, s[16:19], s96 offen offset:256 sc1
    v_fma_f32 v112, v112, v156, v148
    v_fma_f32 v113, v113, v156, v149
    s_waitcnt lgkmcnt(2)
    v_mfma_f32_32x32x16_bf16 v[96:111], a[136:139], v[184:187], v[96:111]
    ds_read_b128 v[164:167], v196 offset:8896
    v_fma_f32 v114, v114, v156, v150
    v_fma_f32 v115, v115, v156, v151
    v_cvt_pk_bf16_f32 v112, v112, v113
    v_cvt_pk_bf16_f32 v113, v114, v115
    v_mfma_f32_32x32x16_bf16 v[96:111], a[140:143], v[188:191], v[96:111]
    ds_read_b128 v[168:171], v197 offset:8896
    s_mov_b32 s96, 4259840
    buffer_load_dwordx4 v[232:235], v56, s[16:19], s96 offen offset:0 sc1
    v_fma_f32 v80, v80, v152, v116
    v_fma_f32 v81, v81, v152, v117
    s_waitcnt lgkmcnt(2)
    v_mfma_f32_32x32x16_bf16 v[96:111], a[144:147], v[192:195], v[96:111]
    v_fma_f32 v82, v82, v152, v118
    v_fma_f32 v83, v83, v152, v119
    v_cvt_pk_bf16_f32 v80, v80, v81
    v_cvt_pk_bf16_f32 v81, v82, v83
    ds_write_b64 v40, v[112:113] offset:0
    v_mfma_f32_32x32x16_bf16 v[96:111], a[148:151], v[160:163], v[96:111]
    ds_write_b64 v38, v[80:81] offset:0
    v_fma_f32 v84, v84, v152, v120
    v_fma_f32 v85, v85, v152, v121
    v_fma_f32 v86, v86, v152, v122
    s_waitcnt lgkmcnt(2)
    v_mfma_f32_32x32x16_bf16 v[96:111], a[152:155], v[164:167], v[96:111]
    v_fma_f32 v87, v87, v152, v123
    v_cvt_pk_bf16_f32 v84, v84, v85
    v_cvt_pk_bf16_f32 v85, v86, v87
    v_fma_f32 v88, v88, v152, v124
    v_fma_f32 v89, v89, v152, v125
    v_mfma_f32_32x32x16_bf16 v[96:111], a[156:159], v[168:171], v[96:111]
    buffer_load_dwordx4 v[236:239], v56, s[16:19], s96 offen offset:256 sc1
    v_fma_f32 v90, v90, v152, v126
    v_fma_f32 v91, v91, v152, v127
    v_cvt_pk_bf16_f32 v88, v88, v89
    v_cvt_pk_bf16_f32 v89, v90, v91
    ds_write_b64 v38, v[84:85] offset:6400
    ds_write_b64 v38, v[88:89] offset:12800
    v_fma_f32 v92, v92, v152, v128
    v_fma_f32 v93, v93, v152, v129
    v_fma_f32 v94, v94, v152, v130
    v_fma_f32 v95, v95, v152, v131
    v_cvt_pk_bf16_f32 v92, v92, v93
    v_cvt_pk_bf16_f32 v93, v94, v95
    ds_write_b64 v39, v[92:93] offset:0
    v_pk_fma_f32 v[96:97], v[96:97], v[154:155], v[132:133] op_sel_hi:[1,0,1]
    v_pk_fma_f32 v[98:99], v[98:99], v[154:155], v[134:135] op_sel_hi:[1,0,1]
    v_cvt_pk_bf16_f32 v96, v96, v97
    v_cvt_pk_bf16_f32 v97, v98, v99
    v_pk_fma_f32 v[100:101], v[100:101], v[154:155], v[136:137] op_sel_hi:[1,0,1]
    v_pk_fma_f32 v[102:103], v[102:103], v[154:155], v[138:139] op_sel_hi:[1,0,1]
    v_cvt_pk_bf16_f32 v100, v100, v101
    v_cvt_pk_bf16_f32 v101, v102, v103
    ds_write_b64 v38, v[96:97] offset:1600
    ds_write_b64 v38, v[100:101] offset:8000
    v_pk_fma_f32 v[104:105], v[104:105], v[154:155], v[140:141] op_sel_hi:[1,0,1]
    v_pk_fma_f32 v[106:107], v[106:107], v[154:155], v[142:143] op_sel_hi:[1,0,1]
    v_cvt_pk_bf16_f32 v104, v104, v105
    v_cvt_pk_bf16_f32 v105, v106, v107
    v_pk_fma_f32 v[108:109], v[108:109], v[154:155], v[144:145] op_sel_hi:[1,0,1]
    v_pk_fma_f32 v[110:111], v[110:111], v[154:155], v[146:147] op_sel_hi:[1,0,1]
    v_cvt_pk_bf16_f32 v108, v108, v109
    v_cvt_pk_bf16_f32 v109, v110, v111
    ds_write_b64 v38, v[104:105] offset:14400
    ds_write_b64 v39, v[108:109] offset:1600
    s_waitcnt lgkmcnt(0)
    s_barrier
    v_mov_b32 v94, 0
    v_mov_b32 v95, 0
    v_mov_b32 v98, 0
    v_mov_b32 v99, 0
    s_mov_b64 exec, 0xffff
    ds_read_b64 v[94:95], v42 offset:320
    ds_read_b64 v[98:99], v42 offset:640
    s_mov_b64 exec, -1
    s_nop 0
    ds_read_b64 v[92:93], v41 offset:320
    ds_read_b64 v[96:97], v41 offset:640
    ds_read_b64 v[84:85], v41 offset:6720
    ds_read_b64 v[86:87], v42 offset:6720
    ds_read_b64 v[80:81], v41 offset:6400
    ds_read_b64 v[82:83], v42 offset:6400
    ds_read_b64 v[88:89], v41 offset:7040
    ds_read_b64 v[90:91], v42 offset:7040
    ds_read_b64_tr_b16 v[106:107], v44 offset:0
    ds_read_b64_tr_b16 v[100:101], v43 offset:0
    ds_read_b64_tr_b16 v[108:109], v44 offset:320
    ds_read_b64_tr_b16 v[102:103], v43 offset:320
    s_mov_b32 s96, 4292608
    buffer_load_dwordx4 v[240:243], v56, s[16:19], s96 offen offset:0 sc1
    ds_read_b64_tr_b16 v[110:111], v44 offset:640
    ds_read_b64_tr_b16 v[104:105], v43 offset:640
    s_mov_b32 s82, 0x3ea52b5c
    s_lshl_b32 s25, s98, 4
    s_add_u32 s25, s25, 4194304
    s_lshl_b32 s26, s98, 3
    s_add_u32 s26, s26, 4194304
    s_waitcnt lgkmcnt(10)
    v_mfma_f32_16x16x32_bf16 v[116:119], v[84:87], v[92:95], v[28:31]
    buffer_load_dwordx4 v[244:247], v56, s[16:19], s96 offen offset:256 sc1
    v_mfma_f32_16x16x32_bf16 v[120:123], v[84:87], v[96:99], v[32:35]
    s_waitcnt lgkmcnt(8)
    v_mfma_f32_16x16x32_bf16 v[112:115], v[80:83], v[92:95], v[32:35]
    s_waitcnt lgkmcnt(6)
    v_mfma_f32_16x16x32_bf16 v[124:127], v[88:91], v[96:99], v[28:31]
    s_nop 5
    v_max_f32 v112, v112, v116
    v_max_f32 v113, v113, v117
    v_max_f32 v114, v114, v118
    v_max_f32 v115, v115, v119
    v_max3_f32 v156, v112, v113, v114
    s_mov_b32 s96, 4194304
    buffer_load_dwordx2 v[248:249], v57, s[16:19], s96 offen offset:0 sc1
    v_max_f32 v156, v156, v115
    v_max_f32 v120, v120, v124
    v_max_f32 v121, v121, v125
    v_max_f32 v122, v122, v126
    v_max_f32 v123, v123, v127
    v_max3_f32 v157, v120, v121, v122
    v_max_f32 v157, v157, v123
    s_nop 1
    v_permlane16_swap_b32 v156, v157
    buffer_load_dwordx2 v[252:253], v57, s[16:19], s96 offen offset:128 sc1
    v_max_f32 v156, v156, v157
    v_mov_b32 v157, v156
    s_nop 1
    v_permlane32_swap_b32 v156, v157
    v_max_f32 v156, v156, v157
    v_mul_f32 v156, s82, v156
    v_mov_b32 v157, v156
    s_nop 1
    v_permlane16_swap_b32_e64 v156, v157
    v_fma_f32 v112, v112, s82, -v156
    s_mov_b32 s96, 4210688
    buffer_load_dwordx2 v[250:251], v57, s[16:19], s96 offen offset:0 sc1
    v_fma_f32 v113, v113, s82, -v156
    v_fma_f32 v114, v114, s82, -v156
    v_fma_f32 v115, v115, s82, -v156
    v_exp_f32 v112, v112
    v_exp_f32 v113, v113
    v_exp_f32 v114, v114
    v_exp_f32 v115, v115
    v_cvt_pk_bf16_f32 v116, v112, v113
    buffer_load_dwordx2 v[254:255], v57, s[16:19], s96 offen offset:128 sc1
    v_cvt_pk_bf16_f32 v117, v114, v115
    v_bfi_b32 v128, v36, 0, v116
    v_and_b32 v130, v36, v116
    v_bfi_b32 v129, v37, 0, v117
    v_and_b32 v131, v37, v117
    s_waitcnt lgkmcnt(3)
    s_nop 0
    v_mfma_f32_16x16x32_bf16 v[144:147], v[106:109], v[128:131], 0
    s_waitcnt lgkmcnt(2)
    v_mfma_f32_16x16x32_bf16 v[136:139], v[100:103], v[128:131], 0
    v_fma_f32 v120, v120, s82, -v157
    s_mov_b32 s96, 0
    s_mov_b32 s97, 5120
    buffer_load_dwordx2 v[208:209], v60, s[4:7], s96 offen
    v_fma_f32 v121, v121, s82, -v157
    v_fma_f32 v122, v122, s82, -v157
    v_fma_f32 v123, v123, s82, -v157
    v_exp_f32 v120, v120
    v_exp_f32 v121, v121
    v_exp_f32 v122, v122
    v_exp_f32 v123, v123
    v_cvt_pk_bf16_f32 v124, v120, v121
    buffer_load_dwordx2 v[210:211], v60, s[4:7], s97 offen
    v_cvt_pk_bf16_f32 v125, v122, v123
    v_bfi_b32 v132, v36, 0, v124
    v_and_b32 v134, v36, v124
    v_bfi_b32 v133, v37, 0, v125
    v_and_b32 v135, v37, v125
    s_waitcnt lgkmcnt(1)
    s_nop 0
    v_mfma_f32_16x16x32_bf16 v[148:151], v[108:111], v[132:135], 0
    s_waitcnt lgkmcnt(0)
    v_mfma_f32_16x16x32_bf16 v[140:143], v[102:105], v[132:135], 0
    v_mov_b32 v158, v144
    v_lshrrev_b32_e64 v212, 5, v1
    v_mul_u32_u24 v212, 5104, v212
    v_bfe_u32 v213, v1, 4, 1
    v_lshlrev_b32 v213, 2, v213
    v_sub_u32 v212, v212, v213
    v_add_u32 v212, v212, v60
    s_mul_i32 s97, s24, 24
    s_sub_u32 s97, 128, s97
    buffer_load_dword v212, v212, s[4:7], s97 offen
    v_permlane16_swap_b32 v144, v158
    v_rcp_f32_e64 v158, v158
    s_nop 0
    v_pk_mul_f32 v[136:137], v[136:137], v[158:159] op_sel_hi:[1,0]
    v_pk_mul_f32 v[138:139], v[138:139], v[158:159] op_sel_hi:[1,0]
    v_pk_mul_f32 v[144:145], v[144:145], v[158:159] op_sel_hi:[1,0]
    v_pk_mul_f32 v[146:147], v[146:147], v[158:159] op_sel_hi:[1,0]
    v_cvt_pk_bf16_f32 v112, v136, v137
    v_cvt_pk_bf16_f32 v116, v144, v145
    v_cvt_pk_bf16_f32 v113, v138, v139
    v_cvt_pk_bf16_f32 v117, v146, v147
    v_mov_b32 v160, v148
    s_nop 1
    v_permlane16_swap_b32 v148, v160
    v_rcp_f32_e64 v160, v160
    s_nop 0
    v_pk_mul_f32 v[140:141], v[140:141], v[160:161] op_sel_hi:[1,0]
    v_pk_mul_f32 v[142:143], v[142:143], v[160:161] op_sel_hi:[1,0]
    v_pk_mul_f32 v[148:149], v[148:149], v[160:161] op_sel_hi:[1,0]
    v_pk_mul_f32 v[150:151], v[150:151], v[160:161] op_sel_hi:[1,0]
    v_cvt_pk_bf16_f32 v114, v140, v141
    v_cvt_pk_bf16_f32 v118, v148, v149
    v_cvt_pk_bf16_f32 v115, v142, v143
    v_cvt_pk_bf16_f32 v119, v150, v151
    v_permlane16_swap_b32 v112, v114
    v_permlane16_swap_b32 v113, v115
    v_permlane16_swap_b32 v116, v118
    v_permlane16_swap_b32 v117, v119
    buffer_store_dwordx4 v[112:115], v45, s[16:19], s25 offen sc1
    s_mov_b64 exec, s[80:81]
    buffer_store_dwordx2 v[116:117], v46, s[16:19], s26 offen sc1
    s_mov_b64 exec, -1
oe_20:
    s_waitcnt vmcnt(16)
    v_mfma_f32_16x16x32_bf16 v[112:115], a[176:179], v[216:219], 0
    v_mov_b32 v136, 0
    v_mov_b32 v137, 0
    s_waitcnt vmcnt(15)
    v_mfma_f32_16x16x32_bf16 v[116:119], a[176:179], v[220:223], 0
    v_mov_b32 v138, 0
    v_mov_b32 v139, 0
    s_waitcnt vmcnt(14)
    v_mfma_f32_16x16x32_bf16 v[112:115], a[196:199], v[224:227], v[112:115]
    v_mov_b32 v140, 0
    v_mov_b32 v141, 0
    s_waitcnt vmcnt(13)
    v_mfma_f32_16x16x32_bf16 v[116:119], a[196:199], v[228:231], v[116:119]
    s_mov_b32 s25, 6815744
    s_add_u32 s26, s36, 6815744
    s_waitcnt vmcnt(12)
    v_mfma_f32_16x16x32_bf16 v[112:115], a[216:219], v[232:235], v[112:115]
    s_add_u32 s27, s35, 3473408
    s_mov_b32 s28, 0x99999999
    s_waitcnt vmcnt(11)
    v_mfma_f32_16x16x32_bf16 v[116:119], a[216:219], v[236:239], v[116:119]
    s_mov_b32 s29, 0x99999999
    s_waitcnt vmcnt(10)
    v_mfma_f32_16x16x32_bf16 v[112:115], a[236:239], v[240:243], v[112:115]
    s_waitcnt vmcnt(9)
    v_mfma_f32_16x16x32_bf16 v[116:119], a[236:239], v[244:247], v[116:119]
    s_waitcnt vmcnt(6)
    v_mfma_f32_16x16x32_bf16 v[112:115], v[52:55], v[248:251], v[112:115]
    s_waitcnt vmcnt(5)
    v_mfma_f32_16x16x32_bf16 v[116:119], v[52:55], v[252:255], v[116:119]
    v_mfma_f32_16x16x32_bf16 v[88:91], a[164:167], v[216:219], 0
    v_mfma_f32_16x16x32_bf16 v[92:95], a[164:167], v[220:223], 0
    v_mfma_f32_16x16x32_bf16 v[88:91], a[184:187], v[224:227], v[88:91]
    v_mfma_f32_16x16x32_bf16 v[92:95], a[184:187], v[228:231], v[92:95]
    v_mfma_f32_16x16x32_bf16 v[88:91], a[204:207], v[232:235], v[88:91]
    v_mfma_f32_16x16x32_bf16 v[92:95], a[204:207], v[236:239], v[92:95]
    s_nop 1
    v_cmp_u_f32 vcc, v112, v116
    s_nop 0
    s_cbranch_vccnz rd_21
rc_22:
    v_mfma_f32_16x16x32_bf16 v[88:91], a[224:227], v[240:243], v[88:91]
    ds_write_b128 v203, v[112:115] offset:24576
    v_mfma_f32_16x16x32_bf16 v[92:95], a[224:227], v[244:247], v[92:95]
    v_mfma_f32_16x16x32_bf16 v[88:91], a[244:247], v[248:251], v[88:91]
    ds_write_b128 v203, v[116:119] offset:25600
    v_mfma_f32_16x16x32_bf16 v[92:95], a[244:247], v[252:255], v[92:95]
    v_mfma_f32_16x16x32_bf16 v[96:99], a[168:171], v[216:219], 0
    s_waitcnt vmcnt(4)
    v_lshlrev_b32 v120, 16, v208
    v_and_b32 v121, 0xffff0000, v208
    v_mfma_f32_16x16x32_bf16 v[100:103], a[168:171], v[220:223], 0
    v_lshlrev_b32_e64 v122, 16, v209
    v_and_b32 v123, 0xffff0000, v209
    v_mfma_f32_16x16x32_bf16 v[96:99], a[188:191], v[224:227], v[96:99]
    s_waitcnt vmcnt(3)
    v_lshlrev_b32 v124, 16, v210
    v_and_b32 v125, 0xffff0000, v210
    v_mfma_f32_16x16x32_bf16 v[100:103], a[188:191], v[228:231], v[100:103]
    v_lshlrev_b32_e64 v126, 16, v211
    v_and_b32 v127, 0xffff0000, v211
    v_mfma_f32_16x16x32_bf16 v[96:99], a[208:211], v[232:235], v[96:99]
    s_waitcnt vmcnt(2)
    v_lshlrev_b32 v128, 16, v212
    v_and_b32 v129, 0xffff0000, v212
    v_mfma_f32_16x16x32_bf16 v[100:103], a[208:211], v[236:239], v[100:103]
    v_mfma_f32_16x16x32_bf16 v[96:99], a[228:231], v[240:243], v[96:99]
    ds_write_b128 v200, v[88:91] offset:0
    v_mfma_f32_16x16x32_bf16 v[100:103], a[228:231], v[244:247], v[100:103]
    v_mfma_f32_16x16x32_bf16 v[96:99], a[248:251], v[248:251], v[96:99]
    ds_write_b128 v200, v[92:95] offset:1024
    v_mfma_f32_16x16x32_bf16 v[100:103], a[248:251], v[252:255], v[100:103]
    v_mfma_f32_16x16x32_bf16 v[104:107], a[172:175], v[216:219], 0
    v_mfma_f32_16x16x32_bf16 v[108:111], a[172:175], v[220:223], 0
    v_mfma_f32_16x16x32_bf16 v[104:107], a[192:195], v[224:227], v[104:107]
    v_mfma_f32_16x16x32_bf16 v[108:111], a[192:195], v[228:231], v[108:111]
    v_mfma_f32_16x16x32_bf16 v[104:107], a[212:215], v[232:235], v[104:107]
    v_mfma_f32_16x16x32_bf16 v[108:111], a[212:215], v[236:239], v[108:111]
    v_mfma_f32_16x16x32_bf16 v[104:107], a[232:235], v[240:243], v[104:107]
    ds_write_b128 v201, v[96:99] offset:2048
    v_mfma_f32_16x16x32_bf16 v[108:111], a[232:235], v[244:247], v[108:111]
    v_mfma_f32_16x16x32_bf16 v[104:107], a[252:255], v[248:251], v[104:107]
    ds_write_b128 v201, v[100:103] offset:3072
    v_mfma_f32_16x16x32_bf16 v[108:111], a[252:255], v[252:255], v[108:111]
    v_mfma_f32_16x16x32_bf16 v[80:83], a[160:163], v[216:219], v[120:123]
    v_mfma_f32_16x16x32_bf16 v[84:87], a[160:163], v[220:223], v[124:127]
    v_mfma_f32_16x16x32_bf16 v[80:83], a[180:183], v[224:227], v[80:83]
    v_mfma_f32_16x16x32_bf16 v[84:87], a[180:183], v[228:231], v[84:87]
    v_mfma_f32_16x16x32_bf16 v[80:83], a[200:203], v[232:235], v[80:83]
    s_nop 0
    ds_write_b128 v202, v[104:107] offset:4096
    v_mfma_f32_16x16x32_bf16 v[84:87], a[200:203], v[236:239], v[84:87]
    ds_write_b128 v202, v[108:111] offset:5120
    v_mfma_f32_16x16x32_bf16 v[80:83], a[220:223], v[240:243], v[80:83]
    v_mfma_f32_16x16x32_bf16 v[84:87], a[220:223], v[244:247], v[84:87]
    v_mfma_f32_16x16x32_bf16 v[80:83], a[240:243], v[248:251], v[80:83]
    v_mfma_f32_16x16x32_bf16 v[84:87], a[240:243], v[252:255], v[84:87]
    s_waitcnt lgkmcnt(0)
    s_barrier
    s_nop 0
    ds_read_b128 v[88:91], v204 offset:0
    ds_read_b128 v[92:95], v204 offset:1024
    ds_read_b128 v[96:99], v204 offset:2048
    ds_read_b128 v[100:103], v204 offset:3072
    ds_read_b128 v[104:107], v204 offset:4096
    ds_read_b128 v[108:111], v204 offset:5120
    ds_read_b64 v[112:113], v205 offset:24576
    ds_read_b64 v[114:115], v205 offset:26624
    ds_read_b64 v[116:117], v205 offset:28672
    ds_read_b64 v[118:119], v205 offset:30720
    s_waitcnt lgkmcnt(9)
    v_pk_add_f32 v[80:81], v[80:81], v[88:89]
    v_pk_add_f32 v[82:83], v[82:83], v[90:91]
    s_waitcnt lgkmcnt(8)
    v_pk_add_f32 v[84:85], v[84:85], v[92:93]
    v_pk_add_f32 v[86:87], v[86:87], v[94:95]
    s_waitcnt lgkmcnt(7)
    v_pk_add_f32 v[80:81], v[80:81], v[96:97]
    v_pk_add_f32 v[82:83], v[82:83], v[98:99]
    s_waitcnt lgkmcnt(6)
    v_pk_add_f32 v[84:85], v[84:85], v[100:101]
    v_pk_add_f32 v[86:87], v[86:87], v[102:103]
    s_waitcnt lgkmcnt(5)
    v_pk_add_f32 v[80:81], v[80:81], v[104:105]
    v_pk_add_f32 v[82:83], v[82:83], v[106:107]
    s_waitcnt lgkmcnt(4)
    v_pk_add_f32 v[84:85], v[84:85], v[108:109]
    v_pk_add_f32 v[86:87], v[86:87], v[110:111]
    v_cvt_pk_bf16_f32 v132, v80, v81
    v_cvt_pk_bf16_f32 v133, v82, v83
    v_cvt_pk_bf16_f32 v134, v84, v85
    v_cvt_pk_bf16_f32 v135, v86, v87
    s_waitcnt lgkmcnt(3)
    v_pk_add_f32 v[128:129], v[128:129], v[112:113]
    s_waitcnt lgkmcnt(2)
    v_pk_add_f32 v[128:129], v[128:129], v[114:115]
    s_waitcnt lgkmcnt(1)
    v_pk_add_f32 v[128:129], v[128:129], v[116:117]
    s_waitcnt lgkmcnt(0)
    v_pk_add_f32 v[128:129], v[128:129], v[118:119]
    v_cvt_pk_bf16_f32 v130, v128, v129
    buffer_store_dwordx4 v[132:135], v59, s[16:19], s25 offen sc1
    buffer_store_dword v130, v61, s[16:19], s26 offen sc1
    v_dot2c_f32_bf16 v136, v132, v215
    v_dot2c_f32_bf16 v137, v132, v132
    v_dot2c_f32_bf16 v136, v133, v215
    v_dot2c_f32_bf16 v137, v133, v133
    v_dot2c_f32_bf16 v138, v134, v215
    v_dot2c_f32_bf16 v139, v134, v134
    v_dot2c_f32_bf16 v138, v135, v215
    v_dot2c_f32_bf16 v139, v135, v135
    v_dot2c_f32_bf16 v140, v130, v215
    v_dot2c_f32_bf16 v141, v130, v130
    v_permlane32_swap_b32 v136, v138
    v_permlane32_swap_b32 v137, v139
    v_pk_add_f32 v[136:137], v[136:137], v[138:139]
    v_pk_add_f32 v[136:137], v[136:137], v[140:141]
    s_nop 1
    v_permlane16_swap_b32 v136, v137
    v_add_f32_e64 v136, v136, v137
    ds_write_b32 v206, v136 offset:32768
    s_mov_b32 s96, 4198400
    buffer_load_dwordx4 v[216:219], v56, s[16:19], s96 offen offset:0 sc1
    buffer_load_dwordx4 v[220:223], v56, s[16:19], s96 offen offset:256 sc1
    s_mov_b32 s96, 4231168
    buffer_load_dwordx4 v[224:227], v56, s[16:19], s96 offen offset:0 sc1
    buffer_load_dwordx4 v[228:231], v56, s[16:19], s96 offen offset:256 sc1
    s_mov_b32 s96, 4263936
    buffer_load_dwordx4 v[232:235], v56, s[16:19], s96 offen offset:0 sc1
    buffer_load_dwordx4 v[236:239], v56, s[16:19], s96 offen offset:256 sc1
    s_mov_b32 s96, 4296704
    buffer_load_dwordx4 v[240:243], v56, s[16:19], s96 offen offset:0 sc1
    buffer_load_dwordx4 v[244:247], v56, s[16:19], s96 offen offset:256 sc1
    s_mov_b32 s96, 4196352
    buffer_load_dwordx2 v[248:249], v57, s[16:19], s96 offen offset:0 sc1
    buffer_load_dwordx2 v[252:253], v57, s[16:19], s96 offen offset:128 sc1
    s_mov_b32 s96, 4212736
    buffer_load_dwordx2 v[250:251], v57, s[16:19], s96 offen offset:0 sc1
    buffer_load_dwordx2 v[254:255], v57, s[16:19], s96 offen offset:128 sc1
    s_mov_b32 s96, 1310720
    s_mov_b32 s97, 1315840
    buffer_load_dwordx2 v[208:209], v60, s[4:7], s96 offen
    buffer_load_dwordx2 v[210:211], v60, s[4:7], s97 offen
    v_lshrrev_b32_e64 v212, 5, v1
    v_mul_u32_u24 v212, 5104, v212
    v_bfe_u32 v213, v1, 4, 1
    v_lshlrev_b32 v213, 2, v213
    v_sub_u32 v212, v212, v213
    v_add_u32 v212, v212, v60
    s_mul_i32 s97, s24, 24
    s_sub_u32 s97, 1310848, s97
    buffer_load_dword v212, v212, s[4:7], s97 offen
    s_waitcnt lgkmcnt(0)
    s_barrier
    ds_read2st64_b32 v[136:137], v207 offset0:0 offset1:1
    ds_read2st64_b32 v[138:139], v207 offset0:2 offset1:3
    ds_read_b64_tr_b16 v[144:145], v65 offset:32
    ds_read_b64_tr_b16 v[146:147], v65 offset:0
    ds_read_b64_tr_b16 v[148:149], v65 offset:160
    ds_read_b64_tr_b16 v[150:151], v65 offset:128
    ds_read_b64_tr_b16 v[152:153], v65 offset:288
    ds_read_b64_tr_b16 v[154:155], v65 offset:256
    ds_read_b64_tr_b16 v[156:157], v65 offset:416
    ds_read_b64_tr_b16 v[158:159], v65 offset:384
    ds_read_b64_tr_b16 v[160:161], v65 offset:544
    ds_read_b64_tr_b16 v[162:163], v65 offset:512
    ds_read_b64_tr_b16 v[164:165], v65 offset:672
    ds_read_b64_tr_b16 v[166:167], v65 offset:640
    ds_read_b64_tr_b16 v[168:169], v65 offset:800
    ds_read_b64_tr_b16 v[170:171], v65 offset:768
    ds_read_b64_tr_b16 v[172:173], v65 offset:928
    ds_read_b64_tr_b16 v[174:175], v65 offset:896
    s_waitcnt lgkmcnt(15)
    v_pk_add_f32 v[136:137], v[136:137], v[138:139]
    v_add_f32 v136, v136, v137
    v_cndmask_b32 v136, v136, 1.0, s[28:29]
    s_mov_b64 exec, s[80:81]
    buffer_atomic_add_f32 v136, v214, s[16:19], s27 offen sc1
    s_mov_b64 exec, -1
    v_lshrrev_b32 v176, 4, v0
    v_mul_u32_u24 v176, 1216, v176
    v_and_b32 v177, 15, v0
    v_lshl_add_u32 v176, v177, 3, v176
    v_add_u32 v176, 64, v176
    v_mov_b32 v178, 0
    v_mov_b32 v179, 0
    ds_write_b64 v176, v[178:179]
    v_mov_b32 v70, 0
    v_mov_b32 v71, 0
    v_mov_b32 v72, 0
    s_lshl_b32 s25, s24, 17
    v_lshrrev_b32 v176, 5, v1
    v_lshl_add_u32 v176, v176, 14, s25
    v_bfe_u32 v177, v1, 4, 1
    v_lshl_add_u32 v176, v177, 13, v176
    v_and_b32_e64 v177, 15, v1
    v_lshl_add_u32 v73, v177, 4, v176
    v_bfe_u32 v176, v1, 2, 3
    v_lshl_add_u32 v176, v176, 14, s25
    v_bfe_u32 v177, v1, 1, 1
    v_lshl_add_u32 v176, v177, 13, v176
    v_and_b32 v177, 1, v1
    v_lshl_add_u32 v77, v177, 4, v176
    v_lshrrev_b32 v177, 5, v1
    v_and_b32 v176, 31, v1
    v_lshlrev_b32 v176, 3, v176
    v_lshl_add_u32 v78, v177, 10, v176
    v_and_b32 v176, 7, v1
    v_lshlrev_b32 v176, 3, v176
    v_lshl_add_u32 v178, v177, 7, v176
    v_add_u32 v74, 31744, v73
    v_add_u32 v75, 63488, v73
    v_add_u32 v76, 95232, v73
    v_add_u32 v178, 53760, v178
    v_and_b32 v176, 31, v1
    v_cmp_eq_u32 vcc, 0, v176
    v_cmp_eq_u32 s[82:83], 24, v176
    s_nop 0
    s_or_b64 vcc, vcc, s[82:83]
    v_mov_b32 v176, 155712
    v_mov_b32 v177, 158288
    v_cndmask_b32 v176, v176, v177, vcc
    v_cndmask_b32 v79, v176, v178, s[78:79]
oe_23:
    s_waitcnt vmcnt(15)
    v_mfma_f32_16x16x32_bf16 v[112:115], a[176:179], v[216:219], 0
    v_mov_b32 v136, 0
    v_mov_b32 v137, 0
    s_waitcnt vmcnt(14)
    v_mfma_f32_16x16x32_bf16 v[116:119], a[176:179], v[220:223], 0
    v_mov_b32 v138, 0
    v_mov_b32 v139, 0
    s_waitcnt vmcnt(13)
    v_mfma_f32_16x16x32_bf16 v[112:115], a[196:199], v[224:227], v[112:115]
    v_mov_b32 v140, 0
    v_mov_b32_e64 v141, 0
    s_waitcnt vmcnt(12)
    v_mfma_f32_16x16x32_bf16 v[116:119], a[196:199], v[228:231], v[116:119]
    s_mov_b32 s25, 6817792
    s_add_u32 s26, s36, 6817792
    s_waitcnt vmcnt(11)
    v_mfma_f32_16x16x32_bf16 v[112:115], a[216:219], v[232:235], v[112:115]
    s_add_u32 s27, s35, 3477504
    s_mov_b32 s28, 0x99999999
    s_waitcnt vmcnt(10)
    v_mfma_f32_16x16x32_bf16 v[116:119], a[216:219], v[236:239], v[116:119]
    s_mov_b32 s29, 0x99999999
    s_waitcnt vmcnt(9)
    v_mfma_f32_16x16x32_bf16 v[112:115], a[236:239], v[240:243], v[112:115]
    s_waitcnt vmcnt(8)
    v_mfma_f32_16x16x32_bf16 v[116:119], a[236:239], v[244:247], v[116:119]
    s_waitcnt vmcnt(5)
    v_mfma_f32_16x16x32_bf16 v[112:115], v[52:55], v[248:251], v[112:115]
    s_waitcnt vmcnt(4)
    v_mfma_f32_16x16x32_bf16 v[116:119], v[52:55], v[252:255], v[116:119]
    v_mfma_f32_16x16x32_bf16 v[88:91], a[164:167], v[216:219], 0
    v_mfma_f32_16x16x32_bf16 v[92:95], a[164:167], v[220:223], 0
    v_mfma_f32_16x16x32_bf16 v[88:91], a[184:187], v[224:227], v[88:91]
    v_mfma_f32_16x16x32_bf16 v[92:95], a[184:187], v[228:231], v[92:95]
    v_mfma_f32_16x16x32_bf16 v[88:91], a[204:207], v[232:235], v[88:91]
    v_mfma_f32_16x16x32_bf16 v[92:95], a[204:207], v[236:239], v[92:95]
    s_nop 1
    v_cmp_u_f32 vcc, v112, v116
    s_nop 0
    s_cbranch_vccnz rd_24
rc_25:
    v_mfma_f32_16x16x32_bf16 v[88:91], a[224:227], v[240:243], v[88:91]
    ds_write_b128 v203, v[112:115] offset:24576
    v_mfma_f32_16x16x32_bf16 v[92:95], a[224:227], v[244:247], v[92:95]
    v_mfma_f32_16x16x32_bf16 v[88:91], a[244:247], v[248:251], v[88:91]
    ds_write_b128 v203, v[116:119] offset:25600
    v_mfma_f32_16x16x32_bf16 v[92:95], a[244:247], v[252:255], v[92:95]
    v_mfma_f32_16x16x32_bf16 v[96:99], a[168:171], v[216:219], 0
    s_waitcnt vmcnt(3)
    v_lshlrev_b32 v120, 16, v208
    v_and_b32 v121, 0xffff0000, v208
    v_mfma_f32_16x16x32_bf16 v[100:103], a[168:171], v[220:223], 0
    v_lshlrev_b32_e64 v122, 16, v209
    v_and_b32 v123, 0xffff0000, v209
    v_mfma_f32_16x16x32_bf16 v[96:99], a[188:191], v[224:227], v[96:99]
    s_waitcnt vmcnt(2)
    v_lshlrev_b32 v124, 16, v210
    v_and_b32 v125, 0xffff0000, v210
    v_mfma_f32_16x16x32_bf16 v[100:103], a[188:191], v[228:231], v[100:103]
    v_lshlrev_b32_e64 v126, 16, v211
    v_and_b32 v127, 0xffff0000, v211
    v_mfma_f32_16x16x32_bf16 v[96:99], a[208:211], v[232:235], v[96:99]
    s_waitcnt vmcnt(1)
    v_lshlrev_b32 v128, 16, v212
    v_and_b32 v129, 0xffff0000, v212
    v_mfma_f32_16x16x32_bf16 v[100:103], a[208:211], v[236:239], v[100:103]
    v_mfma_f32_16x16x32_bf16 v[96:99], a[228:231], v[240:243], v[96:99]
    ds_write_b128 v200, v[88:91] offset:0
    v_mfma_f32_16x16x32_bf16 v[100:103], a[228:231], v[244:247], v[100:103]
    v_mfma_f32_16x16x32_bf16 v[96:99], a[248:251], v[248:251], v[96:99]
    ds_write_b128 v200, v[92:95] offset:1024
    v_mfma_f32_16x16x32_bf16 v[100:103], a[248:251], v[252:255], v[100:103]
    v_mfma_f32_16x16x32_bf16 v[104:107], a[172:175], v[216:219], 0
    v_mfma_f32_16x16x32_bf16 v[108:111], a[172:175], v[220:223], 0
    v_mfma_f32_16x16x32_bf16 v[104:107], a[192:195], v[224:227], v[104:107]
    v_mfma_f32_16x16x32_bf16 v[108:111], a[192:195], v[228:231], v[108:111]
    v_mfma_f32_16x16x32_bf16 v[104:107], a[212:215], v[232:235], v[104:107]
    v_mfma_f32_16x16x32_bf16 v[108:111], a[212:215], v[236:239], v[108:111]
    v_mfma_f32_16x16x32_bf16 v[104:107], a[232:235], v[240:243], v[104:107]
    ds_write_b128 v201, v[96:99] offset:2048
    v_mfma_f32_16x16x32_bf16 v[108:111], a[232:235], v[244:247], v[108:111]
    v_mfma_f32_16x16x32_bf16 v[104:107], a[252:255], v[248:251], v[104:107]
    ds_write_b128 v201, v[100:103] offset:3072
    v_mfma_f32_16x16x32_bf16 v[108:111], a[252:255], v[252:255], v[108:111]
    v_mfma_f32_16x16x32_bf16 v[80:83], a[160:163], v[216:219], v[120:123]
    v_mfma_f32_16x16x32_bf16 v[84:87], a[160:163], v[220:223], v[124:127]
    v_mfma_f32_16x16x32_bf16 v[80:83], a[180:183], v[224:227], v[80:83]
    v_mfma_f32_16x16x32_bf16 v[84:87], a[180:183], v[228:231], v[84:87]
    v_mfma_f32_16x16x32_bf16 v[80:83], a[200:203], v[232:235], v[80:83]
    s_nop 0
    ds_write_b128 v202, v[104:107] offset:4096
    v_mfma_f32_16x16x32_bf16 v[84:87], a[200:203], v[236:239], v[84:87]
    ds_write_b128 v202, v[108:111] offset:5120
    v_mfma_f32_16x16x32_bf16 v[80:83], a[220:223], v[240:243], v[80:83]
    v_mfma_f32_16x16x32_bf16 v[84:87], a[220:223], v[244:247], v[84:87]
    v_mfma_f32_16x16x32_bf16 v[80:83], a[240:243], v[248:251], v[80:83]
    v_mfma_f32_16x16x32_bf16 v[84:87], a[240:243], v[252:255], v[84:87]
    s_waitcnt lgkmcnt(0)
    s_barrier
    s_nop 0
    ds_read_b128 v[88:91], v204 offset:0
    ds_read_b128 v[92:95], v204 offset:1024
    ds_read_b128 v[96:99], v204 offset:2048
    ds_read_b128 v[100:103], v204 offset:3072
    ds_read_b128 v[104:107], v204 offset:4096
    ds_read_b128 v[108:111], v204 offset:5120
    ds_read_b64 v[112:113], v205 offset:24576
    ds_read_b64 v[114:115], v205 offset:26624
    ds_read_b64 v[116:117], v205 offset:28672
    ds_read_b64 v[118:119], v205 offset:30720
    s_lshl_b32 s96, s75, 14
    s_add_u32 s96, s96, 6815744
    s_lshl_b32 s97, s24, 12
    s_add_u32 s97, s97, 3473408
    buffer_load_dwordx4 v[176:179], v62, s[16:19], s96 offen offset:0 sc1
    buffer_load_dwordx4 v[180:183], v62, s[16:19], s96 offen offset:1024 sc1
    s_waitcnt lgkmcnt(9)
    v_pk_add_f32 v[80:81], v[80:81], v[88:89]
    v_pk_add_f32 v[82:83], v[82:83], v[90:91]
    s_waitcnt lgkmcnt(8)
    v_pk_add_f32 v[84:85], v[84:85], v[92:93]
    v_pk_add_f32 v[86:87], v[86:87], v[94:95]
    s_waitcnt lgkmcnt(7)
    v_pk_add_f32 v[80:81], v[80:81], v[96:97]
    v_pk_add_f32 v[82:83], v[82:83], v[98:99]
    s_waitcnt lgkmcnt(6)
    v_pk_add_f32 v[84:85], v[84:85], v[100:101]
    v_pk_add_f32 v[86:87], v[86:87], v[102:103]
    s_waitcnt lgkmcnt(5)
    v_pk_add_f32 v[80:81], v[80:81], v[104:105]
    v_pk_add_f32 v[82:83], v[82:83], v[106:107]
    s_waitcnt lgkmcnt(4)
    v_pk_add_f32 v[84:85], v[84:85], v[108:109]
    v_pk_add_f32 v[86:87], v[86:87], v[110:111]
    v_cvt_pk_bf16_f32 v132, v80, v81
    v_cvt_pk_bf16_f32 v133, v82, v83
    v_cvt_pk_bf16_f32 v134, v84, v85
    v_cvt_pk_bf16_f32 v135, v86, v87
    s_waitcnt lgkmcnt(3)
    v_pk_add_f32 v[128:129], v[128:129], v[112:113]
    s_waitcnt lgkmcnt(2)
    v_pk_add_f32 v[128:129], v[128:129], v[114:115]
    s_waitcnt lgkmcnt(1)
    v_pk_add_f32 v[128:129], v[128:129], v[116:117]
    s_waitcnt lgkmcnt(0)
    v_pk_add_f32 v[128:129], v[128:129], v[118:119]
    v_cvt_pk_bf16_f32 v130, v128, v129
    buffer_store_dwordx4 v[132:135], v59, s[16:19], s25 offen sc1
    buffer_store_dword v130, v61, s[16:19], s26 offen sc1
    v_dot2c_f32_bf16 v136, v132, v215
    v_dot2c_f32_bf16 v137, v132, v132
    v_dot2c_f32_bf16 v136, v133, v215
    v_dot2c_f32_bf16 v137, v133, v133
    v_dot2c_f32_bf16 v138, v134, v215
    v_dot2c_f32_bf16 v139, v134, v134
    v_dot2c_f32_bf16 v138, v135, v215
    v_dot2c_f32_bf16 v139, v135, v135
    v_dot2c_f32_bf16 v140, v130, v215
    v_dot2c_f32_bf16 v141, v130, v130
    v_permlane32_swap_b32 v136, v138
    v_permlane32_swap_b32 v137, v139
    v_pk_add_f32 v[136:137], v[136:137], v[138:139]
    v_pk_add_f32 v[136:137], v[136:137], v[140:141]
    s_nop 1
    v_permlane16_swap_b32 v136, v137
    v_add_f32_e64 v136, v136, v137
    ds_write_b32 v206, v136 offset:32768
    buffer_load_dwordx4 v[184:187], v62, s[16:19], s97 offen offset:0 sc1
    buffer_load_dwordx4 v[188:191], v62, s[16:19], s97 offen offset:1024 sc1
    buffer_load_dwordx4 v[192:195], v62, s[16:19], s97 offen offset:2048 sc1
    buffer_load_dwordx4 v[196:199], v62, s[16:19], s97 offen offset:3072 sc1
    s_waitcnt lgkmcnt(0)
    s_barrier
    ds_read2st64_b32 v[136:137], v207 offset0:0 offset1:1
    ds_read2st64_b32 v[138:139], v207 offset0:2 offset1:3
    s_waitcnt lgkmcnt(0)
    v_pk_add_f32 v[136:137], v[136:137], v[138:139]
    v_add_f32 v136, v136, v137
    v_cndmask_b32 v136, v136, 1.0, s[28:29]
    s_mov_b64 exec, s[80:81]
    buffer_atomic_add_f32 v136, v214, s[16:19], s27 offen sc1
    s_mov_b64 exec, -1
    s_cmp_ge_u32 s2, 160
    s_cbranch_scc1 nc_26
    v_mov_b32 v248, -1
    v_mov_b32 v249, -1
    v_mov_b32 v250, -1
    v_mov_b32 v251, -1
    s_lshl_b32 s88, s75, 14
    s_add_u32 s88, s88, 9437184
    buffer_store_dwordx4 v[248:251], v62, s[16:19], s88 offen offset:0 sc1
    buffer_store_dwordx4 v[248:251], v62, s[16:19], s88 offen offset:1024 sc1
    s_waitcnt vmcnt(3)
ce_28:
    v_max3_u32 v208, v176, v177, v178
    v_max3_u32 v208, v208, v179, v180
    v_max3_u32 v208, v208, v181, v182
    v_max_u32 v208, v208, v183
    v_cmp_eq_u32 s[82:83], -1, v208
    v_min3_f32 v209, v184, v187, v188
    v_min3_f32 v209, v209, v191, v192
    v_min3_f32 v209, v209, v195, v196
    v_min_f32 v209, v209, v199
    v_cmp_neq_f32 vcc, 0x41000000, v209
    s_nop 0
    s_or_b64 vcc, vcc, s[82:83]
    s_cbranch_vccnz rd_29
rc_30:
    v_mul_f32 v208, 0x3acccccd, v185
    v_mul_f32 v209, 0x3acccccd, v189
    v_mul_f32 v186, 0x3acccccd, v186
    v_mul_f32 v190, 0x3acccccd, v190
    v_fma_f32 v186, -v208, v208, v186
    v_fma_f32 v190, -v209, v209, v190
    v_max_f32 v186, 0, v186
    v_max_f32 v190, 0, v190
    v_add_f32 v186, 0x3727c5ac, v186
    v_add_f32 v190, 0x3727c5ac, v190
    v_rsq_f32 v185, v186
    v_rsq_f32 v189, v190
    v_mul_f32 v186, -v208, v185
    v_mul_f32 v190, -v209, v189
    v_lshlrev_b32 v80, 16, v176
    v_and_b32 v82, 0xffff0000, v176
    v_lshlrev_b32 v84, 16, v177
    v_and_b32 v86, 0xffff0000, v177
    v_lshlrev_b32 v81, 16, v178
    v_and_b32 v83, 0xffff0000, v178
    v_lshlrev_b32 v85, 16, v179
    v_and_b32 v87, 0xffff0000, v179
    v_fma_f32 v208, v80, v185, v186
    v_fma_f32 v209, v81, v189, v190
    v_cvt_pk_bf16_f32 v176, v208, v209
    v_fma_f32 v208, v82, v185, v186
    v_fma_f32 v209, v83, v189, v190
    v_cvt_pk_bf16_f32 v177, v208, v209
    v_fma_f32 v208, v84, v185, v186
    v_fma_f32 v209, v85, v189, v190
    v_cvt_pk_bf16_f32 v178, v208, v209
    v_fma_f32 v208, v86, v185, v186
    v_fma_f32 v209, v87, v189, v190
    v_cvt_pk_bf16_f32 v179, v208, v209
    ds_write_b32 v63, v176 offset:0
    ds_write_b32 v63, v177 offset:4864
    ds_write_b32 v63, v178 offset:9728
    ds_write_b32 v63, v179 offset:14592
    v_mul_f32 v208, 0x3acccccd, v193
    v_mul_f32 v209, 0x3acccccd, v197
    v_mul_f32 v194, 0x3acccccd, v194
    v_mul_f32 v198, 0x3acccccd, v198
    v_fma_f32 v194, -v208, v208, v194
    v_fma_f32 v198, -v209, v209, v198
    v_max_f32 v194, 0, v194
    v_max_f32 v198, 0, v198
    v_add_f32 v194, 0x3727c5ac, v194
    v_add_f32 v198, 0x3727c5ac, v198
    v_rsq_f32 v193, v194
    v_rsq_f32 v197, v198
    v_mul_f32 v194, -v208, v193
    v_mul_f32 v198, -v209, v197
    v_lshlrev_b32 v88, 16, v180
    v_and_b32 v90, 0xffff0000, v180
    v_lshlrev_b32 v92, 16, v181
    v_and_b32 v94, 0xffff0000, v181
    v_lshlrev_b32 v89, 16, v182
    v_and_b32 v91, 0xffff0000, v182
    v_lshlrev_b32 v93, 16, v183
    v_and_b32 v95, 0xffff0000, v183
    v_fma_f32 v208, v88, v193, v194
    v_fma_f32 v209, v89, v197, v198
    v_cvt_pk_bf16_f32 v180, v208, v209
    v_fma_f32 v208, v90, v193, v194
    v_fma_f32 v209, v91, v197, v198
    v_cvt_pk_bf16_f32 v181, v208, v209
    v_fma_f32 v208, v92, v193, v194
    v_fma_f32 v209, v93, v197, v198
    v_cvt_pk_bf16_f32 v182, v208, v209
    v_fma_f32 v208, v94, v193, v194
    v_fma_f32 v209, v95, v197, v198
    v_cvt_pk_bf16_f32 v183, v208, v209
    ds_write_b32 v63, v180 offset:256
    ds_write_b32 v63, v181 offset:5120
    ds_write_b32 v63, v182 offset:9984
    ds_write_b32 v63, v183 offset:14848
    s_waitcnt lgkmcnt(0)
    s_barrier
    ds_read_b128 v[212:215], v64 offset:96
    ds_read_b128 v[216:219], v64 offset:64
    ds_read_b128 v[220:223], v64 offset:32
    ds_read_b128 v[224:227], v64 offset:0
    s_waitcnt lgkmcnt(3)
    v_mfma_f32_32x32x16_bf16 v[96:111], v[212:215], v[144:147], 0
    ds_read_b128 v[228:231], v64 offset:224
    ds_read_b64_tr_b16 v[176:177], v65 offset:1056
    ds_read_b64_tr_b16 v[178:179], v65 offset:1024
    ds_read_b64_tr_b16 v[180:181], v65 offset:1184
    ds_read_b64_tr_b16 v[182:183], v65 offset:1152
    s_waitcnt lgkmcnt(7)
    v_mfma_f32_32x32x16_bf16 v[96:111], v[216:219], v[148:151], v[96:111]
    ds_read_b128 v[232:235], v64 offset:192
    ds_read_b64_tr_b16 v[184:185], v65 offset:1312
    ds_read_b64_tr_b16 v[186:187], v65 offset:1280
    ds_read_b64_tr_b16 v[188:189], v65 offset:1440
    ds_read_b64_tr_b16 v[190:191], v65 offset:1408
    s_waitcnt lgkmcnt(11)
    v_mfma_f32_32x32x16_bf16 v[96:111], v[220:223], v[152:155], v[96:111]
    ds_read_b128 v[236:239], v64 offset:160
    ds_read_b64_tr_b16 v[192:193], v65 offset:1568
    ds_read_b64_tr_b16 v[194:195], v65 offset:1536
    ds_read_b64_tr_b16 v[196:197], v65 offset:1696
    ds_read_b64_tr_b16 v[198:199], v65 offset:1664
    s_waitcnt lgkmcnt(15)
    v_mfma_f32_32x32x16_bf16 v[96:111], v[224:227], v[156:159], v[96:111]
    ds_read_b128 v[240:243], v64 offset:128
    ds_read_b64_tr_b16 v[200:201], v65 offset:1824
    ds_read_b64_tr_b16 v[202:203], v65 offset:1792
    ds_read_b64_tr_b16 v[204:205], v65 offset:1952
    ds_read_b64_tr_b16 v[206:207], v65 offset:1920
    s_waitcnt lgkmcnt(15)
    v_mfma_f32_32x32x16_bf16 v[112:127], v[228:231], v[144:147], 0
    buffer_store_dwordx4 v[248:251], v62, s[16:19], s88 offen offset:2048 sc1
    s_nop 3
    s_waitcnt lgkmcnt(14)
    v_mfma_f32_32x32x16_bf16 v[112:127], v[232:235], v[148:151], v[112:127]
    v_cndmask_b32 v208, v99, v72, s[76:77]
    v_cndmask_b32 v209, v103, v99, s[76:77]
    v_cndmask_b32 v210, v107, v103, s[76:77]
    v_cndmask_b32 v211, v111, v107, s[76:77]
    v_mov_b32_e64 v72, v111
    s_waitcnt lgkmcnt(9)
    v_mfma_f32_32x32x16_bf16 v[112:127], v[236:239], v[152:155], v[112:127]
    v_add_f32_dpp v98, v208, v98 wave_ror:1 row_mask:0xf bank_mask:0xf
    v_add_f32_dpp v102, v209, v102 wave_ror:1 row_mask:0xf bank_mask:0xf
    v_add_f32_dpp v106, v210, v106 wave_ror:1 row_mask:0xf bank_mask:0xf
    v_add_f32_dpp v110, v211, v110 wave_ror:1 row_mask:0xf bank_mask:0xf
    v_cndmask_b32 v208, v98, v71, s[76:77]
    s_waitcnt lgkmcnt(4)
    v_mfma_f32_32x32x16_bf16 v[112:127], v[240:243], v[156:159], v[112:127]
    v_cndmask_b32 v209, v102, v98, s[76:77]
    v_cndmask_b32 v210, v106, v102, s[76:77]
    v_cndmask_b32 v211, v110, v106, s[76:77]
    v_mov_b32 v71, v110
    v_add_f32_dpp v97, v208, v97 wave_ror:1 row_mask:0xf bank_mask:0xf
    v_add_f32_dpp v101, v209, v101 wave_ror:1 row_mask:0xf bank_mask:0xf
    v_mfma_f32_32x32x16_bf16 v[112:127], v[212:215], v[160:163], v[112:127]
    ds_read_b128 v[244:247], v64 offset:352
    v_add_f32_dpp v105, v210, v105 wave_ror:1 row_mask:0xf bank_mask:0xf
    v_add_f32_dpp v109, v211, v109 wave_ror:1 row_mask:0xf bank_mask:0xf
    v_cndmask_b32 v208, v97, v70, s[76:77]
    v_cndmask_b32 v209, v101, v97, s[76:77]
    v_cndmask_b32 v210, v105, v101, s[76:77]
    v_mfma_f32_32x32x16_bf16 v[112:127], v[216:219], v[164:167], v[112:127]
    ds_read_b128 v[216:219], v64 offset:320
    v_cndmask_b32 v211, v109, v105, s[76:77]
    v_mov_b32_e64 v70, v109
    v_add_f32_dpp v96, v208, v96 wave_ror:1 row_mask:0xf bank_mask:0xf
    v_add_f32_dpp v100, v209, v100 wave_ror:1 row_mask:0xf bank_mask:0xf
    v_add_f32_dpp v104, v210, v104 wave_ror:1 row_mask:0xf bank_mask:0xf
    v_mfma_f32_32x32x16_bf16 v[112:127], v[220:223], v[168:171], v[112:127]
    ds_read_b128 v[220:223], v64 offset:288
    buffer_store_dwordx4 v[248:251], v62, s[16:19], s88 offen offset:3072 sc1
    v_add_f32_dpp v108, v211, v108 wave_ror:1 row_mask:0xf bank_mask:0xf
    v_mfma_f32_32x32x16_bf16 v[112:127], v[224:227], v[172:175], v[112:127]
    ds_read_b128 v[224:227], v64 offset:256
    ds_write_b32 v66, v96 offset:0
    ds_write_b32 v66, v100 offset:64
    s_waitcnt lgkmcnt(5)
    v_mfma_f32_32x32x16_bf16 v[128:143], v[244:247], v[144:147], 0
    ds_write_b32 v66, v104 offset:128
    ds_write_b32 v66, v108 offset:192
    s_nop 0
    s_waitcnt lgkmcnt(6)
    v_mfma_f32_32x32x16_bf16 v[128:143], v[216:219], v[148:151], v[128:143]
    s_nop 3
    v_cndmask_b32 v208, v115, v72, s[76:77]
    s_waitcnt lgkmcnt(5)
    v_mfma_f32_32x32x16_bf16 v[128:143], v[220:223], v[152:155], v[128:143]
    v_cndmask_b32 v209, v119, v115, s[76:77]
    v_cndmask_b32 v210, v123, v119, s[76:77]
    v_cndmask_b32 v211, v127, v123, s[76:77]
    v_mov_b32 v72, v127
    v_add_f32_dpp v114, v208, v114 wave_ror:1 row_mask:0xf bank_mask:0xf
    s_waitcnt lgkmcnt(4)
    v_mfma_f32_32x32x16_bf16 v[128:143], v[224:227], v[156:159], v[128:143]
    v_add_f32_dpp v118, v209, v118 wave_ror:1 row_mask:0xf bank_mask:0xf
    v_add_f32_dpp v122, v210, v122 wave_ror:1 row_mask:0xf bank_mask:0xf
    v_add_f32_dpp v126, v211, v126 wave_ror:1 row_mask:0xf bank_mask:0xf
    v_cndmask_b32 v208, v114, v71, s[76:77]
    v_cndmask_b32 v209, v118, v114, s[76:77]
    v_cndmask_b32 v210, v122, v118, s[76:77]
    v_mfma_f32_32x32x16_bf16 v[128:143], v[228:231], v[160:163], v[128:143]
    v_cndmask_b32 v211, v126, v122, s[76:77]
    v_mov_b32 v71, v126
    v_add_f32_dpp v113, v208, v113 wave_ror:1 row_mask:0xf bank_mask:0xf
    v_add_f32_dpp v117, v209, v117 wave_ror:1 row_mask:0xf bank_mask:0xf
    v_add_f32_dpp v121, v210, v121 wave_ror:1 row_mask:0xf bank_mask:0xf
    v_add_f32_dpp v125, v211, v125 wave_ror:1 row_mask:0xf bank_mask:0xf
    v_mfma_f32_32x32x16_bf16 v[128:143], v[232:235], v[164:167], v[128:143]
    ds_read_b128 v[232:235], v64 offset:64
    v_cndmask_b32 v208, v113, v70, s[76:77]
    v_cndmask_b32 v209, v117, v113, s[76:77]
    v_cndmask_b32 v210, v121, v117, s[76:77]
    v_cndmask_b32 v211, v125, v121, s[76:77]
    v_mov_b32_e64 v70, v125
    v_mfma_f32_32x32x16_bf16 v[128:143], v[236:239], v[168:171], v[128:143]
    ds_read_b128 v[236:239], v64 offset:32
    v_add_f32_dpp v112, v208, v112 wave_ror:1 row_mask:0xf bank_mask:0xf
    v_add_f32_dpp v116, v209, v116 wave_ror:1 row_mask:0xf bank_mask:0xf
    v_add_f32_dpp v120, v210, v120 wave_ror:1 row_mask:0xf bank_mask:0xf
    v_add_f32_dpp v124, v211, v124 wave_ror:1 row_mask:0xf bank_mask:0xf
    v_mfma_f32_32x32x16_bf16 v[128:143], v[240:243], v[172:175], v[128:143]
    ds_read_b128 v[240:243], v64 offset:0
    ds_write_b32 v66, v112 offset:256
    ds_write_b32 v66, v116 offset:320
    v_mfma_f32_32x32x16_bf16 v[128:143], v[212:215], v[176:179], v[128:143]
    ds_read_b128 v[212:215], v64 offset:480
    ds_write_b32 v66, v120 offset:384
    ds_write_b32 v66, v124 offset:448
    s_waitcnt lgkmcnt(7)
    v_mfma_f32_32x32x16_bf16 v[128:143], v[232:235], v[180:183], v[128:143]
    ds_read_b128 v[232:235], v64 offset:448
    s_waitcnt lgkmcnt(7)
    v_mfma_f32_32x32x16_bf16 v[128:143], v[236:239], v[184:187], v[128:143]
    ds_read_b128 v[236:239], v64 offset:416
    s_waitcnt lgkmcnt(7)
    v_mfma_f32_32x32x16_bf16 v[128:143], v[240:243], v[188:191], v[128:143]
    ds_read_b128 v[240:243], v64 offset:384
    s_nop 3
    s_waitcnt lgkmcnt(5)
    v_mfma_f32_32x32x16_bf16 v[112:127], v[212:215], v[144:147], 0
    s_nop 4
    s_waitcnt lgkmcnt(2)
    v_mfma_f32_32x32x16_bf16 v[112:127], v[232:235], v[148:151], v[112:127]
    v_cndmask_b32 v208, v131, v72, s[76:77]
    v_cndmask_b32 v209, v135, v131, s[76:77]
    v_cndmask_b32 v210, v139, v135, s[76:77]
    v_cndmask_b32 v211, v143, v139, s[76:77]
    v_mov_b32_e64 v72, v143
    s_waitcnt lgkmcnt(1)
    v_mfma_f32_32x32x16_bf16 v[112:127], v[236:239], v[152:155], v[112:127]
    v_add_f32_dpp v130, v208, v130 wave_ror:1 row_mask:0xf bank_mask:0xf
    v_add_f32_dpp v134, v209, v134 wave_ror:1 row_mask:0xf bank_mask:0xf
    v_add_f32_dpp v138, v210, v138 wave_ror:1 row_mask:0xf bank_mask:0xf
    v_add_f32_dpp v142, v211, v142 wave_ror:1 row_mask:0xf bank_mask:0xf
    v_cndmask_b32 v208, v130, v71, s[76:77]
    s_waitcnt lgkmcnt(0)
    v_mfma_f32_32x32x16_bf16 v[112:127], v[240:243], v[156:159], v[112:127]
    v_cndmask_b32 v209, v134, v130, s[76:77]
    v_cndmask_b32 v210, v138, v134, s[76:77]
    v_cndmask_b32 v211, v142, v138, s[76:77]
    v_mov_b32 v71, v142
    v_add_f32_dpp v129, v208, v129 wave_ror:1 row_mask:0xf bank_mask:0xf
    v_add_f32_dpp v133, v209, v133 wave_ror:1 row_mask:0xf bank_mask:0xf
    v_mfma_f32_32x32x16_bf16 v[112:127], v[244:247], v[160:163], v[112:127]
    v_add_f32_dpp v137, v210, v137 wave_ror:1 row_mask:0xf bank_mask:0xf
    v_add_f32_dpp v141, v211, v141 wave_ror:1 row_mask:0xf bank_mask:0xf
    v_cndmask_b32 v208, v129, v70, s[76:77]
    v_cndmask_b32 v209, v133, v129, s[76:77]
    v_cndmask_b32 v210, v137, v133, s[76:77]
    v_cndmask_b32 v211, v141, v137, s[76:77]
    v_mfma_f32_32x32x16_bf16 v[112:127], v[216:219], v[164:167], v[112:127]
    ds_read_b128 v[240:243], v64 offset:192
    v_mov_b32_e64 v70, v141
    v_add_f32_dpp v128, v208, v128 wave_ror:1 row_mask:0xf bank_mask:0xf
    v_add_f32_dpp v132, v209, v132 wave_ror:1 row_mask:0xf bank_mask:0xf
    v_add_f32_dpp v136, v210, v136 wave_ror:1 row_mask:0xf bank_mask:0xf
    v_add_f32_dpp v140, v211, v140 wave_ror:1 row_mask:0xf bank_mask:0xf
    v_mfma_f32_32x32x16_bf16 v[112:127], v[220:223], v[168:171], v[112:127]
    ds_read_b128 v[220:223], v64 offset:160
    ds_write_b32 v66, v128 offset:512
    ds_write_b32 v66, v132 offset:576
    v_mfma_f32_32x32x16_bf16 v[112:127], v[224:227], v[172:175], v[112:127]
    ds_read_b128 v[224:227], v64 offset:128
    ds_write_b32 v66, v136 offset:640
    ds_write_b32 v66, v140 offset:704
    v_mfma_f32_32x32x16_bf16 v[112:127], v[228:231], v[176:179], v[112:127]
    ds_read_b128 v[236:239], v64 offset:96
    s_waitcnt lgkmcnt(7)
    v_mfma_f32_32x32x16_bf16 v[112:127], v[240:243], v[180:183], v[112:127]
    ds_read_b128 v[240:243], v64 offset:64
    s_waitcnt lgkmcnt(7)
    v_mfma_f32_32x32x16_bf16 v[112:127], v[220:223], v[184:187], v[112:127]
    ds_read_b128 v[220:223], v64 offset:32
    s_waitcnt lgkmcnt(5)
    v_mfma_f32_32x32x16_bf16 v[112:127], v[224:227], v[188:191], v[112:127]
    ds_read_b128 v[224:227], v64 offset:0
    s_waitcnt lgkmcnt(3)
    v_mfma_f32_32x32x16_bf16 v[112:127], v[236:239], v[192:195], v[112:127]
    ds_read_b64_tr_b16 v[216:217], v65 offset:544
    ds_read_b64_tr_b16 v[218:219], v65 offset:512
    s_waitcnt lgkmcnt(4)
    v_mfma_f32_32x32x16_bf16 v[112:127], v[240:243], v[196:199], v[112:127]
    ds_read_b64_tr_b16 v[240:241], v65 offset:1056
    ds_read_b64_tr_b16 v[242:243], v65 offset:1024
    s_waitcnt lgkmcnt(5)
    v_mfma_f32_32x32x16_bf16 v[112:127], v[220:223], v[200:203], v[112:127]
    s_waitcnt lgkmcnt(4)
    v_mfma_f32_32x32x16_bf16 v[112:127], v[224:227], v[204:207], v[112:127]
    ds_read_b64_tr_b16 v[224:225], v65 offset:1568
    ds_read_b64_tr_b16 v[226:227], v65 offset:1536
    s_lshl_b32 s96, s75, 14
    s_add_u32 s96, s96, 6815744
    s_lshl_b32 s97, s24, 12
    s_add_u32 s97, s97, 3477504
    buffer_load_dwordx4 v[248:251], v62, s[16:19], s96 offen offset:2048 sc1
    s_waitcnt lgkmcnt(4)
    v_mfma_f32_32x32x16_bf16 v[144:159], v[212:215], v[216:219], 0
    s_nop 3
    v_cndmask_b32 v208, v115, v72, s[76:77]
    s_waitcnt lgkmcnt(2)
    v_mfma_f32_32x32x16_bf16 v[144:159], v[244:247], v[240:243], v[144:159]
    buffer_load_dwordx4 v[252:255], v62, s[16:19], s96 offen offset:3072 sc1
    v_cndmask_b32 v209, v119, v115, s[76:77]
    v_cndmask_b32 v210, v123, v119, s[76:77]
    v_cndmask_b32 v211, v127, v123, s[76:77]
    v_mov_b32_e64 v72, v127
    v_add_f32_dpp v114, v208, v114 wave_ror:1 row_mask:0xf bank_mask:0xf
    v_mfma_f32_32x32x16_bf16 v[160:175], v[212:215], v[240:243], 0
    ds_read_b64_tr_b16 v[216:217], v65 offset:2080
    ds_read_b64_tr_b16 v[218:219], v65 offset:2048
    v_add_f32_dpp v118, v209, v118 wave_ror:1 row_mask:0xf bank_mask:0xf
    v_add_f32_dpp v122, v210, v122 wave_ror:1 row_mask:0xf bank_mask:0xf
    v_add_f32_dpp v126, v211, v126 wave_ror:1 row_mask:0xf bank_mask:0xf
    s_waitcnt lgkmcnt(2)
    v_mfma_f32_32x32x16_bf16 v[144:159], v[228:231], v[224:227], v[144:159]
    buffer_load_dwordx4 v[96:99], v62, s[16:19], s97 offen offset:0 sc1
    v_cndmask_b32 v208, v114, v71, s[76:77]
    v_cndmask_b32 v209, v118, v114, s[76:77]
    v_cndmask_b32 v210, v122, v118, s[76:77]
    v_cndmask_b32 v211, v126, v122, s[76:77]
    v_mov_b32 v71, v126
    v_mfma_f32_32x32x16_bf16 v[160:175], v[244:247], v[224:227], v[160:175]
    v_add_f32_dpp v113, v208, v113 wave_ror:1 row_mask:0xf bank_mask:0xf
    v_add_f32_dpp v117, v209, v117 wave_ror:1 row_mask:0xf bank_mask:0xf
    v_add_f32_dpp v121, v210, v121 wave_ror:1 row_mask:0xf bank_mask:0xf
    v_add_f32_dpp v125, v211, v125 wave_ror:1 row_mask:0xf bank_mask:0xf
    v_cndmask_b32 v208, v113, v70, s[76:77]
    v_cndmask_b32 v209, v117, v113, s[76:77]
    v_mfma_f32_32x32x16_bf16 v[176:191], v[212:215], v[224:227], 0
    buffer_load_dwordx4 v[100:103], v62, s[16:19], s97 offen offset:1024 sc1
    v_cndmask_b32 v210, v121, v117, s[76:77]
    v_cndmask_b32 v211, v125, v121, s[76:77]
    v_mov_b32 v70, v125
    v_add_f32_dpp v112, v208, v112 wave_ror:1 row_mask:0xf bank_mask:0xf
    s_waitcnt lgkmcnt(0)
    v_mfma_f32_32x32x16_bf16 v[144:159], v[236:239], v[216:219], v[144:159]
    ds_read_b64_tr_b16 v[240:241], v65 offset:2592
    ds_read_b64_tr_b16 v[242:243], v65 offset:2560
    v_add_f32_dpp v116, v209, v116 wave_ror:1 row_mask:0xf bank_mask:0xf
    v_add_f32_dpp v120, v210, v120 wave_ror:1 row_mask:0xf bank_mask:0xf
    v_add_f32_dpp v124, v211, v124 wave_ror:1 row_mask:0xf bank_mask:0xf
    v_mfma_f32_32x32x16_bf16 v[160:175], v[228:231], v[216:219], v[160:175]
    buffer_load_dwordx4 v[104:107], v62, s[16:19], s97 offen offset:2048 sc1
    ds_write_b32 v66, v112 offset:768
    ds_write_b32 v66, v116 offset:832
    v_mfma_f32_32x32x16_bf16 v[176:191], v[244:247], v[216:219], v[176:191]
    ds_write_b32 v66, v120 offset:896
    ds_write_b32 v66, v124 offset:960
    v_mfma_f32_32x32x16_bf16 v[192:207], v[212:215], v[216:219], 0
    ds_read_b64_tr_b16 v[212:213], v65 offset:3104
    ds_read_b64_tr_b16 v[214:215], v65 offset:3072
    buffer_load_dwordx4 v[108:111], v62, s[16:19], s97 offen offset:3072 sc1
    s_waitcnt lgkmcnt(6)
    v_mfma_f32_32x32x16_bf16 v[160:175], v[236:239], v[240:243], v[160:175]
    v_mfma_f32_32x32x16_bf16 v[176:191], v[228:231], v[240:243], v[176:191]
    ds_read_b64_tr_b16 v[224:225], v65 offset:3616
    ds_read_b64_tr_b16 v[226:227], v65 offset:3584
    s_waitcnt vmcnt(6) lgkmcnt(4)
    s_barrier
    v_mfma_f32_32x32x16_bf16 v[192:207], v[244:247], v[240:243], v[192:207]
    ds_read_b64_tr_b16 v[244:245], v65 offset:672
    ds_read_b64_tr_b16 v[246:247], v65 offset:640
    ds_read_b64 v[112:113], v67 offset:0
    ds_read_b64 v[114:115], v67 offset:4224
    ds_read_b64 v[116:117], v67 offset:8448
    s_waitcnt lgkmcnt(7)
    v_mfma_f32_32x32x16_bf16 v[176:191], v[236:239], v[212:215], v[176:191]
    ds_read_b128 v[216:219], v64 offset:320
    ds_read_b64_tr_b16 v[240:241], v65 offset:1184
    ds_read_b64_tr_b16 v[242:243], v65 offset:1152
    ds_read_b64 v[118:119], v67 offset:12672
    ds_read_b64 v[120:121], v67 offset:512
    ds_read_b64 v[122:123], v67 offset:4736
    v_mfma_f32_32x32x16_bf16 v[192:207], v[228:231], v[212:215], v[192:207]
    ds_read_b64 v[124:125], v67 offset:8960
    ds_read_b64 v[126:127], v67 offset:13184
    s_lshl_b32 s25, s75, 14
    s_add_u32 s25, s25, 9437184
    s_waitcnt lgkmcnt(13)
    v_mfma_f32_32x32x16_bf16 v[192:207], v[236:239], v[224:227], v[192:207]
    ds_read_b128 v[228:231], v64 offset:192
    ds_read_b64_tr_b16 v[236:237], v65 offset:1696
    ds_read_b64_tr_b16 v[238:239], v65 offset:1664
    s_waitcnt lgkmcnt(14)
    v_mfma_f32_32x32x16_bf16 v[144:159], v[232:235], v[244:247], v[144:159]
    v_mov_b32 v5, 1
    s_add_u32 s82, s86, 24576
    buffer_atomic_add v5, v6, s[16:19], s82 offen offset:0 sc0 sc1
    s_waitcnt lgkmcnt(8)
    v_mfma_f32_32x32x16_bf16 v[144:159], v[216:219], v[240:243], v[144:159]
    v_mfma_f32_32x32x16_bf16 v[160:175], v[232:235], v[240:243], v[160:175]
    ds_read_b128 v[212:215], v64 offset:64
    ds_read_b64_tr_b16 v[224:225], v65 offset:2208
    ds_read_b64_tr_b16 v[226:227], v65 offset:2176
    s_waitcnt lgkmcnt(3)
    v_mfma_f32_32x32x16_bf16 v[144:159], v[228:231], v[236:239], v[144:159]
    v_mfma_f32_32x32x16_bf16 v[160:175], v[216:219], v[236:239], v[160:175]
    v_add_f32 v112, v112, v80
    v_add_f32 v113, v113, v81
    v_add_f32 v114, v114, v82
    v_add_f32 v115, v115, v83
    v_add_f32 v116, v116, v84
    v_mfma_f32_32x32x16_bf16 v[176:191], v[232:235], v[236:239], v[176:191]
    v_add_f32 v117, v117, v85
    v_add_f32 v118, v118, v86
    v_add_f32 v119, v119, v87
    v_cvt_pk_bf16_f32 v128, v112, v114
    v_cvt_pk_bf16_f32 v129, v116, v118
    s_waitcnt lgkmcnt(0)
    v_mfma_f32_32x32x16_bf16 v[144:159], v[212:215], v[224:227], v[144:159]
    ds_read_b64_tr_b16 v[244:245], v65 offset:2720
    ds_read_b64_tr_b16 v[246:247], v65 offset:2688
    v_cvt_pk_bf16_f32 v130, v113, v115
    v_cvt_pk_bf16_f32 v131, v117, v119
    v_mfma_f32_32x32x16_bf16 v[160:175], v[228:231], v[224:227], v[160:175]
    buffer_store_dwordx4 v[128:131], v62, s[16:19], s25 offen offset:0 sc1
    v_add_f32 v120, v120, v88
    v_add_f32 v121, v121, v89
    v_add_f32 v122, v122, v90
    v_add_f32 v123, v123, v91
    v_add_f32 v124, v124, v92
    v_mfma_f32_32x32x16_bf16 v[176:191], v[216:219], v[224:227], v[176:191]
    v_add_f32 v125, v125, v93
    v_add_f32 v126, v126, v94
    v_add_f32_e64 v127, v127, v95
    v_cvt_pk_bf16_f32 v132, v120, v122
    v_cvt_pk_bf16_f32 v133, v124, v126
    v_cvt_pk_bf16_f32 v134, v121, v123
    v_mfma_f32_32x32x16_bf16 v[192:207], v[232:235], v[224:227], v[192:207]
    ds_read_b64_tr_b16 v[232:233], v65 offset:3232
    ds_read_b64_tr_b16 v[234:235], v65 offset:3200
    v_cvt_pk_bf16_f32 v135, v125, v127
    s_waitcnt lgkmcnt(2)
    v_mfma_f32_32x32x16_bf16 v[160:175], v[212:215], v[244:247], v[160:175]
    buffer_store_dwordx4 v[132:135], v62, s[16:19], s25 offen offset:1024 sc1
    ds_read_b64_tr_b16 v[112:113], v65 offset:32
    ds_read_b64_tr_b16 v[114:115], v65 offset:0
    ds_read_b64_tr_b16 v[116:117], v65 offset:160
    ds_read_b64_tr_b16 v[118:119], v65 offset:128
    ds_read_b64_tr_b16 v[120:121], v65 offset:288
    v_mfma_f32_32x32x16_bf16 v[176:191], v[228:231], v[244:247], v[176:191]
    ds_read_b64_tr_b16 v[240:241], v65 offset:3744
    ds_read_b64_tr_b16 v[242:243], v65 offset:3712
    ds_read_b64_tr_b16 v[122:123], v65 offset:256
    ds_read_b64_tr_b16 v[124:125], v65 offset:416
    ds_read_b64_tr_b16 v[126:127], v65 offset:384
    ds_read_b64_tr_b16 v[128:129], v65 offset:544
    v_mfma_f32_32x32x16_bf16 v[192:207], v[216:219], v[244:247], v[192:207]
    ds_read_b128 v[216:219], v64 offset:416
    ds_read_b64_tr_b16 v[236:237], v65 offset:800
    ds_read_b64_tr_b16 v[238:239], v65 offset:768
    ds_read_b64_tr_b16 v[130:131], v65 offset:512
    ds_read_b64_tr_b16 v[132:133], v65 offset:672
    s_waitcnt lgkmcnt(15)
    v_mfma_f32_32x32x16_bf16 v[176:191], v[212:215], v[232:235], v[176:191]
    ds_read_b128 v[224:227], v64 offset:288
    ds_read_b64_tr_b16 v[244:245], v65 offset:1312
    ds_read_b64_tr_b16 v[246:247], v65 offset:1280
    ds_read_b64_tr_b16 v[134:135], v65 offset:640
    ds_read_b64_tr_b16 v[136:137], v65 offset:800
    ds_read_b64_tr_b16 v[138:139], v65 offset:768
    v_mfma_f32_32x32x16_bf16 v[192:207], v[228:231], v[232:235], v[192:207]
    ds_read_b64_tr_b16 v[140:141], v65 offset:928
    ds_read_b64_tr_b16 v[142:143], v65 offset:896
    s_waitcnt lgkmcnt(15)
    v_mfma_f32_32x32x16_bf16 v[192:207], v[212:215], v[240:243], v[192:207]
    ds_read_b128 v[228:231], v64 offset:160
    ds_read_b64_tr_b16 v[212:213], v65 offset:1824
    ds_read_b64_tr_b16 v[214:215], v65 offset:1792
    s_waitcnt vmcnt(3)
ce_31:
    v_max3_u32 v208, v248, v249, v250
    v_max3_u32 v208, v208, v251, v252
    v_max3_u32 v208, v208, v253, v254
    v_max_u32_e64 v208, v208, v255
    v_cmp_eq_u32 s[82:83], -1, v208
    v_min3_f32 v209, v96, v99, v100
    v_min3_f32 v209, v209, v103, v104
    v_min3_f32 v209, v209, v107, v108
    v_min_f32 v209, v209, v111
    v_cmp_neq_f32 vcc, 0x41000000, v209
    s_nop 0
    s_or_b64 vcc, vcc, s[82:83]
    s_cbranch_vccnz rd_32
rc_33:
    s_waitcnt lgkmcnt(13)
    v_mfma_f32_32x32x16_bf16 v[144:159], v[216:219], v[236:239], v[144:159]
    v_mul_f32 v208, 0x3acccccd, v97
    v_mul_f32 v209, 0x3acccccd, v101
    v_mul_f32 v98, 0x3acccccd, v98
    v_mul_f32 v102, 0x3acccccd, v102
    v_fma_f32 v98, -v208, v208, v98
    s_waitcnt lgkmcnt(8)
    v_mfma_f32_32x32x16_bf16 v[144:159], v[224:227], v[244:247], v[144:159]
    v_fma_f32 v102, -v209, v209, v102
    v_max_f32 v98, 0, v98
    v_max_f32 v102, 0, v102
    v_add_f32 v98, 0x3727c5ac, v98
    v_add_f32 v102, 0x3727c5ac, v102
    v_mfma_f32_32x32x16_bf16 v[160:175], v[216:219], v[244:247], v[160:175]
    ds_read_b64_tr_b16 v[232:233], v65 offset:2336
    ds_read_b64_tr_b16 v[234:235], v65 offset:2304
    v_rsq_f32 v97, v98
    s_waitcnt lgkmcnt(2)
    v_mfma_f32_32x32x16_bf16 v[144:159], v[228:231], v[212:215], v[144:159]
    v_rsq_f32_e64 v101, v102
    v_mul_f32 v98, -v208, v97
    v_mul_f32 v102, -v209, v101
    v_lshlrev_b32_e64 v80, 16, v248
    v_and_b32 v82, 0xffff0000, v248
    v_mfma_f32_32x32x16_bf16 v[160:175], v[224:227], v[212:215], v[160:175]
    v_lshlrev_b32 v84, 16, v249
    v_and_b32 v86, 0xffff0000, v249
    v_lshlrev_b32 v81, 16, v250
    v_and_b32 v83, 0xffff0000, v250
    v_lshlrev_b32_e64 v85, 16, v251
    v_and_b32 v87, 0xffff0000, v251
    v_mfma_f32_32x32x16_bf16 v[176:191], v[216:219], v[212:215], v[176:191]
    v_fma_f32 v208, v80, v97, v98
    v_fma_f32 v209, v81, v101, v102
    v_cvt_pk_bf16_f32 v248, v208, v209
    v_fma_f32 v208, v82, v97, v98
    v_fma_f32 v209, v83, v101, v102
    s_waitcnt lgkmcnt(0)
    v_mfma_f32_32x32x16_bf16 v[144:159], v[220:223], v[232:235], v[144:159]
    ds_read_b64_tr_b16 v[240:241], v65 offset:2848
    ds_read_b64_tr_b16 v[242:243], v65 offset:2816
    v_cvt_pk_bf16_f32 v249, v208, v209
    v_fma_f32 v208, v84, v97, v98
    v_fma_f32 v209, v85, v101, v102
    v_cvt_pk_bf16_f32 v250, v208, v209
    v_mfma_f32_32x32x16_bf16 v[160:175], v[228:231], v[232:235], v[160:175]
    v_fma_f32 v208, v86, v97, v98
    v_fma_f32 v209, v87, v101, v102
    v_cvt_pk_bf16_f32 v251, v208, v209
    v_mfma_f32_32x32x16_bf16 v[176:191], v[224:227], v[232:235], v[176:191]
    ds_write_b32 v63, v248 offset:512
    ds_write_b32 v63, v249 offset:5376
    ds_write_b32 v63, v250 offset:10240
    v_mfma_f32_32x32x16_bf16 v[192:207], v[216:219], v[232:235], v[192:207]
    ds_read_b64_tr_b16 v[216:217], v65 offset:3360
    ds_read_b64_tr_b16 v[218:219], v65 offset:3328
    ds_write_b32 v63, v251 offset:15104
    v_mul_f32 v208, 0x3acccccd, v105
    s_waitcnt lgkmcnt(6)
    v_mfma_f32_32x32x16_bf16 v[160:175], v[220:223], v[240:243], v[160:175]
    v_mul_f32 v209, 0x3acccccd, v109
    v_mul_f32 v106, 0x3acccccd, v106
    v_mul_f32 v110, 0x3acccccd, v110
    v_fma_f32 v106, -v208, v208, v106
    v_fma_f32 v110, -v209, v209, v110
    v_max_f32_e64 v106, 0, v106
    v_mfma_f32_32x32x16_bf16 v[176:191], v[228:231], v[240:243], v[176:191]
    ds_read_b64_tr_b16 v[236:237], v65 offset:3872
    ds_read_b64_tr_b16 v[238:239], v65 offset:3840
    v_max_f32_e64 v110, 0, v110
    v_add_f32 v106, 0x3727c5ac, v106
    v_add_f32 v110, 0x3727c5ac, v110
    v_mfma_f32_32x32x16_bf16 v[192:207], v[224:227], v[240:243], v[192:207]
    ds_read_b128 v[224:227], v64 offset:384
    ds_read_b64_tr_b16 v[244:245], v65 offset:928
    ds_read_b64_tr_b16 v[246:247], v65 offset:896
    v_rsq_f32 v105, v106
    s_waitcnt lgkmcnt(6)
    v_mfma_f32_32x32x16_bf16 v[176:191], v[220:223], v[216:219], v[176:191]
    ds_read_b128 v[212:215], v64 offset:256
    ds_read_b64_tr_b16 v[232:233], v65 offset:1440
    ds_read_b64_tr_b16 v[234:235], v65 offset:1408
    v_rsq_f32_e64 v109, v110
    v_mul_f32 v106, -v208, v105
    v_mfma_f32_32x32x16_bf16 v[192:207], v[228:231], v[216:219], v[192:207]
    v_mul_f32 v110, -v209, v109
    v_lshlrev_b32 v88, 16, v252
    v_and_b32 v90, 0xffff0000, v252
    v_lshlrev_b32 v92, 16, v253
    v_and_b32 v94, 0xffff0000, v253
    s_waitcnt lgkmcnt(6)
    v_mfma_f32_32x32x16_bf16 v[192:207], v[220:223], v[236:239], v[192:207]
    ds_read_b128 v[220:223], v64 offset:128
    ds_read_b64_tr_b16 v[228:229], v65 offset:1952
    ds_read_b64_tr_b16 v[230:231], v65 offset:1920
    v_lshlrev_b32 v89, 16, v254
    v_and_b32 v91, 0xffff0000, v254
    s_waitcnt lgkmcnt(6)
    v_mfma_f32_32x32x16_bf16 v[144:159], v[224:227], v[244:247], v[144:159]
    v_lshlrev_b32 v93, 16, v255
    v_and_b32 v95, 0xffff0000, v255
    v_fma_f32 v208, v88, v105, v106
    v_fma_f32 v209, v89, v109, v110
    v_cvt_pk_bf16_f32 v252, v208, v209
    s_waitcnt lgkmcnt(3)
    v_mfma_f32_32x32x16_bf16 v[144:159], v[212:215], v[232:235], v[144:159]
    v_fma_f32 v208, v90, v105, v106
    v_fma_f32 v209, v91, v109, v110
    v_cvt_pk_bf16_f32 v253, v208, v209
    v_fma_f32 v208, v92, v105, v106
    v_fma_f32 v209, v93, v109, v110
    v_cvt_pk_bf16_f32 v254, v208, v209
    v_mfma_f32_32x32x16_bf16 v[160:175], v[224:227], v[232:235], v[160:175]
    ds_read_b128 v[240:243], v64 offset:0
    ds_read_b64_tr_b16 v[216:217], v65 offset:2464
    ds_read_b64_tr_b16 v[218:219], v65 offset:2432
    v_fma_f32 v208, v94, v105, v106
    v_fma_f32 v209, v95, v109, v110
    s_waitcnt lgkmcnt(3)
    v_mfma_f32_32x32x16_bf16 v[144:159], v[220:223], v[228:231], v[144:159]
    v_cvt_pk_bf16_f32 v255, v208, v209
    ds_write_b32 v63, v252 offset:768
    v_mfma_f32_32x32x16_bf16 v[160:175], v[212:215], v[228:231], v[160:175]
    ds_write_b32 v63, v253 offset:5632
    ds_write_b32 v63, v254 offset:10496
    ds_write_b32 v63, v255 offset:15360
    v_mfma_f32_32x32x16_bf16 v[176:191], v[224:227], v[228:231], v[176:191]
    s_waitcnt vmcnt(2)
    v_cmp_eq_u32 vcc, 19, v5
    s_nop 0
    s_cbranch_vccnz gl_34
gc_35:
    s_lshl_b32 s25, s72, 5
    s_add_u32 s25, s25, 0
    s_sub_u32 s26, s25, 4
    s_waitcnt lgkmcnt(4)
    v_mfma_f32_32x32x16_bf16 v[144:159], v[240:243], v[216:219], v[144:159]
    ds_read_b64_tr_b16 v[236:237], v65 offset:2976
    ds_read_b64_tr_b16 v[238:239], v65 offset:2944
    s_max_i32 s26, s26, 0
    s_lshl_b32 s27, s71, 12
    s_add_u32 s27, s27, 9437184
    s_lshl_b32 s99, s25, 3
    v_mfma_f32_32x32x16_bf16 v[160:175], v[220:223], v[216:219], v[160:175]
    s_lshl_b32 s100, s26, 3
    s_lshl_b32 s92, s24, 12
    s_lshl_b32 s93, s24, 9
    s_add_u32 s99, s99, s27
    s_add_u32 s100, s100, s27
    v_mfma_f32_32x32x16_bf16 v[176:191], v[212:215], v[216:219], v[176:191]
    v_mfma_f32_32x32x16_bf16 v[192:207], v[224:227], v[216:219], v[192:207]
    ds_read_b64_tr_b16 v[224:225], v65 offset:3488
    ds_read_b64_tr_b16 v[226:227], v65 offset:3456
    s_waitcnt lgkmcnt(2)
    v_mfma_f32_32x32x16_bf16 v[160:175], v[240:243], v[236:239], v[160:175]
    v_mfma_f32_32x32x16_bf16 v[176:191], v[220:223], v[236:239], v[176:191]
    ds_read_b64_tr_b16 v[244:245], v65 offset:4000
    ds_read_b64_tr_b16 v[246:247], v65 offset:3968
    v_mfma_f32_32x32x16_bf16 v[192:207], v[212:215], v[236:239], v[192:207]
    s_waitcnt lgkmcnt(2)
    v_mfma_f32_32x32x16_bf16 v[176:191], v[240:243], v[224:227], v[176:191]
    v_mfma_f32_32x32x16_bf16 v[192:207], v[220:223], v[224:227], v[192:207]
    s_waitcnt lgkmcnt(0)
    v_mfma_f32_32x32x16_bf16 v[192:207], v[240:243], v[244:247], v[192:207]
    s_waitcnt lgkmcnt(0)
    s_barrier
    ds_read_b128 v[212:215], v64 offset:608
    ds_read_b128 v[216:219], v64 offset:576
    ds_read_b128 v[220:223], v64 offset:544
    ds_read_b128 v[224:227], v64 offset:512
    s_waitcnt lgkmcnt(3)
    v_mfma_f32_32x32x16_bf16 v[144:159], v[212:215], v[112:115], v[144:159]
    ds_read_b128 v[228:231], v64 offset:736
    s_waitcnt lgkmcnt(3)
    v_mfma_f32_32x32x16_bf16 v[144:159], v[216:219], v[116:119], v[144:159]
    ds_read_b128 v[232:235], v64 offset:704
    s_waitcnt lgkmcnt(3)
    v_mfma_f32_32x32x16_bf16 v[144:159], v[220:223], v[120:123], v[144:159]
    ds_read_b128 v[236:239], v64 offset:672
    s_waitcnt lgkmcnt(3)
    v_mfma_f32_32x32x16_bf16 v[144:159], v[224:227], v[124:127], v[144:159]
    ds_read_b128 v[240:243], v64 offset:640
    s_nop 3
    s_waitcnt lgkmcnt(3)
    v_mfma_f32_32x32x16_bf16 v[160:175], v[228:231], v[112:115], v[160:175]
    s_nop 4
    s_waitcnt lgkmcnt(2)
    v_mfma_f32_32x32x16_bf16 v[160:175], v[232:235], v[116:119], v[160:175]
    v_cndmask_b32 v208, v147, v72, s[76:77]
    v_cndmask_b32 v209, v151, v147, s[76:77]
    v_cndmask_b32 v210, v155, v151, s[76:77]
    v_cndmask_b32 v211, v159, v155, s[76:77]
    v_mov_b32_e64 v72, v159
    s_waitcnt lgkmcnt(1)
    v_mfma_f32_32x32x16_bf16 v[160:175], v[236:239], v[120:123], v[160:175]
    v_add_f32_dpp v146, v208, v146 wave_ror:1 row_mask:0xf bank_mask:0xf
    v_add_f32_dpp v150, v209, v150 wave_ror:1 row_mask:0xf bank_mask:0xf
    v_add_f32_dpp v154, v210, v154 wave_ror:1 row_mask:0xf bank_mask:0xf
    v_add_f32_dpp v158, v211, v158 wave_ror:1 row_mask:0xf bank_mask:0xf
    v_cndmask_b32 v208, v146, v71, s[76:77]
    s_waitcnt lgkmcnt(0)
    v_mfma_f32_32x32x16_bf16 v[160:175], v[240:243], v[124:127], v[160:175]
    v_cndmask_b32 v209, v150, v146, s[76:77]
    v_cndmask_b32 v210, v154, v150, s[76:77]
    v_cndmask_b32 v211, v158, v154, s[76:77]
    v_mov_b32 v71, v158
    v_add_f32_dpp v145, v208, v145 wave_ror:1 row_mask:0xf bank_mask:0xf
    v_add_f32_dpp v149, v209, v149 wave_ror:1 row_mask:0xf bank_mask:0xf
    v_mfma_f32_32x32x16_bf16 v[160:175], v[212:215], v[128:131], v[160:175]
    ds_read_b128 v[244:247], v64 offset:864
    v_add_f32_dpp v153, v210, v153 wave_ror:1 row_mask:0xf bank_mask:0xf
    v_add_f32_dpp v157, v211, v157 wave_ror:1 row_mask:0xf bank_mask:0xf
    v_cndmask_b32 v208, v145, v70, s[76:77]
    v_cndmask_b32 v209, v149, v145, s[76:77]
    v_cndmask_b32 v210, v153, v149, s[76:77]
    v_mfma_f32_32x32x16_bf16 v[160:175], v[216:219], v[132:135], v[160:175]
    ds_read_b128 v[248:251], v64 offset:832
    v_cndmask_b32 v211, v157, v153, s[76:77]
    v_mov_b32_e64 v70, v157
    v_add_f32_dpp v144, v208, v144 wave_ror:1 row_mask:0xf bank_mask:0xf
    v_add_f32_dpp v148, v209, v148 wave_ror:1 row_mask:0xf bank_mask:0xf
    v_add_f32_dpp v152, v210, v152 wave_ror:1 row_mask:0xf bank_mask:0xf
    v_mfma_f32_32x32x16_bf16 v[160:175], v[220:223], v[136:139], v[160:175]
    ds_read_b128 v[252:255], v64 offset:800
    v_add_f32_dpp v156, v211, v156 wave_ror:1 row_mask:0xf bank_mask:0xf
    ds_write_b32 v66, v144 offset:0
    v_mfma_f32_32x32x16_bf16 v[160:175], v[224:227], v[140:143], v[160:175]
    ds_read_b128 v[224:227], v64 offset:768
    ds_write_b32 v66, v148 offset:64
    ds_write_b32 v66, v152 offset:128
    s_waitcnt lgkmcnt(6)
    v_mfma_f32_32x32x16_bf16 v[176:191], v[244:247], v[112:115], v[176:191]
    ds_write_b32 v66, v156 offset:192
    s_nop 2
    s_waitcnt lgkmcnt(6)
    v_mfma_f32_32x32x16_bf16 v[176:191], v[248:251], v[116:119], v[176:191]
    s_nop 2
    v_cndmask_b32 v208, v163, v72, s[76:77]
    v_cndmask_b32 v209, v167, v163, s[76:77]
    s_waitcnt lgkmcnt(5)
    v_mfma_f32_32x32x16_bf16 v[176:191], v[252:255], v[120:123], v[176:191]
    v_cndmask_b32 v210, v171, v167, s[76:77]
    v_cndmask_b32 v211, v175, v171, s[76:77]
    v_mov_b32 v72, v175
    v_add_f32_dpp v162, v208, v162 wave_ror:1 row_mask:0xf bank_mask:0xf
    v_add_f32_dpp v166, v209, v166 wave_ror:1 row_mask:0xf bank_mask:0xf
    s_waitcnt lgkmcnt(3)
    v_mfma_f32_32x32x16_bf16 v[176:191], v[224:227], v[124:127], v[176:191]
    v_add_f32_dpp v170, v210, v170 wave_ror:1 row_mask:0xf bank_mask:0xf
    v_add_f32_dpp v174, v211, v174 wave_ror:1 row_mask:0xf bank_mask:0xf
    v_cndmask_b32 v208, v162, v71, s[76:77]
    v_cndmask_b32 v209, v166, v162, s[76:77]
    v_cndmask_b32 v210, v170, v166, s[76:77]
    v_cndmask_b32 v211, v174, v170, s[76:77]
    v_mfma_f32_32x32x16_bf16 v[176:191], v[228:231], v[128:131], v[176:191]
    ds_read_b64_tr_b16 v[228:229], v65 offset:1056
    ds_read_b64_tr_b16 v[230:231], v65 offset:1024
    v_mov_b32 v71, v174
    v_add_f32_dpp v161, v208, v161 wave_ror:1 row_mask:0xf bank_mask:0xf
    v_add_f32_dpp v165, v209, v165 wave_ror:1 row_mask:0xf bank_mask:0xf
    v_add_f32_dpp v169, v210, v169 wave_ror:1 row_mask:0xf bank_mask:0xf
    v_mfma_f32_32x32x16_bf16 v[176:191], v[232:235], v[132:135], v[176:191]
    ds_read_b64_tr_b16 v[232:233], v65 offset:1184
    ds_read_b64_tr_b16 v[234:235], v65 offset:1152
    v_add_f32_dpp v173, v211, v173 wave_ror:1 row_mask:0xf bank_mask:0xf
    v_cndmask_b32 v208, v161, v70, s[76:77]
    v_cndmask_b32 v209, v165, v161, s[76:77]
    v_cndmask_b32 v210, v169, v165, s[76:77]
    v_mfma_f32_32x32x16_bf16 v[176:191], v[236:239], v[136:139], v[176:191]
    ds_read_b64_tr_b16 v[236:237], v65 offset:1312
    ds_read_b64_tr_b16 v[238:239], v65 offset:1280
    v_cndmask_b32 v211, v173, v169, s[76:77]
    v_mov_b32_e64 v70, v173
    v_add_f32_dpp v160, v208, v160 wave_ror:1 row_mask:0xf bank_mask:0xf
    v_add_f32_dpp v164, v209, v164 wave_ror:1 row_mask:0xf bank_mask:0xf
    v_mfma_f32_32x32x16_bf16 v[176:191], v[240:243], v[140:143], v[176:191]
    ds_read_b128 v[240:243], v64 offset:512
    ds_read_b64_tr_b16 v[224:225], v65 offset:1440
    ds_read_b64_tr_b16 v[226:227], v65 offset:1408
    v_add_f32_dpp v168, v210, v168 wave_ror:1 row_mask:0xf bank_mask:0xf
    v_add_f32_dpp v172, v211, v172 wave_ror:1 row_mask:0xf bank_mask:0xf
    s_waitcnt lgkmcnt(7)
    v_mfma_f32_32x32x16_bf16 v[176:191], v[212:215], v[228:231], v[176:191]
    ds_read_b128 v[212:215], v64 offset:992
    ds_write_b32 v66, v160 offset:256
    ds_write_b32 v66, v164 offset:320
    s_waitcnt lgkmcnt(8)
    v_mfma_f32_32x32x16_bf16 v[176:191], v[216:219], v[232:235], v[176:191]
    ds_read_b128 v[216:219], v64 offset:960
    ds_write_b32 v66, v168 offset:384
    ds_write_b32 v66, v172 offset:448
    s_waitcnt lgkmcnt(9)
    v_mfma_f32_32x32x16_bf16 v[176:191], v[220:223], v[236:239], v[176:191]
    ds_read_b128 v[220:223], v64 offset:928
    s_waitcnt lgkmcnt(7)
    v_mfma_f32_32x32x16_bf16 v[176:191], v[240:243], v[224:227], v[176:191]
    ds_read_b128 v[240:243], v64 offset:896
    s_waitcnt lgkmcnt(2)
    s_barrier
    v_mfma_f32_32x32x16_bf16 v[192:207], v[212:215], v[112:115], v[192:207]
    ds_read_b64 v[144:145], v67 offset:0
    ds_read_b64 v[146:147], v67 offset:4224
    ds_read_b64 v[148:149], v67 offset:8448
    ds_read_b64 v[150:151], v67 offset:12672
    s_lshl_b32 s25, s75, 14
    v_mfma_f32_32x32x16_bf16 v[192:207], v[216:219], v[116:119], v[192:207]
    buffer_load_dword v7, v4, s[16:19], s89 offen offset:0 sc1
    s_add_u32 s25, s25, 9437184
    s_nop 0
    v_cndmask_b32 v208, v179, v72, s[76:77]
    v_cndmask_b32 v209, v183, v179, s[76:77]
    s_waitcnt lgkmcnt(5)
    v_mfma_f32_32x32x16_bf16 v[192:207], v[220:223], v[120:123], v[192:207]
    v_cndmask_b32 v210, v187, v183, s[76:77]
    v_cndmask_b32 v211, v191, v187, s[76:77]
    v_mov_b32 v72, v191
    v_add_f32_dpp v178, v208, v178 wave_ror:1 row_mask:0xf bank_mask:0xf
    v_add_f32_dpp v182, v209, v182 wave_ror:1 row_mask:0xf bank_mask:0xf
    s_waitcnt lgkmcnt(4)
    v_mfma_f32_32x32x16_bf16 v[192:207], v[240:243], v[124:127], v[192:207]
    ds_read_b128 v[212:215], v64 offset:768
    v_add_f32_dpp v186, v210, v186 wave_ror:1 row_mask:0xf bank_mask:0xf
    v_add_f32_dpp v190, v211, v190 wave_ror:1 row_mask:0xf bank_mask:0xf
    v_cndmask_b32 v208, v178, v71, s[76:77]
    v_cndmask_b32 v209, v182, v178, s[76:77]
    v_cndmask_b32 v210, v186, v182, s[76:77]
    v_mfma_f32_32x32x16_bf16 v[192:207], v[244:247], v[128:131], v[192:207]
    ds_read_b128 v[244:247], v64 offset:736
    v_cndmask_b32 v211, v190, v186, s[76:77]
    v_mov_b32 v71, v190
    v_add_f32_dpp v177, v208, v177 wave_ror:1 row_mask:0xf bank_mask:0xf
    v_add_f32_dpp v181, v209, v181 wave_ror:1 row_mask:0xf bank_mask:0xf
    v_add_f32_dpp v185, v210, v185 wave_ror:1 row_mask:0xf bank_mask:0xf
    v_mfma_f32_32x32x16_bf16 v[192:207], v[248:251], v[132:135], v[192:207]
    ds_read_b128 v[248:251], v64 offset:704
    v_add_f32_dpp v189, v211, v189 wave_ror:1 row_mask:0xf bank_mask:0xf
    v_cndmask_b32 v208, v177, v70, s[76:77]
    v_cndmask_b32 v209, v181, v177, s[76:77]
    v_cndmask_b32 v210, v185, v181, s[76:77]
    v_cndmask_b32 v211, v189, v185, s[76:77]
    v_mfma_f32_32x32x16_bf16 v[192:207], v[252:255], v[136:139], v[192:207]
    ds_read_b128 v[252:255], v64 offset:672
    v_mov_b32_e64 v70, v189
    v_add_f32_dpp v176, v208, v176 wave_ror:1 row_mask:0xf bank_mask:0xf
    v_add_f32_dpp v180, v209, v180 wave_ror:1 row_mask:0xf bank_mask:0xf
    v_add_f32_dpp v184, v210, v184 wave_ror:1 row_mask:0xf bank_mask:0xf
    s_waitcnt lgkmcnt(3)
    v_mfma_f32_32x32x16_bf16 v[192:207], v[212:215], v[140:143], v[192:207]
    ds_read_b128 v[216:219], v64 offset:640
    v_add_f32_dpp v188, v211, v188 wave_ror:1 row_mask:0xf bank_mask:0xf
    s_waitcnt lgkmcnt(3)
    v_mfma_f32_32x32x16_bf16 v[192:207], v[244:247], v[228:231], v[192:207]
    ds_read_b128 v[228:231], v64 offset:608
    ds_read_b64_tr_b16 v[220:221], v65 offset:1568
    ds_read_b64_tr_b16 v[222:223], v65 offset:1536
    ds_write_b32 v66, v176 offset:512
    s_waitcnt lgkmcnt(6)
    v_mfma_f32_32x32x16_bf16 v[192:207], v[248:251], v[232:235], v[192:207]
    ds_read_b128 v[232:235], v64 offset:576
    ds_read_b64_tr_b16 v[240:241], v65 offset:1696
    ds_read_b64_tr_b16 v[242:243], v65 offset:1664
    ds_write_b32 v66, v180 offset:576
    s_waitcnt lgkmcnt(9)
    v_mfma_f32_32x32x16_bf16 v[192:207], v[252:255], v[236:239], v[192:207]
    ds_read_b128 v[236:239], v64 offset:544
    ds_read_b64_tr_b16 v[212:213], v65 offset:1824
    ds_read_b64_tr_b16 v[214:215], v65 offset:1792
    ds_write_b32 v66, v184 offset:640
    s_waitcnt lgkmcnt(12)
    v_mfma_f32_32x32x16_bf16 v[192:207], v[216:219], v[224:227], v[192:207]
    ds_read_b128 v[224:227], v64 offset:512
    ds_read_b64_tr_b16 v[244:245], v65 offset:1952
    ds_read_b64_tr_b16 v[246:247], v65 offset:1920
    ds_write_b32 v66, v188 offset:704
    s_waitcnt lgkmcnt(13)
    v_mfma_f32_32x32x16_bf16 v[192:207], v[228:231], v[220:223], v[192:207]
    v_add_f32 v144, v144, v80
    v_add_f32 v145, v145, v81
    v_add_f32 v146, v146, v82
    v_add_f32 v147, v147, v83
    s_waitcnt lgkmcnt(9)
    v_mfma_f32_32x32x16_bf16 v[192:207], v[232:235], v[240:243], v[192:207]
    v_add_f32 v148, v148, v84
    v_add_f32 v149, v149, v85
    v_add_f32 v150, v150, v86
    v_add_f32 v151, v151, v87
    v_cvt_pk_bf16_f32 v160, v144, v146
    s_waitcnt lgkmcnt(5)
    v_mfma_f32_32x32x16_bf16 v[192:207], v[236:239], v[212:215], v[192:207]
    v_cvt_pk_bf16_f32 v161, v148, v150
    v_cvt_pk_bf16_f32 v162, v145, v147
    v_cvt_pk_bf16_f32 v163, v149, v151
    s_waitcnt lgkmcnt(1)
    v_mfma_f32_32x32x16_bf16 v[192:207], v[224:227], v[244:247], v[192:207]
    buffer_store_dwordx4 v[160:163], v62, s[16:19], s25 offen offset:2048 sc1
    s_nop 10
    v_cndmask_b32 v208, v195, v72, s[76:77]
    v_cndmask_b32 v209, v199, v195, s[76:77]
    v_cndmask_b32 v210, v203, v199, s[76:77]
    v_cndmask_b32 v211, v207, v203, s[76:77]
    v_mov_b32_e64 v72, v207
    v_add_f32_dpp v194, v208, v194 wave_ror:1 row_mask:0xf bank_mask:0xf
    v_add_f32_dpp v198, v209, v198 wave_ror:1 row_mask:0xf bank_mask:0xf
    v_add_f32_dpp v202, v210, v202 wave_ror:1 row_mask:0xf bank_mask:0xf
    v_add_f32_dpp v206, v211, v206 wave_ror:1 row_mask:0xf bank_mask:0xf
    v_cndmask_b32 v208, v194, v71, s[76:77]
    v_cndmask_b32 v209, v198, v194, s[76:77]
    v_cndmask_b32 v210, v202, v198, s[76:77]
    v_cndmask_b32 v211, v206, v202, s[76:77]
    v_mov_b32_e64 v71, v206
    v_add_f32_dpp v193, v208, v193 wave_ror:1 row_mask:0xf bank_mask:0xf
    v_add_f32_dpp v197, v209, v197 wave_ror:1 row_mask:0xf bank_mask:0xf
    v_add_f32_dpp v201, v210, v201 wave_ror:1 row_mask:0xf bank_mask:0xf
    v_add_f32_dpp v205, v211, v205 wave_ror:1 row_mask:0xf bank_mask:0xf
    v_cndmask_b32 v208, v193, v70, s[76:77]
    v_cndmask_b32 v209, v197, v193, s[76:77]
    v_cndmask_b32 v210, v201, v197, s[76:77]
    v_cndmask_b32 v211, v205, v201, s[76:77]
    v_mov_b32_e64 v70, v205
    v_add_f32_dpp v192, v208, v192 wave_ror:1 row_mask:0xf bank_mask:0xf
    v_add_f32_dpp v196, v209, v196 wave_ror:1 row_mask:0xf bank_mask:0xf
    v_add_f32_dpp v200, v210, v200 wave_ror:1 row_mask:0xf bank_mask:0xf
    v_add_f32_dpp v204, v211, v204 wave_ror:1 row_mask:0xf bank_mask:0xf
    ds_write_b32 v66, v192 offset:768
    ds_write_b32 v66, v196 offset:832
    ds_write_b32 v66, v200 offset:896
    ds_write_b32 v66, v204 offset:960
    s_waitcnt lgkmcnt(0)
    s_waitcnt vmcnt(1)
    v_cmp_gt_u32_e64 vcc, 1, v7
    s_nop 0
    s_and_b64 vcc, vcc, s[50:51]
    s_cbranch_scc1 ps_36
pc_38:
    s_barrier
    ds_read_b64 v[152:153], v67 offset:512
    ds_read_b64 v[154:155], v67 offset:4736
    ds_read_b64 v[156:157], v67 offset:8960
    ds_read_b64 v[158:159], v67 offset:13184
    s_add_u32 m0, s92, 36352
    s_nop 0
    s_nop 0
    buffer_load_dwordx4 v73, s[16:19], s99 offen offset:0 sc1 lds
    buffer_load_dwordx4 v74, s[16:19], s99 offen offset:1024 sc1 lds
    buffer_load_dwordx4 v75, s[16:19], s99 offen offset:2048 sc1 lds
    buffer_load_dwordx4 v76, s[16:19], s99 offen offset:3072 sc1 lds
    s_add_u32 m0, s93, 53760
    s_add_u32 s99, s99, 524288
    s_mov_b64 exec, s[80:81]
    buffer_load_dwordx4 v77, s[16:19], s100 offen sc1 lds
    s_mov_b64 exec, -1
    s_add_u32 s100, s100, 524288
    s_lshl_b32 s25, s75, 14
    s_add_u32 s25, s25, 9437184
    s_waitcnt lgkmcnt(0)
    v_add_f32 v152, v152, v88
    v_add_f32 v153, v153, v89
    v_add_f32 v154, v154, v90
    v_add_f32 v155, v155, v91
    v_add_f32 v156, v156, v92
    v_add_f32 v157, v157, v93
    v_add_f32 v158, v158, v94
    v_add_f32 v159, v159, v95
    v_cvt_pk_bf16_f32 v164, v152, v154
    v_cvt_pk_bf16_f32 v165, v156, v158
    v_cvt_pk_bf16_f32 v166, v153, v155
    v_cvt_pk_bf16_f32 v167, v157, v159
    buffer_store_dwordx4 v[164:167], v62, s[16:19], s25 offen offset:3072 sc1
    v_mov_b32_e64 v5, 1
    s_add_u32 s82, s86, 24576
    buffer_atomic_add v5, v6, s[16:19], s82 offen offset:4 sc0 sc1
    s_add_u32 m0, s92, 55936
    s_nop 0
    s_nop 0
    buffer_load_dwordx4 v73, s[16:19], s99 offen offset:0 sc1 lds
    buffer_load_dwordx4 v74, s[16:19], s99 offen offset:1024 sc1 lds
    buffer_load_dwordx4 v75, s[16:19], s99 offen offset:2048 sc1 lds
    buffer_load_dwordx4 v76, s[16:19], s99 offen offset:3072 sc1 lds
    s_add_u32 m0, s93, 73344
    s_add_u32 s99, s99, 524288
    s_mov_b64 exec, s[80:81]
    buffer_load_dwordx4 v77, s[16:19], s100 offen sc1 lds
    s_mov_b64 exec, -1
    s_add_u32 s100, s100, 524288
    s_branch ec_27
nc_26:
    v_lshlrev_b32 v2, 3, v4
    v_mov_b32_e64 v5, 1
    v_cndmask_b32 v2, v4, v2, s[50:51]
    buffer_atomic_add v5, v2, s[16:19], s86 offen offset:8 sc1
    buffer_load_dword v7, v4, s[16:19], s87 offen offset:8 sc1
    s_waitcnt vmcnt(0)
    v_cmp_gt_u32 vcc, 12, v7
    s_nop 0
    s_and_b64 vcc, vcc, s[50:51]
    s_cbranch_scc1 ps_39
pc_41:
    v_mov_b32 v100, -1
    v_mov_b32 v101, -1
    v_mov_b32 v102, -1
    v_mov_b32 v103, -1
    v_lshlrev_b32 v104, 4, v0
    s_sub_u32 s88, s2, 160
    s_mul_i32 s88, s88, 57344
    s_min_u32 s88, s88, 5185536
    s_add_u32 s88, s88, 12058624
    buffer_store_dwordx4 v[100:103], v104, s[16:19], s88 offen sc1
    s_add_u32 s88, s88, 4096
    buffer_store_dwordx4 v[100:103], v104, s[16:19], s88 offen sc1
    s_add_u32 s88, s88, 4096
    buffer_store_dwordx4 v[100:103], v104, s[16:19], s88 offen sc1
    s_add_u32 s88, s88, 4096
    buffer_store_dwordx4 v[100:103], v104, s[16:19], s88 offen sc1
    s_add_u32 s88, s88, 4096
    buffer_store_dwordx4 v[100:103], v104, s[16:19], s88 offen sc1
    s_add_u32 s88, s88, 4096
    buffer_store_dwordx4 v[100:103], v104, s[16:19], s88 offen sc1
    s_add_u32 s88, s88, 4096
    buffer_store_dwordx4 v[100:103], v104, s[16:19], s88 offen sc1
    s_add_u32 s88, s88, 4096
    buffer_store_dwordx4 v[100:103], v104, s[16:19], s88 offen sc1
    s_add_u32 s88, s88, 4096
    buffer_store_dwordx4 v[100:103], v104, s[16:19], s88 offen sc1
    s_add_u32 s88, s88, 4096
    buffer_store_dwordx4 v[100:103], v104, s[16:19], s88 offen sc1
    s_add_u32 s88, s88, 4096
    buffer_store_dwordx4 v[100:103], v104, s[16:19], s88 offen sc1
    s_add_u32 s88, s88, 4096
    buffer_store_dwordx4 v[100:103], v104, s[16:19], s88 offen sc1
    s_add_u32 s88, s88, 4096
    buffer_store_dwordx4 v[100:103], v104, s[16:19], s88 offen sc1
    s_add_u32 s88, s88, 4096
    buffer_store_dwordx4 v[100:103], v104, s[16:19], s88 offen sc1
    s_waitcnt vmcnt(0)
    s_barrier
    v_mov_b32_e64 v5, 1
    s_add_u32 s82, s86, 8192
    buffer_atomic_add v5, v6, s[16:19], s82 offen offset:12 sc0 sc1
    s_waitcnt vmcnt(0)
    v_cmp_eq_u32 vcc, 11, v5
    s_nop 0
    s_cbranch_vccnz gl_42
gc_43:
    buffer_load_dword v7, v4, s[16:19], s89 offen offset:0 sc1
    s_waitcnt vmcnt(0)
    v_cmp_gt_u32 vcc, 1, v7
    s_nop 0
    s_and_b64 vcc, vcc, s[50:51]
    s_cbranch_scc1 ps_44
pc_46:
    s_barrier
    s_sub_u32 s3, s2, 160
    s_and_b32 s3, s3, 63
    s_add_u32 s3, s3, 0
    s_and_b32 s25, s3, 3
    s_lshl_b32 s25, s25, 12
    s_lshr_b32 s26, s3, 2
    s_lshl_b32 s26, s26, 7
    s_add_u32 s3, s25, s26
    v_lshrrev_b32 v236, 3, v0
    v_and_b32 v237, 7, v0
    v_lshlrev_b32 v237, 4, v237
    v_lshl_add_u32 v236, v236, 14, v237
    s_sub_u32 s25, s2, 160
    s_cmp_lt_u32 s25, 64
    s_cselect_b32 s25, 0, 1073741824
    v_add_u32_e64 v236, s25, v236
    s_add_u32 s26, s3, 9437184
    buffer_load_dwordx4 v[216:219], v236, s[16:19], s26 offen sc1
    s_add_u32 s26, s26, 524288
    buffer_load_dwordx4 v[220:223], v236, s[16:19], s26 offen sc1
    s_add_u32 s26, s26, 524288
    buffer_load_dwordx4 v[224:227], v236, s[16:19], s26 offen sc1
    s_add_u32 s26, s26, 524288
    buffer_load_dwordx4 v[228:231], v236, s[16:19], s26 offen sc1
    s_add_u32 s26, s26, 524288
    buffer_load_dwordx4 v[232:235], v236, s[16:19], s26 offen sc1
    s_lshl_b32 s25, s72, 5
    s_add_u32 s25, s25, 0
    s_sub_u32 s26, s25, 4
    s_max_i32 s26, s26, 0
    s_lshl_b32 s27, s71, 12
    s_add_u32 s27, s27, 9437184
    s_lshl_b32 s99, s25, 3
    s_lshl_b32 s100, s26, 3
    s_lshl_b32 s92, s24, 12
    s_lshl_b32 s93, s24, 9
    s_add_u32 s99, s99, s27
    s_add_u32 s100, s100, s27
    s_add_u32 m0, s92, 36352
    s_nop 0
    buffer_load_dwordx4 v73, s[16:19], s99 offen offset:0 sc1 lds
    buffer_load_dwordx4 v74, s[16:19], s99 offen offset:1024 sc1 lds
    buffer_load_dwordx4 v75, s[16:19], s99 offen offset:2048 sc1 lds
    buffer_load_dwordx4 v76, s[16:19], s99 offen offset:3072 sc1 lds
    s_add_u32 m0, s93, 53760
    s_add_u32 s99, s99, 524288
    s_mov_b64 exec, s[80:81]
    buffer_load_dwordx4 v77, s[16:19], s100 offen sc1 lds
    s_mov_b64 exec, -1
    s_add_u32 s100, s100, 524288
    s_add_u32 m0, s92, 55936
    s_nop 0
    s_nop 0
    buffer_load_dwordx4 v73, s[16:19], s99 offen offset:0 sc1 lds
    buffer_load_dwordx4 v74, s[16:19], s99 offen offset:1024 sc1 lds
    buffer_load_dwordx4 v75, s[16:19], s99 offen offset:2048 sc1 lds
    buffer_load_dwordx4 v76, s[16:19], s99 offen offset:3072 sc1 lds
    s_add_u32 m0, s93, 73344
    s_add_u32 s99, s99, 524288
    s_mov_b64 exec, s[80:81]
    buffer_load_dwordx4 v77, s[16:19], s100 offen sc1 lds
    s_mov_b64 exec, -1
    s_add_u32 s100, s100, 524288
    s_sub_u32 s85, s2, 160
    s_cmp_ge_u32 s85, 64
    s_cbranch_scc1 s2_47
    v_mov_b32 v238, 0x3f803f80
    s_lshl_b32 s25, s24, 7
    s_add_u32 s25, s25, 134272
    v_lshrrev_b32 v239, 4, v1
    v_lshl_add_u32 v237, v239, 2, v237
    v_add_u32 v237, s25, v237
se_48:
    v_mov_b32 v240, 0
    v_mov_b32 v241, 0
    v_mov_b32 v242, 0
    v_mov_b32 v243, 0
    s_waitcnt vmcnt(14)
    v_dot2c_f32_bf16 v240, v216, v238
    v_dot2c_f32_bf16 v241, v216, v216
    v_dot2c_f32_bf16 v240, v217, v238
    v_dot2c_f32_bf16 v241, v217, v217
    v_dot2c_f32_bf16 v242, v218, v238
    v_dot2c_f32_bf16 v243, v218, v218
    v_dot2c_f32_bf16 v242, v219, v238
    v_dot2c_f32_bf16 v243, v219, v219
    s_waitcnt vmcnt(13)
    v_dot2c_f32_bf16 v240, v220, v238
    v_dot2c_f32_bf16 v241, v220, v220
    v_dot2c_f32_bf16 v240, v221, v238
    v_dot2c_f32_bf16 v241, v221, v221
    v_dot2c_f32_bf16 v242, v222, v238
    v_dot2c_f32_bf16 v243, v222, v222
    v_dot2c_f32_bf16 v242, v223, v238
    v_dot2c_f32_bf16 v243, v223, v223
    s_waitcnt vmcnt(12)
    v_dot2c_f32_bf16 v240, v224, v238
    v_dot2c_f32_bf16 v241, v224, v224
    v_dot2c_f32_bf16 v240, v225, v238
    v_dot2c_f32_bf16 v241, v225, v225
    v_dot2c_f32_bf16 v242, v226, v238
    v_dot2c_f32_bf16 v243, v226, v226
    v_dot2c_f32_bf16 v242, v227, v238
    v_dot2c_f32_bf16 v243, v227, v227
    s_waitcnt vmcnt(11)
    v_dot2c_f32_bf16 v240, v228, v238
    v_dot2c_f32_bf16 v241, v228, v228
    v_dot2c_f32_bf16 v240, v229, v238
    v_dot2c_f32_bf16 v241, v229, v229
    v_dot2c_f32_bf16 v242, v230, v238
    v_dot2c_f32_bf16 v243, v230, v230
    v_dot2c_f32_bf16 v242, v231, v238
    v_dot2c_f32_bf16 v243, v231, v231
    s_waitcnt vmcnt(10)
    v_dot2c_f32_bf16 v240, v232, v238
    v_dot2c_f32_bf16 v241, v232, v232
    v_dot2c_f32_bf16 v240, v233, v238
    v_dot2c_f32_bf16 v241, v233, v233
    v_dot2c_f32_bf16 v242, v234, v238
    v_dot2c_f32_bf16 v243, v234, v234
    v_dot2c_f32_bf16 v242, v235, v238
    v_dot2c_f32_bf16 v243, v235, v235
    s_nop 2
    v_cmp_u_f32 vcc, v241, v243
    s_nop 0
    s_cbranch_vccnz rd_49
rc_50:
    v_permlane32_swap_b32 v240, v242
    v_permlane32_swap_b32 v241, v243
    v_pk_add_f32 v[240:241], v[240:241], v[242:243]
    s_nop 1
    v_permlane16_swap_b32 v240, v241
    v_add_f32 v240, v240, v241
    s_nop 1
    v_add_f32_dpp v240, v240, v240 row_ror:8 row_mask:0xf bank_mask:0xf
    ds_write_b32 v237, v240
    v_and_b32 v236, 15, v0
    v_lshlrev_b32 v236, 3, v236
    v_add_u32 v237, 134272, v236
    v_mov_b32 v239, 1073741824
    v_cmp_gt_u32 vcc, 16, v0
    s_nop 1
    v_cndmask_b32 v236, v239, v236, vcc
    s_add_u32 s25, s3, 3457024
    s_waitcnt lgkmcnt(0)
    s_barrier
    ds_read_b64 v[216:217], v237 offset:0
    ds_read_b64 v[218:219], v237 offset:128
    ds_read_b64 v[220:221], v237 offset:256
    ds_read_b64 v[222:223], v237 offset:384
    s_waitcnt lgkmcnt(2)
    v_pk_add_f32 v[216:217], v[216:217], v[218:219]
    s_waitcnt lgkmcnt(0)
    v_pk_add_f32 v[220:221], v[220:221], v[222:223]
    v_pk_add_f32 v[216:217], v[216:217], v[220:221]
    v_mul_f32 v239, 0x3acccccd, v216
    v_mul_f32 v217, 0x3acccccd, v217
    v_fma_f32 v217, -v239, v239, v217
    v_max_f32 v217, 0, v217
    v_add_f32 v217, 0x3727c5ac, v217
    v_rsq_f32_e64 v216, v217
    s_nop 0
    v_mul_f32 v217, -v239, v216
    buffer_store_dwordx2 v[216:217], v236, s[16:19], s25 offen sc1
s2_47:
ec_27:
ge_51:
    v_add_u32 v196, 36352, v78
    v_mov_b32_e64 v198, v79
    s_waitcnt vmcnt(5)
    s_barrier
    ds_read_b64 v[160:161], v198 offset:0
    ds_read_b64 v[162:163], v198 offset:64
    ds_read_b64 v[164:165], v196 offset:0
    ds_read_b64 v[166:167], v196 offset:512
    ds_read_b64 v[168:169], v196 offset:256
    ds_read_b64 v[170:171], v196 offset:768
    ds_read_b64 v[172:173], v198 offset:256
    ds_read_b64 v[174:175], v198 offset:320
    ds_read_b64 v[176:177], v196 offset:2048
    ds_read_b64 v[178:179], v196 offset:2560
    ds_read_b64 v[180:181], v196 offset:2304
    ds_read_b64 v[182:183], v196 offset:2816
    s_waitcnt lgkmcnt(6)
    v_mfma_f32_16x16x32_bf16 v[112:115], a[0:3], v[160:163], 0
    ds_read_b64 v[184:185], v198 offset:512
    v_mfma_f32_32x32x16_bf16 v[80:95], a[0:3], v[164:167], 0
    ds_read_b64 v[186:187], v198 offset:576
    ds_read_b64 v[188:189], v196 offset:4096
    ds_read_b64 v[190:191], v196 offset:4608
    v_mov_b32 v208, 0
    v_mov_b32_e64 v209, 0
    v_mfma_f32_32x32x16_bf16 v[96:111], a[0:3], v[168:171], 0
    ds_read_b64 v[192:193], v196 offset:4352
    ds_read_b64 v[194:195], v196 offset:4864
    s_add_u32 m0, s92, 75520
    s_nop 0
    buffer_load_dwordx4 v73, s[16:19], s99 offen offset:0 sc1 lds
    s_waitcnt lgkmcnt(6)
    v_mfma_f32_16x16x32_bf16 v[112:115], a[4:7], v[172:175], v[112:115]
    ds_read_b64 v[160:161], v198 offset:768
    v_mfma_f32_32x32x16_bf16 v[80:95], a[4:7], v[176:179], v[80:95]
    ds_read_b64 v[162:163], v198 offset:832
    ds_read_b64 v[164:165], v196 offset:6144
    ds_read_b64 v[166:167], v196 offset:6656
    v_lshrrev_b32_e64 v210, 5, v0
    v_mul_u32_u24 v210, 1600, v210
    v_mfma_f32_32x32x16_bf16 v[96:111], a[4:7], v[180:183], v[96:111]
    ds_read_b64 v[168:169], v196 offset:6400
    ds_read_b64 v[170:171], v196 offset:6912
    buffer_load_dwordx4 v74, s[16:19], s99 offen offset:1024 sc1 lds
    v_and_b32 v211, 31, v0
    s_waitcnt lgkmcnt(6)
    v_mfma_f32_16x16x32_bf16 v[112:115], a[8:11], v[184:187], v[112:115]
    ds_read_b64 v[172:173], v198 offset:1024
    v_mfma_f32_32x32x16_bf16 v[80:95], a[8:11], v[188:191], v[80:95]
    ds_read_b64 v[174:175], v198 offset:1088
    ds_read_b64 v[176:177], v196 offset:8192
    ds_read_b64 v[178:179], v196 offset:8704
    v_min_u32_e64 v211, 19, v211
    v_lshl_add_u32 v210, v211, 3, v210
    v_mfma_f32_32x32x16_bf16 v[96:111], a[8:11], v[192:195], v[96:111]
    ds_read_b64 v[180:181], v196 offset:8448
    ds_read_b64 v[182:183], v196 offset:8960
    buffer_load_dwordx4 v75, s[16:19], s99 offen offset:2048 sc1 lds
    v_add_u32 v210, 6400, v210
    s_waitcnt lgkmcnt(6)
    v_mfma_f32_16x16x32_bf16 v[112:115], a[12:15], v[160:163], v[112:115]
    ds_read_b64 v[184:185], v198 offset:1280
    v_mfma_f32_32x32x16_bf16 v[80:95], a[12:15], v[164:167], v[80:95]
    ds_read_b64 v[186:187], v198 offset:1344
    ds_read_b64 v[188:189], v196 offset:10240
    ds_read_b64 v[190:191], v196 offset:10752
    ds_write_b64 v210, v[208:209]
    v_mfma_f32_32x32x16_bf16 v[96:111], a[12:15], v[168:171], v[96:111]
    ds_read_b64 v[192:193], v196 offset:10496
    ds_read_b64 v[194:195], v196 offset:11008
    buffer_load_dwordx4 v76, s[16:19], s99 offen offset:3072 sc1 lds
    s_waitcnt lgkmcnt(7)
    v_mfma_f32_16x16x32_bf16 v[112:115], a[16:19], v[172:175], v[112:115]
    ds_read_b64 v[160:161], v198 offset:1536
    v_mfma_f32_32x32x16_bf16 v[80:95], a[16:19], v[176:179], v[80:95]
    ds_read_b64 v[162:163], v198 offset:1600
    ds_read_b64 v[164:165], v196 offset:12288
    ds_read_b64 v[166:167], v196 offset:12800
    v_mfma_f32_32x32x16_bf16 v[96:111], a[16:19], v[180:183], v[96:111]
    ds_read_b64 v[168:169], v196 offset:12544
    ds_read_b64 v[170:171], v196 offset:13056
    s_add_u32 m0, s93, 92928
    s_add_u32 s99, s99, 524288
    s_mov_b64 exec, s[80:81]
    buffer_load_dwordx4 v77, s[16:19], s100 offen sc1 lds
    s_mov_b64 exec, -1
    s_add_u32 s100, s100, 524288
    s_waitcnt lgkmcnt(6)
    v_mfma_f32_16x16x32_bf16 v[112:115], a[20:23], v[184:187], v[112:115]
    ds_read_b64 v[172:173], v198 offset:1792
    v_mfma_f32_32x32x16_bf16 v[80:95], a[20:23], v[188:191], v[80:95]
    ds_read_b64 v[174:175], v198 offset:1856
    ds_read_b64 v[176:177], v196 offset:14336
    ds_read_b64 v[178:179], v196 offset:14848
    v_mfma_f32_32x32x16_bf16 v[96:111], a[20:23], v[192:195], v[96:111]
    ds_read_b64 v[180:181], v196 offset:14592
    ds_read_b64 v[182:183], v196 offset:15104
    buffer_load_dword v7, v4, s[16:19], s87 offen offset:12 sc1
    v_cmp_eq_u32 vcc, 19, v5
    s_nop 0
    s_cbranch_vccnz gl_52
gc_53:
    s_waitcnt vmcnt(6)
    s_barrier
    s_waitcnt lgkmcnt(6)
    v_mfma_f32_16x16x32_bf16 v[112:115], a[24:27], v[160:163], v[112:115]
    v_add_u32 v198, v49, v198
    v_mfma_f32_32x32x16_bf16 v[80:95], a[24:27], v[164:167], v[80:95]
    v_add_u32 v196, 19584, v196
    ds_read_b64 v[184:185], v198 offset:0
    ds_read_b64 v[186:187], v198 offset:64
    ds_read_b64 v[188:189], v196 offset:0
    v_mfma_f32_32x32x16_bf16 v[96:111], a[24:27], v[168:171], v[96:111]
    ds_read_b64 v[190:191], v196 offset:512
    ds_read_b64 v[192:193], v196 offset:256
    ds_read_b64 v[194:195], v196 offset:768
    s_add_u32 m0, s92, 95104
    s_nop 0
    buffer_load_dwordx4 v73, s[16:19], s99 offen offset:0 sc1 lds
    s_waitcnt lgkmcnt(6)
    v_mfma_f32_16x16x32_bf16 v[112:115], a[28:31], v[172:175], v[112:115]
    ds_read_b64 v[160:161], v198 offset:256
    v_mfma_f32_32x32x16_bf16 v[80:95], a[28:31], v[176:179], v[80:95]
    ds_read_b64 v[162:163], v198 offset:320
    ds_read_b64 v[164:165], v196 offset:2048
    ds_read_b64 v[166:167], v196 offset:2560
    v_mfma_f32_32x32x16_bf16 v[96:111], a[28:31], v[180:183], v[96:111]
    ds_read_b64 v[168:169], v196 offset:2304
    ds_read_b64 v[170:171], v196 offset:2816
    buffer_load_dwordx4 v74, s[16:19], s99 offen offset:1024 sc1 lds
    s_waitcnt lgkmcnt(6)
    v_mfma_f32_16x16x32_bf16 v[112:115], a[32:35], v[184:187], v[112:115]
    ds_read_b64 v[172:173], v198 offset:512
    v_mfma_f32_32x32x16_bf16 v[80:95], a[32:35], v[188:191], v[80:95]
    ds_read_b64 v[174:175], v198 offset:576
    ds_read_b64 v[176:177], v196 offset:4096
    ds_read_b64 v[178:179], v196 offset:4608
    v_mfma_f32_32x32x16_bf16 v[96:111], a[32:35], v[192:195], v[96:111]
    ds_read_b64 v[180:181], v196 offset:4352
    ds_read_b64 v[182:183], v196 offset:4864
    buffer_load_dwordx4 v75, s[16:19], s99 offen offset:2048 sc1 lds
    s_waitcnt lgkmcnt(6)
    v_mfma_f32_16x16x32_bf16 v[112:115], a[36:39], v[160:163], v[112:115]
    ds_read_b64 v[184:185], v198 offset:768
    v_mfma_f32_32x32x16_bf16 v[80:95], a[36:39], v[164:167], v[80:95]
    ds_read_b64 v[186:187], v198 offset:832
    ds_read_b64 v[188:189], v196 offset:6144
    ds_read_b64 v[190:191], v196 offset:6656
    v_mfma_f32_32x32x16_bf16 v[96:111], a[36:39], v[168:171], v[96:111]
    ds_read_b64 v[192:193], v196 offset:6400
    ds_read_b64 v[194:195], v196 offset:6912
    buffer_load_dwordx4 v76, s[16:19], s99 offen offset:3072 sc1 lds
    s_waitcnt lgkmcnt(6)
    v_mfma_f32_16x16x32_bf16 v[112:115], a[40:43], v[172:175], v[112:115]
    ds_read_b64 v[160:161], v198 offset:1024
    v_mfma_f32_32x32x16_bf16 v[80:95], a[40:43], v[176:179], v[80:95]
    ds_read_b64 v[162:163], v198 offset:1088
    ds_read_b64 v[164:165], v196 offset:8192
    ds_read_b64 v[166:167], v196 offset:8704
    v_mfma_f32_32x32x16_bf16 v[96:111], a[40:43], v[180:183], v[96:111]
    ds_read_b64 v[168:169], v196 offset:8448
    ds_read_b64 v[170:171], v196 offset:8960
    s_add_u32 m0, s93, 112512
    s_add_u32 s99, s99, 524288
    s_mov_b64 exec, s[80:81]
    buffer_load_dwordx4 v77, s[16:19], s100 offen sc1 lds
    s_mov_b64 exec, -1
    s_add_u32 s100, s100, 524288
    s_waitcnt lgkmcnt(6)
    v_mfma_f32_16x16x32_bf16 v[112:115], a[44:47], v[184:187], v[112:115]
    ds_read_b64 v[172:173], v198 offset:1280
    v_mfma_f32_32x32x16_bf16 v[80:95], a[44:47], v[188:191], v[80:95]
    ds_read_b64 v[174:175], v198 offset:1344
    ds_read_b64 v[176:177], v196 offset:10240
    ds_read_b64 v[178:179], v196 offset:10752
    v_mfma_f32_32x32x16_bf16 v[96:111], a[44:47], v[192:195], v[96:111]
    ds_read_b64 v[180:181], v196 offset:10496
    ds_read_b64 v[182:183], v196 offset:11008
    s_add_u32 m0, s92, 114688
    s_nop 0
    buffer_load_dwordx4 v73, s[16:19], s99 offen offset:0 sc1 lds
    s_waitcnt lgkmcnt(6)
    v_mfma_f32_16x16x32_bf16 v[112:115], a[48:51], v[160:163], v[112:115]
    ds_read_b64 v[184:185], v198 offset:1536
    v_mfma_f32_32x32x16_bf16 v[80:95], a[48:51], v[164:167], v[80:95]
    ds_read_b64 v[186:187], v198 offset:1600
    ds_read_b64 v[188:189], v196 offset:12288
    ds_read_b64 v[190:191], v196 offset:12800
    v_mfma_f32_32x32x16_bf16 v[96:111], a[48:51], v[168:171], v[96:111]
    ds_read_b64 v[192:193], v196 offset:12544
    ds_read_b64 v[194:195], v196 offset:13056
    buffer_load_dwordx4 v74, s[16:19], s99 offen offset:1024 sc1 lds
    s_waitcnt lgkmcnt(6)
    v_mfma_f32_16x16x32_bf16 v[112:115], a[52:55], v[172:175], v[112:115]
    ds_read_b64 v[160:161], v198 offset:1792
    v_mfma_f32_32x32x16_bf16 v[80:95], a[52:55], v[176:179], v[80:95]
    ds_read_b64 v[162:163], v198 offset:1856
    ds_read_b64 v[164:165], v196 offset:14336
    ds_read_b64 v[166:167], v196 offset:14848
    v_mfma_f32_32x32x16_bf16 v[96:111], a[52:55], v[180:183], v[96:111]
    ds_read_b64 v[168:169], v196 offset:14592
    ds_read_b64 v[170:171], v196 offset:15104
    buffer_load_dwordx4 v75, s[16:19], s99 offen offset:2048 sc1 lds
    s_waitcnt vmcnt(8)
    v_cmp_gt_u32 vcc, 1, v7
    s_nop 0
    s_and_b64 vcc, vcc, s[50:51]
    s_cbranch_scc1 ps_54
pc_56:
    s_barrier
    s_waitcnt lgkmcnt(6)
    v_mfma_f32_16x16x32_bf16 v[112:115], a[56:59], v[184:187], v[112:115]
    v_add_u32_e64 v198, v49, v198
    v_mfma_f32_32x32x16_bf16 v[80:95], a[56:59], v[188:191], v[80:95]
    v_add_u32 v196, 19584, v196
    ds_read_b64 v[172:173], v198 offset:0
    ds_read_b64 v[174:175], v198 offset:64
    ds_read_b64 v[176:177], v196 offset:0
    v_mfma_f32_32x32x16_bf16 v[96:111], a[56:59], v[192:195], v[96:111]
    ds_read_b64 v[178:179], v196 offset:512
    ds_read_b64 v[180:181], v196 offset:256
    ds_read_b64 v[182:183], v196 offset:768
    buffer_load_dwordx4 v76, s[16:19], s99 offen offset:3072 sc1 lds
    s_waitcnt lgkmcnt(6)
    v_mfma_f32_16x16x32_bf16 v[112:115], a[60:63], v[160:163], v[112:115]
    ds_read_b64 v[184:185], v198 offset:256
    v_mfma_f32_32x32x16_bf16 v[80:95], a[60:63], v[164:167], v[80:95]
    ds_read_b64 v[186:187], v198 offset:320
    ds_read_b64 v[188:189], v196 offset:2048
    ds_read_b64 v[190:191], v196 offset:2560
    v_mfma_f32_32x32x16_bf16 v[96:111], a[60:63], v[168:171], v[96:111]
    ds_read_b64 v[192:193], v196 offset:2304
    ds_read_b64 v[194:195], v196 offset:2816
    s_add_u32 m0, s93, 132096
    s_add_u32 s99, s99, 524288
    s_mov_b64 exec, s[80:81]
    buffer_load_dwordx4 v77, s[16:19], s100 offen sc1 lds
    s_mov_b64 exec, -1
    s_add_u32 s100, s100, 524288
    s_waitcnt lgkmcnt(6)
    v_mfma_f32_16x16x32_bf16 v[112:115], a[64:67], v[172:175], v[112:115]
    ds_read_b64 v[160:161], v198 offset:512
    v_mfma_f32_32x32x16_bf16 v[80:95], a[64:67], v[176:179], v[80:95]
    ds_read_b64 v[162:163], v198 offset:576
    ds_read_b64 v[164:165], v196 offset:4096
    ds_read_b64 v[166:167], v196 offset:4608
    v_mfma_f32_32x32x16_bf16 v[96:111], a[64:67], v[180:183], v[96:111]
    ds_read_b64 v[168:169], v196 offset:4352
    ds_read_b64 v[170:171], v196 offset:4864
    s_lshl_b32 s25, s72, 5
    s_add_u32 s25, s25, 256
    s_sub_u32 s26, s25, 4
    s_max_i32 s26, s26, 0
    s_lshl_b32 s27, s71, 12
    s_add_u32 s27, s27, 9437184
    s_lshl_b32 s99, s25, 3
    s_lshl_b32 s100, s26, 3
    s_lshl_b32 s92, s24, 12
    s_lshl_b32 s93, s24, 9
    s_add_u32 s99, s99, s27
    s_add_u32 s100, s100, s27
    s_waitcnt lgkmcnt(6)
    v_mfma_f32_16x16x32_bf16 v[112:115], a[68:71], v[184:187], v[112:115]
    ds_read_b64 v[172:173], v198 offset:768
    v_mfma_f32_32x32x16_bf16 v[80:95], a[68:71], v[188:191], v[80:95]
    ds_read_b64 v[174:175], v198 offset:832
    ds_read_b64 v[176:177], v196 offset:6144
    ds_read_b64 v[178:179], v196 offset:6656
    v_mfma_f32_32x32x16_bf16 v[96:111], a[68:71], v[192:195], v[96:111]
    ds_read_b64 v[180:181], v196 offset:6400
    ds_read_b64 v[182:183], v196 offset:6912
    s_waitcnt lgkmcnt(6)
    v_mfma_f32_16x16x32_bf16 v[112:115], a[72:75], v[160:163], v[112:115]
    ds_read_b64 v[184:185], v198 offset:1024
    v_mfma_f32_32x32x16_bf16 v[80:95], a[72:75], v[164:167], v[80:95]
    ds_read_b64 v[186:187], v198 offset:1088
    ds_read_b64 v[188:189], v196 offset:8192
    ds_read_b64 v[190:191], v196 offset:8704
    v_mfma_f32_32x32x16_bf16 v[96:111], a[72:75], v[168:171], v[96:111]
    ds_read_b64 v[192:193], v196 offset:8448
    ds_read_b64 v[194:195], v196 offset:8960
    s_waitcnt lgkmcnt(6)
    v_mfma_f32_16x16x32_bf16 v[112:115], a[76:79], v[172:175], v[112:115]
    ds_read_b64 v[160:161], v198 offset:1280
    v_mfma_f32_32x32x16_bf16 v[80:95], a[76:79], v[176:179], v[80:95]
    ds_read_b64 v[162:163], v198 offset:1344
    ds_read_b64 v[164:165], v196 offset:10240
    ds_read_b64 v[166:167], v196 offset:10752
    v_mfma_f32_32x32x16_bf16 v[96:111], a[76:79], v[180:183], v[96:111]
    ds_read_b64 v[168:169], v196 offset:10496
    ds_read_b64 v[170:171], v196 offset:11008
    s_waitcnt lgkmcnt(6)
    v_mfma_f32_16x16x32_bf16 v[112:115], a[80:83], v[184:187], v[112:115]
    ds_read_b64 v[172:173], v198 offset:1536
    v_mfma_f32_32x32x16_bf16 v[80:95], a[80:83], v[188:191], v[80:95]
    ds_read_b64 v[174:175], v198 offset:1600
    ds_read_b64 v[176:177], v196 offset:12288
    ds_read_b64 v[178:179], v196 offset:12800
    v_mfma_f32_32x32x16_bf16 v[96:111], a[80:83], v[192:195], v[96:111]
    ds_read_b64 v[180:181], v196 offset:12544
    ds_read_b64 v[182:183], v196 offset:13056
    s_lshl_b32 s98, s72, 5
    s_add_u32 s98, s98, 0
    s_sub_u32 s95, s98, 4
    s_max_i32 s95, s95, 0
    s_lshl_b32 s94, s98, 3
    s_lshl_b32 s95, s95, 3
    s_add_u32 s94, s94, 3457024
    s_add_u32 s95, s95, 3457024
    s_add_u32 s96, s94, 8192
    buffer_load_dwordx2 v[152:153], v47, s[16:19], s94 offen sc1
    s_waitcnt lgkmcnt(6)
    v_mfma_f32_16x16x32_bf16 v[112:115], a[84:87], v[160:163], v[112:115]
    ds_read_b64 v[184:185], v198 offset:1792
    v_mfma_f32_32x32x16_bf16 v[80:95], a[84:87], v[164:167], v[80:95]
    ds_read_b64 v[186:187], v198 offset:1856
    ds_read_b64 v[188:189], v196 offset:14336
    ds_read_b64 v[190:191], v196 offset:14848
    v_mfma_f32_32x32x16_bf16 v[96:111], a[84:87], v[168:171], v[96:111]
    ds_read_b64 v[192:193], v196 offset:14592
    ds_read_b64 v[194:195], v196 offset:15104
    buffer_load_dwordx2 v[154:155], v47, s[16:19], s96 offen sc1
    s_waitcnt vmcnt(7)
    s_barrier
    s_waitcnt lgkmcnt(6)
    v_mfma_f32_16x16x32_bf16 v[112:115], a[88:91], v[172:175], v[112:115]
    v_add_u32_e64 v198, v49, v198
    v_mfma_f32_32x32x16_bf16 v[80:95], a[88:91], v[176:179], v[80:95]
    v_add_u32 v196, 19584, v196
    ds_read_b64 v[160:161], v198 offset:0
    ds_read_b64 v[162:163], v198 offset:64
    ds_read_b64 v[164:165], v196 offset:0
    v_mfma_f32_32x32x16_bf16 v[96:111], a[88:91], v[180:183], v[96:111]
    ds_read_b64 v[166:167], v196 offset:512
    ds_read_b64 v[168:169], v196 offset:256
    ds_read_b64 v[170:171], v196 offset:768
    buffer_load_dwordx2 v[156:157], v48, s[16:19], s95 offen sc1
    s_waitcnt lgkmcnt(6)
    v_mfma_f32_16x16x32_bf16 v[112:115], a[92:95], v[184:187], v[112:115]
    ds_read_b64 v[172:173], v198 offset:256
    v_mfma_f32_32x32x16_bf16 v[80:95], a[92:95], v[188:191], v[80:95]
    ds_read_b64 v[174:175], v198 offset:320
    ds_read_b64 v[176:177], v196 offset:2048
    ds_read_b64 v[178:179], v196 offset:2560
    v_mfma_f32_32x32x16_bf16 v[96:111], a[92:95], v[192:195], v[96:111]
    ds_read_b64 v[180:181], v196 offset:2304
    ds_read_b64 v[182:183], v196 offset:2816
    buffer_load_dword v7, v4, s[16:19], s89 offen offset:4 sc1
    s_waitcnt lgkmcnt(6)
    v_mfma_f32_16x16x32_bf16 v[112:115], a[96:99], v[160:163], v[112:115]
    ds_read_b64 v[184:185], v198 offset:512
    v_mfma_f32_32x32x16_bf16 v[80:95], a[96:99], v[164:167], v[80:95]
    ds_read_b64 v[186:187], v198 offset:576
    ds_read_b64 v[188:189], v196 offset:4096
    ds_read_b64 v[190:191], v196 offset:4608
    v_mfma_f32_32x32x16_bf16 v[96:111], a[96:99], v[168:171], v[96:111]
    ds_read_b64 v[192:193], v196 offset:4352
    ds_read_b64 v[194:195], v196 offset:4864
    s_waitcnt lgkmcnt(6)
    v_mfma_f32_16x16x32_bf16 v[112:115], a[100:103], v[172:175], v[112:115]
    ds_read_b64 v[160:161], v198 offset:768
    v_mfma_f32_32x32x16_bf16 v[80:95], a[100:103], v[176:179], v[80:95]
    ds_read_b64 v[162:163], v198 offset:832
    ds_read_b64 v[164:165], v196 offset:6144
    ds_read_b64 v[166:167], v196 offset:6656
    v_mfma_f32_32x32x16_bf16 v[96:111], a[100:103], v[180:183], v[96:111]
    ds_read_b64 v[168:169], v196 offset:6400
    ds_read_b64 v[170:171], v196 offset:6912
    s_waitcnt lgkmcnt(6)
    v_mfma_f32_16x16x32_bf16 v[112:115], a[104:107], v[184:187], v[112:115]
    ds_read_b64 v[172:173], v198 offset:1024
    v_mfma_f32_32x32x16_bf16 v[80:95], a[104:107], v[188:191], v[80:95]
    ds_read_b64 v[174:175], v198 offset:1088
    ds_read_b64 v[176:177], v196 offset:8192
    ds_read_b64 v[178:179], v196 offset:8704
    v_mfma_f32_32x32x16_bf16 v[96:111], a[104:107], v[192:195], v[96:111]
    ds_read_b64 v[180:181], v196 offset:8448
    ds_read_b64 v[182:183], v196 offset:8960
    s_waitcnt lgkmcnt(6)
    v_mfma_f32_16x16x32_bf16 v[112:115], a[108:111], v[160:163], v[112:115]
    ds_read_b64 v[184:185], v198 offset:1280
    v_mfma_f32_32x32x16_bf16 v[80:95], a[108:111], v[164:167], v[80:95]
    ds_read_b64 v[186:187], v198 offset:1344
    ds_read_b64 v[188:189], v196 offset:10240
    ds_read_b64 v[190:191], v196 offset:10752
    v_mfma_f32_32x32x16_bf16 v[96:111], a[108:111], v[168:171], v[96:111]
    ds_read_b64 v[192:193], v196 offset:10496
    ds_read_b64 v[194:195], v196 offset:11008
    s_waitcnt lgkmcnt(6)
    v_mfma_f32_16x16x32_bf16 v[112:115], a[112:115], v[172:175], v[112:115]
    ds_read_b64 v[160:161], v198 offset:1536
    v_mfma_f32_32x32x16_bf16 v[80:95], a[112:115], v[176:179], v[80:95]
    ds_read_b64 v[162:163], v198 offset:1600
    ds_read_b64 v[164:165], v196 offset:12288
    ds_read_b64 v[166:167], v196 offset:12800
    v_mfma_f32_32x32x16_bf16 v[96:111], a[112:115], v[180:183], v[96:111]
    ds_read_b64 v[168:169], v196 offset:12544
    ds_read_b64 v[170:171], v196 offset:13056
    s_waitcnt lgkmcnt(6)
    v_mfma_f32_16x16x32_bf16 v[112:115], a[116:119], v[184:187], v[112:115]
    ds_read_b64 v[172:173], v198 offset:1792
    v_mfma_f32_32x32x16_bf16 v[80:95], a[116:119], v[188:191], v[80:95]
    ds_read_b64 v[174:175], v198 offset:1856
    ds_read_b64 v[176:177], v196 offset:14336
    ds_read_b64 v[178:179], v196 offset:14848
    v_mfma_f32_32x32x16_bf16 v[96:111], a[116:119], v[192:195], v[96:111]
    ds_read_b64 v[180:181], v196 offset:14592
    ds_read_b64 v[182:183], v196 offset:15104
sl_57:
    s_waitcnt vmcnt(2)
    v_max3_u32 v2, v152, v153, v154
    s_waitcnt vmcnt(1)
    v_max3_u32 v2, v2, v155, v156
    v_max_u32 v2, v2, v157
    v_cmp_eq_u32 vcc, -1, v2
    s_nop 0
    s_cbranch_vccnz rd_58
rc_59:
    s_waitcnt vmcnt(0)
    v_cmp_gt_u32 vcc, 1, v7
    s_nop 0
    s_and_b64 vcc, vcc, s[50:51]
    s_cbranch_scc1 ps_60
pc_62:
    s_barrier
    s_waitcnt lgkmcnt(6)
    v_mfma_f32_16x16x32_bf16 v[112:115], a[120:123], v[160:163], v[112:115]
    v_add_u32_e64 v198, v49, v198
    v_mfma_f32_32x32x16_bf16 v[80:95], a[120:123], v[164:167], v[80:95]
    v_add_u32 v196, 19584, v196
    ds_read_b64 v[184:185], v198 offset:0
    ds_read_b64 v[186:187], v198 offset:64
    v_mul_f32 v148, v24, v157
    v_mul_f32 v149, v25, v157
    v_mfma_f32_32x32x16_bf16 v[96:111], a[120:123], v[168:171], v[96:111]
    ds_read_b64 v[188:189], v196 offset:0
    ds_read_b64 v[190:191], v196 offset:512
    s_sub_u32 s3, s2, 160
    s_and_b32 s3, s3, 63
    s_add_u32 s3, s3, 64
    s_and_b32 s25, s3, 3
    s_lshl_b32 s25, s25, 12
    s_lshr_b32 s26, s3, 2
    s_lshl_b32 s26, s26, 7
    s_add_u32 s3, s25, s26
    v_lshrrev_b32 v236, 3, v0
    v_and_b32 v237, 7, v0
    v_lshlrev_b32 v237, 4, v237
    v_lshl_add_u32 v236, v236, 14, v237
    s_sub_u32 s25, s2, 160
    s_cmp_lt_u32 s25, 64
    s_cselect_b32 s25, 0, 1073741824
    v_add_u32_e64 v236, s25, v236
    s_add_u32 s26, s3, 9437184
    buffer_load_dwordx4 v[216:219], v236, s[16:19], s26 offen sc1
    v_mul_f32 v150, v26, v157
    v_mul_f32_e64 v151, v27, v157
    s_waitcnt lgkmcnt(4)
    v_mfma_f32_16x16x32_bf16 v[112:115], a[124:127], v[172:175], v[112:115]
    ds_read_b64 v[192:193], v198 offset:256
    v_mfma_f32_32x32x16_bf16 v[80:95], a[124:127], v[176:179], v[80:95]
    ds_read_b64 v[194:195], v198 offset:320
    ds_read_b64 v[160:161], v196 offset:2048
    v_mul_f32 v116, v8, v153
    v_mul_f32 v117, v9, v153
    v_mul_f32_e64 v118, v10, v153
    v_mfma_f32_32x32x16_bf16 v[96:111], a[124:127], v[180:183], v[96:111]
    ds_read_b64 v[162:163], v196 offset:2560
    s_add_u32 s26, s26, 524288
    buffer_load_dwordx4 v[220:223], v236, s[16:19], s26 offen sc1
    v_mul_f32 v119, v11, v153
    v_mul_f32_e64 v120, v12, v153
    s_waitcnt lgkmcnt(4)
    v_mfma_f32_16x16x32_bf16 v[112:115], a[128:131], v[184:187], v[112:115]
    ds_read_b64 v[164:165], v198 offset:512
    v_mfma_f32_32x32x16_bf16 v[80:95], a[128:131], v[188:191], v[80:95]
    ds_read_b64 v[166:167], v198 offset:576
    ds_read_b64 v[168:169], v196 offset:4096
    ds_read_b64 v[170:171], v196 offset:4608
    v_mul_f32 v121, v13, v153
    v_mul_f32_e64 v122, v14, v153
    s_waitcnt lgkmcnt(4)
    v_mfma_f32_16x16x32_bf16 v[112:115], a[132:135], v[192:195], v[112:115]
    ds_read_b64 v[172:173], v198 offset:768
    v_mfma_f32_32x32x16_bf16 v[80:95], a[132:135], v[160:163], v[80:95]
    ds_read_b64 v[174:175], v198 offset:832
    ds_read_b64 v[176:177], v196 offset:6144
    ds_read_b64 v[178:179], v196 offset:6656
    s_add_u32 s26, s26, 524288
    buffer_load_dwordx4 v[224:227], v236, s[16:19], s26 offen sc1
    v_mul_f32 v123, v15, v153
    v_mul_f32_e64 v124, v16, v153
    s_waitcnt lgkmcnt(4)
    v_mfma_f32_16x16x32_bf16 v[112:115], a[136:139], v[164:167], v[112:115]
    ds_read_b64 v[180:181], v198 offset:1024
    v_mfma_f32_32x32x16_bf16 v[80:95], a[136:139], v[168:171], v[80:95]
    ds_read_b64 v[182:183], v198 offset:1088
    ds_read_b64 v[184:185], v196 offset:8192
    ds_read_b64 v[186:187], v196 offset:8704
    v_mul_f32 v125, v17, v153
    v_mul_f32_e64 v126, v18, v153
    s_waitcnt lgkmcnt(4)
    v_mfma_f32_16x16x32_bf16 v[112:115], a[140:143], v[172:175], v[112:115]
    ds_read_b64 v[188:189], v198 offset:1280
    v_mfma_f32_32x32x16_bf16 v[80:95], a[140:143], v[176:179], v[80:95]
    ds_read_b64 v[190:191], v198 offset:1344
    ds_read_b64 v[192:193], v196 offset:10240
    ds_read_b64 v[194:195], v196 offset:10752
    s_add_u32 s26, s26, 524288
    buffer_load_dwordx4 v[228:231], v236, s[16:19], s26 offen sc1
    v_mul_f32 v127, v19, v153
    v_mul_f32_e64 v128, v20, v153
    s_waitcnt lgkmcnt(4)
    v_mfma_f32_16x16x32_bf16 v[112:115], a[144:147], v[180:183], v[112:115]
    ds_read_b64 v[160:161], v198 offset:1536
    v_mfma_f32_32x32x16_bf16 v[80:95], a[144:147], v[184:187], v[80:95]
    ds_read_b64 v[162:163], v198 offset:1600
    ds_read_b64 v[164:165], v196 offset:12288
    ds_read_b64 v[166:167], v196 offset:12800
    v_mul_f32 v129, v21, v153
    v_mul_f32_e64 v130, v22, v153
    s_waitcnt lgkmcnt(4)
    v_mfma_f32_16x16x32_bf16 v[112:115], a[148:151], v[188:191], v[112:115]
    ds_read_b64 v[168:169], v198 offset:1792
    v_mfma_f32_32x32x16_bf16 v[80:95], a[148:151], v[192:195], v[80:95]
    ds_read_b64 v[170:171], v198 offset:1856
    ds_read_b64 v[172:173], v196 offset:14336
    ds_read_b64 v[174:175], v196 offset:14848
    s_add_u32 s26, s26, 524288
    buffer_load_dwordx4 v[232:235], v236, s[16:19], s26 offen sc1
    v_mul_f32 v131, v23, v153
    v_mul_f32_e64 v132, v8, v155
    s_waitcnt lgkmcnt(4)
    v_mfma_f32_16x16x32_bf16 v[112:115], a[152:155], v[160:163], v[112:115]
    ds_read_b64 v[176:177], v196 offset:256
    v_mfma_f32_32x32x16_bf16 v[80:95], a[152:155], v[164:167], v[80:95]
    ds_read_b64 v[178:179], v196 offset:768
    ds_read_b64 v[180:181], v196 offset:2304
    ds_read_b64 v[182:183], v196 offset:2816
    v_mul_f32 v133, v9, v155
    v_mul_f32_e64 v134, v10, v155
    s_waitcnt lgkmcnt(4)
    v_mfma_f32_16x16x32_bf16 v[112:115], a[156:159], v[168:171], v[112:115]
    ds_read_b64 v[184:185], v196 offset:4352
    v_mfma_f32_32x32x16_bf16 v[80:95], a[156:159], v[172:175], v[80:95]
    ds_read_b64 v[186:187], v196 offset:4864
    ds_read_b64 v[188:189], v196 offset:6400
    ds_read_b64 v[190:191], v196 offset:6912
    s_add_u32 m0, s92, 36352
    s_nop 0
    buffer_load_dwordx4 v73, s[16:19], s99 offen offset:0 sc1 lds
    v_mul_f32 v135, v11, v155
    v_mul_f32 v136, v12, v155
    v_mul_f32 v137, v13, v155
    v_mul_f32 v138, v14, v155
    v_mul_f32 v139, v15, v155
    v_mul_f32 v140, v16, v155
    v_mul_f32 v141, v17, v155
    v_mul_f32 v142, v18, v155
    v_mul_f32 v143, v19, v155
    v_mul_f32 v144, v20, v155
    v_mul_f32 v145, v21, v155
    v_mul_f32 v146, v22, v155
    v_mul_f32_e64 v147, v23, v155
    s_waitcnt lgkmcnt(4)
    v_mfma_f32_32x32x16_bf16 v[96:111], a[128:131], v[176:179], v[96:111]
    ds_read_b64 v[192:193], v196 offset:8448
    ds_read_b64 v[194:195], v196 offset:8960
    v_mfma_f32_32x32x16_bf16 v[96:111], a[132:135], v[180:183], v[96:111]
    ds_read_b64 v[160:161], v196 offset:10496
    ds_read_b64 v[162:163], v196 offset:11008
    buffer_load_dwordx4 v74, s[16:19], s99 offen offset:1024 sc1 lds
    v_fma_f32 v112, v112, v156, v148
    v_fma_f32 v113, v113, v156, v149
    s_waitcnt lgkmcnt(4)
    v_mfma_f32_32x32x16_bf16 v[96:111], a[136:139], v[184:187], v[96:111]
    ds_read_b64 v[164:165], v196 offset:12544
    ds_read_b64 v[166:167], v196 offset:13056
    v_fma_f32 v114, v114, v156, v150
    v_fma_f32 v115, v115, v156, v151
    v_cvt_pk_bf16_f32 v112, v112, v113
    v_mfma_f32_32x32x16_bf16 v[96:111], a[140:143], v[188:191], v[96:111]
    ds_read_b64 v[168:169], v196 offset:14592
    ds_read_b64 v[170:171], v196 offset:15104
    buffer_load_dwordx4 v75, s[16:19], s99 offen offset:2048 sc1 lds
    v_cvt_pk_bf16_f32 v113, v114, v115
    v_fma_f32 v80, v80, v152, v116
    s_waitcnt lgkmcnt(4)
    v_mfma_f32_32x32x16_bf16 v[96:111], a[144:147], v[192:195], v[96:111]
    v_fma_f32 v81, v81, v152, v117
    v_fma_f32 v82, v82, v152, v118
    v_fma_f32 v83, v83, v152, v119
    v_cvt_pk_bf16_f32 v80, v80, v81
    v_cvt_pk_bf16_f32 v81, v82, v83
    v_mfma_f32_32x32x16_bf16 v[96:111], a[148:151], v[160:163], v[96:111]
    ds_write_b64 v40, v[112:113] offset:0
    ds_write_b64 v38, v[80:81] offset:0
    v_fma_f32 v84, v84, v152, v120
    v_fma_f32 v85, v85, v152, v121
    s_waitcnt lgkmcnt(2)
    v_mfma_f32_32x32x16_bf16 v[96:111], a[152:155], v[164:167], v[96:111]
    v_fma_f32 v86, v86, v152, v122
    v_fma_f32 v87, v87, v152, v123
    v_cvt_pk_bf16_f32 v84, v84, v85
    v_cvt_pk_bf16_f32 v85, v86, v87
    v_fma_f32 v88, v88, v152, v124
    v_mfma_f32_32x32x16_bf16 v[96:111], a[156:159], v[168:171], v[96:111]
    buffer_load_dwordx4 v76, s[16:19], s99 offen offset:3072 sc1 lds
    v_fma_f32 v89, v89, v152, v125
    v_fma_f32 v90, v90, v152, v126
    v_fma_f32 v91, v91, v152, v127
    v_cvt_pk_bf16_f32 v88, v88, v89
    v_cvt_pk_bf16_f32 v89, v90, v91
    ds_write_b64 v38, v[84:85] offset:6400
    ds_write_b64 v38, v[88:89] offset:12800
    v_fma_f32 v92, v92, v152, v128
    v_fma_f32 v93, v93, v152, v129
    v_fma_f32 v94, v94, v152, v130
    v_fma_f32 v95, v95, v152, v131
    v_cvt_pk_bf16_f32 v92, v92, v93
    v_cvt_pk_bf16_f32 v93, v94, v95
    ds_write_b64 v39, v[92:93] offset:0
    v_pk_fma_f32 v[96:97], v[96:97], v[154:155], v[132:133] op_sel_hi:[1,0,1]
    v_pk_fma_f32 v[98:99], v[98:99], v[154:155], v[134:135] op_sel_hi:[1,0,1]
    v_cvt_pk_bf16_f32 v96, v96, v97
    v_cvt_pk_bf16_f32 v97, v98, v99
    v_pk_fma_f32 v[100:101], v[100:101], v[154:155], v[136:137] op_sel_hi:[1,0,1]
    v_pk_fma_f32 v[102:103], v[102:103], v[154:155], v[138:139] op_sel_hi:[1,0,1]
    v_cvt_pk_bf16_f32 v100, v100, v101
    v_cvt_pk_bf16_f32 v101, v102, v103
    ds_write_b64 v38, v[96:97] offset:1600
    ds_write_b64 v38, v[100:101] offset:8000
    v_pk_fma_f32 v[104:105], v[104:105], v[154:155], v[140:141] op_sel_hi:[1,0,1]
    v_pk_fma_f32 v[106:107], v[106:107], v[154:155], v[142:143] op_sel_hi:[1,0,1]
    v_cvt_pk_bf16_f32 v104, v104, v105
    v_cvt_pk_bf16_f32 v105, v106, v107
    v_pk_fma_f32 v[108:109], v[108:109], v[154:155], v[144:145] op_sel_hi:[1,0,1]
    v_pk_fma_f32 v[110:111], v[110:111], v[154:155], v[146:147] op_sel_hi:[1,0,1]
    v_cvt_pk_bf16_f32 v108, v108, v109
    v_cvt_pk_bf16_f32 v109, v110, v111
    ds_write_b64 v38, v[104:105] offset:14400
    ds_write_b64 v39, v[108:109] offset:1600
    v_cmp_u_f32 vcc, v82, v114
    v_cmp_u_f32 s[82:83], v98, v98
    s_lshl_b32 s25, s24, 2
    s_add_u32 s25, s25, 161280
    s_or_b64 vcc, vcc, s[82:83]
    s_cselect_b32 s26, 1, 0
    v_mov_b32 v196, s25
    v_mov_b32 v197, s26
    ds_write_b32 v196, v197
    s_waitcnt lgkmcnt(0)
    s_barrier
    s_sub_u32 s85, s2, 160
    s_cmp_ge_u32 s85, 64
    s_cbranch_scc1 s2_63
    v_mov_b32 v238, 0x3f803f80
    s_lshl_b32 s25, s24, 7
    s_add_u32 s25, s25, 134272
    v_lshrrev_b32 v239, 4, v1
    v_lshl_add_u32 v237, v239, 2, v237
    v_add_u32 v237, s25, v237
se_64:
    v_mov_b32 v240, 0
    v_mov_b32 v241, 0
    v_mov_b32 v242, 0
    v_mov_b32 v243, 0
    s_waitcnt vmcnt(8)
    v_dot2c_f32_bf16 v240, v216, v238
    v_dot2c_f32_bf16 v241, v216, v216
    v_dot2c_f32_bf16 v240, v217, v238
    v_dot2c_f32_bf16 v241, v217, v217
    v_dot2c_f32_bf16 v242, v218, v238
    v_dot2c_f32_bf16 v243, v218, v218
    v_dot2c_f32_bf16 v242, v219, v238
    v_dot2c_f32_bf16 v243, v219, v219
    s_waitcnt vmcnt(7)
    v_dot2c_f32_bf16 v240, v220, v238
    v_dot2c_f32_bf16 v241, v220, v220
    v_dot2c_f32_bf16 v240, v221, v238
    v_dot2c_f32_bf16 v241, v221, v221
    v_dot2c_f32_bf16 v242, v222, v238
    v_dot2c_f32_bf16 v243, v222, v222
    v_dot2c_f32_bf16 v242, v223, v238
    v_dot2c_f32_bf16 v243, v223, v223
    s_waitcnt vmcnt(6)
    v_dot2c_f32_bf16 v240, v224, v238
    v_dot2c_f32_bf16 v241, v224, v224
    v_dot2c_f32_bf16 v240, v225, v238
    v_dot2c_f32_bf16 v241, v225, v225
    v_dot2c_f32_bf16 v242, v226, v238
    v_dot2c_f32_bf16 v243, v226, v226
    v_dot2c_f32_bf16 v242, v227, v238
    v_dot2c_f32_bf16 v243, v227, v227
    s_waitcnt vmcnt(5)
    v_dot2c_f32_bf16 v240, v228, v238
    v_dot2c_f32_bf16 v241, v228, v228
    v_dot2c_f32_bf16 v240, v229, v238
    v_dot2c_f32_bf16 v241, v229, v229
    v_dot2c_f32_bf16 v242, v230, v238
    v_dot2c_f32_bf16 v243, v230, v230
    v_dot2c_f32_bf16 v242, v231, v238
    v_dot2c_f32_bf16 v243, v231, v231
    s_waitcnt vmcnt(4)
    v_dot2c_f32_bf16 v240, v232, v238
    v_dot2c_f32_bf16 v241, v232, v232
    v_dot2c_f32_bf16 v240, v233, v238
    v_dot2c_f32_bf16 v241, v233, v233
    v_dot2c_f32_bf16 v242, v234, v238
    v_dot2c_f32_bf16 v243, v234, v234
    v_dot2c_f32_bf16 v242, v235, v238
    v_dot2c_f32_bf16 v243, v235, v235
    s_nop 2
    v_cmp_u_f32 vcc, v241, v243
    s_nop 0
    s_cbranch_vccnz rd_65
rc_66:
    v_permlane32_swap_b32 v240, v242
    v_permlane32_swap_b32 v241, v243
    v_pk_add_f32 v[240:241], v[240:241], v[242:243]
    s_nop 1
    v_permlane16_swap_b32 v240, v241
    v_add_f32_e64 v240, v240, v241
    s_nop 1
    v_add_f32_dpp v240, v240, v240 row_ror:8 row_mask:0xf bank_mask:0xf
    ds_write_b32 v237, v240
    v_and_b32 v236, 15, v0
    v_lshlrev_b32 v236, 3, v236
    v_add_u32 v237, 134272, v236
    v_mov_b32 v239, 1073741824
    v_cmp_gt_u32 vcc, 16, v0
    s_nop 1
    v_cndmask_b32 v236, v239, v236, vcc
    s_add_u32 s25, s3, 3457024
    s_waitcnt lgkmcnt(0)
    s_barrier
    ds_read_b64 v[216:217], v237 offset:0
    ds_read_b64 v[218:219], v237 offset:128
    ds_read_b64 v[220:221], v237 offset:256
    ds_read_b64 v[222:223], v237 offset:384
    s_waitcnt lgkmcnt(2)
    v_pk_add_f32 v[216:217], v[216:217], v[218:219]
    s_waitcnt lgkmcnt(0)
    v_pk_add_f32 v[220:221], v[220:221], v[222:223]
    v_pk_add_f32 v[216:217], v[216:217], v[220:221]
    v_mul_f32 v239, 0x3acccccd, v216
    v_mul_f32 v217, 0x3acccccd, v217
    v_fma_f32 v217, -v239, v239, v217
    v_max_f32 v217, 0, v217
    v_add_f32 v217, 0x3727c5ac, v217
    v_rsq_f32_e64 v216, v217
    s_nop 0
    v_mul_f32 v217, -v239, v216
    buffer_store_dwordx2 v[216:217], v236, s[16:19], s25 offen sc1
s2_63:
    v_mov_b32 v158, 161280
    ds_read_b128 v[128:131], v158
    v_mov_b32 v94, 0
    v_mov_b32 v95, 0
    v_mov_b32 v98, 0
    v_mov_b32 v99, 0
    s_mov_b64 exec, 0xffff
    ds_read_b64 v[94:95], v42 offset:320
    ds_read_b64 v[98:99], v42 offset:640
    s_mov_b64 exec, -1
    s_nop 0
    ds_read_b64 v[92:93], v41 offset:320
    ds_read_b64 v[96:97], v41 offset:640
    ds_read_b64 v[84:85], v41 offset:6720
    ds_read_b64 v[86:87], v42 offset:6720
    ds_read_b64 v[80:81], v41 offset:6400
    ds_read_b64 v[82:83], v42 offset:6400
    ds_read_b64 v[88:89], v41 offset:7040
    ds_read_b64 v[90:91], v42 offset:7040
    ds_read_b64_tr_b16 v[106:107], v44 offset:0
    ds_read_b64_tr_b16 v[100:101], v43 offset:0
    s_add_u32 m0, s93, 53760
    s_add_u32 s99, s99, 524288
    s_mov_b64 exec, s[80:81]
    buffer_load_dwordx4 v77, s[16:19], s100 offen sc1 lds
    s_mov_b64 exec, -1
    s_add_u32 s100, s100, 524288
    ds_read_b64_tr_b16 v[108:109], v44 offset:320
    ds_read_b64_tr_b16 v[102:103], v43 offset:320
    ds_read_b64_tr_b16 v[110:111], v44 offset:640
    ds_read_b64_tr_b16 v[104:105], v43 offset:640
    v_mov_b32 v156, 0xf149f2ca
    v_cndmask_b32 v152, v32, v156, s[90:91]
    v_cndmask_b32 v153, v33, v156, s[90:91]
    v_cndmask_b32 v154, v34, v156, s[90:91]
    s_add_u32 m0, s92, 55936
    s_nop 0
    buffer_load_dwordx4 v73, s[16:19], s99 offen offset:0 sc1 lds
    v_cndmask_b32 v155, v35, v156, s[90:91]
    s_mov_b32 s82, 0x3ea52b5c
    s_lshl_b32 s25, s98, 4
    s_add_u32 s25, s25, 12058624
    s_lshl_b32 s26, s98, 3
    s_add_u32 s26, s26, 12058624
    s_waitcnt lgkmcnt(15)
    v_or3_b32 v128, v128, v129, v130
    v_or_b32 v128, v128, v131
    buffer_load_dwordx4 v74, s[16:19], s99 offen offset:1024 sc1 lds
    v_cmp_ne_u32_e64 vcc, 0, v128
    s_nop 0
    s_cbranch_vccnz rd_67
rc_68:
    s_waitcnt lgkmcnt(10)
    v_mfma_f32_16x16x32_bf16 v[116:119], v[84:87], v[92:95], v[28:31]
    v_mfma_f32_16x16x32_bf16 v[120:123], v[84:87], v[96:99], v[32:35]
    s_waitcnt lgkmcnt(8)
    v_mfma_f32_16x16x32_bf16 v[112:115], v[80:83], v[92:95], v[152:155]
    s_waitcnt lgkmcnt(6)
    v_mfma_f32_16x16x32_bf16 v[124:127], v[88:91], v[96:99], v[28:31]
    s_nop 5
    v_max_f32 v112, v112, v116
    v_max_f32 v113, v113, v117
    v_max_f32 v114, v114, v118
    buffer_load_dwordx4 v75, s[16:19], s99 offen offset:2048 sc1 lds
    v_max_f32 v115, v115, v119
    v_max3_f32 v156, v112, v113, v114
    v_max_f32 v156, v156, v115
    v_max_f32 v120, v120, v124
    v_max_f32 v121, v121, v125
    v_max_f32 v122, v122, v126
    v_max_f32 v123, v123, v127
    v_max3_f32 v157, v120, v121, v122
    buffer_load_dwordx4 v76, s[16:19], s99 offen offset:3072 sc1 lds
    v_max_f32 v157, v157, v123
    s_nop 1
    v_permlane16_swap_b32 v156, v157
    v_max_f32 v156, v156, v157
    v_mov_b32 v157, v156
    s_nop 1
    v_permlane32_swap_b32 v156, v157
    v_max_f32 v156, v156, v157
    v_mul_f32 v156, s82, v156
    v_mov_b32 v157, v156
    s_add_u32 m0, s93, 73344
    s_add_u32 s99, s99, 524288
    s_mov_b64 exec, s[80:81]
    buffer_load_dwordx4 v77, s[16:19], s100 offen sc1 lds
    s_mov_b64 exec, -1
    s_add_u32 s100, s100, 524288
    v_permlane16_swap_b32_e64 v156, v157
    v_fma_f32 v112, v112, s82, -v156
    v_fma_f32 v113, v113, s82, -v156
    v_fma_f32 v114, v114, s82, -v156
    v_fma_f32 v115, v115, s82, -v156
    v_exp_f32 v112, v112
    v_exp_f32 v113, v113
    v_exp_f32 v114, v114
    s_add_u32 m0, s92, 75520
    s_nop 0
    buffer_load_dwordx4 v73, s[16:19], s99 offen offset:0 sc1 lds
    v_exp_f32_e64 v115, v115
    v_cvt_pk_bf16_f32 v116, v112, v113
    v_cvt_pk_bf16_f32 v117, v114, v115
    v_bfi_b32 v128, v36, 0, v116
    v_and_b32 v130, v36, v116
    v_bfi_b32 v129, v37, 0, v117
    v_and_b32 v131, v37, v117
    s_waitcnt lgkmcnt(3)
    s_nop 0
    v_mfma_f32_16x16x32_bf16 v[144:147], v[106:109], v[128:131], 0
    buffer_load_dwordx4 v74, s[16:19], s99 offen offset:1024 sc1 lds
    s_waitcnt lgkmcnt(2)
    v_mfma_f32_16x16x32_bf16 v[136:139], v[100:103], v[128:131], 0
    v_fma_f32 v120, v120, s82, -v157
    v_fma_f32 v121, v121, s82, -v157
    v_fma_f32 v122, v122, s82, -v157
    v_fma_f32 v123, v123, s82, -v157
    v_exp_f32 v120, v120
    v_exp_f32 v121, v121
    v_exp_f32 v122, v122
    buffer_load_dwordx4 v75, s[16:19], s99 offen offset:2048 sc1 lds
    v_exp_f32_e64 v123, v123
    v_cvt_pk_bf16_f32 v124, v120, v121
    v_cvt_pk_bf16_f32 v125, v122, v123
    v_bfi_b32 v132, v36, 0, v124
    v_and_b32 v134, v36, v124
    v_bfi_b32 v133, v37, 0, v125
    v_and_b32 v135, v37, v125
    s_waitcnt lgkmcnt(1)
    s_nop 0
    v_mfma_f32_16x16x32_bf16 v[148:151], v[108:111], v[132:135], 0
    buffer_load_dwordx4 v76, s[16:19], s99 offen offset:3072 sc1 lds
    s_waitcnt lgkmcnt(0)
    v_mfma_f32_16x16x32_bf16 v[140:143], v[102:105], v[132:135], 0
    v_mov_b32 v158, v144
    s_nop 1
    v_permlane16_swap_b32 v144, v158
    v_rcp_f32 v158, v158
    s_nop 0
    v_pk_mul_f32 v[136:137], v[136:137], v[158:159] op_sel_hi:[1,0]
    v_pk_mul_f32 v[138:139], v[138:139], v[158:159] op_sel_hi:[1,0]
    v_pk_mul_f32 v[144:145], v[144:145], v[158:159] op_sel_hi:[1,0]
    v_pk_mul_f32 v[146:147], v[146:147], v[158:159] op_sel_hi:[1,0]
    s_add_u32 m0, s93, 92928
    s_add_u32 s99, s99, 524288
    s_mov_b64 exec, s[80:81]
    buffer_load_dwordx4 v77, s[16:19], s100 offen sc1 lds
    s_mov_b64 exec, -1
    s_add_u32 s100, s100, 524288
    v_cvt_pk_bf16_f32 v112, v136, v137
    v_cvt_pk_bf16_f32 v116, v144, v145
    v_cvt_pk_bf16_f32 v113, v138, v139
    v_cvt_pk_bf16_f32 v117, v146, v147
    v_mov_b32 v160, v148
    s_nop 1
    v_permlane16_swap_b32 v148, v160
    v_rcp_f32_e64 v160, v160
    s_nop 0
    v_pk_mul_f32 v[140:141], v[140:141], v[160:161] op_sel_hi:[1,0]
    v_pk_mul_f32 v[142:143], v[142:143], v[160:161] op_sel_hi:[1,0]
    v_pk_mul_f32 v[148:149], v[148:149], v[160:161] op_sel_hi:[1,0]
    v_pk_mul_f32 v[150:151], v[150:151], v[160:161] op_sel_hi:[1,0]
    v_cvt_pk_bf16_f32 v114, v140, v141
    v_cvt_pk_bf16_f32 v118, v148, v149
    v_cvt_pk_bf16_f32 v115, v142, v143
    v_cvt_pk_bf16_f32 v119, v150, v151
    v_permlane16_swap_b32 v112, v114
    v_permlane16_swap_b32 v113, v115
    v_permlane16_swap_b32 v116, v118
    v_permlane16_swap_b32 v117, v119
    buffer_store_dwordx4 v[112:115], v45, s[16:19], s25 offen sc1
    s_mov_b64 exec, s[80:81]
    buffer_store_dwordx2 v[116:117], v46, s[16:19], s26 offen sc1
    s_mov_b64 exec, -1
ge_69:
    v_add_u32 v196, 36352, v78
    v_mov_b32_e64 v198, v79
    s_waitcnt vmcnt(12)
    s_barrier
    ds_read_b64 v[160:161], v198 offset:0
    ds_read_b64 v[162:163], v198 offset:64
    ds_read_b64 v[164:165], v196 offset:0
    ds_read_b64 v[166:167], v196 offset:512
    ds_read_b64 v[168:169], v196 offset:256
    ds_read_b64 v[170:171], v196 offset:768
    ds_read_b64 v[172:173], v198 offset:256
    ds_read_b64 v[174:175], v198 offset:320
    ds_read_b64 v[176:177], v196 offset:2048
    ds_read_b64 v[178:179], v196 offset:2560
    ds_read_b64 v[180:181], v196 offset:2304
    ds_read_b64 v[182:183], v196 offset:2816
    s_waitcnt lgkmcnt(6)
    v_mfma_f32_16x16x32_bf16 v[112:115], a[0:3], v[160:163], 0
    ds_read_b64 v[184:185], v198 offset:512
    v_mfma_f32_32x32x16_bf16 v[80:95], a[0:3], v[164:167], 0
    ds_read_b64 v[186:187], v198 offset:576
    ds_read_b64 v[188:189], v196 offset:4096
    ds_read_b64 v[190:191], v196 offset:4608
    v_mfma_f32_32x32x16_bf16 v[96:111], a[0:3], v[168:171], 0
    ds_read_b64 v[192:193], v196 offset:4352
    ds_read_b64 v[194:195], v196 offset:4864
    s_add_u32 m0, s92, 95104
    s_nop 0
    buffer_load_dwordx4 v73, s[16:19], s99 offen offset:0 sc1 lds
    s_waitcnt lgkmcnt(6)
    v_mfma_f32_16x16x32_bf16 v[112:115], a[4:7], v[172:175], v[112:115]
    ds_read_b64 v[160:161], v198 offset:768
    v_mfma_f32_32x32x16_bf16 v[80:95], a[4:7], v[176:179], v[80:95]
    ds_read_b64 v[162:163], v198 offset:832
    ds_read_b64 v[164:165], v196 offset:6144
    ds_read_b64 v[166:167], v196 offset:6656
    v_mfma_f32_32x32x16_bf16 v[96:111], a[4:7], v[180:183], v[96:111]
    ds_read_b64 v[168:169], v196 offset:6400
    ds_read_b64 v[170:171], v196 offset:6912
    buffer_load_dwordx4 v74, s[16:19], s99 offen offset:1024 sc1 lds
    s_waitcnt lgkmcnt(6)
    v_mfma_f32_16x16x32_bf16 v[112:115], a[8:11], v[184:187], v[112:115]
    ds_read_b64 v[172:173], v198 offset:1024
    v_mfma_f32_32x32x16_bf16 v[80:95], a[8:11], v[188:191], v[80:95]
    ds_read_b64 v[174:175], v198 offset:1088
    ds_read_b64 v[176:177], v196 offset:8192
    ds_read_b64 v[178:179], v196 offset:8704
    v_mfma_f32_32x32x16_bf16 v[96:111], a[8:11], v[192:195], v[96:111]
    ds_read_b64 v[180:181], v196 offset:8448
    ds_read_b64 v[182:183], v196 offset:8960
    buffer_load_dwordx4 v75, s[16:19], s99 offen offset:2048 sc1 lds
    s_waitcnt lgkmcnt(6)
    v_mfma_f32_16x16x32_bf16 v[112:115], a[12:15], v[160:163], v[112:115]
    ds_read_b64 v[184:185], v198 offset:1280
    v_mfma_f32_32x32x16_bf16 v[80:95], a[12:15], v[164:167], v[80:95]
    ds_read_b64 v[186:187], v198 offset:1344
    ds_read_b64 v[188:189], v196 offset:10240
    ds_read_b64 v[190:191], v196 offset:10752
    v_mfma_f32_32x32x16_bf16 v[96:111], a[12:15], v[168:171], v[96:111]
    ds_read_b64 v[192:193], v196 offset:10496
    ds_read_b64 v[194:195], v196 offset:11008
    buffer_load_dwordx4 v76, s[16:19], s99 offen offset:3072 sc1 lds
    s_waitcnt lgkmcnt(6)
    v_mfma_f32_16x16x32_bf16 v[112:115], a[16:19], v[172:175], v[112:115]
    ds_read_b64 v[160:161], v198 offset:1536
    v_mfma_f32_32x32x16_bf16 v[80:95], a[16:19], v[176:179], v[80:95]
    ds_read_b64 v[162:163], v198 offset:1600
    ds_read_b64 v[164:165], v196 offset:12288
    ds_read_b64 v[166:167], v196 offset:12800
    v_mfma_f32_32x32x16_bf16 v[96:111], a[16:19], v[180:183], v[96:111]
    ds_read_b64 v[168:169], v196 offset:12544
    ds_read_b64 v[170:171], v196 offset:13056
    s_add_u32 m0, s93, 112512
    s_add_u32 s99, s99, 524288
    s_mov_b64 exec, s[80:81]
    buffer_load_dwordx4 v77, s[16:19], s100 offen sc1 lds
    s_mov_b64 exec, -1
    s_add_u32 s100, s100, 524288
    s_waitcnt lgkmcnt(6)
    v_mfma_f32_16x16x32_bf16 v[112:115], a[20:23], v[184:187], v[112:115]
    ds_read_b64 v[172:173], v198 offset:1792
    v_mfma_f32_32x32x16_bf16 v[80:95], a[20:23], v[188:191], v[80:95]
    ds_read_b64 v[174:175], v198 offset:1856
    ds_read_b64 v[176:177], v196 offset:14336
    ds_read_b64 v[178:179], v196 offset:14848
    v_mfma_f32_32x32x16_bf16 v[96:111], a[20:23], v[192:195], v[96:111]
    ds_read_b64 v[180:181], v196 offset:14592
    ds_read_b64 v[182:183], v196 offset:15104
    s_add_u32 m0, s92, 114688
    s_nop 0
    buffer_load_dwordx4 v73, s[16:19], s99 offen offset:0 sc1 lds
    s_waitcnt vmcnt(13)
    s_barrier
    s_waitcnt lgkmcnt(6)
    v_mfma_f32_16x16x32_bf16 v[112:115], a[24:27], v[160:163], v[112:115]
    v_add_u32 v198, v49, v198
    v_mfma_f32_32x32x16_bf16 v[80:95], a[24:27], v[164:167], v[80:95]
    v_add_u32 v196, 19584, v196
    ds_read_b64 v[184:185], v198 offset:0
    ds_read_b64 v[186:187], v198 offset:64
    ds_read_b64 v[188:189], v196 offset:0
    v_mfma_f32_32x32x16_bf16 v[96:111], a[24:27], v[168:171], v[96:111]
    ds_read_b64 v[190:191], v196 offset:512
    ds_read_b64 v[192:193], v196 offset:256
    ds_read_b64 v[194:195], v196 offset:768
    buffer_load_dwordx4 v74, s[16:19], s99 offen offset:1024 sc1 lds
    s_waitcnt lgkmcnt(6)
    v_mfma_f32_16x16x32_bf16 v[112:115], a[28:31], v[172:175], v[112:115]
    ds_read_b64 v[160:161], v198 offset:256
    v_mfma_f32_32x32x16_bf16 v[80:95], a[28:31], v[176:179], v[80:95]
    ds_read_b64 v[162:163], v198 offset:320
    ds_read_b64 v[164:165], v196 offset:2048
    ds_read_b64 v[166:167], v196 offset:2560
    v_mfma_f32_32x32x16_bf16 v[96:111], a[28:31], v[180:183], v[96:111]
    ds_read_b64 v[168:169], v196 offset:2304
    ds_read_b64 v[170:171], v196 offset:2816
    buffer_load_dwordx4 v75, s[16:19], s99 offen offset:2048 sc1 lds
    s_waitcnt lgkmcnt(6)
    v_mfma_f32_16x16x32_bf16 v[112:115], a[32:35], v[184:187], v[112:115]
    ds_read_b64 v[172:173], v198 offset:512
    v_mfma_f32_32x32x16_bf16 v[80:95], a[32:35], v[188:191], v[80:95]
    ds_read_b64 v[174:175], v198 offset:576
    ds_read_b64 v[176:177], v196 offset:4096
    ds_read_b64 v[178:179], v196 offset:4608
    v_mfma_f32_32x32x16_bf16 v[96:111], a[32:35], v[192:195], v[96:111]
    ds_read_b64 v[180:181], v196 offset:4352
    ds_read_b64 v[182:183], v196 offset:4864
    buffer_load_dwordx4 v76, s[16:19], s99 offen offset:3072 sc1 lds
    s_waitcnt lgkmcnt(6)
    v_mfma_f32_16x16x32_bf16 v[112:115], a[36:39], v[160:163], v[112:115]
    ds_read_b64 v[184:185], v198 offset:768
    v_mfma_f32_32x32x16_bf16 v[80:95], a[36:39], v[164:167], v[80:95]
    ds_read_b64 v[186:187], v198 offset:832
    ds_read_b64 v[188:189], v196 offset:6144
    ds_read_b64 v[190:191], v196 offset:6656
    v_mfma_f32_32x32x16_bf16 v[96:111], a[36:39], v[168:171], v[96:111]
    ds_read_b64 v[192:193], v196 offset:6400
    ds_read_b64 v[194:195], v196 offset:6912
    s_add_u32 m0, s93, 132096
    s_add_u32 s99, s99, 524288
    s_mov_b64 exec, s[80:81]
    buffer_load_dwordx4 v77, s[16:19], s100 offen sc1 lds
    s_mov_b64 exec, -1
    s_add_u32 s100, s100, 524288
    s_waitcnt lgkmcnt(6)
    v_mfma_f32_16x16x32_bf16 v[112:115], a[40:43], v[172:175], v[112:115]
    ds_read_b64 v[160:161], v198 offset:1024
    v_mfma_f32_32x32x16_bf16 v[80:95], a[40:43], v[176:179], v[80:95]
    ds_read_b64 v[162:163], v198 offset:1088
    ds_read_b64 v[164:165], v196 offset:8192
    ds_read_b64 v[166:167], v196 offset:8704
    v_add_u32 v199, 36352, v58
    s_lshl_b32 s32, s24, 11
    v_mfma_f32_32x32x16_bf16 v[96:111], a[40:43], v[180:183], v[96:111]
    ds_read_b64 v[168:169], v196 offset:8448
    ds_read_b64 v[170:171], v196 offset:8960
    s_lshl_b32 s98, s72, 5
    s_add_u32 s98, s98, 256
    s_sub_u32 s95, s98, 4
    s_max_i32 s95, s95, 0
    s_lshl_b32 s94, s98, 3
    s_lshl_b32 s95, s95, 3
    s_add_u32 s94, s94, 3457024
    s_add_u32 s95, s95, 3457024
    s_add_u32 s96, s94, 8192
    buffer_load_dwordx2 v[152:153], v47, s[16:19], s94 offen sc1
    s_waitcnt lgkmcnt(6)
    v_mfma_f32_16x16x32_bf16 v[112:115], a[44:47], v[184:187], v[112:115]
    ds_read_b64 v[172:173], v198 offset:1280
    v_mfma_f32_32x32x16_bf16 v[80:95], a[44:47], v[188:191], v[80:95]
    ds_read_b64 v[174:175], v198 offset:1344
    ds_read_b64 v[176:177], v196 offset:10240
    ds_read_b64 v[178:179], v196 offset:10752
    v_add_u32_e64 v203, s32, v199
    s_add_u32 s32, s24, 1
    v_mfma_f32_32x32x16_bf16 v[96:111], a[44:47], v[192:195], v[96:111]
    ds_read_b64 v[180:181], v196 offset:10496
    ds_read_b64 v[182:183], v196 offset:11008
    buffer_load_dwordx2 v[154:155], v47, s[16:19], s96 offen sc1
    s_and_b32 s32, s32, 3
    s_waitcnt lgkmcnt(6)
    v_mfma_f32_16x16x32_bf16 v[112:115], a[48:51], v[160:163], v[112:115]
    ds_read_b64 v[184:185], v198 offset:1536
    v_mfma_f32_32x32x16_bf16 v[80:95], a[48:51], v[164:167], v[80:95]
    ds_read_b64 v[186:187], v198 offset:1600
    ds_read_b64 v[188:189], v196 offset:12288
    ds_read_b64 v[190:191], v196 offset:12800
    s_mul_i32 s32, s32, 6144
    v_add_u32_e64 v200, s32, v199
    v_mfma_f32_32x32x16_bf16 v[96:111], a[48:51], v[168:171], v[96:111]
    ds_read_b64 v[192:193], v196 offset:12544
    ds_read_b64 v[194:195], v196 offset:13056
    buffer_load_dwordx2 v[156:157], v48, s[16:19], s95 offen sc1
    s_add_u32 s32, s24, 2
    s_waitcnt lgkmcnt(6)
    v_mfma_f32_16x16x32_bf16 v[112:115], a[52:55], v[172:175], v[112:115]
    ds_read_b64 v[160:161], v198 offset:1792
    v_mfma_f32_32x32x16_bf16 v[80:95], a[52:55], v[176:179], v[80:95]
    ds_read_b64 v[162:163], v198 offset:1856
    ds_read_b64 v[164:165], v196 offset:14336
    ds_read_b64 v[166:167], v196 offset:14848
    s_and_b32 s32, s32, 3
    s_mul_i32 s32, s32, 6144
    v_mfma_f32_32x32x16_bf16 v[96:111], a[52:55], v[180:183], v[96:111]
    ds_read_b64 v[168:169], v196 offset:14592
    ds_read_b64 v[170:171], v196 offset:15104
    v_add_u32 v201, s32, v199
    s_add_u32 s32, s24, 3
    s_waitcnt vmcnt(15)
    s_barrier
    s_waitcnt lgkmcnt(6)
    v_mfma_f32_16x16x32_bf16 v[112:115], a[56:59], v[184:187], v[112:115]
    v_add_u32_e64 v198, v49, v198
    v_mfma_f32_32x32x16_bf16 v[80:95], a[56:59], v[188:191], v[80:95]
    v_add_u32 v196, 19584, v196
    ds_read_b64 v[172:173], v198 offset:0
    ds_read_b64 v[174:175], v198 offset:64
    ds_read_b64 v[176:177], v196 offset:0
    s_and_b32 s32, s32, 3
    v_mfma_f32_32x32x16_bf16 v[96:111], a[56:59], v[192:195], v[96:111]
    ds_read_b64 v[178:179], v196 offset:512
    ds_read_b64 v[180:181], v196 offset:256
    ds_read_b64 v[182:183], v196 offset:768
    s_mul_i32 s32, s32, 6144
    s_waitcnt lgkmcnt(6)
    v_mfma_f32_16x16x32_bf16 v[112:115], a[60:63], v[160:163], v[112:115]
    ds_read_b64 v[184:185], v198 offset:256
    v_mfma_f32_32x32x16_bf16 v[80:95], a[60:63], v[164:167], v[80:95]
    ds_read_b64 v[186:187], v198 offset:320
    ds_read_b64 v[188:189], v196 offset:2048
    ds_read_b64 v[190:191], v196 offset:2560
    v_add_u32_e64 v202, s32, v199
    s_mul_i32 s32, s24, 6144
    v_mfma_f32_32x32x16_bf16 v[96:111], a[60:63], v[168:171], v[96:111]
    ds_read_b64 v[192:193], v196 offset:2304
    ds_read_b64 v[194:195], v196 offset:2816
    v_add_u32_e64 v204, s32, v199
    s_lshl_b32 s32, s24, 8
    s_waitcnt lgkmcnt(6)
    v_mfma_f32_16x16x32_bf16 v[112:115], a[64:67], v[172:175], v[112:115]
    ds_read_b64 v[160:161], v198 offset:512
    v_mfma_f32_32x32x16_bf16 v[80:95], a[64:67], v[176:179], v[80:95]
    ds_read_b64 v[162:163], v198 offset:576
    ds_read_b64 v[164:165], v196 offset:4096
    ds_read_b64 v[166:167], v196 offset:4608
    s_add_u32 s32, s32, 36352
    v_and_b32_e64 v214, 15, v1
    v_mfma_f32_32x32x16_bf16 v[96:111], a[64:67], v[180:183], v[96:111]
    ds_read_b64 v[168:169], v196 offset:4352
    ds_read_b64 v[170:171], v196 offset:4864
    v_lshl_add_u32 v206, v214, 4, s32
    v_lshrrev_b32 v215, 5, v1
    s_waitcnt lgkmcnt(6)
    v_mfma_f32_16x16x32_bf16 v[112:115], a[68:71], v[184:187], v[112:115]
    ds_read_b64 v[172:173], v198 offset:768
    v_mfma_f32_32x32x16_bf16 v[80:95], a[68:71], v[188:191], v[80:95]
    ds_read_b64 v[174:175], v198 offset:832
    ds_read_b64 v[176:177], v196 offset:6144
    ds_read_b64 v[178:179], v196 offset:6656
    v_lshl_add_u32 v205, v215, 10, v206
    v_bfe_u32 v215, v1, 4, 1
    v_mfma_f32_32x32x16_bf16 v[96:111], a[68:71], v[192:195], v[96:111]
    ds_read_b64 v[180:181], v196 offset:6400
    ds_read_b64 v[182:183], v196 offset:6912
    v_lshl_add_u32 v205, v215, 3, v205
    v_lshlrev_b32 v214, 2, v214
    s_waitcnt lgkmcnt(6)
    v_mfma_f32_16x16x32_bf16 v[112:115], a[72:75], v[160:163], v[112:115]
    ds_read_b64 v[184:185], v198 offset:1024
    v_mfma_f32_32x32x16_bf16 v[80:95], a[72:75], v[164:167], v[80:95]
    ds_read_b64 v[186:187], v198 offset:1088
    ds_read_b64 v[188:189], v196 offset:8192
    ds_read_b64 v[190:191], v196 offset:8704
    v_lshl_add_u32 v214, v215, 10, v214
    s_lshl_b32 s32, s24, 6
    v_mfma_f32_32x32x16_bf16 v[96:111], a[72:75], v[168:171], v[96:111]
    ds_read_b64 v[192:193], v196 offset:8448
    ds_read_b64 v[194:195], v196 offset:8960
    v_lshl_add_u32 v207, v215, 3, s32
    v_and_b32_e64 v215, 12, v1
    s_waitcnt lgkmcnt(6)
    v_mfma_f32_16x16x32_bf16 v[112:115], a[76:79], v[172:175], v[112:115]
    ds_read_b64 v[160:161], v198 offset:1280
    v_mfma_f32_32x32x16_bf16 v[80:95], a[76:79], v[176:179], v[80:95]
    ds_read_b64 v[162:163], v198 offset:1344
    ds_read_b64 v[164:165], v196 offset:10240
    ds_read_b64 v[166:167], v196 offset:10752
    v_lshl_add_u32 v207, v215, 2, v207
    v_and_b32_e64 v215, 2, v1
    v_mfma_f32_32x32x16_bf16 v[96:111], a[76:79], v[180:183], v[96:111]
    ds_read_b64 v[168:169], v196 offset:10496
    ds_read_b64 v[170:171], v196 offset:11008
    v_lshl_add_u32 v207, v215, 1, v207
    v_add_u32 v207, 69120, v207
    s_waitcnt lgkmcnt(6)
    v_mfma_f32_16x16x32_bf16 v[112:115], a[80:83], v[184:187], v[112:115]
    ds_read_b64 v[172:173], v198 offset:1536
    v_mfma_f32_32x32x16_bf16 v[80:95], a[80:83], v[188:191], v[80:95]
    ds_read_b64 v[174:175], v198 offset:1600
    ds_read_b64 v[176:177], v196 offset:12288
    ds_read_b64 v[178:179], v196 offset:12800
    v_lshrrev_b32 v215, 4, v1
    v_lshl_add_u32 v206, v215, 2, v206
    v_mfma_f32_32x32x16_bf16 v[96:111], a[80:83], v[192:195], v[96:111]
    ds_read_b64 v[180:181], v196 offset:12544
    ds_read_b64 v[182:183], v196 offset:13056
    v_mov_b32 v215, 0x3f803f80
    s_waitcnt lgkmcnt(6)
    v_mfma_f32_16x16x32_bf16 v[112:115], a[84:87], v[160:163], v[112:115]
    ds_read_b64 v[184:185], v198 offset:1792
    v_mfma_f32_32x32x16_bf16 v[80:95], a[84:87], v[164:167], v[80:95]
    ds_read_b64 v[186:187], v198 offset:1856
    ds_read_b64 v[188:189], v196 offset:14336
    ds_read_b64 v[190:191], v196 offset:14848
    v_mfma_f32_32x32x16_bf16 v[96:111], a[84:87], v[168:171], v[96:111]
    ds_read_b64 v[192:193], v196 offset:14592
    ds_read_b64 v[194:195], v196 offset:15104
sl_70:
    s_waitcnt vmcnt(1)
    v_max3_u32 v2, v152, v153, v154
    s_waitcnt vmcnt(0)
    v_max3_u32 v2, v2, v155, v156
    v_max_u32 v2, v2, v157
    v_cmp_eq_u32 vcc, -1, v2
    s_nop 0
    s_cbranch_vccnz rd_71
rc_72:
    s_barrier
    s_waitcnt lgkmcnt(6)
    v_mfma_f32_16x16x32_bf16 v[112:115], a[88:91], v[172:175], v[112:115]
    v_add_u32 v198, v49, v198
    v_mfma_f32_32x32x16_bf16 v[80:95], a[88:91], v[176:179], v[80:95]
    v_add_u32 v196, 19584, v196
    ds_read_b64 v[160:161], v198 offset:0
    ds_read_b64 v[162:163], v198 offset:64
    ds_read_b64 v[164:165], v196 offset:0
    v_mul_f32_e64 v148, v24, v157
    v_mfma_f32_32x32x16_bf16 v[96:111], a[88:91], v[180:183], v[96:111]
    ds_read_b64 v[166:167], v196 offset:512
    ds_read_b64 v[168:169], v196 offset:256
    ds_read_b64 v[170:171], v196 offset:768
    v_mul_f32 v149, v25, v157
    s_waitcnt lgkmcnt(6)
    v_mfma_f32_16x16x32_bf16 v[112:115], a[92:95], v[184:187], v[112:115]
    ds_read_b64 v[172:173], v198 offset:256
    v_mfma_f32_32x32x16_bf16 v[80:95], a[92:95], v[188:191], v[80:95]
    ds_read_b64 v[174:175], v198 offset:320
    ds_read_b64 v[176:177], v196 offset:2048
    ds_read_b64 v[178:179], v196 offset:2560
    v_mul_f32 v150, v26, v157
    v_mul_f32 v151, v27, v157
    v_mfma_f32_32x32x16_bf16 v[96:111], a[92:95], v[192:195], v[96:111]
    ds_read_b64 v[180:181], v196 offset:2304
    ds_read_b64 v[182:183], v196 offset:2816
    v_mul_f32 v116, v8, v153
    v_mul_f32_e64 v117, v9, v153
    s_waitcnt lgkmcnt(6)
    v_mfma_f32_16x16x32_bf16 v[112:115], a[96:99], v[160:163], v[112:115]
    ds_read_b64 v[184:185], v198 offset:512
    v_mfma_f32_32x32x16_bf16 v[80:95], a[96:99], v[164:167], v[80:95]
    ds_read_b64 v[186:187], v198 offset:576
    ds_read_b64 v[188:189], v196 offset:4096
    ds_read_b64 v[190:191], v196 offset:4608
    v_mul_f32 v118, v10, v153
    v_mul_f32 v119, v11, v153
    v_mfma_f32_32x32x16_bf16 v[96:111], a[96:99], v[168:171], v[96:111]
    ds_read_b64 v[192:193], v196 offset:4352
    ds_read_b64 v[194:195], v196 offset:4864
    v_mul_f32 v120, v12, v153
    v_mul_f32_e64 v121, v13, v153
    s_waitcnt lgkmcnt(6)
    v_mfma_f32_16x16x32_bf16 v[112:115], a[100:103], v[172:175], v[112:115]
    ds_read_b64 v[160:161], v198 offset:768
    v_mfma_f32_32x32x16_bf16 v[80:95], a[100:103], v[176:179], v[80:95]
    ds_read_b64 v[162:163], v198 offset:832
    ds_read_b64 v[164:165], v196 offset:6144
    ds_read_b64 v[166:167], v196 offset:6656
    v_mul_f32 v122, v14, v153
    v_mul_f32 v123, v15, v153
    v_mfma_f32_32x32x16_bf16 v[96:111], a[100:103], v[180:183], v[96:111]
    ds_read_b64 v[168:169], v196 offset:6400
    ds_read_b64 v[170:171], v196 offset:6912
    v_mul_f32 v124, v16, v153
    v_mul_f32_e64 v125, v17, v153
    s_waitcnt lgkmcnt(6)
    v_mfma_f32_16x16x32_bf16 v[112:115], a[104:107], v[184:187], v[112:115]
    ds_read_b64 v[172:173], v198 offset:1024
    v_mfma_f32_32x32x16_bf16 v[80:95], a[104:107], v[188:191], v[80:95]
    ds_read_b64 v[174:175], v198 offset:1088
    ds_read_b64 v[176:177], v196 offset:8192
    ds_read_b64 v[178:179], v196 offset:8704
    v_mul_f32 v126, v18, v153
    v_mul_f32 v127, v19, v153
    v_mfma_f32_32x32x16_bf16 v[96:111], a[104:107], v[192:195], v[96:111]
    ds_read_b64 v[180:181], v196 offset:8448
    ds_read_b64 v[182:183], v196 offset:8960
    v_mul_f32 v128, v20, v153
    v_mul_f32_e64 v129, v21, v153
    s_waitcnt lgkmcnt(6)
    v_mfma_f32_16x16x32_bf16 v[112:115], a[108:111], v[160:163], v[112:115]
    ds_read_b64 v[184:185], v198 offset:1280
    v_mfma_f32_32x32x16_bf16 v[80:95], a[108:111], v[164:167], v[80:95]
    ds_read_b64 v[186:187], v198 offset:1344
    ds_read_b64 v[188:189], v196 offset:10240
    ds_read_b64 v[190:191], v196 offset:10752
    v_mul_f32 v130, v22, v153
    v_mul_f32 v131, v23, v153
    v_mfma_f32_32x32x16_bf16 v[96:111], a[108:111], v[168:171], v[96:111]
    ds_read_b64 v[192:193], v196 offset:10496
    ds_read_b64 v[194:195], v196 offset:11008
    v_mul_f32 v132, v8, v155
    v_mul_f32_e64 v133, v9, v155
    s_waitcnt lgkmcnt(6)
    v_mfma_f32_16x16x32_bf16 v[112:115], a[112:115], v[172:175], v[112:115]
    ds_read_b64 v[160:161], v198 offset:1536
    v_mfma_f32_32x32x16_bf16 v[80:95], a[112:115], v[176:179], v[80:95]
    ds_read_b64 v[162:163], v198 offset:1600
    ds_read_b64 v[164:165], v196 offset:12288
    ds_read_b64 v[166:167], v196 offset:12800
    v_mul_f32 v134, v10, v155
    v_mul_f32 v135, v11, v155
    v_mfma_f32_32x32x16_bf16 v[96:111], a[112:115], v[180:183], v[96:111]
    ds_read_b64 v[168:169], v196 offset:12544
    ds_read_b64 v[170:171], v196 offset:13056
    v_mul_f32 v136, v12, v155
    v_mul_f32_e64 v137, v13, v155
    s_waitcnt lgkmcnt(6)
    v_mfma_f32_16x16x32_bf16 v[112:115], a[116:119], v[184:187], v[112:115]
    ds_read_b64 v[172:173], v198 offset:1792
    v_mfma_f32_32x32x16_bf16 v[80:95], a[116:119], v[188:191], v[80:95]
    ds_read_b64 v[174:175], v198 offset:1856
    ds_read_b64 v[176:177], v196 offset:14336
    ds_read_b64 v[178:179], v196 offset:14848
    v_mul_f32 v138, v14, v155
    v_mul_f32 v139, v15, v155
    v_mfma_f32_32x32x16_bf16 v[96:111], a[116:119], v[192:195], v[96:111]
    ds_read_b64 v[180:181], v196 offset:14592
    ds_read_b64 v[182:183], v196 offset:15104
    v_mul_f32 v140, v16, v155
    v_mul_f32 v141, v17, v155
    s_barrier
    s_waitcnt lgkmcnt(6)
    v_mfma_f32_16x16x32_bf16 v[112:115], a[120:123], v[160:163], v[112:115]
    v_add_u32_e64 v198, v49, v198
    v_mfma_f32_32x32x16_bf16 v[80:95], a[120:123], v[164:167], v[80:95]
    v_add_u32 v196, 19584, v196
    ds_read_b64 v[184:185], v198 offset:0
    ds_read_b64 v[186:187], v198 offset:64
    v_mul_f32 v142, v18, v155
    v_mul_f32 v143, v19, v155
    v_mfma_f32_32x32x16_bf16 v[96:111], a[120:123], v[168:171], v[96:111]
    ds_read_b64 v[188:189], v196 offset:0
    ds_read_b64 v[190:191], v196 offset:512
    s_mov_b32 s96, 12058624
    buffer_load_dwordx4 v[216:219], v56, s[16:19], s96 offen offset:0 sc1
    v_mul_f32 v144, v20, v155
    v_mul_f32_e64 v145, v21, v155
    s_waitcnt lgkmcnt(4)
    v_mfma_f32_16x16x32_bf16 v[112:115], a[124:127], v[172:175], v[112:115]
    ds_read_b64 v[192:193], v198 offset:256
    v_mfma_f32_32x32x16_bf16 v[80:95], a[124:127], v[176:179], v[80:95]
    ds_read_b64 v[194:195], v198 offset:320
    ds_read_b64 v[160:161], v196 offset:2048
    v_mul_f32 v146, v22, v155
    v_mul_f32 v147, v23, v155
    v_mfma_f32_32x32x16_bf16 v[96:111], a[124:127], v[180:183], v[96:111]
    ds_read_b64 v[162:163], v196 offset:2560
    buffer_load_dwordx4 v[220:223], v56, s[16:19], s96 offen offset:256 sc1
    s_waitcnt lgkmcnt(4)
    v_mfma_f32_16x16x32_bf16 v[112:115], a[128:131], v[184:187], v[112:115]
    ds_read_b64 v[164:165], v198 offset:512
    v_mfma_f32_32x32x16_bf16 v[80:95], a[128:131], v[188:191], v[80:95]
    ds_read_b64 v[166:167], v198 offset:576
    ds_read_b64 v[168:169], v196 offset:4096
    ds_read_b64 v[170:171], v196 offset:4608
    s_waitcnt lgkmcnt(4)
    v_mfma_f32_16x16x32_bf16 v[112:115], a[132:135], v[192:195], v[112:115]
    ds_read_b64 v[172:173], v198 offset:768
    v_mfma_f32_32x32x16_bf16 v[80:95], a[132:135], v[160:163], v[80:95]
    ds_read_b64 v[174:175], v198 offset:832
    ds_read_b64 v[176:177], v196 offset:6144
    ds_read_b64 v[178:179], v196 offset:6656
    s_mov_b32 s96, 12091392
    buffer_load_dwordx4 v[224:227], v56, s[16:19], s96 offen offset:0 sc1
    s_waitcnt lgkmcnt(4)
    v_mfma_f32_16x16x32_bf16 v[112:115], a[136:139], v[164:167], v[112:115]
    ds_read_b64 v[180:181], v198 offset:1024
    v_mfma_f32_32x32x16_bf16 v[80:95], a[136:139], v[168:171], v[80:95]
    ds_read_b64 v[182:183], v198 offset:1088
    ds_read_b64 v[184:185], v196 offset:8192
    ds_read_b64 v[186:187], v196 offset:8704
    s_waitcnt lgkmcnt(4)
    v_mfma_f32_16x16x32_bf16 v[112:115], a[140:143], v[172:175], v[112:115]
    ds_read_b64 v[188:189], v198 offset:1280
    v_mfma_f32_32x32x16_bf16 v[80:95], a[140:143], v[176:179], v[80:95]
    ds_read_b64 v[190:191], v198 offset:1344
    ds_read_b64 v[192:193], v196 offset:10240
    ds_read_b64 v[194:195], v196 offset:10752
    buffer_load_dwordx4 v[228:231], v56, s[16:19], s96 offen offset:256 sc1
    s_waitcnt lgkmcnt(4)
    v_mfma_f32_16x16x32_bf16 v[112:115], a[144:147], v[180:183], v[112:115]
    ds_read_b64 v[160:161], v198 offset:1536
    v_mfma_f32_32x32x16_bf16 v[80:95], a[144:147], v[184:187], v[80:95]
    ds_read_b64 v[162:163], v198 offset:1600
    ds_read_b64 v[164:165], v196 offset:12288
    ds_read_b64 v[166:167], v196 offset:12800
    s_waitcnt lgkmcnt(4)
    v_mfma_f32_16x16x32_bf16 v[112:115], a[148:151], v[188:191], v[112:115]
    ds_read_b64 v[168:169], v198 offset:1792
    v_mfma_f32_32x32x16_bf16 v[80:95], a[148:151], v[192:195], v[80:95]
    ds_read_b64 v[170:171], v198 offset:1856
    ds_read_b64 v[172:173], v196 offset:14336
    ds_read_b64 v[174:175], v196 offset:14848
    s_mov_b32 s96, 12124160
    buffer_load_dwordx4 v[232:235], v56, s[16:19], s96 offen offset:0 sc1
    s_waitcnt lgkmcnt(4)
    v_mfma_f32_16x16x32_bf16 v[112:115], a[152:155], v[160:163], v[112:115]
    ds_read_b64 v[176:177], v196 offset:256
    v_mfma_f32_32x32x16_bf16 v[80:95], a[152:155], v[164:167], v[80:95]
    ds_read_b64 v[178:179], v196 offset:768
    ds_read_b64 v[180:181], v196 offset:2304
    ds_read_b64 v[182:183], v196 offset:2816
    s_waitcnt lgkmcnt(4)
    v_mfma_f32_16x16x32_bf16 v[112:115], a[156:159], v[168:171], v[112:115]
    ds_read_b64 v[184:185], v196 offset:4352
    v_mfma_f32_32x32x16_bf16 v[80:95], a[156:159], v[172:175], v[80:95]
    ds_read_b64 v[186:187], v196 offset:4864
    ds_read_b64 v[188:189], v196 offset:6400
    ds_read_b64 v[190:191], v196 offset:6912
    buffer_load_dwordx4 v[236:239], v56, s[16:19], s96 offen offset:256 sc1
    s_waitcnt lgkmcnt(4)
    v_mfma_f32_32x32x16_bf16 v[96:111], a[128:131], v[176:179], v[96:111]
    ds_read_b64 v[192:193], v196 offset:8448
    ds_read_b64 v[194:195], v196 offset:8960
    v_mfma_f32_32x32x16_bf16 v[96:111], a[132:135], v[180:183], v[96:111]
    ds_read_b64 v[160:161], v196 offset:10496
    ds_read_b64 v[162:163], v196 offset:11008
    s_mov_b32 s96, 12156928
    buffer_load_dwordx4 v[240:243], v56, s[16:19], s96 offen offset:0 sc1
    v_fma_f32 v112, v112, v156, v148
    v_fma_f32 v113, v113, v156, v149
    s_waitcnt lgkmcnt(4)
    v_mfma_f32_32x32x16_bf16 v[96:111], a[136:139], v[184:187], v[96:111]
    ds_read_b64 v[164:165], v196 offset:12544
    ds_read_b64 v[166:167], v196 offset:13056
    v_fma_f32 v114, v114, v156, v150
    v_fma_f32 v115, v115, v156, v151
    v_cvt_pk_bf16_f32 v112, v112, v113
    v_mfma_f32_32x32x16_bf16 v[96:111], a[140:143], v[188:191], v[96:111]
    ds_read_b64 v[168:169], v196 offset:14592
    ds_read_b64 v[170:171], v196 offset:15104
    buffer_load_dwordx4 v[244:247], v56, s[16:19], s96 offen offset:256 sc1
    v_cvt_pk_bf16_f32 v113, v114, v115
    v_fma_f32 v80, v80, v152, v116
    s_waitcnt lgkmcnt(4)
    v_mfma_f32_32x32x16_bf16 v[96:111], a[144:147], v[192:195], v[96:111]
    v_fma_f32 v81, v81, v152, v117
    v_fma_f32 v82, v82, v152, v118
    v_fma_f32 v83, v83, v152, v119
    v_cvt_pk_bf16_f32 v80, v80, v81
    v_cvt_pk_bf16_f32 v81, v82, v83
    v_mfma_f32_32x32x16_bf16 v[96:111], a[148:151], v[160:163], v[96:111]
    ds_write_b64 v40, v[112:113] offset:0
    ds_write_b64 v38, v[80:81] offset:0
    v_fma_f32 v84, v84, v152, v120
    v_fma_f32 v85, v85, v152, v121
    s_waitcnt lgkmcnt(2)
    v_mfma_f32_32x32x16_bf16 v[96:111], a[152:155], v[164:167], v[96:111]
    v_fma_f32 v86, v86, v152, v122
    v_fma_f32 v87, v87, v152, v123
    v_cvt_pk_bf16_f32 v84, v84, v85
    v_cvt_pk_bf16_f32 v85, v86, v87
    v_fma_f32 v88, v88, v152, v124
    v_mfma_f32_32x32x16_bf16 v[96:111], a[156:159], v[168:171], v[96:111]
    s_mov_b32 s96, 12058624
    buffer_load_dwordx2 v[248:249], v57, s[16:19], s96 offen offset:0 sc1
    v_fma_f32 v89, v89, v152, v125
    v_fma_f32 v90, v90, v152, v126
    v_fma_f32 v91, v91, v152, v127
    v_cvt_pk_bf16_f32 v88, v88, v89
    v_cvt_pk_bf16_f32 v89, v90, v91
    ds_write_b64 v38, v[84:85] offset:6400
    ds_write_b64 v38, v[88:89] offset:12800
    v_fma_f32 v92, v92, v152, v128
    v_fma_f32 v93, v93, v152, v129
    v_fma_f32 v94, v94, v152, v130
    v_fma_f32 v95, v95, v152, v131
    v_cvt_pk_bf16_f32 v92, v92, v93
    v_cvt_pk_bf16_f32 v93, v94, v95
    ds_write_b64 v39, v[92:93] offset:0
    v_pk_fma_f32 v[96:97], v[96:97], v[154:155], v[132:133] op_sel_hi:[1,0,1]
    v_pk_fma_f32 v[98:99], v[98:99], v[154:155], v[134:135] op_sel_hi:[1,0,1]
    v_cvt_pk_bf16_f32 v96, v96, v97
    v_cvt_pk_bf16_f32 v97, v98, v99
    v_pk_fma_f32 v[100:101], v[100:101], v[154:155], v[136:137] op_sel_hi:[1,0,1]
    v_pk_fma_f32 v[102:103], v[102:103], v[154:155], v[138:139] op_sel_hi:[1,0,1]
    v_cvt_pk_bf16_f32 v100, v100, v101
    v_cvt_pk_bf16_f32 v101, v102, v103
    ds_write_b64 v38, v[96:97] offset:1600
    ds_write_b64 v38, v[100:101] offset:8000
    v_pk_fma_f32 v[104:105], v[104:105], v[154:155], v[140:141] op_sel_hi:[1,0,1]
    v_pk_fma_f32 v[106:107], v[106:107], v[154:155], v[142:143] op_sel_hi:[1,0,1]
    v_cvt_pk_bf16_f32 v104, v104, v105
    v_cvt_pk_bf16_f32 v105, v106, v107
    v_pk_fma_f32 v[108:109], v[108:109], v[154:155], v[144:145] op_sel_hi:[1,0,1]
    v_pk_fma_f32 v[110:111], v[110:111], v[154:155], v[146:147] op_sel_hi:[1,0,1]
    v_cvt_pk_bf16_f32 v108, v108, v109
    v_cvt_pk_bf16_f32 v109, v110, v111
    ds_write_b64 v38, v[104:105] offset:14400
    ds_write_b64 v39, v[108:109] offset:1600
    v_cmp_u_f32 vcc, v82, v114
    v_cmp_u_f32 s[82:83], v98, v98
    s_lshl_b32 s25, s24, 2
    s_add_u32 s25, s25, 161280
    s_or_b64 vcc, vcc, s[82:83]
    s_cselect_b32 s26, 1, 0
    v_mov_b32 v196, s25
    v_mov_b32 v197, s26
    ds_write_b32 v196, v197
    s_waitcnt lgkmcnt(0)
    s_barrier
    v_mov_b32 v158, 161280
    ds_read_b128 v[128:131], v158
    v_mov_b32 v94, 0
    v_mov_b32 v95, 0
    v_mov_b32 v98, 0
    v_mov_b32 v99, 0
    s_mov_b64 exec, 0xffff
    ds_read_b64 v[94:95], v42 offset:320
    ds_read_b64 v[98:99], v42 offset:640
    s_mov_b64 exec, -1
    s_nop 0
    ds_read_b64 v[92:93], v41 offset:320
    ds_read_b64 v[96:97], v41 offset:640
    ds_read_b64 v[84:85], v41 offset:6720
    ds_read_b64 v[86:87], v42 offset:6720
    ds_read_b64 v[80:81], v41 offset:6400
    ds_read_b64 v[82:83], v42 offset:6400
    ds_read_b64 v[88:89], v41 offset:7040
    ds_read_b64 v[90:91], v42 offset:7040
    ds_read_b64_tr_b16 v[106:107], v44 offset:0
    ds_read_b64_tr_b16 v[100:101], v43 offset:0
    buffer_load_dwordx2 v[252:253], v57, s[16:19], s96 offen offset:128 sc1
    ds_read_b64_tr_b16 v[108:109], v44 offset:320
    ds_read_b64_tr_b16 v[102:103], v43 offset:320
    ds_read_b64_tr_b16 v[110:111], v44 offset:640
    ds_read_b64_tr_b16 v[104:105], v43 offset:640
    s_mov_b32 s82, 0x3ea52b5c
    s_lshl_b32 s25, s98, 4
    s_add_u32 s25, s25, 12058624
    s_lshl_b32 s26, s98, 3
    s_mov_b32 s96, 12075008
    buffer_load_dwordx2 v[250:251], v57, s[16:19], s96 offen offset:0 sc1
    s_add_u32 s26, s26, 12058624
    s_waitcnt lgkmcnt(15)
    v_or3_b32 v128, v128, v129, v130
    v_or_b32 v128, v128, v131
    v_cmp_ne_u32 vcc, 0, v128
    s_nop 0
    s_cbranch_vccnz rd_73
rc_74:
    s_waitcnt lgkmcnt(10)
    v_mfma_f32_16x16x32_bf16 v[116:119], v[84:87], v[92:95], v[28:31]
    v_mfma_f32_16x16x32_bf16 v[120:123], v[84:87], v[96:99], v[32:35]
    s_waitcnt lgkmcnt(8)
    v_mfma_f32_16x16x32_bf16 v[112:115], v[80:83], v[92:95], v[32:35]
    s_waitcnt lgkmcnt(6)
    v_mfma_f32_16x16x32_bf16 v[124:127], v[88:91], v[96:99], v[28:31]
    buffer_load_dwordx2 v[254:255], v57, s[16:19], s96 offen offset:128 sc1
    s_nop 4
    v_max_f32 v112, v112, v116
    v_max_f32 v113, v113, v117
    v_max_f32 v114, v114, v118
    v_max_f32 v115, v115, v119
    v_max3_f32 v156, v112, v113, v114
    v_max_f32 v156, v156, v115
    v_max_f32 v120, v120, v124
    v_max_f32 v121, v121, v125
    s_mov_b32 s96, 9437184
    buffer_load_dwordx4 v[208:211], v59, s[16:19], s96 offen sc1
    v_max_f32 v122, v122, v126
    v_max_f32 v123, v123, v127
    v_max3_f32 v157, v120, v121, v122
    v_max_f32 v157, v157, v123
    s_nop 1
    v_permlane16_swap_b32 v156, v157
    v_max_f32 v156, v156, v157
    v_mov_b32 v157, v156
    s_nop 1
    v_permlane32_swap_b32_e64 v156, v157
    s_add_u32 s97, s36, 9437184
    buffer_load_dword v212, v61, s[16:19], s97 offen sc1
    v_max_f32 v156, v156, v157
    v_mul_f32 v156, s82, v156
    v_mov_b32 v157, v156
    s_nop 1
    v_permlane16_swap_b32_e64 v156, v157
    v_fma_f32 v112, v112, s82, -v156
    v_fma_f32 v113, v113, s82, -v156
    v_fma_f32 v114, v114, s82, -v156
    v_fma_f32 v115, v115, s82, -v156
    v_exp_f32 v112, v112
    v_exp_f32 v113, v113
    v_exp_f32 v114, v114
    v_exp_f32 v115, v115
    v_cvt_pk_bf16_f32 v116, v112, v113
    v_cvt_pk_bf16_f32 v117, v114, v115
    v_bfi_b32 v128, v36, 0, v116
    v_and_b32 v130, v36, v116
    v_bfi_b32 v129, v37, 0, v117
    v_and_b32 v131, v37, v117
    s_waitcnt lgkmcnt(3)
    s_nop 0
    v_mfma_f32_16x16x32_bf16 v[144:147], v[106:109], v[128:131], 0
    s_waitcnt lgkmcnt(2)
    v_mfma_f32_16x16x32_bf16 v[136:139], v[100:103], v[128:131], 0
    v_fma_f32 v120, v120, s82, -v157
    v_fma_f32 v121, v121, s82, -v157
    v_fma_f32 v122, v122, s82, -v157
    v_fma_f32 v123, v123, s82, -v157
    v_exp_f32 v120, v120
    v_exp_f32 v121, v121
    v_exp_f32 v122, v122
    v_exp_f32_e64 v123, v123
    v_cvt_pk_bf16_f32 v124, v120, v121
    v_cvt_pk_bf16_f32 v125, v122, v123
    v_bfi_b32 v132, v36, 0, v124
    v_and_b32 v134, v36, v124
    v_bfi_b32 v133, v37, 0, v125
    v_and_b32 v135, v37, v125
    s_waitcnt lgkmcnt(1)
    s_nop 0
    v_mfma_f32_16x16x32_bf16 v[148:151], v[108:111], v[132:135], 0
    s_waitcnt lgkmcnt(0)
    v_mfma_f32_16x16x32_bf16 v[140:143], v[102:105], v[132:135], 0
    v_mov_b32 v158, v144
    s_nop 1
    v_permlane16_swap_b32 v144, v158
    v_rcp_f32 v158, v158
    s_nop 0
    v_pk_mul_f32 v[136:137], v[136:137], v[158:159] op_sel_hi:[1,0]
    v_pk_mul_f32 v[138:139], v[138:139], v[158:159] op_sel_hi:[1,0]
    v_pk_mul_f32 v[144:145], v[144:145], v[158:159] op_sel_hi:[1,0]
    v_pk_mul_f32 v[146:147], v[146:147], v[158:159] op_sel_hi:[1,0]
    v_cvt_pk_bf16_f32 v112, v136, v137
    v_cvt_pk_bf16_f32 v116, v144, v145
    v_cvt_pk_bf16_f32 v113, v138, v139
    v_cvt_pk_bf16_f32 v117, v146, v147
    v_mov_b32 v160, v148
    s_nop 1
    v_permlane16_swap_b32 v148, v160
    v_rcp_f32_e64 v160, v160
    s_nop 0
    v_pk_mul_f32 v[140:141], v[140:141], v[160:161] op_sel_hi:[1,0]
    v_pk_mul_f32 v[142:143], v[142:143], v[160:161] op_sel_hi:[1,0]
    v_pk_mul_f32 v[148:149], v[148:149], v[160:161] op_sel_hi:[1,0]
    v_pk_mul_f32 v[150:151], v[150:151], v[160:161] op_sel_hi:[1,0]
    v_cvt_pk_bf16_f32 v114, v140, v141
    v_cvt_pk_bf16_f32 v118, v148, v149
    v_cvt_pk_bf16_f32 v115, v142, v143
    v_cvt_pk_bf16_f32 v119, v150, v151
    v_permlane16_swap_b32 v112, v114
    v_permlane16_swap_b32 v113, v115
    v_permlane16_swap_b32 v116, v118
    v_permlane16_swap_b32 v117, v119
    buffer_store_dwordx4 v[112:115], v45, s[16:19], s25 offen sc1
    s_mov_b64 exec, s[80:81]
    buffer_store_dwordx2 v[116:117], v46, s[16:19], s26 offen sc1
    s_mov_b64 exec, -1
oe_75:
    s_waitcnt vmcnt(15)
    v_mfma_f32_16x16x32_bf16 v[112:115], a[176:179], v[216:219], 0
    v_mov_b32 v136, 0
    v_mov_b32 v137, 0
    s_waitcnt vmcnt(14)
    v_mfma_f32_16x16x32_bf16 v[116:119], a[176:179], v[220:223], 0
    v_mov_b32 v138, 0
    v_mov_b32 v139, 0
    s_waitcnt vmcnt(13)
    v_mfma_f32_16x16x32_bf16 v[112:115], a[196:199], v[224:227], v[112:115]
    v_mov_b32 v140, 0
    v_mov_b32 v141, 0
    s_waitcnt vmcnt(12)
    v_mfma_f32_16x16x32_bf16 v[116:119], a[196:199], v[228:231], v[116:119]
    s_mov_b32 s25, 14680064
    s_add_u32 s26, s36, 14680064
    s_waitcnt vmcnt(11)
    v_mfma_f32_16x16x32_bf16 v[112:115], a[216:219], v[232:235], v[112:115]
    s_add_u32 s27, s35, 3506176
    s_mov_b32 s28, 0x99999999
    s_waitcnt vmcnt(10)
    v_mfma_f32_16x16x32_bf16 v[116:119], a[216:219], v[236:239], v[116:119]
    s_mov_b32 s29, 0x99999999
    s_waitcnt vmcnt(9)
    v_mfma_f32_16x16x32_bf16 v[112:115], a[236:239], v[240:243], v[112:115]
    s_waitcnt vmcnt(8)
    v_mfma_f32_16x16x32_bf16 v[116:119], a[236:239], v[244:247], v[116:119]
    s_waitcnt vmcnt(5)
    v_mfma_f32_16x16x32_bf16 v[112:115], v[52:55], v[248:251], v[112:115]
    s_waitcnt vmcnt(4)
    v_mfma_f32_16x16x32_bf16 v[116:119], v[52:55], v[252:255], v[116:119]
    v_mfma_f32_16x16x32_bf16 v[88:91], a[164:167], v[216:219], 0
    v_mfma_f32_16x16x32_bf16 v[92:95], a[164:167], v[220:223], 0
    v_mfma_f32_16x16x32_bf16 v[88:91], a[184:187], v[224:227], v[88:91]
    s_waitcnt vmcnt(3)
    v_max3_u32 v132, v208, v209, v210
    s_waitcnt vmcnt(2)
    v_max3_u32 v132, v132, v211, v212
    v_mfma_f32_16x16x32_bf16 v[92:95], a[184:187], v[228:231], v[92:95]
    v_cmp_eq_u32 s[82:83], -1, v132
    v_mfma_f32_16x16x32_bf16 v[88:91], a[204:207], v[232:235], v[88:91]
    v_mfma_f32_16x16x32_bf16 v[92:95], a[204:207], v[236:239], v[92:95]
    v_cmp_u_f32 vcc, v112, v116
    s_nop 0
    s_or_b64 vcc, vcc, s[82:83]
    s_cbranch_vccnz rd_76
rc_77:
    v_mfma_f32_16x16x32_bf16 v[88:91], a[224:227], v[240:243], v[88:91]
    ds_write_b128 v203, v[112:115] offset:24576
    v_mfma_f32_16x16x32_bf16 v[92:95], a[224:227], v[244:247], v[92:95]
    v_mfma_f32_16x16x32_bf16 v[88:91], a[244:247], v[248:251], v[88:91]
    ds_write_b128 v203, v[116:119] offset:25600
    v_mfma_f32_16x16x32_bf16 v[92:95], a[244:247], v[252:255], v[92:95]
    v_mfma_f32_16x16x32_bf16 v[96:99], a[168:171], v[216:219], 0
    v_lshlrev_b32_e64 v120, 16, v208
    v_and_b32 v121, 0xffff0000, v208
    v_mfma_f32_16x16x32_bf16 v[100:103], a[168:171], v[220:223], 0
    v_lshlrev_b32_e64 v122, 16, v209
    v_and_b32 v123, 0xffff0000, v209
    v_mfma_f32_16x16x32_bf16 v[96:99], a[188:191], v[224:227], v[96:99]
    v_lshlrev_b32_e64 v124, 16, v210
    v_and_b32 v125, 0xffff0000, v210
    v_mfma_f32_16x16x32_bf16 v[100:103], a[188:191], v[228:231], v[100:103]
    v_lshlrev_b32_e64 v126, 16, v211
    v_and_b32 v127, 0xffff0000, v211
    v_mfma_f32_16x16x32_bf16 v[96:99], a[208:211], v[232:235], v[96:99]
    v_lshlrev_b32_e64 v128, 16, v212
    v_and_b32 v129, 0xffff0000, v212
    v_mfma_f32_16x16x32_bf16 v[100:103], a[208:211], v[236:239], v[100:103]
    v_mfma_f32_16x16x32_bf16 v[96:99], a[228:231], v[240:243], v[96:99]
    ds_write_b128 v200, v[88:91] offset:0
    v_mfma_f32_16x16x32_bf16 v[100:103], a[228:231], v[244:247], v[100:103]
    v_mfma_f32_16x16x32_bf16 v[96:99], a[248:251], v[248:251], v[96:99]
    ds_write_b128 v200, v[92:95] offset:1024
    v_mfma_f32_16x16x32_bf16 v[100:103], a[248:251], v[252:255], v[100:103]
    v_mfma_f32_16x16x32_bf16 v[104:107], a[172:175], v[216:219], 0
    v_mfma_f32_16x16x32_bf16 v[108:111], a[172:175], v[220:223], 0
    v_mfma_f32_16x16x32_bf16 v[104:107], a[192:195], v[224:227], v[104:107]
    v_mfma_f32_16x16x32_bf16 v[108:111], a[192:195], v[228:231], v[108:111]
    v_mfma_f32_16x16x32_bf16 v[104:107], a[212:215], v[232:235], v[104:107]
    v_mfma_f32_16x16x32_bf16 v[108:111], a[212:215], v[236:239], v[108:111]
    v_mfma_f32_16x16x32_bf16 v[104:107], a[232:235], v[240:243], v[104:107]
    ds_write_b128 v201, v[96:99] offset:2048
    v_mfma_f32_16x16x32_bf16 v[108:111], a[232:235], v[244:247], v[108:111]
    v_mfma_f32_16x16x32_bf16 v[104:107], a[252:255], v[248:251], v[104:107]
    ds_write_b128 v201, v[100:103] offset:3072
    v_mfma_f32_16x16x32_bf16 v[108:111], a[252:255], v[252:255], v[108:111]
    v_mfma_f32_16x16x32_bf16 v[80:83], a[160:163], v[216:219], v[120:123]
    v_mfma_f32_16x16x32_bf16 v[84:87], a[160:163], v[220:223], v[124:127]
    v_mfma_f32_16x16x32_bf16 v[80:83], a[180:183], v[224:227], v[80:83]
    v_mfma_f32_16x16x32_bf16 v[84:87], a[180:183], v[228:231], v[84:87]
    v_mfma_f32_16x16x32_bf16 v[80:83], a[200:203], v[232:235], v[80:83]
    s_nop 0
    ds_write_b128 v202, v[104:107] offset:4096
    v_mfma_f32_16x16x32_bf16 v[84:87], a[200:203], v[236:239], v[84:87]
    ds_write_b128 v202, v[108:111] offset:5120
    v_mfma_f32_16x16x32_bf16 v[80:83], a[220:223], v[240:243], v[80:83]
    v_mfma_f32_16x16x32_bf16 v[84:87], a[220:223], v[244:247], v[84:87]
    v_mfma_f32_16x16x32_bf16 v[80:83], a[240:243], v[248:251], v[80:83]
    v_mfma_f32_16x16x32_bf16 v[84:87], a[240:243], v[252:255], v[84:87]
    s_waitcnt lgkmcnt(0)
    s_barrier
    s_nop 0
    ds_read_b128 v[88:91], v204 offset:0
    ds_read_b128 v[92:95], v204 offset:1024
    ds_read_b128 v[96:99], v204 offset:2048
    ds_read_b128 v[100:103], v204 offset:3072
    ds_read_b128 v[104:107], v204 offset:4096
    ds_read_b128 v[108:111], v204 offset:5120
    ds_read_b64 v[112:113], v205 offset:24576
    ds_read_b64 v[114:115], v205 offset:26624
    ds_read_b64 v[116:117], v205 offset:28672
    ds_read_b64 v[118:119], v205 offset:30720
    s_mov_b32 s96, 12062720
    buffer_load_dwordx4 v[216:219], v56, s[16:19], s96 offen offset:0 sc1
    buffer_load_dwordx4 v[220:223], v56, s[16:19], s96 offen offset:256 sc1
    s_mov_b32 s96, 12095488
    buffer_load_dwordx4 v[224:227], v56, s[16:19], s96 offen offset:0 sc1
    s_waitcnt lgkmcnt(9)
    v_pk_add_f32 v[80:81], v[80:81], v[88:89]
    v_pk_add_f32 v[82:83], v[82:83], v[90:91]
    s_waitcnt lgkmcnt(8)
    v_pk_add_f32 v[84:85], v[84:85], v[92:93]
    v_pk_add_f32 v[86:87], v[86:87], v[94:95]
    s_waitcnt lgkmcnt(7)
    v_pk_add_f32 v[80:81], v[80:81], v[96:97]
    v_pk_add_f32 v[82:83], v[82:83], v[98:99]
    s_waitcnt lgkmcnt(6)
    v_pk_add_f32 v[84:85], v[84:85], v[100:101]
    v_pk_add_f32 v[86:87], v[86:87], v[102:103]
    s_waitcnt lgkmcnt(5)
    v_pk_add_f32 v[80:81], v[80:81], v[104:105]
    v_pk_add_f32 v[82:83], v[82:83], v[106:107]
    s_waitcnt lgkmcnt(4)
    v_pk_add_f32 v[84:85], v[84:85], v[108:109]
    v_pk_add_f32 v[86:87], v[86:87], v[110:111]
    v_cvt_pk_bf16_f32 v132, v80, v81
    v_cvt_pk_bf16_f32 v133, v82, v83
    v_cvt_pk_bf16_f32 v134, v84, v85
    v_cvt_pk_bf16_f32 v135, v86, v87
    s_waitcnt lgkmcnt(3)
    v_pk_add_f32 v[128:129], v[128:129], v[112:113]
    s_waitcnt lgkmcnt(2)
    v_pk_add_f32 v[128:129], v[128:129], v[114:115]
    s_waitcnt lgkmcnt(1)
    v_pk_add_f32 v[128:129], v[128:129], v[116:117]
    s_waitcnt lgkmcnt(0)
    v_pk_add_f32 v[128:129], v[128:129], v[118:119]
    v_cvt_pk_bf16_f32 v130, v128, v129
    buffer_store_dwordx4 v[132:135], v59, s[16:19], s25 offen sc1
    buffer_store_dword v130, v61, s[16:19], s26 offen sc1
    v_dot2c_f32_bf16 v136, v132, v215
    v_dot2c_f32_bf16 v137, v132, v132
    v_dot2c_f32_bf16 v136, v133, v215
    v_dot2c_f32_bf16 v137, v133, v133
    v_dot2c_f32_bf16 v138, v134, v215
    v_dot2c_f32_bf16 v139, v134, v134
    v_dot2c_f32_bf16 v138, v135, v215
    v_dot2c_f32_bf16 v139, v135, v135
    v_dot2c_f32_bf16 v140, v130, v215
    v_dot2c_f32_bf16 v141, v130, v130
    v_permlane32_swap_b32 v136, v138
    v_permlane32_swap_b32 v137, v139
    v_pk_add_f32 v[136:137], v[136:137], v[138:139]
    v_pk_add_f32 v[136:137], v[136:137], v[140:141]
    s_nop 1
    v_permlane16_swap_b32 v136, v137
    v_add_f32_e64 v136, v136, v137
    ds_write_b32 v206, v136 offset:32768
    buffer_load_dwordx4 v[228:231], v56, s[16:19], s96 offen offset:256 sc1
    s_mov_b32 s96, 12128256
    buffer_load_dwordx4 v[232:235], v56, s[16:19], s96 offen offset:0 sc1
    buffer_load_dwordx4 v[236:239], v56, s[16:19], s96 offen offset:256 sc1
    s_mov_b32 s96, 12161024
    buffer_load_dwordx4 v[240:243], v56, s[16:19], s96 offen offset:0 sc1
    buffer_load_dwordx4 v[244:247], v56, s[16:19], s96 offen offset:256 sc1
    s_mov_b32 s96, 12060672
    buffer_load_dwordx2 v[248:249], v57, s[16:19], s96 offen offset:0 sc1
    buffer_load_dwordx2 v[252:253], v57, s[16:19], s96 offen offset:128 sc1
    s_mov_b32 s96, 12077056
    buffer_load_dwordx2 v[250:251], v57, s[16:19], s96 offen offset:0 sc1
    buffer_load_dwordx2 v[254:255], v57, s[16:19], s96 offen offset:128 sc1
    s_mov_b32 s96, 9439232
    buffer_load_dwordx4 v[208:211], v59, s[16:19], s96 offen sc1
    s_add_u32 s97, s36, 9439232
    buffer_load_dword v212, v61, s[16:19], s97 offen sc1
    s_waitcnt lgkmcnt(0)
    s_barrier
    ds_read2st64_b32 v[136:137], v207 offset0:0 offset1:1
    ds_read2st64_b32 v[138:139], v207 offset0:2 offset1:3
    ds_read_b64_tr_b16 v[144:145], v65 offset:32
    ds_read_b64_tr_b16 v[146:147], v65 offset:0
    ds_read_b64_tr_b16 v[148:149], v65 offset:160
    ds_read_b64_tr_b16 v[150:151], v65 offset:128
    ds_read_b64_tr_b16 v[152:153], v65 offset:288
    ds_read_b64_tr_b16 v[154:155], v65 offset:256
    ds_read_b64_tr_b16 v[156:157], v65 offset:416
    ds_read_b64_tr_b16 v[158:159], v65 offset:384
    ds_read_b64_tr_b16 v[160:161], v65 offset:544
    ds_read_b64_tr_b16 v[162:163], v65 offset:512
    ds_read_b64_tr_b16 v[164:165], v65 offset:672
    ds_read_b64_tr_b16 v[166:167], v65 offset:640
    ds_read_b64_tr_b16 v[168:169], v65 offset:800
    ds_read_b64_tr_b16 v[170:171], v65 offset:768
    ds_read_b64_tr_b16 v[172:173], v65 offset:928
    ds_read_b64_tr_b16 v[174:175], v65 offset:896
    s_waitcnt lgkmcnt(15)
    v_pk_add_f32 v[136:137], v[136:137], v[138:139]
    v_add_f32 v136, v136, v137
    v_cndmask_b32 v136, v136, 1.0, s[28:29]
    s_mov_b64 exec, s[80:81]
    buffer_atomic_add_f32 v136, v214, s[16:19], s27 offen sc1
    s_mov_b64 exec, -1
    v_lshrrev_b32 v176, 4, v0
    v_mul_u32_u24 v176, 1216, v176
    v_and_b32 v177, 15, v0
    v_lshl_add_u32 v176, v177, 3, v176
    v_add_u32 v176, 64, v176
    v_mov_b32 v178, 0
    v_mov_b32 v179, 0
    ds_write_b64 v176, v[178:179]
    v_mov_b32 v70, 0
    v_mov_b32 v71, 0
    v_mov_b32 v72, 0
oe_78:
    s_waitcnt vmcnt(16)
    v_mfma_f32_16x16x32_bf16 v[112:115], a[176:179], v[216:219], 0
    v_mov_b32 v136, 0
    v_mov_b32 v137, 0
    s_waitcnt vmcnt(15)
    v_mfma_f32_16x16x32_bf16 v[116:119], a[176:179], v[220:223], 0
    v_mov_b32 v138, 0
    v_mov_b32 v139, 0
    s_waitcnt vmcnt(14)
    v_mfma_f32_16x16x32_bf16 v[112:115], a[196:199], v[224:227], v[112:115]
    v_mov_b32 v140, 0
    v_mov_b32 v141, 0
    s_waitcnt vmcnt(11)
    v_mfma_f32_16x16x32_bf16 v[116:119], a[196:199], v[228:231], v[116:119]
    s_mov_b32 s25, 14682112
    s_add_u32 s26, s36, 14682112
    s_waitcnt vmcnt(10)
    v_mfma_f32_16x16x32_bf16 v[112:115], a[216:219], v[232:235], v[112:115]
    s_add_u32 s27, s35, 3510272
    s_mov_b32 s28, 0x99999999
    s_waitcnt vmcnt(9)
    v_mfma_f32_16x16x32_bf16 v[116:119], a[216:219], v[236:239], v[116:119]
    s_mov_b32 s29, 0x99999999
    s_waitcnt vmcnt(8)
    v_mfma_f32_16x16x32_bf16 v[112:115], a[236:239], v[240:243], v[112:115]
    s_waitcnt vmcnt(7)
    v_mfma_f32_16x16x32_bf16 v[116:119], a[236:239], v[244:247], v[116:119]
    s_waitcnt vmcnt(4)
    v_mfma_f32_16x16x32_bf16 v[112:115], v[52:55], v[248:251], v[112:115]
    s_waitcnt vmcnt(3)
    v_mfma_f32_16x16x32_bf16 v[116:119], v[52:55], v[252:255], v[116:119]
    v_mfma_f32_16x16x32_bf16 v[88:91], a[164:167], v[216:219], 0
    v_mfma_f32_16x16x32_bf16 v[92:95], a[164:167], v[220:223], 0
    v_mfma_f32_16x16x32_bf16 v[88:91], a[184:187], v[224:227], v[88:91]
    s_waitcnt vmcnt(2)
    v_max3_u32 v132, v208, v209, v210
    s_waitcnt vmcnt(1)
    v_max3_u32 v132, v132, v211, v212
    v_mfma_f32_16x16x32_bf16 v[92:95], a[184:187], v[228:231], v[92:95]
    v_cmp_eq_u32 s[82:83], -1, v132
    v_mfma_f32_16x16x32_bf16 v[88:91], a[204:207], v[232:235], v[88:91]
    v_mfma_f32_16x16x32_bf16 v[92:95], a[204:207], v[236:239], v[92:95]
    v_cmp_u_f32 vcc, v112, v116
    s_nop 0
    s_or_b64 vcc, vcc, s[82:83]
    s_cbranch_vccnz rd_79
rc_80:
    v_mfma_f32_16x16x32_bf16 v[88:91], a[224:227], v[240:243], v[88:91]
    ds_write_b128 v203, v[112:115] offset:24576
    v_mfma_f32_16x16x32_bf16 v[92:95], a[224:227], v[244:247], v[92:95]
    v_mfma_f32_16x16x32_bf16 v[88:91], a[244:247], v[248:251], v[88:91]
    ds_write_b128 v203, v[116:119] offset:25600
    v_mfma_f32_16x16x32_bf16 v[92:95], a[244:247], v[252:255], v[92:95]
    v_mfma_f32_16x16x32_bf16 v[96:99], a[168:171], v[216:219], 0
    v_lshlrev_b32_e64 v120, 16, v208
    v_and_b32 v121, 0xffff0000, v208
    v_mfma_f32_16x16x32_bf16 v[100:103], a[168:171], v[220:223], 0
    v_lshlrev_b32_e64 v122, 16, v209
    v_and_b32 v123, 0xffff0000, v209
    v_mfma_f32_16x16x32_bf16 v[96:99], a[188:191], v[224:227], v[96:99]
    v_lshlrev_b32_e64 v124, 16, v210
    v_and_b32 v125, 0xffff0000, v210
    v_mfma_f32_16x16x32_bf16 v[100:103], a[188:191], v[228:231], v[100:103]
    v_lshlrev_b32_e64 v126, 16, v211
    v_and_b32 v127, 0xffff0000, v211
    v_mfma_f32_16x16x32_bf16 v[96:99], a[208:211], v[232:235], v[96:99]
    v_lshlrev_b32_e64 v128, 16, v212
    v_and_b32 v129, 0xffff0000, v212
    v_mfma_f32_16x16x32_bf16 v[100:103], a[208:211], v[236:239], v[100:103]
    v_mfma_f32_16x16x32_bf16 v[96:99], a[228:231], v[240:243], v[96:99]
    ds_write_b128 v200, v[88:91] offset:0
    v_mfma_f32_16x16x32_bf16 v[100:103], a[228:231], v[244:247], v[100:103]
    v_mfma_f32_16x16x32_bf16 v[96:99], a[248:251], v[248:251], v[96:99]
    ds_write_b128 v200, v[92:95] offset:1024
    v_mfma_f32_16x16x32_bf16 v[100:103], a[248:251], v[252:255], v[100:103]
    v_mfma_f32_16x16x32_bf16 v[104:107], a[172:175], v[216:219], 0
    v_mfma_f32_16x16x32_bf16 v[108:111], a[172:175], v[220:223], 0
    v_mfma_f32_16x16x32_bf16 v[104:107], a[192:195], v[224:227], v[104:107]
    v_mfma_f32_16x16x32_bf16 v[108:111], a[192:195], v[228:231], v[108:111]
    v_mfma_f32_16x16x32_bf16 v[104:107], a[212:215], v[232:235], v[104:107]
    v_mfma_f32_16x16x32_bf16 v[108:111], a[212:215], v[236:239], v[108:111]
    v_mfma_f32_16x16x32_bf16 v[104:107], a[232:235], v[240:243], v[104:107]
    ds_write_b128 v201, v[96:99] offset:2048
    v_mfma_f32_16x16x32_bf16 v[108:111], a[232:235], v[244:247], v[108:111]
    v_mfma_f32_16x16x32_bf16 v[104:107], a[252:255], v[248:251], v[104:107]
    ds_write_b128 v201, v[100:103] offset:3072
    v_mfma_f32_16x16x32_bf16 v[108:111], a[252:255], v[252:255], v[108:111]
    v_mfma_f32_16x16x32_bf16 v[80:83], a[160:163], v[216:219], v[120:123]
    v_mfma_f32_16x16x32_bf16 v[84:87], a[160:163], v[220:223], v[124:127]
    v_mfma_f32_16x16x32_bf16 v[80:83], a[180:183], v[224:227], v[80:83]
    v_mfma_f32_16x16x32_bf16 v[84:87], a[180:183], v[228:231], v[84:87]
    v_mfma_f32_16x16x32_bf16 v[80:83], a[200:203], v[232:235], v[80:83]
    s_nop 0
    ds_write_b128 v202, v[104:107] offset:4096
    v_mfma_f32_16x16x32_bf16 v[84:87], a[200:203], v[236:239], v[84:87]
    ds_write_b128 v202, v[108:111] offset:5120
    v_mfma_f32_16x16x32_bf16 v[80:83], a[220:223], v[240:243], v[80:83]
    v_mfma_f32_16x16x32_bf16 v[84:87], a[220:223], v[244:247], v[84:87]
    v_mfma_f32_16x16x32_bf16 v[80:83], a[240:243], v[248:251], v[80:83]
    v_mfma_f32_16x16x32_bf16 v[84:87], a[240:243], v[252:255], v[84:87]
    s_waitcnt lgkmcnt(0)
    s_barrier
    s_nop 0
    ds_read_b128 v[88:91], v204 offset:0
    ds_read_b128 v[92:95], v204 offset:1024
    ds_read_b128 v[96:99], v204 offset:2048
    ds_read_b128 v[100:103], v204 offset:3072
    ds_read_b128 v[104:107], v204 offset:4096
    ds_read_b128 v[108:111], v204 offset:5120
    ds_read_b64 v[112:113], v205 offset:24576
    ds_read_b64 v[114:115], v205 offset:26624
    ds_read_b64 v[116:117], v205 offset:28672
    ds_read_b64 v[118:119], v205 offset:30720
    s_lshl_b32 s96, s75, 14
    s_add_u32 s96, s96, 14680064
    s_lshl_b32 s97, s24, 12
    s_add_u32 s97, s97, 3506176
    buffer_load_dwordx4 v[176:179], v62, s[16:19], s96 offen offset:0 sc1
    buffer_load_dwordx4 v[180:183], v62, s[16:19], s96 offen offset:1024 sc1
    buffer_load_dwordx4 v[184:187], v62, s[16:19], s97 offen offset:0 sc1
    buffer_load_dwordx4 v[188:191], v62, s[16:19], s97 offen offset:1024 sc1
    buffer_load_dwordx4 v[192:195], v62, s[16:19], s97 offen offset:2048 sc1
    buffer_load_dwordx4 v[196:199], v62, s[16:19], s97 offen offset:3072 sc1
    s_waitcnt lgkmcnt(9)
    v_pk_add_f32 v[80:81], v[80:81], v[88:89]
    v_pk_add_f32 v[82:83], v[82:83], v[90:91]
    s_waitcnt lgkmcnt(8)
    v_pk_add_f32 v[84:85], v[84:85], v[92:93]
    v_pk_add_f32 v[86:87], v[86:87], v[94:95]
    s_waitcnt lgkmcnt(7)
    v_pk_add_f32 v[80:81], v[80:81], v[96:97]
    v_pk_add_f32 v[82:83], v[82:83], v[98:99]
    s_waitcnt lgkmcnt(6)
    v_pk_add_f32 v[84:85], v[84:85], v[100:101]
    v_pk_add_f32 v[86:87], v[86:87], v[102:103]
    s_waitcnt lgkmcnt(5)
    v_pk_add_f32 v[80:81], v[80:81], v[104:105]
    v_pk_add_f32 v[82:83], v[82:83], v[106:107]
    s_waitcnt lgkmcnt(4)
    v_pk_add_f32 v[84:85], v[84:85], v[108:109]
    v_pk_add_f32 v[86:87], v[86:87], v[110:111]
    v_cvt_pk_bf16_f32 v132, v80, v81
    v_cvt_pk_bf16_f32 v133, v82, v83
    v_cvt_pk_bf16_f32 v134, v84, v85
    v_cvt_pk_bf16_f32 v135, v86, v87
    s_waitcnt lgkmcnt(3)
    v_pk_add_f32 v[128:129], v[128:129], v[112:113]
    s_waitcnt lgkmcnt(2)
    v_pk_add_f32 v[128:129], v[128:129], v[114:115]
    s_waitcnt lgkmcnt(1)
    v_pk_add_f32 v[128:129], v[128:129], v[116:117]
    s_waitcnt lgkmcnt(0)
    v_pk_add_f32 v[128:129], v[128:129], v[118:119]
    v_cvt_pk_bf16_f32 v130, v128, v129
    buffer_store_dwordx4 v[132:135], v59, s[16:19], s25 offen sc1
    buffer_store_dword v130, v61, s[16:19], s26 offen sc1
    v_dot2c_f32_bf16 v136, v132, v215
    v_dot2c_f32_bf16 v137, v132, v132
    v_dot2c_f32_bf16 v136, v133, v215
    v_dot2c_f32_bf16 v137, v133, v133
    v_dot2c_f32_bf16 v138, v134, v215
    v_dot2c_f32_bf16 v139, v134, v134
    v_dot2c_f32_bf16 v138, v135, v215
    v_dot2c_f32_bf16 v139, v135, v135
    v_dot2c_f32_bf16 v140, v130, v215
    v_dot2c_f32_bf16 v141, v130, v130
    v_permlane32_swap_b32 v136, v138
    v_permlane32_swap_b32 v137, v139
    v_pk_add_f32 v[136:137], v[136:137], v[138:139]
    v_pk_add_f32 v[136:137], v[136:137], v[140:141]
    s_nop 1
    v_permlane16_swap_b32 v136, v137
    v_add_f32 v136, v136, v137
    ds_write_b32 v206, v136 offset:32768
    s_waitcnt lgkmcnt(0)
    s_barrier
    ds_read2st64_b32 v[136:137], v207 offset0:0 offset1:1
    ds_read2st64_b32 v[138:139], v207 offset0:2 offset1:3
    s_waitcnt lgkmcnt(0)
    v_pk_add_f32 v[136:137], v[136:137], v[138:139]
    v_add_f32 v136, v136, v137
    v_cndmask_b32 v136, v136, 1.0, s[28:29]
    s_mov_b64 exec, s[80:81]
    buffer_atomic_add_f32 v136, v214, s[16:19], s27 offen sc1
    s_mov_b64 exec, -1
    s_cmp_ge_u32 s2, 160
    s_cbranch_scc1 nc_81
    s_waitcnt vmcnt(3)
ce_83:
    v_max3_u32 v208, v176, v177, v178
    v_max3_u32 v208, v208, v179, v180
    v_max3_u32 v208, v208, v181, v182
    v_max_u32 v208, v208, v183
    v_cmp_eq_u32 s[82:83], -1, v208
    v_min3_f32 v209, v184, v187, v188
    v_min3_f32 v209, v209, v191, v192
    v_min3_f32 v209, v209, v195, v196
    v_min_f32 v209, v209, v199
    v_cmp_neq_f32 vcc, 0x41000000, v209
    s_nop 0
    s_or_b64 vcc, vcc, s[82:83]
    s_cbranch_vccnz rd_84
rc_85:
    v_mul_f32 v208, 0x3acccccd, v185
    v_mul_f32 v209, 0x3acccccd, v189
    v_mul_f32 v186, 0x3acccccd, v186
    v_mul_f32 v190, 0x3acccccd, v190
    v_fma_f32 v186, -v208, v208, v186
    v_fma_f32 v190, -v209, v209, v190
    v_max_f32 v186, 0, v186
    v_max_f32 v190, 0, v190
    v_add_f32 v186, 0x3727c5ac, v186
    v_add_f32 v190, 0x3727c5ac, v190
    v_rsq_f32 v185, v186
    v_rsq_f32 v189, v190
    v_mul_f32 v186, -v208, v185
    v_mul_f32 v190, -v209, v189
    v_lshlrev_b32 v80, 16, v176
    v_and_b32 v82, 0xffff0000, v176
    v_lshlrev_b32 v84, 16, v177
    v_and_b32 v86, 0xffff0000, v177
    v_lshlrev_b32 v81, 16, v178
    v_and_b32 v83, 0xffff0000, v178
    v_lshlrev_b32 v85, 16, v179
    v_and_b32 v87, 0xffff0000, v179
    v_fma_f32 v208, v80, v185, v186
    v_fma_f32 v209, v81, v189, v190
    v_cvt_pk_bf16_f32 v176, v208, v209
    v_fma_f32 v208, v82, v185, v186
    v_fma_f32 v209, v83, v189, v190
    v_cvt_pk_bf16_f32 v177, v208, v209
    v_fma_f32 v208, v84, v185, v186
    v_fma_f32 v209, v85, v189, v190
    v_cvt_pk_bf16_f32 v178, v208, v209
    v_fma_f32 v208, v86, v185, v186
    v_fma_f32 v209, v87, v189, v190
    v_cvt_pk_bf16_f32 v179, v208, v209
    ds_write_b32 v63, v176 offset:0
    ds_write_b32 v63, v177 offset:4864
    ds_write_b32 v63, v178 offset:9728
    ds_write_b32 v63, v179 offset:14592
    v_mul_f32 v208, 0x3acccccd, v193
    v_mul_f32 v209, 0x3acccccd, v197
    v_mul_f32 v194, 0x3acccccd, v194
    v_mul_f32 v198, 0x3acccccd, v198
    v_fma_f32 v194, -v208, v208, v194
    v_fma_f32 v198, -v209, v209, v198
    v_max_f32 v194, 0, v194
    v_max_f32 v198, 0, v198
    v_add_f32 v194, 0x3727c5ac, v194
    v_add_f32 v198, 0x3727c5ac, v198
    v_rsq_f32 v193, v194
    v_rsq_f32 v197, v198
    v_mul_f32 v194, -v208, v193
    v_mul_f32 v198, -v209, v197
    v_lshlrev_b32 v88, 16, v180
    v_and_b32 v90, 0xffff0000, v180
    v_lshlrev_b32 v92, 16, v181
    v_and_b32 v94, 0xffff0000, v181
    v_lshlrev_b32 v89, 16, v182
    v_and_b32 v91, 0xffff0000, v182
    v_lshlrev_b32 v93, 16, v183
    v_and_b32 v95, 0xffff0000, v183
    v_fma_f32 v208, v88, v193, v194
    v_fma_f32 v209, v89, v197, v198
    v_cvt_pk_bf16_f32 v180, v208, v209
    v_fma_f32 v208, v90, v193, v194
    v_fma_f32 v209, v91, v197, v198
    v_cvt_pk_bf16_f32 v181, v208, v209
    v_fma_f32 v208, v92, v193, v194
    v_fma_f32 v209, v93, v197, v198
    v_cvt_pk_bf16_f32 v182, v208, v209
    v_fma_f32 v208, v94, v193, v194
    v_fma_f32 v209, v95, v197, v198
    v_cvt_pk_bf16_f32 v183, v208, v209
    ds_write_b32 v63, v180 offset:256
    ds_write_b32 v63, v181 offset:5120
    ds_write_b32 v63, v182 offset:9984
    ds_write_b32 v63, v183 offset:14848
    s_waitcnt lgkmcnt(0)
    s_barrier
    ds_read_b128 v[212:215], v64 offset:96
    ds_read_b128 v[216:219], v64 offset:64
    ds_read_b128 v[220:223], v64 offset:32
    ds_read_b128 v[224:227], v64 offset:0
    s_waitcnt lgkmcnt(3)
    v_mfma_f32_32x32x16_bf16 v[96:111], v[212:215], v[144:147], 0
    ds_read_b128 v[228:231], v64 offset:224
    ds_read_b64_tr_b16 v[176:177], v65 offset:1056
    ds_read_b64_tr_b16 v[178:179], v65 offset:1024
    ds_read_b64_tr_b16 v[180:181], v65 offset:1184
    ds_read_b64_tr_b16 v[182:183], v65 offset:1152
    s_waitcnt lgkmcnt(7)
    v_mfma_f32_32x32x16_bf16 v[96:111], v[216:219], v[148:151], v[96:111]
    ds_read_b128 v[232:235], v64 offset:192
    ds_read_b64_tr_b16 v[184:185], v65 offset:1312
    ds_read_b64_tr_b16 v[186:187], v65 offset:1280
    ds_read_b64_tr_b16 v[188:189], v65 offset:1440
    ds_read_b64_tr_b16 v[190:191], v65 offset:1408
    s_waitcnt lgkmcnt(11)
    v_mfma_f32_32x32x16_bf16 v[96:111], v[220:223], v[152:155], v[96:111]
    ds_read_b128 v[236:239], v64 offset:160
    ds_read_b64_tr_b16 v[192:193], v65 offset:1568
    ds_read_b64_tr_b16 v[194:195], v65 offset:1536
    ds_read_b64_tr_b16 v[196:197], v65 offset:1696
    ds_read_b64_tr_b16 v[198:199], v65 offset:1664
    s_waitcnt lgkmcnt(15)
    v_mfma_f32_32x32x16_bf16 v[96:111], v[224:227], v[156:159], v[96:111]
    ds_read_b128 v[240:243], v64 offset:128
    ds_read_b64_tr_b16 v[200:201], v65 offset:1824
    ds_read_b64_tr_b16 v[202:203], v65 offset:1792
    ds_read_b64_tr_b16 v[204:205], v65 offset:1952
    ds_read_b64_tr_b16 v[206:207], v65 offset:1920
    s_waitcnt lgkmcnt(15)
    v_mfma_f32_32x32x16_bf16 v[112:127], v[228:231], v[144:147], 0
    s_nop 4
    s_waitcnt lgkmcnt(14)
    v_mfma_f32_32x32x16_bf16 v[112:127], v[232:235], v[148:151], v[112:127]
    v_cndmask_b32 v208, v99, v72, s[76:77]
    v_cndmask_b32 v209, v103, v99, s[76:77]
    v_cndmask_b32 v210, v107, v103, s[76:77]
    v_cndmask_b32 v211, v111, v107, s[76:77]
    v_mov_b32_e64 v72, v111
    s_waitcnt lgkmcnt(9)
    v_mfma_f32_32x32x16_bf16 v[112:127], v[236:239], v[152:155], v[112:127]
    v_add_f32_dpp v98, v208, v98 wave_ror:1 row_mask:0xf bank_mask:0xf
    v_add_f32_dpp v102, v209, v102 wave_ror:1 row_mask:0xf bank_mask:0xf
    v_add_f32_dpp v106, v210, v106 wave_ror:1 row_mask:0xf bank_mask:0xf
    v_add_f32_dpp v110, v211, v110 wave_ror:1 row_mask:0xf bank_mask:0xf
    v_cndmask_b32 v208, v98, v71, s[76:77]
    s_waitcnt lgkmcnt(4)
    v_mfma_f32_32x32x16_bf16 v[112:127], v[240:243], v[156:159], v[112:127]
    v_cndmask_b32 v209, v102, v98, s[76:77]
    v_cndmask_b32 v210, v106, v102, s[76:77]
    v_cndmask_b32 v211, v110, v106, s[76:77]
    v_mov_b32 v71, v110
    v_add_f32_dpp v97, v208, v97 wave_ror:1 row_mask:0xf bank_mask:0xf
    v_add_f32_dpp v101, v209, v101 wave_ror:1 row_mask:0xf bank_mask:0xf
    v_mfma_f32_32x32x16_bf16 v[112:127], v[212:215], v[160:163], v[112:127]
    ds_read_b128 v[244:247], v64 offset:352
    v_add_f32_dpp v105, v210, v105 wave_ror:1 row_mask:0xf bank_mask:0xf
    v_add_f32_dpp v109, v211, v109 wave_ror:1 row_mask:0xf bank_mask:0xf
    v_cndmask_b32 v208, v97, v70, s[76:77]
    v_cndmask_b32 v209, v101, v97, s[76:77]
    v_cndmask_b32 v210, v105, v101, s[76:77]
    v_mfma_f32_32x32x16_bf16 v[112:127], v[216:219], v[164:167], v[112:127]
    ds_read_b128 v[216:219], v64 offset:320
    v_cndmask_b32 v211, v109, v105, s[76:77]
    v_mov_b32_e64 v70, v109
    v_add_f32_dpp v96, v208, v96 wave_ror:1 row_mask:0xf bank_mask:0xf
    v_add_f32_dpp v100, v209, v100 wave_ror:1 row_mask:0xf bank_mask:0xf
    v_add_f32_dpp v104, v210, v104 wave_ror:1 row_mask:0xf bank_mask:0xf
    v_mfma_f32_32x32x16_bf16 v[112:127], v[220:223], v[168:171], v[112:127]
    ds_read_b128 v[220:223], v64 offset:288
    v_add_f32_dpp v108, v211, v108 wave_ror:1 row_mask:0xf bank_mask:0xf
    ds_write_b32 v66, v96 offset:0
    v_mfma_f32_32x32x16_bf16 v[112:127], v[224:227], v[172:175], v[112:127]
    ds_read_b128 v[224:227], v64 offset:256
    ds_write_b32 v66, v100 offset:64
    ds_write_b32 v66, v104 offset:128
    s_waitcnt lgkmcnt(6)
    v_mfma_f32_32x32x16_bf16 v[128:143], v[244:247], v[144:147], 0
    ds_write_b32 v66, v108 offset:192
    s_nop 2
    s_waitcnt lgkmcnt(6)
    v_mfma_f32_32x32x16_bf16 v[128:143], v[216:219], v[148:151], v[128:143]
    s_nop 2
    v_cndmask_b32 v208, v115, v72, s[76:77]
    v_cndmask_b32 v209, v119, v115, s[76:77]
    s_waitcnt lgkmcnt(5)
    v_mfma_f32_32x32x16_bf16 v[128:143], v[220:223], v[152:155], v[128:143]
    v_cndmask_b32 v210, v123, v119, s[76:77]
    v_cndmask_b32 v211, v127, v123, s[76:77]
    v_mov_b32 v72, v127
    v_add_f32_dpp v114, v208, v114 wave_ror:1 row_mask:0xf bank_mask:0xf
    v_add_f32_dpp v118, v209, v118 wave_ror:1 row_mask:0xf bank_mask:0xf
    s_waitcnt lgkmcnt(3)
    v_mfma_f32_32x32x16_bf16 v[128:143], v[224:227], v[156:159], v[128:143]
    v_add_f32_dpp v122, v210, v122 wave_ror:1 row_mask:0xf bank_mask:0xf
    v_add_f32_dpp v126, v211, v126 wave_ror:1 row_mask:0xf bank_mask:0xf
    v_cndmask_b32 v208, v114, v71, s[76:77]
    v_cndmask_b32 v209, v118, v114, s[76:77]
    v_cndmask_b32 v210, v122, v118, s[76:77]
    v_cndmask_b32 v211, v126, v122, s[76:77]
    v_mfma_f32_32x32x16_bf16 v[128:143], v[228:231], v[160:163], v[128:143]
    v_mov_b32 v71, v126
    v_add_f32_dpp v113, v208, v113 wave_ror:1 row_mask:0xf bank_mask:0xf
    v_add_f32_dpp v117, v209, v117 wave_ror:1 row_mask:0xf bank_mask:0xf
    v_add_f32_dpp v121, v210, v121 wave_ror:1 row_mask:0xf bank_mask:0xf
    v_add_f32_dpp v125, v211, v125 wave_ror:1 row_mask:0xf bank_mask:0xf
    v_cndmask_b32 v208, v113, v70, s[76:77]
    v_mfma_f32_32x32x16_bf16 v[128:143], v[232:235], v[164:167], v[128:143]
    ds_read_b128 v[232:235], v64 offset:64
    v_cndmask_b32 v209, v117, v113, s[76:77]
    v_cndmask_b32 v210, v121, v117, s[76:77]
    v_cndmask_b32 v211, v125, v121, s[76:77]
    v_mov_b32_e64 v70, v125
    v_add_f32_dpp v112, v208, v112 wave_ror:1 row_mask:0xf bank_mask:0xf
    v_mfma_f32_32x32x16_bf16 v[128:143], v[236:239], v[168:171], v[128:143]
    ds_read_b128 v[236:239], v64 offset:32
    v_add_f32_dpp v116, v209, v116 wave_ror:1 row_mask:0xf bank_mask:0xf
    v_add_f32_dpp v120, v210, v120 wave_ror:1 row_mask:0xf bank_mask:0xf
    v_add_f32_dpp v124, v211, v124 wave_ror:1 row_mask:0xf bank_mask:0xf
    v_mfma_f32_32x32x16_bf16 v[128:143], v[240:243], v[172:175], v[128:143]
    ds_read_b128 v[240:243], v64 offset:0
    ds_write_b32 v66, v112 offset:256
    ds_write_b32 v66, v116 offset:320
    v_mfma_f32_32x32x16_bf16 v[128:143], v[212:215], v[176:179], v[128:143]
    ds_read_b128 v[212:215], v64 offset:480
    ds_write_b32 v66, v120 offset:384
    ds_write_b32 v66, v124 offset:448
    s_waitcnt lgkmcnt(7)
    v_mfma_f32_32x32x16_bf16 v[128:143], v[232:235], v[180:183], v[128:143]
    ds_read_b128 v[232:235], v64 offset:448
    s_waitcnt lgkmcnt(7)
    v_mfma_f32_32x32x16_bf16 v[128:143], v[236:239], v[184:187], v[128:143]
    ds_read_b128 v[236:239], v64 offset:416
    s_waitcnt lgkmcnt(7)
    v_mfma_f32_32x32x16_bf16 v[128:143], v[240:243], v[188:191], v[128:143]
    ds_read_b128 v[240:243], v64 offset:384
    s_nop 3
    s_waitcnt lgkmcnt(5)
    v_mfma_f32_32x32x16_bf16 v[112:127], v[212:215], v[144:147], 0
    s_nop 4
    s_waitcnt lgkmcnt(2)
    v_mfma_f32_32x32x16_bf16 v[112:127], v[232:235], v[148:151], v[112:127]
    v_cndmask_b32 v208, v131, v72, s[76:77]
    v_cndmask_b32 v209, v135, v131, s[76:77]
    v_cndmask_b32 v210, v139, v135, s[76:77]
    v_cndmask_b32 v211, v143, v139, s[76:77]
    v_mov_b32_e64 v72, v143
    s_waitcnt lgkmcnt(1)
    v_mfma_f32_32x32x16_bf16 v[112:127], v[236:239], v[152:155], v[112:127]
    v_add_f32_dpp v130, v208, v130 wave_ror:1 row_mask:0xf bank_mask:0xf
    v_add_f32_dpp v134, v209, v134 wave_ror:1 row_mask:0xf bank_mask:0xf
    v_add_f32_dpp v138, v210, v138 wave_ror:1 row_mask:0xf bank_mask:0xf
    v_add_f32_dpp v142, v211, v142 wave_ror:1 row_mask:0xf bank_mask:0xf
    v_cndmask_b32 v208, v130, v71, s[76:77]
    s_waitcnt lgkmcnt(0)
    v_mfma_f32_32x32x16_bf16 v[112:127], v[240:243], v[156:159], v[112:127]
    v_cndmask_b32 v209, v134, v130, s[76:77]
    v_cndmask_b32 v210, v138, v134, s[76:77]
    v_cndmask_b32 v211, v142, v138, s[76:77]
    v_mov_b32 v71, v142
    v_add_f32_dpp v129, v208, v129 wave_ror:1 row_mask:0xf bank_mask:0xf
    v_add_f32_dpp v133, v209, v133 wave_ror:1 row_mask:0xf bank_mask:0xf
    v_mfma_f32_32x32x16_bf16 v[112:127], v[244:247], v[160:163], v[112:127]
    v_add_f32_dpp v137, v210, v137 wave_ror:1 row_mask:0xf bank_mask:0xf
    v_add_f32_dpp v141, v211, v141 wave_ror:1 row_mask:0xf bank_mask:0xf
    v_cndmask_b32 v208, v129, v70, s[76:77]
    v_cndmask_b32 v209, v133, v129, s[76:77]
    v_cndmask_b32 v210, v137, v133, s[76:77]
    v_cndmask_b32 v211, v141, v137, s[76:77]
    v_mfma_f32_32x32x16_bf16 v[112:127], v[216:219], v[164:167], v[112:127]
    ds_read_b128 v[240:243], v64 offset:192
    v_mov_b32_e64 v70, v141
    v_add_f32_dpp v128, v208, v128 wave_ror:1 row_mask:0xf bank_mask:0xf
    v_add_f32_dpp v132, v209, v132 wave_ror:1 row_mask:0xf bank_mask:0xf
    v_add_f32_dpp v136, v210, v136 wave_ror:1 row_mask:0xf bank_mask:0xf
    v_add_f32_dpp v140, v211, v140 wave_ror:1 row_mask:0xf bank_mask:0xf
    v_mfma_f32_32x32x16_bf16 v[112:127], v[220:223], v[168:171], v[112:127]
    ds_read_b128 v[220:223], v64 offset:160
    ds_write_b32 v66, v128 offset:512
    ds_write_b32 v66, v132 offset:576
    v_mfma_f32_32x32x16_bf16 v[112:127], v[224:227], v[172:175], v[112:127]
    ds_read_b128 v[224:227], v64 offset:128
    ds_write_b32 v66, v136 offset:640
    ds_write_b32 v66, v140 offset:704
    v_mfma_f32_32x32x16_bf16 v[112:127], v[228:231], v[176:179], v[112:127]
    ds_read_b128 v[236:239], v64 offset:96
    s_waitcnt lgkmcnt(7)
    v_mfma_f32_32x32x16_bf16 v[112:127], v[240:243], v[180:183], v[112:127]
    ds_read_b128 v[240:243], v64 offset:64
    s_waitcnt lgkmcnt(7)
    v_mfma_f32_32x32x16_bf16 v[112:127], v[220:223], v[184:187], v[112:127]
    ds_read_b128 v[220:223], v64 offset:32
    s_waitcnt lgkmcnt(5)
    v_mfma_f32_32x32x16_bf16 v[112:127], v[224:227], v[188:191], v[112:127]
    ds_read_b128 v[224:227], v64 offset:0
    s_waitcnt lgkmcnt(3)
    v_mfma_f32_32x32x16_bf16 v[112:127], v[236:239], v[192:195], v[112:127]
    ds_read_b64_tr_b16 v[216:217], v65 offset:544
    ds_read_b64_tr_b16 v[218:219], v65 offset:512
    s_waitcnt lgkmcnt(4)
    v_mfma_f32_32x32x16_bf16 v[112:127], v[240:243], v[196:199], v[112:127]
    ds_read_b64_tr_b16 v[240:241], v65 offset:1056
    ds_read_b64_tr_b16 v[242:243], v65 offset:1024
    s_waitcnt lgkmcnt(5)
    v_mfma_f32_32x32x16_bf16 v[112:127], v[220:223], v[200:203], v[112:127]
    s_waitcnt lgkmcnt(4)
    v_mfma_f32_32x32x16_bf16 v[112:127], v[224:227], v[204:207], v[112:127]
    ds_read_b64_tr_b16 v[224:225], v65 offset:1568
    ds_read_b64_tr_b16 v[226:227], v65 offset:1536
    s_lshl_b32 s96, s75, 14
    s_add_u32 s96, s96, 14680064
    s_lshl_b32 s97, s24, 12
    s_add_u32 s97, s97, 3510272
    buffer_load_dwordx4 v[248:251], v62, s[16:19], s96 offen offset:2048 sc1
    s_waitcnt lgkmcnt(4)
    v_mfma_f32_32x32x16_bf16 v[144:159], v[212:215], v[216:219], 0
    s_nop 3
    v_cndmask_b32 v208, v115, v72, s[76:77]
    s_waitcnt lgkmcnt(2)
    v_mfma_f32_32x32x16_bf16 v[144:159], v[244:247], v[240:243], v[144:159]
    buffer_load_dwordx4 v[252:255], v62, s[16:19], s96 offen offset:3072 sc1
    v_cndmask_b32 v209, v119, v115, s[76:77]
    v_cndmask_b32 v210, v123, v119, s[76:77]
    v_cndmask_b32 v211, v127, v123, s[76:77]
    v_mov_b32_e64 v72, v127
    v_add_f32_dpp v114, v208, v114 wave_ror:1 row_mask:0xf bank_mask:0xf
    v_mfma_f32_32x32x16_bf16 v[160:175], v[212:215], v[240:243], 0
    ds_read_b64_tr_b16 v[216:217], v65 offset:2080
    ds_read_b64_tr_b16 v[218:219], v65 offset:2048
    v_add_f32_dpp v118, v209, v118 wave_ror:1 row_mask:0xf bank_mask:0xf
    v_add_f32_dpp v122, v210, v122 wave_ror:1 row_mask:0xf bank_mask:0xf
    v_add_f32_dpp v126, v211, v126 wave_ror:1 row_mask:0xf bank_mask:0xf
    s_waitcnt lgkmcnt(2)
    v_mfma_f32_32x32x16_bf16 v[144:159], v[228:231], v[224:227], v[144:159]
    buffer_load_dwordx4 v[96:99], v62, s[16:19], s97 offen offset:0 sc1
    v_cndmask_b32 v208, v114, v71, s[76:77]
    v_cndmask_b32 v209, v118, v114, s[76:77]
    v_cndmask_b32 v210, v122, v118, s[76:77]
    v_cndmask_b32 v211, v126, v122, s[76:77]
    v_mov_b32 v71, v126
    v_mfma_f32_32x32x16_bf16 v[160:175], v[244:247], v[224:227], v[160:175]
    v_add_f32_dpp v113, v208, v113 wave_ror:1 row_mask:0xf bank_mask:0xf
    v_add_f32_dpp v117, v209, v117 wave_ror:1 row_mask:0xf bank_mask:0xf
    v_add_f32_dpp v121, v210, v121 wave_ror:1 row_mask:0xf bank_mask:0xf
    v_add_f32_dpp v125, v211, v125 wave_ror:1 row_mask:0xf bank_mask:0xf
    v_cndmask_b32 v208, v113, v70, s[76:77]
    v_cndmask_b32 v209, v117, v113, s[76:77]
    v_mfma_f32_32x32x16_bf16 v[176:191], v[212:215], v[224:227], 0
    buffer_load_dwordx4 v[100:103], v62, s[16:19], s97 offen offset:1024 sc1
    v_cndmask_b32 v210, v121, v117, s[76:77]
    v_cndmask_b32 v211, v125, v121, s[76:77]
    v_mov_b32 v70, v125
    v_add_f32_dpp v112, v208, v112 wave_ror:1 row_mask:0xf bank_mask:0xf
    s_waitcnt lgkmcnt(0)
    v_mfma_f32_32x32x16_bf16 v[144:159], v[236:239], v[216:219], v[144:159]
    ds_read_b64_tr_b16 v[240:241], v65 offset:2592
    ds_read_b64_tr_b16 v[242:243], v65 offset:2560
    v_add_f32_dpp v116, v209, v116 wave_ror:1 row_mask:0xf bank_mask:0xf
    v_add_f32_dpp v120, v210, v120 wave_ror:1 row_mask:0xf bank_mask:0xf
    v_add_f32_dpp v124, v211, v124 wave_ror:1 row_mask:0xf bank_mask:0xf
    v_mfma_f32_32x32x16_bf16 v[160:175], v[228:231], v[216:219], v[160:175]
    buffer_load_dwordx4 v[104:107], v62, s[16:19], s97 offen offset:2048 sc1
    ds_write_b32 v66, v112 offset:768
    ds_write_b32 v66, v116 offset:832
    v_mfma_f32_32x32x16_bf16 v[176:191], v[244:247], v[216:219], v[176:191]
    ds_write_b32 v66, v120 offset:896
    ds_write_b32 v66, v124 offset:960
    v_mfma_f32_32x32x16_bf16 v[192:207], v[212:215], v[216:219], 0
    ds_read_b64_tr_b16 v[212:213], v65 offset:3104
    ds_read_b64_tr_b16 v[214:215], v65 offset:3072
    buffer_load_dwordx4 v[108:111], v62, s[16:19], s97 offen offset:3072 sc1
    s_waitcnt lgkmcnt(6)
    v_mfma_f32_32x32x16_bf16 v[160:175], v[236:239], v[240:243], v[160:175]
    v_mfma_f32_32x32x16_bf16 v[176:191], v[228:231], v[240:243], v[176:191]
    ds_read_b64_tr_b16 v[224:225], v65 offset:3616
    ds_read_b64_tr_b16 v[226:227], v65 offset:3584
    s_waitcnt lgkmcnt(4)
    s_barrier
    v_mfma_f32_32x32x16_bf16 v[192:207], v[244:247], v[240:243], v[192:207]
    ds_read_b64_tr_b16 v[244:245], v65 offset:672
    ds_read_b64_tr_b16 v[246:247], v65 offset:640
    ds_read_b64 v[112:113], v67 offset:0
    ds_read_b64 v[114:115], v67 offset:4224
    ds_read_b64 v[116:117], v67 offset:8448
    s_waitcnt lgkmcnt(7)
    v_mfma_f32_32x32x16_bf16 v[176:191], v[236:239], v[212:215], v[176:191]
    ds_read_b128 v[216:219], v64 offset:320
    ds_read_b64_tr_b16 v[240:241], v65 offset:1184
    ds_read_b64_tr_b16 v[242:243], v65 offset:1152
    ds_read_b64 v[118:119], v67 offset:12672
    ds_read_b64 v[120:121], v67 offset:512
    ds_read_b64 v[122:123], v67 offset:4736
    v_mfma_f32_32x32x16_bf16 v[192:207], v[228:231], v[212:215], v[192:207]
    ds_read_b64 v[124:125], v67 offset:8960
    ds_read_b64 v[126:127], v67 offset:13184
    s_waitcnt lgkmcnt(13)
    v_mfma_f32_32x32x16_bf16 v[192:207], v[236:239], v[224:227], v[192:207]
    ds_read_b128 v[228:231], v64 offset:192
    ds_read_b64_tr_b16 v[236:237], v65 offset:1696
    ds_read_b64_tr_b16 v[238:239], v65 offset:1664
    s_waitcnt lgkmcnt(14)
    v_mfma_f32_32x32x16_bf16 v[144:159], v[232:235], v[244:247], v[144:159]
    s_waitcnt lgkmcnt(8)
    v_mfma_f32_32x32x16_bf16 v[144:159], v[216:219], v[240:243], v[144:159]
    v_mfma_f32_32x32x16_bf16 v[160:175], v[232:235], v[240:243], v[160:175]
    ds_read_b128 v[212:215], v64 offset:64
    ds_read_b64_tr_b16 v[224:225], v65 offset:2208
    ds_read_b64_tr_b16 v[226:227], v65 offset:2176
    s_waitcnt lgkmcnt(6)
    v_add_f32 v112, v112, v80
    s_waitcnt lgkmcnt(3)
    v_mfma_f32_32x32x16_bf16 v[144:159], v[228:231], v[236:239], v[144:159]
    v_add_f32 v113, v113, v81
    v_add_f32 v114, v114, v82
    v_add_f32 v115, v115, v83
    v_add_f32 v116, v116, v84
    v_add_f32 v117, v117, v85
    v_add_f32 v118, v118, v86
    v_mfma_f32_32x32x16_bf16 v[160:175], v[216:219], v[236:239], v[160:175]
    v_add_f32_e64 v119, v119, v87
    v_cvt_pk_bf16_f32 v128, v112, v114
    v_cvt_pk_bf16_f32 v129, v116, v118
    v_cvt_pk_bf16_f32 v130, v113, v115
    v_cvt_pk_bf16_f32 v131, v117, v119
    s_mov_b32 s25, 0
    v_mfma_f32_32x32x16_bf16 v[176:191], v[232:235], v[236:239], v[176:191]
    buffer_store_dwordx2 v[128:129], v68, s[20:23], s25 offen
    s_mov_b32 s25, 5120
    buffer_store_dwordx2 v[130:131], v68, s[20:23], s25 offen
    v_add_f32 v120, v120, v88
    v_add_f32 v121, v121, v89
    s_waitcnt lgkmcnt(0)
    v_mfma_f32_32x32x16_bf16 v[144:159], v[212:215], v[224:227], v[144:159]
    ds_read_b64_tr_b16 v[244:245], v65 offset:2720
    ds_read_b64_tr_b16 v[246:247], v65 offset:2688
    v_add_f32 v122, v122, v90
    v_add_f32 v123, v123, v91
    v_add_f32 v124, v124, v92
    v_add_f32 v125, v125, v93
    v_mfma_f32_32x32x16_bf16 v[160:175], v[228:231], v[224:227], v[160:175]
    v_add_f32 v126, v126, v94
    v_add_f32 v127, v127, v95
    v_cvt_pk_bf16_f32 v132, v120, v122
    v_cvt_pk_bf16_f32 v133, v124, v126
    v_cvt_pk_bf16_f32 v134, v121, v123
    v_cvt_pk_bf16_f32 v135, v125, v127
    v_mfma_f32_32x32x16_bf16 v[176:191], v[216:219], v[224:227], v[176:191]
    s_mov_b32 s25, 655360
    buffer_store_dwordx2 v[132:133], v68, s[20:23], s25 offen
    s_mov_b32 s25, 660480
    buffer_store_dwordx2 v[134:135], v68, s[20:23], s25 offen
    ds_read_b64_tr_b16 v[112:113], v65 offset:32
    ds_read_b64_tr_b16 v[114:115], v65 offset:0
    v_mfma_f32_32x32x16_bf16 v[192:207], v[232:235], v[224:227], v[192:207]
    ds_read_b64_tr_b16 v[232:233], v65 offset:3232
    ds_read_b64_tr_b16 v[234:235], v65 offset:3200
    ds_read_b64_tr_b16 v[116:117], v65 offset:160
    ds_read_b64_tr_b16 v[118:119], v65 offset:128
    ds_read_b64_tr_b16 v[120:121], v65 offset:288
    s_waitcnt lgkmcnt(7)
    v_mfma_f32_32x32x16_bf16 v[160:175], v[212:215], v[244:247], v[160:175]
    ds_read_b64_tr_b16 v[122:123], v65 offset:256
    ds_read_b64_tr_b16 v[124:125], v65 offset:416
    ds_read_b64_tr_b16 v[126:127], v65 offset:384
    ds_read_b64_tr_b16 v[128:129], v65 offset:544
    ds_read_b64_tr_b16 v[130:131], v65 offset:512
    ds_read_b64_tr_b16 v[132:133], v65 offset:672
    v_mfma_f32_32x32x16_bf16 v[176:191], v[228:231], v[244:247], v[176:191]
    ds_read_b64_tr_b16 v[240:241], v65 offset:3744
    ds_read_b64_tr_b16 v[242:243], v65 offset:3712
    ds_read_b64_tr_b16 v[134:135], v65 offset:640
    ds_read_b64_tr_b16 v[136:137], v65 offset:800
    ds_read_b64_tr_b16 v[138:139], v65 offset:768
    ds_read_b64_tr_b16 v[140:141], v65 offset:928
    v_mfma_f32_32x32x16_bf16 v[192:207], v[216:219], v[244:247], v[192:207]
    ds_read_b128 v[216:219], v64 offset:416
    ds_read_b64_tr_b16 v[236:237], v65 offset:800
    ds_read_b64_tr_b16 v[238:239], v65 offset:768
    ds_read_b64_tr_b16 v[142:143], v65 offset:896
    s_waitcnt lgkmcnt(15)
    v_mfma_f32_32x32x16_bf16 v[176:191], v[212:215], v[232:235], v[176:191]
    ds_read_b128 v[224:227], v64 offset:288
    ds_read_b64_tr_b16 v[244:245], v65 offset:1312
    ds_read_b64_tr_b16 v[246:247], v65 offset:1280
    s_waitcnt vmcnt(4)
ce_86:
    v_max3_u32 v208, v248, v249, v250
    v_max3_u32 v208, v208, v251, v252
    v_max3_u32 v208, v208, v253, v254
    v_max_u32 v208, v208, v255
    v_cmp_eq_u32 s[82:83], -1, v208
    v_min3_f32 v209, v96, v99, v100
    v_min3_f32 v209, v209, v103, v104
    v_min3_f32 v209, v209, v107, v108
    v_min_f32 v209, v209, v111
    v_cmp_neq_f32 vcc, 0x41000000, v209
    s_nop 0
    s_or_b64 vcc, vcc, s[82:83]
    s_cbranch_vccnz rd_87
rc_88:
    v_mfma_f32_32x32x16_bf16 v[192:207], v[228:231], v[232:235], v[192:207]
    v_mul_f32 v208, 0x3acccccd, v97
    v_mul_f32 v209, 0x3acccccd, v101
    v_mul_f32 v98, 0x3acccccd, v98
    v_mul_f32 v102, 0x3acccccd, v102
    v_fma_f32 v98, -v208, v208, v98
    s_waitcnt lgkmcnt(11)
    v_mfma_f32_32x32x16_bf16 v[192:207], v[212:215], v[240:243], v[192:207]
    ds_read_b128 v[228:231], v64 offset:160
    ds_read_b64_tr_b16 v[212:213], v65 offset:1824
    ds_read_b64_tr_b16 v[214:215], v65 offset:1792
    v_fma_f32 v102, -v209, v209, v102
    v_max_f32 v98, 0, v98
    s_waitcnt lgkmcnt(7)
    v_mfma_f32_32x32x16_bf16 v[144:159], v[216:219], v[236:239], v[144:159]
    v_max_f32 v102, 0, v102
    v_add_f32 v98, 0x3727c5ac, v98
    v_add_f32 v102, 0x3727c5ac, v102
    v_rsq_f32 v97, v98
    s_waitcnt lgkmcnt(3)
    v_mfma_f32_32x32x16_bf16 v[144:159], v[224:227], v[244:247], v[144:159]
    v_rsq_f32_e64 v101, v102
    v_mul_f32 v98, -v208, v97
    v_mul_f32 v102, -v209, v101
    v_lshlrev_b32_e64 v80, 16, v248
    v_and_b32 v82, 0xffff0000, v248
    v_mfma_f32_32x32x16_bf16 v[160:175], v[216:219], v[244:247], v[160:175]
    ds_read_b64_tr_b16 v[232:233], v65 offset:2336
    ds_read_b64_tr_b16 v[234:235], v65 offset:2304
    v_lshlrev_b32 v84, 16, v249
    v_and_b32 v86, 0xffff0000, v249
    v_lshlrev_b32_e64 v81, 16, v250
    s_waitcnt lgkmcnt(2)
    v_mfma_f32_32x32x16_bf16 v[144:159], v[228:231], v[212:215], v[144:159]
    v_and_b32 v83, 0xffff0000, v250
    v_lshlrev_b32_e64 v85, 16, v251
    v_and_b32 v87, 0xffff0000, v251
    v_fma_f32 v208, v80, v97, v98
    v_fma_f32 v209, v81, v101, v102
    v_cvt_pk_bf16_f32 v248, v208, v209
    v_mfma_f32_32x32x16_bf16 v[160:175], v[224:227], v[212:215], v[160:175]
    v_fma_f32 v208, v82, v97, v98
    v_fma_f32 v209, v83, v101, v102
    v_cvt_pk_bf16_f32 v249, v208, v209
    v_fma_f32 v208, v84, v97, v98
    v_fma_f32 v209, v85, v101, v102
    v_cvt_pk_bf16_f32 v250, v208, v209
    v_mfma_f32_32x32x16_bf16 v[176:191], v[216:219], v[212:215], v[176:191]
    v_fma_f32 v208, v86, v97, v98
    v_fma_f32 v209, v87, v101, v102
    v_cvt_pk_bf16_f32 v251, v208, v209
    s_waitcnt lgkmcnt(0)
    v_mfma_f32_32x32x16_bf16 v[144:159], v[220:223], v[232:235], v[144:159]
    ds_read_b64_tr_b16 v[240:241], v65 offset:2848
    ds_read_b64_tr_b16 v[242:243], v65 offset:2816
    ds_write_b32 v63, v248 offset:512
    ds_write_b32 v63, v249 offset:5376
    v_mfma_f32_32x32x16_bf16 v[160:175], v[228:231], v[232:235], v[160:175]
    ds_write_b32 v63, v250 offset:10240
    ds_write_b32 v63, v251 offset:15104
    v_mul_f32 v208, 0x3acccccd, v105
    v_mul_f32 v209, 0x3acccccd, v109
    v_mfma_f32_32x32x16_bf16 v[176:191], v[224:227], v[232:235], v[176:191]
    v_mul_f32 v106, 0x3acccccd, v106
    v_mul_f32 v110, 0x3acccccd, v110
    v_fma_f32 v106, -v208, v208, v106
    v_fma_f32 v110, -v209, v209, v110
    v_max_f32 v106, 0, v106
    v_max_f32_e64 v110, 0, v110
    v_mfma_f32_32x32x16_bf16 v[192:207], v[216:219], v[232:235], v[192:207]
    ds_read_b64_tr_b16 v[216:217], v65 offset:3360
    ds_read_b64_tr_b16 v[218:219], v65 offset:3328
    v_add_f32 v106, 0x3727c5ac, v106
    v_add_f32 v110, 0x3727c5ac, v110
    s_waitcnt lgkmcnt(6)
    v_mfma_f32_32x32x16_bf16 v[160:175], v[220:223], v[240:243], v[160:175]
    v_rsq_f32 v105, v106
    v_rsq_f32_e64 v109, v110
    v_mul_f32 v106, -v208, v105
    v_mul_f32 v110, -v209, v109
    v_mfma_f32_32x32x16_bf16 v[176:191], v[228:231], v[240:243], v[176:191]
    ds_read_b64_tr_b16 v[236:237], v65 offset:3872
    ds_read_b64_tr_b16 v[238:239], v65 offset:3840
    v_lshlrev_b32 v88, 16, v252
    v_and_b32 v90, 0xffff0000, v252
    v_lshlrev_b32 v92, 16, v253
    v_and_b32 v94, 0xffff0000, v253
    v_mfma_f32_32x32x16_bf16 v[192:207], v[224:227], v[240:243], v[192:207]
    ds_read_b128 v[224:227], v64 offset:384
    ds_read_b64_tr_b16 v[244:245], v65 offset:928
    ds_read_b64_tr_b16 v[246:247], v65 offset:896
    v_lshlrev_b32 v89, 16, v254
    v_and_b32 v91, 0xffff0000, v254
    s_waitcnt lgkmcnt(5)
    v_mfma_f32_32x32x16_bf16 v[176:191], v[220:223], v[216:219], v[176:191]
    ds_read_b128 v[212:215], v64 offset:256
    ds_read_b64_tr_b16 v[232:233], v65 offset:1440
    ds_read_b64_tr_b16 v[234:235], v65 offset:1408
    v_lshlrev_b32_e64 v93, 16, v255
    v_and_b32 v95, 0xffff0000, v255
    v_fma_f32 v208, v88, v105, v106
    v_mfma_f32_32x32x16_bf16 v[192:207], v[228:231], v[216:219], v[192:207]
    v_fma_f32 v209, v89, v109, v110
    v_cvt_pk_bf16_f32 v252, v208, v209
    v_fma_f32 v208, v90, v105, v106
    v_fma_f32 v209, v91, v109, v110
    v_cvt_pk_bf16_f32 v253, v208, v209
    s_waitcnt lgkmcnt(6)
    v_mfma_f32_32x32x16_bf16 v[192:207], v[220:223], v[236:239], v[192:207]
    ds_read_b128 v[220:223], v64 offset:128
    ds_read_b64_tr_b16 v[228:229], v65 offset:1952
    ds_read_b64_tr_b16 v[230:231], v65 offset:1920
    v_fma_f32 v208, v92, v105, v106
    v_fma_f32 v209, v93, v109, v110
    s_waitcnt lgkmcnt(6)
    v_mfma_f32_32x32x16_bf16 v[144:159], v[224:227], v[244:247], v[144:159]
    v_cvt_pk_bf16_f32 v254, v208, v209
    v_fma_f32 v208, v94, v105, v106
    v_fma_f32 v209, v95, v109, v110
    v_cvt_pk_bf16_f32 v255, v208, v209
    s_waitcnt lgkmcnt(3)
    v_mfma_f32_32x32x16_bf16 v[144:159], v[212:215], v[232:235], v[144:159]
    ds_write_b32 v63, v252 offset:768
    ds_write_b32 v63, v253 offset:5632
    ds_write_b32 v63, v254 offset:10496
    v_mfma_f32_32x32x16_bf16 v[160:175], v[224:227], v[232:235], v[160:175]
    ds_read_b128 v[240:243], v64 offset:0
    ds_read_b64_tr_b16 v[216:217], v65 offset:2464
    ds_read_b64_tr_b16 v[218:219], v65 offset:2432
    ds_write_b32 v63, v255 offset:15360
    s_waitcnt lgkmcnt(7)
    v_mfma_f32_32x32x16_bf16 v[144:159], v[220:223], v[228:231], v[144:159]
    v_mfma_f32_32x32x16_bf16 v[160:175], v[212:215], v[228:231], v[160:175]
    v_mfma_f32_32x32x16_bf16 v[176:191], v[224:227], v[228:231], v[176:191]
    s_waitcnt lgkmcnt(1)
    v_mfma_f32_32x32x16_bf16 v[144:159], v[240:243], v[216:219], v[144:159]
    ds_read_b64_tr_b16 v[236:237], v65 offset:2976
    ds_read_b64_tr_b16 v[238:239], v65 offset:2944
    v_mfma_f32_32x32x16_bf16 v[160:175], v[220:223], v[216:219], v[160:175]
    v_mfma_f32_32x32x16_bf16 v[176:191], v[212:215], v[216:219], v[176:191]
    v_mfma_f32_32x32x16_bf16 v[192:207], v[224:227], v[216:219], v[192:207]
    ds_read_b64_tr_b16 v[224:225], v65 offset:3488
    ds_read_b64_tr_b16 v[226:227], v65 offset:3456
    s_waitcnt lgkmcnt(2)
    v_mfma_f32_32x32x16_bf16 v[160:175], v[240:243], v[236:239], v[160:175]
    v_mfma_f32_32x32x16_bf16 v[176:191], v[220:223], v[236:239], v[176:191]
    ds_read_b64_tr_b16 v[244:245], v65 offset:4000
    ds_read_b64_tr_b16 v[246:247], v65 offset:3968
    v_mfma_f32_32x32x16_bf16 v[192:207], v[212:215], v[236:239], v[192:207]
    s_waitcnt lgkmcnt(2)
    v_mfma_f32_32x32x16_bf16 v[176:191], v[240:243], v[224:227], v[176:191]
    v_mfma_f32_32x32x16_bf16 v[192:207], v[220:223], v[224:227], v[192:207]
    s_waitcnt lgkmcnt(0)
    v_mfma_f32_32x32x16_bf16 v[192:207], v[240:243], v[244:247], v[192:207]
    s_waitcnt lgkmcnt(0)
    s_barrier
    ds_read_b128 v[212:215], v64 offset:608
    ds_read_b128 v[216:219], v64 offset:576
    ds_read_b128 v[220:223], v64 offset:544
    ds_read_b128 v[224:227], v64 offset:512
    s_waitcnt lgkmcnt(3)
    v_mfma_f32_32x32x16_bf16 v[144:159], v[212:215], v[112:115], v[144:159]
    ds_read_b128 v[228:231], v64 offset:736
    s_waitcnt lgkmcnt(3)
    v_mfma_f32_32x32x16_bf16 v[144:159], v[216:219], v[116:119], v[144:159]
    ds_read_b128 v[232:235], v64 offset:704
    s_waitcnt lgkmcnt(3)
    v_mfma_f32_32x32x16_bf16 v[144:159], v[220:223], v[120:123], v[144:159]
    ds_read_b128 v[236:239], v64 offset:672
    s_waitcnt lgkmcnt(3)
    v_mfma_f32_32x32x16_bf16 v[144:159], v[224:227], v[124:127], v[144:159]
    ds_read_b128 v[240:243], v64 offset:640
    s_nop 3
    s_waitcnt lgkmcnt(3)
    v_mfma_f32_32x32x16_bf16 v[160:175], v[228:231], v[112:115], v[160:175]
    s_nop 4
    s_waitcnt lgkmcnt(2)
    v_mfma_f32_32x32x16_bf16 v[160:175], v[232:235], v[116:119], v[160:175]
    v_cndmask_b32 v208, v147, v72, s[76:77]
    v_cndmask_b32 v209, v151, v147, s[76:77]
    v_cndmask_b32 v210, v155, v151, s[76:77]
    v_cndmask_b32 v211, v159, v155, s[76:77]
    v_mov_b32 v72, v159
    s_waitcnt lgkmcnt(1)
    v_mfma_f32_32x32x16_bf16 v[160:175], v[236:239], v[120:123], v[160:175]
    v_add_f32_dpp v146, v208, v146 wave_ror:1 row_mask:0xf bank_mask:0xf
    v_add_f32_dpp v150, v209, v150 wave_ror:1 row_mask:0xf bank_mask:0xf
    v_add_f32_dpp v154, v210, v154 wave_ror:1 row_mask:0xf bank_mask:0xf
    v_add_f32_dpp v158, v211, v158 wave_ror:1 row_mask:0xf bank_mask:0xf
    v_cndmask_b32 v208, v146, v71, s[76:77]
    s_waitcnt lgkmcnt(0)
    v_mfma_f32_32x32x16_bf16 v[160:175], v[240:243], v[124:127], v[160:175]
    v_cndmask_b32 v209, v150, v146, s[76:77]
    v_cndmask_b32 v210, v154, v150, s[76:77]
    v_cndmask_b32 v211, v158, v154, s[76:77]
    v_mov_b32 v71, v158
    v_add_f32_dpp v145, v208, v145 wave_ror:1 row_mask:0xf bank_mask:0xf
    v_add_f32_dpp v149, v209, v149 wave_ror:1 row_mask:0xf bank_mask:0xf
    v_mfma_f32_32x32x16_bf16 v[160:175], v[212:215], v[128:131], v[160:175]
    ds_read_b128 v[244:247], v64 offset:864
    v_add_f32_dpp v153, v210, v153 wave_ror:1 row_mask:0xf bank_mask:0xf
    v_add_f32_dpp v157, v211, v157 wave_ror:1 row_mask:0xf bank_mask:0xf
    v_cndmask_b32 v208, v145, v70, s[76:77]
    v_cndmask_b32 v209, v149, v145, s[76:77]
    v_cndmask_b32 v210, v153, v149, s[76:77]
    v_mfma_f32_32x32x16_bf16 v[160:175], v[216:219], v[132:135], v[160:175]
    ds_read_b128 v[248:251], v64 offset:832
    v_cndmask_b32 v211, v157, v153, s[76:77]
    v_mov_b32_e64 v70, v157
    v_add_f32_dpp v144, v208, v144 wave_ror:1 row_mask:0xf bank_mask:0xf
    v_add_f32_dpp v148, v209, v148 wave_ror:1 row_mask:0xf bank_mask:0xf
    v_add_f32_dpp v152, v210, v152 wave_ror:1 row_mask:0xf bank_mask:0xf
    v_mfma_f32_32x32x16_bf16 v[160:175], v[220:223], v[136:139], v[160:175]
    ds_read_b128 v[252:255], v64 offset:800
    v_add_f32_dpp v156, v211, v156 wave_ror:1 row_mask:0xf bank_mask:0xf
    ds_write_b32 v66, v144 offset:0
    v_mfma_f32_32x32x16_bf16 v[160:175], v[224:227], v[140:143], v[160:175]
    ds_read_b128 v[224:227], v64 offset:768
    ds_write_b32 v66, v148 offset:64
    ds_write_b32 v66, v152 offset:128
    s_waitcnt lgkmcnt(6)
    v_mfma_f32_32x32x16_bf16 v[176:191], v[244:247], v[112:115], v[176:191]
    ds_write_b32 v66, v156 offset:192
    s_nop 2
    s_waitcnt lgkmcnt(6)
    v_mfma_f32_32x32x16_bf16 v[176:191], v[248:251], v[116:119], v[176:191]
    s_nop 2
    v_cndmask_b32 v208, v163, v72, s[76:77]
    v_cndmask_b32 v209, v167, v163, s[76:77]
    s_waitcnt lgkmcnt(5)
    v_mfma_f32_32x32x16_bf16 v[176:191], v[252:255], v[120:123], v[176:191]
    v_cndmask_b32 v210, v171, v167, s[76:77]
    v_cndmask_b32 v211, v175, v171, s[76:77]
    v_mov_b32 v72, v175
    v_add_f32_dpp v162, v208, v162 wave_ror:1 row_mask:0xf bank_mask:0xf
    v_add_f32_dpp v166, v209, v166 wave_ror:1 row_mask:0xf bank_mask:0xf
    s_waitcnt lgkmcnt(3)
    v_mfma_f32_32x32x16_bf16 v[176:191], v[224:227], v[124:127], v[176:191]
    v_add_f32_dpp v170, v210, v170 wave_ror:1 row_mask:0xf bank_mask:0xf
    v_add_f32_dpp v174, v211, v174 wave_ror:1 row_mask:0xf bank_mask:0xf
    v_cndmask_b32 v208, v162, v71, s[76:77]
    v_cndmask_b32 v209, v166, v162, s[76:77]
    v_cndmask_b32 v210, v170, v166, s[76:77]
    v_cndmask_b32 v211, v174, v170, s[76:77]
    v_mfma_f32_32x32x16_bf16 v[176:191], v[228:231], v[128:131], v[176:191]
    ds_read_b64_tr_b16 v[228:229], v65 offset:1056
    ds_read_b64_tr_b16 v[230:231], v65 offset:1024
    v_mov_b32 v71, v174
    v_add_f32_dpp v161, v208, v161 wave_ror:1 row_mask:0xf bank_mask:0xf
    v_add_f32_dpp v165, v209, v165 wave_ror:1 row_mask:0xf bank_mask:0xf
    v_add_f32_dpp v169, v210, v169 wave_ror:1 row_mask:0xf bank_mask:0xf
    v_mfma_f32_32x32x16_bf16 v[176:191], v[232:235], v[132:135], v[176:191]
    ds_read_b64_tr_b16 v[232:233], v65 offset:1184
    ds_read_b64_tr_b16 v[234:235], v65 offset:1152
    v_add_f32_dpp v173, v211, v173 wave_ror:1 row_mask:0xf bank_mask:0xf
    v_cndmask_b32 v208, v161, v70, s[76:77]
    v_cndmask_b32 v209, v165, v161, s[76:77]
    v_cndmask_b32 v210, v169, v165, s[76:77]
    v_mfma_f32_32x32x16_bf16 v[176:191], v[236:239], v[136:139], v[176:191]
    ds_read_b64_tr_b16 v[236:237], v65 offset:1312
    ds_read_b64_tr_b16 v[238:239], v65 offset:1280
    v_cndmask_b32 v211, v173, v169, s[76:77]
    v_mov_b32_e64 v70, v173
    v_add_f32_dpp v160, v208, v160 wave_ror:1 row_mask:0xf bank_mask:0xf
    v_add_f32_dpp v164, v209, v164 wave_ror:1 row_mask:0xf bank_mask:0xf
    v_mfma_f32_32x32x16_bf16 v[176:191], v[240:243], v[140:143], v[176:191]
    ds_read_b128 v[240:243], v64 offset:512
    ds_read_b64_tr_b16 v[224:225], v65 offset:1440
    ds_read_b64_tr_b16 v[226:227], v65 offset:1408
    v_add_f32_dpp v168, v210, v168 wave_ror:1 row_mask:0xf bank_mask:0xf
    v_add_f32_dpp v172, v211, v172 wave_ror:1 row_mask:0xf bank_mask:0xf
    s_waitcnt lgkmcnt(7)
    v_mfma_f32_32x32x16_bf16 v[176:191], v[212:215], v[228:231], v[176:191]
    ds_read_b128 v[212:215], v64 offset:992
    ds_write_b32 v66, v160 offset:256
    ds_write_b32 v66, v164 offset:320
    s_waitcnt lgkmcnt(8)
    v_mfma_f32_32x32x16_bf16 v[176:191], v[216:219], v[232:235], v[176:191]
    ds_read_b128 v[216:219], v64 offset:960
    ds_write_b32 v66, v168 offset:384
    ds_write_b32 v66, v172 offset:448
    s_waitcnt lgkmcnt(9)
    v_mfma_f32_32x32x16_bf16 v[176:191], v[220:223], v[236:239], v[176:191]
    ds_read_b128 v[220:223], v64 offset:928
    s_waitcnt lgkmcnt(7)
    v_mfma_f32_32x32x16_bf16 v[176:191], v[240:243], v[224:227], v[176:191]
    ds_read_b128 v[240:243], v64 offset:896
    s_waitcnt lgkmcnt(2)
    s_barrier
    v_mfma_f32_32x32x16_bf16 v[192:207], v[212:215], v[112:115], v[192:207]
    ds_read_b64 v[144:145], v67 offset:0
    ds_read_b64 v[146:147], v67 offset:4224
    ds_read_b64 v[148:149], v67 offset:8448
    ds_read_b64 v[150:151], v67 offset:12672
    s_nop 0
    v_mfma_f32_32x32x16_bf16 v[192:207], v[216:219], v[116:119], v[192:207]
    s_nop 2
    v_cndmask_b32 v208, v179, v72, s[76:77]
    v_cndmask_b32 v209, v183, v179, s[76:77]
    s_waitcnt lgkmcnt(5)
    v_mfma_f32_32x32x16_bf16 v[192:207], v[220:223], v[120:123], v[192:207]
    v_cndmask_b32 v210, v187, v183, s[76:77]
    v_cndmask_b32 v211, v191, v187, s[76:77]
    v_mov_b32 v72, v191
    v_add_f32_dpp v178, v208, v178 wave_ror:1 row_mask:0xf bank_mask:0xf
    v_add_f32_dpp v182, v209, v182 wave_ror:1 row_mask:0xf bank_mask:0xf
    s_waitcnt lgkmcnt(4)
    v_mfma_f32_32x32x16_bf16 v[192:207], v[240:243], v[124:127], v[192:207]
    ds_read_b128 v[212:215], v64 offset:768
    v_add_f32_dpp v186, v210, v186 wave_ror:1 row_mask:0xf bank_mask:0xf
    v_add_f32_dpp v190, v211, v190 wave_ror:1 row_mask:0xf bank_mask:0xf
    v_cndmask_b32 v208, v178, v71, s[76:77]
    v_cndmask_b32 v209, v182, v178, s[76:77]
    v_cndmask_b32 v210, v186, v182, s[76:77]
    v_mfma_f32_32x32x16_bf16 v[192:207], v[244:247], v[128:131], v[192:207]
    ds_read_b128 v[244:247], v64 offset:736
    v_cndmask_b32 v211, v190, v186, s[76:77]
    v_mov_b32 v71, v190
    v_add_f32_dpp v177, v208, v177 wave_ror:1 row_mask:0xf bank_mask:0xf
    v_add_f32_dpp v181, v209, v181 wave_ror:1 row_mask:0xf bank_mask:0xf
    v_add_f32_dpp v185, v210, v185 wave_ror:1 row_mask:0xf bank_mask:0xf
    v_mfma_f32_32x32x16_bf16 v[192:207], v[248:251], v[132:135], v[192:207]
    ds_read_b128 v[248:251], v64 offset:704
    v_add_f32_dpp v189, v211, v189 wave_ror:1 row_mask:0xf bank_mask:0xf
    v_cndmask_b32 v208, v177, v70, s[76:77]
    v_cndmask_b32 v209, v181, v177, s[76:77]
    v_cndmask_b32 v210, v185, v181, s[76:77]
    v_cndmask_b32 v211, v189, v185, s[76:77]
    v_mfma_f32_32x32x16_bf16 v[192:207], v[252:255], v[136:139], v[192:207]
    ds_read_b128 v[252:255], v64 offset:672
    v_mov_b32_e64 v70, v189
    v_add_f32_dpp v176, v208, v176 wave_ror:1 row_mask:0xf bank_mask:0xf
    v_add_f32_dpp v180, v209, v180 wave_ror:1 row_mask:0xf bank_mask:0xf
    v_add_f32_dpp v184, v210, v184 wave_ror:1 row_mask:0xf bank_mask:0xf
    s_waitcnt lgkmcnt(3)
    v_mfma_f32_32x32x16_bf16 v[192:207], v[212:215], v[140:143], v[192:207]
    ds_read_b128 v[216:219], v64 offset:640
    v_add_f32_dpp v188, v211, v188 wave_ror:1 row_mask:0xf bank_mask:0xf
    s_waitcnt lgkmcnt(3)
    v_mfma_f32_32x32x16_bf16 v[192:207], v[244:247], v[228:231], v[192:207]
    ds_read_b128 v[228:231], v64 offset:608
    ds_read_b64_tr_b16 v[220:221], v65 offset:1568
    ds_read_b64_tr_b16 v[222:223], v65 offset:1536
    ds_write_b32 v66, v176 offset:512
    s_waitcnt lgkmcnt(6)
    v_mfma_f32_32x32x16_bf16 v[192:207], v[248:251], v[232:235], v[192:207]
    ds_read_b128 v[232:235], v64 offset:576
    ds_read_b64_tr_b16 v[240:241], v65 offset:1696
    ds_read_b64_tr_b16 v[242:243], v65 offset:1664
    ds_write_b32 v66, v180 offset:576
    s_waitcnt lgkmcnt(9)
    v_mfma_f32_32x32x16_bf16 v[192:207], v[252:255], v[236:239], v[192:207]
    ds_read_b128 v[236:239], v64 offset:544
    ds_read_b64_tr_b16 v[212:213], v65 offset:1824
    ds_read_b64_tr_b16 v[214:215], v65 offset:1792
    ds_write_b32 v66, v184 offset:640
    s_waitcnt lgkmcnt(12)
    v_mfma_f32_32x32x16_bf16 v[192:207], v[216:219], v[224:227], v[192:207]
    ds_read_b128 v[224:227], v64 offset:512
    ds_read_b64_tr_b16 v[244:245], v65 offset:1952
    ds_read_b64_tr_b16 v[246:247], v65 offset:1920
    ds_write_b32 v66, v188 offset:704
    s_waitcnt lgkmcnt(13)
    v_mfma_f32_32x32x16_bf16 v[192:207], v[228:231], v[220:223], v[192:207]
    v_add_f32 v144, v144, v80
    v_add_f32 v145, v145, v81
    v_add_f32 v146, v146, v82
    v_add_f32 v147, v147, v83
    s_waitcnt lgkmcnt(9)
    v_mfma_f32_32x32x16_bf16 v[192:207], v[232:235], v[240:243], v[192:207]
    v_add_f32 v148, v148, v84
    v_add_f32 v149, v149, v85
    v_add_f32 v150, v150, v86
    v_add_f32 v151, v151, v87
    v_cvt_pk_bf16_f32 v160, v144, v146
    s_waitcnt lgkmcnt(5)
    v_mfma_f32_32x32x16_bf16 v[192:207], v[236:239], v[212:215], v[192:207]
    v_cvt_pk_bf16_f32 v161, v148, v150
    v_cvt_pk_bf16_f32 v162, v145, v147
    v_cvt_pk_bf16_f32 v163, v149, v151
    s_mov_b32 s25, 1310720
    s_waitcnt lgkmcnt(1)
    v_mfma_f32_32x32x16_bf16 v[192:207], v[224:227], v[244:247], v[192:207]
    buffer_store_dwordx2 v[160:161], v68, s[20:23], s25 offen
    s_mov_b32 s25, 1315840
    buffer_store_dwordx2 v[162:163], v68, s[20:23], s25 offen
    s_nop 8
    v_cndmask_b32 v208, v195, v72, s[76:77]
    v_cndmask_b32 v209, v199, v195, s[76:77]
    v_cndmask_b32 v210, v203, v199, s[76:77]
    v_cndmask_b32 v211, v207, v203, s[76:77]
    v_mov_b32_e64 v72, v207
    v_add_f32_dpp v194, v208, v194 wave_ror:1 row_mask:0xf bank_mask:0xf
    v_add_f32_dpp v198, v209, v198 wave_ror:1 row_mask:0xf bank_mask:0xf
    v_add_f32_dpp v202, v210, v202 wave_ror:1 row_mask:0xf bank_mask:0xf
    v_add_f32_dpp v206, v211, v206 wave_ror:1 row_mask:0xf bank_mask:0xf
    v_cndmask_b32 v208, v194, v71, s[76:77]
    v_cndmask_b32 v209, v198, v194, s[76:77]
    v_cndmask_b32 v210, v202, v198, s[76:77]
    v_cndmask_b32 v211, v206, v202, s[76:77]
    v_mov_b32_e64 v71, v206
    v_add_f32_dpp v193, v208, v193 wave_ror:1 row_mask:0xf bank_mask:0xf
    v_add_f32_dpp v197, v209, v197 wave_ror:1 row_mask:0xf bank_mask:0xf
    v_add_f32_dpp v201, v210, v201 wave_ror:1 row_mask:0xf bank_mask:0xf
    v_add_f32_dpp v205, v211, v205 wave_ror:1 row_mask:0xf bank_mask:0xf
    v_cndmask_b32 v208, v193, v70, s[76:77]
    v_cndmask_b32 v209, v197, v193, s[76:77]
    v_cndmask_b32 v210, v201, v197, s[76:77]
    v_cndmask_b32 v211, v205, v201, s[76:77]
    v_mov_b32_e64 v70, v205
    v_add_f32_dpp v192, v208, v192 wave_ror:1 row_mask:0xf bank_mask:0xf
    v_add_f32_dpp v196, v209, v196 wave_ror:1 row_mask:0xf bank_mask:0xf
    v_add_f32_dpp v200, v210, v200 wave_ror:1 row_mask:0xf bank_mask:0xf
    v_add_f32_dpp v204, v211, v204 wave_ror:1 row_mask:0xf bank_mask:0xf
    ds_write_b32 v66, v192 offset:768
    ds_write_b32 v66, v196 offset:832
    ds_write_b32 v66, v200 offset:896
    ds_write_b32 v66, v204 offset:960
    s_waitcnt lgkmcnt(0)
    s_barrier
    ds_read_b64 v[152:153], v67 offset:512
    ds_read_b64 v[154:155], v67 offset:4736
    ds_read_b64 v[156:157], v67 offset:8960
    ds_read_b64 v[158:159], v67 offset:13184
    s_waitcnt lgkmcnt(0)
    v_add_f32 v152, v152, v88
    v_add_f32 v153, v153, v89
    v_add_f32 v154, v154, v90
    v_add_f32 v155, v155, v91
    v_add_f32 v156, v156, v92
    v_add_f32 v157, v157, v93
    v_add_f32 v158, v158, v94
    v_add_f32_e64 v159, v159, v95
    v_cvt_pk_bf16_f32 v164, v152, v154
    v_cvt_pk_bf16_f32 v165, v156, v158
    v_cvt_pk_bf16_f32 v166, v153, v155
    v_cvt_pk_bf16_f32 v167, v157, v159
    s_mov_b32 s25, 1966080
    buffer_store_dwordx2 v[164:165], v68, s[20:23], s25 offen
    s_mov_b32 s25, 1971200
    buffer_store_dwordx2 v[166:167], v68, s[20:23], s25 offen
    s_branch ec_82
nc_81:
ec_82:
L_end:
    s_endpgm
ps_5:
    s_mov_b32 s84, 1048576
pl_6:
    global_load_dword v7, v5, s[66:67] sc1
    s_waitcnt vmcnt(0)
    s_sub_u32 s84, s84, 1
    s_cbranch_scc1 pc_7
    v_cmp_gt_u32_e64 vcc, 1, v7
    s_nop 0
    s_and_b64 vcc, vcc, s[50:51]
    s_and_b64 vcc, vcc, 1
    s_cbranch_scc1 pl_6
    s_branch pc_7
ps_8:
    s_mov_b32 s84, 1048576
pl_9:
    buffer_load_dword v7, v4, s[16:19], s87 offen offset:0 sc1
    s_waitcnt vmcnt(0)
    s_sub_u32 s84, s84, 1
    s_cbranch_scc1 pc_10
    v_cmp_gt_u32 vcc, 32, v7
    s_nop 0
    s_and_b64 vcc, vcc, s[50:51]
    s_cbranch_scc1 pl_9
    s_branch pc_10
ps_11:
    s_mov_b32 s84, 1048576
pl_12:
    global_load_dword v7, v5, s[66:67] sc1
    s_waitcnt vmcnt(0)
    s_sub_u32 s84, s84, 1
    s_cbranch_scc1 pc_13
    v_cmp_gt_u32_e64 vcc, 1, v7
    s_nop 0
    s_and_b64 vcc, vcc, s[50:51]
    s_and_b64 vcc, vcc, 1
    s_cbranch_scc1 pl_12
    s_branch pc_13
ps_14:
    s_mov_b32 s84, 1048576
pl_15:
    buffer_load_dword v7, v4, s[16:19], s87 offen offset:0 sc1
    s_waitcnt vmcnt(0)
    s_sub_u32 s84, s84, 1
    s_cbranch_scc1 pc_16
    v_cmp_gt_u32 vcc, 32, v7
    s_nop 0
    s_and_b64 vcc, vcc, s[50:51]
    s_cbranch_scc1 pl_15
    s_branch pc_16
ps_17:
    s_mov_b32 s84, 1048576
pl_18:
    buffer_load_dword v7, v4, s[16:19], s89 offen offset:8 sc1
    s_waitcnt vmcnt(0)
    s_sub_u32 s84, s84, 1
    s_cbranch_scc1 pc_19
    v_cmp_gt_u32_e64 vcc, 32, v7
    s_nop 0
    s_and_b64 vcc, vcc, s[50:51]
    s_cbranch_scc1 pl_18
    s_branch pc_19
rd_21:
    s_cmp_eq_u32 s38, 0
    s_cbranch_scc1 rc_22
    s_sub_u32 s38, s38, 1
    s_nop 7
    s_nop 7
    s_sleep 4
    s_mov_b64 exec, vcc
    s_mov_b32 s96, 4194304
    buffer_load_dwordx4 v[216:219], v56, s[16:19], s96 offen offset:0 sc1
    buffer_load_dwordx4 v[220:223], v56, s[16:19], s96 offen offset:256 sc1
    s_mov_b32 s96, 4227072
    buffer_load_dwordx4 v[224:227], v56, s[16:19], s96 offen offset:0 sc1
    buffer_load_dwordx4 v[228:231], v56, s[16:19], s96 offen offset:256 sc1
    s_mov_b32 s96, 4259840
    buffer_load_dwordx4 v[232:235], v56, s[16:19], s96 offen offset:0 sc1
    buffer_load_dwordx4 v[236:239], v56, s[16:19], s96 offen offset:256 sc1
    s_mov_b32 s96, 4292608
    buffer_load_dwordx4 v[240:243], v56, s[16:19], s96 offen offset:0 sc1
    buffer_load_dwordx4 v[244:247], v56, s[16:19], s96 offen offset:256 sc1
    s_mov_b32 s96, 4194304
    buffer_load_dwordx2 v[248:249], v57, s[16:19], s96 offen offset:0 sc1
    buffer_load_dwordx2 v[252:253], v57, s[16:19], s96 offen offset:128 sc1
    s_mov_b32 s96, 4210688
    buffer_load_dwordx2 v[250:251], v57, s[16:19], s96 offen offset:0 sc1
    buffer_load_dwordx2 v[254:255], v57, s[16:19], s96 offen offset:128 sc1
    s_mov_b32 s96, 0
    s_mov_b32 s97, 5120
    s_waitcnt vmcnt(16)
    buffer_load_dwordx2 v[208:209], v60, s[4:7], s96 offen
    s_waitcnt vmcnt(16)
    buffer_load_dwordx2 v[210:211], v60, s[4:7], s97 offen
    s_waitcnt vmcnt(16)
    v_lshrrev_b32_e64 v212, 5, v1
    v_mul_u32_u24 v212, 5104, v212
    v_bfe_u32 v213, v1, 4, 1
    v_lshlrev_b32 v213, 2, v213
    v_sub_u32 v212, v212, v213
    v_add_u32 v212, v212, v60
    s_mul_i32 s97, s24, 24
    s_sub_u32 s97, 128, s97
    buffer_load_dword v212, v212, s[4:7], s97 offen
    s_mov_b64 exec, -1
    s_waitcnt vmcnt(0) lgkmcnt(0)
    s_branch oe_20
rd_24:
    s_cmp_eq_u32 s38, 0
    s_cbranch_scc1 rc_25
    s_sub_u32 s38, s38, 1
    s_nop 7
    s_nop 7
    s_sleep 4
    s_mov_b64 exec, vcc
    s_mov_b32 s96, 4198400
    buffer_load_dwordx4 v[216:219], v56, s[16:19], s96 offen offset:0 sc1
    buffer_load_dwordx4 v[220:223], v56, s[16:19], s96 offen offset:256 sc1
    s_mov_b32 s96, 4231168
    buffer_load_dwordx4 v[224:227], v56, s[16:19], s96 offen offset:0 sc1
    buffer_load_dwordx4 v[228:231], v56, s[16:19], s96 offen offset:256 sc1
    s_mov_b32 s96, 4263936
    buffer_load_dwordx4 v[232:235], v56, s[16:19], s96 offen offset:0 sc1
    buffer_load_dwordx4 v[236:239], v56, s[16:19], s96 offen offset:256 sc1
    s_mov_b32 s96, 4296704
    buffer_load_dwordx4 v[240:243], v56, s[16:19], s96 offen offset:0 sc1
    buffer_load_dwordx4 v[244:247], v56, s[16:19], s96 offen offset:256 sc1
    s_mov_b32 s96, 4196352
    buffer_load_dwordx2 v[248:249], v57, s[16:19], s96 offen offset:0 sc1
    buffer_load_dwordx2 v[252:253], v57, s[16:19], s96 offen offset:128 sc1
    s_mov_b32 s96, 4212736
    buffer_load_dwordx2 v[250:251], v57, s[16:19], s96 offen offset:0 sc1
    buffer_load_dwordx2 v[254:255], v57, s[16:19], s96 offen offset:128 sc1
    s_mov_b32 s96, 1310720
    s_mov_b32 s97, 1315840
    s_waitcnt vmcnt(15)
    buffer_load_dwordx2 v[208:209], v60, s[4:7], s96 offen
    s_waitcnt vmcnt(15)
    buffer_load_dwordx2 v[210:211], v60, s[4:7], s97 offen
    s_waitcnt vmcnt(15)
    v_lshrrev_b32 v212, 5, v1
    v_mul_u32_u24 v212, 5104, v212
    v_bfe_u32 v213, v1, 4, 1
    v_lshlrev_b32 v213, 2, v213
    v_sub_u32 v212, v212, v213
    v_add_u32 v212, v212, v60
    s_mul_i32 s97, s24, 24
    s_sub_u32 s97, 1310848, s97
    buffer_load_dword v212, v212, s[4:7], s97 offen
    s_mov_b64 exec, -1
    s_waitcnt vmcnt(0) lgkmcnt(0)
    s_branch oe_23
rd_29:
    s_cmp_eq_u32 s38, 0
    s_cbranch_scc1 rc_30
    s_sub_u32 s38, s38, 1
    s_nop 7
    s_nop 7
    s_sleep 4
    s_mov_b64 exec, vcc
    s_lshl_b32 s96, s75, 14
    s_add_u32 s96, s96, 6815744
    s_lshl_b32 s97, s24, 12
    s_add_u32 s97, s97, 3473408
    buffer_load_dwordx4 v[176:179], v62, s[16:19], s96 offen offset:0 sc1
    buffer_load_dwordx4 v[180:183], v62, s[16:19], s96 offen offset:1024 sc1
    buffer_load_dwordx4 v[184:187], v62, s[16:19], s97 offen offset:0 sc1
    buffer_load_dwordx4 v[188:191], v62, s[16:19], s97 offen offset:1024 sc1
    buffer_load_dwordx4 v[192:195], v62, s[16:19], s97 offen offset:2048 sc1
    buffer_load_dwordx4 v[196:199], v62, s[16:19], s97 offen offset:3072 sc1
    s_mov_b64 exec, -1
    s_waitcnt vmcnt(0) lgkmcnt(0)
    s_branch ce_28
rd_32:
    s_cmp_eq_u32 s38, 0
    s_cbranch_scc1 rc_33
    s_sub_u32 s38, s38, 1
    s_nop 7
    s_nop 7
    s_sleep 4
    s_mov_b64 exec, vcc
    s_lshl_b32 s96, s75, 14
    s_add_u32 s96, s96, 6815744
    s_lshl_b32 s97, s24, 12
    s_add_u32 s97, s97, 3477504
    buffer_load_dwordx4 v[248:251], v62, s[16:19], s96 offen offset:2048 sc1
    buffer_load_dwordx4 v[252:255], v62, s[16:19], s96 offen offset:3072 sc1
    buffer_load_dwordx4 v[96:99], v62, s[16:19], s97 offen offset:0 sc1
    buffer_load_dwordx4 v[100:103], v62, s[16:19], s97 offen offset:1024 sc1
    buffer_load_dwordx4 v[104:107], v62, s[16:19], s97 offen offset:2048 sc1
    buffer_load_dwordx4 v[108:111], v62, s[16:19], s97 offen offset:3072 sc1
    s_mov_b64 exec, -1
    s_waitcnt vmcnt(0) lgkmcnt(0)
    s_branch ce_31
gl_34:
    s_add_u32 s82, s86, 16384
    v_lshlrev_b32 v2, 10, v1
    v_mov_b32_e64 v5, 1
    s_mov_b64 exec, 255
    buffer_store_dword v5, v2, s[16:19], s82 offen offset:0 sc1
    s_mov_b64 exec, -1
    s_branch gc_35
ps_36:
    s_mov_b32 s84, 1048576
pl_37:
    buffer_load_dword v7, v4, s[16:19], s89 offen offset:0 sc1
    s_waitcnt vmcnt(0)
    s_sub_u32 s84, s84, 1
    s_cbranch_scc1 pc_38
    v_cmp_gt_u32 vcc, 1, v7
    s_nop 0
    s_and_b64 vcc, vcc, s[50:51]
    s_cbranch_scc1 pl_37
    s_branch pc_38
ps_39:
    s_mov_b32 s84, 1048576
pl_40:
    buffer_load_dword v7, v4, s[16:19], s87 offen offset:8 sc1
    s_waitcnt vmcnt(0)
    s_sub_u32 s84, s84, 1
    s_cbranch_scc1 pc_41
    v_cmp_gt_u32 vcc, 12, v7
    s_nop 0
    s_and_b64 vcc, vcc, s[50:51]
    s_cbranch_scc1 pl_40
    s_branch pc_41
gl_42:
    s_add_u32 s82, s86, 0
    v_lshlrev_b32 v2, 10, v1
    v_mov_b32_e64 v5, 1
    s_mov_b64 exec, 255
    buffer_store_dword v5, v2, s[16:19], s82 offen offset:12 sc1
    s_mov_b64 exec, -1
    s_branch gc_43
ps_44:
    s_mov_b32 s84, 1048576
pl_45:
    buffer_load_dword v7, v4, s[16:19], s89 offen offset:0 sc1
    s_waitcnt vmcnt(0)
    s_sub_u32 s84, s84, 1
    s_cbranch_scc1 pc_46
    v_cmp_gt_u32_e64 vcc, 1, v7
    s_nop 0
    s_and_b64 vcc, vcc, s[50:51]
    s_cbranch_scc1 pl_45
    s_branch pc_46
rd_49:
    s_cmp_eq_u32 s38, 0
    s_cbranch_scc1 rc_50
    s_sub_u32 s38, s38, 1
    s_nop 7
    s_nop 7
    s_sleep 4
    s_mov_b64 exec, vcc
    s_add_u32 s26, s3, 9437184
    buffer_load_dwordx4 v[216:219], v236, s[16:19], s26 offen sc1
    s_add_u32 s26, s26, 524288
    buffer_load_dwordx4 v[220:223], v236, s[16:19], s26 offen sc1
    s_add_u32 s26, s26, 524288
    buffer_load_dwordx4 v[224:227], v236, s[16:19], s26 offen sc1
    s_add_u32 s26, s26, 524288
    buffer_load_dwordx4 v[228:231], v236, s[16:19], s26 offen sc1
    s_add_u32 s26, s26, 524288
    buffer_load_dwordx4 v[232:235], v236, s[16:19], s26 offen sc1
    s_mov_b64 exec, -1
    s_waitcnt vmcnt(0) lgkmcnt(0)
    s_branch se_48
gl_52:
    s_add_u32 s82, s86, 16384
    v_lshlrev_b32 v2, 10, v1
    v_mov_b32_e64 v5, 1
    s_mov_b64 exec, 255
    buffer_store_dword v5, v2, s[16:19], s82 offen offset:4 sc1
    s_mov_b64 exec, -1
    s_branch gc_53
ps_54:
    s_mov_b32 s84, 1048576
pl_55:
    buffer_load_dword v7, v4, s[16:19], s87 offen offset:12 sc1
    s_waitcnt vmcnt(0)
    s_sub_u32 s84, s84, 1
    s_cbranch_scc1 pc_56
    v_cmp_gt_u32_e64 vcc, 1, v7
    s_nop 0
    s_and_b64 vcc, vcc, s[50:51]
    s_cbranch_scc1 pl_55
    s_branch pc_56
rd_58:
    s_cmp_eq_u32 s38, 0
    s_cbranch_scc1 rc_59
    s_sub_u32 s38, s38, 1
    s_nop 7
    s_nop 7
    s_sleep 4
    s_mov_b64 exec, vcc
    s_lshl_b32 s98, s72, 5
    s_add_u32 s98, s98, 0
    s_sub_u32 s95, s98, 4
    s_max_i32 s95, s95, 0
    s_lshl_b32 s94, s98, 3
    s_lshl_b32 s95, s95, 3
    s_add_u32 s94, s94, 3457024
    s_add_u32 s95, s95, 3457024
    s_add_u32 s96, s94, 8192
    buffer_load_dwordx2 v[152:153], v47, s[16:19], s94 offen sc1
    buffer_load_dwordx2 v[154:155], v47, s[16:19], s96 offen sc1
    buffer_load_dwordx2 v[156:157], v48, s[16:19], s95 offen sc1
    s_mov_b64 exec, -1
    s_waitcnt vmcnt(0) lgkmcnt(0)
    s_branch sl_57
ps_60:
    s_mov_b32 s84, 1048576
pl_61:
    buffer_load_dword v7, v4, s[16:19], s89 offen offset:4 sc1
    s_waitcnt vmcnt(0)
    s_sub_u32 s84, s84, 1
    s_cbranch_scc1 pc_62
    v_cmp_gt_u32 vcc, 1, v7
    s_nop 0
    s_and_b64 vcc, vcc, s[50:51]
    s_cbranch_scc1 pl_61
    s_branch pc_62
rd_65:
    s_cmp_eq_u32 s38, 0
    s_cbranch_scc1 rc_66
    s_sub_u32 s38, s38, 1
    s_nop 7
    s_nop 7
    s_sleep 4
    s_mov_b64 exec, vcc
    s_add_u32 s26, s3, 9437184
    buffer_load_dwordx4 v[216:219], v236, s[16:19], s26 offen sc1
    s_add_u32 s26, s26, 524288
    buffer_load_dwordx4 v[220:223], v236, s[16:19], s26 offen sc1
    s_add_u32 s26, s26, 524288
    buffer_load_dwordx4 v[224:227], v236, s[16:19], s26 offen sc1
    s_add_u32 s26, s26, 524288
    buffer_load_dwordx4 v[228:231], v236, s[16:19], s26 offen sc1
    s_add_u32 s26, s26, 524288
    buffer_load_dwordx4 v[232:235], v236, s[16:19], s26 offen sc1
    s_mov_b64 exec, -1
    s_waitcnt vmcnt(0) lgkmcnt(0)
    s_branch se_64
rd_67:
    s_cmp_eq_u32 s39, 0
    s_cbranch_scc1 rc_68
    s_sub_u32 s39, s39, 1
    s_nop 7
    s_nop 7
    s_waitcnt vmcnt(0) lgkmcnt(0)
    s_barrier
    s_lshl_b32 s25, s72, 5
    s_add_u32 s25, s25, 0
    s_sub_u32 s26, s25, 4
    s_max_i32 s26, s26, 0
    s_lshl_b32 s27, s71, 12
    s_add_u32 s27, s27, 9437184
    s_lshl_b32 s99, s25, 3
    s_lshl_b32 s100, s26, 3
    s_lshl_b32 s92, s24, 12
    s_lshl_b32 s93, s24, 9
    s_add_u32 s99, s99, s27
    s_add_u32 s100, s100, s27
    s_add_u32 m0, s92, 36352
    s_nop 0
    buffer_load_dwordx4 v73, s[16:19], s99 offen offset:0 sc1 lds
    buffer_load_dwordx4 v74, s[16:19], s99 offen offset:1024 sc1 lds
    buffer_load_dwordx4 v75, s[16:19], s99 offen offset:2048 sc1 lds
    buffer_load_dwordx4 v76, s[16:19], s99 offen offset:3072 sc1 lds
    s_add_u32 m0, s93, 53760
    s_add_u32 s99, s99, 524288
    s_mov_b64 exec, s[80:81]
    buffer_load_dwordx4 v77, s[16:19], s100 offen sc1 lds
    s_mov_b64 exec, -1
    s_add_u32 s100, s100, 524288
    s_add_u32 m0, s92, 55936
    s_nop 0
    s_nop 0
    buffer_load_dwordx4 v73, s[16:19], s99 offen offset:0 sc1 lds
    buffer_load_dwordx4 v74, s[16:19], s99 offen offset:1024 sc1 lds
    buffer_load_dwordx4 v75, s[16:19], s99 offen offset:2048 sc1 lds
    buffer_load_dwordx4 v76, s[16:19], s99 offen offset:3072 sc1 lds
    s_add_u32 m0, s93, 73344
    s_add_u32 s99, s99, 524288
    s_mov_b64 exec, s[80:81]
    buffer_load_dwordx4 v77, s[16:19], s100 offen sc1 lds
    s_mov_b64 exec, -1
    s_add_u32 s100, s100, 524288
    s_mov_b64 exec, -1
    s_waitcnt vmcnt(0) lgkmcnt(0)
    s_branch ge_51
rd_71:
    s_cmp_eq_u32 s38, 0
    s_cbranch_scc1 rc_72
    s_sub_u32 s38, s38, 1
    s_nop 7
    s_nop 7
    s_sleep 4
    s_mov_b64 exec, vcc
    s_lshl_b32 s98, s72, 5
    s_add_u32 s98, s98, 256
    s_sub_u32 s95, s98, 4
    s_max_i32 s95, s95, 0
    s_lshl_b32 s94, s98, 3
    s_lshl_b32 s95, s95, 3
    s_nop 0
    s_add_u32 s94, s94, 3457024
    s_add_u32 s95, s95, 3457024
    s_add_u32 s96, s94, 8192
    buffer_load_dwordx2 v[152:153], v47, s[16:19], s94 offen sc1
    buffer_load_dwordx2 v[154:155], v47, s[16:19], s96 offen sc1
    buffer_load_dwordx2 v[156:157], v48, s[16:19], s95 offen sc1
    s_mov_b64 exec, -1
    s_waitcnt vmcnt(0) lgkmcnt(0)
    s_branch sl_70
rd_73:
    s_cmp_eq_u32 s39, 0
    s_cbranch_scc1 rc_74
    s_sub_u32 s39, s39, 1
    s_nop 7
    s_nop 7
    s_waitcnt vmcnt(0) lgkmcnt(0)
    s_barrier
    s_lshl_b32 s25, s72, 5
    s_add_u32 s25, s25, 256
    s_sub_u32 s26, s25, 4
    s_max_i32 s26, s26, 0
    s_lshl_b32 s27, s71, 12
    s_add_u32 s27, s27, 9437184
    s_lshl_b32 s99, s25, 3
    s_lshl_b32 s100, s26, 3
    s_lshl_b32 s92, s24, 12
    s_lshl_b32 s93, s24, 9
    s_add_u32 s99, s99, s27
    s_add_u32 s100, s100, s27
    s_add_u32 m0, s92, 36352
    s_nop 0
    s_nop 0
    buffer_load_dwordx4 v73, s[16:19], s99 offen offset:0 sc1 lds
    buffer_load_dwordx4 v74, s[16:19], s99 offen offset:1024 sc1 lds
    buffer_load_dwordx4 v75, s[16:19], s99 offen offset:2048 sc1 lds
    buffer_load_dwordx4 v76, s[16:19], s99 offen offset:3072 sc1 lds
    s_add_u32 m0, s93, 53760
    s_add_u32 s99, s99, 524288
    s_mov_b64 exec, s[80:81]
    buffer_load_dwordx4 v77, s[16:19], s100 offen sc1 lds
    s_mov_b64 exec, -1
    s_add_u32 s100, s100, 524288
    s_add_u32 m0, s92, 55936
    s_nop 0
    s_nop 0
    buffer_load_dwordx4 v73, s[16:19], s99 offen offset:0 sc1 lds
    buffer_load_dwordx4 v74, s[16:19], s99 offen offset:1024 sc1 lds
    buffer_load_dwordx4 v75, s[16:19], s99 offen offset:2048 sc1 lds
    buffer_load_dwordx4 v76, s[16:19], s99 offen offset:3072 sc1 lds
    s_add_u32 m0, s93, 73344
    s_add_u32 s99, s99, 524288
    s_mov_b64 exec, s[80:81]
    buffer_load_dwordx4 v77, s[16:19], s100 offen sc1 lds
    s_mov_b64 exec, -1
    s_add_u32 s100, s100, 524288
    s_add_u32 m0, s92, 75520
    s_nop 0
    s_nop 0
    buffer_load_dwordx4 v73, s[16:19], s99 offen offset:0 sc1 lds
    buffer_load_dwordx4 v74, s[16:19], s99 offen offset:1024 sc1 lds
    buffer_load_dwordx4 v75, s[16:19], s99 offen offset:2048 sc1 lds
    buffer_load_dwordx4 v76, s[16:19], s99 offen offset:3072 sc1 lds
    s_add_u32 m0, s93, 92928
    s_add_u32 s99, s99, 524288
    s_mov_b64 exec, s[80:81]
    buffer_load_dwordx4 v77, s[16:19], s100 offen sc1 lds
    s_mov_b64 exec, -1
    s_add_u32 s100, s100, 524288
    s_mov_b64 exec, -1
    s_waitcnt vmcnt(0) lgkmcnt(0)
    s_branch ge_69
rd_76:
    s_cmp_eq_u32 s38, 0
    s_cbranch_scc1 rc_77
    s_sub_u32 s38, s38, 1
    s_nop 7
    s_nop 7
    s_sleep 4
    s_mov_b64 exec, vcc
    s_mov_b32 s96, 12058624
    buffer_load_dwordx4 v[216:219], v56, s[16:19], s96 offen offset:0 sc1
    buffer_load_dwordx4 v[220:223], v56, s[16:19], s96 offen offset:256 sc1
    s_mov_b32 s96, 12091392
    buffer_load_dwordx4 v[224:227], v56, s[16:19], s96 offen offset:0 sc1
    buffer_load_dwordx4 v[228:231], v56, s[16:19], s96 offen offset:256 sc1
    s_mov_b32 s96, 12124160
    buffer_load_dwordx4 v[232:235], v56, s[16:19], s96 offen offset:0 sc1
    buffer_load_dwordx4 v[236:239], v56, s[16:19], s96 offen offset:256 sc1
    s_mov_b32 s96, 12156928
    buffer_load_dwordx4 v[240:243], v56, s[16:19], s96 offen offset:0 sc1
    buffer_load_dwordx4 v[244:247], v56, s[16:19], s96 offen offset:256 sc1
    s_mov_b32 s96, 12058624
    buffer_load_dwordx2 v[248:249], v57, s[16:19], s96 offen offset:0 sc1
    buffer_load_dwordx2 v[252:253], v57, s[16:19], s96 offen offset:128 sc1
    s_mov_b32 s96, 12075008
    buffer_load_dwordx2 v[250:251], v57, s[16:19], s96 offen offset:0 sc1
    buffer_load_dwordx2 v[254:255], v57, s[16:19], s96 offen offset:128 sc1
    s_mov_b32 s96, 9437184
    buffer_load_dwordx4 v[208:211], v59, s[16:19], s96 offen sc1
    s_add_u32 s97, s36, 9437184
    buffer_load_dword v212, v61, s[16:19], s97 offen sc1
    s_mov_b64 exec, -1
    s_waitcnt vmcnt(0) lgkmcnt(0)
    s_branch oe_75
rd_79:
    s_cmp_eq_u32 s38, 0
    s_cbranch_scc1 rc_80
    s_sub_u32 s38, s38, 1
    s_nop 7
    s_nop 7
    s_sleep 4
    s_mov_b64 exec, vcc
    s_mov_b32 s96, 12062720
    buffer_load_dwordx4 v[216:219], v56, s[16:19], s96 offen offset:0 sc1
    buffer_load_dwordx4 v[220:223], v56, s[16:19], s96 offen offset:256 sc1
    s_mov_b32 s96, 12095488
    buffer_load_dwordx4 v[224:227], v56, s[16:19], s96 offen offset:0 sc1
    buffer_load_dwordx4 v[228:231], v56, s[16:19], s96 offen offset:256 sc1
    s_mov_b32 s96, 12128256
    buffer_load_dwordx4 v[232:235], v56, s[16:19], s96 offen offset:0 sc1
    buffer_load_dwordx4 v[236:239], v56, s[16:19], s96 offen offset:256 sc1
    s_mov_b32 s96, 12161024
    buffer_load_dwordx4 v[240:243], v56, s[16:19], s96 offen offset:0 sc1
    buffer_load_dwordx4 v[244:247], v56, s[16:19], s96 offen offset:256 sc1
    s_mov_b32 s96, 12060672
    buffer_load_dwordx2 v[248:249], v57, s[16:19], s96 offen offset:0 sc1
    buffer_load_dwordx2 v[252:253], v57, s[16:19], s96 offen offset:128 sc1
    s_mov_b32 s96, 12077056
    buffer_load_dwordx2 v[250:251], v57, s[16:19], s96 offen offset:0 sc1
    buffer_load_dwordx2 v[254:255], v57, s[16:19], s96 offen offset:128 sc1
    s_mov_b32 s96, 9439232
    buffer_load_dwordx4 v[208:211], v59, s[16:19], s96 offen sc1
    s_add_u32 s97, s36, 9439232
    buffer_load_dword v212, v61, s[16:19], s97 offen sc1
    s_mov_b64 exec, -1
    s_waitcnt vmcnt(0) lgkmcnt(0)
    s_branch oe_78
rd_84:
    s_cmp_eq_u32 s38, 0
    s_cbranch_scc1 rc_85
    s_sub_u32 s38, s38, 1
    s_nop 7
    s_nop 7
    s_sleep 4
    s_mov_b64 exec, vcc
    s_lshl_b32 s96, s75, 14
    s_add_u32 s96, s96, 14680064
    s_lshl_b32 s97, s24, 12
    s_add_u32 s97, s97, 3506176
    buffer_load_dwordx4 v[176:179], v62, s[16:19], s96 offen offset:0 sc1
    buffer_load_dwordx4 v[180:183], v62, s[16:19], s96 offen offset:1024 sc1
    buffer_load_dwordx4 v[184:187], v62, s[16:19], s97 offen offset:0 sc1
    buffer_load_dwordx4 v[188:191], v62, s[16:19], s97 offen offset:1024 sc1
    buffer_load_dwordx4 v[192:195], v62, s[16:19], s97 offen offset:2048 sc1
    buffer_load_dwordx4 v[196:199], v62, s[16:19], s97 offen offset:3072 sc1
    s_mov_b64 exec, -1
    s_waitcnt vmcnt(0) lgkmcnt(0)
    s_branch ce_83
rd_87:
    s_cmp_eq_u32 s38, 0
    s_cbranch_scc1 rc_88
    s_sub_u32 s38, s38, 1
    s_nop 7
    s_nop 7
    s_sleep 4
    s_mov_b64 exec, vcc
    s_lshl_b32 s96, s75, 14
    s_add_u32 s96, s96, 14680064
    s_lshl_b32 s97, s24, 12
    s_add_u32 s97, s97, 3510272
    buffer_load_dwordx4 v[248:251], v62, s[16:19], s96 offen offset:2048 sc1
    buffer_load_dwordx4 v[252:255], v62, s[16:19], s96 offen offset:3072 sc1
    buffer_load_dwordx4 v[96:99], v62, s[16:19], s97 offen offset:0 sc1
    buffer_load_dwordx4 v[100:103], v62, s[16:19], s97 offen offset:1024 sc1
    buffer_load_dwordx4 v[104:107], v62, s[16:19], s97 offen offset:2048 sc1
    buffer_load_dwordx4 v[108:111], v62, s[16:19], s97 offen offset:3072 sc1
    s_mov_b64 exec, -1
    s_waitcnt vmcnt(0) lgkmcnt(0)
    s_branch ce_86
L_last:
    s_endpgm
.section .rodata,"a"
.p2align 6
.amdhsa_kernel interleave_layers__sliding_local_dilated__ssm_conv_s4d__prompt_kernel
  .amdhsa_next_free_vgpr 512
  .amdhsa_next_free_sgpr 102
  .amdhsa_accum_offset 256
  .amdhsa_group_segment_fixed_size 0
  .amdhsa_kernarg_size 104
  .amdhsa_user_sgpr_count 2
  .amdhsa_user_sgpr_kernarg_segment_ptr 1
  .amdhsa_system_sgpr_workgroup_id_x 1
.end_amdhsa_kernel
```
